```python
import torch

def _softmax(x, axis=-1):
    return torch.softmax(x, dim=axis)
def _gelu(x):
    return torch.nn.functional.gelu(x, approximate="tanh")
def _silu(x):
    return torch.nn.functional.silu(x)
def _sigmoid(x):
    return torch.sigmoid(x)
def _layernorm(x, axis=-1, eps=1e-5):
    m = x.mean(dim=axis, keepdim=True)
    v = x.var(dim=axis, keepdim=True, unbiased=False)
    return (x - m) / torch.sqrt(v + eps)
def _scatter_add(tgt, idx, src, axis=0):
    return tgt.clone().index_add_(axis, idx, src)
def _segment_sum(src, seg, n):
    out = torch.zeros((n,) + src.shape[1:], dtype=src.dtype)
    return out.index_add_(0, seg, src)
def _pad(x, pw):
    flat = tuple(v for pair in reversed(pw) for v in pair)
    return torch.nn.functional.pad(x, flat)

kernel_name = 'concat_heads__mha_block_cached__mha_block_cached__near_ridge'

def setup_inputs():

    _w = (lambda a: (lambda t: t.to(torch.bfloat16) if t.is_floating_point() else t)(torch.as_tensor(a)))
    def _A_setup():
        B, Sq, D = 8, 256, 576
        H, Sk, Dh = 32, 1024, 128
        return {
            "x": _w((lambda *s: torch.randn(*s, dtype=torch.bfloat16) * 0.8)(B, Sq, D)),
            "k_cache": _w((lambda *s: torch.randn(*s, dtype=torch.bfloat16) * 0.8)(B, H, Sk, Dh)),
            "v_cache": _w((lambda *s: torch.randn(*s, dtype=torch.bfloat16) * 0.05)(B, H, Sk, Dh)),
            "wq": _w((lambda *s: torch.randn(*s, dtype=torch.bfloat16) * 0.8)(D, H * Dh) * (D ** -0.5)),
            "wo": _w((lambda *s: torch.randn(*s, dtype=torch.bfloat16) * 0.05)(H * Dh, D) * ((H * Dh) ** -0.5)),
        }
    _A_in = _A_setup()

    def _B_setup():
        B, Sq, D = 8, 256, 576
        H, Sk, Dh = 32, 1024, 128
        return {
            "x": _w((lambda *s: torch.randn(*s, dtype=torch.bfloat16) * 0.8)(B, Sq, D)),
            "k_cache": _w((lambda *s: torch.randn(*s, dtype=torch.bfloat16) * 0.8)(B, H, Sk, Dh)),
            "v_cache": _w((lambda *s: torch.randn(*s, dtype=torch.bfloat16) * 0.05)(B, H, Sk, Dh)),
            "wq": _w((lambda *s: torch.randn(*s, dtype=torch.bfloat16) * 0.8)(D, H * Dh) * (D ** -0.5)),
            "wo": _w((lambda *s: torch.randn(*s, dtype=torch.bfloat16) * 0.05)(H * Dh, D) * ((H * Dh) ** -0.5)),
        }
    _B_in = _B_setup()

    return {
        "A_x": _A_in["x"],
        "A_k_cache": _A_in["k_cache"],
        "A_v_cache": _A_in["v_cache"],
        "A_wq": _A_in["wq"],
        "A_wo": _A_in["wo"],
        "B_x": _B_in["x"],
        "B_k_cache": _B_in["k_cache"],
        "B_v_cache": _B_in["v_cache"],
        "B_wq": _B_in["wq"],
        "B_wo": _B_in["wo"],
    }

def reference(A_x, A_k_cache, A_v_cache, A_wq, A_wo, B_x, B_k_cache, B_v_cache, B_wq, B_wo):
    def _A_ref(x, k_cache, v_cache, wq, wo):
        B, Sq, D = x.shape
        H, Dh = 32, 128
        q = (lambda x, *d: x.permute(*d))((x @ wq).reshape(B, Sq, H, Dh), 0, 2, 1, 3)
        scores = torch.einsum("bhqd,bhkd->bhqk", q, k_cache) * (Dh ** -0.5)
        p = _softmax(scores, axis=-1)
        o = torch.einsum("bhqk,bhkd->bhqd", p, v_cache)
        return (lambda x, *d: x.permute(*d))(o, 0, 2, 1, 3).reshape(B, Sq, H * Dh) @ wo

    def _B_ref(x, k_cache, v_cache, wq, wo):
        B, Sq, D = x.shape
        H, Dh = 32, 128
        q = (lambda x, *d: x.permute(*d))((x @ wq).reshape(B, Sq, H, Dh), 0, 2, 1, 3)
        scores = torch.einsum("bhqd,bhkd->bhqk", q, k_cache) * (Dh ** -0.5)
        p = _softmax(scores, axis=-1)
        o = torch.einsum("bhqk,bhkd->bhqd", p, v_cache)
        return (lambda x, *d: x.permute(*d))(o, 0, 2, 1, 3).reshape(B, Sq, H * Dh) @ wo

    a = _A_ref(A_x, A_k_cache, A_v_cache, A_wq, A_wo)
    b = _B_ref(B_x, B_k_cache, B_v_cache, B_wq, B_wo)
    return torch.concatenate([a, b], axis=-1)
```

```asm
; @launch grid=(256,1,1) block=(256,1,1) lds=163840
.amdgcn_target "amdgcn-amd-amdhsa--gfx950"
.text
.globl concat_heads__mha_block_cached__mha_block_cached__near_ridge_kernel
.p2align 8
.type concat_heads__mha_block_cached__mha_block_cached__near_ridge_kernel,@function
concat_heads__mha_block_cached__mha_block_cached__near_ridge_kernel:
s_cmp_lt_u32 s2,256
s_cbranch_scc1 K1_GO
s_endpgm
K1_GO:
s_load_dwordx16 s[64:79],s[0:1],0
s_load_dwordx8 s[80:87],s[0:1],64
s_load_dwordx2 s[88:89],s[0:1],96
s_getpc_b64 s[92:93]
K1_PC:
s_mov_b32 s94,K1_COLD-K1_PC
s_mov_b32 s95,0x20000
s_lshr_b32 s90,s2,3
s_lshl_b32 s90,s90,12
v_lshrrev_b32 v29,6,v0
v_and_b32 v41,7,v0
v_lshl_add_u32 v41,v29,3,v41
v_lshlrev_b32 v41,7,v41
buffer_load_dword v22,v41,s[92:95],s90 offen
v_and_b32 v0,63,v0
v_readfirstlane_b32 s3,v29
s_and_b32 s4,s2,7
s_lshr_b32 s5,s2,3
s_lshr_b32 s36,s4,2
s_and_b32 s6,s4,1
s_lshl_b32 s6,s6,2
s_and_b32 s7,s5,3
s_add_u32 s37,s6,s7
s_and_b32 s6,s4,2
s_lshl_b32 s6,s6,2
s_lshr_b32 s7,s5,2
s_add_u32 s38,s6,s7
s_lshl_b32 s39,s3,12
s_lshl_b32 s40,s3,13
s_mov_b32 s42,1040356334
s_mov_b32 s43,1040356334
s_mov_b32 s52,1400897536
s_lshr_b32 s6,s38,2
s_xor_b32 s44,s6,0
s_mul_i32 s44,s44,18432
s_xor_b32 s45,s6,1
s_mul_i32 s45,s45,18432
s_xor_b32 s46,s6,2
s_mul_i32 s46,s46,18432
s_xor_b32 s47,s6,3
s_mul_i32 s47,s47,18432
v_and_b32 v30,15,v0
v_lshrrev_b32 v31,4,v0
v_bfe_u32 v32,v0,2,2
v_and_b32 v33,3,v0
v_lshlrev_b32 v3,4,v0
v_and_b32 v34,1,v29
v_lshl_add_u32 v34,v34,2,v31
v_lshlrev_b32 v34,1,v34
v_xor_b32 v34,v34,v30
v_lshlrev_b32 v34,4,v34
v_lshl_add_u32 v35,v29,3,v31
v_lshl_add_u32 v2,v35,13,v34
v_lshrrev_b32 v34,3,v0
v_lshl_add_u32 v35,v29,6,v34
v_mul_u32_u24 v35,1152,v35
v_and_b32 v36,7,v0
v_xor_b32 v36,v36,v31
v_lshlrev_b32 v36,4,v36
v_add_u32 v1,v35,v36
v_xor_b32 v36,64,v36
v_add_u32 v42,v35,v36
s_lshl_b32 s6,s5,2
s_add_u32 s6,s6,s3
s_lshl_b32 s7,s6,13
s_and_b32 s53,s38,8
s_lshl_b32 s53,s53,9
s_add_u32 s7,s7,s53
v_and_b32 v37,31,v0
v_lshlrev_b32 v37,7,v37
v_add_u32 v37,s7,v37
s_and_b32 s53,s37,4
s_lshl_b32 s53,s53,8
s_lshl_b32 s7,s6,3
s_add_u32 s7,s7,s53
s_mul_i32 s7,s7,1152
v_and_b32 v38,7,v0
v_mul_u32_u24 v38,1152,v38
v_bfe_u32 v36,v0,3,1
v_lshl_add_u32 v38,v36,7,v38
v_add_u32 v38,s7,v38
v_and_b32 v65,7,v0
v_mul_u32_u24 v65,1152,v65
v_add_u32 v65,s7,v65
s_lshr_b32 s7,s6,1
s_lshl_b32 s7,s7,13
s_and_b32 s53,s6,1
s_lshl_b32 s53,s53,11
s_add_u32 s7,s7,s53
s_and_b32 s53,s38,8
s_lshl_b32 s53,s53,9
s_add_u32 s7,s7,s53
v_lshlrev_b32 v64,7,v30
v_add_u32 v64,s7,v64
s_waitcnt lgkmcnt(0)
s_cmp_eq_u32 s36,0
s_cselect_b32 s64,s64,s74
s_cselect_b32 s65,s65,s75
s_cselect_b32 s66,s66,s76
s_cselect_b32 s67,s67,s77
s_cselect_b32 s68,s68,s78
s_cselect_b32 s69,s69,s79
s_cselect_b32 s70,s70,s80
s_cselect_b32 s71,s71,s81
s_cselect_b32 s72,s72,s82
s_cselect_b32 s73,s73,s83
s_lshl_b32 s4,s38,9
s_add_u32 s20,s70,s4
s_addc_u32 s21,s71,0
s_sub_u32 s22,4718592,s4
s_mov_b32 s23,0x20000
s_mul_i32 s4,s37,294912
s_add_u32 s16,s64,s4
s_addc_u32 s17,s65,0
s_mov_b32 s18,294912
s_mov_b32 s19,0x20000
s_mov_b32 s56,s70
s_mov_b32 s57,s71
s_mov_b32 s58,4718592
s_mov_b32 s59,0x20000
s_mov_b32 s60,s64
s_mov_b32 s61,s65
s_mov_b32 s62,2359296
s_mov_b32 s63,0x20000
s_add_u32 m0,s39,49152
s_mov_b32 s41,0
buffer_load_dwordx4 v2,s[20:23],s41 offen  lds
s_mov_b32 s41,31744
buffer_load_dwordx4 v2,s[20:23],s41 offen offset:1024  lds
s_mov_b32 s41,260096
buffer_load_dwordx4 v2,s[20:23],s41 offen offset:2048  lds
s_mov_b32 s41,291840
buffer_load_dwordx4 v2,s[20:23],s41 offen offset:3072  lds
s_add_u32 m0,s40,131072
s_add_u32 s41,s44,0
buffer_load_dwordx4 v1,s[16:19],s41 offen  lds
s_add_u32 s41,s44,8192
buffer_load_dwordx4 v42,s[16:19],s41 offen offset:1024  lds
s_add_u32 m0,s40,133120
s_add_u32 s41,s45,0
buffer_load_dwordx4 v1,s[16:19],s41 offen  lds
s_add_u32 s41,s45,8192
buffer_load_dwordx4 v42,s[16:19],s41 offen offset:1024  lds
s_add_u32 m0,s40,135168
s_add_u32 s41,s46,0
buffer_load_dwordx4 v1,s[16:19],s41 offen  lds
s_add_u32 s41,s46,8192
buffer_load_dwordx4 v42,s[16:19],s41 offen offset:1024  lds
s_add_u32 m0,s40,137216
s_add_u32 s41,s47,0
buffer_load_dwordx4 v1,s[16:19],s41 offen  lds
s_add_u32 s41,s47,8192
buffer_load_dwordx4 v42,s[16:19],s41 offen offset:1024  lds
s_add_u32 m0,s39,114688
s_mov_b32 s41,256
buffer_load_dwordx4 v2,s[20:23],s41 offen  lds
s_mov_b32 s41,32000
buffer_load_dwordx4 v2,s[20:23],s41 offen offset:1024  lds
s_mov_b32 s41,260352
buffer_load_dwordx4 v2,s[20:23],s41 offen offset:2048  lds
s_mov_b32 s41,292096
buffer_load_dwordx4 v2,s[20:23],s41 offen offset:3072  lds
s_mov_b32 s41,524288
buffer_load_dword v22,v64,s[56:59],s41 offen
buffer_load_dword v22,v65,s[60:63],0 offen offset:128
s_lshl_b32 s4,s37,4
s_add_u32 s4,s4,s38
s_lshl_b32 s5,s4,19
s_add_u32 s8,s66,s5
s_addc_u32 s9,s67,0
s_mov_b32 s10,0x80000
s_mov_b32 s11,0x20000
s_add_u32 s12,s68,s5
s_addc_u32 s13,s69,0
s_mov_b32 s14,0x80000
s_mov_b32 s15,0x20000
s_lshr_b32 s5,s38,3
s_mul_i32 s5,s5,2359296
s_add_u32 s24,s72,s5
s_addc_u32 s25,s73,0
s_mov_b32 s26,2359296
s_mov_b32 s27,0x20000
s_lshr_b32 s5,s2,3
s_lshl_b32 s5,s5,2
s_add_u32 s5,s5,s3
s_and_b32 s6,s2,1
s_lshl_b32 s6,s6,7
s_add_u32 s5,s5,s6
s_mul_i32 s5,s5,9216
s_mov_b32 s54,s5
s_lshl_b32 s5,s36,5
s_lshl_b32 s6,s37,2
s_add_u32 s5,s5,s6
s_add_u32 s5,s5,s3
s_lshl_b32 s5,s5,7
s_and_b32 s6,s38,12
s_lshl_b32 s6,s6,3
s_add_u32 s5,s5,s6
s_lshl_b32 s5,s5,12
s_add_u32 s28,s88,s5
s_addc_u32 s29,s89,0
s_mov_b32 s30,131072
s_mov_b32 s31,0x20000
v_lshlrev_b32 v35,12,v31
v_lshl_add_u32 v35,v32,8,v35
v_lshl_add_u32 v35,v33,3,v35
v_and_b32 v34,1,v31
v_lshl_add_u32 v36,v34,2,v32
v_lshl_add_u32 v35,v36,5,v35
v_xor_b32 v36,0,v35
v_add_u32 v48,32768,v36
v_add_u32 v56,98304,v36
v_xor_b32 v36,32,v35
v_add_u32 v49,32768,v36
v_add_u32 v57,98304,v36
v_xor_b32 v36,64,v35
v_add_u32 v50,32768,v36
v_add_u32 v58,98304,v36
v_xor_b32 v36,96,v35
v_add_u32 v51,32768,v36
v_add_u32 v59,98304,v36
v_xor_b32 v36,128,v35
v_add_u32 v52,32768,v36
v_add_u32 v60,98304,v36
v_xor_b32 v36,160,v35
v_add_u32 v53,32768,v36
v_add_u32 v61,98304,v36
v_xor_b32 v36,192,v35
v_add_u32 v54,32768,v36
v_add_u32 v62,98304,v36
v_xor_b32 v36,224,v35
v_add_u32 v55,32768,v36
v_add_u32 v63,98304,v36
v_lshrrev_b32 v34,1,v30
v_xor_b32 v34,v34,v31
v_lshlrev_b32 v34,4,v34
v_lshl_add_u32 v34,v30,7,v34
v_lshl_add_u32 v34,v29,13,v34
v_add_u32 v39,131072,v34
v_xor_b32 v40,64,v39
v_lshl_add_u32 v34,v29,4,v31
v_lshlrev_b32 v34,8,v34
v_xor_b32 v35,v30,v31
v_lshl_add_u32 v4,v35,4,v34
v_xor_b32 v5,64,v4
v_xor_b32 v6,128,v4
v_xor_b32 v7,192,v4
v_lshlrev_b32 v35,1,v31
v_xor_b32 v35,v30,v35
v_lshl_add_u32 v8,v35,4,v34
v_xor_b32 v9,0x80,v8
v_and_b32 v34,1,v31
v_lshrrev_b32 v35,1,v31
v_lshl_add_u32 v34,v34,1,v35
v_xor_b32 v34,v34,v30
v_lshlrev_b32 v34,4,v34
v_lshl_add_u32 v10,v30,8,v34
v_xor_b32 v11,64,v10
v_xor_b32 v12,128,v10
v_xor_b32 v13,192,v10
v_lshl_add_u32 v34,v31,2,v32
v_and_b32 v35,7,v34
v_lshlrev_b32 v35,5,v35
v_lshl_add_u32 v35,v33,3,v35
v_lshl_add_u32 v34,v34,8,v35
v_add_u32 v14,65536,v34
v_xor_b32 v15,32,v14
v_xor_b32 v16,64,v14
v_xor_b32 v17,96,v14
v_xor_b32 v18,128,v14
v_xor_b32 v19,160,v14
v_xor_b32 v20,192,v14
v_xor_b32 v21,224,v14
v_mov_b32 v44,0x3f803f80
v_mov_b32 v45,0x3f803f80
v_mov_b32 v46,0x3f803f80
v_mov_b32 v47,0x3f803f80
v_min_u32 v29,17,v0
v_lshlrev_b32 v29,7,v29
v_add_u32 v29,s54,v29
s_lshr_b32 s64,s38,2
s_and_b32 s91,s38,3
s_mul_i32 s4,s64,1179648
s_mul_i32 s5,s91,288
s_add_u32 s4,s4,s5
s_add_u32 s50,s72,s4
s_addc_u32 s51,s73,0
s_mov_b32 s4,s91
s_mul_i32 s74,s4,294912
s_lshl_b32 s78,s4,15
s_cmp_lt_u32 0,s91
s_cselect_b32 s4,0,1
s_mul_i32 s75,s4,294912
s_lshl_b32 s79,s4,15
s_cmp_lt_u32 1,s91
s_cselect_b32 s4,1,2
s_mul_i32 s76,s4,294912
s_lshl_b32 s80,s4,15
s_cmp_lt_u32 2,s91
s_cselect_b32 s4,2,3
s_mul_i32 s77,s4,294912
s_lshl_b32 s81,s4,15
v_lshl_add_u32 v34,v31,2,v32
v_mul_u32_u24 v34,288,v34
v_lshl_add_u32 v23,v33,3,v34
v_add_u32 v28,0x10000,v23
s_lshr_b32 s6,s3,1
s_lshl_b32 s6,s6,16
s_and_b32 s7,s3,1
s_mul_i32 s7,s7,9216
s_add_u32 s65,s6,s7
s_mul_i32 s66,s3,36864
s_add_u32 s32,s88,42991616
s_addc_u32 s33,s89,0
s_mov_b32 s34,0x80000
s_mov_b32 s35,0x20000
s_add_u32 s72,s88,44040192
s_addc_u32 s73,s89,0
v_mov_b32 v27,0
v_lshlrev_b32 v25,19,v0
s_lshl_b32 s83,s36,7
s_lshl_b32 s4,s36,3
s_add_u32 s4,s4,s37
s_lshl_b32 s5,s4,2
s_add_u32 s5,s5,s3
s_lshl_b32 s5,s5,2
s_add_u32 s5,s5,s64
s_lshl_b32 s69,s5,8
s_mov_b32 s82,s69
s_lshl_b32 s5,s91,19
s_add_u32 s5,s5,s69
v_lshlrev_b32 v26,16,v0
v_lshrrev_b32 v34,1,v0
v_lshl_add_u32 v26,v34,19,v26
v_add_u32 v26,s5,v26
s_lshl_b32 s4,s4,4
s_add_u32 s4,s4,s38
s_lshl_b32 s4,s4,2
s_add_u32 s70,s4,s3
s_lshl_b32 s67,s70,8
s_add_u32 s67,s67,0x40000
s_lshl_b32 s71,s3,8
s_add_u32 s71,s71,s83
s_waitcnt vmcnt(6)
s_barrier
ds_read_b64_tr_b16 v[80:81],v48 offset:16384
ds_read_b64_tr_b16 v[82:83],v48 offset:17408
ds_read_b64_tr_b16 v[84:85],v48 offset:18432
ds_read_b64_tr_b16 v[86:87],v48 offset:19456
ds_read_b64_tr_b16 v[88:89],v49 offset:16384
ds_read_b64_tr_b16 v[90:91],v49 offset:17408
ds_read_b64_tr_b16 v[92:93],v49 offset:18432
ds_read_b64_tr_b16 v[94:95],v49 offset:19456
ds_read_b64_tr_b16 v[96:97],v50 offset:16384
ds_read_b64_tr_b16 v[98:99],v50 offset:17408
ds_read_b64_tr_b16 v[100:101],v50 offset:18432
ds_read_b64_tr_b16 v[102:103],v50 offset:19456
ds_read_b128 a[64:67],v39 offset:0
ds_read_b128 a[68:71],v40 offset:0
ds_read_b128 a[72:75],v39 offset:2048
ds_read_b128 a[76:79],v40 offset:2048
ds_read_b128 a[80:83],v39 offset:4096
ds_read_b128 a[84:87],v40 offset:4096
ds_read_b128 a[88:91],v39 offset:6144
ds_read_b128 a[92:95],v40 offset:6144
s_waitcnt lgkmcnt(7)
v_mfma_f32_16x16x32_bf16 a[128:131],v[80:83],a[64:67],0
ds_read_b64_tr_b16 v[104:105],v51 offset:16384
s_mov_b32 s41,1048576
s_waitcnt lgkmcnt(7)
v_mfma_f32_16x16x32_bf16 a[128:131],v[84:87],a[68:71],a[128:131]
ds_read_b64_tr_b16 v[106:107],v51 offset:17408
s_waitcnt lgkmcnt(7)
v_mfma_f32_16x16x32_bf16 a[132:135],v[80:83],a[72:75],0
ds_read_b64_tr_b16 v[108:109],v51 offset:18432
s_waitcnt lgkmcnt(7)
v_mfma_f32_16x16x32_bf16 a[132:135],v[84:87],a[76:79],a[132:135]
ds_read_b64_tr_b16 v[110:111],v51 offset:19456
s_waitcnt lgkmcnt(7)
v_mfma_f32_16x16x32_bf16 a[136:139],v[80:83],a[80:83],0
buffer_load_dword v22,v64,s[56:59],s41 offen
s_waitcnt lgkmcnt(6)
v_mfma_f32_16x16x32_bf16 a[136:139],v[84:87],a[84:87],a[136:139]
buffer_load_dword v22,v65,s[60:63],0 offen offset:256
s_waitcnt lgkmcnt(5)
v_mfma_f32_16x16x32_bf16 a[140:143],v[80:83],a[88:91],0
s_add_u32 m0,s39,32768
s_waitcnt lgkmcnt(4)
v_mfma_f32_16x16x32_bf16 a[140:143],v[84:87],a[92:95],a[140:143]
s_mov_b32 s41,524288
v_mfma_f32_16x16x32_bf16 a[144:147],v[88:91],a[64:67],0
ds_read_b64_tr_b16 v[112:113],v52 offset:16384
v_mfma_f32_16x16x32_bf16 a[144:147],v[92:95],a[68:71],a[144:147]
ds_read_b64_tr_b16 v[114:115],v52 offset:17408
v_mfma_f32_16x16x32_bf16 a[148:151],v[88:91],a[72:75],0
ds_read_b64_tr_b16 v[116:117],v52 offset:18432
v_mfma_f32_16x16x32_bf16 a[148:151],v[92:95],a[76:79],a[148:151]
ds_read_b64_tr_b16 v[118:119],v52 offset:19456
v_mfma_f32_16x16x32_bf16 a[152:155],v[88:91],a[80:83],0
buffer_load_dwordx4 v2,s[20:23],s41 offen  lds
v_mfma_f32_16x16x32_bf16 a[152:155],v[92:95],a[84:87],a[152:155]
s_mov_b32 s41,556032
v_mfma_f32_16x16x32_bf16 a[156:159],v[88:91],a[88:91],0
buffer_load_dwordx4 v2,s[20:23],s41 offen offset:1024  lds
v_mfma_f32_16x16x32_bf16 a[156:159],v[92:95],a[92:95],a[156:159]
s_mov_b32 s41,784384
v_mfma_f32_16x16x32_bf16 a[160:163],v[96:99],a[64:67],0
ds_read_b64_tr_b16 v[120:121],v53 offset:16384
v_mfma_f32_16x16x32_bf16 a[160:163],v[100:103],a[68:71],a[160:163]
ds_read_b64_tr_b16 v[122:123],v53 offset:17408
v_mfma_f32_16x16x32_bf16 a[164:167],v[96:99],a[72:75],0
ds_read_b64_tr_b16 v[124:125],v53 offset:18432
v_mfma_f32_16x16x32_bf16 a[164:167],v[100:103],a[76:79],a[164:167]
ds_read_b64_tr_b16 v[126:127],v53 offset:19456
v_mfma_f32_16x16x32_bf16 a[168:171],v[96:99],a[80:83],0
buffer_load_dwordx4 v2,s[20:23],s41 offen offset:2048  lds
v_mfma_f32_16x16x32_bf16 a[168:171],v[100:103],a[84:87],a[168:171]
s_mov_b32 s41,816128
v_mfma_f32_16x16x32_bf16 a[172:175],v[96:99],a[88:91],0
buffer_load_dwordx4 v2,s[20:23],s41 offen offset:3072  lds
v_mfma_f32_16x16x32_bf16 a[172:175],v[100:103],a[92:95],a[172:175]
s_add_u32 m0,s40,131072
s_waitcnt lgkmcnt(4)
v_mfma_f32_16x16x32_bf16 a[176:179],v[104:107],a[64:67],0
ds_read_b64_tr_b16 v[80:81],v54 offset:16384
s_add_u32 s41,s44,128
v_mfma_f32_16x16x32_bf16 a[176:179],v[108:111],a[68:71],a[176:179]
ds_read_b64_tr_b16 v[82:83],v54 offset:17408
v_mfma_f32_16x16x32_bf16 a[180:183],v[104:107],a[72:75],0
ds_read_b64_tr_b16 v[84:85],v54 offset:18432
v_mfma_f32_16x16x32_bf16 a[180:183],v[108:111],a[76:79],a[180:183]
ds_read_b64_tr_b16 v[86:87],v54 offset:19456
v_mfma_f32_16x16x32_bf16 a[184:187],v[104:107],a[80:83],0
buffer_load_dwordx4 v1,s[16:19],s41 offen  lds
v_mfma_f32_16x16x32_bf16 a[184:187],v[108:111],a[84:87],a[184:187]
s_add_u32 s41,s44,8320
v_mfma_f32_16x16x32_bf16 a[188:191],v[104:107],a[88:91],0
buffer_load_dwordx4 v42,s[16:19],s41 offen offset:1024  lds
v_mfma_f32_16x16x32_bf16 a[188:191],v[108:111],a[92:95],a[188:191]
s_add_u32 m0,s40,133120
v_mfma_f32_16x16x32_bf16 a[192:195],v[112:115],a[64:67],0
ds_read_b64_tr_b16 v[88:89],v55 offset:16384
s_add_u32 s41,s45,128
v_mfma_f32_16x16x32_bf16 a[192:195],v[116:119],a[68:71],a[192:195]
ds_read_b64_tr_b16 v[90:91],v55 offset:17408
v_mfma_f32_16x16x32_bf16 a[196:199],v[112:115],a[72:75],0
ds_read_b64_tr_b16 v[92:93],v55 offset:18432
v_mfma_f32_16x16x32_bf16 a[196:199],v[116:119],a[76:79],a[196:199]
ds_read_b64_tr_b16 v[94:95],v55 offset:19456
v_mfma_f32_16x16x32_bf16 a[200:203],v[112:115],a[80:83],0
buffer_load_dwordx4 v1,s[16:19],s41 offen  lds
v_mfma_f32_16x16x32_bf16 a[200:203],v[116:119],a[84:87],a[200:203]
s_add_u32 s41,s45,8320
buffer_load_dwordx4 v42,s[16:19],s41 offen offset:1024  lds
v_mfma_f32_16x16x32_bf16 a[204:207],v[112:115],a[88:91],0
s_waitcnt vmcnt(12)
s_add_u32 m0,s40,135168
v_mfma_f32_16x16x32_bf16 a[204:207],v[116:119],a[92:95],a[204:207]
s_waitcnt lgkmcnt(0)
s_barrier
v_mfma_f32_16x16x32_bf16 a[208:211],v[120:123],a[64:67],0
ds_read_b64_tr_b16 v[96:97],v56 offset:16384
s_add_u32 s41,s46,128
v_mfma_f32_16x16x32_bf16 a[208:211],v[124:127],a[68:71],a[208:211]
ds_read_b64_tr_b16 v[98:99],v56 offset:17408
v_mfma_f32_16x16x32_bf16 a[212:215],v[120:123],a[72:75],0
ds_read_b64_tr_b16 v[100:101],v56 offset:18432
v_mfma_f32_16x16x32_bf16 a[212:215],v[124:127],a[76:79],a[212:215]
ds_read_b64_tr_b16 v[102:103],v56 offset:19456
v_mfma_f32_16x16x32_bf16 a[216:219],v[120:123],a[80:83],0
buffer_load_dwordx4 v1,s[16:19],s41 offen  lds
v_mfma_f32_16x16x32_bf16 a[216:219],v[124:127],a[84:87],a[216:219]
s_add_u32 s41,s46,8320
v_mfma_f32_16x16x32_bf16 a[220:223],v[120:123],a[88:91],0
buffer_load_dwordx4 v42,s[16:19],s41 offen offset:1024  lds
v_mfma_f32_16x16x32_bf16 a[220:223],v[124:127],a[92:95],a[220:223]
s_add_u32 m0,s40,137216
v_mfma_f32_16x16x32_bf16 a[224:227],v[80:83],a[64:67],0
ds_read_b64_tr_b16 v[104:105],v57 offset:16384
s_add_u32 s41,s47,128
v_mfma_f32_16x16x32_bf16 a[224:227],v[84:87],a[68:71],a[224:227]
ds_read_b64_tr_b16 v[106:107],v57 offset:17408
v_mfma_f32_16x16x32_bf16 a[228:231],v[80:83],a[72:75],0
ds_read_b64_tr_b16 v[108:109],v57 offset:18432
v_mfma_f32_16x16x32_bf16 a[228:231],v[84:87],a[76:79],a[228:231]
ds_read_b64_tr_b16 v[110:111],v57 offset:19456
v_mfma_f32_16x16x32_bf16 a[232:235],v[80:83],a[80:83],0
buffer_load_dwordx4 v1,s[16:19],s41 offen  lds
v_mfma_f32_16x16x32_bf16 a[232:235],v[84:87],a[84:87],a[232:235]
s_add_u32 s41,s47,8320
v_mfma_f32_16x16x32_bf16 a[236:239],v[80:83],a[88:91],0
buffer_load_dwordx4 v42,s[16:19],s41 offen offset:1024  lds
v_mfma_f32_16x16x32_bf16 a[236:239],v[84:87],a[92:95],a[236:239]
s_add_u32 m0,s39,98304
v_mfma_f32_16x16x32_bf16 a[240:243],v[88:91],a[64:67],0
ds_read_b64_tr_b16 v[112:113],v58 offset:16384
s_mov_b32 s41,524544
v_mfma_f32_16x16x32_bf16 a[240:243],v[92:95],a[68:71],a[240:243]
ds_read_b64_tr_b16 v[114:115],v58 offset:17408
v_mfma_f32_16x16x32_bf16 a[244:247],v[88:91],a[72:75],0
ds_read_b64_tr_b16 v[116:117],v58 offset:18432
v_mfma_f32_16x16x32_bf16 a[244:247],v[92:95],a[76:79],a[244:247]
ds_read_b64_tr_b16 v[118:119],v58 offset:19456
v_mfma_f32_16x16x32_bf16 a[248:251],v[88:91],a[80:83],0
buffer_load_dwordx4 v2,s[20:23],s41 offen  lds
v_mfma_f32_16x16x32_bf16 a[248:251],v[92:95],a[84:87],a[248:251]
s_mov_b32 s41,556288
v_mfma_f32_16x16x32_bf16 a[252:255],v[88:91],a[88:91],0
buffer_load_dwordx4 v2,s[20:23],s41 offen offset:1024  lds
v_mfma_f32_16x16x32_bf16 a[252:255],v[92:95],a[92:95],a[252:255]
s_mov_b32 s41,784640
s_waitcnt lgkmcnt(3)
v_mfma_f32_16x16x32_bf16 v[128:131],v[96:99],a[64:67],0
ds_read_b64_tr_b16 v[120:121],v59 offset:16384
v_mfma_f32_16x16x32_bf16 v[128:131],v[100:103],a[68:71],v[128:131]
ds_read_b64_tr_b16 v[122:123],v59 offset:17408
v_mfma_f32_16x16x32_bf16 v[160:163],v[96:99],a[72:75],0
ds_read_b64_tr_b16 v[124:125],v59 offset:18432
v_mfma_f32_16x16x32_bf16 v[160:163],v[100:103],a[76:79],v[160:163]
ds_read_b64_tr_b16 v[126:127],v59 offset:19456
v_mfma_f32_16x16x32_bf16 v[192:195],v[96:99],a[80:83],0
buffer_load_dwordx4 v2,s[20:23],s41 offen offset:2048  lds
v_mfma_f32_16x16x32_bf16 v[192:195],v[100:103],a[84:87],v[192:195]
s_mov_b32 s41,816384
v_mfma_f32_16x16x32_bf16 v[224:227],v[96:99],a[88:91],0
buffer_load_dwordx4 v2,s[20:23],s41 offen offset:3072  lds
v_mfma_f32_16x16x32_bf16 v[224:227],v[100:103],a[92:95],v[224:227]
s_add_u32 m0,s39,49152
v_mfma_f32_16x16x32_bf16 v[132:135],v[104:107],a[64:67],0
ds_read_b64_tr_b16 v[80:81],v60 offset:16384
s_mov_b32 s41,1048576
v_mfma_f32_16x16x32_bf16 v[132:135],v[108:111],a[68:71],v[132:135]
ds_read_b64_tr_b16 v[82:83],v60 offset:17408
v_mfma_f32_16x16x32_bf16 v[164:167],v[104:107],a[72:75],0
ds_read_b64_tr_b16 v[84:85],v60 offset:18432
v_mfma_f32_16x16x32_bf16 v[164:167],v[108:111],a[76:79],v[164:167]
ds_read_b64_tr_b16 v[86:87],v60 offset:19456
v_mfma_f32_16x16x32_bf16 v[196:199],v[104:107],a[80:83],0
buffer_load_dwordx4 v2,s[20:23],s41 offen  lds
v_mfma_f32_16x16x32_bf16 v[196:199],v[108:111],a[84:87],v[196:199]
s_add_u32 m0,s39,49152
v_mfma_f32_16x16x32_bf16 v[228:231],v[104:107],a[88:91],0
s_mov_b32 s41,1080320
v_mfma_f32_16x16x32_bf16 v[228:231],v[108:111],a[92:95],v[228:231]
buffer_load_dwordx4 v2,s[20:23],s41 offen offset:1024  lds
s_waitcnt lgkmcnt(3)
v_mfma_f32_16x16x32_bf16 v[136:139],v[112:115],a[64:67],0
ds_read_b64_tr_b16 v[88:89],v61 offset:16384
s_add_u32 m0,s39,49152
v_mfma_f32_16x16x32_bf16 v[136:139],v[116:119],a[68:71],v[136:139]
ds_read_b64_tr_b16 v[90:91],v61 offset:17408
s_mov_b32 s41,1308672
v_mfma_f32_16x16x32_bf16 v[168:171],v[112:115],a[72:75],0
ds_read_b64_tr_b16 v[92:93],v61 offset:18432
v_mfma_f32_16x16x32_bf16 v[168:171],v[116:119],a[76:79],v[168:171]
ds_read_b64_tr_b16 v[94:95],v61 offset:19456
v_mfma_f32_16x16x32_bf16 v[200:203],v[112:115],a[80:83],0
buffer_load_dwordx4 v2,s[20:23],s41 offen offset:2048  lds
v_mfma_f32_16x16x32_bf16 v[200:203],v[116:119],a[84:87],v[200:203]
s_mov_b32 s41,1572864
v_mfma_f32_16x16x32_bf16 v[232:235],v[112:115],a[88:91],0
buffer_load_dword v22,v64,s[56:59],s41 offen
v_mfma_f32_16x16x32_bf16 v[232:235],v[116:119],a[92:95],v[232:235]
buffer_load_dword v22,v65,s[60:63],0 offen offset:384
v_mfma_f32_16x16x32_bf16 v[140:143],v[120:123],a[64:67],0
ds_read_b64_tr_b16 v[96:97],v62 offset:16384
s_add_u32 m0,s39,49152
v_mfma_f32_16x16x32_bf16 v[140:143],v[124:127],a[68:71],v[140:143]
ds_read_b64_tr_b16 v[98:99],v62 offset:17408
s_mov_b32 s41,1340416
v_mfma_f32_16x16x32_bf16 v[172:175],v[120:123],a[72:75],0
ds_read_b64_tr_b16 v[100:101],v62 offset:18432
v_mfma_f32_16x16x32_bf16 v[172:175],v[124:127],a[76:79],v[172:175]
ds_read_b64_tr_b16 v[102:103],v62 offset:19456
s_waitcnt vmcnt(15)
v_mfma_f32_16x16x32_bf16 v[204:207],v[120:123],a[80:83],0
ds_read_b128 a[96:99],v39 offset:0
ds_read_b128 a[100:103],v40 offset:0
v_mfma_f32_16x16x32_bf16 v[204:207],v[124:127],a[84:87],v[204:207]
buffer_load_dwordx4 v2,s[20:23],s41 offen offset:3072  lds
v_mfma_f32_16x16x32_bf16 v[236:239],v[120:123],a[88:91],0
v_mfma_f32_16x16x32_bf16 v[236:239],v[124:127],a[92:95],v[236:239]
s_waitcnt lgkmcnt(5)
v_mfma_f32_16x16x32_bf16 v[144:147],v[80:83],a[64:67],0
ds_read_b64_tr_b16 v[104:105],v63 offset:16384
v_mfma_f32_16x16x32_bf16 v[144:147],v[84:87],a[68:71],v[144:147]
ds_read_b64_tr_b16 v[106:107],v63 offset:17408
v_mfma_f32_16x16x32_bf16 v[176:179],v[80:83],a[72:75],0
ds_read_b64_tr_b16 v[108:109],v63 offset:18432
s_add_u32 m0,s40,131072
v_mfma_f32_16x16x32_bf16 v[176:179],v[84:87],a[76:79],v[176:179]
ds_read_b64_tr_b16 v[110:111],v63 offset:19456
s_add_u32 s41,s44,256
v_mfma_f32_16x16x32_bf16 v[208:211],v[80:83],a[80:83],0
s_waitcnt vmcnt(14)
s_waitcnt lgkmcnt(4)
buffer_load_dwordx4 v1,s[16:19],s41 offen  lds
v_mfma_f32_16x16x32_bf16 v[208:211],v[84:87],a[84:87],v[208:211]
ds_read_b128 a[104:107],v39 offset:2048
ds_read_b128 a[108:111],v40 offset:2048
v_mfma_f32_16x16x32_bf16 v[240:243],v[80:83],a[88:91],0
s_add_u32 s41,s44,8448
v_mfma_f32_16x16x32_bf16 v[240:243],v[84:87],a[92:95],v[240:243]
s_waitcnt lgkmcnt(0)
s_barrier
v_mfma_f32_16x16x32_bf16 v[148:151],v[88:91],a[64:67],0
ds_read_b64_tr_b16 v[112:113],v48 offset:0
v_mfma_f32_16x16x32_bf16 v[148:151],v[92:95],a[68:71],v[148:151]
ds_read_b64_tr_b16 v[114:115],v48 offset:1024
v_mfma_f32_16x16x32_bf16 v[180:183],v[88:91],a[72:75],0
ds_read_b64_tr_b16 v[116:117],v48 offset:2048
v_mfma_f32_16x16x32_bf16 v[180:183],v[92:95],a[76:79],v[180:183]
ds_read_b64_tr_b16 v[118:119],v48 offset:3072
v_mfma_f32_16x16x32_bf16 v[212:215],v[88:91],a[80:83],0
buffer_load_dwordx4 v42,s[16:19],s41 offen offset:1024  lds
v_mfma_f32_16x16x32_bf16 v[212:215],v[92:95],a[84:87],v[212:215]
s_waitcnt vmcnt(14)
s_add_u32 m0,s39,114688
v_mfma_f32_16x16x32_bf16 v[244:247],v[88:91],a[88:91],0
ds_read_b128 a[112:115],v39 offset:4096
ds_read_b128 a[116:119],v40 offset:4096
v_mfma_f32_16x16x32_bf16 v[244:247],v[92:95],a[92:95],v[244:247]
s_mov_b32 s41,1048832
v_mfma_f32_16x16x32_bf16 v[152:155],v[96:99],a[64:67],0
ds_read_b64_tr_b16 v[120:121],v49 offset:0
v_mfma_f32_16x16x32_bf16 v[152:155],v[100:103],a[68:71],v[152:155]
ds_read_b64_tr_b16 v[122:123],v49 offset:1024
v_mfma_f32_16x16x32_bf16 v[184:187],v[96:99],a[72:75],0
ds_read_b64_tr_b16 v[124:125],v49 offset:2048
v_mfma_f32_16x16x32_bf16 v[184:187],v[100:103],a[76:79],v[184:187]
ds_read_b64_tr_b16 v[126:127],v49 offset:3072
v_mfma_f32_16x16x32_bf16 v[216:219],v[96:99],a[80:83],0
buffer_load_dwordx4 v2,s[20:23],s41 offen  lds
v_mfma_f32_16x16x32_bf16 v[216:219],v[100:103],a[84:87],v[216:219]
s_add_u32 m0,s40,133120
v_mfma_f32_16x16x32_bf16 v[248:251],v[96:99],a[88:91],0
s_waitcnt vmcnt(13)
s_add_u32 s41,s45,256
v_mfma_f32_16x16x32_bf16 v[248:251],v[100:103],a[92:95],v[248:251]
ds_read_b128 a[120:123],v39 offset:6144
ds_read_b128 a[124:127],v40 offset:6144
v_mfma_f32_16x16x32_bf16 v[156:159],v[104:107],a[64:67],0
ds_read_b64_tr_b16 v[80:81],v50 offset:0
v_mfma_f32_16x16x32_bf16 v[156:159],v[108:111],a[68:71],v[156:159]
ds_read_b64_tr_b16 v[82:83],v50 offset:1024
v_mfma_f32_16x16x32_bf16 v[188:191],v[104:107],a[72:75],0
ds_read_b64_tr_b16 v[84:85],v50 offset:2048
v_mfma_f32_16x16x32_bf16 v[188:191],v[108:111],a[76:79],v[188:191]
ds_read_b64_tr_b16 v[86:87],v50 offset:3072
v_mfma_f32_16x16x32_bf16 v[220:223],v[104:107],a[80:83],0
buffer_load_dwordx4 v1,s[16:19],s41 offen  lds
v_mfma_f32_16x16x32_bf16 v[220:223],v[108:111],a[84:87],v[220:223]
s_add_u32 s41,s45,8448
v_mfma_f32_16x16x32_bf16 v[252:255],v[104:107],a[88:91],0
buffer_load_dwordx4 v42,s[16:19],s41 offen offset:1024  lds
v_mfma_f32_16x16x32_bf16 v[252:255],v[108:111],a[92:95],v[252:255]
s_add_u32 m0,s39,114688
s_waitcnt lgkmcnt(4)
v_mfma_f32_16x16x32_bf16 a[128:131],v[112:115],a[96:99],a[128:131]
ds_read_b64_tr_b16 v[88:89],v51 offset:0
s_mov_b32 s41,1080576
v_mfma_f32_16x16x32_bf16 a[128:131],v[116:119],a[100:103],a[128:131]
ds_read_b64_tr_b16 v[90:91],v51 offset:1024
v_mfma_f32_16x16x32_bf16 a[132:135],v[112:115],a[104:107],a[132:135]
ds_read_b64_tr_b16 v[92:93],v51 offset:2048
v_mfma_f32_16x16x32_bf16 a[132:135],v[116:119],a[108:111],a[132:135]
ds_read_b64_tr_b16 v[94:95],v51 offset:3072
v_mfma_f32_16x16x32_bf16 a[136:139],v[112:115],a[112:115],a[136:139]
buffer_load_dwordx4 v2,s[20:23],s41 offen offset:1024  lds
v_mfma_f32_16x16x32_bf16 a[136:139],v[116:119],a[116:119],a[136:139]
s_add_u32 m0,s40,135168
v_mfma_f32_16x16x32_bf16 a[140:143],v[112:115],a[120:123],a[140:143]
s_add_u32 s41,s46,256
v_mfma_f32_16x16x32_bf16 a[140:143],v[116:119],a[124:127],a[140:143]
buffer_load_dwordx4 v1,s[16:19],s41 offen  lds
v_mfma_f32_16x16x32_bf16 a[144:147],v[120:123],a[96:99],a[144:147]
ds_read_b64_tr_b16 v[96:97],v52 offset:0
s_add_u32 s41,s46,8448
v_mfma_f32_16x16x32_bf16 a[144:147],v[124:127],a[100:103],a[144:147]
ds_read_b64_tr_b16 v[98:99],v52 offset:1024
v_mfma_f32_16x16x32_bf16 a[148:151],v[120:123],a[104:107],a[148:151]
ds_read_b64_tr_b16 v[100:101],v52 offset:2048
v_mfma_f32_16x16x32_bf16 a[148:151],v[124:127],a[108:111],a[148:151]
ds_read_b64_tr_b16 v[102:103],v52 offset:3072
v_mfma_f32_16x16x32_bf16 a[152:155],v[120:123],a[112:115],a[152:155]
buffer_load_dwordx4 v42,s[16:19],s41 offen offset:1024  lds
v_mfma_f32_16x16x32_bf16 a[152:155],v[124:127],a[116:119],a[152:155]
s_add_u32 m0,s39,114688
v_mfma_f32_16x16x32_bf16 a[156:159],v[120:123],a[120:123],a[156:159]
s_mov_b32 s41,1308928
v_mfma_f32_16x16x32_bf16 a[156:159],v[124:127],a[124:127],a[156:159]
buffer_load_dwordx4 v2,s[20:23],s41 offen offset:2048  lds
s_waitcnt lgkmcnt(3)
v_mfma_f32_16x16x32_bf16 a[160:163],v[80:83],a[96:99],a[160:163]
ds_read_b64_tr_b16 v[104:105],v53 offset:0
s_add_u32 m0,s40,137216
v_mfma_f32_16x16x32_bf16 a[160:163],v[84:87],a[100:103],a[160:163]
ds_read_b64_tr_b16 v[106:107],v53 offset:1024
s_add_u32 s41,s47,256
v_mfma_f32_16x16x32_bf16 a[164:167],v[80:83],a[104:107],a[164:167]
ds_read_b64_tr_b16 v[108:109],v53 offset:2048
v_mfma_f32_16x16x32_bf16 a[164:167],v[84:87],a[108:111],a[164:167]
ds_read_b64_tr_b16 v[110:111],v53 offset:3072
v_mfma_f32_16x16x32_bf16 a[168:171],v[80:83],a[112:115],a[168:171]
buffer_load_dwordx4 v1,s[16:19],s41 offen  lds
v_mfma_f32_16x16x32_bf16 a[168:171],v[84:87],a[116:119],a[168:171]
s_add_u32 s41,s47,8448
v_mfma_f32_16x16x32_bf16 a[172:175],v[80:83],a[120:123],a[172:175]
buffer_load_dwordx4 v42,s[16:19],s41 offen offset:1024  lds
v_mfma_f32_16x16x32_bf16 a[172:175],v[84:87],a[124:127],a[172:175]
s_add_u32 m0,s39,114688
v_mfma_f32_16x16x32_bf16 a[176:179],v[88:91],a[96:99],a[176:179]
ds_read_b64_tr_b16 v[112:113],v54 offset:0
s_mov_b32 s41,1340672
v_mfma_f32_16x16x32_bf16 a[176:179],v[92:95],a[100:103],a[176:179]
ds_read_b64_tr_b16 v[114:115],v54 offset:1024
v_mfma_f32_16x16x32_bf16 a[180:183],v[88:91],a[104:107],a[180:183]
ds_read_b64_tr_b16 v[116:117],v54 offset:2048
v_mfma_f32_16x16x32_bf16 a[180:183],v[92:95],a[108:111],a[180:183]
ds_read_b64_tr_b16 v[118:119],v54 offset:3072
v_mfma_f32_16x16x32_bf16 a[184:187],v[88:91],a[112:115],a[184:187]
buffer_load_dwordx4 v2,s[20:23],s41 offen offset:3072  lds
v_mfma_f32_16x16x32_bf16 a[184:187],v[92:95],a[116:119],a[184:187]
s_mov_b32 s41,2097152
v_mfma_f32_16x16x32_bf16 a[188:191],v[88:91],a[120:123],a[188:191]
buffer_load_dword v22,v64,s[56:59],s41 offen
v_mfma_f32_16x16x32_bf16 a[188:191],v[92:95],a[124:127],a[188:191]
buffer_load_dword v22,v65,s[60:63],0 offen offset:512
s_waitcnt lgkmcnt(3)
v_mfma_f32_16x16x32_bf16 a[192:195],v[96:99],a[96:99],a[192:195]
ds_read_b64_tr_b16 v[120:121],v55 offset:0
v_mfma_f32_16x16x32_bf16 a[192:195],v[100:103],a[100:103],a[192:195]
ds_read_b64_tr_b16 v[122:123],v55 offset:1024
v_mfma_f32_16x16x32_bf16 a[196:199],v[96:99],a[104:107],a[196:199]
ds_read_b64_tr_b16 v[124:125],v55 offset:2048
v_mfma_f32_16x16x32_bf16 a[196:199],v[100:103],a[108:111],a[196:199]
ds_read_b64_tr_b16 v[126:127],v55 offset:3072
v_mfma_f32_16x16x32_bf16 a[200:203],v[96:99],a[112:115],a[200:203]
v_mfma_f32_16x16x32_bf16 a[200:203],v[100:103],a[116:119],a[200:203]
v_mfma_f32_16x16x32_bf16 a[204:207],v[96:99],a[120:123],a[204:207]
s_waitcnt vmcnt(20)
v_mfma_f32_16x16x32_bf16 a[204:207],v[100:103],a[124:127],a[204:207]
s_waitcnt lgkmcnt(0)
s_barrier
v_mfma_f32_16x16x32_bf16 a[208:211],v[104:107],a[96:99],a[208:211]
ds_read_b64_tr_b16 v[80:81],v56 offset:0
s_add_u32 m0,s39,32768
v_mfma_f32_16x16x32_bf16 a[208:211],v[108:111],a[100:103],a[208:211]
ds_read_b64_tr_b16 v[82:83],v56 offset:1024
s_mov_b32 s41,1572864
v_mfma_f32_16x16x32_bf16 a[212:215],v[104:107],a[104:107],a[212:215]
ds_read_b64_tr_b16 v[84:85],v56 offset:2048
v_mfma_f32_16x16x32_bf16 a[212:215],v[108:111],a[108:111],a[212:215]
ds_read_b64_tr_b16 v[86:87],v56 offset:3072
v_mfma_f32_16x16x32_bf16 a[216:219],v[104:107],a[112:115],a[216:219]
buffer_load_dwordx4 v2,s[20:23],s41 offen  lds
v_mfma_f32_16x16x32_bf16 a[216:219],v[108:111],a[116:119],a[216:219]
v_mfma_f32_16x16x32_bf16 a[220:223],v[104:107],a[120:123],a[220:223]
v_mfma_f32_16x16x32_bf16 a[220:223],v[108:111],a[124:127],a[220:223]
v_mfma_f32_16x16x32_bf16 a[224:227],v[112:115],a[96:99],a[224:227]
ds_read_b64_tr_b16 v[88:89],v57 offset:0
s_add_u32 m0,s39,32768
v_mfma_f32_16x16x32_bf16 a[224:227],v[116:119],a[100:103],a[224:227]
ds_read_b64_tr_b16 v[90:91],v57 offset:1024
s_mov_b32 s41,1604608
v_mfma_f32_16x16x32_bf16 a[228:231],v[112:115],a[104:107],a[228:231]
ds_read_b64_tr_b16 v[92:93],v57 offset:2048
v_mfma_f32_16x16x32_bf16 a[228:231],v[116:119],a[108:111],a[228:231]
ds_read_b64_tr_b16 v[94:95],v57 offset:3072
v_mfma_f32_16x16x32_bf16 a[232:235],v[112:115],a[112:115],a[232:235]
buffer_load_dwordx4 v2,s[20:23],s41 offen offset:1024  lds
v_mfma_f32_16x16x32_bf16 a[232:235],v[116:119],a[116:119],a[232:235]
v_mfma_f32_16x16x32_bf16 a[236:239],v[112:115],a[120:123],a[236:239]
v_mfma_f32_16x16x32_bf16 a[236:239],v[116:119],a[124:127],a[236:239]
v_mfma_f32_16x16x32_bf16 a[240:243],v[120:123],a[96:99],a[240:243]
ds_read_b64_tr_b16 v[96:97],v58 offset:0
s_add_u32 m0,s39,32768
v_mfma_f32_16x16x32_bf16 a[240:243],v[124:127],a[100:103],a[240:243]
ds_read_b64_tr_b16 v[98:99],v58 offset:1024
s_mov_b32 s41,1832960
v_mfma_f32_16x16x32_bf16 a[244:247],v[120:123],a[104:107],a[244:247]
ds_read_b64_tr_b16 v[100:101],v58 offset:2048
v_mfma_f32_16x16x32_bf16 a[244:247],v[124:127],a[108:111],a[244:247]
ds_read_b64_tr_b16 v[102:103],v58 offset:3072
v_mfma_f32_16x16x32_bf16 a[248:251],v[120:123],a[112:115],a[248:251]
buffer_load_dwordx4 v2,s[20:23],s41 offen offset:2048  lds
v_mfma_f32_16x16x32_bf16 a[248:251],v[124:127],a[116:119],a[248:251]
v_mfma_f32_16x16x32_bf16 a[252:255],v[120:123],a[120:123],a[252:255]
v_mfma_f32_16x16x32_bf16 a[252:255],v[124:127],a[124:127],a[252:255]
s_waitcnt lgkmcnt(4)
v_mfma_f32_16x16x32_bf16 v[128:131],v[80:83],a[96:99],v[128:131]
ds_read_b64_tr_b16 v[104:105],v59 offset:0
s_add_u32 m0,s39,32768
v_mfma_f32_16x16x32_bf16 v[128:131],v[84:87],a[100:103],v[128:131]
ds_read_b64_tr_b16 v[106:107],v59 offset:1024
s_mov_b32 s41,1864704
v_mfma_f32_16x16x32_bf16 v[160:163],v[80:83],a[104:107],v[160:163]
ds_read_b64_tr_b16 v[108:109],v59 offset:2048
v_mfma_f32_16x16x32_bf16 v[160:163],v[84:87],a[108:111],v[160:163]
ds_read_b64_tr_b16 v[110:111],v59 offset:3072
v_mfma_f32_16x16x32_bf16 v[192:195],v[80:83],a[112:115],v[192:195]
buffer_load_dwordx4 v2,s[20:23],s41 offen offset:3072  lds
v_mfma_f32_16x16x32_bf16 v[192:195],v[84:87],a[116:119],v[192:195]
v_mfma_f32_16x16x32_bf16 v[224:227],v[80:83],a[120:123],v[224:227]
v_mfma_f32_16x16x32_bf16 v[224:227],v[84:87],a[124:127],v[224:227]
v_mfma_f32_16x16x32_bf16 v[132:135],v[88:91],a[96:99],v[132:135]
ds_read_b64_tr_b16 v[112:113],v60 offset:0
v_mfma_f32_16x16x32_bf16 v[132:135],v[92:95],a[100:103],v[132:135]
ds_read_b64_tr_b16 v[114:115],v60 offset:1024
v_mfma_f32_16x16x32_bf16 v[164:167],v[88:91],a[104:107],v[164:167]
ds_read_b64_tr_b16 v[116:117],v60 offset:2048
v_mfma_f32_16x16x32_bf16 v[164:167],v[92:95],a[108:111],v[164:167]
ds_read_b64_tr_b16 v[118:119],v60 offset:3072
v_mfma_f32_16x16x32_bf16 v[196:199],v[88:91],a[112:115],v[196:199]
v_mfma_f32_16x16x32_bf16 v[196:199],v[92:95],a[116:119],v[196:199]
v_mfma_f32_16x16x32_bf16 v[228:231],v[88:91],a[120:123],v[228:231]
v_mfma_f32_16x16x32_bf16 v[228:231],v[92:95],a[124:127],v[228:231]
s_waitcnt lgkmcnt(4)
v_mfma_f32_16x16x32_bf16 v[136:139],v[96:99],a[96:99],v[136:139]
ds_read_b64_tr_b16 v[120:121],v61 offset:0
v_mfma_f32_16x16x32_bf16 v[136:139],v[100:103],a[100:103],v[136:139]
ds_read_b64_tr_b16 v[122:123],v61 offset:1024
v_mfma_f32_16x16x32_bf16 v[168:171],v[96:99],a[104:107],v[168:171]
ds_read_b64_tr_b16 v[124:125],v61 offset:2048
v_mfma_f32_16x16x32_bf16 v[168:171],v[100:103],a[108:111],v[168:171]
ds_read_b64_tr_b16 v[126:127],v61 offset:3072
v_mfma_f32_16x16x32_bf16 v[200:203],v[96:99],a[112:115],v[200:203]
v_mfma_f32_16x16x32_bf16 v[200:203],v[100:103],a[116:119],v[200:203]
v_mfma_f32_16x16x32_bf16 v[232:235],v[96:99],a[120:123],v[232:235]
v_mfma_f32_16x16x32_bf16 v[232:235],v[100:103],a[124:127],v[232:235]
v_mfma_f32_16x16x32_bf16 v[140:143],v[104:107],a[96:99],v[140:143]
ds_read_b64_tr_b16 v[80:81],v62 offset:0
v_mfma_f32_16x16x32_bf16 v[140:143],v[108:111],a[100:103],v[140:143]
ds_read_b64_tr_b16 v[82:83],v62 offset:1024
v_mfma_f32_16x16x32_bf16 v[172:175],v[104:107],a[104:107],v[172:175]
ds_read_b64_tr_b16 v[84:85],v62 offset:2048
v_mfma_f32_16x16x32_bf16 v[172:175],v[108:111],a[108:111],v[172:175]
ds_read_b64_tr_b16 v[86:87],v62 offset:3072
s_waitcnt vmcnt(16)
v_mfma_f32_16x16x32_bf16 v[204:207],v[104:107],a[112:115],v[204:207]
ds_read_b128 a[64:67],v39 offset:0
ds_read_b128 a[68:71],v40 offset:0
v_mfma_f32_16x16x32_bf16 v[204:207],v[108:111],a[116:119],v[204:207]
v_mfma_f32_16x16x32_bf16 v[236:239],v[104:107],a[120:123],v[236:239]
v_mfma_f32_16x16x32_bf16 v[236:239],v[108:111],a[124:127],v[236:239]
s_waitcnt lgkmcnt(6)
v_mfma_f32_16x16x32_bf16 v[144:147],v[112:115],a[96:99],v[144:147]
ds_read_b64_tr_b16 v[88:89],v63 offset:0
v_mfma_f32_16x16x32_bf16 v[144:147],v[116:119],a[100:103],v[144:147]
ds_read_b64_tr_b16 v[90:91],v63 offset:1024
v_mfma_f32_16x16x32_bf16 v[176:179],v[112:115],a[104:107],v[176:179]
ds_read_b64_tr_b16 v[92:93],v63 offset:2048
s_add_u32 m0,s40,131072
v_mfma_f32_16x16x32_bf16 v[176:179],v[116:119],a[108:111],v[176:179]
ds_read_b64_tr_b16 v[94:95],v63 offset:3072
s_add_u32 s41,s44,384
v_mfma_f32_16x16x32_bf16 v[208:211],v[112:115],a[112:115],v[208:211]
s_waitcnt vmcnt(13)
s_waitcnt lgkmcnt(4)
buffer_load_dwordx4 v1,s[16:19],s41 offen  lds
v_mfma_f32_16x16x32_bf16 v[208:211],v[116:119],a[116:119],v[208:211]
ds_read_b128 a[72:75],v39 offset:2048
ds_read_b128 a[76:79],v40 offset:2048
v_mfma_f32_16x16x32_bf16 v[240:243],v[112:115],a[120:123],v[240:243]
s_add_u32 s41,s44,8576
v_mfma_f32_16x16x32_bf16 v[240:243],v[116:119],a[124:127],v[240:243]
s_waitcnt lgkmcnt(0)
s_barrier
v_mfma_f32_16x16x32_bf16 v[148:151],v[120:123],a[96:99],v[148:151]
ds_read_b64_tr_b16 v[96:97],v48 offset:16384
v_mfma_f32_16x16x32_bf16 v[148:151],v[124:127],a[100:103],v[148:151]
ds_read_b64_tr_b16 v[98:99],v48 offset:17408
v_mfma_f32_16x16x32_bf16 v[180:183],v[120:123],a[104:107],v[180:183]
ds_read_b64_tr_b16 v[100:101],v48 offset:18432
v_mfma_f32_16x16x32_bf16 v[180:183],v[124:127],a[108:111],v[180:183]
ds_read_b64_tr_b16 v[102:103],v48 offset:19456
v_mfma_f32_16x16x32_bf16 v[212:215],v[120:123],a[112:115],v[212:215]
buffer_load_dwordx4 v42,s[16:19],s41 offen offset:1024  lds
v_mfma_f32_16x16x32_bf16 v[212:215],v[124:127],a[116:119],v[212:215]
s_waitcnt vmcnt(12)
s_add_u32 m0,s39,98304
v_mfma_f32_16x16x32_bf16 v[244:247],v[120:123],a[120:123],v[244:247]
ds_read_b128 a[80:83],v39 offset:4096
ds_read_b128 a[84:87],v40 offset:4096
v_mfma_f32_16x16x32_bf16 v[244:247],v[124:127],a[124:127],v[244:247]
s_mov_b32 s41,1573120
v_mfma_f32_16x16x32_bf16 v[152:155],v[80:83],a[96:99],v[152:155]
ds_read_b64_tr_b16 v[104:105],v49 offset:16384
v_mfma_f32_16x16x32_bf16 v[152:155],v[84:87],a[100:103],v[152:155]
ds_read_b64_tr_b16 v[106:107],v49 offset:17408
v_mfma_f32_16x16x32_bf16 v[184:187],v[80:83],a[104:107],v[184:187]
ds_read_b64_tr_b16 v[108:109],v49 offset:18432
v_mfma_f32_16x16x32_bf16 v[184:187],v[84:87],a[108:111],v[184:187]
ds_read_b64_tr_b16 v[110:111],v49 offset:19456
v_mfma_f32_16x16x32_bf16 v[216:219],v[80:83],a[112:115],v[216:219]
buffer_load_dwordx4 v2,s[20:23],s41 offen  lds
v_mfma_f32_16x16x32_bf16 v[216:219],v[84:87],a[116:119],v[216:219]
s_add_u32 m0,s40,133120
v_mfma_f32_16x16x32_bf16 v[248:251],v[80:83],a[120:123],v[248:251]
s_waitcnt vmcnt(10)
s_add_u32 s41,s45,384
v_mfma_f32_16x16x32_bf16 v[248:251],v[84:87],a[124:127],v[248:251]
ds_read_b128 a[88:91],v39 offset:6144
ds_read_b128 a[92:95],v40 offset:6144
v_mfma_f32_16x16x32_bf16 v[156:159],v[88:91],a[96:99],v[156:159]
ds_read_b64_tr_b16 v[112:113],v50 offset:16384
v_mfma_f32_16x16x32_bf16 v[156:159],v[92:95],a[100:103],v[156:159]
ds_read_b64_tr_b16 v[114:115],v50 offset:17408
v_mfma_f32_16x16x32_bf16 v[188:191],v[88:91],a[104:107],v[188:191]
ds_read_b64_tr_b16 v[116:117],v50 offset:18432
v_mfma_f32_16x16x32_bf16 v[188:191],v[92:95],a[108:111],v[188:191]
ds_read_b64_tr_b16 v[118:119],v50 offset:19456
v_mfma_f32_16x16x32_bf16 v[220:223],v[88:91],a[112:115],v[220:223]
buffer_load_dwordx4 v1,s[16:19],s41 offen  lds
v_mfma_f32_16x16x32_bf16 v[220:223],v[92:95],a[116:119],v[220:223]
s_add_u32 s41,s45,8576
v_mfma_f32_16x16x32_bf16 v[252:255],v[88:91],a[120:123],v[252:255]
buffer_load_dwordx4 v42,s[16:19],s41 offen offset:1024  lds
v_mfma_f32_16x16x32_bf16 v[252:255],v[92:95],a[124:127],v[252:255]
s_add_u32 m0,s39,98304
s_waitcnt lgkmcnt(4)
v_mfma_f32_16x16x32_bf16 a[128:131],v[96:99],a[64:67],a[128:131]
ds_read_b64_tr_b16 v[120:121],v51 offset:16384
s_mov_b32 s41,1604864
v_mfma_f32_16x16x32_bf16 a[128:131],v[100:103],a[68:71],a[128:131]
ds_read_b64_tr_b16 v[122:123],v51 offset:17408
v_mfma_f32_16x16x32_bf16 a[132:135],v[96:99],a[72:75],a[132:135]
ds_read_b64_tr_b16 v[124:125],v51 offset:18432
v_mfma_f32_16x16x32_bf16 a[132:135],v[100:103],a[76:79],a[132:135]
ds_read_b64_tr_b16 v[126:127],v51 offset:19456
v_mfma_f32_16x16x32_bf16 a[136:139],v[96:99],a[80:83],a[136:139]
buffer_load_dwordx4 v2,s[20:23],s41 offen offset:1024  lds
v_mfma_f32_16x16x32_bf16 a[136:139],v[100:103],a[84:87],a[136:139]
s_add_u32 m0,s40,135168
v_mfma_f32_16x16x32_bf16 a[140:143],v[96:99],a[88:91],a[140:143]
s_add_u32 s41,s46,384
v_mfma_f32_16x16x32_bf16 a[140:143],v[100:103],a[92:95],a[140:143]
buffer_load_dwordx4 v1,s[16:19],s41 offen  lds
v_mfma_f32_16x16x32_bf16 a[144:147],v[104:107],a[64:67],a[144:147]
ds_read_b64_tr_b16 v[80:81],v52 offset:16384
s_add_u32 s41,s46,8576
v_mfma_f32_16x16x32_bf16 a[144:147],v[108:111],a[68:71],a[144:147]
ds_read_b64_tr_b16 v[82:83],v52 offset:17408
v_mfma_f32_16x16x32_bf16 a[148:151],v[104:107],a[72:75],a[148:151]
ds_read_b64_tr_b16 v[84:85],v52 offset:18432
v_mfma_f32_16x16x32_bf16 a[148:151],v[108:111],a[76:79],a[148:151]
ds_read_b64_tr_b16 v[86:87],v52 offset:19456
v_mfma_f32_16x16x32_bf16 a[152:155],v[104:107],a[80:83],a[152:155]
buffer_load_dwordx4 v42,s[16:19],s41 offen offset:1024  lds
v_mfma_f32_16x16x32_bf16 a[152:155],v[108:111],a[84:87],a[152:155]
s_add_u32 m0,s39,98304
v_mfma_f32_16x16x32_bf16 a[156:159],v[104:107],a[88:91],a[156:159]
s_mov_b32 s41,1833216
v_mfma_f32_16x16x32_bf16 a[156:159],v[108:111],a[92:95],a[156:159]
buffer_load_dwordx4 v2,s[20:23],s41 offen offset:2048  lds
s_waitcnt lgkmcnt(3)
v_mfma_f32_16x16x32_bf16 a[160:163],v[112:115],a[64:67],a[160:163]
ds_read_b64_tr_b16 v[88:89],v53 offset:16384
s_add_u32 m0,s40,137216
v_mfma_f32_16x16x32_bf16 a[160:163],v[116:119],a[68:71],a[160:163]
ds_read_b64_tr_b16 v[90:91],v53 offset:17408
s_add_u32 s41,s47,384
v_mfma_f32_16x16x32_bf16 a[164:167],v[112:115],a[72:75],a[164:167]
ds_read_b64_tr_b16 v[92:93],v53 offset:18432
v_mfma_f32_16x16x32_bf16 a[164:167],v[116:119],a[76:79],a[164:167]
ds_read_b64_tr_b16 v[94:95],v53 offset:19456
v_mfma_f32_16x16x32_bf16 a[168:171],v[112:115],a[80:83],a[168:171]
buffer_load_dwordx4 v1,s[16:19],s41 offen  lds
v_mfma_f32_16x16x32_bf16 a[168:171],v[116:119],a[84:87],a[168:171]
s_add_u32 s41,s47,8576
v_mfma_f32_16x16x32_bf16 a[172:175],v[112:115],a[88:91],a[172:175]
buffer_load_dwordx4 v42,s[16:19],s41 offen offset:1024  lds
v_mfma_f32_16x16x32_bf16 a[172:175],v[116:119],a[92:95],a[172:175]
s_add_u32 m0,s39,98304
v_mfma_f32_16x16x32_bf16 a[176:179],v[120:123],a[64:67],a[176:179]
ds_read_b64_tr_b16 v[96:97],v54 offset:16384
s_mov_b32 s41,1864960
v_mfma_f32_16x16x32_bf16 a[176:179],v[124:127],a[68:71],a[176:179]
ds_read_b64_tr_b16 v[98:99],v54 offset:17408
v_mfma_f32_16x16x32_bf16 a[180:183],v[120:123],a[72:75],a[180:183]
ds_read_b64_tr_b16 v[100:101],v54 offset:18432
v_mfma_f32_16x16x32_bf16 a[180:183],v[124:127],a[76:79],a[180:183]
ds_read_b64_tr_b16 v[102:103],v54 offset:19456
v_mfma_f32_16x16x32_bf16 a[184:187],v[120:123],a[80:83],a[184:187]
buffer_load_dwordx4 v2,s[20:23],s41 offen offset:3072  lds
v_mfma_f32_16x16x32_bf16 a[184:187],v[124:127],a[84:87],a[184:187]
s_mov_b32 s41,2621440
v_mfma_f32_16x16x32_bf16 a[188:191],v[120:123],a[88:91],a[188:191]
buffer_load_dword v22,v64,s[56:59],s41 offen
v_mfma_f32_16x16x32_bf16 a[188:191],v[124:127],a[92:95],a[188:191]
buffer_load_dword v22,v65,s[60:63],0 offen offset:640
s_waitcnt lgkmcnt(3)
v_mfma_f32_16x16x32_bf16 a[192:195],v[80:83],a[64:67],a[192:195]
ds_read_b64_tr_b16 v[104:105],v55 offset:16384
v_mfma_f32_16x16x32_bf16 a[192:195],v[84:87],a[68:71],a[192:195]
ds_read_b64_tr_b16 v[106:107],v55 offset:17408
v_mfma_f32_16x16x32_bf16 a[196:199],v[80:83],a[72:75],a[196:199]
ds_read_b64_tr_b16 v[108:109],v55 offset:18432
v_mfma_f32_16x16x32_bf16 a[196:199],v[84:87],a[76:79],a[196:199]
ds_read_b64_tr_b16 v[110:111],v55 offset:19456
v_mfma_f32_16x16x32_bf16 a[200:203],v[80:83],a[80:83],a[200:203]
v_mfma_f32_16x16x32_bf16 a[200:203],v[84:87],a[84:87],a[200:203]
v_mfma_f32_16x16x32_bf16 a[204:207],v[80:83],a[88:91],a[204:207]
s_waitcnt vmcnt(20)
v_mfma_f32_16x16x32_bf16 a[204:207],v[84:87],a[92:95],a[204:207]
s_waitcnt lgkmcnt(0)
s_barrier
v_mfma_f32_16x16x32_bf16 a[208:211],v[88:91],a[64:67],a[208:211]
ds_read_b64_tr_b16 v[112:113],v56 offset:16384
s_add_u32 m0,s39,49152
v_mfma_f32_16x16x32_bf16 a[208:211],v[92:95],a[68:71],a[208:211]
ds_read_b64_tr_b16 v[114:115],v56 offset:17408
s_mov_b32 s41,2097152
v_mfma_f32_16x16x32_bf16 a[212:215],v[88:91],a[72:75],a[212:215]
ds_read_b64_tr_b16 v[116:117],v56 offset:18432
v_mfma_f32_16x16x32_bf16 a[212:215],v[92:95],a[76:79],a[212:215]
ds_read_b64_tr_b16 v[118:119],v56 offset:19456
v_mfma_f32_16x16x32_bf16 a[216:219],v[88:91],a[80:83],a[216:219]
buffer_load_dwordx4 v2,s[20:23],s41 offen  lds
v_mfma_f32_16x16x32_bf16 a[216:219],v[92:95],a[84:87],a[216:219]
v_mfma_f32_16x16x32_bf16 a[220:223],v[88:91],a[88:91],a[220:223]
v_mfma_f32_16x16x32_bf16 a[220:223],v[92:95],a[92:95],a[220:223]
v_mfma_f32_16x16x32_bf16 a[224:227],v[96:99],a[64:67],a[224:227]
ds_read_b64_tr_b16 v[120:121],v57 offset:16384
s_add_u32 m0,s39,49152
v_mfma_f32_16x16x32_bf16 a[224:227],v[100:103],a[68:71],a[224:227]
ds_read_b64_tr_b16 v[122:123],v57 offset:17408
s_mov_b32 s41,2128896
v_mfma_f32_16x16x32_bf16 a[228:231],v[96:99],a[72:75],a[228:231]
ds_read_b64_tr_b16 v[124:125],v57 offset:18432
v_mfma_f32_16x16x32_bf16 a[228:231],v[100:103],a[76:79],a[228:231]
ds_read_b64_tr_b16 v[126:127],v57 offset:19456
v_mfma_f32_16x16x32_bf16 a[232:235],v[96:99],a[80:83],a[232:235]
buffer_load_dwordx4 v2,s[20:23],s41 offen offset:1024  lds
v_mfma_f32_16x16x32_bf16 a[232:235],v[100:103],a[84:87],a[232:235]
v_mfma_f32_16x16x32_bf16 a[236:239],v[96:99],a[88:91],a[236:239]
v_mfma_f32_16x16x32_bf16 a[236:239],v[100:103],a[92:95],a[236:239]
v_mfma_f32_16x16x32_bf16 a[240:243],v[104:107],a[64:67],a[240:243]
ds_read_b64_tr_b16 v[80:81],v58 offset:16384
s_add_u32 m0,s39,49152
v_mfma_f32_16x16x32_bf16 a[240:243],v[108:111],a[68:71],a[240:243]
ds_read_b64_tr_b16 v[82:83],v58 offset:17408
s_mov_b32 s41,2357248
v_mfma_f32_16x16x32_bf16 a[244:247],v[104:107],a[72:75],a[244:247]
ds_read_b64_tr_b16 v[84:85],v58 offset:18432
v_mfma_f32_16x16x32_bf16 a[244:247],v[108:111],a[76:79],a[244:247]
ds_read_b64_tr_b16 v[86:87],v58 offset:19456
v_mfma_f32_16x16x32_bf16 a[248:251],v[104:107],a[80:83],a[248:251]
buffer_load_dwordx4 v2,s[20:23],s41 offen offset:2048  lds
v_mfma_f32_16x16x32_bf16 a[248:251],v[108:111],a[84:87],a[248:251]
v_mfma_f32_16x16x32_bf16 a[252:255],v[104:107],a[88:91],a[252:255]
v_mfma_f32_16x16x32_bf16 a[252:255],v[108:111],a[92:95],a[252:255]
s_waitcnt lgkmcnt(4)
v_mfma_f32_16x16x32_bf16 v[128:131],v[112:115],a[64:67],v[128:131]
ds_read_b64_tr_b16 v[88:89],v59 offset:16384
s_add_u32 m0,s39,49152
v_mfma_f32_16x16x32_bf16 v[128:131],v[116:119],a[68:71],v[128:131]
ds_read_b64_tr_b16 v[90:91],v59 offset:17408
s_mov_b32 s41,2388992
v_mfma_f32_16x16x32_bf16 v[160:163],v[112:115],a[72:75],v[160:163]
ds_read_b64_tr_b16 v[92:93],v59 offset:18432
v_mfma_f32_16x16x32_bf16 v[160:163],v[116:119],a[76:79],v[160:163]
ds_read_b64_tr_b16 v[94:95],v59 offset:19456
v_mfma_f32_16x16x32_bf16 v[192:195],v[112:115],a[80:83],v[192:195]
buffer_load_dwordx4 v2,s[20:23],s41 offen offset:3072  lds
v_mfma_f32_16x16x32_bf16 v[192:195],v[116:119],a[84:87],v[192:195]
v_mfma_f32_16x16x32_bf16 v[224:227],v[112:115],a[88:91],v[224:227]
v_mfma_f32_16x16x32_bf16 v[224:227],v[116:119],a[92:95],v[224:227]
v_mfma_f32_16x16x32_bf16 v[132:135],v[120:123],a[64:67],v[132:135]
ds_read_b64_tr_b16 v[96:97],v60 offset:16384
v_mfma_f32_16x16x32_bf16 v[132:135],v[124:127],a[68:71],v[132:135]
ds_read_b64_tr_b16 v[98:99],v60 offset:17408
v_mfma_f32_16x16x32_bf16 v[164:167],v[120:123],a[72:75],v[164:167]
ds_read_b64_tr_b16 v[100:101],v60 offset:18432
v_mfma_f32_16x16x32_bf16 v[164:167],v[124:127],a[76:79],v[164:167]
ds_read_b64_tr_b16 v[102:103],v60 offset:19456
v_mfma_f32_16x16x32_bf16 v[196:199],v[120:123],a[80:83],v[196:199]
v_mfma_f32_16x16x32_bf16 v[196:199],v[124:127],a[84:87],v[196:199]
v_mfma_f32_16x16x32_bf16 v[228:231],v[120:123],a[88:91],v[228:231]
v_mfma_f32_16x16x32_bf16 v[228:231],v[124:127],a[92:95],v[228:231]
s_waitcnt lgkmcnt(4)
v_mfma_f32_16x16x32_bf16 v[136:139],v[80:83],a[64:67],v[136:139]
ds_read_b64_tr_b16 v[104:105],v61 offset:16384
v_mfma_f32_16x16x32_bf16 v[136:139],v[84:87],a[68:71],v[136:139]
ds_read_b64_tr_b16 v[106:107],v61 offset:17408
v_mfma_f32_16x16x32_bf16 v[168:171],v[80:83],a[72:75],v[168:171]
ds_read_b64_tr_b16 v[108:109],v61 offset:18432
v_mfma_f32_16x16x32_bf16 v[168:171],v[84:87],a[76:79],v[168:171]
ds_read_b64_tr_b16 v[110:111],v61 offset:19456
v_mfma_f32_16x16x32_bf16 v[200:203],v[80:83],a[80:83],v[200:203]
v_mfma_f32_16x16x32_bf16 v[200:203],v[84:87],a[84:87],v[200:203]
v_mfma_f32_16x16x32_bf16 v[232:235],v[80:83],a[88:91],v[232:235]
v_mfma_f32_16x16x32_bf16 v[232:235],v[84:87],a[92:95],v[232:235]
v_mfma_f32_16x16x32_bf16 v[140:143],v[88:91],a[64:67],v[140:143]
ds_read_b64_tr_b16 v[112:113],v62 offset:16384
v_mfma_f32_16x16x32_bf16 v[140:143],v[92:95],a[68:71],v[140:143]
ds_read_b64_tr_b16 v[114:115],v62 offset:17408
v_mfma_f32_16x16x32_bf16 v[172:175],v[88:91],a[72:75],v[172:175]
ds_read_b64_tr_b16 v[116:117],v62 offset:18432
v_mfma_f32_16x16x32_bf16 v[172:175],v[92:95],a[76:79],v[172:175]
ds_read_b64_tr_b16 v[118:119],v62 offset:19456
s_waitcnt vmcnt(16)
v_mfma_f32_16x16x32_bf16 v[204:207],v[88:91],a[80:83],v[204:207]
ds_read_b128 a[96:99],v39 offset:0
ds_read_b128 a[100:103],v40 offset:0
v_mfma_f32_16x16x32_bf16 v[204:207],v[92:95],a[84:87],v[204:207]
v_mfma_f32_16x16x32_bf16 v[236:239],v[88:91],a[88:91],v[236:239]
v_mfma_f32_16x16x32_bf16 v[236:239],v[92:95],a[92:95],v[236:239]
s_waitcnt lgkmcnt(6)
v_mfma_f32_16x16x32_bf16 v[144:147],v[96:99],a[64:67],v[144:147]
ds_read_b64_tr_b16 v[120:121],v63 offset:16384
v_mfma_f32_16x16x32_bf16 v[144:147],v[100:103],a[68:71],v[144:147]
ds_read_b64_tr_b16 v[122:123],v63 offset:17408
v_mfma_f32_16x16x32_bf16 v[176:179],v[96:99],a[72:75],v[176:179]
ds_read_b64_tr_b16 v[124:125],v63 offset:18432
s_add_u32 m0,s40,131072
v_mfma_f32_16x16x32_bf16 v[176:179],v[100:103],a[76:79],v[176:179]
ds_read_b64_tr_b16 v[126:127],v63 offset:19456
s_add_u32 s41,s44,512
v_mfma_f32_16x16x32_bf16 v[208:211],v[96:99],a[80:83],v[208:211]
s_waitcnt vmcnt(13)
s_waitcnt lgkmcnt(4)
buffer_load_dwordx4 v1,s[16:19],s41 offen  lds
v_mfma_f32_16x16x32_bf16 v[208:211],v[100:103],a[84:87],v[208:211]
ds_read_b128 a[104:107],v39 offset:2048
ds_read_b128 a[108:111],v40 offset:2048
v_mfma_f32_16x16x32_bf16 v[240:243],v[96:99],a[88:91],v[240:243]
s_add_u32 s41,s44,8704
v_mfma_f32_16x16x32_bf16 v[240:243],v[100:103],a[92:95],v[240:243]
s_waitcnt lgkmcnt(0)
s_barrier
v_mfma_f32_16x16x32_bf16 v[148:151],v[104:107],a[64:67],v[148:151]
ds_read_b64_tr_b16 v[80:81],v48 offset:0
v_mfma_f32_16x16x32_bf16 v[148:151],v[108:111],a[68:71],v[148:151]
ds_read_b64_tr_b16 v[82:83],v48 offset:1024
v_mfma_f32_16x16x32_bf16 v[180:183],v[104:107],a[72:75],v[180:183]
ds_read_b64_tr_b16 v[84:85],v48 offset:2048
v_mfma_f32_16x16x32_bf16 v[180:183],v[108:111],a[76:79],v[180:183]
ds_read_b64_tr_b16 v[86:87],v48 offset:3072
v_mfma_f32_16x16x32_bf16 v[212:215],v[104:107],a[80:83],v[212:215]
buffer_load_dwordx4 v42,s[16:19],s41 offen offset:1024  lds
v_mfma_f32_16x16x32_bf16 v[212:215],v[108:111],a[84:87],v[212:215]
s_waitcnt vmcnt(12)
s_add_u32 m0,s39,114688
v_mfma_f32_16x16x32_bf16 v[244:247],v[104:107],a[88:91],v[244:247]
ds_read_b128 a[112:115],v39 offset:4096
ds_read_b128 a[116:119],v40 offset:4096
v_mfma_f32_16x16x32_bf16 v[244:247],v[108:111],a[92:95],v[244:247]
s_mov_b32 s41,2097408
v_mfma_f32_16x16x32_bf16 v[152:155],v[112:115],a[64:67],v[152:155]
ds_read_b64_tr_b16 v[88:89],v49 offset:0
v_mfma_f32_16x16x32_bf16 v[152:155],v[116:119],a[68:71],v[152:155]
ds_read_b64_tr_b16 v[90:91],v49 offset:1024
v_mfma_f32_16x16x32_bf16 v[184:187],v[112:115],a[72:75],v[184:187]
ds_read_b64_tr_b16 v[92:93],v49 offset:2048
v_mfma_f32_16x16x32_bf16 v[184:187],v[116:119],a[76:79],v[184:187]
ds_read_b64_tr_b16 v[94:95],v49 offset:3072
v_mfma_f32_16x16x32_bf16 v[216:219],v[112:115],a[80:83],v[216:219]
buffer_load_dwordx4 v2,s[20:23],s41 offen  lds
v_mfma_f32_16x16x32_bf16 v[216:219],v[116:119],a[84:87],v[216:219]
s_add_u32 m0,s40,133120
v_mfma_f32_16x16x32_bf16 v[248:251],v[112:115],a[88:91],v[248:251]
s_waitcnt vmcnt(10)
s_add_u32 s41,s45,512
v_mfma_f32_16x16x32_bf16 v[248:251],v[116:119],a[92:95],v[248:251]
ds_read_b128 a[120:123],v39 offset:6144
ds_read_b128 a[124:127],v40 offset:6144
v_mfma_f32_16x16x32_bf16 v[156:159],v[120:123],a[64:67],v[156:159]
ds_read_b64_tr_b16 v[96:97],v50 offset:0
v_mfma_f32_16x16x32_bf16 v[156:159],v[124:127],a[68:71],v[156:159]
ds_read_b64_tr_b16 v[98:99],v50 offset:1024
v_mfma_f32_16x16x32_bf16 v[188:191],v[120:123],a[72:75],v[188:191]
ds_read_b64_tr_b16 v[100:101],v50 offset:2048
v_mfma_f32_16x16x32_bf16 v[188:191],v[124:127],a[76:79],v[188:191]
ds_read_b64_tr_b16 v[102:103],v50 offset:3072
v_mfma_f32_16x16x32_bf16 v[220:223],v[120:123],a[80:83],v[220:223]
buffer_load_dwordx4 v1,s[16:19],s41 offen  lds
v_mfma_f32_16x16x32_bf16 v[220:223],v[124:127],a[84:87],v[220:223]
s_add_u32 s41,s45,8704
v_mfma_f32_16x16x32_bf16 v[252:255],v[120:123],a[88:91],v[252:255]
buffer_load_dwordx4 v42,s[16:19],s41 offen offset:1024  lds
v_mfma_f32_16x16x32_bf16 v[252:255],v[124:127],a[92:95],v[252:255]
s_add_u32 m0,s39,114688
s_waitcnt lgkmcnt(4)
v_mfma_f32_16x16x32_bf16 a[128:131],v[80:83],a[96:99],a[128:131]
ds_read_b64_tr_b16 v[104:105],v51 offset:0
s_mov_b32 s41,2129152
v_mfma_f32_16x16x32_bf16 a[128:131],v[84:87],a[100:103],a[128:131]
ds_read_b64_tr_b16 v[106:107],v51 offset:1024
v_mfma_f32_16x16x32_bf16 a[132:135],v[80:83],a[104:107],a[132:135]
ds_read_b64_tr_b16 v[108:109],v51 offset:2048
v_mfma_f32_16x16x32_bf16 a[132:135],v[84:87],a[108:111],a[132:135]
ds_read_b64_tr_b16 v[110:111],v51 offset:3072
v_mfma_f32_16x16x32_bf16 a[136:139],v[80:83],a[112:115],a[136:139]
buffer_load_dwordx4 v2,s[20:23],s41 offen offset:1024  lds
v_mfma_f32_16x16x32_bf16 a[136:139],v[84:87],a[116:119],a[136:139]
s_add_u32 m0,s40,135168
v_mfma_f32_16x16x32_bf16 a[140:143],v[80:83],a[120:123],a[140:143]
s_add_u32 s41,s46,512
v_mfma_f32_16x16x32_bf16 a[140:143],v[84:87],a[124:127],a[140:143]
buffer_load_dwordx4 v1,s[16:19],s41 offen  lds
v_mfma_f32_16x16x32_bf16 a[144:147],v[88:91],a[96:99],a[144:147]
ds_read_b64_tr_b16 v[112:113],v52 offset:0
s_add_u32 s41,s46,8704
v_mfma_f32_16x16x32_bf16 a[144:147],v[92:95],a[100:103],a[144:147]
ds_read_b64_tr_b16 v[114:115],v52 offset:1024
v_mfma_f32_16x16x32_bf16 a[148:151],v[88:91],a[104:107],a[148:151]
ds_read_b64_tr_b16 v[116:117],v52 offset:2048
v_mfma_f32_16x16x32_bf16 a[148:151],v[92:95],a[108:111],a[148:151]
ds_read_b64_tr_b16 v[118:119],v52 offset:3072
v_mfma_f32_16x16x32_bf16 a[152:155],v[88:91],a[112:115],a[152:155]
buffer_load_dwordx4 v42,s[16:19],s41 offen offset:1024  lds
v_mfma_f32_16x16x32_bf16 a[152:155],v[92:95],a[116:119],a[152:155]
s_add_u32 m0,s39,114688
v_mfma_f32_16x16x32_bf16 a[156:159],v[88:91],a[120:123],a[156:159]
s_mov_b32 s41,2357504
v_mfma_f32_16x16x32_bf16 a[156:159],v[92:95],a[124:127],a[156:159]
buffer_load_dwordx4 v2,s[20:23],s41 offen offset:2048  lds
s_waitcnt lgkmcnt(3)
v_mfma_f32_16x16x32_bf16 a[160:163],v[96:99],a[96:99],a[160:163]
ds_read_b64_tr_b16 v[120:121],v53 offset:0
s_add_u32 m0,s40,137216
v_mfma_f32_16x16x32_bf16 a[160:163],v[100:103],a[100:103],a[160:163]
ds_read_b64_tr_b16 v[122:123],v53 offset:1024
s_add_u32 s41,s47,512
v_mfma_f32_16x16x32_bf16 a[164:167],v[96:99],a[104:107],a[164:167]
ds_read_b64_tr_b16 v[124:125],v53 offset:2048
v_mfma_f32_16x16x32_bf16 a[164:167],v[100:103],a[108:111],a[164:167]
ds_read_b64_tr_b16 v[126:127],v53 offset:3072
v_mfma_f32_16x16x32_bf16 a[168:171],v[96:99],a[112:115],a[168:171]
buffer_load_dwordx4 v1,s[16:19],s41 offen  lds
v_mfma_f32_16x16x32_bf16 a[168:171],v[100:103],a[116:119],a[168:171]
s_add_u32 s41,s47,8704
v_mfma_f32_16x16x32_bf16 a[172:175],v[96:99],a[120:123],a[172:175]
buffer_load_dwordx4 v42,s[16:19],s41 offen offset:1024  lds
v_mfma_f32_16x16x32_bf16 a[172:175],v[100:103],a[124:127],a[172:175]
s_add_u32 m0,s39,114688
v_mfma_f32_16x16x32_bf16 a[176:179],v[104:107],a[96:99],a[176:179]
ds_read_b64_tr_b16 v[80:81],v54 offset:0
s_mov_b32 s41,2389248
v_mfma_f32_16x16x32_bf16 a[176:179],v[108:111],a[100:103],a[176:179]
ds_read_b64_tr_b16 v[82:83],v54 offset:1024
v_mfma_f32_16x16x32_bf16 a[180:183],v[104:107],a[104:107],a[180:183]
ds_read_b64_tr_b16 v[84:85],v54 offset:2048
v_mfma_f32_16x16x32_bf16 a[180:183],v[108:111],a[108:111],a[180:183]
ds_read_b64_tr_b16 v[86:87],v54 offset:3072
v_mfma_f32_16x16x32_bf16 a[184:187],v[104:107],a[112:115],a[184:187]
buffer_load_dwordx4 v2,s[20:23],s41 offen offset:3072  lds
v_mfma_f32_16x16x32_bf16 a[184:187],v[108:111],a[116:119],a[184:187]
s_mov_b32 s41,3145728
v_mfma_f32_16x16x32_bf16 a[188:191],v[104:107],a[120:123],a[188:191]
buffer_load_dword v22,v37,s[56:59],s41 offen
v_mfma_f32_16x16x32_bf16 a[188:191],v[108:111],a[124:127],a[188:191]
buffer_load_dword v22,v38,s[60:63],0 offen offset:768
s_waitcnt lgkmcnt(3)
v_mfma_f32_16x16x32_bf16 a[192:195],v[112:115],a[96:99],a[192:195]
ds_read_b64_tr_b16 v[88:89],v55 offset:0
v_mfma_f32_16x16x32_bf16 a[192:195],v[116:119],a[100:103],a[192:195]
ds_read_b64_tr_b16 v[90:91],v55 offset:1024
v_mfma_f32_16x16x32_bf16 a[196:199],v[112:115],a[104:107],a[196:199]
ds_read_b64_tr_b16 v[92:93],v55 offset:2048
v_mfma_f32_16x16x32_bf16 a[196:199],v[116:119],a[108:111],a[196:199]
ds_read_b64_tr_b16 v[94:95],v55 offset:3072
v_mfma_f32_16x16x32_bf16 a[200:203],v[112:115],a[112:115],a[200:203]
v_mfma_f32_16x16x32_bf16 a[200:203],v[116:119],a[116:119],a[200:203]
v_mfma_f32_16x16x32_bf16 a[204:207],v[112:115],a[120:123],a[204:207]
s_waitcnt vmcnt(20)
v_mfma_f32_16x16x32_bf16 a[204:207],v[116:119],a[124:127],a[204:207]
s_waitcnt lgkmcnt(0)
s_barrier
v_mfma_f32_16x16x32_bf16 a[208:211],v[120:123],a[96:99],a[208:211]
ds_read_b64_tr_b16 v[96:97],v56 offset:0
s_add_u32 m0,s39,32768
v_mfma_f32_16x16x32_bf16 a[208:211],v[124:127],a[100:103],a[208:211]
ds_read_b64_tr_b16 v[98:99],v56 offset:1024
s_mov_b32 s41,2621440
v_mfma_f32_16x16x32_bf16 a[212:215],v[120:123],a[104:107],a[212:215]
ds_read_b64_tr_b16 v[100:101],v56 offset:2048
v_mfma_f32_16x16x32_bf16 a[212:215],v[124:127],a[108:111],a[212:215]
ds_read_b64_tr_b16 v[102:103],v56 offset:3072
v_mfma_f32_16x16x32_bf16 a[216:219],v[120:123],a[112:115],a[216:219]
buffer_load_dwordx4 v2,s[20:23],s41 offen  lds
v_mfma_f32_16x16x32_bf16 a[216:219],v[124:127],a[116:119],a[216:219]
v_mfma_f32_16x16x32_bf16 a[220:223],v[120:123],a[120:123],a[220:223]
v_mfma_f32_16x16x32_bf16 a[220:223],v[124:127],a[124:127],a[220:223]
v_mfma_f32_16x16x32_bf16 a[224:227],v[80:83],a[96:99],a[224:227]
ds_read_b64_tr_b16 v[104:105],v57 offset:0
s_add_u32 m0,s39,32768
v_mfma_f32_16x16x32_bf16 a[224:227],v[84:87],a[100:103],a[224:227]
ds_read_b64_tr_b16 v[106:107],v57 offset:1024
s_mov_b32 s41,2653184
v_mfma_f32_16x16x32_bf16 a[228:231],v[80:83],a[104:107],a[228:231]
ds_read_b64_tr_b16 v[108:109],v57 offset:2048
v_mfma_f32_16x16x32_bf16 a[228:231],v[84:87],a[108:111],a[228:231]
ds_read_b64_tr_b16 v[110:111],v57 offset:3072
v_mfma_f32_16x16x32_bf16 a[232:235],v[80:83],a[112:115],a[232:235]
buffer_load_dwordx4 v2,s[20:23],s41 offen offset:1024  lds
v_mfma_f32_16x16x32_bf16 a[232:235],v[84:87],a[116:119],a[232:235]
v_mfma_f32_16x16x32_bf16 a[236:239],v[80:83],a[120:123],a[236:239]
v_mfma_f32_16x16x32_bf16 a[236:239],v[84:87],a[124:127],a[236:239]
v_mfma_f32_16x16x32_bf16 a[240:243],v[88:91],a[96:99],a[240:243]
ds_read_b64_tr_b16 v[112:113],v58 offset:0
s_add_u32 m0,s39,32768
v_mfma_f32_16x16x32_bf16 a[240:243],v[92:95],a[100:103],a[240:243]
ds_read_b64_tr_b16 v[114:115],v58 offset:1024
s_mov_b32 s41,2881536
v_mfma_f32_16x16x32_bf16 a[244:247],v[88:91],a[104:107],a[244:247]
ds_read_b64_tr_b16 v[116:117],v58 offset:2048
v_mfma_f32_16x16x32_bf16 a[244:247],v[92:95],a[108:111],a[244:247]
ds_read_b64_tr_b16 v[118:119],v58 offset:3072
v_mfma_f32_16x16x32_bf16 a[248:251],v[88:91],a[112:115],a[248:251]
buffer_load_dwordx4 v2,s[20:23],s41 offen offset:2048  lds
v_mfma_f32_16x16x32_bf16 a[248:251],v[92:95],a[116:119],a[248:251]
v_mfma_f32_16x16x32_bf16 a[252:255],v[88:91],a[120:123],a[252:255]
v_mfma_f32_16x16x32_bf16 a[252:255],v[92:95],a[124:127],a[252:255]
s_waitcnt lgkmcnt(4)
v_mfma_f32_16x16x32_bf16 v[128:131],v[96:99],a[96:99],v[128:131]
ds_read_b64_tr_b16 v[120:121],v59 offset:0
s_add_u32 m0,s39,32768
v_mfma_f32_16x16x32_bf16 v[128:131],v[100:103],a[100:103],v[128:131]
ds_read_b64_tr_b16 v[122:123],v59 offset:1024
s_mov_b32 s41,2913280
v_mfma_f32_16x16x32_bf16 v[160:163],v[96:99],a[104:107],v[160:163]
ds_read_b64_tr_b16 v[124:125],v59 offset:2048
v_mfma_f32_16x16x32_bf16 v[160:163],v[100:103],a[108:111],v[160:163]
ds_read_b64_tr_b16 v[126:127],v59 offset:3072
v_mfma_f32_16x16x32_bf16 v[192:195],v[96:99],a[112:115],v[192:195]
buffer_load_dwordx4 v2,s[20:23],s41 offen offset:3072  lds
v_mfma_f32_16x16x32_bf16 v[192:195],v[100:103],a[116:119],v[192:195]
v_mfma_f32_16x16x32_bf16 v[224:227],v[96:99],a[120:123],v[224:227]
v_mfma_f32_16x16x32_bf16 v[224:227],v[100:103],a[124:127],v[224:227]
v_mfma_f32_16x16x32_bf16 v[132:135],v[104:107],a[96:99],v[132:135]
ds_read_b64_tr_b16 v[80:81],v60 offset:0
v_mfma_f32_16x16x32_bf16 v[132:135],v[108:111],a[100:103],v[132:135]
ds_read_b64_tr_b16 v[82:83],v60 offset:1024
v_mfma_f32_16x16x32_bf16 v[164:167],v[104:107],a[104:107],v[164:167]
ds_read_b64_tr_b16 v[84:85],v60 offset:2048
v_mfma_f32_16x16x32_bf16 v[164:167],v[108:111],a[108:111],v[164:167]
ds_read_b64_tr_b16 v[86:87],v60 offset:3072
v_mfma_f32_16x16x32_bf16 v[196:199],v[104:107],a[112:115],v[196:199]
v_mfma_f32_16x16x32_bf16 v[196:199],v[108:111],a[116:119],v[196:199]
v_mfma_f32_16x16x32_bf16 v[228:231],v[104:107],a[120:123],v[228:231]
v_mfma_f32_16x16x32_bf16 v[228:231],v[108:111],a[124:127],v[228:231]
s_waitcnt lgkmcnt(4)
v_mfma_f32_16x16x32_bf16 v[136:139],v[112:115],a[96:99],v[136:139]
ds_read_b64_tr_b16 v[88:89],v61 offset:0
v_mfma_f32_16x16x32_bf16 v[136:139],v[116:119],a[100:103],v[136:139]
ds_read_b64_tr_b16 v[90:91],v61 offset:1024
v_mfma_f32_16x16x32_bf16 v[168:171],v[112:115],a[104:107],v[168:171]
ds_read_b64_tr_b16 v[92:93],v61 offset:2048
v_mfma_f32_16x16x32_bf16 v[168:171],v[116:119],a[108:111],v[168:171]
ds_read_b64_tr_b16 v[94:95],v61 offset:3072
v_mfma_f32_16x16x32_bf16 v[200:203],v[112:115],a[112:115],v[200:203]
v_mfma_f32_16x16x32_bf16 v[200:203],v[116:119],a[116:119],v[200:203]
v_mfma_f32_16x16x32_bf16 v[232:235],v[112:115],a[120:123],v[232:235]
v_mfma_f32_16x16x32_bf16 v[232:235],v[116:119],a[124:127],v[232:235]
v_mfma_f32_16x16x32_bf16 v[140:143],v[120:123],a[96:99],v[140:143]
ds_read_b64_tr_b16 v[96:97],v62 offset:0
v_mfma_f32_16x16x32_bf16 v[140:143],v[124:127],a[100:103],v[140:143]
ds_read_b64_tr_b16 v[98:99],v62 offset:1024
v_mfma_f32_16x16x32_bf16 v[172:175],v[120:123],a[104:107],v[172:175]
ds_read_b64_tr_b16 v[100:101],v62 offset:2048
v_mfma_f32_16x16x32_bf16 v[172:175],v[124:127],a[108:111],v[172:175]
ds_read_b64_tr_b16 v[102:103],v62 offset:3072
s_waitcnt vmcnt(16)
v_mfma_f32_16x16x32_bf16 v[204:207],v[120:123],a[112:115],v[204:207]
ds_read_b128 a[64:67],v39 offset:0
ds_read_b128 a[68:71],v40 offset:0
v_mfma_f32_16x16x32_bf16 v[204:207],v[124:127],a[116:119],v[204:207]
v_mfma_f32_16x16x32_bf16 v[236:239],v[120:123],a[120:123],v[236:239]
v_mfma_f32_16x16x32_bf16 v[236:239],v[124:127],a[124:127],v[236:239]
s_waitcnt lgkmcnt(6)
v_mfma_f32_16x16x32_bf16 v[144:147],v[80:83],a[96:99],v[144:147]
ds_read_b64_tr_b16 v[104:105],v63 offset:0
v_mfma_f32_16x16x32_bf16 v[144:147],v[84:87],a[100:103],v[144:147]
ds_read_b64_tr_b16 v[106:107],v63 offset:1024
v_mfma_f32_16x16x32_bf16 v[176:179],v[80:83],a[104:107],v[176:179]
ds_read_b64_tr_b16 v[108:109],v63 offset:2048
s_add_u32 m0,s40,131072
v_mfma_f32_16x16x32_bf16 v[176:179],v[84:87],a[108:111],v[176:179]
ds_read_b64_tr_b16 v[110:111],v63 offset:3072
s_add_u32 s41,s44,640
v_mfma_f32_16x16x32_bf16 v[208:211],v[80:83],a[112:115],v[208:211]
s_waitcnt vmcnt(13)
s_waitcnt lgkmcnt(4)
buffer_load_dwordx4 v1,s[16:19],s41 offen  lds
v_mfma_f32_16x16x32_bf16 v[208:211],v[84:87],a[116:119],v[208:211]
ds_read_b128 a[72:75],v39 offset:2048
ds_read_b128 a[76:79],v40 offset:2048
v_mfma_f32_16x16x32_bf16 v[240:243],v[80:83],a[120:123],v[240:243]
s_add_u32 s41,s44,8832
v_mfma_f32_16x16x32_bf16 v[240:243],v[84:87],a[124:127],v[240:243]
s_waitcnt lgkmcnt(0)
s_barrier
v_mfma_f32_16x16x32_bf16 v[148:151],v[88:91],a[96:99],v[148:151]
ds_read_b64_tr_b16 v[112:113],v48 offset:16384
v_mfma_f32_16x16x32_bf16 v[148:151],v[92:95],a[100:103],v[148:151]
ds_read_b64_tr_b16 v[114:115],v48 offset:17408
v_mfma_f32_16x16x32_bf16 v[180:183],v[88:91],a[104:107],v[180:183]
ds_read_b64_tr_b16 v[116:117],v48 offset:18432
v_mfma_f32_16x16x32_bf16 v[180:183],v[92:95],a[108:111],v[180:183]
ds_read_b64_tr_b16 v[118:119],v48 offset:19456
v_mfma_f32_16x16x32_bf16 v[212:215],v[88:91],a[112:115],v[212:215]
buffer_load_dwordx4 v42,s[16:19],s41 offen offset:1024  lds
v_mfma_f32_16x16x32_bf16 v[212:215],v[92:95],a[116:119],v[212:215]
s_waitcnt vmcnt(12)
s_add_u32 m0,s39,98304
v_mfma_f32_16x16x32_bf16 v[244:247],v[88:91],a[120:123],v[244:247]
ds_read_b128 a[80:83],v39 offset:4096
ds_read_b128 a[84:87],v40 offset:4096
v_mfma_f32_16x16x32_bf16 v[244:247],v[92:95],a[124:127],v[244:247]
s_mov_b32 s41,2621696
v_mfma_f32_16x16x32_bf16 v[152:155],v[96:99],a[96:99],v[152:155]
ds_read_b64_tr_b16 v[120:121],v49 offset:16384
v_mfma_f32_16x16x32_bf16 v[152:155],v[100:103],a[100:103],v[152:155]
ds_read_b64_tr_b16 v[122:123],v49 offset:17408
v_mfma_f32_16x16x32_bf16 v[184:187],v[96:99],a[104:107],v[184:187]
ds_read_b64_tr_b16 v[124:125],v49 offset:18432
v_mfma_f32_16x16x32_bf16 v[184:187],v[100:103],a[108:111],v[184:187]
ds_read_b64_tr_b16 v[126:127],v49 offset:19456
v_mfma_f32_16x16x32_bf16 v[216:219],v[96:99],a[112:115],v[216:219]
buffer_load_dwordx4 v2,s[20:23],s41 offen  lds
v_mfma_f32_16x16x32_bf16 v[216:219],v[100:103],a[116:119],v[216:219]
s_add_u32 m0,s40,133120
v_mfma_f32_16x16x32_bf16 v[248:251],v[96:99],a[120:123],v[248:251]
s_waitcnt vmcnt(10)
s_add_u32 s41,s45,640
v_mfma_f32_16x16x32_bf16 v[248:251],v[100:103],a[124:127],v[248:251]
ds_read_b128 a[88:91],v39 offset:6144
ds_read_b128 a[92:95],v40 offset:6144
v_mfma_f32_16x16x32_bf16 v[156:159],v[104:107],a[96:99],v[156:159]
ds_read_b64_tr_b16 v[80:81],v50 offset:16384
v_mfma_f32_16x16x32_bf16 v[156:159],v[108:111],a[100:103],v[156:159]
ds_read_b64_tr_b16 v[82:83],v50 offset:17408
v_mfma_f32_16x16x32_bf16 v[188:191],v[104:107],a[104:107],v[188:191]
ds_read_b64_tr_b16 v[84:85],v50 offset:18432
v_mfma_f32_16x16x32_bf16 v[188:191],v[108:111],a[108:111],v[188:191]
ds_read_b64_tr_b16 v[86:87],v50 offset:19456
v_mfma_f32_16x16x32_bf16 v[220:223],v[104:107],a[112:115],v[220:223]
buffer_load_dwordx4 v1,s[16:19],s41 offen  lds
v_mfma_f32_16x16x32_bf16 v[220:223],v[108:111],a[116:119],v[220:223]
s_add_u32 s41,s45,8832
v_mfma_f32_16x16x32_bf16 v[252:255],v[104:107],a[120:123],v[252:255]
buffer_load_dwordx4 v42,s[16:19],s41 offen offset:1024  lds
v_mfma_f32_16x16x32_bf16 v[252:255],v[108:111],a[124:127],v[252:255]
s_add_u32 m0,s39,98304
s_waitcnt lgkmcnt(4)
v_mfma_f32_16x16x32_bf16 a[128:131],v[112:115],a[64:67],a[128:131]
ds_read_b64_tr_b16 v[88:89],v51 offset:16384
s_mov_b32 s41,2653440
v_mfma_f32_16x16x32_bf16 a[128:131],v[116:119],a[68:71],a[128:131]
ds_read_b64_tr_b16 v[90:91],v51 offset:17408
v_mfma_f32_16x16x32_bf16 a[132:135],v[112:115],a[72:75],a[132:135]
ds_read_b64_tr_b16 v[92:93],v51 offset:18432
v_mfma_f32_16x16x32_bf16 a[132:135],v[116:119],a[76:79],a[132:135]
ds_read_b64_tr_b16 v[94:95],v51 offset:19456
v_mfma_f32_16x16x32_bf16 a[136:139],v[112:115],a[80:83],a[136:139]
buffer_load_dwordx4 v2,s[20:23],s41 offen offset:1024  lds
v_mfma_f32_16x16x32_bf16 a[136:139],v[116:119],a[84:87],a[136:139]
s_add_u32 m0,s40,135168
v_mfma_f32_16x16x32_bf16 a[140:143],v[112:115],a[88:91],a[140:143]
s_add_u32 s41,s46,640
v_mfma_f32_16x16x32_bf16 a[140:143],v[116:119],a[92:95],a[140:143]
buffer_load_dwordx4 v1,s[16:19],s41 offen  lds
v_mfma_f32_16x16x32_bf16 a[144:147],v[120:123],a[64:67],a[144:147]
ds_read_b64_tr_b16 v[96:97],v52 offset:16384
s_add_u32 s41,s46,8832
v_mfma_f32_16x16x32_bf16 a[144:147],v[124:127],a[68:71],a[144:147]
ds_read_b64_tr_b16 v[98:99],v52 offset:17408
v_mfma_f32_16x16x32_bf16 a[148:151],v[120:123],a[72:75],a[148:151]
ds_read_b64_tr_b16 v[100:101],v52 offset:18432
v_mfma_f32_16x16x32_bf16 a[148:151],v[124:127],a[76:79],a[148:151]
ds_read_b64_tr_b16 v[102:103],v52 offset:19456
v_mfma_f32_16x16x32_bf16 a[152:155],v[120:123],a[80:83],a[152:155]
buffer_load_dwordx4 v42,s[16:19],s41 offen offset:1024  lds
v_mfma_f32_16x16x32_bf16 a[152:155],v[124:127],a[84:87],a[152:155]
s_add_u32 m0,s39,98304
v_mfma_f32_16x16x32_bf16 a[156:159],v[120:123],a[88:91],a[156:159]
s_mov_b32 s41,2881792
v_mfma_f32_16x16x32_bf16 a[156:159],v[124:127],a[92:95],a[156:159]
buffer_load_dwordx4 v2,s[20:23],s41 offen offset:2048  lds
s_waitcnt lgkmcnt(3)
v_mfma_f32_16x16x32_bf16 a[160:163],v[80:83],a[64:67],a[160:163]
ds_read_b64_tr_b16 v[104:105],v53 offset:16384
s_add_u32 m0,s40,137216
v_mfma_f32_16x16x32_bf16 a[160:163],v[84:87],a[68:71],a[160:163]
ds_read_b64_tr_b16 v[106:107],v53 offset:17408
s_add_u32 s41,s47,640
v_mfma_f32_16x16x32_bf16 a[164:167],v[80:83],a[72:75],a[164:167]
ds_read_b64_tr_b16 v[108:109],v53 offset:18432
v_mfma_f32_16x16x32_bf16 a[164:167],v[84:87],a[76:79],a[164:167]
ds_read_b64_tr_b16 v[110:111],v53 offset:19456
v_mfma_f32_16x16x32_bf16 a[168:171],v[80:83],a[80:83],a[168:171]
buffer_load_dwordx4 v1,s[16:19],s41 offen  lds
v_mfma_f32_16x16x32_bf16 a[168:171],v[84:87],a[84:87],a[168:171]
s_add_u32 s41,s47,8832
v_mfma_f32_16x16x32_bf16 a[172:175],v[80:83],a[88:91],a[172:175]
buffer_load_dwordx4 v42,s[16:19],s41 offen offset:1024  lds
v_mfma_f32_16x16x32_bf16 a[172:175],v[84:87],a[92:95],a[172:175]
s_add_u32 m0,s39,98304
v_mfma_f32_16x16x32_bf16 a[176:179],v[88:91],a[64:67],a[176:179]
ds_read_b64_tr_b16 v[112:113],v54 offset:16384
s_mov_b32 s41,2913536
v_mfma_f32_16x16x32_bf16 a[176:179],v[92:95],a[68:71],a[176:179]
ds_read_b64_tr_b16 v[114:115],v54 offset:17408
v_mfma_f32_16x16x32_bf16 a[180:183],v[88:91],a[72:75],a[180:183]
ds_read_b64_tr_b16 v[116:117],v54 offset:18432
v_mfma_f32_16x16x32_bf16 a[180:183],v[92:95],a[76:79],a[180:183]
ds_read_b64_tr_b16 v[118:119],v54 offset:19456
v_mfma_f32_16x16x32_bf16 a[184:187],v[88:91],a[80:83],a[184:187]
buffer_load_dwordx4 v2,s[20:23],s41 offen offset:3072  lds
v_mfma_f32_16x16x32_bf16 a[184:187],v[92:95],a[84:87],a[184:187]
s_mov_b32 s41,4194304
v_mfma_f32_16x16x32_bf16 a[188:191],v[88:91],a[88:91],a[188:191]
buffer_load_dword v22,v64,s[56:59],s41 offen
v_mfma_f32_16x16x32_bf16 a[188:191],v[92:95],a[92:95],a[188:191]
buffer_load_dword v22,v65,s[60:63],0 offen offset:1024
s_waitcnt lgkmcnt(3)
v_mfma_f32_16x16x32_bf16 a[192:195],v[96:99],a[64:67],a[192:195]
ds_read_b64_tr_b16 v[120:121],v55 offset:16384
v_mfma_f32_16x16x32_bf16 a[192:195],v[100:103],a[68:71],a[192:195]
ds_read_b64_tr_b16 v[122:123],v55 offset:17408
v_mfma_f32_16x16x32_bf16 a[196:199],v[96:99],a[72:75],a[196:199]
ds_read_b64_tr_b16 v[124:125],v55 offset:18432
v_mfma_f32_16x16x32_bf16 a[196:199],v[100:103],a[76:79],a[196:199]
ds_read_b64_tr_b16 v[126:127],v55 offset:19456
v_mfma_f32_16x16x32_bf16 a[200:203],v[96:99],a[80:83],a[200:203]
buffer_load_dword v22,v41,s[92:95],s90 offen
v_mfma_f32_16x16x32_bf16 a[200:203],v[100:103],a[84:87],a[200:203]
v_mfma_f32_16x16x32_bf16 a[204:207],v[96:99],a[88:91],a[204:207]
s_waitcnt vmcnt(21)
v_mfma_f32_16x16x32_bf16 a[204:207],v[100:103],a[92:95],a[204:207]
s_waitcnt lgkmcnt(0)
s_barrier
v_mfma_f32_16x16x32_bf16 a[208:211],v[104:107],a[64:67],a[208:211]
ds_read_b64_tr_b16 v[80:81],v56 offset:16384
s_add_u32 m0,s39,49152
v_mfma_f32_16x16x32_bf16 a[208:211],v[108:111],a[68:71],a[208:211]
ds_read_b64_tr_b16 v[82:83],v56 offset:17408
s_mov_b32 s41,3145728
v_mfma_f32_16x16x32_bf16 a[212:215],v[104:107],a[72:75],a[212:215]
ds_read_b64_tr_b16 v[84:85],v56 offset:18432
v_mfma_f32_16x16x32_bf16 a[212:215],v[108:111],a[76:79],a[212:215]
ds_read_b64_tr_b16 v[86:87],v56 offset:19456
v_mfma_f32_16x16x32_bf16 a[216:219],v[104:107],a[80:83],a[216:219]
buffer_load_dwordx4 v2,s[20:23],s41 offen  lds
v_mfma_f32_16x16x32_bf16 a[216:219],v[108:111],a[84:87],a[216:219]
v_mfma_f32_16x16x32_bf16 a[220:223],v[104:107],a[88:91],a[220:223]
v_mfma_f32_16x16x32_bf16 a[220:223],v[108:111],a[92:95],a[220:223]
v_mfma_f32_16x16x32_bf16 a[224:227],v[112:115],a[64:67],a[224:227]
ds_read_b64_tr_b16 v[88:89],v57 offset:16384
s_add_u32 m0,s39,49152
v_mfma_f32_16x16x32_bf16 a[224:227],v[116:119],a[68:71],a[224:227]
ds_read_b64_tr_b16 v[90:91],v57 offset:17408
s_mov_b32 s41,3177472
v_mfma_f32_16x16x32_bf16 a[228:231],v[112:115],a[72:75],a[228:231]
ds_read_b64_tr_b16 v[92:93],v57 offset:18432
v_mfma_f32_16x16x32_bf16 a[228:231],v[116:119],a[76:79],a[228:231]
ds_read_b64_tr_b16 v[94:95],v57 offset:19456
v_mfma_f32_16x16x32_bf16 a[232:235],v[112:115],a[80:83],a[232:235]
buffer_load_dwordx4 v2,s[20:23],s41 offen offset:1024  lds
v_mfma_f32_16x16x32_bf16 a[232:235],v[116:119],a[84:87],a[232:235]
v_mfma_f32_16x16x32_bf16 a[236:239],v[112:115],a[88:91],a[236:239]
v_mfma_f32_16x16x32_bf16 a[236:239],v[116:119],a[92:95],a[236:239]
v_mfma_f32_16x16x32_bf16 a[240:243],v[120:123],a[64:67],a[240:243]
ds_read_b64_tr_b16 v[96:97],v58 offset:16384
s_add_u32 m0,s39,49152
v_mfma_f32_16x16x32_bf16 a[240:243],v[124:127],a[68:71],a[240:243]
ds_read_b64_tr_b16 v[98:99],v58 offset:17408
s_mov_b32 s41,3405824
v_mfma_f32_16x16x32_bf16 a[244:247],v[120:123],a[72:75],a[244:247]
ds_read_b64_tr_b16 v[100:101],v58 offset:18432
v_mfma_f32_16x16x32_bf16 a[244:247],v[124:127],a[76:79],a[244:247]
ds_read_b64_tr_b16 v[102:103],v58 offset:19456
v_mfma_f32_16x16x32_bf16 a[248:251],v[120:123],a[80:83],a[248:251]
buffer_load_dwordx4 v2,s[20:23],s41 offen offset:2048  lds
v_mfma_f32_16x16x32_bf16 a[248:251],v[124:127],a[84:87],a[248:251]
v_mfma_f32_16x16x32_bf16 a[252:255],v[120:123],a[88:91],a[252:255]
v_mfma_f32_16x16x32_bf16 a[252:255],v[124:127],a[92:95],a[252:255]
s_waitcnt lgkmcnt(4)
v_mfma_f32_16x16x32_bf16 v[128:131],v[80:83],a[64:67],v[128:131]
ds_read_b64_tr_b16 v[104:105],v59 offset:16384
s_add_u32 m0,s39,49152
v_mfma_f32_16x16x32_bf16 v[128:131],v[84:87],a[68:71],v[128:131]
ds_read_b64_tr_b16 v[106:107],v59 offset:17408
s_mov_b32 s41,3437568
v_mfma_f32_16x16x32_bf16 v[160:163],v[80:83],a[72:75],v[160:163]
ds_read_b64_tr_b16 v[108:109],v59 offset:18432
v_mfma_f32_16x16x32_bf16 v[160:163],v[84:87],a[76:79],v[160:163]
ds_read_b64_tr_b16 v[110:111],v59 offset:19456
v_mfma_f32_16x16x32_bf16 v[192:195],v[80:83],a[80:83],v[192:195]
buffer_load_dwordx4 v2,s[20:23],s41 offen offset:3072  lds
v_mfma_f32_16x16x32_bf16 v[192:195],v[84:87],a[84:87],v[192:195]
v_mfma_f32_16x16x32_bf16 v[224:227],v[80:83],a[88:91],v[224:227]
v_mfma_f32_16x16x32_bf16 v[224:227],v[84:87],a[92:95],v[224:227]
v_mfma_f32_16x16x32_bf16 v[132:135],v[88:91],a[64:67],v[132:135]
ds_read_b64_tr_b16 v[112:113],v60 offset:16384
v_mfma_f32_16x16x32_bf16 v[132:135],v[92:95],a[68:71],v[132:135]
ds_read_b64_tr_b16 v[114:115],v60 offset:17408
v_mfma_f32_16x16x32_bf16 v[164:167],v[88:91],a[72:75],v[164:167]
ds_read_b64_tr_b16 v[116:117],v60 offset:18432
v_mfma_f32_16x16x32_bf16 v[164:167],v[92:95],a[76:79],v[164:167]
ds_read_b64_tr_b16 v[118:119],v60 offset:19456
v_mfma_f32_16x16x32_bf16 v[196:199],v[88:91],a[80:83],v[196:199]
v_mfma_f32_16x16x32_bf16 v[196:199],v[92:95],a[84:87],v[196:199]
v_mfma_f32_16x16x32_bf16 v[228:231],v[88:91],a[88:91],v[228:231]
v_mfma_f32_16x16x32_bf16 v[228:231],v[92:95],a[92:95],v[228:231]
s_waitcnt lgkmcnt(4)
v_mfma_f32_16x16x32_bf16 v[136:139],v[96:99],a[64:67],v[136:139]
ds_read_b64_tr_b16 v[120:121],v61 offset:16384
v_mfma_f32_16x16x32_bf16 v[136:139],v[100:103],a[68:71],v[136:139]
ds_read_b64_tr_b16 v[122:123],v61 offset:17408
v_mfma_f32_16x16x32_bf16 v[168:171],v[96:99],a[72:75],v[168:171]
ds_read_b64_tr_b16 v[124:125],v61 offset:18432
v_mfma_f32_16x16x32_bf16 v[168:171],v[100:103],a[76:79],v[168:171]
ds_read_b64_tr_b16 v[126:127],v61 offset:19456
v_mfma_f32_16x16x32_bf16 v[200:203],v[96:99],a[80:83],v[200:203]
v_mfma_f32_16x16x32_bf16 v[200:203],v[100:103],a[84:87],v[200:203]
v_mfma_f32_16x16x32_bf16 v[232:235],v[96:99],a[88:91],v[232:235]
v_mfma_f32_16x16x32_bf16 v[232:235],v[100:103],a[92:95],v[232:235]
v_mfma_f32_16x16x32_bf16 v[140:143],v[104:107],a[64:67],v[140:143]
ds_read_b64_tr_b16 v[80:81],v62 offset:16384
s_add_u32 m0,s39,0
v_mfma_f32_16x16x32_bf16 v[140:143],v[108:111],a[68:71],v[140:143]
ds_read_b64_tr_b16 v[82:83],v62 offset:17408
s_mov_b32 s41,0
v_mfma_f32_16x16x32_bf16 v[172:175],v[104:107],a[72:75],v[172:175]
ds_read_b64_tr_b16 v[84:85],v62 offset:18432
v_mfma_f32_16x16x32_bf16 v[172:175],v[108:111],a[76:79],v[172:175]
ds_read_b64_tr_b16 v[86:87],v62 offset:19456
s_waitcnt vmcnt(17)
v_mfma_f32_16x16x32_bf16 v[204:207],v[104:107],a[80:83],v[204:207]
ds_read_b128 a[96:99],v39 offset:0
ds_read_b128 a[100:103],v40 offset:0
v_mfma_f32_16x16x32_bf16 v[204:207],v[108:111],a[84:87],v[204:207]
buffer_load_dwordx4 v4,s[8:11],s41 offen nt lds
v_mfma_f32_16x16x32_bf16 v[236:239],v[104:107],a[88:91],v[236:239]
v_mfma_f32_16x16x32_bf16 v[236:239],v[108:111],a[92:95],v[236:239]
s_waitcnt lgkmcnt(5)
v_mfma_f32_16x16x32_bf16 v[144:147],v[112:115],a[64:67],v[144:147]
ds_read_b64_tr_b16 v[88:89],v63 offset:16384
v_mfma_f32_16x16x32_bf16 v[144:147],v[116:119],a[68:71],v[144:147]
ds_read_b64_tr_b16 v[90:91],v63 offset:17408
v_mfma_f32_16x16x32_bf16 v[176:179],v[112:115],a[72:75],v[176:179]
ds_read_b64_tr_b16 v[92:93],v63 offset:18432
s_add_u32 m0,s40,131072
v_mfma_f32_16x16x32_bf16 v[176:179],v[116:119],a[76:79],v[176:179]
ds_read_b64_tr_b16 v[94:95],v63 offset:19456
s_add_u32 s41,s44,768
v_mfma_f32_16x16x32_bf16 v[208:211],v[112:115],a[80:83],v[208:211]
s_waitcnt vmcnt(15)
s_waitcnt lgkmcnt(4)
buffer_load_dwordx4 v1,s[16:19],s41 offen  lds
v_mfma_f32_16x16x32_bf16 v[208:211],v[116:119],a[84:87],v[208:211]
ds_read_b128 a[104:107],v39 offset:2048
ds_read_b128 a[108:111],v40 offset:2048
v_mfma_f32_16x16x32_bf16 v[240:243],v[112:115],a[88:91],v[240:243]
s_add_u32 s41,s44,8960
v_mfma_f32_16x16x32_bf16 v[240:243],v[116:119],a[92:95],v[240:243]
s_waitcnt lgkmcnt(0)
s_barrier
v_mfma_f32_16x16x32_bf16 v[148:151],v[120:123],a[64:67],v[148:151]
ds_read_b64_tr_b16 v[96:97],v48 offset:0
v_mfma_f32_16x16x32_bf16 v[148:151],v[124:127],a[68:71],v[148:151]
ds_read_b64_tr_b16 v[98:99],v48 offset:1024
v_mfma_f32_16x16x32_bf16 v[180:183],v[120:123],a[72:75],v[180:183]
ds_read_b64_tr_b16 v[100:101],v48 offset:2048
v_mfma_f32_16x16x32_bf16 v[180:183],v[124:127],a[76:79],v[180:183]
ds_read_b64_tr_b16 v[102:103],v48 offset:3072
v_mfma_f32_16x16x32_bf16 v[212:215],v[120:123],a[80:83],v[212:215]
buffer_load_dwordx4 v42,s[16:19],s41 offen offset:1024  lds
v_mfma_f32_16x16x32_bf16 v[212:215],v[124:127],a[84:87],v[212:215]
s_waitcnt vmcnt(14)
s_add_u32 m0,s39,114688
v_mfma_f32_16x16x32_bf16 v[244:247],v[120:123],a[88:91],v[244:247]
ds_read_b128 a[112:115],v39 offset:4096
ds_read_b128 a[116:119],v40 offset:4096
v_mfma_f32_16x16x32_bf16 v[244:247],v[124:127],a[92:95],v[244:247]
s_mov_b32 s41,3145984
v_mfma_f32_16x16x32_bf16 v[152:155],v[80:83],a[64:67],v[152:155]
ds_read_b64_tr_b16 v[104:105],v49 offset:0
v_mfma_f32_16x16x32_bf16 v[152:155],v[84:87],a[68:71],v[152:155]
ds_read_b64_tr_b16 v[106:107],v49 offset:1024
v_mfma_f32_16x16x32_bf16 v[184:187],v[80:83],a[72:75],v[184:187]
ds_read_b64_tr_b16 v[108:109],v49 offset:2048
v_mfma_f32_16x16x32_bf16 v[184:187],v[84:87],a[76:79],v[184:187]
ds_read_b64_tr_b16 v[110:111],v49 offset:3072
v_mfma_f32_16x16x32_bf16 v[216:219],v[80:83],a[80:83],v[216:219]
buffer_load_dwordx4 v2,s[20:23],s41 offen  lds
v_mfma_f32_16x16x32_bf16 v[216:219],v[84:87],a[84:87],v[216:219]
s_add_u32 m0,s40,133120
v_mfma_f32_16x16x32_bf16 v[248:251],v[80:83],a[88:91],v[248:251]
s_waitcnt vmcnt(12)
s_add_u32 s41,s45,768
v_mfma_f32_16x16x32_bf16 v[248:251],v[84:87],a[92:95],v[248:251]
ds_read_b128 a[120:123],v39 offset:6144
ds_read_b128 a[124:127],v40 offset:6144
v_mfma_f32_16x16x32_bf16 v[156:159],v[88:91],a[64:67],v[156:159]
ds_read_b64_tr_b16 v[112:113],v50 offset:0
v_mfma_f32_16x16x32_bf16 v[156:159],v[92:95],a[68:71],v[156:159]
ds_read_b64_tr_b16 v[114:115],v50 offset:1024
v_mfma_f32_16x16x32_bf16 v[188:191],v[88:91],a[72:75],v[188:191]
ds_read_b64_tr_b16 v[116:117],v50 offset:2048
v_mfma_f32_16x16x32_bf16 v[188:191],v[92:95],a[76:79],v[188:191]
ds_read_b64_tr_b16 v[118:119],v50 offset:3072
v_mfma_f32_16x16x32_bf16 v[220:223],v[88:91],a[80:83],v[220:223]
buffer_load_dwordx4 v1,s[16:19],s41 offen  lds
v_mfma_f32_16x16x32_bf16 v[220:223],v[92:95],a[84:87],v[220:223]
s_add_u32 s41,s45,8960
v_mfma_f32_16x16x32_bf16 v[252:255],v[88:91],a[88:91],v[252:255]
buffer_load_dwordx4 v42,s[16:19],s41 offen offset:1024  lds
v_mfma_f32_16x16x32_bf16 v[252:255],v[92:95],a[92:95],v[252:255]
s_add_u32 m0,s39,0
s_waitcnt lgkmcnt(4)
v_mfma_f32_16x16x32_bf16 a[128:131],v[96:99],a[96:99],a[128:131]
ds_read_b64_tr_b16 v[120:121],v51 offset:0
s_mov_b32 s41,0
v_mfma_f32_16x16x32_bf16 a[128:131],v[100:103],a[100:103],a[128:131]
ds_read_b64_tr_b16 v[122:123],v51 offset:1024
v_mfma_f32_16x16x32_bf16 a[132:135],v[96:99],a[104:107],a[132:135]
ds_read_b64_tr_b16 v[124:125],v51 offset:2048
v_mfma_f32_16x16x32_bf16 a[132:135],v[100:103],a[108:111],a[132:135]
ds_read_b64_tr_b16 v[126:127],v51 offset:3072
v_mfma_f32_16x16x32_bf16 a[136:139],v[96:99],a[112:115],a[136:139]
buffer_load_dwordx4 v5,s[8:11],s41 offen offset:1024 nt lds
v_mfma_f32_16x16x32_bf16 a[136:139],v[100:103],a[116:119],a[136:139]
s_add_u32 m0,s39,114688
v_mfma_f32_16x16x32_bf16 a[140:143],v[96:99],a[120:123],a[140:143]
s_mov_b32 s41,3177728
v_mfma_f32_16x16x32_bf16 a[140:143],v[100:103],a[124:127],a[140:143]
buffer_load_dwordx4 v2,s[20:23],s41 offen offset:1024  lds
v_mfma_f32_16x16x32_bf16 a[144:147],v[104:107],a[96:99],a[144:147]
ds_read_b64_tr_b16 v[80:81],v52 offset:0
s_add_u32 m0,s40,135168
v_mfma_f32_16x16x32_bf16 a[144:147],v[108:111],a[100:103],a[144:147]
ds_read_b64_tr_b16 v[82:83],v52 offset:1024
s_add_u32 s41,s46,768
v_mfma_f32_16x16x32_bf16 a[148:151],v[104:107],a[104:107],a[148:151]
ds_read_b64_tr_b16 v[84:85],v52 offset:2048
v_mfma_f32_16x16x32_bf16 a[148:151],v[108:111],a[108:111],a[148:151]
ds_read_b64_tr_b16 v[86:87],v52 offset:3072
v_mfma_f32_16x16x32_bf16 a[152:155],v[104:107],a[112:115],a[152:155]
buffer_load_dwordx4 v1,s[16:19],s41 offen  lds
v_mfma_f32_16x16x32_bf16 a[152:155],v[108:111],a[116:119],a[152:155]
s_add_u32 s41,s46,8960
v_mfma_f32_16x16x32_bf16 a[156:159],v[104:107],a[120:123],a[156:159]
buffer_load_dwordx4 v42,s[16:19],s41 offen offset:1024  lds
v_mfma_f32_16x16x32_bf16 a[156:159],v[108:111],a[124:127],a[156:159]
s_add_u32 m0,s39,114688
s_waitcnt lgkmcnt(3)
v_mfma_f32_16x16x32_bf16 a[160:163],v[112:115],a[96:99],a[160:163]
ds_read_b64_tr_b16 v[88:89],v53 offset:0
s_mov_b32 s41,3406080
v_mfma_f32_16x16x32_bf16 a[160:163],v[116:119],a[100:103],a[160:163]
ds_read_b64_tr_b16 v[90:91],v53 offset:1024
v_mfma_f32_16x16x32_bf16 a[164:167],v[112:115],a[104:107],a[164:167]
ds_read_b64_tr_b16 v[92:93],v53 offset:2048
v_mfma_f32_16x16x32_bf16 a[164:167],v[116:119],a[108:111],a[164:167]
ds_read_b64_tr_b16 v[94:95],v53 offset:3072
v_mfma_f32_16x16x32_bf16 a[168:171],v[112:115],a[112:115],a[168:171]
buffer_load_dwordx4 v2,s[20:23],s41 offen offset:2048  lds
v_mfma_f32_16x16x32_bf16 a[168:171],v[116:119],a[116:119],a[168:171]
s_add_u32 m0,s40,137216
v_mfma_f32_16x16x32_bf16 a[172:175],v[112:115],a[120:123],a[172:175]
s_add_u32 s41,s47,768
v_mfma_f32_16x16x32_bf16 a[172:175],v[116:119],a[124:127],a[172:175]
buffer_load_dwordx4 v1,s[16:19],s41 offen  lds
v_mfma_f32_16x16x32_bf16 a[176:179],v[120:123],a[96:99],a[176:179]
ds_read_b64_tr_b16 v[96:97],v54 offset:0
s_add_u32 s41,s47,8960
v_mfma_f32_16x16x32_bf16 a[176:179],v[124:127],a[100:103],a[176:179]
ds_read_b64_tr_b16 v[98:99],v54 offset:1024
v_mfma_f32_16x16x32_bf16 a[180:183],v[120:123],a[104:107],a[180:183]
ds_read_b64_tr_b16 v[100:101],v54 offset:2048
v_mfma_f32_16x16x32_bf16 a[180:183],v[124:127],a[108:111],a[180:183]
ds_read_b64_tr_b16 v[102:103],v54 offset:3072
v_mfma_f32_16x16x32_bf16 a[184:187],v[120:123],a[112:115],a[184:187]
buffer_load_dwordx4 v42,s[16:19],s41 offen offset:1024  lds
v_mfma_f32_16x16x32_bf16 a[184:187],v[124:127],a[116:119],a[184:187]
s_add_u32 m0,s39,114688
v_mfma_f32_16x16x32_bf16 a[188:191],v[120:123],a[120:123],a[188:191]
s_mov_b32 s41,3437824
v_mfma_f32_16x16x32_bf16 a[188:191],v[124:127],a[124:127],a[188:191]
buffer_load_dwordx4 v2,s[20:23],s41 offen offset:3072  lds
s_waitcnt lgkmcnt(3)
v_mfma_f32_16x16x32_bf16 a[192:195],v[80:83],a[96:99],a[192:195]
ds_read_b64_tr_b16 v[104:105],v55 offset:0
s_add_u32 m0,s39,0
v_mfma_f32_16x16x32_bf16 a[192:195],v[84:87],a[100:103],a[192:195]
ds_read_b64_tr_b16 v[106:107],v55 offset:1024
s_mov_b32 s41,0
v_mfma_f32_16x16x32_bf16 a[196:199],v[80:83],a[104:107],a[196:199]
ds_read_b64_tr_b16 v[108:109],v55 offset:2048
v_mfma_f32_16x16x32_bf16 a[196:199],v[84:87],a[108:111],a[196:199]
ds_read_b64_tr_b16 v[110:111],v55 offset:3072
v_mfma_f32_16x16x32_bf16 a[200:203],v[80:83],a[112:115],a[200:203]
buffer_load_dwordx4 v6,s[8:11],s41 offen offset:2048 nt lds
v_mfma_f32_16x16x32_bf16 a[200:203],v[84:87],a[116:119],a[200:203]
s_add_u32 m0,s39,0
v_mfma_f32_16x16x32_bf16 a[204:207],v[80:83],a[120:123],a[204:207]
s_waitcnt vmcnt(22)
s_mov_b32 s41,0
v_mfma_f32_16x16x32_bf16 a[204:207],v[84:87],a[124:127],a[204:207]
s_waitcnt lgkmcnt(0)
s_barrier
v_mfma_f32_16x16x32_bf16 a[208:211],v[88:91],a[96:99],a[208:211]
ds_read_b64_tr_b16 v[112:113],v56 offset:0
v_mfma_f32_16x16x32_bf16 a[208:211],v[92:95],a[100:103],a[208:211]
ds_read_b64_tr_b16 v[114:115],v56 offset:1024
v_mfma_f32_16x16x32_bf16 a[212:215],v[88:91],a[104:107],a[212:215]
ds_read_b64_tr_b16 v[116:117],v56 offset:2048
v_mfma_f32_16x16x32_bf16 a[212:215],v[92:95],a[108:111],a[212:215]
ds_read_b64_tr_b16 v[118:119],v56 offset:3072
v_mfma_f32_16x16x32_bf16 a[216:219],v[88:91],a[112:115],a[216:219]
buffer_load_dwordx4 v7,s[8:11],s41 offen offset:3072 nt lds
v_mfma_f32_16x16x32_bf16 a[216:219],v[92:95],a[116:119],a[216:219]
s_add_u32 m0,s39,32768
v_mfma_f32_16x16x32_bf16 a[220:223],v[88:91],a[120:123],a[220:223]
s_mov_b32 s41,3670016
v_mfma_f32_16x16x32_bf16 a[220:223],v[92:95],a[124:127],a[220:223]
buffer_load_dwordx4 v2,s[20:23],s41 offen  lds
v_mfma_f32_16x16x32_bf16 a[224:227],v[96:99],a[96:99],a[224:227]
ds_read_b64_tr_b16 v[120:121],v57 offset:0
s_add_u32 m0,s39,65536
v_mfma_f32_16x16x32_bf16 a[224:227],v[100:103],a[100:103],a[224:227]
ds_read_b64_tr_b16 v[122:123],v57 offset:1024
s_mov_b32 s41,0
v_mfma_f32_16x16x32_bf16 a[228:231],v[96:99],a[104:107],a[228:231]
ds_read_b64_tr_b16 v[124:125],v57 offset:2048
v_mfma_f32_16x16x32_bf16 a[228:231],v[100:103],a[108:111],a[228:231]
ds_read_b64_tr_b16 v[126:127],v57 offset:3072
v_mfma_f32_16x16x32_bf16 a[232:235],v[96:99],a[112:115],a[232:235]
buffer_load_dwordx4 v8,s[12:15],s41 offen nt lds
v_mfma_f32_16x16x32_bf16 a[232:235],v[100:103],a[116:119],a[232:235]
s_add_u32 m0,s39,32768
v_mfma_f32_16x16x32_bf16 a[236:239],v[96:99],a[120:123],a[236:239]
s_mov_b32 s41,3701760
v_mfma_f32_16x16x32_bf16 a[236:239],v[100:103],a[124:127],a[236:239]
buffer_load_dwordx4 v2,s[20:23],s41 offen offset:1024  lds
v_mfma_f32_16x16x32_bf16 a[240:243],v[104:107],a[96:99],a[240:243]
ds_read_b64_tr_b16 v[80:81],v58 offset:0
s_add_u32 m0,s39,32768
v_mfma_f32_16x16x32_bf16 a[240:243],v[108:111],a[100:103],a[240:243]
ds_read_b64_tr_b16 v[82:83],v58 offset:1024
s_mov_b32 s41,3930112
v_mfma_f32_16x16x32_bf16 a[244:247],v[104:107],a[104:107],a[244:247]
ds_read_b64_tr_b16 v[84:85],v58 offset:2048
v_mfma_f32_16x16x32_bf16 a[244:247],v[108:111],a[108:111],a[244:247]
ds_read_b64_tr_b16 v[86:87],v58 offset:3072
v_mfma_f32_16x16x32_bf16 a[248:251],v[104:107],a[112:115],a[248:251]
buffer_load_dwordx4 v2,s[20:23],s41 offen offset:2048  lds
v_mfma_f32_16x16x32_bf16 a[248:251],v[108:111],a[116:119],a[248:251]
s_add_u32 m0,s39,65536
v_mfma_f32_16x16x32_bf16 a[252:255],v[104:107],a[120:123],a[252:255]
s_mov_b32 s41,0
v_mfma_f32_16x16x32_bf16 a[252:255],v[108:111],a[124:127],a[252:255]
buffer_load_dwordx4 v9,s[12:15],s41 offen offset:1024 nt lds
s_waitcnt lgkmcnt(3)
v_mfma_f32_16x16x32_bf16 v[128:131],v[112:115],a[96:99],v[128:131]
ds_read_b64_tr_b16 v[88:89],v59 offset:0
s_add_u32 m0,s39,32768
v_mfma_f32_16x16x32_bf16 v[128:131],v[116:119],a[100:103],v[128:131]
ds_read_b64_tr_b16 v[90:91],v59 offset:1024
s_mov_b32 s41,3961856
v_mfma_f32_16x16x32_bf16 v[160:163],v[112:115],a[104:107],v[160:163]
ds_read_b64_tr_b16 v[92:93],v59 offset:2048
v_mfma_f32_16x16x32_bf16 v[160:163],v[116:119],a[108:111],v[160:163]
ds_read_b64_tr_b16 v[94:95],v59 offset:3072
v_mfma_f32_16x16x32_bf16 v[192:195],v[112:115],a[112:115],v[192:195]
buffer_load_dwordx4 v2,s[20:23],s41 offen offset:3072  lds
v_mfma_f32_16x16x32_bf16 v[192:195],v[116:119],a[116:119],v[192:195]
v_mfma_f32_16x16x32_bf16 v[224:227],v[112:115],a[120:123],v[224:227]
v_mfma_f32_16x16x32_bf16 v[224:227],v[116:119],a[124:127],v[224:227]
v_mfma_f32_16x16x32_bf16 v[132:135],v[120:123],a[96:99],v[132:135]
ds_read_b64_tr_b16 v[96:97],v60 offset:0
v_mfma_f32_16x16x32_bf16 v[132:135],v[124:127],a[100:103],v[132:135]
ds_read_b64_tr_b16 v[98:99],v60 offset:1024
v_mfma_f32_16x16x32_bf16 v[164:167],v[120:123],a[104:107],v[164:167]
ds_read_b64_tr_b16 v[100:101],v60 offset:2048
v_mfma_f32_16x16x32_bf16 v[164:167],v[124:127],a[108:111],v[164:167]
ds_read_b64_tr_b16 v[102:103],v60 offset:3072
v_mfma_f32_16x16x32_bf16 v[196:199],v[120:123],a[112:115],v[196:199]
v_mfma_f32_16x16x32_bf16 v[196:199],v[124:127],a[116:119],v[196:199]
v_mfma_f32_16x16x32_bf16 v[228:231],v[120:123],a[120:123],v[228:231]
v_mfma_f32_16x16x32_bf16 v[228:231],v[124:127],a[124:127],v[228:231]
s_waitcnt lgkmcnt(4)
v_mfma_f32_16x16x32_bf16 v[136:139],v[80:83],a[96:99],v[136:139]
ds_read_b64_tr_b16 v[104:105],v61 offset:0
s_add_u32 m0,s39,65536
v_mfma_f32_16x16x32_bf16 v[136:139],v[84:87],a[100:103],v[136:139]
ds_read_b64_tr_b16 v[106:107],v61 offset:1024
s_mov_b32 s41,0
v_mfma_f32_16x16x32_bf16 v[168:171],v[80:83],a[104:107],v[168:171]
ds_read_b64_tr_b16 v[108:109],v61 offset:2048
v_mfma_f32_16x16x32_bf16 v[168:171],v[84:87],a[108:111],v[168:171]
ds_read_b64_tr_b16 v[110:111],v61 offset:3072
v_mfma_f32_16x16x32_bf16 v[200:203],v[80:83],a[112:115],v[200:203]
buffer_load_dwordx4 v8,s[12:15],s41 offen offset:2048 nt lds
v_mfma_f32_16x16x32_bf16 v[200:203],v[84:87],a[116:119],v[200:203]
v_mfma_f32_16x16x32_bf16 v[232:235],v[80:83],a[120:123],v[232:235]
v_mfma_f32_16x16x32_bf16 v[232:235],v[84:87],a[124:127],v[232:235]
v_mfma_f32_16x16x32_bf16 v[140:143],v[88:91],a[96:99],v[140:143]
ds_read_b64_tr_b16 v[112:113],v62 offset:0
v_mfma_f32_16x16x32_bf16 v[140:143],v[92:95],a[100:103],v[140:143]
ds_read_b64_tr_b16 v[114:115],v62 offset:1024
v_mfma_f32_16x16x32_bf16 v[172:175],v[88:91],a[104:107],v[172:175]
ds_read_b64_tr_b16 v[116:117],v62 offset:2048
v_mfma_f32_16x16x32_bf16 v[172:175],v[92:95],a[108:111],v[172:175]
ds_read_b64_tr_b16 v[118:119],v62 offset:3072
s_waitcnt vmcnt(20)
v_mfma_f32_16x16x32_bf16 v[204:207],v[88:91],a[112:115],v[204:207]
ds_read_b128 a[64:67],v39 offset:0
ds_read_b128 a[68:71],v40 offset:0
v_mfma_f32_16x16x32_bf16 v[204:207],v[92:95],a[116:119],v[204:207]
v_mfma_f32_16x16x32_bf16 v[236:239],v[88:91],a[120:123],v[236:239]
v_mfma_f32_16x16x32_bf16 v[236:239],v[92:95],a[124:127],v[236:239]
s_waitcnt lgkmcnt(6)
v_mfma_f32_16x16x32_bf16 v[144:147],v[96:99],a[96:99],v[144:147]
ds_read_b64_tr_b16 v[120:121],v63 offset:0
v_mfma_f32_16x16x32_bf16 v[144:147],v[100:103],a[100:103],v[144:147]
ds_read_b64_tr_b16 v[122:123],v63 offset:1024
v_mfma_f32_16x16x32_bf16 v[176:179],v[96:99],a[104:107],v[176:179]
ds_read_b64_tr_b16 v[124:125],v63 offset:2048
s_add_u32 m0,s40,131072
v_mfma_f32_16x16x32_bf16 v[176:179],v[100:103],a[108:111],v[176:179]
ds_read_b64_tr_b16 v[126:127],v63 offset:3072
s_add_u32 s41,s44,896
v_mfma_f32_16x16x32_bf16 v[208:211],v[96:99],a[112:115],v[208:211]
s_waitcnt vmcnt(17)
s_waitcnt lgkmcnt(4)
buffer_load_dwordx4 v1,s[16:19],s41 offen  lds
v_mfma_f32_16x16x32_bf16 v[208:211],v[100:103],a[116:119],v[208:211]
ds_read_b128 a[72:75],v39 offset:2048
ds_read_b128 a[76:79],v40 offset:2048
v_mfma_f32_16x16x32_bf16 v[240:243],v[96:99],a[120:123],v[240:243]
s_add_u32 s41,s44,9088
v_mfma_f32_16x16x32_bf16 v[240:243],v[100:103],a[124:127],v[240:243]
s_waitcnt lgkmcnt(0)
s_barrier
v_mfma_f32_16x16x32_bf16 v[148:151],v[104:107],a[96:99],v[148:151]
ds_read_b64_tr_b16 v[80:81],v48 offset:16384
v_mfma_f32_16x16x32_bf16 v[148:151],v[108:111],a[100:103],v[148:151]
ds_read_b64_tr_b16 v[82:83],v48 offset:17408
v_mfma_f32_16x16x32_bf16 v[180:183],v[104:107],a[104:107],v[180:183]
ds_read_b64_tr_b16 v[84:85],v48 offset:18432
v_mfma_f32_16x16x32_bf16 v[180:183],v[108:111],a[108:111],v[180:183]
ds_read_b64_tr_b16 v[86:87],v48 offset:19456
v_mfma_f32_16x16x32_bf16 v[212:215],v[104:107],a[112:115],v[212:215]
buffer_load_dwordx4 v42,s[16:19],s41 offen offset:1024  lds
v_mfma_f32_16x16x32_bf16 v[212:215],v[108:111],a[116:119],v[212:215]
s_waitcnt vmcnt(15)
s_add_u32 m0,s39,65536
v_mfma_f32_16x16x32_bf16 v[244:247],v[104:107],a[120:123],v[244:247]
ds_read_b128 a[80:83],v39 offset:4096
ds_read_b128 a[84:87],v40 offset:4096
v_mfma_f32_16x16x32_bf16 v[244:247],v[108:111],a[124:127],v[244:247]
s_mov_b32 s41,0
v_mfma_f32_16x16x32_bf16 v[152:155],v[112:115],a[96:99],v[152:155]
ds_read_b64_tr_b16 v[88:89],v49 offset:16384
v_mfma_f32_16x16x32_bf16 v[152:155],v[116:119],a[100:103],v[152:155]
ds_read_b64_tr_b16 v[90:91],v49 offset:17408
v_mfma_f32_16x16x32_bf16 v[184:187],v[112:115],a[104:107],v[184:187]
ds_read_b64_tr_b16 v[92:93],v49 offset:18432
v_mfma_f32_16x16x32_bf16 v[184:187],v[116:119],a[108:111],v[184:187]
ds_read_b64_tr_b16 v[94:95],v49 offset:19456
v_mfma_f32_16x16x32_bf16 v[216:219],v[112:115],a[112:115],v[216:219]
buffer_load_dwordx4 v9,s[12:15],s41 offen offset:3072 nt lds
v_mfma_f32_16x16x32_bf16 v[216:219],v[116:119],a[116:119],v[216:219]
s_add_u32 m0,s39,98304
v_mfma_f32_16x16x32_bf16 v[248:251],v[112:115],a[120:123],v[248:251]
s_waitcnt vmcnt(13)
s_mov_b32 s41,3670272
v_mfma_f32_16x16x32_bf16 v[248:251],v[116:119],a[124:127],v[248:251]
ds_read_b128 a[88:91],v39 offset:6144
ds_read_b128 a[92:95],v40 offset:6144
v_mfma_f32_16x16x32_bf16 v[156:159],v[120:123],a[96:99],v[156:159]
ds_read_b64_tr_b16 v[96:97],v50 offset:16384
v_mfma_f32_16x16x32_bf16 v[156:159],v[124:127],a[100:103],v[156:159]
ds_read_b64_tr_b16 v[98:99],v50 offset:17408
v_mfma_f32_16x16x32_bf16 v[188:191],v[120:123],a[104:107],v[188:191]
ds_read_b64_tr_b16 v[100:101],v50 offset:18432
v_mfma_f32_16x16x32_bf16 v[188:191],v[124:127],a[108:111],v[188:191]
ds_read_b64_tr_b16 v[102:103],v50 offset:19456
v_mfma_f32_16x16x32_bf16 v[220:223],v[120:123],a[112:115],v[220:223]
buffer_load_dwordx4 v2,s[20:23],s41 offen  lds
v_mfma_f32_16x16x32_bf16 v[220:223],v[124:127],a[116:119],v[220:223]
s_add_u32 m0,s40,133120
v_mfma_f32_16x16x32_bf16 v[252:255],v[120:123],a[120:123],v[252:255]
s_add_u32 s41,s45,896
v_mfma_f32_16x16x32_bf16 v[252:255],v[124:127],a[124:127],v[252:255]
buffer_load_dwordx4 v1,s[16:19],s41 offen  lds
s_waitcnt lgkmcnt(4)
v_mfma_f32_16x16x32_bf16 a[128:131],v[80:83],a[64:67],a[128:131]
ds_read_b64_tr_b16 v[104:105],v51 offset:16384
s_add_u32 s41,s45,9088
v_mfma_f32_16x16x32_bf16 a[128:131],v[84:87],a[68:71],a[128:131]
ds_read_b64_tr_b16 v[106:107],v51 offset:17408
v_mfma_f32_16x16x32_bf16 a[132:135],v[80:83],a[72:75],a[132:135]
ds_read_b64_tr_b16 v[108:109],v51 offset:18432
v_mfma_f32_16x16x32_bf16 a[132:135],v[84:87],a[76:79],a[132:135]
ds_read_b64_tr_b16 v[110:111],v51 offset:19456
v_mfma_f32_16x16x32_bf16 a[136:139],v[80:83],a[80:83],a[136:139]
buffer_load_dwordx4 v42,s[16:19],s41 offen offset:1024  lds
v_mfma_f32_16x16x32_bf16 a[136:139],v[84:87],a[84:87],a[136:139]
s_add_u32 m0,s39,98304
v_mfma_f32_16x16x32_bf16 a[140:143],v[80:83],a[88:91],a[140:143]
s_mov_b32 s41,3702016
v_mfma_f32_16x16x32_bf16 a[140:143],v[84:87],a[92:95],a[140:143]
buffer_load_dwordx4 v2,s[20:23],s41 offen offset:1024  lds
v_mfma_f32_16x16x32_bf16 a[144:147],v[88:91],a[64:67],a[144:147]
ds_read_b64_tr_b16 v[112:113],v52 offset:16384
s_add_u32 m0,s40,135168
v_mfma_f32_16x16x32_bf16 a[144:147],v[92:95],a[68:71],a[144:147]
ds_read_b64_tr_b16 v[114:115],v52 offset:17408
s_add_u32 s41,s46,896
v_mfma_f32_16x16x32_bf16 a[148:151],v[88:91],a[72:75],a[148:151]
ds_read_b64_tr_b16 v[116:117],v52 offset:18432
v_mfma_f32_16x16x32_bf16 a[148:151],v[92:95],a[76:79],a[148:151]
ds_read_b64_tr_b16 v[118:119],v52 offset:19456
v_mfma_f32_16x16x32_bf16 a[152:155],v[88:91],a[80:83],a[152:155]
buffer_load_dwordx4 v1,s[16:19],s41 offen  lds
v_mfma_f32_16x16x32_bf16 a[152:155],v[92:95],a[84:87],a[152:155]
s_add_u32 s41,s46,9088
v_mfma_f32_16x16x32_bf16 a[156:159],v[88:91],a[88:91],a[156:159]
buffer_load_dwordx4 v42,s[16:19],s41 offen offset:1024  lds
v_mfma_f32_16x16x32_bf16 a[156:159],v[92:95],a[92:95],a[156:159]
s_add_u32 m0,s39,98304
s_waitcnt lgkmcnt(3)
v_mfma_f32_16x16x32_bf16 a[160:163],v[96:99],a[64:67],a[160:163]
ds_read_b64_tr_b16 v[120:121],v53 offset:16384
s_mov_b32 s41,3930368
v_mfma_f32_16x16x32_bf16 a[160:163],v[100:103],a[68:71],a[160:163]
ds_read_b64_tr_b16 v[122:123],v53 offset:17408
v_mfma_f32_16x16x32_bf16 a[164:167],v[96:99],a[72:75],a[164:167]
ds_read_b64_tr_b16 v[124:125],v53 offset:18432
v_mfma_f32_16x16x32_bf16 a[164:167],v[100:103],a[76:79],a[164:167]
ds_read_b64_tr_b16 v[126:127],v53 offset:19456
v_mfma_f32_16x16x32_bf16 a[168:171],v[96:99],a[80:83],a[168:171]
buffer_load_dwordx4 v2,s[20:23],s41 offen offset:2048  lds
v_mfma_f32_16x16x32_bf16 a[168:171],v[100:103],a[84:87],a[168:171]
s_add_u32 m0,s39,16384
v_mfma_f32_16x16x32_bf16 a[172:175],v[96:99],a[88:91],a[172:175]
s_mov_b32 s41,16384
v_mfma_f32_16x16x32_bf16 a[172:175],v[100:103],a[92:95],a[172:175]
buffer_load_dwordx4 v4,s[8:11],s41 offen nt lds
v_mfma_f32_16x16x32_bf16 a[176:179],v[104:107],a[64:67],a[176:179]
ds_read_b64_tr_b16 v[80:81],v54 offset:16384
s_add_u32 m0,s40,137216
v_mfma_f32_16x16x32_bf16 a[176:179],v[108:111],a[68:71],a[176:179]
ds_read_b64_tr_b16 v[82:83],v54 offset:17408
s_add_u32 s41,s47,896
v_mfma_f32_16x16x32_bf16 a[180:183],v[104:107],a[72:75],a[180:183]
ds_read_b64_tr_b16 v[84:85],v54 offset:18432
v_mfma_f32_16x16x32_bf16 a[180:183],v[108:111],a[76:79],a[180:183]
ds_read_b64_tr_b16 v[86:87],v54 offset:19456
v_mfma_f32_16x16x32_bf16 a[184:187],v[104:107],a[80:83],a[184:187]
buffer_load_dwordx4 v1,s[16:19],s41 offen  lds
v_mfma_f32_16x16x32_bf16 a[184:187],v[108:111],a[84:87],a[184:187]
s_add_u32 s41,s47,9088
v_mfma_f32_16x16x32_bf16 a[188:191],v[104:107],a[88:91],a[188:191]
buffer_load_dwordx4 v42,s[16:19],s41 offen offset:1024  lds
v_mfma_f32_16x16x32_bf16 a[188:191],v[108:111],a[92:95],a[188:191]
s_add_u32 m0,s39,98304
s_waitcnt lgkmcnt(3)
v_mfma_f32_16x16x32_bf16 a[192:195],v[112:115],a[64:67],a[192:195]
ds_read_b64_tr_b16 v[88:89],v55 offset:16384
s_mov_b32 s41,3962112
v_mfma_f32_16x16x32_bf16 a[192:195],v[116:119],a[68:71],a[192:195]
ds_read_b64_tr_b16 v[90:91],v55 offset:17408
v_mfma_f32_16x16x32_bf16 a[196:199],v[112:115],a[72:75],a[196:199]
ds_read_b64_tr_b16 v[92:93],v55 offset:18432
v_mfma_f32_16x16x32_bf16 a[196:199],v[116:119],a[76:79],a[196:199]
ds_read_b64_tr_b16 v[94:95],v55 offset:19456
v_mfma_f32_16x16x32_bf16 a[200:203],v[112:115],a[80:83],a[200:203]
buffer_load_dwordx4 v2,s[20:23],s41 offen offset:3072  lds
v_mfma_f32_16x16x32_bf16 a[200:203],v[116:119],a[84:87],a[200:203]
s_add_u32 m0,s39,16384
v_mfma_f32_16x16x32_bf16 a[204:207],v[112:115],a[88:91],a[204:207]
s_waitcnt vmcnt(23)
s_mov_b32 s41,16384
v_mfma_f32_16x16x32_bf16 a[204:207],v[116:119],a[92:95],a[204:207]
s_waitcnt lgkmcnt(0)
s_barrier
v_mfma_f32_16x16x32_bf16 a[208:211],v[120:123],a[64:67],a[208:211]
ds_read_b64_tr_b16 v[96:97],v56 offset:16384
v_mfma_f32_16x16x32_bf16 a[208:211],v[124:127],a[68:71],a[208:211]
ds_read_b64_tr_b16 v[98:99],v56 offset:17408
v_mfma_f32_16x16x32_bf16 a[212:215],v[120:123],a[72:75],a[212:215]
ds_read_b64_tr_b16 v[100:101],v56 offset:18432
v_mfma_f32_16x16x32_bf16 a[212:215],v[124:127],a[76:79],a[212:215]
ds_read_b64_tr_b16 v[102:103],v56 offset:19456
v_mfma_f32_16x16x32_bf16 a[216:219],v[120:123],a[80:83],a[216:219]
buffer_load_dwordx4 v5,s[8:11],s41 offen offset:1024 nt lds
v_mfma_f32_16x16x32_bf16 a[216:219],v[124:127],a[84:87],a[216:219]
s_add_u32 m0,s39,16384
v_mfma_f32_16x16x32_bf16 a[220:223],v[120:123],a[88:91],a[220:223]
s_mov_b32 s41,16384
v_mfma_f32_16x16x32_bf16 a[220:223],v[124:127],a[92:95],a[220:223]
buffer_load_dwordx4 v6,s[8:11],s41 offen offset:2048 nt lds
v_mfma_f32_16x16x32_bf16 a[224:227],v[80:83],a[64:67],a[224:227]
ds_read_b64_tr_b16 v[104:105],v57 offset:16384
s_add_u32 m0,s39,49152
v_mfma_f32_16x16x32_bf16 a[224:227],v[84:87],a[68:71],a[224:227]
ds_read_b64_tr_b16 v[106:107],v57 offset:17408
s_mov_b32 s41,4194304
v_mfma_f32_16x16x32_bf16 a[228:231],v[80:83],a[72:75],a[228:231]
ds_read_b64_tr_b16 v[108:109],v57 offset:18432
v_mfma_f32_16x16x32_bf16 a[228:231],v[84:87],a[76:79],a[228:231]
ds_read_b64_tr_b16 v[110:111],v57 offset:19456
v_mfma_f32_16x16x32_bf16 a[232:235],v[80:83],a[80:83],a[232:235]
buffer_load_dwordx4 v2,s[20:23],s41 offen  lds
v_mfma_f32_16x16x32_bf16 a[232:235],v[84:87],a[84:87],a[232:235]
s_add_u32 m0,s39,49152
v_mfma_f32_16x16x32_bf16 a[236:239],v[80:83],a[88:91],a[236:239]
s_mov_b32 s41,4226048
v_mfma_f32_16x16x32_bf16 a[236:239],v[84:87],a[92:95],a[236:239]
buffer_load_dwordx4 v2,s[20:23],s41 offen offset:1024  lds
v_mfma_f32_16x16x32_bf16 a[240:243],v[88:91],a[64:67],a[240:243]
ds_read_b64_tr_b16 v[112:113],v58 offset:16384
s_add_u32 m0,s39,16384
v_mfma_f32_16x16x32_bf16 a[240:243],v[92:95],a[68:71],a[240:243]
ds_read_b64_tr_b16 v[114:115],v58 offset:17408
s_mov_b32 s41,16384
v_mfma_f32_16x16x32_bf16 a[244:247],v[88:91],a[72:75],a[244:247]
ds_read_b64_tr_b16 v[116:117],v58 offset:18432
v_mfma_f32_16x16x32_bf16 a[244:247],v[92:95],a[76:79],a[244:247]
ds_read_b64_tr_b16 v[118:119],v58 offset:19456
v_mfma_f32_16x16x32_bf16 a[248:251],v[88:91],a[80:83],a[248:251]
buffer_load_dwordx4 v7,s[8:11],s41 offen offset:3072 nt lds
v_mfma_f32_16x16x32_bf16 a[248:251],v[92:95],a[84:87],a[248:251]
s_add_u32 m0,s39,49152
v_mfma_f32_16x16x32_bf16 a[252:255],v[88:91],a[88:91],a[252:255]
s_mov_b32 s41,4454400
v_mfma_f32_16x16x32_bf16 a[252:255],v[92:95],a[92:95],a[252:255]
buffer_load_dwordx4 v2,s[20:23],s41 offen offset:2048  lds
s_waitcnt lgkmcnt(3)
v_mfma_f32_16x16x32_bf16 v[128:131],v[96:99],a[64:67],v[128:131]
ds_read_b64_tr_b16 v[120:121],v59 offset:16384
s_add_u32 m0,s39,49152
v_mfma_f32_16x16x32_bf16 v[128:131],v[100:103],a[68:71],v[128:131]
ds_read_b64_tr_b16 v[122:123],v59 offset:17408
s_mov_b32 s41,4486144
v_mfma_f32_16x16x32_bf16 v[160:163],v[96:99],a[72:75],v[160:163]
ds_read_b64_tr_b16 v[124:125],v59 offset:18432
v_mfma_f32_16x16x32_bf16 v[160:163],v[100:103],a[76:79],v[160:163]
ds_read_b64_tr_b16 v[126:127],v59 offset:19456
v_mfma_f32_16x16x32_bf16 v[192:195],v[96:99],a[80:83],v[192:195]
buffer_load_dwordx4 v2,s[20:23],s41 offen offset:3072  lds
v_mfma_f32_16x16x32_bf16 v[192:195],v[100:103],a[84:87],v[192:195]
v_mfma_f32_16x16x32_bf16 v[224:227],v[96:99],a[88:91],v[224:227]
v_mfma_f32_16x16x32_bf16 v[224:227],v[100:103],a[92:95],v[224:227]
v_mfma_f32_16x16x32_bf16 v[132:135],v[104:107],a[64:67],v[132:135]
ds_read_b64_tr_b16 v[80:81],v60 offset:16384
v_mfma_f32_16x16x32_bf16 v[132:135],v[108:111],a[68:71],v[132:135]
ds_read_b64_tr_b16 v[82:83],v60 offset:17408
v_mfma_f32_16x16x32_bf16 v[164:167],v[104:107],a[72:75],v[164:167]
ds_read_b64_tr_b16 v[84:85],v60 offset:18432
v_mfma_f32_16x16x32_bf16 v[164:167],v[108:111],a[76:79],v[164:167]
ds_read_b64_tr_b16 v[86:87],v60 offset:19456
v_mfma_f32_16x16x32_bf16 v[196:199],v[104:107],a[80:83],v[196:199]
v_mfma_f32_16x16x32_bf16 v[196:199],v[108:111],a[84:87],v[196:199]
s_add_u32 m0,s39,81920
v_mfma_f32_16x16x32_bf16 v[228:231],v[104:107],a[88:91],v[228:231]
s_mov_b32 s41,16384
v_mfma_f32_16x16x32_bf16 v[228:231],v[108:111],a[92:95],v[228:231]
buffer_load_dwordx4 v8,s[12:15],s41 offen nt lds
s_waitcnt lgkmcnt(4)
v_mfma_f32_16x16x32_bf16 v[136:139],v[112:115],a[64:67],v[136:139]
ds_read_b64_tr_b16 v[88:89],v61 offset:16384
v_mfma_f32_16x16x32_bf16 v[136:139],v[116:119],a[68:71],v[136:139]
ds_read_b64_tr_b16 v[90:91],v61 offset:17408
v_mfma_f32_16x16x32_bf16 v[168:171],v[112:115],a[72:75],v[168:171]
ds_read_b64_tr_b16 v[92:93],v61 offset:18432
v_mfma_f32_16x16x32_bf16 v[168:171],v[116:119],a[76:79],v[168:171]
ds_read_b64_tr_b16 v[94:95],v61 offset:19456
v_mfma_f32_16x16x32_bf16 v[200:203],v[112:115],a[80:83],v[200:203]
v_mfma_f32_16x16x32_bf16 v[200:203],v[116:119],a[84:87],v[200:203]
v_mfma_f32_16x16x32_bf16 v[232:235],v[112:115],a[88:91],v[232:235]
v_mfma_f32_16x16x32_bf16 v[232:235],v[116:119],a[92:95],v[232:235]
v_mfma_f32_16x16x32_bf16 v[140:143],v[120:123],a[64:67],v[140:143]
ds_read_b64_tr_b16 v[96:97],v62 offset:16384
v_mfma_f32_16x16x32_bf16 v[140:143],v[124:127],a[68:71],v[140:143]
ds_read_b64_tr_b16 v[98:99],v62 offset:17408
v_mfma_f32_16x16x32_bf16 v[172:175],v[120:123],a[72:75],v[172:175]
ds_read_b64_tr_b16 v[100:101],v62 offset:18432
v_mfma_f32_16x16x32_bf16 v[172:175],v[124:127],a[76:79],v[172:175]
ds_read_b64_tr_b16 v[102:103],v62 offset:19456
s_waitcnt vmcnt(20)
v_mfma_f32_16x16x32_bf16 v[204:207],v[120:123],a[80:83],v[204:207]
ds_read_b128 a[96:99],v39 offset:0
ds_read_b128 a[100:103],v40 offset:0
v_mfma_f32_16x16x32_bf16 v[204:207],v[124:127],a[84:87],v[204:207]
v_mfma_f32_16x16x32_bf16 v[236:239],v[120:123],a[88:91],v[236:239]
v_mfma_f32_16x16x32_bf16 v[236:239],v[124:127],a[92:95],v[236:239]
s_waitcnt lgkmcnt(6)
v_mfma_f32_16x16x32_bf16 v[144:147],v[80:83],a[64:67],v[144:147]
ds_read_b64_tr_b16 v[104:105],v63 offset:16384
v_mfma_f32_16x16x32_bf16 v[144:147],v[84:87],a[68:71],v[144:147]
ds_read_b64_tr_b16 v[106:107],v63 offset:17408
v_mfma_f32_16x16x32_bf16 v[176:179],v[80:83],a[72:75],v[176:179]
ds_read_b64_tr_b16 v[108:109],v63 offset:18432
s_add_u32 m0,s40,131072
v_mfma_f32_16x16x32_bf16 v[176:179],v[84:87],a[76:79],v[176:179]
ds_read_b64_tr_b16 v[110:111],v63 offset:19456
s_add_u32 s41,s44,1024
v_mfma_f32_16x16x32_bf16 v[208:211],v[80:83],a[80:83],v[208:211]
s_waitcnt vmcnt(16)
s_waitcnt lgkmcnt(4)
buffer_load_dwordx4 v1,s[16:19],s41 offen  lds
v_mfma_f32_16x16x32_bf16 v[208:211],v[84:87],a[84:87],v[208:211]
ds_read_b128 a[104:107],v39 offset:2048
ds_read_b128 a[108:111],v40 offset:2048
v_mfma_f32_16x16x32_bf16 v[240:243],v[80:83],a[88:91],v[240:243]
s_add_u32 s41,s44,9216
v_mfma_f32_16x16x32_bf16 v[240:243],v[84:87],a[92:95],v[240:243]
s_waitcnt lgkmcnt(0)
s_barrier
v_mfma_f32_16x16x32_bf16 v[148:151],v[88:91],a[64:67],v[148:151]
ds_read_b64_tr_b16 v[112:113],v48 offset:0
v_mfma_f32_16x16x32_bf16 v[148:151],v[92:95],a[68:71],v[148:151]
ds_read_b64_tr_b16 v[114:115],v48 offset:1024
v_mfma_f32_16x16x32_bf16 v[180:183],v[88:91],a[72:75],v[180:183]
ds_read_b64_tr_b16 v[116:117],v48 offset:2048
v_mfma_f32_16x16x32_bf16 v[180:183],v[92:95],a[76:79],v[180:183]
ds_read_b64_tr_b16 v[118:119],v48 offset:3072
v_mfma_f32_16x16x32_bf16 v[212:215],v[88:91],a[80:83],v[212:215]
buffer_load_dwordx4 v42,s[16:19],s41 offen offset:1024  lds
v_mfma_f32_16x16x32_bf16 v[212:215],v[92:95],a[84:87],v[212:215]
s_waitcnt vmcnt(15)
s_add_u32 m0,s39,81920
v_mfma_f32_16x16x32_bf16 v[244:247],v[88:91],a[88:91],v[244:247]
ds_read_b128 a[112:115],v39 offset:4096
ds_read_b128 a[116:119],v40 offset:4096
v_mfma_f32_16x16x32_bf16 v[244:247],v[92:95],a[92:95],v[244:247]
s_mov_b32 s41,16384
v_mfma_f32_16x16x32_bf16 v[152:155],v[96:99],a[64:67],v[152:155]
ds_read_b64_tr_b16 v[120:121],v49 offset:0
v_mfma_f32_16x16x32_bf16 v[152:155],v[100:103],a[68:71],v[152:155]
ds_read_b64_tr_b16 v[122:123],v49 offset:1024
v_mfma_f32_16x16x32_bf16 v[184:187],v[96:99],a[72:75],v[184:187]
ds_read_b64_tr_b16 v[124:125],v49 offset:2048
v_mfma_f32_16x16x32_bf16 v[184:187],v[100:103],a[76:79],v[184:187]
ds_read_b64_tr_b16 v[126:127],v49 offset:3072
v_mfma_f32_16x16x32_bf16 v[216:219],v[96:99],a[80:83],v[216:219]
buffer_load_dwordx4 v9,s[12:15],s41 offen offset:1024 nt lds
v_mfma_f32_16x16x32_bf16 v[216:219],v[100:103],a[84:87],v[216:219]
s_add_u32 m0,s39,114688
v_mfma_f32_16x16x32_bf16 v[248:251],v[96:99],a[88:91],v[248:251]
s_waitcnt vmcnt(12)
s_mov_b32 s41,4194560
v_mfma_f32_16x16x32_bf16 v[248:251],v[100:103],a[92:95],v[248:251]
ds_read_b128 a[120:123],v39 offset:6144
ds_read_b128 a[124:127],v40 offset:6144
v_mfma_f32_16x16x32_bf16 v[156:159],v[104:107],a[64:67],v[156:159]
ds_read_b64_tr_b16 v[80:81],v50 offset:0
v_mfma_f32_16x16x32_bf16 v[156:159],v[108:111],a[68:71],v[156:159]
ds_read_b64_tr_b16 v[82:83],v50 offset:1024
v_mfma_f32_16x16x32_bf16 v[188:191],v[104:107],a[72:75],v[188:191]
ds_read_b64_tr_b16 v[84:85],v50 offset:2048
v_mfma_f32_16x16x32_bf16 v[188:191],v[108:111],a[76:79],v[188:191]
ds_read_b64_tr_b16 v[86:87],v50 offset:3072
v_mfma_f32_16x16x32_bf16 v[220:223],v[104:107],a[80:83],v[220:223]
buffer_load_dwordx4 v2,s[20:23],s41 offen  lds
v_mfma_f32_16x16x32_bf16 v[220:223],v[108:111],a[84:87],v[220:223]
s_add_u32 m0,s40,133120
v_mfma_f32_16x16x32_bf16 v[252:255],v[104:107],a[88:91],v[252:255]
s_add_u32 s41,s45,1024
v_mfma_f32_16x16x32_bf16 v[252:255],v[108:111],a[92:95],v[252:255]
buffer_load_dwordx4 v1,s[16:19],s41 offen  lds
s_waitcnt lgkmcnt(4)
v_mfma_f32_16x16x32_bf16 a[128:131],v[112:115],a[96:99],a[128:131]
ds_read_b64_tr_b16 v[88:89],v51 offset:0
s_add_u32 s41,s45,9216
v_mfma_f32_16x16x32_bf16 a[128:131],v[116:119],a[100:103],a[128:131]
ds_read_b64_tr_b16 v[90:91],v51 offset:1024
v_mfma_f32_16x16x32_bf16 a[132:135],v[112:115],a[104:107],a[132:135]
ds_read_b64_tr_b16 v[92:93],v51 offset:2048
v_mfma_f32_16x16x32_bf16 a[132:135],v[116:119],a[108:111],a[132:135]
ds_read_b64_tr_b16 v[94:95],v51 offset:3072
v_mfma_f32_16x16x32_bf16 a[136:139],v[112:115],a[112:115],a[136:139]
buffer_load_dwordx4 v42,s[16:19],s41 offen offset:1024  lds
v_mfma_f32_16x16x32_bf16 a[136:139],v[116:119],a[116:119],a[136:139]
s_add_u32 m0,s39,114688
v_mfma_f32_16x16x32_bf16 a[140:143],v[112:115],a[120:123],a[140:143]
s_mov_b32 s41,4226304
v_mfma_f32_16x16x32_bf16 a[140:143],v[116:119],a[124:127],a[140:143]
buffer_load_dwordx4 v2,s[20:23],s41 offen offset:1024  lds
v_mfma_f32_16x16x32_bf16 a[144:147],v[120:123],a[96:99],a[144:147]
ds_read_b64_tr_b16 v[96:97],v52 offset:0
s_add_u32 m0,s40,135168
v_mfma_f32_16x16x32_bf16 a[144:147],v[124:127],a[100:103],a[144:147]
ds_read_b64_tr_b16 v[98:99],v52 offset:1024
s_add_u32 s41,s46,1024
v_mfma_f32_16x16x32_bf16 a[148:151],v[120:123],a[104:107],a[148:151]
ds_read_b64_tr_b16 v[100:101],v52 offset:2048
v_mfma_f32_16x16x32_bf16 a[148:151],v[124:127],a[108:111],a[148:151]
ds_read_b64_tr_b16 v[102:103],v52 offset:3072
v_mfma_f32_16x16x32_bf16 a[152:155],v[120:123],a[112:115],a[152:155]
buffer_load_dwordx4 v1,s[16:19],s41 offen  lds
v_mfma_f32_16x16x32_bf16 a[152:155],v[124:127],a[116:119],a[152:155]
s_add_u32 s41,s46,9216
v_mfma_f32_16x16x32_bf16 a[156:159],v[120:123],a[120:123],a[156:159]
buffer_load_dwordx4 v42,s[16:19],s41 offen offset:1024  lds
v_mfma_f32_16x16x32_bf16 a[156:159],v[124:127],a[124:127],a[156:159]
s_add_u32 m0,s39,81920
s_waitcnt lgkmcnt(3)
v_mfma_f32_16x16x32_bf16 a[160:163],v[80:83],a[96:99],a[160:163]
ds_read_b64_tr_b16 v[104:105],v53 offset:0
s_mov_b32 s41,16384
v_mfma_f32_16x16x32_bf16 a[160:163],v[84:87],a[100:103],a[160:163]
ds_read_b64_tr_b16 v[106:107],v53 offset:1024
v_mfma_f32_16x16x32_bf16 a[164:167],v[80:83],a[104:107],a[164:167]
ds_read_b64_tr_b16 v[108:109],v53 offset:2048
v_mfma_f32_16x16x32_bf16 a[164:167],v[84:87],a[108:111],a[164:167]
ds_read_b64_tr_b16 v[110:111],v53 offset:3072
v_mfma_f32_16x16x32_bf16 a[168:171],v[80:83],a[112:115],a[168:171]
buffer_load_dwordx4 v8,s[12:15],s41 offen offset:2048 nt lds
v_mfma_f32_16x16x32_bf16 a[168:171],v[84:87],a[116:119],a[168:171]
s_add_u32 m0,s39,114688
v_mfma_f32_16x16x32_bf16 a[172:175],v[80:83],a[120:123],a[172:175]
s_mov_b32 s41,4454656
v_mfma_f32_16x16x32_bf16 a[172:175],v[84:87],a[124:127],a[172:175]
buffer_load_dwordx4 v2,s[20:23],s41 offen offset:2048  lds
v_mfma_f32_16x16x32_bf16 a[176:179],v[88:91],a[96:99],a[176:179]
ds_read_b64_tr_b16 v[112:113],v54 offset:0
s_add_u32 m0,s40,137216
v_mfma_f32_16x16x32_bf16 a[176:179],v[92:95],a[100:103],a[176:179]
ds_read_b64_tr_b16 v[114:115],v54 offset:1024
s_add_u32 s41,s47,1024
v_mfma_f32_16x16x32_bf16 a[180:183],v[88:91],a[104:107],a[180:183]
ds_read_b64_tr_b16 v[116:117],v54 offset:2048
v_mfma_f32_16x16x32_bf16 a[180:183],v[92:95],a[108:111],a[180:183]
ds_read_b64_tr_b16 v[118:119],v54 offset:3072
v_mfma_f32_16x16x32_bf16 a[184:187],v[88:91],a[112:115],a[184:187]
buffer_load_dwordx4 v1,s[16:19],s41 offen  lds
v_mfma_f32_16x16x32_bf16 a[184:187],v[92:95],a[116:119],a[184:187]
s_add_u32 s41,s47,9216
v_mfma_f32_16x16x32_bf16 a[188:191],v[88:91],a[120:123],a[188:191]
buffer_load_dwordx4 v42,s[16:19],s41 offen offset:1024  lds
v_mfma_f32_16x16x32_bf16 a[188:191],v[92:95],a[124:127],a[188:191]
s_add_u32 m0,s39,114688
s_waitcnt lgkmcnt(3)
v_mfma_f32_16x16x32_bf16 a[192:195],v[96:99],a[96:99],a[192:195]
ds_read_b64_tr_b16 v[120:121],v55 offset:0
s_mov_b32 s41,4486400
v_mfma_f32_16x16x32_bf16 a[192:195],v[100:103],a[100:103],a[192:195]
ds_read_b64_tr_b16 v[122:123],v55 offset:1024
v_mfma_f32_16x16x32_bf16 a[196:199],v[96:99],a[104:107],a[196:199]
ds_read_b64_tr_b16 v[124:125],v55 offset:2048
v_mfma_f32_16x16x32_bf16 a[196:199],v[100:103],a[108:111],a[196:199]
ds_read_b64_tr_b16 v[126:127],v55 offset:3072
v_mfma_f32_16x16x32_bf16 a[200:203],v[96:99],a[112:115],a[200:203]
buffer_load_dwordx4 v2,s[20:23],s41 offen offset:3072  lds
v_mfma_f32_16x16x32_bf16 a[200:203],v[100:103],a[116:119],a[200:203]
s_add_u32 m0,s39,81920
v_mfma_f32_16x16x32_bf16 a[204:207],v[96:99],a[120:123],a[204:207]
s_waitcnt vmcnt(22)
s_mov_b32 s41,16384
v_mfma_f32_16x16x32_bf16 a[204:207],v[100:103],a[124:127],a[204:207]
s_waitcnt lgkmcnt(0)
s_barrier
v_mfma_f32_16x16x32_bf16 a[208:211],v[104:107],a[96:99],a[208:211]
ds_read_b64_tr_b16 v[80:81],v56 offset:0
v_mfma_f32_16x16x32_bf16 a[208:211],v[108:111],a[100:103],a[208:211]
ds_read_b64_tr_b16 v[82:83],v56 offset:1024
v_mfma_f32_16x16x32_bf16 a[212:215],v[104:107],a[104:107],a[212:215]
ds_read_b64_tr_b16 v[84:85],v56 offset:2048
v_mfma_f32_16x16x32_bf16 a[212:215],v[108:111],a[108:111],a[212:215]
ds_read_b64_tr_b16 v[86:87],v56 offset:3072
v_mfma_f32_16x16x32_bf16 a[216:219],v[104:107],a[112:115],a[216:219]
buffer_load_dwordx4 v9,s[12:15],s41 offen offset:3072 nt lds
v_mfma_f32_16x16x32_bf16 a[216:219],v[108:111],a[116:119],a[216:219]
s_add_u32 m0,s39,32768
v_mfma_f32_16x16x32_bf16 a[220:223],v[104:107],a[120:123],a[220:223]
s_mov_b32 s41,32768
v_mfma_f32_16x16x32_bf16 a[220:223],v[108:111],a[124:127],a[220:223]
buffer_load_dwordx4 v4,s[8:11],s41 offen nt lds
v_mfma_f32_16x16x32_bf16 a[224:227],v[112:115],a[96:99],a[224:227]
ds_read_b64_tr_b16 v[88:89],v57 offset:0
s_add_u32 m0,s39,32768
v_mfma_f32_16x16x32_bf16 a[224:227],v[116:119],a[100:103],a[224:227]
ds_read_b64_tr_b16 v[90:91],v57 offset:1024
s_mov_b32 s41,32768
v_mfma_f32_16x16x32_bf16 a[228:231],v[112:115],a[104:107],a[228:231]
ds_read_b64_tr_b16 v[92:93],v57 offset:2048
v_mfma_f32_16x16x32_bf16 a[228:231],v[116:119],a[108:111],a[228:231]
ds_read_b64_tr_b16 v[94:95],v57 offset:3072
v_mfma_f32_16x16x32_bf16 a[232:235],v[112:115],a[112:115],a[232:235]
buffer_load_dwordx4 v5,s[8:11],s41 offen offset:1024 nt lds
v_mfma_f32_16x16x32_bf16 a[232:235],v[116:119],a[116:119],a[232:235]
v_mfma_f32_16x16x32_bf16 a[236:239],v[112:115],a[120:123],a[236:239]
v_mfma_f32_16x16x32_bf16 a[236:239],v[116:119],a[124:127],a[236:239]
s_add_u32 m0,s39,32768
v_mfma_f32_16x16x32_bf16 a[240:243],v[120:123],a[96:99],a[240:243]
ds_read_b64_tr_b16 v[96:97],v58 offset:0
s_mov_b32 s41,32768
v_mfma_f32_16x16x32_bf16 a[240:243],v[124:127],a[100:103],a[240:243]
ds_read_b64_tr_b16 v[98:99],v58 offset:1024
v_mfma_f32_16x16x32_bf16 a[244:247],v[120:123],a[104:107],a[244:247]
ds_read_b64_tr_b16 v[100:101],v58 offset:2048
v_mfma_f32_16x16x32_bf16 a[244:247],v[124:127],a[108:111],a[244:247]
ds_read_b64_tr_b16 v[102:103],v58 offset:3072
v_mfma_f32_16x16x32_bf16 a[248:251],v[120:123],a[112:115],a[248:251]
buffer_load_dwordx4 v6,s[8:11],s41 offen offset:2048 nt lds
v_mfma_f32_16x16x32_bf16 a[248:251],v[124:127],a[116:119],a[248:251]
v_mfma_f32_16x16x32_bf16 a[252:255],v[120:123],a[120:123],a[252:255]
s_add_u32 m0,s39,32768
v_mfma_f32_16x16x32_bf16 a[252:255],v[124:127],a[124:127],a[252:255]
s_mov_b32 s41,32768
s_waitcnt lgkmcnt(4)
v_mfma_f32_16x16x32_bf16 v[128:131],v[80:83],a[96:99],v[128:131]
ds_read_b64_tr_b16 v[104:105],v59 offset:0
v_mfma_f32_16x16x32_bf16 v[128:131],v[84:87],a[100:103],v[128:131]
ds_read_b64_tr_b16 v[106:107],v59 offset:1024
v_mfma_f32_16x16x32_bf16 v[160:163],v[80:83],a[104:107],v[160:163]
ds_read_b64_tr_b16 v[108:109],v59 offset:2048
v_mfma_f32_16x16x32_bf16 v[160:163],v[84:87],a[108:111],v[160:163]
ds_read_b64_tr_b16 v[110:111],v59 offset:3072
v_mfma_f32_16x16x32_bf16 v[192:195],v[80:83],a[112:115],v[192:195]
buffer_load_dwordx4 v7,s[8:11],s41 offen offset:3072 nt lds
v_mfma_f32_16x16x32_bf16 v[192:195],v[84:87],a[116:119],v[192:195]
v_mfma_f32_16x16x32_bf16 v[224:227],v[80:83],a[120:123],v[224:227]
v_mfma_f32_16x16x32_bf16 v[224:227],v[84:87],a[124:127],v[224:227]
v_mfma_f32_16x16x32_bf16 v[132:135],v[88:91],a[96:99],v[132:135]
ds_read_b64_tr_b16 v[112:113],v60 offset:0
v_mfma_f32_16x16x32_bf16 v[132:135],v[92:95],a[100:103],v[132:135]
ds_read_b64_tr_b16 v[114:115],v60 offset:1024
v_mfma_f32_16x16x32_bf16 v[164:167],v[88:91],a[104:107],v[164:167]
ds_read_b64_tr_b16 v[116:117],v60 offset:2048
v_mfma_f32_16x16x32_bf16 v[164:167],v[92:95],a[108:111],v[164:167]
ds_read_b64_tr_b16 v[118:119],v60 offset:3072
v_mfma_f32_16x16x32_bf16 v[196:199],v[88:91],a[112:115],v[196:199]
v_mfma_f32_16x16x32_bf16 v[196:199],v[92:95],a[116:119],v[196:199]
v_mfma_f32_16x16x32_bf16 v[228:231],v[88:91],a[120:123],v[228:231]
v_mfma_f32_16x16x32_bf16 v[228:231],v[92:95],a[124:127],v[228:231]
s_waitcnt lgkmcnt(4)
v_mfma_f32_16x16x32_bf16 v[136:139],v[96:99],a[96:99],v[136:139]
ds_read_b64_tr_b16 v[120:121],v61 offset:0
v_mfma_f32_16x16x32_bf16 v[136:139],v[100:103],a[100:103],v[136:139]
ds_read_b64_tr_b16 v[122:123],v61 offset:1024
v_mfma_f32_16x16x32_bf16 v[168:171],v[96:99],a[104:107],v[168:171]
ds_read_b64_tr_b16 v[124:125],v61 offset:2048
v_mfma_f32_16x16x32_bf16 v[168:171],v[100:103],a[108:111],v[168:171]
ds_read_b64_tr_b16 v[126:127],v61 offset:3072
v_mfma_f32_16x16x32_bf16 v[200:203],v[96:99],a[112:115],v[200:203]
v_mfma_f32_16x16x32_bf16 v[200:203],v[100:103],a[116:119],v[200:203]
v_mfma_f32_16x16x32_bf16 v[232:235],v[96:99],a[120:123],v[232:235]
v_mfma_f32_16x16x32_bf16 v[232:235],v[100:103],a[124:127],v[232:235]
v_mfma_f32_16x16x32_bf16 v[140:143],v[104:107],a[96:99],v[140:143]
ds_read_b64_tr_b16 v[80:81],v62 offset:0
v_mfma_f32_16x16x32_bf16 v[140:143],v[108:111],a[100:103],v[140:143]
ds_read_b64_tr_b16 v[82:83],v62 offset:1024
v_mfma_f32_16x16x32_bf16 v[172:175],v[104:107],a[104:107],v[172:175]
ds_read_b64_tr_b16 v[84:85],v62 offset:2048
v_mfma_f32_16x16x32_bf16 v[172:175],v[108:111],a[108:111],v[172:175]
ds_read_b64_tr_b16 v[86:87],v62 offset:3072
s_waitcnt vmcnt(17)
v_mfma_f32_16x16x32_bf16 v[204:207],v[104:107],a[112:115],v[204:207]
ds_read_b128 a[64:67],v39 offset:0
ds_read_b128 a[68:71],v40 offset:0
v_mfma_f32_16x16x32_bf16 v[204:207],v[108:111],a[116:119],v[204:207]
v_mfma_f32_16x16x32_bf16 v[236:239],v[104:107],a[120:123],v[236:239]
v_mfma_f32_16x16x32_bf16 v[236:239],v[108:111],a[124:127],v[236:239]
s_waitcnt lgkmcnt(6)
v_mfma_f32_16x16x32_bf16 v[144:147],v[112:115],a[96:99],v[144:147]
ds_read_b64_tr_b16 v[88:89],v63 offset:0
v_mfma_f32_16x16x32_bf16 v[144:147],v[116:119],a[100:103],v[144:147]
ds_read_b64_tr_b16 v[90:91],v63 offset:1024
v_mfma_f32_16x16x32_bf16 v[176:179],v[112:115],a[104:107],v[176:179]
ds_read_b64_tr_b16 v[92:93],v63 offset:2048
v_mfma_f32_16x16x32_bf16 v[176:179],v[116:119],a[108:111],v[176:179]
ds_read_b64_tr_b16 v[94:95],v63 offset:3072
v_mfma_f32_16x16x32_bf16 v[208:211],v[112:115],a[112:115],v[208:211]
s_waitcnt vmcnt(13)
v_mfma_f32_16x16x32_bf16 v[208:211],v[116:119],a[116:119],v[208:211]
ds_read_b128 a[72:75],v39 offset:2048
ds_read_b128 a[76:79],v40 offset:2048
v_mfma_f32_16x16x32_bf16 v[240:243],v[112:115],a[120:123],v[240:243]
v_mfma_f32_16x16x32_bf16 v[240:243],v[116:119],a[124:127],v[240:243]
s_waitcnt lgkmcnt(0)
s_barrier
v_mfma_f32_16x16x32_bf16 v[148:151],v[120:123],a[96:99],v[148:151]
ds_read_b64_tr_b16 v[96:97],v48 offset:16384
s_add_u32 m0,s39,98304
v_mfma_f32_16x16x32_bf16 v[148:151],v[124:127],a[100:103],v[148:151]
ds_read_b64_tr_b16 v[98:99],v48 offset:17408
s_mov_b32 s41,32768
v_mfma_f32_16x16x32_bf16 v[180:183],v[120:123],a[104:107],v[180:183]
ds_read_b64_tr_b16 v[100:101],v48 offset:18432
v_mfma_f32_16x16x32_bf16 v[180:183],v[124:127],a[108:111],v[180:183]
ds_read_b64_tr_b16 v[102:103],v48 offset:19456
v_mfma_f32_16x16x32_bf16 v[212:215],v[120:123],a[112:115],v[212:215]
buffer_load_dwordx4 v8,s[12:15],s41 offen nt lds
v_mfma_f32_16x16x32_bf16 v[212:215],v[124:127],a[116:119],v[212:215]
s_waitcnt vmcnt(11)
v_mfma_f32_16x16x32_bf16 v[244:247],v[120:123],a[120:123],v[244:247]
ds_read_b128 a[80:83],v39 offset:4096
ds_read_b128 a[84:87],v40 offset:4096
v_mfma_f32_16x16x32_bf16 v[244:247],v[124:127],a[124:127],v[244:247]
s_add_u32 m0,s39,98304
v_mfma_f32_16x16x32_bf16 v[152:155],v[80:83],a[96:99],v[152:155]
ds_read_b64_tr_b16 v[104:105],v49 offset:16384
s_mov_b32 s41,32768
v_mfma_f32_16x16x32_bf16 v[152:155],v[84:87],a[100:103],v[152:155]
ds_read_b64_tr_b16 v[106:107],v49 offset:17408
v_mfma_f32_16x16x32_bf16 v[184:187],v[80:83],a[104:107],v[184:187]
ds_read_b64_tr_b16 v[108:109],v49 offset:18432
v_mfma_f32_16x16x32_bf16 v[184:187],v[84:87],a[108:111],v[184:187]
ds_read_b64_tr_b16 v[110:111],v49 offset:19456
v_mfma_f32_16x16x32_bf16 v[216:219],v[80:83],a[112:115],v[216:219]
buffer_load_dwordx4 v9,s[12:15],s41 offen offset:1024 nt lds
v_mfma_f32_16x16x32_bf16 v[216:219],v[84:87],a[116:119],v[216:219]
v_mfma_f32_16x16x32_bf16 v[248:251],v[80:83],a[120:123],v[248:251]
s_waitcnt vmcnt(8)
v_mfma_f32_16x16x32_bf16 v[248:251],v[84:87],a[124:127],v[248:251]
ds_read_b128 a[88:91],v39 offset:6144
ds_read_b128 a[92:95],v40 offset:6144
v_mfma_f32_16x16x32_bf16 v[156:159],v[88:91],a[96:99],v[156:159]
ds_read_b64_tr_b16 v[112:113],v50 offset:16384
s_add_u32 m0,s39,98304
v_mfma_f32_16x16x32_bf16 v[156:159],v[92:95],a[100:103],v[156:159]
ds_read_b64_tr_b16 v[114:115],v50 offset:17408
s_mov_b32 s41,32768
v_mfma_f32_16x16x32_bf16 v[188:191],v[88:91],a[104:107],v[188:191]
ds_read_b64_tr_b16 v[116:117],v50 offset:18432
v_mfma_f32_16x16x32_bf16 v[188:191],v[92:95],a[108:111],v[188:191]
ds_read_b64_tr_b16 v[118:119],v50 offset:19456
v_mfma_f32_16x16x32_bf16 v[220:223],v[88:91],a[112:115],v[220:223]
buffer_load_dwordx4 v8,s[12:15],s41 offen offset:2048 nt lds
v_mfma_f32_16x16x32_bf16 v[220:223],v[92:95],a[116:119],v[220:223]
v_mfma_f32_16x16x32_bf16 v[252:255],v[88:91],a[120:123],v[252:255]
s_add_u32 m0,s39,98304
v_mfma_f32_16x16x32_bf16 v[252:255],v[92:95],a[124:127],v[252:255]
s_mov_b32 s41,32768
s_waitcnt lgkmcnt(3)
v_mfma_f32_16x16x32_bf16 a[128:131],v[96:99],a[64:67],a[128:131]
ds_read_b64_tr_b16 v[120:121],v51 offset:16384
v_mfma_f32_16x16x32_bf16 a[128:131],v[100:103],a[68:71],a[128:131]
ds_read_b64_tr_b16 v[122:123],v51 offset:17408
v_mfma_f32_16x16x32_bf16 a[132:135],v[96:99],a[72:75],a[132:135]
ds_read_b64_tr_b16 v[124:125],v51 offset:18432
v_mfma_f32_16x16x32_bf16 a[132:135],v[100:103],a[76:79],a[132:135]
ds_read_b64_tr_b16 v[126:127],v51 offset:19456
v_mfma_f32_16x16x32_bf16 a[136:139],v[96:99],a[80:83],a[136:139]
buffer_load_dwordx4 v9,s[12:15],s41 offen offset:3072 nt lds
v_mfma_f32_16x16x32_bf16 a[136:139],v[100:103],a[84:87],a[136:139]
v_mfma_f32_16x16x32_bf16 a[140:143],v[96:99],a[88:91],a[140:143]
v_mfma_f32_16x16x32_bf16 a[140:143],v[100:103],a[92:95],a[140:143]
v_mfma_f32_16x16x32_bf16 a[144:147],v[104:107],a[64:67],a[144:147]
ds_read_b64_tr_b16 v[80:81],v52 offset:16384
v_mfma_f32_16x16x32_bf16 a[144:147],v[108:111],a[68:71],a[144:147]
ds_read_b64_tr_b16 v[82:83],v52 offset:17408
v_mfma_f32_16x16x32_bf16 a[148:151],v[104:107],a[72:75],a[148:151]
ds_read_b64_tr_b16 v[84:85],v52 offset:18432
v_mfma_f32_16x16x32_bf16 a[148:151],v[108:111],a[76:79],a[148:151]
ds_read_b64_tr_b16 v[86:87],v52 offset:19456
v_mfma_f32_16x16x32_bf16 a[152:155],v[104:107],a[80:83],a[152:155]
v_mfma_f32_16x16x32_bf16 a[152:155],v[108:111],a[84:87],a[152:155]
v_mfma_f32_16x16x32_bf16 a[156:159],v[104:107],a[88:91],a[156:159]
v_mfma_f32_16x16x32_bf16 a[156:159],v[108:111],a[92:95],a[156:159]
s_waitcnt lgkmcnt(4)
v_mfma_f32_16x16x32_bf16 a[160:163],v[112:115],a[64:67],a[160:163]
ds_read_b64_tr_b16 v[88:89],v53 offset:16384
v_mfma_f32_16x16x32_bf16 a[160:163],v[116:119],a[68:71],a[160:163]
ds_read_b64_tr_b16 v[90:91],v53 offset:17408
v_mfma_f32_16x16x32_bf16 a[164:167],v[112:115],a[72:75],a[164:167]
ds_read_b64_tr_b16 v[92:93],v53 offset:18432
v_mfma_f32_16x16x32_bf16 a[164:167],v[116:119],a[76:79],a[164:167]
ds_read_b64_tr_b16 v[94:95],v53 offset:19456
v_mfma_f32_16x16x32_bf16 a[168:171],v[112:115],a[80:83],a[168:171]
v_mfma_f32_16x16x32_bf16 a[168:171],v[116:119],a[84:87],a[168:171]
v_accvgpr_read_b32 v64,a128
v_accvgpr_read_b32 v65,a129
v_accvgpr_read_b32 v66,a130
v_accvgpr_read_b32 v67,a131
v_mfma_f32_16x16x32_bf16 a[172:175],v[112:115],a[88:91],a[172:175]
v_accvgpr_read_b32 v68,a144
v_accvgpr_read_b32 v69,a145
v_accvgpr_read_b32 v70,a146
v_accvgpr_read_b32 v71,a147
v_mfma_f32_16x16x32_bf16 a[172:175],v[116:119],a[92:95],a[172:175]
v_accvgpr_read_b32 v72,a132
v_accvgpr_read_b32 v73,a133
v_accvgpr_read_b32 v74,a134
v_accvgpr_read_b32 v75,a135
v_mfma_f32_16x16x32_bf16 a[176:179],v[120:123],a[64:67],a[176:179]
ds_read_b64_tr_b16 v[96:97],v54 offset:16384
v_accvgpr_read_b32 v76,a148
v_accvgpr_read_b32 v77,a149
v_accvgpr_read_b32 v78,a150
v_mfma_f32_16x16x32_bf16 a[176:179],v[124:127],a[68:71],a[176:179]
ds_read_b64_tr_b16 v[98:99],v54 offset:17408
v_accvgpr_read_b32 v79,a151
v_mul_f32 v64,s42,v64
v_mul_f32 v65,s42,v65
v_mfma_f32_16x16x32_bf16 a[180:183],v[120:123],a[72:75],a[180:183]
ds_read_b64_tr_b16 v[100:101],v54 offset:18432
v_mul_f32 v66,s42,v66
v_mul_f32 v67,s42,v67
v_mul_f32 v68,s42,v68
v_mfma_f32_16x16x32_bf16 a[180:183],v[124:127],a[76:79],a[180:183]
ds_read_b64_tr_b16 v[102:103],v54 offset:19456
v_mul_f32 v69,s42,v69
v_mul_f32 v70,s42,v70
v_mul_f32 v71,s42,v71
v_mfma_f32_16x16x32_bf16 a[184:187],v[120:123],a[80:83],a[184:187]
v_mul_f32 v72,s42,v72
v_mul_f32 v73,s42,v73
v_mul_f32 v74,s42,v74
v_mul_f32 v75,s42,v75
v_mfma_f32_16x16x32_bf16 a[184:187],v[124:127],a[84:87],a[184:187]
v_mul_f32 v76,s42,v76
v_mul_f32 v77,s42,v77
v_mul_f32 v78,s42,v78
v_mul_f32 v79,s42,v79
v_mfma_f32_16x16x32_bf16 a[188:191],v[120:123],a[88:91],a[188:191]
v_cvt_pk_bf16_f32 v64,v64,v65
v_cvt_pk_bf16_f32 v65,v66,v67
v_cvt_pk_bf16_f32 v66,v68,v69
v_cvt_pk_bf16_f32 v67,v70,v71
v_mfma_f32_16x16x32_bf16 a[188:191],v[124:127],a[92:95],a[188:191]
v_cvt_pk_bf16_f32 v72,v72,v73
v_cvt_pk_bf16_f32 v73,v74,v75
v_cvt_pk_bf16_f32 v74,v76,v77
v_cvt_pk_bf16_f32 v75,v78,v79
s_waitcnt lgkmcnt(0)
v_mfma_f32_16x16x32_bf16 a[192:195],v[80:83],a[64:67],a[192:195]
ds_read_b64_tr_b16 v[104:105],v55 offset:16384
v_permlane16_swap_b32 v64,v66
v_permlane16_swap_b32 v65,v67
v_permlane16_swap_b32 v72,v74
v_mfma_f32_16x16x32_bf16 a[192:195],v[84:87],a[68:71],a[192:195]
ds_read_b64_tr_b16 v[106:107],v55 offset:17408
v_permlane16_swap_b32 v73,v75
v_accvgpr_write_b32 a0,v64
v_accvgpr_write_b32 a1,v65
v_mfma_f32_16x16x32_bf16 a[196:199],v[80:83],a[72:75],a[196:199]
ds_read_b64_tr_b16 v[108:109],v55 offset:18432
v_accvgpr_write_b32 a2,v66
v_accvgpr_write_b32 a3,v67
v_accvgpr_write_b32 a16,v72
v_mfma_f32_16x16x32_bf16 a[196:199],v[84:87],a[76:79],a[196:199]
ds_read_b64_tr_b16 v[110:111],v55 offset:19456
v_accvgpr_write_b32 a17,v73
v_accvgpr_write_b32 a18,v74
v_accvgpr_write_b32 a19,v75
v_mfma_f32_16x16x32_bf16 a[200:203],v[80:83],a[80:83],a[200:203]
v_accvgpr_read_b32 v64,a136
v_accvgpr_read_b32 v65,a137
v_accvgpr_read_b32 v66,a138
v_accvgpr_read_b32 v67,a139
v_mfma_f32_16x16x32_bf16 a[200:203],v[84:87],a[84:87],a[200:203]
v_accvgpr_read_b32 v68,a152
v_accvgpr_read_b32 v69,a153
v_accvgpr_read_b32 v70,a154
v_accvgpr_read_b32 v71,a155
v_mfma_f32_16x16x32_bf16 a[204:207],v[80:83],a[88:91],a[204:207]
s_waitcnt vmcnt(9)
v_accvgpr_read_b32 v72,a140
v_accvgpr_read_b32 v73,a141
v_accvgpr_read_b32 v74,a142
v_mfma_f32_16x16x32_bf16 a[204:207],v[84:87],a[92:95],a[204:207]
s_waitcnt lgkmcnt(0)
s_barrier
v_accvgpr_read_b32 v75,a143
v_accvgpr_read_b32 v76,a156
v_mfma_f32_16x16x32_bf16 a[208:211],v[88:91],a[64:67],a[208:211]
ds_read_b64_tr_b16 v[112:113],v56 offset:16384
s_add_u32 m0,s39,49152
v_accvgpr_read_b32 v77,a157
v_accvgpr_read_b32 v78,a158
v_mfma_f32_16x16x32_bf16 a[208:211],v[92:95],a[68:71],a[208:211]
ds_read_b64_tr_b16 v[114:115],v56 offset:17408
s_mov_b32 s41,49152
v_accvgpr_read_b32 v79,a159
v_mul_f32 v64,s42,v64
v_mfma_f32_16x16x32_bf16 a[212:215],v[88:91],a[72:75],a[212:215]
ds_read_b64_tr_b16 v[116:117],v56 offset:18432
v_mul_f32 v65,s42,v65
v_mul_f32 v66,s42,v66
v_mul_f32 v67,s42,v67
v_mfma_f32_16x16x32_bf16 a[212:215],v[92:95],a[76:79],a[212:215]
ds_read_b64_tr_b16 v[118:119],v56 offset:19456
v_mul_f32 v68,s42,v68
v_mul_f32 v69,s42,v69
v_mul_f32 v70,s42,v70
v_mfma_f32_16x16x32_bf16 a[216:219],v[88:91],a[80:83],a[216:219]
buffer_load_dwordx4 v4,s[8:11],s41 offen nt lds
v_mul_f32 v71,s42,v71
v_mul_f32 v72,s42,v72
v_mul_f32 v73,s42,v73
v_mfma_f32_16x16x32_bf16 a[216:219],v[92:95],a[84:87],a[216:219]
v_mul_f32 v74,s42,v74
v_mul_f32 v75,s42,v75
v_mul_f32 v76,s42,v76
v_mul_f32 v77,s42,v77
v_mfma_f32_16x16x32_bf16 a[220:223],v[88:91],a[88:91],a[220:223]
v_mul_f32 v78,s42,v78
v_mul_f32 v79,s42,v79
v_cvt_pk_bf16_f32 v64,v64,v65
v_cvt_pk_bf16_f32 v65,v66,v67
v_mfma_f32_16x16x32_bf16 a[220:223],v[92:95],a[92:95],a[220:223]
s_add_u32 m0,s39,49152
v_cvt_pk_bf16_f32 v66,v68,v69
v_cvt_pk_bf16_f32 v67,v70,v71
v_cvt_pk_bf16_f32 v72,v72,v73
v_mfma_f32_16x16x32_bf16 a[224:227],v[96:99],a[64:67],a[224:227]
ds_read_b64_tr_b16 v[120:121],v57 offset:16384
s_mov_b32 s41,49152
v_cvt_pk_bf16_f32 v73,v74,v75
v_cvt_pk_bf16_f32 v74,v76,v77
v_mfma_f32_16x16x32_bf16 a[224:227],v[100:103],a[68:71],a[224:227]
ds_read_b64_tr_b16 v[122:123],v57 offset:17408
v_cvt_pk_bf16_f32 v75,v78,v79
v_permlane16_swap_b32 v64,v66
v_permlane16_swap_b32 v65,v67
v_mfma_f32_16x16x32_bf16 a[228:231],v[96:99],a[72:75],a[228:231]
ds_read_b64_tr_b16 v[124:125],v57 offset:18432
v_permlane16_swap_b32 v72,v74
v_permlane16_swap_b32 v73,v75
v_accvgpr_write_b32 a32,v64
v_mfma_f32_16x16x32_bf16 a[228:231],v[100:103],a[76:79],a[228:231]
ds_read_b64_tr_b16 v[126:127],v57 offset:19456
v_accvgpr_write_b32 a33,v65
v_accvgpr_write_b32 a34,v66
v_accvgpr_write_b32 a35,v67
v_mfma_f32_16x16x32_bf16 a[232:235],v[96:99],a[80:83],a[232:235]
buffer_load_dwordx4 v5,s[8:11],s41 offen offset:1024 nt lds
v_accvgpr_write_b32 a48,v72
v_accvgpr_write_b32 a49,v73
v_accvgpr_write_b32 a50,v74
v_mfma_f32_16x16x32_bf16 a[232:235],v[100:103],a[84:87],a[232:235]
v_accvgpr_write_b32 a51,v75
v_accvgpr_read_b32 v64,a160
v_accvgpr_read_b32 v65,a161
v_accvgpr_read_b32 v66,a162
v_mfma_f32_16x16x32_bf16 a[236:239],v[96:99],a[88:91],a[236:239]
v_accvgpr_read_b32 v67,a163
v_accvgpr_read_b32 v68,a176
v_accvgpr_read_b32 v69,a177
v_accvgpr_read_b32 v70,a178
v_mfma_f32_16x16x32_bf16 a[236:239],v[100:103],a[92:95],a[236:239]
s_add_u32 m0,s39,49152
v_accvgpr_read_b32 v71,a179
v_accvgpr_read_b32 v72,a164
v_accvgpr_read_b32 v73,a165
v_mfma_f32_16x16x32_bf16 a[240:243],v[104:107],a[64:67],a[240:243]
ds_read_b64_tr_b16 v[80:81],v58 offset:16384
s_mov_b32 s41,49152
v_accvgpr_read_b32 v74,a166
v_accvgpr_read_b32 v75,a167
v_mfma_f32_16x16x32_bf16 a[240:243],v[108:111],a[68:71],a[240:243]
ds_read_b64_tr_b16 v[82:83],v58 offset:17408
v_accvgpr_read_b32 v76,a180
v_accvgpr_read_b32 v77,a181
v_accvgpr_read_b32 v78,a182
v_mfma_f32_16x16x32_bf16 a[244:247],v[104:107],a[72:75],a[244:247]
ds_read_b64_tr_b16 v[84:85],v58 offset:18432
v_accvgpr_read_b32 v79,a183
v_mul_f32 v64,s42,v64
v_mul_f32 v65,s42,v65
v_mfma_f32_16x16x32_bf16 a[244:247],v[108:111],a[76:79],a[244:247]
ds_read_b64_tr_b16 v[86:87],v58 offset:19456
v_mul_f32 v66,s42,v66
v_mul_f32 v67,s42,v67
v_mul_f32 v68,s42,v68
v_mfma_f32_16x16x32_bf16 a[248:251],v[104:107],a[80:83],a[248:251]
buffer_load_dwordx4 v6,s[8:11],s41 offen offset:2048 nt lds
v_mul_f32 v69,s42,v69
v_mul_f32 v70,s42,v70
v_mul_f32 v71,s42,v71
v_mfma_f32_16x16x32_bf16 a[248:251],v[108:111],a[84:87],a[248:251]
v_mul_f32 v72,s42,v72
v_mul_f32 v73,s42,v73
v_mul_f32 v74,s42,v74
v_mul_f32 v75,s42,v75
v_mfma_f32_16x16x32_bf16 a[252:255],v[104:107],a[88:91],a[252:255]
s_add_u32 m0,s39,49152
v_mul_f32 v76,s42,v76
v_mul_f32 v77,s42,v77
v_mul_f32 v78,s42,v78
v_mfma_f32_16x16x32_bf16 a[252:255],v[108:111],a[92:95],a[252:255]
s_mov_b32 s41,49152
v_mul_f32 v79,s42,v79
v_cvt_pk_bf16_f32 v64,v64,v65
v_cvt_pk_bf16_f32 v65,v66,v67
s_waitcnt lgkmcnt(0)
v_mfma_f32_16x16x32_bf16 v[128:131],v[112:115],a[64:67],v[128:131]
ds_read_b64_tr_b16 v[88:89],v59 offset:16384
v_cvt_pk_bf16_f32 v66,v68,v69
v_cvt_pk_bf16_f32 v67,v70,v71
v_cvt_pk_bf16_f32 v72,v72,v73
v_mfma_f32_16x16x32_bf16 v[128:131],v[116:119],a[68:71],v[128:131]
ds_read_b64_tr_b16 v[90:91],v59 offset:17408
v_cvt_pk_bf16_f32 v73,v74,v75
v_cvt_pk_bf16_f32 v74,v76,v77
v_cvt_pk_bf16_f32 v75,v78,v79
v_mfma_f32_16x16x32_bf16 v[160:163],v[112:115],a[72:75],v[160:163]
ds_read_b64_tr_b16 v[92:93],v59 offset:18432
v_permlane16_swap_b32 v64,v66
v_permlane16_swap_b32 v65,v67
v_permlane16_swap_b32 v72,v74
v_mfma_f32_16x16x32_bf16 v[160:163],v[116:119],a[76:79],v[160:163]
ds_read_b64_tr_b16 v[94:95],v59 offset:19456
v_permlane16_swap_b32 v73,v75
v_accvgpr_write_b32 a4,v64
v_accvgpr_write_b32 a5,v65
v_mfma_f32_16x16x32_bf16 v[192:195],v[112:115],a[80:83],v[192:195]
buffer_load_dwordx4 v7,s[8:11],s41 offen offset:3072 nt lds
v_accvgpr_write_b32 a6,v66
v_accvgpr_write_b32 a7,v67
v_accvgpr_write_b32 a20,v72
v_mfma_f32_16x16x32_bf16 v[192:195],v[116:119],a[84:87],v[192:195]
v_accvgpr_write_b32 a21,v73
v_accvgpr_write_b32 a22,v74
v_accvgpr_write_b32 a23,v75
v_accvgpr_read_b32 v64,a168
v_mfma_f32_16x16x32_bf16 v[224:227],v[112:115],a[88:91],v[224:227]
v_accvgpr_read_b32 v65,a169
v_accvgpr_read_b32 v66,a170
v_accvgpr_read_b32 v67,a171
v_accvgpr_read_b32 v68,a184
v_mfma_f32_16x16x32_bf16 v[224:227],v[116:119],a[92:95],v[224:227]
v_accvgpr_read_b32 v69,a185
v_accvgpr_read_b32 v70,a186
v_accvgpr_read_b32 v71,a187
v_accvgpr_read_b32 v72,a172
v_mfma_f32_16x16x32_bf16 v[132:135],v[120:123],a[64:67],v[132:135]
ds_read_b64_tr_b16 v[96:97],v60 offset:16384
v_accvgpr_read_b32 v73,a173
v_accvgpr_read_b32 v74,a174
v_accvgpr_read_b32 v75,a175
v_mfma_f32_16x16x32_bf16 v[132:135],v[124:127],a[68:71],v[132:135]
ds_read_b64_tr_b16 v[98:99],v60 offset:17408
v_accvgpr_read_b32 v76,a188
v_accvgpr_read_b32 v77,a189
v_accvgpr_read_b32 v78,a190
v_mfma_f32_16x16x32_bf16 v[164:167],v[120:123],a[72:75],v[164:167]
ds_read_b64_tr_b16 v[100:101],v60 offset:18432
v_accvgpr_read_b32 v79,a191
v_mul_f32 v64,s42,v64
v_mul_f32 v65,s42,v65
v_mfma_f32_16x16x32_bf16 v[164:167],v[124:127],a[76:79],v[164:167]
ds_read_b64_tr_b16 v[102:103],v60 offset:19456
v_mul_f32 v66,s42,v66
v_mul_f32 v67,s42,v67
v_mul_f32 v68,s42,v68
v_mfma_f32_16x16x32_bf16 v[196:199],v[120:123],a[80:83],v[196:199]
buffer_store_dword v27,v26,s[32:35],0 offen sc1
v_mul_f32 v69,s42,v69
v_mul_f32 v70,s42,v70
v_mul_f32 v71,s42,v71
v_mfma_f32_16x16x32_bf16 v[196:199],v[124:127],a[84:87],v[196:199]
buffer_store_dword v27,v25,s[32:35],s67 offen sc1
v_mul_f32 v72,s42,v72
v_mul_f32 v73,s42,v73
v_mul_f32 v74,s42,v74
v_mfma_f32_16x16x32_bf16 v[228:231],v[120:123],a[88:91],v[228:231]
v_mul_f32 v75,s42,v75
v_mul_f32 v76,s42,v76
v_mul_f32 v77,s42,v77
v_mul_f32 v78,s42,v78
v_mfma_f32_16x16x32_bf16 v[228:231],v[124:127],a[92:95],v[228:231]
v_mul_f32 v79,s42,v79
v_cvt_pk_bf16_f32 v64,v64,v65
v_cvt_pk_bf16_f32 v65,v66,v67
v_cvt_pk_bf16_f32 v66,v68,v69
v_mfma_f32_16x16x32_bf16 v[136:139],v[80:83],a[64:67],v[136:139]
ds_read_b64_tr_b16 v[104:105],v61 offset:16384
v_cvt_pk_bf16_f32 v67,v70,v71
v_cvt_pk_bf16_f32 v72,v72,v73
v_cvt_pk_bf16_f32 v73,v74,v75
v_mfma_f32_16x16x32_bf16 v[136:139],v[84:87],a[68:71],v[136:139]
ds_read_b64_tr_b16 v[106:107],v61 offset:17408
v_cvt_pk_bf16_f32 v74,v76,v77
v_cvt_pk_bf16_f32 v75,v78,v79
v_permlane16_swap_b32 v64,v66
v_mfma_f32_16x16x32_bf16 v[168:171],v[80:83],a[72:75],v[168:171]
ds_read_b64_tr_b16 v[108:109],v61 offset:18432
v_permlane16_swap_b32 v65,v67
v_permlane16_swap_b32 v72,v74
v_permlane16_swap_b32 v73,v75
v_mfma_f32_16x16x32_bf16 v[168:171],v[84:87],a[76:79],v[168:171]
ds_read_b64_tr_b16 v[110:111],v61 offset:19456
v_accvgpr_write_b32 a36,v64
v_accvgpr_write_b32 a37,v65
v_accvgpr_write_b32 a38,v66
v_mfma_f32_16x16x32_bf16 v[200:203],v[80:83],a[80:83],v[200:203]
v_accvgpr_write_b32 a39,v67
v_accvgpr_write_b32 a52,v72
v_accvgpr_write_b32 a53,v73
v_accvgpr_write_b32 a54,v74
v_mfma_f32_16x16x32_bf16 v[200:203],v[84:87],a[84:87],v[200:203]
v_accvgpr_write_b32 a55,v75
v_accvgpr_read_b32 v64,a192
v_accvgpr_read_b32 v65,a193
v_accvgpr_read_b32 v66,a194
v_mfma_f32_16x16x32_bf16 v[232:235],v[80:83],a[88:91],v[232:235]
v_accvgpr_read_b32 v67,a195
v_accvgpr_read_b32 v68,a208
v_accvgpr_read_b32 v69,a209
v_accvgpr_read_b32 v70,a210
v_mfma_f32_16x16x32_bf16 v[232:235],v[84:87],a[92:95],v[232:235]
v_accvgpr_read_b32 v71,a211
v_accvgpr_read_b32 v72,a196
v_accvgpr_read_b32 v73,a197
v_accvgpr_read_b32 v74,a198
s_waitcnt lgkmcnt(0)
v_mfma_f32_16x16x32_bf16 v[140:143],v[88:91],a[64:67],v[140:143]
ds_read_b64_tr_b16 v[112:113],v62 offset:16384
v_accvgpr_read_b32 v75,a199
v_accvgpr_read_b32 v76,a212
v_accvgpr_read_b32 v77,a213
v_mfma_f32_16x16x32_bf16 v[140:143],v[92:95],a[68:71],v[140:143]
ds_read_b64_tr_b16 v[114:115],v62 offset:17408
v_accvgpr_read_b32 v78,a214
v_accvgpr_read_b32 v79,a215
v_mul_f32 v64,s42,v64
v_mfma_f32_16x16x32_bf16 v[172:175],v[88:91],a[72:75],v[172:175]
ds_read_b64_tr_b16 v[116:117],v62 offset:18432
v_mul_f32 v65,s42,v65
v_mul_f32 v66,s42,v66
v_mul_f32 v67,s42,v67
v_mfma_f32_16x16x32_bf16 v[172:175],v[92:95],a[76:79],v[172:175]
ds_read_b64_tr_b16 v[118:119],v62 offset:19456
v_mul_f32 v68,s42,v68
v_mul_f32 v69,s42,v69
v_mul_f32 v70,s42,v70
v_mfma_f32_16x16x32_bf16 v[204:207],v[88:91],a[80:83],v[204:207]
v_mul_f32 v71,s42,v71
v_mul_f32 v72,s42,v72
v_mul_f32 v73,s42,v73
v_mul_f32 v74,s42,v74
v_mfma_f32_16x16x32_bf16 v[204:207],v[92:95],a[84:87],v[204:207]
v_mul_f32 v75,s42,v75
v_mul_f32 v76,s42,v76
v_mul_f32 v77,s42,v77
v_mul_f32 v78,s42,v78
v_mfma_f32_16x16x32_bf16 v[236:239],v[88:91],a[88:91],v[236:239]
v_mul_f32 v79,s42,v79
v_cvt_pk_bf16_f32 v64,v64,v65
v_cvt_pk_bf16_f32 v65,v66,v67
v_cvt_pk_bf16_f32 v66,v68,v69
v_mfma_f32_16x16x32_bf16 v[236:239],v[92:95],a[92:95],v[236:239]
v_cvt_pk_bf16_f32 v67,v70,v71
v_cvt_pk_bf16_f32 v72,v72,v73
v_cvt_pk_bf16_f32 v73,v74,v75
v_cvt_pk_bf16_f32 v74,v76,v77
v_mfma_f32_16x16x32_bf16 v[144:147],v[96:99],a[64:67],v[144:147]
ds_read_b64_tr_b16 v[120:121],v63 offset:16384
v_cvt_pk_bf16_f32 v75,v78,v79
v_permlane16_swap_b32 v64,v66
v_permlane16_swap_b32 v65,v67
v_mfma_f32_16x16x32_bf16 v[144:147],v[100:103],a[68:71],v[144:147]
ds_read_b64_tr_b16 v[122:123],v63 offset:17408
v_permlane16_swap_b32 v72,v74
v_permlane16_swap_b32 v73,v75
v_accvgpr_write_b32 a8,v64
v_mfma_f32_16x16x32_bf16 v[176:179],v[96:99],a[72:75],v[176:179]
ds_read_b64_tr_b16 v[124:125],v63 offset:18432
v_accvgpr_write_b32 a9,v65
v_accvgpr_write_b32 a10,v66
v_accvgpr_write_b32 a11,v67
v_mfma_f32_16x16x32_bf16 v[176:179],v[100:103],a[76:79],v[176:179]
ds_read_b64_tr_b16 v[126:127],v63 offset:19456
v_accvgpr_write_b32 a24,v72
v_accvgpr_write_b32 a25,v73
v_accvgpr_write_b32 a26,v74
v_mfma_f32_16x16x32_bf16 v[208:211],v[96:99],a[80:83],v[208:211]
v_accvgpr_write_b32 a27,v75
v_accvgpr_read_b32 v64,a200
v_accvgpr_read_b32 v65,a201
v_accvgpr_read_b32 v66,a202
v_mfma_f32_16x16x32_bf16 v[208:211],v[100:103],a[84:87],v[208:211]
v_accvgpr_read_b32 v67,a203
v_accvgpr_read_b32 v68,a216
v_accvgpr_read_b32 v69,a217
v_accvgpr_read_b32 v70,a218
v_mfma_f32_16x16x32_bf16 v[240:243],v[96:99],a[88:91],v[240:243]
v_accvgpr_read_b32 v71,a219
v_accvgpr_read_b32 v72,a204
v_accvgpr_read_b32 v73,a205
v_accvgpr_read_b32 v74,a206
v_mfma_f32_16x16x32_bf16 v[240:243],v[100:103],a[92:95],v[240:243]
s_waitcnt lgkmcnt(0)
s_barrier
v_accvgpr_read_b32 v75,a207
v_accvgpr_read_b32 v76,a220
v_mfma_f32_16x16x32_bf16 v[148:151],v[104:107],a[64:67],v[148:151]
s_mov_b32 s48,49152
s_add_u32 m0,s39,114688
v_accvgpr_read_b32 v77,a221
v_accvgpr_read_b32 v78,a222
v_mfma_f32_16x16x32_bf16 v[148:151],v[108:111],a[68:71],v[148:151]
buffer_load_dwordx4 v8,s[12:15],s48 offen nt lds
v_accvgpr_read_b32 v79,a223
v_mul_f32 v64,s42,v64
v_mul_f32 v65,s42,v65
v_mfma_f32_16x16x32_bf16 v[180:183],v[104:107],a[72:75],v[180:183]
buffer_load_dwordx4 v9,s[12:15],s48 offen offset:1024 nt lds
v_mul_f32 v66,s42,v66
v_mul_f32 v67,s42,v67
v_mul_f32 v68,s42,v68
v_mfma_f32_16x16x32_bf16 v[180:183],v[108:111],a[76:79],v[180:183]
buffer_load_dwordx4 v8,s[12:15],s48 offen offset:2048 nt lds
v_mul_f32 v69,s42,v69
v_mul_f32 v70,s42,v70
v_mul_f32 v71,s42,v71
v_mfma_f32_16x16x32_bf16 v[212:215],v[104:107],a[80:83],v[212:215]
buffer_load_dwordx4 v9,s[12:15],s48 offen offset:3072 nt lds
v_mul_f32 v72,s42,v72
v_mul_f32 v73,s42,v73
v_mul_f32 v74,s42,v74
v_mfma_f32_16x16x32_bf16 v[212:215],v[108:111],a[84:87],v[212:215]
v_mul_f32 v75,s42,v75
v_mul_f32 v76,s42,v76
v_mul_f32 v77,s42,v77
v_mul_f32 v78,s42,v78
v_mfma_f32_16x16x32_bf16 v[244:247],v[104:107],a[88:91],v[244:247]
v_mul_f32 v79,s42,v79
v_cvt_pk_bf16_f32 v64,v64,v65
v_cvt_pk_bf16_f32 v65,v66,v67
v_cvt_pk_bf16_f32 v66,v68,v69
v_mfma_f32_16x16x32_bf16 v[244:247],v[108:111],a[92:95],v[244:247]
v_cvt_pk_bf16_f32 v67,v70,v71
v_cvt_pk_bf16_f32 v72,v72,v73
v_cvt_pk_bf16_f32 v73,v74,v75
v_cvt_pk_bf16_f32 v74,v76,v77
v_mfma_f32_16x16x32_bf16 v[152:155],v[112:115],a[64:67],v[152:155]
v_cvt_pk_bf16_f32 v75,v78,v79
v_permlane16_swap_b32 v64,v66
v_permlane16_swap_b32 v65,v67
v_permlane16_swap_b32 v72,v74
v_mfma_f32_16x16x32_bf16 v[152:155],v[116:119],a[68:71],v[152:155]
v_permlane16_swap_b32 v73,v75
v_accvgpr_write_b32 a40,v64
v_accvgpr_write_b32 a41,v65
v_accvgpr_write_b32 a42,v66
v_mfma_f32_16x16x32_bf16 v[184:187],v[112:115],a[72:75],v[184:187]
v_accvgpr_write_b32 a43,v67
v_accvgpr_write_b32 a56,v72
v_accvgpr_write_b32 a57,v73
v_accvgpr_write_b32 a58,v74
v_mfma_f32_16x16x32_bf16 v[184:187],v[116:119],a[76:79],v[184:187]
v_accvgpr_write_b32 a59,v75
v_accvgpr_read_b32 v64,a224
v_accvgpr_read_b32 v65,a225
v_accvgpr_read_b32 v66,a226
v_mfma_f32_16x16x32_bf16 v[216:219],v[112:115],a[80:83],v[216:219]
s_mov_b32 s41,0
v_accvgpr_read_b32 v67,a227
v_accvgpr_read_b32 v68,a240
v_accvgpr_read_b32 v69,a241
v_mfma_f32_16x16x32_bf16 v[216:219],v[116:119],a[84:87],v[216:219]
buffer_load_dword v22,v29,s[24:27],s41 offen
v_accvgpr_read_b32 v70,a242
v_accvgpr_read_b32 v71,a243
v_accvgpr_read_b32 v72,a228
v_mfma_f32_16x16x32_bf16 v[248:251],v[112:115],a[88:91],v[248:251]
s_mov_b32 s41,2304
v_accvgpr_read_b32 v73,a229
v_accvgpr_read_b32 v74,a230
v_accvgpr_read_b32 v75,a231
v_mfma_f32_16x16x32_bf16 v[248:251],v[116:119],a[92:95],v[248:251]
buffer_load_dword v22,v29,s[24:27],s41 offen
v_accvgpr_read_b32 v76,a244
v_accvgpr_read_b32 v77,a245
v_accvgpr_read_b32 v78,a246
v_mfma_f32_16x16x32_bf16 v[156:159],v[120:123],a[64:67],v[156:159]
s_mov_b32 s41,4608
v_accvgpr_read_b32 v79,a247
v_mul_f32 v64,s42,v64
v_mul_f32 v65,s42,v65
v_mfma_f32_16x16x32_bf16 v[156:159],v[124:127],a[68:71],v[156:159]
buffer_load_dword v22,v29,s[24:27],s41 offen
v_mul_f32 v66,s42,v66
v_mul_f32 v67,s42,v67
v_mul_f32 v68,s42,v68
v_mfma_f32_16x16x32_bf16 v[188:191],v[120:123],a[72:75],v[188:191]
s_mov_b32 s41,6912
v_mul_f32 v69,s42,v69
v_mul_f32 v70,s42,v70
v_mul_f32 v71,s42,v71
v_mfma_f32_16x16x32_bf16 v[188:191],v[124:127],a[76:79],v[188:191]
buffer_load_dword v22,v29,s[24:27],s41 offen
v_mul_f32 v72,s42,v72
v_mul_f32 v73,s42,v73
v_mul_f32 v74,s42,v74
v_mfma_f32_16x16x32_bf16 v[220:223],v[120:123],a[80:83],v[220:223]
v_mul_f32 v75,s42,v75
v_mul_f32 v76,s42,v76
v_mul_f32 v77,s42,v77
v_mul_f32 v78,s42,v78
v_mfma_f32_16x16x32_bf16 v[220:223],v[124:127],a[84:87],v[220:223]
v_mul_f32 v79,s42,v79
v_cvt_pk_bf16_f32 v64,v64,v65
v_cvt_pk_bf16_f32 v65,v66,v67
v_cvt_pk_bf16_f32 v66,v68,v69
v_mfma_f32_16x16x32_bf16 v[252:255],v[120:123],a[88:91],v[252:255]
v_cvt_pk_bf16_f32 v67,v70,v71
v_cvt_pk_bf16_f32 v72,v72,v73
v_cvt_pk_bf16_f32 v73,v74,v75
v_cvt_pk_bf16_f32 v74,v76,v77
v_mfma_f32_16x16x32_bf16 v[252:255],v[124:127],a[92:95],v[252:255]
v_cvt_pk_bf16_f32 v75,v78,v79
v_permlane16_swap_b32 v64,v66
v_permlane16_swap_b32 v65,v67
v_permlane16_swap_b32 v72,v74
v_permlane16_swap_b32 v73,v75
v_accvgpr_write_b32 a12,v64
v_accvgpr_write_b32 a13,v65
v_accvgpr_write_b32 a14,v66
v_accvgpr_write_b32 a15,v67
v_accvgpr_write_b32 a28,v72
v_accvgpr_write_b32 a29,v73
v_accvgpr_write_b32 a30,v74
v_accvgpr_write_b32 a31,v75
v_accvgpr_read_b32 v64,a232
v_accvgpr_read_b32 v65,a233
v_accvgpr_read_b32 v66,a234
v_accvgpr_read_b32 v67,a235
v_accvgpr_read_b32 v68,a248
v_accvgpr_read_b32 v69,a249
v_accvgpr_read_b32 v70,a250
v_accvgpr_read_b32 v71,a251
v_accvgpr_read_b32 v72,a236
v_accvgpr_read_b32 v73,a237
v_accvgpr_read_b32 v74,a238
v_accvgpr_read_b32 v75,a239
v_accvgpr_read_b32 v76,a252
v_accvgpr_read_b32 v77,a253
v_accvgpr_read_b32 v78,a254
v_accvgpr_read_b32 v79,a255
v_mul_f32 v64,s42,v64
v_mul_f32 v65,s42,v65
v_mul_f32 v66,s42,v66
v_mul_f32 v67,s42,v67
v_mul_f32 v68,s42,v68
v_mul_f32 v69,s42,v69
v_mul_f32 v70,s42,v70
v_mul_f32 v71,s42,v71
v_mul_f32 v72,s42,v72
v_mul_f32 v73,s42,v73
v_mul_f32 v74,s42,v74
v_mul_f32 v75,s42,v75
v_mul_f32 v76,s42,v76
v_mul_f32 v77,s42,v77
v_mul_f32 v78,s42,v78
v_mul_f32 v79,s42,v79
v_cvt_pk_bf16_f32 v64,v64,v65
v_cvt_pk_bf16_f32 v65,v66,v67
v_cvt_pk_bf16_f32 v66,v68,v69
v_cvt_pk_bf16_f32 v67,v70,v71
v_cvt_pk_bf16_f32 v72,v72,v73
v_cvt_pk_bf16_f32 v73,v74,v75
v_cvt_pk_bf16_f32 v74,v76,v77
v_cvt_pk_bf16_f32 v75,v78,v79
v_permlane16_swap_b32 v64,v66
v_permlane16_swap_b32 v65,v67
v_permlane16_swap_b32 v72,v74
v_permlane16_swap_b32 v73,v75
v_accvgpr_write_b32 a44,v64
v_accvgpr_write_b32 a45,v65
v_accvgpr_write_b32 a46,v66
v_accvgpr_write_b32 a47,v67
v_accvgpr_write_b32 a60,v72
v_accvgpr_write_b32 a61,v73
v_accvgpr_write_b32 a62,v74
v_accvgpr_write_b32 a63,v75
ds_read_b128 a[128:131],v10 offset:0
ds_read_b128 a[132:135],v11 offset:0
ds_read_b128 a[136:139],v12 offset:0
ds_read_b128 a[140:143],v13 offset:0
ds_read_b128 a[144:147],v10 offset:4096
ds_read_b128 a[148:151],v11 offset:4096
ds_read_b128 a[152:155],v12 offset:4096
ds_read_b128 a[156:159],v13 offset:4096
ds_read_b128 a[160:163],v10 offset:8192
ds_read_b128 a[164:167],v11 offset:8192
ds_read_b128 a[168:171],v12 offset:8192
ds_read_b128 a[172:175],v13 offset:8192
ds_read_b128 a[176:179],v10 offset:12288
ds_read_b128 a[180:183],v11 offset:12288
ds_read_b128 a[184:187],v12 offset:12288
ds_read_b128 a[188:191],v13 offset:12288
s_nop 1
v_pk_mul_f32 v[128:129],v[128:129],s[42:43]
v_pk_mul_f32 v[130:131],v[130:131],s[42:43]
v_pk_mul_f32 v[132:133],v[132:133],s[42:43]
v_pk_mul_f32 v[134:135],v[134:135],s[42:43]
v_pk_mul_f32 v[136:137],v[136:137],s[42:43]
v_pk_mul_f32 v[138:139],v[138:139],s[42:43]
v_pk_mul_f32 v[140:141],v[140:141],s[42:43]
v_pk_mul_f32 v[142:143],v[142:143],s[42:43]
v_pk_mul_f32 v[144:145],v[144:145],s[42:43]
v_pk_mul_f32 v[146:147],v[146:147],s[42:43]
v_pk_mul_f32 v[148:149],v[148:149],s[42:43]
v_pk_mul_f32 v[150:151],v[150:151],s[42:43]
v_pk_mul_f32 v[152:153],v[152:153],s[42:43]
v_pk_mul_f32 v[154:155],v[154:155],s[42:43]
v_pk_mul_f32 v[156:157],v[156:157],s[42:43]
v_pk_mul_f32 v[158:159],v[158:159],s[42:43]
s_waitcnt lgkmcnt(0)
v_mfma_f32_16x16x32_bf16 v[96:99],a[128:131],a[0:3],0
ds_read_b64_tr_b16 a[192:193],v14 offset:0
ds_read_b64_tr_b16 a[194:195],v14 offset:4096
v_cvt_pk_bf16_f32 v128,v128,v129
v_cvt_pk_bf16_f32 v129,v130,v131
v_mfma_f32_16x16x32_bf16 v[96:99],a[132:135],a[4:7],v[96:99]
ds_read_b64_tr_b16 a[196:197],v14 offset:8192
ds_read_b64_tr_b16 a[198:199],v14 offset:12288
v_cvt_pk_bf16_f32 v130,v132,v133
v_cvt_pk_bf16_f32 v131,v134,v135
v_mfma_f32_16x16x32_bf16 v[96:99],a[136:139],a[8:11],v[96:99]
ds_read_b64_tr_b16 a[200:201],v15 offset:0
ds_read_b64_tr_b16 a[202:203],v15 offset:4096
v_cvt_pk_bf16_f32 v136,v136,v137
v_cvt_pk_bf16_f32 v137,v138,v139
v_mfma_f32_16x16x32_bf16 v[96:99],a[140:143],a[12:15],v[96:99]
ds_read_b64_tr_b16 a[204:205],v15 offset:8192
ds_read_b64_tr_b16 a[206:207],v15 offset:12288
v_cvt_pk_bf16_f32 v138,v140,v141
v_cvt_pk_bf16_f32 v139,v142,v143
v_mfma_f32_16x16x32_bf16 v[100:103],a[128:131],a[16:19],0
ds_read_b64_tr_b16 a[208:209],v16 offset:0
ds_read_b64_tr_b16 a[210:211],v16 offset:4096
v_cvt_pk_bf16_f32 v144,v144,v145
v_cvt_pk_bf16_f32 v145,v146,v147
v_mfma_f32_16x16x32_bf16 v[100:103],a[132:135],a[20:23],v[100:103]
ds_read_b64_tr_b16 a[212:213],v16 offset:8192
ds_read_b64_tr_b16 a[214:215],v16 offset:12288
v_cvt_pk_bf16_f32 v146,v148,v149
v_cvt_pk_bf16_f32 v147,v150,v151
v_mfma_f32_16x16x32_bf16 v[100:103],a[136:139],a[24:27],v[100:103]
ds_read_b64_tr_b16 a[216:217],v17 offset:0
ds_read_b64_tr_b16 a[218:219],v17 offset:4096
v_cvt_pk_bf16_f32 v152,v152,v153
v_cvt_pk_bf16_f32 v153,v154,v155
v_mfma_f32_16x16x32_bf16 v[100:103],a[140:143],a[28:31],v[100:103]
ds_read_b64_tr_b16 a[220:221],v17 offset:8192
ds_read_b64_tr_b16 a[222:223],v17 offset:12288
v_cvt_pk_bf16_f32 v154,v156,v157
v_cvt_pk_bf16_f32 v155,v158,v159
v_mfma_f32_16x16x32_bf16 v[104:107],a[128:131],a[32:35],0
ds_read_b64_tr_b16 a[224:225],v18 offset:0
ds_read_b64_tr_b16 a[226:227],v18 offset:4096
v_permlane16_swap_b32 v128,v130
v_permlane16_swap_b32 v129,v131
v_mfma_f32_16x16x32_bf16 v[104:107],a[132:135],a[36:39],v[104:107]
ds_read_b64_tr_b16 a[228:229],v18 offset:8192
ds_read_b64_tr_b16 a[230:231],v18 offset:12288
v_permlane16_swap_b32 v136,v138
v_permlane16_swap_b32 v137,v139
v_mfma_f32_16x16x32_bf16 v[104:107],a[136:139],a[40:43],v[104:107]
ds_read_b64_tr_b16 a[232:233],v19 offset:0
ds_read_b64_tr_b16 a[234:235],v19 offset:4096
v_permlane16_swap_b32 v144,v146
v_permlane16_swap_b32 v145,v147
v_mfma_f32_16x16x32_bf16 v[104:107],a[140:143],a[44:47],v[104:107]
ds_read_b64_tr_b16 a[236:237],v19 offset:8192
ds_read_b64_tr_b16 a[238:239],v19 offset:12288
v_permlane16_swap_b32 v152,v154
v_permlane16_swap_b32 v153,v155
v_mfma_f32_16x16x32_bf16 v[108:111],a[128:131],a[48:51],0
ds_read_b64_tr_b16 a[240:241],v20 offset:0
ds_read_b64_tr_b16 a[242:243],v20 offset:4096
v_accvgpr_write_b32 a64,v128
v_accvgpr_write_b32 a65,v129
v_mfma_f32_16x16x32_bf16 v[108:111],a[132:135],a[52:55],v[108:111]
ds_read_b64_tr_b16 a[244:245],v20 offset:8192
ds_read_b64_tr_b16 a[246:247],v20 offset:12288
v_accvgpr_write_b32 a66,v130
v_accvgpr_write_b32 a67,v131
v_mfma_f32_16x16x32_bf16 v[108:111],a[136:139],a[56:59],v[108:111]
ds_read_b64_tr_b16 a[248:249],v21 offset:0
ds_read_b64_tr_b16 a[250:251],v21 offset:4096
v_accvgpr_write_b32 a68,v136
v_accvgpr_write_b32 a69,v137
v_mfma_f32_16x16x32_bf16 v[108:111],a[140:143],a[60:63],v[108:111]
ds_read_b64_tr_b16 a[252:253],v21 offset:8192
ds_read_b64_tr_b16 a[254:255],v21 offset:12288
v_accvgpr_write_b32 a70,v138
v_accvgpr_write_b32 a71,v139
v_accvgpr_write_b32 a72,v144
v_accvgpr_write_b32 a73,v145
v_accvgpr_write_b32 a74,v146
v_accvgpr_write_b32 a75,v147
v_accvgpr_write_b32 a76,v152
v_accvgpr_write_b32 a77,v153
v_accvgpr_write_b32 a78,v154
v_accvgpr_write_b32 a79,v155
v_max3_f32 v34,v96,v97,v98
v_max3_f32 v35,v100,v101,v102
v_max3_f32 v36,v104,v105,v106
v_max3_f32 v37,v108,v109,v110
v_max_f32 v34,v34,v99
v_max_f32 v35,v35,v103
v_max_f32 v36,v36,v107
v_max_f32 v37,v37,v111
v_mov_b32 v96,v34
v_mov_b32 v100,v35
v_mov_b32 v104,v36
v_mov_b32 v108,v37
v_permlane16_swap_b32 v34,v96
v_permlane16_swap_b32 v35,v100
v_permlane16_swap_b32 v36,v104
v_permlane16_swap_b32 v37,v108
v_max_f32 v34,v34,v96
v_max_f32 v35,v35,v100
v_max_f32 v36,v36,v104
v_max_f32 v37,v37,v108
v_mov_b32 v96,v34
v_mov_b32 v100,v35
v_mov_b32 v104,v36
v_mov_b32 v108,v37
v_permlane32_swap_b32 v34,v96
v_permlane32_swap_b32 v35,v100
v_permlane32_swap_b32 v36,v104
v_permlane32_swap_b32 v37,v108
v_max_f32 v34,v34,v96
v_max_f32 v35,v35,v100
v_max_f32 v36,v36,v104
v_max_f32 v37,v37,v108
v_sub_f32 v64,0,v34
v_sub_f32 v65,0,v34
v_sub_f32 v66,0,v34
v_sub_f32 v67,0,v34
v_sub_f32 v68,0,v35
v_sub_f32 v69,0,v35
v_sub_f32 v70,0,v35
v_sub_f32 v71,0,v35
v_sub_f32 v72,0,v36
v_sub_f32 v73,0,v36
v_sub_f32 v74,0,v36
v_sub_f32 v75,0,v36
v_sub_f32 v76,0,v37
v_sub_f32 v77,0,v37
v_sub_f32 v78,0,v37
v_sub_f32 v79,0,v37
s_nop 1
v_mfma_f32_16x16x32_bf16 v[96:99],a[128:131],a[0:3],v[64:67]
v_mul_f32 v160,s42,v160
v_mul_f32 v161,s42,v161
v_mul_f32 v162,s42,v162
v_mul_f32 v163,s42,v163
v_mul_f32 v164,s42,v164
v_mfma_f32_16x16x32_bf16 v[96:99],a[132:135],a[4:7],v[96:99]
v_mul_f32 v165,s42,v165
v_mul_f32 v166,s42,v166
v_mul_f32 v167,s42,v167
v_mul_f32 v168,s42,v168
v_mul_f32 v169,s42,v169
v_mfma_f32_16x16x32_bf16 v[96:99],a[136:139],a[8:11],v[96:99]
v_mul_f32 v170,s42,v170
v_mul_f32 v171,s42,v171
v_mul_f32 v172,s42,v172
v_mul_f32 v173,s42,v173
v_mul_f32 v174,s42,v174
v_mfma_f32_16x16x32_bf16 v[96:99],a[140:143],a[12:15],v[96:99]
v_mul_f32 v175,s42,v175
v_mul_f32 v176,s42,v176
v_mul_f32 v177,s42,v177
v_mul_f32 v178,s42,v178
v_mul_f32 v179,s42,v179
v_mfma_f32_16x16x32_bf16 v[100:103],a[144:147],a[0:3],v[64:67]
v_mul_f32 v180,s42,v180
v_mul_f32 v181,s42,v181
v_mul_f32 v182,s42,v182
v_mul_f32 v183,s42,v183
v_mul_f32 v184,s42,v184
v_mfma_f32_16x16x32_bf16 v[100:103],a[148:151],a[4:7],v[100:103]
v_mul_f32 v185,s42,v185
v_mul_f32 v186,s42,v186
v_mul_f32 v187,s42,v187
v_mul_f32 v188,s42,v188
v_mul_f32 v189,s42,v189
v_mfma_f32_16x16x32_bf16 v[100:103],a[152:155],a[8:11],v[100:103]
v_mul_f32 v190,s42,v190
v_mul_f32 v191,s42,v191
v_cvt_pk_bf16_f32 v160,v160,v161
v_cvt_pk_bf16_f32 v161,v162,v163
v_cvt_pk_bf16_f32 v162,v164,v165
v_mfma_f32_16x16x32_bf16 v[100:103],a[156:159],a[12:15],v[100:103]
v_cvt_pk_bf16_f32 v163,v166,v167
v_cvt_pk_bf16_f32 v168,v168,v169
v_cvt_pk_bf16_f32 v169,v170,v171
v_cvt_pk_bf16_f32 v170,v172,v173
v_cvt_pk_bf16_f32 v171,v174,v175
v_mfma_f32_16x16x32_bf16 v[104:107],a[160:163],a[0:3],v[64:67]
v_cvt_pk_bf16_f32 v176,v176,v177
v_cvt_pk_bf16_f32 v177,v178,v179
v_cvt_pk_bf16_f32 v178,v180,v181
v_cvt_pk_bf16_f32 v179,v182,v183
v_cvt_pk_bf16_f32 v184,v184,v185
v_mfma_f32_16x16x32_bf16 v[104:107],a[164:167],a[4:7],v[104:107]
v_cvt_pk_bf16_f32 v185,v186,v187
v_cvt_pk_bf16_f32 v186,v188,v189
v_cvt_pk_bf16_f32 v187,v190,v191
v_permlane16_swap_b32 v160,v162
v_permlane16_swap_b32 v161,v163
v_mfma_f32_16x16x32_bf16 v[104:107],a[168:171],a[8:11],v[104:107]
v_permlane16_swap_b32 v168,v170
v_permlane16_swap_b32 v169,v171
v_permlane16_swap_b32 v176,v178
v_permlane16_swap_b32 v177,v179
v_permlane16_swap_b32 v184,v186
v_mfma_f32_16x16x32_bf16 v[104:107],a[172:175],a[12:15],v[104:107]
v_permlane16_swap_b32 v185,v187
v_accvgpr_write_b32 a80,v160
v_accvgpr_write_b32 a81,v161
v_accvgpr_write_b32 a82,v162
v_accvgpr_write_b32 a83,v163
v_mfma_f32_16x16x32_bf16 v[108:111],a[176:179],a[0:3],v[64:67]
v_accvgpr_write_b32 a84,v168
v_accvgpr_write_b32 a85,v169
v_accvgpr_write_b32 a86,v170
v_accvgpr_write_b32 a87,v171
v_accvgpr_write_b32 a88,v176
v_mfma_f32_16x16x32_bf16 v[108:111],a[180:183],a[4:7],v[108:111]
v_accvgpr_write_b32 a89,v177
v_accvgpr_write_b32 a90,v178
v_accvgpr_write_b32 a91,v179
v_accvgpr_write_b32 a92,v184
v_accvgpr_write_b32 a93,v185
v_mfma_f32_16x16x32_bf16 v[108:111],a[184:187],a[8:11],v[108:111]
v_accvgpr_write_b32 a94,v186
v_accvgpr_write_b32 a95,v187
v_mfma_f32_16x16x32_bf16 v[108:111],a[188:191],a[12:15],v[108:111]
v_mfma_f32_16x16x32_bf16 v[112:115],a[128:131],a[16:19],v[68:71]
v_exp_f32 v96,v96
v_mfma_f32_16x16x32_bf16 v[112:115],a[132:135],a[20:23],v[112:115]
v_exp_f32 v97,v97
v_mfma_f32_16x16x32_bf16 v[112:115],a[136:139],a[24:27],v[112:115]
v_exp_f32 v98,v98
v_cvt_pk_bf16_f32 v80,v96,v97
v_mfma_f32_16x16x32_bf16 v[112:115],a[140:143],a[28:31],v[112:115]
v_exp_f32 v99,v99
v_mfma_f32_16x16x32_bf16 v[116:119],a[144:147],a[16:19],v[68:71]
v_exp_f32 v100,v100
v_cvt_pk_bf16_f32 v81,v98,v99
v_mfma_f32_16x16x32_bf16 v[116:119],a[148:151],a[20:23],v[116:119]
v_exp_f32 v101,v101
v_mfma_f32_16x16x32_bf16 v[116:119],a[152:155],a[24:27],v[116:119]
v_exp_f32 v102,v102
v_cvt_pk_bf16_f32 v82,v100,v101
v_mfma_f32_16x16x32_bf16 v[116:119],a[156:159],a[28:31],v[116:119]
v_exp_f32 v103,v103
v_mfma_f32_16x16x32_bf16 v[120:123],a[160:163],a[16:19],v[68:71]
v_exp_f32 v104,v104
v_cvt_pk_bf16_f32 v83,v102,v103
v_mfma_f32_16x16x32_bf16 v[120:123],a[164:167],a[20:23],v[120:123]
v_exp_f32 v105,v105
v_mfma_f32_16x16x32_bf16 v[120:123],a[168:171],a[24:27],v[120:123]
v_exp_f32 v106,v106
v_cvt_pk_bf16_f32 v84,v104,v105
v_mfma_f32_16x16x32_bf16 v[120:123],a[172:175],a[28:31],v[120:123]
v_exp_f32 v107,v107
v_mfma_f32_16x16x32_bf16 v[124:127],a[176:179],a[16:19],v[68:71]
v_exp_f32 v108,v108
v_cvt_pk_bf16_f32 v85,v106,v107
v_mfma_f32_16x16x32_bf16 v[124:127],a[180:183],a[20:23],v[124:127]
v_exp_f32 v109,v109
v_mfma_f32_16x16x32_bf16 v[124:127],a[184:187],a[24:27],v[124:127]
v_exp_f32 v110,v110
v_cvt_pk_bf16_f32 v86,v108,v109
v_mfma_f32_16x16x32_bf16 v[124:127],a[188:191],a[28:31],v[124:127]
v_exp_f32 v111,v111
s_nop 0
v_cvt_pk_bf16_f32 v87,v110,v111
v_mfma_f32_16x16x32_bf16 v[96:99],a[128:131],a[32:35],v[72:75]
v_mul_f32 v192,s42,v192
v_mul_f32 v193,s42,v193
v_mul_f32 v194,s42,v194
v_mfma_f32_16x16x32_bf16 v[96:99],a[132:135],a[36:39],v[96:99]
v_exp_f32 v112,v112
v_mul_f32 v195,s42,v195
v_mfma_f32_16x16x32_bf16 v[96:99],a[136:139],a[40:43],v[96:99]
v_mul_f32 v196,s42,v196
v_mul_f32 v197,s42,v197
v_mul_f32 v198,s42,v198
v_mfma_f32_16x16x32_bf16 v[96:99],a[140:143],a[44:47],v[96:99]
v_exp_f32 v113,v113
v_mul_f32 v199,s42,v199
v_mfma_f32_16x16x32_bf16 v[100:103],a[144:147],a[32:35],v[72:75]
v_cvt_pk_bf16_f32 v88,v112,v113
v_mul_f32 v200,s42,v200
v_mul_f32 v201,s42,v201
v_mfma_f32_16x16x32_bf16 v[100:103],a[148:151],a[36:39],v[100:103]
v_exp_f32 v114,v114
v_mul_f32 v202,s42,v202
v_mfma_f32_16x16x32_bf16 v[100:103],a[152:155],a[40:43],v[100:103]
v_mul_f32 v203,s42,v203
v_mul_f32 v204,s42,v204
v_mul_f32 v205,s42,v205
v_mfma_f32_16x16x32_bf16 v[100:103],a[156:159],a[44:47],v[100:103]
v_exp_f32 v115,v115
v_mul_f32 v206,s42,v206
v_mfma_f32_16x16x32_bf16 v[104:107],a[160:163],a[32:35],v[72:75]
v_cvt_pk_bf16_f32 v89,v114,v115
v_mul_f32 v207,s42,v207
v_mul_f32 v208,s42,v208
v_mfma_f32_16x16x32_bf16 v[104:107],a[164:167],a[36:39],v[104:107]
v_exp_f32 v116,v116
v_mul_f32 v209,s42,v209
v_mfma_f32_16x16x32_bf16 v[104:107],a[168:171],a[40:43],v[104:107]
v_mul_f32 v210,s42,v210
v_mul_f32 v211,s42,v211
v_mul_f32 v212,s42,v212
v_mfma_f32_16x16x32_bf16 v[104:107],a[172:175],a[44:47],v[104:107]
v_exp_f32 v117,v117
v_mul_f32 v213,s42,v213
v_mfma_f32_16x16x32_bf16 v[108:111],a[176:179],a[32:35],v[72:75]
v_cvt_pk_bf16_f32 v90,v116,v117
v_mul_f32 v214,s42,v214
v_mul_f32 v215,s42,v215
v_mfma_f32_16x16x32_bf16 v[108:111],a[180:183],a[36:39],v[108:111]
v_exp_f32 v118,v118
v_mul_f32 v216,s42,v216
v_mfma_f32_16x16x32_bf16 v[108:111],a[184:187],a[40:43],v[108:111]
v_mul_f32 v217,s42,v217
v_mul_f32 v218,s42,v218
v_mul_f32 v219,s42,v219
v_mfma_f32_16x16x32_bf16 v[108:111],a[188:191],a[44:47],v[108:111]
v_exp_f32 v119,v119
v_mul_f32 v220,s42,v220
s_waitcnt lgkmcnt(0)
v_mfma_f32_16x16x32_bf16 v[128:131],a[192:195],v[80:83],0
v_cvt_pk_bf16_f32 v91,v118,v119
v_mul_f32 v221,s42,v221
v_mul_f32 v222,s42,v222
v_mfma_f32_16x16x32_bf16 v[128:131],a[196:199],v[84:87],v[128:131]
v_exp_f32 v120,v120
v_mul_f32 v223,s42,v223
v_mfma_f32_16x16x32_bf16 v[132:135],a[200:203],v[80:83],0
v_cvt_pk_bf16_f32 v192,v192,v193
v_cvt_pk_bf16_f32 v193,v194,v195
v_cvt_pk_bf16_f32 v194,v196,v197
v_mfma_f32_16x16x32_bf16 v[132:135],a[204:207],v[84:87],v[132:135]
v_exp_f32 v121,v121
v_cvt_pk_bf16_f32 v195,v198,v199
v_mfma_f32_16x16x32_bf16 v[136:139],a[208:211],v[80:83],0
v_cvt_pk_bf16_f32 v92,v120,v121
v_cvt_pk_bf16_f32 v200,v200,v201
v_cvt_pk_bf16_f32 v201,v202,v203
v_mfma_f32_16x16x32_bf16 v[136:139],a[212:215],v[84:87],v[136:139]
v_exp_f32 v122,v122
v_cvt_pk_bf16_f32 v202,v204,v205
v_mfma_f32_16x16x32_bf16 v[140:143],a[216:219],v[80:83],0
v_cvt_pk_bf16_f32 v203,v206,v207
v_cvt_pk_bf16_f32 v208,v208,v209
v_cvt_pk_bf16_f32 v209,v210,v211
v_mfma_f32_16x16x32_bf16 v[140:143],a[220:223],v[84:87],v[140:143]
v_exp_f32 v123,v123
v_cvt_pk_bf16_f32 v210,v212,v213
v_mfma_f32_16x16x32_bf16 v[144:147],a[224:227],v[80:83],0
v_cvt_pk_bf16_f32 v93,v122,v123
v_cvt_pk_bf16_f32 v211,v214,v215
v_cvt_pk_bf16_f32 v216,v216,v217
v_mfma_f32_16x16x32_bf16 v[144:147],a[228:231],v[84:87],v[144:147]
v_exp_f32 v124,v124
v_cvt_pk_bf16_f32 v217,v218,v219
v_mfma_f32_16x16x32_bf16 v[148:151],a[232:235],v[80:83],0
v_cvt_pk_bf16_f32 v218,v220,v221
v_cvt_pk_bf16_f32 v219,v222,v223
v_permlane16_swap_b32 v192,v194
v_mfma_f32_16x16x32_bf16 v[148:151],a[236:239],v[84:87],v[148:151]
v_exp_f32 v125,v125
v_permlane16_swap_b32 v193,v195
v_mfma_f32_16x16x32_bf16 v[152:155],a[240:243],v[80:83],0
v_cvt_pk_bf16_f32 v94,v124,v125
v_permlane16_swap_b32 v200,v202
v_permlane16_swap_b32 v201,v203
v_mfma_f32_16x16x32_bf16 v[152:155],a[244:247],v[84:87],v[152:155]
v_exp_f32 v126,v126
v_permlane16_swap_b32 v208,v210
v_mfma_f32_16x16x32_bf16 v[156:159],a[248:251],v[80:83],0
v_permlane16_swap_b32 v209,v211
v_permlane16_swap_b32 v216,v218
v_permlane16_swap_b32 v217,v219
v_mfma_f32_16x16x32_bf16 v[156:159],a[252:255],v[84:87],v[156:159]
v_exp_f32 v127,v127
v_accvgpr_write_b32 a96,v192
v_mfma_f32_16x16x32_bf16 v[48:51],v[44:47],v[80:83],0
v_cvt_pk_bf16_f32 v95,v126,v127
v_accvgpr_write_b32 a97,v193
v_accvgpr_write_b32 a98,v194
v_mfma_f32_16x16x32_bf16 v[48:51],v[44:47],v[84:87],v[48:51]
s_waitcnt vmcnt(22)
s_barrier
v_accvgpr_write_b32 a99,v195
v_mfma_f32_16x16x32_bf16 v[112:115],a[128:131],a[48:51],v[76:79]
v_accvgpr_write_b32 a100,v200
v_accvgpr_write_b32 a101,v201
v_accvgpr_write_b32 a102,v202
v_mfma_f32_16x16x32_bf16 v[112:115],a[132:135],a[52:55],v[112:115]
v_exp_f32 v96,v96
v_accvgpr_write_b32 a103,v203
v_mfma_f32_16x16x32_bf16 v[112:115],a[136:139],a[56:59],v[112:115]
v_accvgpr_write_b32 a104,v208
v_accvgpr_write_b32 a105,v209
v_accvgpr_write_b32 a106,v210
v_mfma_f32_16x16x32_bf16 v[112:115],a[140:143],a[60:63],v[112:115]
v_exp_f32 v97,v97
v_accvgpr_write_b32 a107,v211
v_mfma_f32_16x16x32_bf16 v[116:119],a[144:147],a[48:51],v[76:79]
ds_read_b128 a[128:131],v10 offset:16384
v_cvt_pk_bf16_f32 v80,v96,v97
v_accvgpr_write_b32 a108,v216
v_mfma_f32_16x16x32_bf16 v[116:119],a[148:151],a[52:55],v[116:119]
v_exp_f32 v98,v98
v_accvgpr_write_b32 a109,v217
v_mfma_f32_16x16x32_bf16 v[116:119],a[152:155],a[56:59],v[116:119]
ds_read_b128 a[132:135],v11 offset:16384
v_accvgpr_write_b32 a110,v218
v_accvgpr_write_b32 a111,v219
v_mfma_f32_16x16x32_bf16 v[116:119],a[156:159],a[60:63],v[116:119]
v_exp_f32 v99,v99
v_mul_f32 v224,s42,v224
v_mfma_f32_16x16x32_bf16 v[120:123],a[160:163],a[48:51],v[76:79]
ds_read_b128 a[136:139],v12 offset:16384
v_cvt_pk_bf16_f32 v81,v98,v99
v_mul_f32 v225,s42,v225
v_mfma_f32_16x16x32_bf16 v[120:123],a[164:167],a[52:55],v[120:123]
v_exp_f32 v100,v100
v_mul_f32 v226,s42,v226
v_mfma_f32_16x16x32_bf16 v[120:123],a[168:171],a[56:59],v[120:123]
ds_read_b128 a[140:143],v13 offset:16384
v_mul_f32 v227,s42,v227
v_mul_f32 v228,s42,v228
v_mfma_f32_16x16x32_bf16 v[120:123],a[172:175],a[60:63],v[120:123]
v_exp_f32 v101,v101
v_mul_f32 v229,s42,v229
v_mfma_f32_16x16x32_bf16 v[124:127],a[176:179],a[48:51],v[76:79]
ds_read_b128 a[144:147],v10 offset:20480
v_cvt_pk_bf16_f32 v82,v100,v101
v_mul_f32 v230,s42,v230
v_mfma_f32_16x16x32_bf16 v[124:127],a[180:183],a[52:55],v[124:127]
v_exp_f32 v102,v102
v_mul_f32 v231,s42,v231
v_mfma_f32_16x16x32_bf16 v[124:127],a[184:187],a[56:59],v[124:127]
ds_read_b128 a[148:151],v11 offset:20480
v_mul_f32 v232,s42,v232
v_mul_f32 v233,s42,v233
v_mfma_f32_16x16x32_bf16 v[124:127],a[188:191],a[60:63],v[124:127]
v_exp_f32 v103,v103
v_mul_f32 v234,s42,v234
v_mfma_f32_16x16x32_bf16 v[160:163],a[192:195],v[88:91],0
ds_read_b128 a[152:155],v12 offset:20480
v_cvt_pk_bf16_f32 v83,v102,v103
v_mul_f32 v235,s42,v235
v_mfma_f32_16x16x32_bf16 v[160:163],a[196:199],v[92:95],v[160:163]
v_exp_f32 v104,v104
v_mul_f32 v236,s42,v236
v_mfma_f32_16x16x32_bf16 v[164:167],a[200:203],v[88:91],0
ds_read_b128 a[156:159],v13 offset:20480
v_mul_f32 v237,s42,v237
v_mul_f32 v238,s42,v238
v_mfma_f32_16x16x32_bf16 v[164:167],a[204:207],v[92:95],v[164:167]
v_exp_f32 v105,v105
v_mul_f32 v239,s42,v239
v_mfma_f32_16x16x32_bf16 v[168:171],a[208:211],v[88:91],0
ds_read_b128 a[160:163],v10 offset:24576
v_cvt_pk_bf16_f32 v84,v104,v105
v_mul_f32 v240,s42,v240
v_mfma_f32_16x16x32_bf16 v[168:171],a[212:215],v[92:95],v[168:171]
v_exp_f32 v106,v106
v_mul_f32 v241,s42,v241
v_mfma_f32_16x16x32_bf16 v[172:175],a[216:219],v[88:91],0
ds_read_b128 a[164:167],v11 offset:24576
v_mul_f32 v242,s42,v242
v_mul_f32 v243,s42,v243
v_mfma_f32_16x16x32_bf16 v[172:175],a[220:223],v[92:95],v[172:175]
v_exp_f32 v107,v107
v_mul_f32 v244,s42,v244
v_mfma_f32_16x16x32_bf16 v[176:179],a[224:227],v[88:91],0
ds_read_b128 a[168:171],v12 offset:24576
v_cvt_pk_bf16_f32 v85,v106,v107
v_mul_f32 v245,s42,v245
v_mfma_f32_16x16x32_bf16 v[176:179],a[228:231],v[92:95],v[176:179]
v_exp_f32 v108,v108
v_mul_f32 v246,s42,v246
v_mfma_f32_16x16x32_bf16 v[180:183],a[232:235],v[88:91],0
ds_read_b128 a[172:175],v13 offset:24576
v_mul_f32 v247,s42,v247
v_mul_f32 v248,s42,v248
v_mfma_f32_16x16x32_bf16 v[180:183],a[236:239],v[92:95],v[180:183]
v_exp_f32 v109,v109
v_mul_f32 v249,s42,v249
v_mfma_f32_16x16x32_bf16 v[184:187],a[240:243],v[88:91],0
ds_read_b128 a[176:179],v10 offset:28672
v_cvt_pk_bf16_f32 v86,v108,v109
v_mul_f32 v250,s42,v250
v_mfma_f32_16x16x32_bf16 v[184:187],a[244:247],v[92:95],v[184:187]
v_exp_f32 v110,v110
v_mul_f32 v251,s42,v251
v_mfma_f32_16x16x32_bf16 v[188:191],a[248:251],v[88:91],0
ds_read_b128 a[180:183],v11 offset:28672
v_mul_f32 v252,s42,v252
v_mul_f32 v253,s42,v253
v_mfma_f32_16x16x32_bf16 v[188:191],a[252:255],v[92:95],v[188:191]
v_exp_f32 v111,v111
v_mul_f32 v254,s42,v254
v_mfma_f32_16x16x32_bf16 v[52:55],v[44:47],v[88:91],0
ds_read_b128 a[184:187],v12 offset:28672
v_cvt_pk_bf16_f32 v87,v110,v111
v_mul_f32 v255,s42,v255
v_mfma_f32_16x16x32_bf16 v[52:55],v[44:47],v[92:95],v[52:55]
ds_read_b128 a[188:191],v13 offset:28672
v_cvt_pk_bf16_f32 v224,v224,v225
v_cvt_pk_bf16_f32 v225,v226,v227
v_mfma_f32_16x16x32_bf16 v[192:195],a[192:195],v[80:83],0
v_cvt_pk_bf16_f32 v226,v228,v229
v_cvt_pk_bf16_f32 v227,v230,v231
v_cvt_pk_bf16_f32 v232,v232,v233
v_mfma_f32_16x16x32_bf16 v[192:195],a[196:199],v[84:87],v[192:195]
v_exp_f32 v112,v112
v_cvt_pk_bf16_f32 v233,v234,v235
v_mfma_f32_16x16x32_bf16 v[196:199],a[200:203],v[80:83],0
v_cvt_pk_bf16_f32 v234,v236,v237
v_cvt_pk_bf16_f32 v235,v238,v239
v_cvt_pk_bf16_f32 v240,v240,v241
v_mfma_f32_16x16x32_bf16 v[196:199],a[204:207],v[84:87],v[196:199]
v_exp_f32 v113,v113
v_cvt_pk_bf16_f32 v241,v242,v243
v_mfma_f32_16x16x32_bf16 v[200:203],a[208:211],v[80:83],0
v_cvt_pk_bf16_f32 v88,v112,v113
v_cvt_pk_bf16_f32 v242,v244,v245
v_cvt_pk_bf16_f32 v243,v246,v247
v_mfma_f32_16x16x32_bf16 v[200:203],a[212:215],v[84:87],v[200:203]
v_exp_f32 v114,v114
v_cvt_pk_bf16_f32 v248,v248,v249
v_mfma_f32_16x16x32_bf16 v[204:207],a[216:219],v[80:83],0
v_cvt_pk_bf16_f32 v249,v250,v251
v_cvt_pk_bf16_f32 v250,v252,v253
v_cvt_pk_bf16_f32 v251,v254,v255
v_mfma_f32_16x16x32_bf16 v[204:207],a[220:223],v[84:87],v[204:207]
v_exp_f32 v115,v115
v_permlane16_swap_b32 v224,v226
v_mfma_f32_16x16x32_bf16 v[208:211],a[224:227],v[80:83],0
v_cvt_pk_bf16_f32 v89,v114,v115
v_permlane16_swap_b32 v225,v227
v_permlane16_swap_b32 v232,v234
v_mfma_f32_16x16x32_bf16 v[208:211],a[228:231],v[84:87],v[208:211]
v_exp_f32 v116,v116
v_permlane16_swap_b32 v233,v235
v_mfma_f32_16x16x32_bf16 v[212:215],a[232:235],v[80:83],0
v_permlane16_swap_b32 v240,v242
v_permlane16_swap_b32 v241,v243
v_permlane16_swap_b32 v248,v250
v_mfma_f32_16x16x32_bf16 v[212:215],a[236:239],v[84:87],v[212:215]
v_exp_f32 v117,v117
v_permlane16_swap_b32 v249,v251
v_mfma_f32_16x16x32_bf16 v[216:219],a[240:243],v[80:83],0
v_cvt_pk_bf16_f32 v90,v116,v117
v_accvgpr_write_b32 a112,v224
v_accvgpr_write_b32 a113,v225
v_mfma_f32_16x16x32_bf16 v[216:219],a[244:247],v[84:87],v[216:219]
v_exp_f32 v118,v118
v_accvgpr_write_b32 a114,v226
v_mfma_f32_16x16x32_bf16 v[220:223],a[248:251],v[80:83],0
s_waitcnt lgkmcnt(0)
v_accvgpr_write_b32 a115,v227
v_accvgpr_write_b32 a116,v232
v_mfma_f32_16x16x32_bf16 v[220:223],a[252:255],v[84:87],v[220:223]
v_exp_f32 v119,v119
v_accvgpr_write_b32 a117,v233
v_mfma_f32_16x16x32_bf16 v[56:59],v[44:47],v[80:83],0
v_cvt_pk_bf16_f32 v91,v118,v119
v_accvgpr_write_b32 a118,v234
v_accvgpr_write_b32 a119,v235
v_mfma_f32_16x16x32_bf16 v[56:59],v[44:47],v[84:87],v[56:59]
v_exp_f32 v120,v120
v_accvgpr_write_b32 a120,v240
v_mfma_f32_16x16x32_bf16 v[96:99],a[128:131],a[0:3],v[64:67]
v_accvgpr_write_b32 a121,v241
v_accvgpr_write_b32 a122,v242
v_accvgpr_write_b32 a123,v243
v_mfma_f32_16x16x32_bf16 v[96:99],a[132:135],a[4:7],v[96:99]
v_exp_f32 v121,v121
v_accvgpr_write_b32 a124,v248
v_mfma_f32_16x16x32_bf16 v[96:99],a[136:139],a[8:11],v[96:99]
v_cvt_pk_bf16_f32 v92,v120,v121
v_accvgpr_write_b32 a125,v249
v_accvgpr_write_b32 a126,v250
v_mfma_f32_16x16x32_bf16 v[96:99],a[140:143],a[12:15],v[96:99]
v_exp_f32 v122,v122
v_accvgpr_write_b32 a127,v251
v_mfma_f32_16x16x32_bf16 v[100:103],a[144:147],a[0:3],v[64:67]
v_mfma_f32_16x16x32_bf16 v[100:103],a[148:151],a[4:7],v[100:103]
v_exp_f32 v123,v123
v_mfma_f32_16x16x32_bf16 v[100:103],a[152:155],a[8:11],v[100:103]
v_cvt_pk_bf16_f32 v93,v122,v123
v_mfma_f32_16x16x32_bf16 v[100:103],a[156:159],a[12:15],v[100:103]
v_exp_f32 v124,v124
v_mfma_f32_16x16x32_bf16 v[104:107],a[160:163],a[0:3],v[64:67]
v_mfma_f32_16x16x32_bf16 v[104:107],a[164:167],a[4:7],v[104:107]
v_exp_f32 v125,v125
v_mfma_f32_16x16x32_bf16 v[104:107],a[168:171],a[8:11],v[104:107]
v_cvt_pk_bf16_f32 v94,v124,v125
v_mfma_f32_16x16x32_bf16 v[104:107],a[172:175],a[12:15],v[104:107]
v_exp_f32 v126,v126
v_mfma_f32_16x16x32_bf16 v[108:111],a[176:179],a[0:3],v[64:67]
v_mfma_f32_16x16x32_bf16 v[108:111],a[180:183],a[4:7],v[108:111]
v_exp_f32 v127,v127
v_mfma_f32_16x16x32_bf16 v[108:111],a[184:187],a[8:11],v[108:111]
v_cvt_pk_bf16_f32 v95,v126,v127
v_mfma_f32_16x16x32_bf16 v[108:111],a[188:191],a[12:15],v[108:111]
v_mfma_f32_16x16x32_bf16 v[224:227],a[192:195],v[88:91],0
v_mfma_f32_16x16x32_bf16 v[224:227],a[196:199],v[92:95],v[224:227]
v_exp_f32 v96,v96
v_mfma_f32_16x16x32_bf16 v[228:231],a[200:203],v[88:91],0
ds_read_b64_tr_b16 a[192:193],v14 offset:16384
ds_read_b64_tr_b16 a[194:195],v14 offset:20480
v_mfma_f32_16x16x32_bf16 v[228:231],a[204:207],v[92:95],v[228:231]
v_exp_f32 v97,v97
v_mfma_f32_16x16x32_bf16 v[232:235],a[208:211],v[88:91],0
ds_read_b64_tr_b16 a[196:197],v14 offset:24576
v_cvt_pk_bf16_f32 v80,v96,v97
v_mfma_f32_16x16x32_bf16 v[232:235],a[212:215],v[92:95],v[232:235]
v_exp_f32 v98,v98
v_mfma_f32_16x16x32_bf16 v[236:239],a[216:219],v[88:91],0
ds_read_b64_tr_b16 a[198:199],v14 offset:28672
ds_read_b64_tr_b16 a[200:201],v15 offset:16384
v_mfma_f32_16x16x32_bf16 v[236:239],a[220:223],v[92:95],v[236:239]
v_exp_f32 v99,v99
v_mfma_f32_16x16x32_bf16 v[240:243],a[224:227],v[88:91],0
ds_read_b64_tr_b16 a[202:203],v15 offset:20480
v_cvt_pk_bf16_f32 v81,v98,v99
v_mfma_f32_16x16x32_bf16 v[240:243],a[228:231],v[92:95],v[240:243]
v_exp_f32 v100,v100
v_mfma_f32_16x16x32_bf16 v[244:247],a[232:235],v[88:91],0
ds_read_b64_tr_b16 a[204:205],v15 offset:24576
ds_read_b64_tr_b16 a[206:207],v15 offset:28672
v_mfma_f32_16x16x32_bf16 v[244:247],a[236:239],v[92:95],v[244:247]
v_exp_f32 v101,v101
v_mfma_f32_16x16x32_bf16 v[248:251],a[240:243],v[88:91],0
ds_read_b64_tr_b16 a[208:209],v16 offset:16384
v_cvt_pk_bf16_f32 v82,v100,v101
v_mfma_f32_16x16x32_bf16 v[248:251],a[244:247],v[92:95],v[248:251]
v_exp_f32 v102,v102
v_mfma_f32_16x16x32_bf16 v[252:255],a[248:251],v[88:91],0
ds_read_b64_tr_b16 a[210:211],v16 offset:20480
ds_read_b64_tr_b16 a[212:213],v16 offset:24576
v_mfma_f32_16x16x32_bf16 v[252:255],a[252:255],v[92:95],v[252:255]
v_exp_f32 v103,v103
v_mfma_f32_16x16x32_bf16 v[60:63],v[44:47],v[88:91],0
ds_read_b64_tr_b16 a[214:215],v16 offset:28672
v_cvt_pk_bf16_f32 v83,v102,v103
v_mfma_f32_16x16x32_bf16 v[60:63],v[44:47],v[92:95],v[60:63]
v_exp_f32 v104,v104
v_mfma_f32_16x16x32_bf16 v[112:115],a[128:131],a[16:19],v[68:71]
ds_read_b64_tr_b16 a[216:217],v17 offset:16384
ds_read_b64_tr_b16 a[218:219],v17 offset:20480
v_mfma_f32_16x16x32_bf16 v[112:115],a[132:135],a[20:23],v[112:115]
v_exp_f32 v105,v105
v_mfma_f32_16x16x32_bf16 v[112:115],a[136:139],a[24:27],v[112:115]
ds_read_b64_tr_b16 a[220:221],v17 offset:24576
v_cvt_pk_bf16_f32 v84,v104,v105
v_mfma_f32_16x16x32_bf16 v[112:115],a[140:143],a[28:31],v[112:115]
v_exp_f32 v106,v106
v_mfma_f32_16x16x32_bf16 v[116:119],a[144:147],a[16:19],v[68:71]
ds_read_b64_tr_b16 a[222:223],v17 offset:28672
ds_read_b64_tr_b16 a[224:225],v18 offset:16384
v_mfma_f32_16x16x32_bf16 v[116:119],a[148:151],a[20:23],v[116:119]
v_exp_f32 v107,v107
v_mfma_f32_16x16x32_bf16 v[116:119],a[152:155],a[24:27],v[116:119]
ds_read_b64_tr_b16 a[226:227],v18 offset:20480
v_cvt_pk_bf16_f32 v85,v106,v107
v_mfma_f32_16x16x32_bf16 v[116:119],a[156:159],a[28:31],v[116:119]
v_exp_f32 v108,v108
v_mfma_f32_16x16x32_bf16 v[120:123],a[160:163],a[16:19],v[68:71]
ds_read_b64_tr_b16 a[228:229],v18 offset:24576
ds_read_b64_tr_b16 a[230:231],v18 offset:28672
v_mfma_f32_16x16x32_bf16 v[120:123],a[164:167],a[20:23],v[120:123]
v_exp_f32 v109,v109
v_mfma_f32_16x16x32_bf16 v[120:123],a[168:171],a[24:27],v[120:123]
ds_read_b64_tr_b16 a[232:233],v19 offset:16384
v_cvt_pk_bf16_f32 v86,v108,v109
v_mfma_f32_16x16x32_bf16 v[120:123],a[172:175],a[28:31],v[120:123]
v_exp_f32 v110,v110
v_mfma_f32_16x16x32_bf16 v[124:127],a[176:179],a[16:19],v[68:71]
ds_read_b64_tr_b16 a[234:235],v19 offset:20480
ds_read_b64_tr_b16 a[236:237],v19 offset:24576
v_mfma_f32_16x16x32_bf16 v[124:127],a[180:183],a[20:23],v[124:127]
v_exp_f32 v111,v111
v_mfma_f32_16x16x32_bf16 v[124:127],a[184:187],a[24:27],v[124:127]
ds_read_b64_tr_b16 a[238:239],v19 offset:28672
v_cvt_pk_bf16_f32 v87,v110,v111
v_mfma_f32_16x16x32_bf16 v[124:127],a[188:191],a[28:31],v[124:127]
ds_read_b64_tr_b16 a[240:241],v20 offset:16384
ds_read_b64_tr_b16 a[242:243],v20 offset:20480
v_mfma_f32_16x16x32_bf16 v[96:99],a[128:131],a[32:35],v[72:75]
ds_read_b64_tr_b16 a[244:245],v20 offset:24576
ds_read_b64_tr_b16 a[246:247],v20 offset:28672
v_mfma_f32_16x16x32_bf16 v[96:99],a[132:135],a[36:39],v[96:99]
v_exp_f32 v112,v112
v_mfma_f32_16x16x32_bf16 v[96:99],a[136:139],a[40:43],v[96:99]
ds_read_b64_tr_b16 a[248:249],v21 offset:16384
ds_read_b64_tr_b16 a[250:251],v21 offset:20480
v_mfma_f32_16x16x32_bf16 v[96:99],a[140:143],a[44:47],v[96:99]
v_exp_f32 v113,v113
v_mfma_f32_16x16x32_bf16 v[100:103],a[144:147],a[32:35],v[72:75]
ds_read_b64_tr_b16 a[252:253],v21 offset:24576
v_cvt_pk_bf16_f32 v88,v112,v113
v_mfma_f32_16x16x32_bf16 v[100:103],a[148:151],a[36:39],v[100:103]
v_exp_f32 v114,v114
v_mfma_f32_16x16x32_bf16 v[100:103],a[152:155],a[40:43],v[100:103]
ds_read_b64_tr_b16 a[254:255],v21 offset:28672
v_mfma_f32_16x16x32_bf16 v[100:103],a[156:159],a[44:47],v[100:103]
v_exp_f32 v115,v115
v_mfma_f32_16x16x32_bf16 v[104:107],a[160:163],a[32:35],v[72:75]
v_cvt_pk_bf16_f32 v89,v114,v115
v_mfma_f32_16x16x32_bf16 v[104:107],a[164:167],a[36:39],v[104:107]
v_exp_f32 v116,v116
v_mfma_f32_16x16x32_bf16 v[104:107],a[168:171],a[40:43],v[104:107]
v_mfma_f32_16x16x32_bf16 v[104:107],a[172:175],a[44:47],v[104:107]
v_exp_f32 v117,v117
v_mfma_f32_16x16x32_bf16 v[108:111],a[176:179],a[32:35],v[72:75]
v_cvt_pk_bf16_f32 v90,v116,v117
v_mfma_f32_16x16x32_bf16 v[108:111],a[180:183],a[36:39],v[108:111]
v_exp_f32 v118,v118
v_mfma_f32_16x16x32_bf16 v[108:111],a[184:187],a[40:43],v[108:111]
s_waitcnt lgkmcnt(0)
v_mfma_f32_16x16x32_bf16 v[108:111],a[188:191],a[44:47],v[108:111]
v_exp_f32 v119,v119
v_mfma_f32_16x16x32_bf16 v[128:131],a[192:195],v[80:83],v[128:131]
v_cvt_pk_bf16_f32 v91,v118,v119
v_mfma_f32_16x16x32_bf16 v[128:131],a[196:199],v[84:87],v[128:131]
v_exp_f32 v120,v120
v_mfma_f32_16x16x32_bf16 v[132:135],a[200:203],v[80:83],v[132:135]
v_mfma_f32_16x16x32_bf16 v[132:135],a[204:207],v[84:87],v[132:135]
v_exp_f32 v121,v121
v_mfma_f32_16x16x32_bf16 v[136:139],a[208:211],v[80:83],v[136:139]
v_cvt_pk_bf16_f32 v92,v120,v121
v_mfma_f32_16x16x32_bf16 v[136:139],a[212:215],v[84:87],v[136:139]
v_exp_f32 v122,v122
v_mfma_f32_16x16x32_bf16 v[140:143],a[216:219],v[80:83],v[140:143]
v_mfma_f32_16x16x32_bf16 v[140:143],a[220:223],v[84:87],v[140:143]
v_exp_f32 v123,v123
v_mfma_f32_16x16x32_bf16 v[144:147],a[224:227],v[80:83],v[144:147]
v_cvt_pk_bf16_f32 v93,v122,v123
v_mfma_f32_16x16x32_bf16 v[144:147],a[228:231],v[84:87],v[144:147]
v_exp_f32 v124,v124
v_mfma_f32_16x16x32_bf16 v[148:151],a[232:235],v[80:83],v[148:151]
v_mfma_f32_16x16x32_bf16 v[148:151],a[236:239],v[84:87],v[148:151]
v_exp_f32 v125,v125
v_mfma_f32_16x16x32_bf16 v[152:155],a[240:243],v[80:83],v[152:155]
v_cvt_pk_bf16_f32 v94,v124,v125
v_mfma_f32_16x16x32_bf16 v[152:155],a[244:247],v[84:87],v[152:155]
v_exp_f32 v126,v126
v_mfma_f32_16x16x32_bf16 v[156:159],a[248:251],v[80:83],v[156:159]
v_mfma_f32_16x16x32_bf16 v[156:159],a[252:255],v[84:87],v[156:159]
v_exp_f32 v127,v127
v_mfma_f32_16x16x32_bf16 v[48:51],v[44:47],v[80:83],v[48:51]
v_cvt_pk_bf16_f32 v95,v126,v127
v_mfma_f32_16x16x32_bf16 v[48:51],v[44:47],v[84:87],v[48:51]
s_waitcnt vmcnt(14)
s_barrier
v_mfma_f32_16x16x32_bf16 v[112:115],a[128:131],a[48:51],v[76:79]
v_mfma_f32_16x16x32_bf16 v[112:115],a[132:135],a[52:55],v[112:115]
v_exp_f32 v96,v96
v_mfma_f32_16x16x32_bf16 v[112:115],a[136:139],a[56:59],v[112:115]
v_mfma_f32_16x16x32_bf16 v[112:115],a[140:143],a[60:63],v[112:115]
v_exp_f32 v97,v97
v_mfma_f32_16x16x32_bf16 v[116:119],a[144:147],a[48:51],v[76:79]
ds_read_b128 a[128:131],v10 offset:32768
v_cvt_pk_bf16_f32 v80,v96,v97
v_mfma_f32_16x16x32_bf16 v[116:119],a[148:151],a[52:55],v[116:119]
v_exp_f32 v98,v98
v_mfma_f32_16x16x32_bf16 v[116:119],a[152:155],a[56:59],v[116:119]
ds_read_b128 a[132:135],v11 offset:32768
v_mfma_f32_16x16x32_bf16 v[116:119],a[156:159],a[60:63],v[116:119]
v_exp_f32 v99,v99
v_mfma_f32_16x16x32_bf16 v[120:123],a[160:163],a[48:51],v[76:79]
ds_read_b128 a[136:139],v12 offset:32768
v_cvt_pk_bf16_f32 v81,v98,v99
v_mfma_f32_16x16x32_bf16 v[120:123],a[164:167],a[52:55],v[120:123]
v_exp_f32 v100,v100
v_mfma_f32_16x16x32_bf16 v[120:123],a[168:171],a[56:59],v[120:123]
ds_read_b128 a[140:143],v13 offset:32768
v_mfma_f32_16x16x32_bf16 v[120:123],a[172:175],a[60:63],v[120:123]
v_exp_f32 v101,v101
v_mfma_f32_16x16x32_bf16 v[124:127],a[176:179],a[48:51],v[76:79]
ds_read_b128 a[144:147],v10 offset:36864
v_cvt_pk_bf16_f32 v82,v100,v101
v_mfma_f32_16x16x32_bf16 v[124:127],a[180:183],a[52:55],v[124:127]
v_exp_f32 v102,v102
v_mfma_f32_16x16x32_bf16 v[124:127],a[184:187],a[56:59],v[124:127]
ds_read_b128 a[148:151],v11 offset:36864
v_mfma_f32_16x16x32_bf16 v[124:127],a[188:191],a[60:63],v[124:127]
v_exp_f32 v103,v103
v_mfma_f32_16x16x32_bf16 v[160:163],a[192:195],v[88:91],v[160:163]
ds_read_b128 a[152:155],v12 offset:36864
v_cvt_pk_bf16_f32 v83,v102,v103
v_mfma_f32_16x16x32_bf16 v[160:163],a[196:199],v[92:95],v[160:163]
v_exp_f32 v104,v104
v_mfma_f32_16x16x32_bf16 v[164:167],a[200:203],v[88:91],v[164:167]
ds_read_b128 a[156:159],v13 offset:36864
v_mfma_f32_16x16x32_bf16 v[164:167],a[204:207],v[92:95],v[164:167]
v_exp_f32 v105,v105
v_mfma_f32_16x16x32_bf16 v[168:171],a[208:211],v[88:91],v[168:171]
ds_read_b128 a[160:163],v10 offset:40960
v_cvt_pk_bf16_f32 v84,v104,v105
v_mfma_f32_16x16x32_bf16 v[168:171],a[212:215],v[92:95],v[168:171]
v_exp_f32 v106,v106
v_mfma_f32_16x16x32_bf16 v[172:175],a[216:219],v[88:91],v[172:175]
ds_read_b128 a[164:167],v11 offset:40960
v_mfma_f32_16x16x32_bf16 v[172:175],a[220:223],v[92:95],v[172:175]
v_exp_f32 v107,v107
v_mfma_f32_16x16x32_bf16 v[176:179],a[224:227],v[88:91],v[176:179]
ds_read_b128 a[168:171],v12 offset:40960
v_cvt_pk_bf16_f32 v85,v106,v107
v_mfma_f32_16x16x32_bf16 v[176:179],a[228:231],v[92:95],v[176:179]
v_exp_f32 v108,v108
v_mfma_f32_16x16x32_bf16 v[180:183],a[232:235],v[88:91],v[180:183]
ds_read_b128 a[172:175],v13 offset:40960
v_mfma_f32_16x16x32_bf16 v[180:183],a[236:239],v[92:95],v[180:183]
v_exp_f32 v109,v109
v_mfma_f32_16x16x32_bf16 v[184:187],a[240:243],v[88:91],v[184:187]
ds_read_b128 a[176:179],v10 offset:45056
v_cvt_pk_bf16_f32 v86,v108,v109
v_mfma_f32_16x16x32_bf16 v[184:187],a[244:247],v[92:95],v[184:187]
v_exp_f32 v110,v110
v_mfma_f32_16x16x32_bf16 v[188:191],a[248:251],v[88:91],v[188:191]
ds_read_b128 a[180:183],v11 offset:45056
v_mfma_f32_16x16x32_bf16 v[188:191],a[252:255],v[92:95],v[188:191]
v_exp_f32 v111,v111
v_mfma_f32_16x16x32_bf16 v[52:55],v[44:47],v[88:91],v[52:55]
ds_read_b128 a[184:187],v12 offset:45056
v_cvt_pk_bf16_f32 v87,v110,v111
v_mfma_f32_16x16x32_bf16 v[52:55],v[44:47],v[92:95],v[52:55]
ds_read_b128 a[188:191],v13 offset:45056
v_mfma_f32_16x16x32_bf16 v[192:195],a[192:195],v[80:83],v[192:195]
v_mfma_f32_16x16x32_bf16 v[192:195],a[196:199],v[84:87],v[192:195]
v_exp_f32 v112,v112
v_mfma_f32_16x16x32_bf16 v[196:199],a[200:203],v[80:83],v[196:199]
v_mfma_f32_16x16x32_bf16 v[196:199],a[204:207],v[84:87],v[196:199]
v_exp_f32 v113,v113
v_mfma_f32_16x16x32_bf16 v[200:203],a[208:211],v[80:83],v[200:203]
v_cvt_pk_bf16_f32 v88,v112,v113
v_mfma_f32_16x16x32_bf16 v[200:203],a[212:215],v[84:87],v[200:203]
v_exp_f32 v114,v114
v_mfma_f32_16x16x32_bf16 v[204:207],a[216:219],v[80:83],v[204:207]
v_mfma_f32_16x16x32_bf16 v[204:207],a[220:223],v[84:87],v[204:207]
v_exp_f32 v115,v115
v_mfma_f32_16x16x32_bf16 v[208:211],a[224:227],v[80:83],v[208:211]
v_cvt_pk_bf16_f32 v89,v114,v115
v_mfma_f32_16x16x32_bf16 v[208:211],a[228:231],v[84:87],v[208:211]
v_exp_f32 v116,v116
v_mfma_f32_16x16x32_bf16 v[212:215],a[232:235],v[80:83],v[212:215]
v_mfma_f32_16x16x32_bf16 v[212:215],a[236:239],v[84:87],v[212:215]
v_exp_f32 v117,v117
v_mfma_f32_16x16x32_bf16 v[216:219],a[240:243],v[80:83],v[216:219]
v_cvt_pk_bf16_f32 v90,v116,v117
v_mfma_f32_16x16x32_bf16 v[216:219],a[244:247],v[84:87],v[216:219]
v_exp_f32 v118,v118
v_mfma_f32_16x16x32_bf16 v[220:223],a[248:251],v[80:83],v[220:223]
s_waitcnt lgkmcnt(0)
v_mfma_f32_16x16x32_bf16 v[220:223],a[252:255],v[84:87],v[220:223]
v_exp_f32 v119,v119
v_mfma_f32_16x16x32_bf16 v[56:59],v[44:47],v[80:83],v[56:59]
v_cvt_pk_bf16_f32 v91,v118,v119
v_mfma_f32_16x16x32_bf16 v[56:59],v[44:47],v[84:87],v[56:59]
v_exp_f32 v120,v120
v_mfma_f32_16x16x32_bf16 v[96:99],a[128:131],a[0:3],v[64:67]
v_mfma_f32_16x16x32_bf16 v[96:99],a[132:135],a[4:7],v[96:99]
v_exp_f32 v121,v121
v_mfma_f32_16x16x32_bf16 v[96:99],a[136:139],a[8:11],v[96:99]
v_cvt_pk_bf16_f32 v92,v120,v121
v_mfma_f32_16x16x32_bf16 v[96:99],a[140:143],a[12:15],v[96:99]
v_exp_f32 v122,v122
v_mfma_f32_16x16x32_bf16 v[100:103],a[144:147],a[0:3],v[64:67]
v_mfma_f32_16x16x32_bf16 v[100:103],a[148:151],a[4:7],v[100:103]
v_exp_f32 v123,v123
v_mfma_f32_16x16x32_bf16 v[100:103],a[152:155],a[8:11],v[100:103]
v_cvt_pk_bf16_f32 v93,v122,v123
v_mfma_f32_16x16x32_bf16 v[100:103],a[156:159],a[12:15],v[100:103]
v_exp_f32 v124,v124
v_mfma_f32_16x16x32_bf16 v[104:107],a[160:163],a[0:3],v[64:67]
v_mfma_f32_16x16x32_bf16 v[104:107],a[164:167],a[4:7],v[104:107]
v_exp_f32 v125,v125
v_mfma_f32_16x16x32_bf16 v[104:107],a[168:171],a[8:11],v[104:107]
v_cvt_pk_bf16_f32 v94,v124,v125
v_mfma_f32_16x16x32_bf16 v[104:107],a[172:175],a[12:15],v[104:107]
v_exp_f32 v126,v126
v_mfma_f32_16x16x32_bf16 v[108:111],a[176:179],a[0:3],v[64:67]
v_mfma_f32_16x16x32_bf16 v[108:111],a[180:183],a[4:7],v[108:111]
v_exp_f32 v127,v127
v_mfma_f32_16x16x32_bf16 v[108:111],a[184:187],a[8:11],v[108:111]
v_cvt_pk_bf16_f32 v95,v126,v127
v_mfma_f32_16x16x32_bf16 v[108:111],a[188:191],a[12:15],v[108:111]
v_mfma_f32_16x16x32_bf16 v[224:227],a[192:195],v[88:91],v[224:227]
v_mfma_f32_16x16x32_bf16 v[224:227],a[196:199],v[92:95],v[224:227]
v_exp_f32 v96,v96
v_mfma_f32_16x16x32_bf16 v[228:231],a[200:203],v[88:91],v[228:231]
ds_read_b64_tr_b16 a[192:193],v14 offset:32768
ds_read_b64_tr_b16 a[194:195],v14 offset:36864
v_mfma_f32_16x16x32_bf16 v[228:231],a[204:207],v[92:95],v[228:231]
v_exp_f32 v97,v97
v_mfma_f32_16x16x32_bf16 v[232:235],a[208:211],v[88:91],v[232:235]
ds_read_b64_tr_b16 a[196:197],v14 offset:40960
v_cvt_pk_bf16_f32 v80,v96,v97
v_mfma_f32_16x16x32_bf16 v[232:235],a[212:215],v[92:95],v[232:235]
v_exp_f32 v98,v98
v_mfma_f32_16x16x32_bf16 v[236:239],a[216:219],v[88:91],v[236:239]
ds_read_b64_tr_b16 a[198:199],v14 offset:45056
ds_read_b64_tr_b16 a[200:201],v15 offset:32768
v_mfma_f32_16x16x32_bf16 v[236:239],a[220:223],v[92:95],v[236:239]
v_exp_f32 v99,v99
v_mfma_f32_16x16x32_bf16 v[240:243],a[224:227],v[88:91],v[240:243]
ds_read_b64_tr_b16 a[202:203],v15 offset:36864
v_cvt_pk_bf16_f32 v81,v98,v99
v_mfma_f32_16x16x32_bf16 v[240:243],a[228:231],v[92:95],v[240:243]
v_exp_f32 v100,v100
v_mfma_f32_16x16x32_bf16 v[244:247],a[232:235],v[88:91],v[244:247]
ds_read_b64_tr_b16 a[204:205],v15 offset:40960
ds_read_b64_tr_b16 a[206:207],v15 offset:45056
v_mfma_f32_16x16x32_bf16 v[244:247],a[236:239],v[92:95],v[244:247]
v_exp_f32 v101,v101
v_mfma_f32_16x16x32_bf16 v[248:251],a[240:243],v[88:91],v[248:251]
ds_read_b64_tr_b16 a[208:209],v16 offset:32768
v_cvt_pk_bf16_f32 v82,v100,v101
v_mfma_f32_16x16x32_bf16 v[248:251],a[244:247],v[92:95],v[248:251]
v_exp_f32 v102,v102
v_mfma_f32_16x16x32_bf16 v[252:255],a[248:251],v[88:91],v[252:255]
ds_read_b64_tr_b16 a[210:211],v16 offset:36864
ds_read_b64_tr_b16 a[212:213],v16 offset:40960
v_mfma_f32_16x16x32_bf16 v[252:255],a[252:255],v[92:95],v[252:255]
v_exp_f32 v103,v103
v_mfma_f32_16x16x32_bf16 v[60:63],v[44:47],v[88:91],v[60:63]
ds_read_b64_tr_b16 a[214:215],v16 offset:45056
v_cvt_pk_bf16_f32 v83,v102,v103
v_mfma_f32_16x16x32_bf16 v[60:63],v[44:47],v[92:95],v[60:63]
v_exp_f32 v104,v104
v_mfma_f32_16x16x32_bf16 v[112:115],a[128:131],a[16:19],v[68:71]
ds_read_b64_tr_b16 a[216:217],v17 offset:32768
ds_read_b64_tr_b16 a[218:219],v17 offset:36864
v_mfma_f32_16x16x32_bf16 v[112:115],a[132:135],a[20:23],v[112:115]
v_exp_f32 v105,v105
v_mfma_f32_16x16x32_bf16 v[112:115],a[136:139],a[24:27],v[112:115]
ds_read_b64_tr_b16 a[220:221],v17 offset:40960
v_cvt_pk_bf16_f32 v84,v104,v105
v_mfma_f32_16x16x32_bf16 v[112:115],a[140:143],a[28:31],v[112:115]
v_exp_f32 v106,v106
v_mfma_f32_16x16x32_bf16 v[116:119],a[144:147],a[16:19],v[68:71]
ds_read_b64_tr_b16 a[222:223],v17 offset:45056
ds_read_b64_tr_b16 a[224:225],v18 offset:32768
v_mfma_f32_16x16x32_bf16 v[116:119],a[148:151],a[20:23],v[116:119]
v_exp_f32 v107,v107
v_mfma_f32_16x16x32_bf16 v[116:119],a[152:155],a[24:27],v[116:119]
ds_read_b64_tr_b16 a[226:227],v18 offset:36864
v_cvt_pk_bf16_f32 v85,v106,v107
v_mfma_f32_16x16x32_bf16 v[116:119],a[156:159],a[28:31],v[116:119]
v_exp_f32 v108,v108
v_mfma_f32_16x16x32_bf16 v[120:123],a[160:163],a[16:19],v[68:71]
ds_read_b64_tr_b16 a[228:229],v18 offset:40960
ds_read_b64_tr_b16 a[230:231],v18 offset:45056
v_mfma_f32_16x16x32_bf16 v[120:123],a[164:167],a[20:23],v[120:123]
v_exp_f32 v109,v109
v_mfma_f32_16x16x32_bf16 v[120:123],a[168:171],a[24:27],v[120:123]
ds_read_b64_tr_b16 a[232:233],v19 offset:32768
v_cvt_pk_bf16_f32 v86,v108,v109
v_mfma_f32_16x16x32_bf16 v[120:123],a[172:175],a[28:31],v[120:123]
s_mov_b32 s48,65536
v_exp_f32 v110,v110
v_mfma_f32_16x16x32_bf16 v[124:127],a[176:179],a[16:19],v[68:71]
ds_read_b64_tr_b16 a[234:235],v19 offset:36864
ds_read_b64_tr_b16 a[236:237],v19 offset:40960
s_add_u32 m0,s39,0
v_mfma_f32_16x16x32_bf16 v[124:127],a[180:183],a[20:23],v[124:127]
buffer_load_dwordx4 v4,s[8:11],s48 offen nt lds
v_exp_f32 v111,v111
v_mfma_f32_16x16x32_bf16 v[124:127],a[184:187],a[24:27],v[124:127]
ds_read_b64_tr_b16 a[238:239],v19 offset:45056
v_cvt_pk_bf16_f32 v87,v110,v111
v_mfma_f32_16x16x32_bf16 v[124:127],a[188:191],a[28:31],v[124:127]
ds_read_b64_tr_b16 a[240:241],v20 offset:32768
ds_read_b64_tr_b16 a[242:243],v20 offset:36864
v_mfma_f32_16x16x32_bf16 v[96:99],a[128:131],a[32:35],v[72:75]
ds_read_b64_tr_b16 a[244:245],v20 offset:40960
ds_read_b64_tr_b16 a[246:247],v20 offset:45056
v_mfma_f32_16x16x32_bf16 v[96:99],a[132:135],a[36:39],v[96:99]
v_exp_f32 v112,v112
v_mfma_f32_16x16x32_bf16 v[96:99],a[136:139],a[40:43],v[96:99]
ds_read_b64_tr_b16 a[248:249],v21 offset:32768
ds_read_b64_tr_b16 a[250:251],v21 offset:36864
v_mfma_f32_16x16x32_bf16 v[96:99],a[140:143],a[44:47],v[96:99]
v_exp_f32 v113,v113
v_mfma_f32_16x16x32_bf16 v[100:103],a[144:147],a[32:35],v[72:75]
ds_read_b64_tr_b16 a[252:253],v21 offset:40960
v_cvt_pk_bf16_f32 v88,v112,v113
v_mfma_f32_16x16x32_bf16 v[100:103],a[148:151],a[36:39],v[100:103]
v_exp_f32 v114,v114
v_mfma_f32_16x16x32_bf16 v[100:103],a[152:155],a[40:43],v[100:103]
ds_read_b64_tr_b16 a[254:255],v21 offset:45056
s_mov_b32 s60,s86
v_mfma_f32_16x16x32_bf16 v[100:103],a[156:159],a[44:47],v[100:103]
v_exp_f32 v115,v115
v_mfma_f32_16x16x32_bf16 v[104:107],a[160:163],a[32:35],v[72:75]
s_mov_b32 s61,s87
v_cvt_pk_bf16_f32 v89,v114,v115
v_mfma_f32_16x16x32_bf16 v[104:107],a[164:167],a[36:39],v[104:107]
v_exp_f32 v116,v116
v_mfma_f32_16x16x32_bf16 v[104:107],a[168:171],a[40:43],v[104:107]
s_mov_b32 s62,256
s_mov_b32 s63,0x20000
v_mfma_f32_16x16x32_bf16 v[104:107],a[172:175],a[44:47],v[104:107]
v_exp_f32 v117,v117
v_mfma_f32_16x16x32_bf16 v[108:111],a[176:179],a[32:35],v[72:75]
s_mov_b32 s56,s72
v_cvt_pk_bf16_f32 v90,v116,v117
v_mfma_f32_16x16x32_bf16 v[108:111],a[180:183],a[36:39],v[108:111]
buffer_load_dwordx4 v5,s[8:11],s48 offen offset:1024 nt lds
v_exp_f32 v118,v118
v_mfma_f32_16x16x32_bf16 v[108:111],a[184:187],a[40:43],v[108:111]
s_waitcnt lgkmcnt(0)
s_mov_b32 s57,s73
v_mfma_f32_16x16x32_bf16 v[108:111],a[188:191],a[44:47],v[108:111]
v_exp_f32 v119,v119
v_mfma_f32_16x16x32_bf16 v[128:131],a[192:195],v[80:83],v[128:131]
s_mov_b32 s58,15728640
v_cvt_pk_bf16_f32 v91,v118,v119
v_mfma_f32_16x16x32_bf16 v[128:131],a[196:199],v[84:87],v[128:131]
v_exp_f32 v120,v120
v_mfma_f32_16x16x32_bf16 v[132:135],a[200:203],v[80:83],v[132:135]
s_mov_b32 s59,0x20000
v_mfma_f32_16x16x32_bf16 v[132:135],a[204:207],v[84:87],v[132:135]
v_exp_f32 v121,v121
v_mfma_f32_16x16x32_bf16 v[136:139],a[208:211],v[80:83],v[136:139]
v_cvt_pk_bf16_f32 v92,v120,v121
v_mfma_f32_16x16x32_bf16 v[136:139],a[212:215],v[84:87],v[136:139]
v_exp_f32 v122,v122
v_mfma_f32_16x16x32_bf16 v[140:143],a[216:219],v[80:83],v[140:143]
v_mfma_f32_16x16x32_bf16 v[140:143],a[220:223],v[84:87],v[140:143]
v_exp_f32 v123,v123
v_mfma_f32_16x16x32_bf16 v[144:147],a[224:227],v[80:83],v[144:147]
v_cvt_pk_bf16_f32 v93,v122,v123
v_mfma_f32_16x16x32_bf16 v[144:147],a[228:231],v[84:87],v[144:147]
v_exp_f32 v124,v124
v_mfma_f32_16x16x32_bf16 v[148:151],a[232:235],v[80:83],v[148:151]
v_mfma_f32_16x16x32_bf16 v[148:151],a[236:239],v[84:87],v[148:151]
v_exp_f32 v125,v125
v_mfma_f32_16x16x32_bf16 v[152:155],a[240:243],v[80:83],v[152:155]
v_cvt_pk_bf16_f32 v94,v124,v125
v_mfma_f32_16x16x32_bf16 v[152:155],a[244:247],v[84:87],v[152:155]
buffer_load_dwordx4 v6,s[8:11],s48 offen offset:2048 nt lds
v_exp_f32 v126,v126
v_mfma_f32_16x16x32_bf16 v[156:159],a[248:251],v[80:83],v[156:159]
v_mfma_f32_16x16x32_bf16 v[156:159],a[252:255],v[84:87],v[156:159]
v_exp_f32 v127,v127
v_mfma_f32_16x16x32_bf16 v[48:51],v[44:47],v[80:83],v[48:51]
v_cvt_pk_bf16_f32 v95,v126,v127
v_mfma_f32_16x16x32_bf16 v[48:51],v[44:47],v[84:87],v[48:51]
s_waitcnt vmcnt(7)
s_barrier
v_mfma_f32_16x16x32_bf16 v[112:115],a[128:131],a[48:51],v[76:79]
v_mfma_f32_16x16x32_bf16 v[112:115],a[132:135],a[52:55],v[112:115]
v_exp_f32 v96,v96
v_mfma_f32_16x16x32_bf16 v[112:115],a[136:139],a[56:59],v[112:115]
v_mfma_f32_16x16x32_bf16 v[112:115],a[140:143],a[60:63],v[112:115]
v_exp_f32 v97,v97
v_mfma_f32_16x16x32_bf16 v[116:119],a[144:147],a[48:51],v[76:79]
ds_read_b128 a[128:131],v10 offset:49152
v_cvt_pk_bf16_f32 v80,v96,v97
v_mfma_f32_16x16x32_bf16 v[116:119],a[148:151],a[52:55],v[116:119]
v_exp_f32 v98,v98
v_mfma_f32_16x16x32_bf16 v[116:119],a[152:155],a[56:59],v[116:119]
ds_read_b128 a[132:135],v11 offset:49152
v_mfma_f32_16x16x32_bf16 v[116:119],a[156:159],a[60:63],v[116:119]
v_exp_f32 v99,v99
v_mfma_f32_16x16x32_bf16 v[120:123],a[160:163],a[48:51],v[76:79]
ds_read_b128 a[136:139],v12 offset:49152
v_cvt_pk_bf16_f32 v81,v98,v99
v_mfma_f32_16x16x32_bf16 v[120:123],a[164:167],a[52:55],v[120:123]
v_exp_f32 v100,v100
v_mfma_f32_16x16x32_bf16 v[120:123],a[168:171],a[56:59],v[120:123]
ds_read_b128 a[140:143],v13 offset:49152
v_mfma_f32_16x16x32_bf16 v[120:123],a[172:175],a[60:63],v[120:123]
v_exp_f32 v101,v101
v_mfma_f32_16x16x32_bf16 v[124:127],a[176:179],a[48:51],v[76:79]
ds_read_b128 a[144:147],v10 offset:53248
v_cvt_pk_bf16_f32 v82,v100,v101
v_mfma_f32_16x16x32_bf16 v[124:127],a[180:183],a[52:55],v[124:127]
buffer_load_dwordx4 v7,s[8:11],s48 offen offset:3072 nt lds
v_exp_f32 v102,v102
v_mfma_f32_16x16x32_bf16 v[124:127],a[184:187],a[56:59],v[124:127]
ds_read_b128 a[148:151],v11 offset:53248
v_mfma_f32_16x16x32_bf16 v[124:127],a[188:191],a[60:63],v[124:127]
v_exp_f32 v103,v103
v_mfma_f32_16x16x32_bf16 v[160:163],a[192:195],v[88:91],v[160:163]
ds_read_b128 a[152:155],v12 offset:53248
v_cvt_pk_bf16_f32 v83,v102,v103
v_mfma_f32_16x16x32_bf16 v[160:163],a[196:199],v[92:95],v[160:163]
v_exp_f32 v104,v104
v_mfma_f32_16x16x32_bf16 v[164:167],a[200:203],v[88:91],v[164:167]
ds_read_b128 a[156:159],v13 offset:53248
v_mfma_f32_16x16x32_bf16 v[164:167],a[204:207],v[92:95],v[164:167]
v_exp_f32 v105,v105
v_mfma_f32_16x16x32_bf16 v[168:171],a[208:211],v[88:91],v[168:171]
ds_read_b128 a[160:163],v10 offset:57344
v_cvt_pk_bf16_f32 v84,v104,v105
v_mfma_f32_16x16x32_bf16 v[168:171],a[212:215],v[92:95],v[168:171]
v_exp_f32 v106,v106
v_mfma_f32_16x16x32_bf16 v[172:175],a[216:219],v[88:91],v[172:175]
ds_read_b128 a[164:167],v11 offset:57344
v_mfma_f32_16x16x32_bf16 v[172:175],a[220:223],v[92:95],v[172:175]
v_exp_f32 v107,v107
v_mfma_f32_16x16x32_bf16 v[176:179],a[224:227],v[88:91],v[176:179]
ds_read_b128 a[168:171],v12 offset:57344
v_cvt_pk_bf16_f32 v85,v106,v107
v_mfma_f32_16x16x32_bf16 v[176:179],a[228:231],v[92:95],v[176:179]
v_exp_f32 v108,v108
v_mfma_f32_16x16x32_bf16 v[180:183],a[232:235],v[88:91],v[180:183]
ds_read_b128 a[172:175],v13 offset:57344
v_mfma_f32_16x16x32_bf16 v[180:183],a[236:239],v[92:95],v[180:183]
v_exp_f32 v109,v109
v_mfma_f32_16x16x32_bf16 v[184:187],a[240:243],v[88:91],v[184:187]
ds_read_b128 a[176:179],v10 offset:61440
v_cvt_pk_bf16_f32 v86,v108,v109
v_mfma_f32_16x16x32_bf16 v[184:187],a[244:247],v[92:95],v[184:187]
s_add_u32 m0,s39,65536
v_exp_f32 v110,v110
v_mfma_f32_16x16x32_bf16 v[188:191],a[248:251],v[88:91],v[188:191]
ds_read_b128 a[180:183],v11 offset:61440
v_mfma_f32_16x16x32_bf16 v[188:191],a[252:255],v[92:95],v[188:191]
buffer_load_dwordx4 v8,s[12:15],s48 offen nt lds
v_exp_f32 v111,v111
v_mfma_f32_16x16x32_bf16 v[52:55],v[44:47],v[88:91],v[52:55]
ds_read_b128 a[184:187],v12 offset:61440
v_cvt_pk_bf16_f32 v87,v110,v111
v_mfma_f32_16x16x32_bf16 v[52:55],v[44:47],v[92:95],v[52:55]
ds_read_b128 a[188:191],v13 offset:61440
v_mfma_f32_16x16x32_bf16 v[192:195],a[192:195],v[80:83],v[192:195]
v_mfma_f32_16x16x32_bf16 v[192:195],a[196:199],v[84:87],v[192:195]
v_exp_f32 v112,v112
v_mfma_f32_16x16x32_bf16 v[196:199],a[200:203],v[80:83],v[196:199]
v_mfma_f32_16x16x32_bf16 v[196:199],a[204:207],v[84:87],v[196:199]
v_exp_f32 v113,v113
v_mfma_f32_16x16x32_bf16 v[200:203],a[208:211],v[80:83],v[200:203]
v_cvt_pk_bf16_f32 v88,v112,v113
v_mfma_f32_16x16x32_bf16 v[200:203],a[212:215],v[84:87],v[200:203]
v_exp_f32 v114,v114
v_mfma_f32_16x16x32_bf16 v[204:207],a[216:219],v[80:83],v[204:207]
v_mfma_f32_16x16x32_bf16 v[204:207],a[220:223],v[84:87],v[204:207]
v_exp_f32 v115,v115
v_mfma_f32_16x16x32_bf16 v[208:211],a[224:227],v[80:83],v[208:211]
v_cvt_pk_bf16_f32 v89,v114,v115
v_mfma_f32_16x16x32_bf16 v[208:211],a[228:231],v[84:87],v[208:211]
v_exp_f32 v116,v116
v_mfma_f32_16x16x32_bf16 v[212:215],a[232:235],v[80:83],v[212:215]
v_mfma_f32_16x16x32_bf16 v[212:215],a[236:239],v[84:87],v[212:215]
v_exp_f32 v117,v117
v_mfma_f32_16x16x32_bf16 v[216:219],a[240:243],v[80:83],v[216:219]
buffer_load_dwordx4 v9,s[12:15],s48 offen offset:1024 nt lds
v_cvt_pk_bf16_f32 v90,v116,v117
v_mfma_f32_16x16x32_bf16 v[216:219],a[244:247],v[84:87],v[216:219]
v_exp_f32 v118,v118
v_mfma_f32_16x16x32_bf16 v[220:223],a[248:251],v[80:83],v[220:223]
s_waitcnt lgkmcnt(0)
v_mfma_f32_16x16x32_bf16 v[220:223],a[252:255],v[84:87],v[220:223]
v_exp_f32 v119,v119
v_mfma_f32_16x16x32_bf16 v[56:59],v[44:47],v[80:83],v[56:59]
v_cvt_pk_bf16_f32 v91,v118,v119
v_mfma_f32_16x16x32_bf16 v[56:59],v[44:47],v[84:87],v[56:59]
v_exp_f32 v120,v120
v_mfma_f32_16x16x32_bf16 v[96:99],a[128:131],a[0:3],v[64:67]
v_mfma_f32_16x16x32_bf16 v[96:99],a[132:135],a[4:7],v[96:99]
v_exp_f32 v121,v121
v_mfma_f32_16x16x32_bf16 v[96:99],a[136:139],a[8:11],v[96:99]
v_cvt_pk_bf16_f32 v92,v120,v121
v_mfma_f32_16x16x32_bf16 v[96:99],a[140:143],a[12:15],v[96:99]
v_exp_f32 v122,v122
v_mfma_f32_16x16x32_bf16 v[100:103],a[144:147],a[0:3],v[64:67]
v_mfma_f32_16x16x32_bf16 v[100:103],a[148:151],a[4:7],v[100:103]
v_exp_f32 v123,v123
v_mfma_f32_16x16x32_bf16 v[100:103],a[152:155],a[8:11],v[100:103]
v_cvt_pk_bf16_f32 v93,v122,v123
v_mfma_f32_16x16x32_bf16 v[100:103],a[156:159],a[12:15],v[100:103]
v_exp_f32 v124,v124
v_mfma_f32_16x16x32_bf16 v[104:107],a[160:163],a[0:3],v[64:67]
v_mfma_f32_16x16x32_bf16 v[104:107],a[164:167],a[4:7],v[104:107]
v_exp_f32 v125,v125
v_mfma_f32_16x16x32_bf16 v[104:107],a[168:171],a[8:11],v[104:107]
v_cvt_pk_bf16_f32 v94,v124,v125
v_mfma_f32_16x16x32_bf16 v[104:107],a[172:175],a[12:15],v[104:107]
buffer_load_dwordx4 v8,s[12:15],s48 offen offset:2048 nt lds
v_exp_f32 v126,v126
v_mfma_f32_16x16x32_bf16 v[108:111],a[176:179],a[0:3],v[64:67]
v_mfma_f32_16x16x32_bf16 v[108:111],a[180:183],a[4:7],v[108:111]
v_exp_f32 v127,v127
v_mfma_f32_16x16x32_bf16 v[108:111],a[184:187],a[8:11],v[108:111]
v_cvt_pk_bf16_f32 v95,v126,v127
v_mfma_f32_16x16x32_bf16 v[108:111],a[188:191],a[12:15],v[108:111]
v_mfma_f32_16x16x32_bf16 v[224:227],a[192:195],v[88:91],v[224:227]
v_mfma_f32_16x16x32_bf16 v[224:227],a[196:199],v[92:95],v[224:227]
v_exp_f32 v96,v96
v_mfma_f32_16x16x32_bf16 v[228:231],a[200:203],v[88:91],v[228:231]
ds_read_b64_tr_b16 a[192:193],v14 offset:49152
ds_read_b64_tr_b16 a[194:195],v14 offset:53248
v_mfma_f32_16x16x32_bf16 v[228:231],a[204:207],v[92:95],v[228:231]
v_exp_f32 v97,v97
v_mfma_f32_16x16x32_bf16 v[232:235],a[208:211],v[88:91],v[232:235]
ds_read_b64_tr_b16 a[196:197],v14 offset:57344
v_cvt_pk_bf16_f32 v80,v96,v97
v_mfma_f32_16x16x32_bf16 v[232:235],a[212:215],v[92:95],v[232:235]
v_exp_f32 v98,v98
v_mfma_f32_16x16x32_bf16 v[236:239],a[216:219],v[88:91],v[236:239]
ds_read_b64_tr_b16 a[198:199],v14 offset:61440
ds_read_b64_tr_b16 a[200:201],v15 offset:49152
v_mfma_f32_16x16x32_bf16 v[236:239],a[220:223],v[92:95],v[236:239]
v_exp_f32 v99,v99
v_mfma_f32_16x16x32_bf16 v[240:243],a[224:227],v[88:91],v[240:243]
ds_read_b64_tr_b16 a[202:203],v15 offset:53248
v_cvt_pk_bf16_f32 v81,v98,v99
v_mfma_f32_16x16x32_bf16 v[240:243],a[228:231],v[92:95],v[240:243]
v_exp_f32 v100,v100
v_mfma_f32_16x16x32_bf16 v[244:247],a[232:235],v[88:91],v[244:247]
ds_read_b64_tr_b16 a[204:205],v15 offset:57344
ds_read_b64_tr_b16 a[206:207],v15 offset:61440
v_mfma_f32_16x16x32_bf16 v[244:247],a[236:239],v[92:95],v[244:247]
v_exp_f32 v101,v101
v_mfma_f32_16x16x32_bf16 v[248:251],a[240:243],v[88:91],v[248:251]
ds_read_b64_tr_b16 a[208:209],v16 offset:49152
v_cvt_pk_bf16_f32 v82,v100,v101
v_mfma_f32_16x16x32_bf16 v[248:251],a[244:247],v[92:95],v[248:251]
buffer_load_dwordx4 v9,s[12:15],s48 offen offset:3072 nt lds
v_exp_f32 v102,v102
v_mfma_f32_16x16x32_bf16 v[252:255],a[248:251],v[88:91],v[252:255]
ds_read_b64_tr_b16 a[210:211],v16 offset:53248
ds_read_b64_tr_b16 a[212:213],v16 offset:57344
v_mfma_f32_16x16x32_bf16 v[252:255],a[252:255],v[92:95],v[252:255]
v_exp_f32 v103,v103
v_mfma_f32_16x16x32_bf16 v[60:63],v[44:47],v[88:91],v[60:63]
ds_read_b64_tr_b16 a[214:215],v16 offset:61440
v_cvt_pk_bf16_f32 v83,v102,v103
v_mfma_f32_16x16x32_bf16 v[60:63],v[44:47],v[92:95],v[60:63]
v_exp_f32 v104,v104
v_mfma_f32_16x16x32_bf16 v[112:115],a[128:131],a[16:19],v[68:71]
ds_read_b64_tr_b16 a[216:217],v17 offset:49152
ds_read_b64_tr_b16 a[218:219],v17 offset:53248
v_mfma_f32_16x16x32_bf16 v[112:115],a[132:135],a[20:23],v[112:115]
v_exp_f32 v105,v105
v_mfma_f32_16x16x32_bf16 v[112:115],a[136:139],a[24:27],v[112:115]
ds_read_b64_tr_b16 a[220:221],v17 offset:57344
v_cvt_pk_bf16_f32 v84,v104,v105
v_mfma_f32_16x16x32_bf16 v[112:115],a[140:143],a[28:31],v[112:115]
v_exp_f32 v106,v106
v_mfma_f32_16x16x32_bf16 v[116:119],a[144:147],a[16:19],v[68:71]
ds_read_b64_tr_b16 a[222:223],v17 offset:61440
ds_read_b64_tr_b16 a[224:225],v18 offset:49152
v_mfma_f32_16x16x32_bf16 v[116:119],a[148:151],a[20:23],v[116:119]
v_exp_f32 v107,v107
v_mfma_f32_16x16x32_bf16 v[116:119],a[152:155],a[24:27],v[116:119]
ds_read_b64_tr_b16 a[226:227],v18 offset:53248
v_cvt_pk_bf16_f32 v85,v106,v107
v_mfma_f32_16x16x32_bf16 v[116:119],a[156:159],a[28:31],v[116:119]
v_exp_f32 v108,v108
v_mfma_f32_16x16x32_bf16 v[120:123],a[160:163],a[16:19],v[68:71]
ds_read_b64_tr_b16 a[228:229],v18 offset:57344
ds_read_b64_tr_b16 a[230:231],v18 offset:61440
v_mfma_f32_16x16x32_bf16 v[120:123],a[164:167],a[20:23],v[120:123]
v_exp_f32 v109,v109
v_mfma_f32_16x16x32_bf16 v[120:123],a[168:171],a[24:27],v[120:123]
ds_read_b64_tr_b16 a[232:233],v19 offset:49152
v_cvt_pk_bf16_f32 v86,v108,v109
v_mfma_f32_16x16x32_bf16 v[120:123],a[172:175],a[28:31],v[120:123]
s_mov_b32 s48,81920
v_exp_f32 v110,v110
v_mfma_f32_16x16x32_bf16 v[124:127],a[176:179],a[16:19],v[68:71]
ds_read_b64_tr_b16 a[234:235],v19 offset:53248
ds_read_b64_tr_b16 a[236:237],v19 offset:57344
s_add_u32 m0,s39,16384
v_mfma_f32_16x16x32_bf16 v[124:127],a[180:183],a[20:23],v[124:127]
buffer_load_dwordx4 v4,s[8:11],s48 offen nt lds
v_exp_f32 v111,v111
v_mfma_f32_16x16x32_bf16 v[124:127],a[184:187],a[24:27],v[124:127]
ds_read_b64_tr_b16 a[238:239],v19 offset:61440
v_cvt_pk_bf16_f32 v87,v110,v111
v_mfma_f32_16x16x32_bf16 v[124:127],a[188:191],a[28:31],v[124:127]
ds_read_b64_tr_b16 a[240:241],v20 offset:49152
ds_read_b64_tr_b16 a[242:243],v20 offset:53248
v_mfma_f32_16x16x32_bf16 v[96:99],a[128:131],a[32:35],v[72:75]
ds_read_b64_tr_b16 a[244:245],v20 offset:57344
ds_read_b64_tr_b16 a[246:247],v20 offset:61440
v_mfma_f32_16x16x32_bf16 v[96:99],a[132:135],a[36:39],v[96:99]
v_exp_f32 v112,v112
v_mfma_f32_16x16x32_bf16 v[96:99],a[136:139],a[40:43],v[96:99]
ds_read_b64_tr_b16 a[248:249],v21 offset:49152
ds_read_b64_tr_b16 a[250:251],v21 offset:53248
v_mfma_f32_16x16x32_bf16 v[96:99],a[140:143],a[44:47],v[96:99]
v_exp_f32 v113,v113
v_mfma_f32_16x16x32_bf16 v[100:103],a[144:147],a[32:35],v[72:75]
ds_read_b64_tr_b16 a[252:253],v21 offset:57344
v_cvt_pk_bf16_f32 v88,v112,v113
v_mfma_f32_16x16x32_bf16 v[100:103],a[148:151],a[36:39],v[100:103]
v_exp_f32 v114,v114
v_mfma_f32_16x16x32_bf16 v[100:103],a[152:155],a[40:43],v[100:103]
ds_read_b64_tr_b16 a[254:255],v21 offset:61440
v_mfma_f32_16x16x32_bf16 v[100:103],a[156:159],a[44:47],v[100:103]
v_exp_f32 v115,v115
v_mfma_f32_16x16x32_bf16 v[104:107],a[160:163],a[32:35],v[72:75]
v_cvt_pk_bf16_f32 v89,v114,v115
v_mfma_f32_16x16x32_bf16 v[104:107],a[164:167],a[36:39],v[104:107]
v_exp_f32 v116,v116
v_mfma_f32_16x16x32_bf16 v[104:107],a[168:171],a[40:43],v[104:107]
v_mfma_f32_16x16x32_bf16 v[104:107],a[172:175],a[44:47],v[104:107]
v_exp_f32 v117,v117
v_mfma_f32_16x16x32_bf16 v[108:111],a[176:179],a[32:35],v[72:75]
buffer_load_dwordx4 v5,s[8:11],s48 offen offset:1024 nt lds
v_cvt_pk_bf16_f32 v90,v116,v117
v_mfma_f32_16x16x32_bf16 v[108:111],a[180:183],a[36:39],v[108:111]
v_exp_f32 v118,v118
v_mfma_f32_16x16x32_bf16 v[108:111],a[184:187],a[40:43],v[108:111]
s_waitcnt lgkmcnt(0)
v_mfma_f32_16x16x32_bf16 v[108:111],a[188:191],a[44:47],v[108:111]
v_exp_f32 v119,v119
v_mfma_f32_16x16x32_bf16 v[128:131],a[192:195],v[80:83],v[128:131]
v_cvt_pk_bf16_f32 v91,v118,v119
v_mfma_f32_16x16x32_bf16 v[128:131],a[196:199],v[84:87],v[128:131]
v_exp_f32 v120,v120
v_mfma_f32_16x16x32_bf16 v[132:135],a[200:203],v[80:83],v[132:135]
v_mfma_f32_16x16x32_bf16 v[132:135],a[204:207],v[84:87],v[132:135]
v_exp_f32 v121,v121
v_mfma_f32_16x16x32_bf16 v[136:139],a[208:211],v[80:83],v[136:139]
v_cvt_pk_bf16_f32 v92,v120,v121
v_mfma_f32_16x16x32_bf16 v[136:139],a[212:215],v[84:87],v[136:139]
v_exp_f32 v122,v122
v_mfma_f32_16x16x32_bf16 v[140:143],a[216:219],v[80:83],v[140:143]
v_mfma_f32_16x16x32_bf16 v[140:143],a[220:223],v[84:87],v[140:143]
v_exp_f32 v123,v123
v_mfma_f32_16x16x32_bf16 v[144:147],a[224:227],v[80:83],v[144:147]
v_cvt_pk_bf16_f32 v93,v122,v123
v_mfma_f32_16x16x32_bf16 v[144:147],a[228:231],v[84:87],v[144:147]
v_exp_f32 v124,v124
v_mfma_f32_16x16x32_bf16 v[148:151],a[232:235],v[80:83],v[148:151]
v_mfma_f32_16x16x32_bf16 v[148:151],a[236:239],v[84:87],v[148:151]
v_exp_f32 v125,v125
v_mfma_f32_16x16x32_bf16 v[152:155],a[240:243],v[80:83],v[152:155]
v_cvt_pk_bf16_f32 v94,v124,v125
v_mfma_f32_16x16x32_bf16 v[152:155],a[244:247],v[84:87],v[152:155]
buffer_load_dwordx4 v6,s[8:11],s48 offen offset:2048 nt lds
v_exp_f32 v126,v126
v_mfma_f32_16x16x32_bf16 v[156:159],a[248:251],v[80:83],v[156:159]
v_mfma_f32_16x16x32_bf16 v[156:159],a[252:255],v[84:87],v[156:159]
v_exp_f32 v127,v127
v_mfma_f32_16x16x32_bf16 v[48:51],v[44:47],v[80:83],v[48:51]
v_cvt_pk_bf16_f32 v95,v126,v127
v_mfma_f32_16x16x32_bf16 v[48:51],v[44:47],v[84:87],v[48:51]
s_waitcnt vmcnt(3)
s_barrier
v_mfma_f32_16x16x32_bf16 v[112:115],a[128:131],a[48:51],v[76:79]
v_mfma_f32_16x16x32_bf16 v[112:115],a[132:135],a[52:55],v[112:115]
v_exp_f32 v96,v96
v_mfma_f32_16x16x32_bf16 v[112:115],a[136:139],a[56:59],v[112:115]
v_mfma_f32_16x16x32_bf16 v[112:115],a[140:143],a[60:63],v[112:115]
v_exp_f32 v97,v97
v_mfma_f32_16x16x32_bf16 v[116:119],a[144:147],a[48:51],v[76:79]
ds_read_b128 a[128:131],v10 offset:0
v_cvt_pk_bf16_f32 v80,v96,v97
v_mfma_f32_16x16x32_bf16 v[116:119],a[148:151],a[52:55],v[116:119]
v_exp_f32 v98,v98
v_mfma_f32_16x16x32_bf16 v[116:119],a[152:155],a[56:59],v[116:119]
ds_read_b128 a[132:135],v11 offset:0
v_mfma_f32_16x16x32_bf16 v[116:119],a[156:159],a[60:63],v[116:119]
v_exp_f32 v99,v99
v_mfma_f32_16x16x32_bf16 v[120:123],a[160:163],a[48:51],v[76:79]
ds_read_b128 a[136:139],v12 offset:0
v_cvt_pk_bf16_f32 v81,v98,v99
v_mfma_f32_16x16x32_bf16 v[120:123],a[164:167],a[52:55],v[120:123]
v_exp_f32 v100,v100
v_mfma_f32_16x16x32_bf16 v[120:123],a[168:171],a[56:59],v[120:123]
ds_read_b128 a[140:143],v13 offset:0
v_mfma_f32_16x16x32_bf16 v[120:123],a[172:175],a[60:63],v[120:123]
v_exp_f32 v101,v101
v_mfma_f32_16x16x32_bf16 v[124:127],a[176:179],a[48:51],v[76:79]
ds_read_b128 a[144:147],v10 offset:4096
v_cvt_pk_bf16_f32 v82,v100,v101
v_mfma_f32_16x16x32_bf16 v[124:127],a[180:183],a[52:55],v[124:127]
buffer_load_dwordx4 v7,s[8:11],s48 offen offset:3072 nt lds
v_exp_f32 v102,v102
v_mfma_f32_16x16x32_bf16 v[124:127],a[184:187],a[56:59],v[124:127]
ds_read_b128 a[148:151],v11 offset:4096
v_mfma_f32_16x16x32_bf16 v[124:127],a[188:191],a[60:63],v[124:127]
v_exp_f32 v103,v103
v_mfma_f32_16x16x32_bf16 v[160:163],a[192:195],v[88:91],v[160:163]
ds_read_b128 a[152:155],v12 offset:4096
v_cvt_pk_bf16_f32 v83,v102,v103
v_mfma_f32_16x16x32_bf16 v[160:163],a[196:199],v[92:95],v[160:163]
v_exp_f32 v104,v104
v_mfma_f32_16x16x32_bf16 v[164:167],a[200:203],v[88:91],v[164:167]
ds_read_b128 a[156:159],v13 offset:4096
v_mfma_f32_16x16x32_bf16 v[164:167],a[204:207],v[92:95],v[164:167]
v_exp_f32 v105,v105
v_mfma_f32_16x16x32_bf16 v[168:171],a[208:211],v[88:91],v[168:171]
ds_read_b128 a[160:163],v10 offset:8192
v_cvt_pk_bf16_f32 v84,v104,v105
v_mfma_f32_16x16x32_bf16 v[168:171],a[212:215],v[92:95],v[168:171]
v_exp_f32 v106,v106
v_mfma_f32_16x16x32_bf16 v[172:175],a[216:219],v[88:91],v[172:175]
ds_read_b128 a[164:167],v11 offset:8192
v_mfma_f32_16x16x32_bf16 v[172:175],a[220:223],v[92:95],v[172:175]
v_exp_f32 v107,v107
v_mfma_f32_16x16x32_bf16 v[176:179],a[224:227],v[88:91],v[176:179]
ds_read_b128 a[168:171],v12 offset:8192
v_cvt_pk_bf16_f32 v85,v106,v107
v_mfma_f32_16x16x32_bf16 v[176:179],a[228:231],v[92:95],v[176:179]
v_exp_f32 v108,v108
v_mfma_f32_16x16x32_bf16 v[180:183],a[232:235],v[88:91],v[180:183]
ds_read_b128 a[172:175],v13 offset:8192
v_mfma_f32_16x16x32_bf16 v[180:183],a[236:239],v[92:95],v[180:183]
v_exp_f32 v109,v109
v_mfma_f32_16x16x32_bf16 v[184:187],a[240:243],v[88:91],v[184:187]
ds_read_b128 a[176:179],v10 offset:12288
v_cvt_pk_bf16_f32 v86,v108,v109
v_mfma_f32_16x16x32_bf16 v[184:187],a[244:247],v[92:95],v[184:187]
s_add_u32 m0,s39,81920
v_exp_f32 v110,v110
v_mfma_f32_16x16x32_bf16 v[188:191],a[248:251],v[88:91],v[188:191]
ds_read_b128 a[180:183],v11 offset:12288
v_mfma_f32_16x16x32_bf16 v[188:191],a[252:255],v[92:95],v[188:191]
buffer_load_dwordx4 v8,s[12:15],s48 offen nt lds
v_exp_f32 v111,v111
v_mfma_f32_16x16x32_bf16 v[52:55],v[44:47],v[88:91],v[52:55]
ds_read_b128 a[184:187],v12 offset:12288
v_cvt_pk_bf16_f32 v87,v110,v111
v_mfma_f32_16x16x32_bf16 v[52:55],v[44:47],v[92:95],v[52:55]
ds_read_b128 a[188:191],v13 offset:12288
v_mfma_f32_16x16x32_bf16 v[192:195],a[192:195],v[80:83],v[192:195]
v_mfma_f32_16x16x32_bf16 v[192:195],a[196:199],v[84:87],v[192:195]
v_exp_f32 v112,v112
v_mfma_f32_16x16x32_bf16 v[196:199],a[200:203],v[80:83],v[196:199]
v_mfma_f32_16x16x32_bf16 v[196:199],a[204:207],v[84:87],v[196:199]
v_exp_f32 v113,v113
v_mfma_f32_16x16x32_bf16 v[200:203],a[208:211],v[80:83],v[200:203]
v_cvt_pk_bf16_f32 v88,v112,v113
v_mfma_f32_16x16x32_bf16 v[200:203],a[212:215],v[84:87],v[200:203]
v_exp_f32 v114,v114
v_mfma_f32_16x16x32_bf16 v[204:207],a[216:219],v[80:83],v[204:207]
v_mfma_f32_16x16x32_bf16 v[204:207],a[220:223],v[84:87],v[204:207]
v_exp_f32 v115,v115
v_mfma_f32_16x16x32_bf16 v[208:211],a[224:227],v[80:83],v[208:211]
v_cvt_pk_bf16_f32 v89,v114,v115
v_mfma_f32_16x16x32_bf16 v[208:211],a[228:231],v[84:87],v[208:211]
v_exp_f32 v116,v116
v_mfma_f32_16x16x32_bf16 v[212:215],a[232:235],v[80:83],v[212:215]
v_mfma_f32_16x16x32_bf16 v[212:215],a[236:239],v[84:87],v[212:215]
v_exp_f32 v117,v117
v_mfma_f32_16x16x32_bf16 v[216:219],a[240:243],v[80:83],v[216:219]
buffer_load_dwordx4 v9,s[12:15],s48 offen offset:1024 nt lds
v_cvt_pk_bf16_f32 v90,v116,v117
v_mfma_f32_16x16x32_bf16 v[216:219],a[244:247],v[84:87],v[216:219]
v_exp_f32 v118,v118
v_mfma_f32_16x16x32_bf16 v[220:223],a[248:251],v[80:83],v[220:223]
s_waitcnt lgkmcnt(0)
v_mfma_f32_16x16x32_bf16 v[220:223],a[252:255],v[84:87],v[220:223]
v_exp_f32 v119,v119
v_mfma_f32_16x16x32_bf16 v[56:59],v[44:47],v[80:83],v[56:59]
v_cvt_pk_bf16_f32 v91,v118,v119
v_mfma_f32_16x16x32_bf16 v[56:59],v[44:47],v[84:87],v[56:59]
v_exp_f32 v120,v120
v_mfma_f32_16x16x32_bf16 v[96:99],a[128:131],a[0:3],v[64:67]
v_mfma_f32_16x16x32_bf16 v[96:99],a[132:135],a[4:7],v[96:99]
v_exp_f32 v121,v121
v_mfma_f32_16x16x32_bf16 v[96:99],a[136:139],a[8:11],v[96:99]
v_cvt_pk_bf16_f32 v92,v120,v121
v_mfma_f32_16x16x32_bf16 v[96:99],a[140:143],a[12:15],v[96:99]
v_exp_f32 v122,v122
v_mfma_f32_16x16x32_bf16 v[100:103],a[144:147],a[0:3],v[64:67]
v_mfma_f32_16x16x32_bf16 v[100:103],a[148:151],a[4:7],v[100:103]
v_exp_f32 v123,v123
v_mfma_f32_16x16x32_bf16 v[100:103],a[152:155],a[8:11],v[100:103]
v_cvt_pk_bf16_f32 v93,v122,v123
v_mfma_f32_16x16x32_bf16 v[100:103],a[156:159],a[12:15],v[100:103]
v_exp_f32 v124,v124
v_mfma_f32_16x16x32_bf16 v[104:107],a[160:163],a[0:3],v[64:67]
v_mfma_f32_16x16x32_bf16 v[104:107],a[164:167],a[4:7],v[104:107]
v_exp_f32 v125,v125
v_mfma_f32_16x16x32_bf16 v[104:107],a[168:171],a[8:11],v[104:107]
v_cvt_pk_bf16_f32 v94,v124,v125
v_mfma_f32_16x16x32_bf16 v[104:107],a[172:175],a[12:15],v[104:107]
buffer_load_dwordx4 v8,s[12:15],s48 offen offset:2048 nt lds
v_exp_f32 v126,v126
v_mfma_f32_16x16x32_bf16 v[108:111],a[176:179],a[0:3],v[64:67]
v_mfma_f32_16x16x32_bf16 v[108:111],a[180:183],a[4:7],v[108:111]
v_exp_f32 v127,v127
v_mfma_f32_16x16x32_bf16 v[108:111],a[184:187],a[8:11],v[108:111]
v_cvt_pk_bf16_f32 v95,v126,v127
v_mfma_f32_16x16x32_bf16 v[108:111],a[188:191],a[12:15],v[108:111]
v_mfma_f32_16x16x32_bf16 v[224:227],a[192:195],v[88:91],v[224:227]
v_mfma_f32_16x16x32_bf16 v[224:227],a[196:199],v[92:95],v[224:227]
v_exp_f32 v96,v96
v_mfma_f32_16x16x32_bf16 v[228:231],a[200:203],v[88:91],v[228:231]
ds_read_b64_tr_b16 a[192:193],v14 offset:0
ds_read_b64_tr_b16 a[194:195],v14 offset:4096
v_mfma_f32_16x16x32_bf16 v[228:231],a[204:207],v[92:95],v[228:231]
v_exp_f32 v97,v97
v_mfma_f32_16x16x32_bf16 v[232:235],a[208:211],v[88:91],v[232:235]
ds_read_b64_tr_b16 a[196:197],v14 offset:8192
v_cvt_pk_bf16_f32 v80,v96,v97
v_mfma_f32_16x16x32_bf16 v[232:235],a[212:215],v[92:95],v[232:235]
v_exp_f32 v98,v98
v_mfma_f32_16x16x32_bf16 v[236:239],a[216:219],v[88:91],v[236:239]
ds_read_b64_tr_b16 a[198:199],v14 offset:12288
ds_read_b64_tr_b16 a[200:201],v15 offset:0
v_mfma_f32_16x16x32_bf16 v[236:239],a[220:223],v[92:95],v[236:239]
v_exp_f32 v99,v99
v_mfma_f32_16x16x32_bf16 v[240:243],a[224:227],v[88:91],v[240:243]
ds_read_b64_tr_b16 a[202:203],v15 offset:4096
v_cvt_pk_bf16_f32 v81,v98,v99
v_mfma_f32_16x16x32_bf16 v[240:243],a[228:231],v[92:95],v[240:243]
v_exp_f32 v100,v100
v_mfma_f32_16x16x32_bf16 v[244:247],a[232:235],v[88:91],v[244:247]
ds_read_b64_tr_b16 a[204:205],v15 offset:8192
ds_read_b64_tr_b16 a[206:207],v15 offset:12288
v_mfma_f32_16x16x32_bf16 v[244:247],a[236:239],v[92:95],v[244:247]
v_exp_f32 v101,v101
v_mfma_f32_16x16x32_bf16 v[248:251],a[240:243],v[88:91],v[248:251]
ds_read_b64_tr_b16 a[208:209],v16 offset:0
v_cvt_pk_bf16_f32 v82,v100,v101
v_mfma_f32_16x16x32_bf16 v[248:251],a[244:247],v[92:95],v[248:251]
buffer_load_dwordx4 v9,s[12:15],s48 offen offset:3072 nt lds
v_exp_f32 v102,v102
v_mfma_f32_16x16x32_bf16 v[252:255],a[248:251],v[88:91],v[252:255]
ds_read_b64_tr_b16 a[210:211],v16 offset:4096
ds_read_b64_tr_b16 a[212:213],v16 offset:8192
v_mfma_f32_16x16x32_bf16 v[252:255],a[252:255],v[92:95],v[252:255]
v_exp_f32 v103,v103
v_mfma_f32_16x16x32_bf16 v[60:63],v[44:47],v[88:91],v[60:63]
ds_read_b64_tr_b16 a[214:215],v16 offset:12288
v_cvt_pk_bf16_f32 v83,v102,v103
v_mfma_f32_16x16x32_bf16 v[60:63],v[44:47],v[92:95],v[60:63]
v_exp_f32 v104,v104
v_mfma_f32_16x16x32_bf16 v[112:115],a[128:131],a[16:19],v[68:71]
ds_read_b64_tr_b16 a[216:217],v17 offset:0
ds_read_b64_tr_b16 a[218:219],v17 offset:4096
v_mfma_f32_16x16x32_bf16 v[112:115],a[132:135],a[20:23],v[112:115]
v_exp_f32 v105,v105
v_mfma_f32_16x16x32_bf16 v[112:115],a[136:139],a[24:27],v[112:115]
ds_read_b64_tr_b16 a[220:221],v17 offset:8192
v_cvt_pk_bf16_f32 v84,v104,v105
v_mfma_f32_16x16x32_bf16 v[112:115],a[140:143],a[28:31],v[112:115]
v_exp_f32 v106,v106
v_mfma_f32_16x16x32_bf16 v[116:119],a[144:147],a[16:19],v[68:71]
ds_read_b64_tr_b16 a[222:223],v17 offset:12288
ds_read_b64_tr_b16 a[224:225],v18 offset:0
v_mfma_f32_16x16x32_bf16 v[116:119],a[148:151],a[20:23],v[116:119]
v_exp_f32 v107,v107
v_mfma_f32_16x16x32_bf16 v[116:119],a[152:155],a[24:27],v[116:119]
ds_read_b64_tr_b16 a[226:227],v18 offset:4096
v_cvt_pk_bf16_f32 v85,v106,v107
v_mfma_f32_16x16x32_bf16 v[116:119],a[156:159],a[28:31],v[116:119]
v_exp_f32 v108,v108
v_mfma_f32_16x16x32_bf16 v[120:123],a[160:163],a[16:19],v[68:71]
ds_read_b64_tr_b16 a[228:229],v18 offset:8192
ds_read_b64_tr_b16 a[230:231],v18 offset:12288
v_mfma_f32_16x16x32_bf16 v[120:123],a[164:167],a[20:23],v[120:123]
v_exp_f32 v109,v109
v_mfma_f32_16x16x32_bf16 v[120:123],a[168:171],a[24:27],v[120:123]
ds_read_b64_tr_b16 a[232:233],v19 offset:0
v_cvt_pk_bf16_f32 v86,v108,v109
v_mfma_f32_16x16x32_bf16 v[120:123],a[172:175],a[28:31],v[120:123]
s_mov_b32 s48,98304
v_exp_f32 v110,v110
v_mfma_f32_16x16x32_bf16 v[124:127],a[176:179],a[16:19],v[68:71]
ds_read_b64_tr_b16 a[234:235],v19 offset:4096
ds_read_b64_tr_b16 a[236:237],v19 offset:8192
s_add_u32 m0,s39,32768
v_mfma_f32_16x16x32_bf16 v[124:127],a[180:183],a[20:23],v[124:127]
buffer_load_dwordx4 v4,s[8:11],s48 offen nt lds
v_exp_f32 v111,v111
v_mfma_f32_16x16x32_bf16 v[124:127],a[184:187],a[24:27],v[124:127]
ds_read_b64_tr_b16 a[238:239],v19 offset:12288
v_cvt_pk_bf16_f32 v87,v110,v111
v_mfma_f32_16x16x32_bf16 v[124:127],a[188:191],a[28:31],v[124:127]
ds_read_b64_tr_b16 a[240:241],v20 offset:0
ds_read_b64_tr_b16 a[242:243],v20 offset:4096
v_mfma_f32_16x16x32_bf16 v[96:99],a[128:131],a[32:35],v[72:75]
ds_read_b64_tr_b16 a[244:245],v20 offset:8192
ds_read_b64_tr_b16 a[246:247],v20 offset:12288
v_mfma_f32_16x16x32_bf16 v[96:99],a[132:135],a[36:39],v[96:99]
v_exp_f32 v112,v112
v_mfma_f32_16x16x32_bf16 v[96:99],a[136:139],a[40:43],v[96:99]
ds_read_b64_tr_b16 a[248:249],v21 offset:0
ds_read_b64_tr_b16 a[250:251],v21 offset:4096
v_mfma_f32_16x16x32_bf16 v[96:99],a[140:143],a[44:47],v[96:99]
v_exp_f32 v113,v113
v_mfma_f32_16x16x32_bf16 v[100:103],a[144:147],a[32:35],v[72:75]
ds_read_b64_tr_b16 a[252:253],v21 offset:8192
v_cvt_pk_bf16_f32 v88,v112,v113
v_mfma_f32_16x16x32_bf16 v[100:103],a[148:151],a[36:39],v[100:103]
v_exp_f32 v114,v114
v_mfma_f32_16x16x32_bf16 v[100:103],a[152:155],a[40:43],v[100:103]
ds_read_b64_tr_b16 a[254:255],v21 offset:12288
v_mfma_f32_16x16x32_bf16 v[100:103],a[156:159],a[44:47],v[100:103]
v_exp_f32 v115,v115
v_mfma_f32_16x16x32_bf16 v[104:107],a[160:163],a[32:35],v[72:75]
v_cvt_pk_bf16_f32 v89,v114,v115
v_mfma_f32_16x16x32_bf16 v[104:107],a[164:167],a[36:39],v[104:107]
v_exp_f32 v116,v116
v_mfma_f32_16x16x32_bf16 v[104:107],a[168:171],a[40:43],v[104:107]
v_mfma_f32_16x16x32_bf16 v[104:107],a[172:175],a[44:47],v[104:107]
v_exp_f32 v117,v117
v_mfma_f32_16x16x32_bf16 v[108:111],a[176:179],a[32:35],v[72:75]
buffer_load_dwordx4 v5,s[8:11],s48 offen offset:1024 nt lds
v_cvt_pk_bf16_f32 v90,v116,v117
v_mfma_f32_16x16x32_bf16 v[108:111],a[180:183],a[36:39],v[108:111]
v_exp_f32 v118,v118
v_mfma_f32_16x16x32_bf16 v[108:111],a[184:187],a[40:43],v[108:111]
s_waitcnt lgkmcnt(0)
v_mfma_f32_16x16x32_bf16 v[108:111],a[188:191],a[44:47],v[108:111]
v_exp_f32 v119,v119
v_mfma_f32_16x16x32_bf16 v[128:131],a[192:195],v[80:83],v[128:131]
v_cvt_pk_bf16_f32 v91,v118,v119
v_mfma_f32_16x16x32_bf16 v[128:131],a[196:199],v[84:87],v[128:131]
v_exp_f32 v120,v120
v_mfma_f32_16x16x32_bf16 v[132:135],a[200:203],v[80:83],v[132:135]
v_mfma_f32_16x16x32_bf16 v[132:135],a[204:207],v[84:87],v[132:135]
v_exp_f32 v121,v121
v_mfma_f32_16x16x32_bf16 v[136:139],a[208:211],v[80:83],v[136:139]
v_cvt_pk_bf16_f32 v92,v120,v121
v_mfma_f32_16x16x32_bf16 v[136:139],a[212:215],v[84:87],v[136:139]
v_exp_f32 v122,v122
v_mfma_f32_16x16x32_bf16 v[140:143],a[216:219],v[80:83],v[140:143]
v_mfma_f32_16x16x32_bf16 v[140:143],a[220:223],v[84:87],v[140:143]
v_exp_f32 v123,v123
v_mfma_f32_16x16x32_bf16 v[144:147],a[224:227],v[80:83],v[144:147]
v_cvt_pk_bf16_f32 v93,v122,v123
v_mfma_f32_16x16x32_bf16 v[144:147],a[228:231],v[84:87],v[144:147]
v_exp_f32 v124,v124
v_mfma_f32_16x16x32_bf16 v[148:151],a[232:235],v[80:83],v[148:151]
v_mfma_f32_16x16x32_bf16 v[148:151],a[236:239],v[84:87],v[148:151]
v_exp_f32 v125,v125
v_mfma_f32_16x16x32_bf16 v[152:155],a[240:243],v[80:83],v[152:155]
v_cvt_pk_bf16_f32 v94,v124,v125
v_mfma_f32_16x16x32_bf16 v[152:155],a[244:247],v[84:87],v[152:155]
buffer_load_dwordx4 v6,s[8:11],s48 offen offset:2048 nt lds
v_exp_f32 v126,v126
v_mfma_f32_16x16x32_bf16 v[156:159],a[248:251],v[80:83],v[156:159]
v_mfma_f32_16x16x32_bf16 v[156:159],a[252:255],v[84:87],v[156:159]
v_exp_f32 v127,v127
v_mfma_f32_16x16x32_bf16 v[48:51],v[44:47],v[80:83],v[48:51]
v_cvt_pk_bf16_f32 v95,v126,v127
v_mfma_f32_16x16x32_bf16 v[48:51],v[44:47],v[84:87],v[48:51]
s_waitcnt vmcnt(3)
s_barrier
v_mfma_f32_16x16x32_bf16 v[112:115],a[128:131],a[48:51],v[76:79]
v_mfma_f32_16x16x32_bf16 v[112:115],a[132:135],a[52:55],v[112:115]
v_exp_f32 v96,v96
v_mfma_f32_16x16x32_bf16 v[112:115],a[136:139],a[56:59],v[112:115]
v_mfma_f32_16x16x32_bf16 v[112:115],a[140:143],a[60:63],v[112:115]
v_exp_f32 v97,v97
v_mfma_f32_16x16x32_bf16 v[116:119],a[144:147],a[48:51],v[76:79]
ds_read_b128 a[128:131],v10 offset:16384
v_cvt_pk_bf16_f32 v80,v96,v97
v_mfma_f32_16x16x32_bf16 v[116:119],a[148:151],a[52:55],v[116:119]
v_exp_f32 v98,v98
v_mfma_f32_16x16x32_bf16 v[116:119],a[152:155],a[56:59],v[116:119]
ds_read_b128 a[132:135],v11 offset:16384
v_mfma_f32_16x16x32_bf16 v[116:119],a[156:159],a[60:63],v[116:119]
v_exp_f32 v99,v99
v_mfma_f32_16x16x32_bf16 v[120:123],a[160:163],a[48:51],v[76:79]
ds_read_b128 a[136:139],v12 offset:16384
v_cvt_pk_bf16_f32 v81,v98,v99
v_mfma_f32_16x16x32_bf16 v[120:123],a[164:167],a[52:55],v[120:123]
v_exp_f32 v100,v100
v_mfma_f32_16x16x32_bf16 v[120:123],a[168:171],a[56:59],v[120:123]
ds_read_b128 a[140:143],v13 offset:16384
v_mfma_f32_16x16x32_bf16 v[120:123],a[172:175],a[60:63],v[120:123]
v_exp_f32 v101,v101
v_mfma_f32_16x16x32_bf16 v[124:127],a[176:179],a[48:51],v[76:79]
ds_read_b128 a[144:147],v10 offset:20480
v_cvt_pk_bf16_f32 v82,v100,v101
v_mfma_f32_16x16x32_bf16 v[124:127],a[180:183],a[52:55],v[124:127]
buffer_load_dwordx4 v7,s[8:11],s48 offen offset:3072 nt lds
v_exp_f32 v102,v102
v_mfma_f32_16x16x32_bf16 v[124:127],a[184:187],a[56:59],v[124:127]
ds_read_b128 a[148:151],v11 offset:20480
v_mfma_f32_16x16x32_bf16 v[124:127],a[188:191],a[60:63],v[124:127]
v_exp_f32 v103,v103
v_mfma_f32_16x16x32_bf16 v[160:163],a[192:195],v[88:91],v[160:163]
ds_read_b128 a[152:155],v12 offset:20480
v_cvt_pk_bf16_f32 v83,v102,v103
v_mfma_f32_16x16x32_bf16 v[160:163],a[196:199],v[92:95],v[160:163]
v_exp_f32 v104,v104
v_mfma_f32_16x16x32_bf16 v[164:167],a[200:203],v[88:91],v[164:167]
ds_read_b128 a[156:159],v13 offset:20480
v_mfma_f32_16x16x32_bf16 v[164:167],a[204:207],v[92:95],v[164:167]
v_exp_f32 v105,v105
v_mfma_f32_16x16x32_bf16 v[168:171],a[208:211],v[88:91],v[168:171]
ds_read_b128 a[160:163],v10 offset:24576
v_cvt_pk_bf16_f32 v84,v104,v105
v_mfma_f32_16x16x32_bf16 v[168:171],a[212:215],v[92:95],v[168:171]
v_exp_f32 v106,v106
v_mfma_f32_16x16x32_bf16 v[172:175],a[216:219],v[88:91],v[172:175]
ds_read_b128 a[164:167],v11 offset:24576
v_mfma_f32_16x16x32_bf16 v[172:175],a[220:223],v[92:95],v[172:175]
v_exp_f32 v107,v107
v_mfma_f32_16x16x32_bf16 v[176:179],a[224:227],v[88:91],v[176:179]
ds_read_b128 a[168:171],v12 offset:24576
v_cvt_pk_bf16_f32 v85,v106,v107
v_mfma_f32_16x16x32_bf16 v[176:179],a[228:231],v[92:95],v[176:179]
v_exp_f32 v108,v108
v_mfma_f32_16x16x32_bf16 v[180:183],a[232:235],v[88:91],v[180:183]
ds_read_b128 a[172:175],v13 offset:24576
v_mfma_f32_16x16x32_bf16 v[180:183],a[236:239],v[92:95],v[180:183]
v_exp_f32 v109,v109
v_mfma_f32_16x16x32_bf16 v[184:187],a[240:243],v[88:91],v[184:187]
ds_read_b128 a[176:179],v10 offset:28672
v_cvt_pk_bf16_f32 v86,v108,v109
v_mfma_f32_16x16x32_bf16 v[184:187],a[244:247],v[92:95],v[184:187]
s_add_u32 m0,s39,98304
v_exp_f32 v110,v110
v_mfma_f32_16x16x32_bf16 v[188:191],a[248:251],v[88:91],v[188:191]
ds_read_b128 a[180:183],v11 offset:28672
v_mfma_f32_16x16x32_bf16 v[188:191],a[252:255],v[92:95],v[188:191]
buffer_load_dwordx4 v8,s[12:15],s48 offen nt lds
v_exp_f32 v111,v111
v_mfma_f32_16x16x32_bf16 v[52:55],v[44:47],v[88:91],v[52:55]
ds_read_b128 a[184:187],v12 offset:28672
v_cvt_pk_bf16_f32 v87,v110,v111
v_mfma_f32_16x16x32_bf16 v[52:55],v[44:47],v[92:95],v[52:55]
ds_read_b128 a[188:191],v13 offset:28672
v_mfma_f32_16x16x32_bf16 v[192:195],a[192:195],v[80:83],v[192:195]
v_mfma_f32_16x16x32_bf16 v[192:195],a[196:199],v[84:87],v[192:195]
v_exp_f32 v112,v112
v_mfma_f32_16x16x32_bf16 v[196:199],a[200:203],v[80:83],v[196:199]
v_mfma_f32_16x16x32_bf16 v[196:199],a[204:207],v[84:87],v[196:199]
v_exp_f32 v113,v113
v_mfma_f32_16x16x32_bf16 v[200:203],a[208:211],v[80:83],v[200:203]
v_cvt_pk_bf16_f32 v88,v112,v113
v_mfma_f32_16x16x32_bf16 v[200:203],a[212:215],v[84:87],v[200:203]
v_exp_f32 v114,v114
v_mfma_f32_16x16x32_bf16 v[204:207],a[216:219],v[80:83],v[204:207]
v_mfma_f32_16x16x32_bf16 v[204:207],a[220:223],v[84:87],v[204:207]
v_exp_f32 v115,v115
v_mfma_f32_16x16x32_bf16 v[208:211],a[224:227],v[80:83],v[208:211]
v_cvt_pk_bf16_f32 v89,v114,v115
v_mfma_f32_16x16x32_bf16 v[208:211],a[228:231],v[84:87],v[208:211]
v_exp_f32 v116,v116
v_mfma_f32_16x16x32_bf16 v[212:215],a[232:235],v[80:83],v[212:215]
v_mfma_f32_16x16x32_bf16 v[212:215],a[236:239],v[84:87],v[212:215]
v_exp_f32 v117,v117
v_mfma_f32_16x16x32_bf16 v[216:219],a[240:243],v[80:83],v[216:219]
buffer_load_dwordx4 v9,s[12:15],s48 offen offset:1024 nt lds
v_cvt_pk_bf16_f32 v90,v116,v117
v_mfma_f32_16x16x32_bf16 v[216:219],a[244:247],v[84:87],v[216:219]
v_exp_f32 v118,v118
v_mfma_f32_16x16x32_bf16 v[220:223],a[248:251],v[80:83],v[220:223]
s_waitcnt lgkmcnt(0)
v_mfma_f32_16x16x32_bf16 v[220:223],a[252:255],v[84:87],v[220:223]
v_exp_f32 v119,v119
v_mfma_f32_16x16x32_bf16 v[56:59],v[44:47],v[80:83],v[56:59]
v_cvt_pk_bf16_f32 v91,v118,v119
v_mfma_f32_16x16x32_bf16 v[56:59],v[44:47],v[84:87],v[56:59]
v_exp_f32 v120,v120
v_mfma_f32_16x16x32_bf16 v[96:99],a[128:131],a[0:3],v[64:67]
v_mfma_f32_16x16x32_bf16 v[96:99],a[132:135],a[4:7],v[96:99]
v_exp_f32 v121,v121
v_mfma_f32_16x16x32_bf16 v[96:99],a[136:139],a[8:11],v[96:99]
v_cvt_pk_bf16_f32 v92,v120,v121
v_mfma_f32_16x16x32_bf16 v[96:99],a[140:143],a[12:15],v[96:99]
v_exp_f32 v122,v122
v_mfma_f32_16x16x32_bf16 v[100:103],a[144:147],a[0:3],v[64:67]
v_mfma_f32_16x16x32_bf16 v[100:103],a[148:151],a[4:7],v[100:103]
v_exp_f32 v123,v123
v_mfma_f32_16x16x32_bf16 v[100:103],a[152:155],a[8:11],v[100:103]
v_cvt_pk_bf16_f32 v93,v122,v123
v_mfma_f32_16x16x32_bf16 v[100:103],a[156:159],a[12:15],v[100:103]
v_exp_f32 v124,v124
v_mfma_f32_16x16x32_bf16 v[104:107],a[160:163],a[0:3],v[64:67]
v_mfma_f32_16x16x32_bf16 v[104:107],a[164:167],a[4:7],v[104:107]
v_exp_f32 v125,v125
v_mfma_f32_16x16x32_bf16 v[104:107],a[168:171],a[8:11],v[104:107]
v_cvt_pk_bf16_f32 v94,v124,v125
v_mfma_f32_16x16x32_bf16 v[104:107],a[172:175],a[12:15],v[104:107]
buffer_load_dwordx4 v8,s[12:15],s48 offen offset:2048 nt lds
v_exp_f32 v126,v126
v_mfma_f32_16x16x32_bf16 v[108:111],a[176:179],a[0:3],v[64:67]
v_mfma_f32_16x16x32_bf16 v[108:111],a[180:183],a[4:7],v[108:111]
v_exp_f32 v127,v127
v_mfma_f32_16x16x32_bf16 v[108:111],a[184:187],a[8:11],v[108:111]
v_cvt_pk_bf16_f32 v95,v126,v127
v_mfma_f32_16x16x32_bf16 v[108:111],a[188:191],a[12:15],v[108:111]
v_mfma_f32_16x16x32_bf16 v[224:227],a[192:195],v[88:91],v[224:227]
v_mfma_f32_16x16x32_bf16 v[224:227],a[196:199],v[92:95],v[224:227]
v_exp_f32 v96,v96
v_mfma_f32_16x16x32_bf16 v[228:231],a[200:203],v[88:91],v[228:231]
ds_read_b64_tr_b16 a[192:193],v14 offset:16384
ds_read_b64_tr_b16 a[194:195],v14 offset:20480
v_mfma_f32_16x16x32_bf16 v[228:231],a[204:207],v[92:95],v[228:231]
v_exp_f32 v97,v97
v_mfma_f32_16x16x32_bf16 v[232:235],a[208:211],v[88:91],v[232:235]
ds_read_b64_tr_b16 a[196:197],v14 offset:24576
v_cvt_pk_bf16_f32 v80,v96,v97
v_mfma_f32_16x16x32_bf16 v[232:235],a[212:215],v[92:95],v[232:235]
v_exp_f32 v98,v98
v_mfma_f32_16x16x32_bf16 v[236:239],a[216:219],v[88:91],v[236:239]
ds_read_b64_tr_b16 a[198:199],v14 offset:28672
ds_read_b64_tr_b16 a[200:201],v15 offset:16384
v_mfma_f32_16x16x32_bf16 v[236:239],a[220:223],v[92:95],v[236:239]
v_exp_f32 v99,v99
v_mfma_f32_16x16x32_bf16 v[240:243],a[224:227],v[88:91],v[240:243]
ds_read_b64_tr_b16 a[202:203],v15 offset:20480
v_cvt_pk_bf16_f32 v81,v98,v99
v_mfma_f32_16x16x32_bf16 v[240:243],a[228:231],v[92:95],v[240:243]
v_exp_f32 v100,v100
v_mfma_f32_16x16x32_bf16 v[244:247],a[232:235],v[88:91],v[244:247]
ds_read_b64_tr_b16 a[204:205],v15 offset:24576
ds_read_b64_tr_b16 a[206:207],v15 offset:28672
v_mfma_f32_16x16x32_bf16 v[244:247],a[236:239],v[92:95],v[244:247]
v_exp_f32 v101,v101
v_mfma_f32_16x16x32_bf16 v[248:251],a[240:243],v[88:91],v[248:251]
ds_read_b64_tr_b16 a[208:209],v16 offset:16384
v_cvt_pk_bf16_f32 v82,v100,v101
v_mfma_f32_16x16x32_bf16 v[248:251],a[244:247],v[92:95],v[248:251]
buffer_load_dwordx4 v9,s[12:15],s48 offen offset:3072 nt lds
v_exp_f32 v102,v102
v_mfma_f32_16x16x32_bf16 v[252:255],a[248:251],v[88:91],v[252:255]
ds_read_b64_tr_b16 a[210:211],v16 offset:20480
ds_read_b64_tr_b16 a[212:213],v16 offset:24576
v_mfma_f32_16x16x32_bf16 v[252:255],a[252:255],v[92:95],v[252:255]
v_exp_f32 v103,v103
v_mfma_f32_16x16x32_bf16 v[60:63],v[44:47],v[88:91],v[60:63]
ds_read_b64_tr_b16 a[214:215],v16 offset:28672
v_cvt_pk_bf16_f32 v83,v102,v103
v_mfma_f32_16x16x32_bf16 v[60:63],v[44:47],v[92:95],v[60:63]
v_exp_f32 v104,v104
v_mfma_f32_16x16x32_bf16 v[112:115],a[128:131],a[16:19],v[68:71]
ds_read_b64_tr_b16 a[216:217],v17 offset:16384
ds_read_b64_tr_b16 a[218:219],v17 offset:20480
v_mfma_f32_16x16x32_bf16 v[112:115],a[132:135],a[20:23],v[112:115]
v_exp_f32 v105,v105
v_mfma_f32_16x16x32_bf16 v[112:115],a[136:139],a[24:27],v[112:115]
ds_read_b64_tr_b16 a[220:221],v17 offset:24576
v_cvt_pk_bf16_f32 v84,v104,v105
v_mfma_f32_16x16x32_bf16 v[112:115],a[140:143],a[28:31],v[112:115]
v_exp_f32 v106,v106
v_mfma_f32_16x16x32_bf16 v[116:119],a[144:147],a[16:19],v[68:71]
ds_read_b64_tr_b16 a[222:223],v17 offset:28672
ds_read_b64_tr_b16 a[224:225],v18 offset:16384
v_mfma_f32_16x16x32_bf16 v[116:119],a[148:151],a[20:23],v[116:119]
v_exp_f32 v107,v107
v_mfma_f32_16x16x32_bf16 v[116:119],a[152:155],a[24:27],v[116:119]
ds_read_b64_tr_b16 a[226:227],v18 offset:20480
v_cvt_pk_bf16_f32 v85,v106,v107
v_mfma_f32_16x16x32_bf16 v[116:119],a[156:159],a[28:31],v[116:119]
v_exp_f32 v108,v108
v_mfma_f32_16x16x32_bf16 v[120:123],a[160:163],a[16:19],v[68:71]
ds_read_b64_tr_b16 a[228:229],v18 offset:24576
ds_read_b64_tr_b16 a[230:231],v18 offset:28672
v_mfma_f32_16x16x32_bf16 v[120:123],a[164:167],a[20:23],v[120:123]
v_exp_f32 v109,v109
v_mfma_f32_16x16x32_bf16 v[120:123],a[168:171],a[24:27],v[120:123]
ds_read_b64_tr_b16 a[232:233],v19 offset:16384
v_cvt_pk_bf16_f32 v86,v108,v109
v_mfma_f32_16x16x32_bf16 v[120:123],a[172:175],a[28:31],v[120:123]
s_mov_b32 s48,114688
v_exp_f32 v110,v110
v_mfma_f32_16x16x32_bf16 v[124:127],a[176:179],a[16:19],v[68:71]
ds_read_b64_tr_b16 a[234:235],v19 offset:20480
ds_read_b64_tr_b16 a[236:237],v19 offset:24576
s_add_u32 m0,s39,49152
v_mfma_f32_16x16x32_bf16 v[124:127],a[180:183],a[20:23],v[124:127]
buffer_load_dwordx4 v4,s[8:11],s48 offen nt lds
v_exp_f32 v111,v111
v_mfma_f32_16x16x32_bf16 v[124:127],a[184:187],a[24:27],v[124:127]
ds_read_b64_tr_b16 a[238:239],v19 offset:28672
v_cvt_pk_bf16_f32 v87,v110,v111
v_mfma_f32_16x16x32_bf16 v[124:127],a[188:191],a[28:31],v[124:127]
ds_read_b64_tr_b16 a[240:241],v20 offset:16384
ds_read_b64_tr_b16 a[242:243],v20 offset:20480
v_mfma_f32_16x16x32_bf16 v[96:99],a[128:131],a[32:35],v[72:75]
ds_read_b64_tr_b16 a[244:245],v20 offset:24576
ds_read_b64_tr_b16 a[246:247],v20 offset:28672
v_mfma_f32_16x16x32_bf16 v[96:99],a[132:135],a[36:39],v[96:99]
v_exp_f32 v112,v112
v_mfma_f32_16x16x32_bf16 v[96:99],a[136:139],a[40:43],v[96:99]
ds_read_b64_tr_b16 a[248:249],v21 offset:16384
ds_read_b64_tr_b16 a[250:251],v21 offset:20480
v_mfma_f32_16x16x32_bf16 v[96:99],a[140:143],a[44:47],v[96:99]
v_exp_f32 v113,v113
v_mfma_f32_16x16x32_bf16 v[100:103],a[144:147],a[32:35],v[72:75]
ds_read_b64_tr_b16 a[252:253],v21 offset:24576
v_cvt_pk_bf16_f32 v88,v112,v113
v_mfma_f32_16x16x32_bf16 v[100:103],a[148:151],a[36:39],v[100:103]
v_exp_f32 v114,v114
v_mfma_f32_16x16x32_bf16 v[100:103],a[152:155],a[40:43],v[100:103]
ds_read_b64_tr_b16 a[254:255],v21 offset:28672
v_mfma_f32_16x16x32_bf16 v[100:103],a[156:159],a[44:47],v[100:103]
v_exp_f32 v115,v115
v_mfma_f32_16x16x32_bf16 v[104:107],a[160:163],a[32:35],v[72:75]
v_cvt_pk_bf16_f32 v89,v114,v115
v_mfma_f32_16x16x32_bf16 v[104:107],a[164:167],a[36:39],v[104:107]
v_exp_f32 v116,v116
v_mfma_f32_16x16x32_bf16 v[104:107],a[168:171],a[40:43],v[104:107]
v_mfma_f32_16x16x32_bf16 v[104:107],a[172:175],a[44:47],v[104:107]
v_exp_f32 v117,v117
v_mfma_f32_16x16x32_bf16 v[108:111],a[176:179],a[32:35],v[72:75]
buffer_load_dwordx4 v5,s[8:11],s48 offen offset:1024 nt lds
v_cvt_pk_bf16_f32 v90,v116,v117
v_mfma_f32_16x16x32_bf16 v[108:111],a[180:183],a[36:39],v[108:111]
v_exp_f32 v118,v118
v_mfma_f32_16x16x32_bf16 v[108:111],a[184:187],a[40:43],v[108:111]
s_waitcnt lgkmcnt(0)
v_mfma_f32_16x16x32_bf16 v[108:111],a[188:191],a[44:47],v[108:111]
v_exp_f32 v119,v119
v_mfma_f32_16x16x32_bf16 v[128:131],a[192:195],v[80:83],v[128:131]
v_cvt_pk_bf16_f32 v91,v118,v119
v_mfma_f32_16x16x32_bf16 v[128:131],a[196:199],v[84:87],v[128:131]
v_exp_f32 v120,v120
v_mfma_f32_16x16x32_bf16 v[132:135],a[200:203],v[80:83],v[132:135]
v_mfma_f32_16x16x32_bf16 v[132:135],a[204:207],v[84:87],v[132:135]
v_exp_f32 v121,v121
v_mfma_f32_16x16x32_bf16 v[136:139],a[208:211],v[80:83],v[136:139]
v_cvt_pk_bf16_f32 v92,v120,v121
v_mfma_f32_16x16x32_bf16 v[136:139],a[212:215],v[84:87],v[136:139]
v_exp_f32 v122,v122
v_mfma_f32_16x16x32_bf16 v[140:143],a[216:219],v[80:83],v[140:143]
v_mfma_f32_16x16x32_bf16 v[140:143],a[220:223],v[84:87],v[140:143]
v_exp_f32 v123,v123
v_mfma_f32_16x16x32_bf16 v[144:147],a[224:227],v[80:83],v[144:147]
v_cvt_pk_bf16_f32 v93,v122,v123
v_mfma_f32_16x16x32_bf16 v[144:147],a[228:231],v[84:87],v[144:147]
v_exp_f32 v124,v124
v_mfma_f32_16x16x32_bf16 v[148:151],a[232:235],v[80:83],v[148:151]
v_mfma_f32_16x16x32_bf16 v[148:151],a[236:239],v[84:87],v[148:151]
v_exp_f32 v125,v125
v_mfma_f32_16x16x32_bf16 v[152:155],a[240:243],v[80:83],v[152:155]
v_cvt_pk_bf16_f32 v94,v124,v125
v_mfma_f32_16x16x32_bf16 v[152:155],a[244:247],v[84:87],v[152:155]
buffer_load_dwordx4 v6,s[8:11],s48 offen offset:2048 nt lds
v_exp_f32 v126,v126
v_mfma_f32_16x16x32_bf16 v[156:159],a[248:251],v[80:83],v[156:159]
v_mfma_f32_16x16x32_bf16 v[156:159],a[252:255],v[84:87],v[156:159]
v_exp_f32 v127,v127
v_mfma_f32_16x16x32_bf16 v[48:51],v[44:47],v[80:83],v[48:51]
v_cvt_pk_bf16_f32 v95,v126,v127
v_mfma_f32_16x16x32_bf16 v[48:51],v[44:47],v[84:87],v[48:51]
s_waitcnt vmcnt(3)
s_barrier
v_mfma_f32_16x16x32_bf16 v[112:115],a[128:131],a[48:51],v[76:79]
v_mfma_f32_16x16x32_bf16 v[112:115],a[132:135],a[52:55],v[112:115]
v_exp_f32 v96,v96
v_mfma_f32_16x16x32_bf16 v[112:115],a[136:139],a[56:59],v[112:115]
v_mfma_f32_16x16x32_bf16 v[112:115],a[140:143],a[60:63],v[112:115]
v_exp_f32 v97,v97
v_mfma_f32_16x16x32_bf16 v[116:119],a[144:147],a[48:51],v[76:79]
ds_read_b128 a[128:131],v10 offset:32768
v_cvt_pk_bf16_f32 v80,v96,v97
v_mfma_f32_16x16x32_bf16 v[116:119],a[148:151],a[52:55],v[116:119]
v_exp_f32 v98,v98
v_mfma_f32_16x16x32_bf16 v[116:119],a[152:155],a[56:59],v[116:119]
ds_read_b128 a[132:135],v11 offset:32768
v_mfma_f32_16x16x32_bf16 v[116:119],a[156:159],a[60:63],v[116:119]
v_exp_f32 v99,v99
v_mfma_f32_16x16x32_bf16 v[120:123],a[160:163],a[48:51],v[76:79]
ds_read_b128 a[136:139],v12 offset:32768
v_cvt_pk_bf16_f32 v81,v98,v99
v_mfma_f32_16x16x32_bf16 v[120:123],a[164:167],a[52:55],v[120:123]
v_exp_f32 v100,v100
v_mfma_f32_16x16x32_bf16 v[120:123],a[168:171],a[56:59],v[120:123]
ds_read_b128 a[140:143],v13 offset:32768
v_mfma_f32_16x16x32_bf16 v[120:123],a[172:175],a[60:63],v[120:123]
v_exp_f32 v101,v101
v_mfma_f32_16x16x32_bf16 v[124:127],a[176:179],a[48:51],v[76:79]
ds_read_b128 a[144:147],v10 offset:36864
v_cvt_pk_bf16_f32 v82,v100,v101
v_mfma_f32_16x16x32_bf16 v[124:127],a[180:183],a[52:55],v[124:127]
buffer_load_dwordx4 v7,s[8:11],s48 offen offset:3072 nt lds
v_exp_f32 v102,v102
v_mfma_f32_16x16x32_bf16 v[124:127],a[184:187],a[56:59],v[124:127]
ds_read_b128 a[148:151],v11 offset:36864
v_mfma_f32_16x16x32_bf16 v[124:127],a[188:191],a[60:63],v[124:127]
v_exp_f32 v103,v103
v_mfma_f32_16x16x32_bf16 v[160:163],a[192:195],v[88:91],v[160:163]
ds_read_b128 a[152:155],v12 offset:36864
v_cvt_pk_bf16_f32 v83,v102,v103
v_mfma_f32_16x16x32_bf16 v[160:163],a[196:199],v[92:95],v[160:163]
v_exp_f32 v104,v104
v_mfma_f32_16x16x32_bf16 v[164:167],a[200:203],v[88:91],v[164:167]
ds_read_b128 a[156:159],v13 offset:36864
v_mfma_f32_16x16x32_bf16 v[164:167],a[204:207],v[92:95],v[164:167]
v_exp_f32 v105,v105
v_mfma_f32_16x16x32_bf16 v[168:171],a[208:211],v[88:91],v[168:171]
ds_read_b128 a[160:163],v10 offset:40960
v_cvt_pk_bf16_f32 v84,v104,v105
v_mfma_f32_16x16x32_bf16 v[168:171],a[212:215],v[92:95],v[168:171]
v_exp_f32 v106,v106
v_mfma_f32_16x16x32_bf16 v[172:175],a[216:219],v[88:91],v[172:175]
ds_read_b128 a[164:167],v11 offset:40960
v_mfma_f32_16x16x32_bf16 v[172:175],a[220:223],v[92:95],v[172:175]
v_exp_f32 v107,v107
v_mfma_f32_16x16x32_bf16 v[176:179],a[224:227],v[88:91],v[176:179]
ds_read_b128 a[168:171],v12 offset:40960
v_cvt_pk_bf16_f32 v85,v106,v107
v_mfma_f32_16x16x32_bf16 v[176:179],a[228:231],v[92:95],v[176:179]
v_exp_f32 v108,v108
v_mfma_f32_16x16x32_bf16 v[180:183],a[232:235],v[88:91],v[180:183]
ds_read_b128 a[172:175],v13 offset:40960
v_mfma_f32_16x16x32_bf16 v[180:183],a[236:239],v[92:95],v[180:183]
v_exp_f32 v109,v109
v_mfma_f32_16x16x32_bf16 v[184:187],a[240:243],v[88:91],v[184:187]
ds_read_b128 a[176:179],v10 offset:45056
v_cvt_pk_bf16_f32 v86,v108,v109
v_mfma_f32_16x16x32_bf16 v[184:187],a[244:247],v[92:95],v[184:187]
s_add_u32 m0,s39,114688
v_exp_f32 v110,v110
v_mfma_f32_16x16x32_bf16 v[188:191],a[248:251],v[88:91],v[188:191]
ds_read_b128 a[180:183],v11 offset:45056
v_mfma_f32_16x16x32_bf16 v[188:191],a[252:255],v[92:95],v[188:191]
buffer_load_dwordx4 v8,s[12:15],s48 offen nt lds
v_exp_f32 v111,v111
v_mfma_f32_16x16x32_bf16 v[52:55],v[44:47],v[88:91],v[52:55]
ds_read_b128 a[184:187],v12 offset:45056
v_cvt_pk_bf16_f32 v87,v110,v111
v_mfma_f32_16x16x32_bf16 v[52:55],v[44:47],v[92:95],v[52:55]
ds_read_b128 a[188:191],v13 offset:45056
v_mfma_f32_16x16x32_bf16 v[192:195],a[192:195],v[80:83],v[192:195]
v_mfma_f32_16x16x32_bf16 v[192:195],a[196:199],v[84:87],v[192:195]
v_exp_f32 v112,v112
v_mfma_f32_16x16x32_bf16 v[196:199],a[200:203],v[80:83],v[196:199]
v_mfma_f32_16x16x32_bf16 v[196:199],a[204:207],v[84:87],v[196:199]
v_exp_f32 v113,v113
v_mfma_f32_16x16x32_bf16 v[200:203],a[208:211],v[80:83],v[200:203]
v_cvt_pk_bf16_f32 v88,v112,v113
v_mfma_f32_16x16x32_bf16 v[200:203],a[212:215],v[84:87],v[200:203]
v_exp_f32 v114,v114
v_mfma_f32_16x16x32_bf16 v[204:207],a[216:219],v[80:83],v[204:207]
v_mfma_f32_16x16x32_bf16 v[204:207],a[220:223],v[84:87],v[204:207]
v_exp_f32 v115,v115
v_mfma_f32_16x16x32_bf16 v[208:211],a[224:227],v[80:83],v[208:211]
v_cvt_pk_bf16_f32 v89,v114,v115
v_mfma_f32_16x16x32_bf16 v[208:211],a[228:231],v[84:87],v[208:211]
v_exp_f32 v116,v116
v_mfma_f32_16x16x32_bf16 v[212:215],a[232:235],v[80:83],v[212:215]
v_mfma_f32_16x16x32_bf16 v[212:215],a[236:239],v[84:87],v[212:215]
v_exp_f32 v117,v117
v_mfma_f32_16x16x32_bf16 v[216:219],a[240:243],v[80:83],v[216:219]
buffer_load_dwordx4 v9,s[12:15],s48 offen offset:1024 nt lds
v_cvt_pk_bf16_f32 v90,v116,v117
v_mfma_f32_16x16x32_bf16 v[216:219],a[244:247],v[84:87],v[216:219]
v_exp_f32 v118,v118
v_mfma_f32_16x16x32_bf16 v[220:223],a[248:251],v[80:83],v[220:223]
s_waitcnt lgkmcnt(0)
v_mfma_f32_16x16x32_bf16 v[220:223],a[252:255],v[84:87],v[220:223]
v_exp_f32 v119,v119
v_mfma_f32_16x16x32_bf16 v[56:59],v[44:47],v[80:83],v[56:59]
v_cvt_pk_bf16_f32 v91,v118,v119
v_mfma_f32_16x16x32_bf16 v[56:59],v[44:47],v[84:87],v[56:59]
v_exp_f32 v120,v120
v_mfma_f32_16x16x32_bf16 v[96:99],a[128:131],a[0:3],v[64:67]
v_mfma_f32_16x16x32_bf16 v[96:99],a[132:135],a[4:7],v[96:99]
v_exp_f32 v121,v121
v_mfma_f32_16x16x32_bf16 v[96:99],a[136:139],a[8:11],v[96:99]
v_cvt_pk_bf16_f32 v92,v120,v121
v_mfma_f32_16x16x32_bf16 v[96:99],a[140:143],a[12:15],v[96:99]
v_exp_f32 v122,v122
v_mfma_f32_16x16x32_bf16 v[100:103],a[144:147],a[0:3],v[64:67]
v_mfma_f32_16x16x32_bf16 v[100:103],a[148:151],a[4:7],v[100:103]
v_exp_f32 v123,v123
v_mfma_f32_16x16x32_bf16 v[100:103],a[152:155],a[8:11],v[100:103]
v_cvt_pk_bf16_f32 v93,v122,v123
v_mfma_f32_16x16x32_bf16 v[100:103],a[156:159],a[12:15],v[100:103]
v_exp_f32 v124,v124
v_mfma_f32_16x16x32_bf16 v[104:107],a[160:163],a[0:3],v[64:67]
v_mfma_f32_16x16x32_bf16 v[104:107],a[164:167],a[4:7],v[104:107]
v_exp_f32 v125,v125
v_mfma_f32_16x16x32_bf16 v[104:107],a[168:171],a[8:11],v[104:107]
v_cvt_pk_bf16_f32 v94,v124,v125
v_mfma_f32_16x16x32_bf16 v[104:107],a[172:175],a[12:15],v[104:107]
buffer_load_dwordx4 v8,s[12:15],s48 offen offset:2048 nt lds
v_exp_f32 v126,v126
v_mfma_f32_16x16x32_bf16 v[108:111],a[176:179],a[0:3],v[64:67]
v_mfma_f32_16x16x32_bf16 v[108:111],a[180:183],a[4:7],v[108:111]
v_exp_f32 v127,v127
v_mfma_f32_16x16x32_bf16 v[108:111],a[184:187],a[8:11],v[108:111]
v_cvt_pk_bf16_f32 v95,v126,v127
v_mfma_f32_16x16x32_bf16 v[108:111],a[188:191],a[12:15],v[108:111]
v_mfma_f32_16x16x32_bf16 v[224:227],a[192:195],v[88:91],v[224:227]
v_mfma_f32_16x16x32_bf16 v[224:227],a[196:199],v[92:95],v[224:227]
v_exp_f32 v96,v96
v_mfma_f32_16x16x32_bf16 v[228:231],a[200:203],v[88:91],v[228:231]
ds_read_b64_tr_b16 a[192:193],v14 offset:32768
ds_read_b64_tr_b16 a[194:195],v14 offset:36864
v_mfma_f32_16x16x32_bf16 v[228:231],a[204:207],v[92:95],v[228:231]
v_exp_f32 v97,v97
v_mfma_f32_16x16x32_bf16 v[232:235],a[208:211],v[88:91],v[232:235]
ds_read_b64_tr_b16 a[196:197],v14 offset:40960
v_cvt_pk_bf16_f32 v80,v96,v97
v_mfma_f32_16x16x32_bf16 v[232:235],a[212:215],v[92:95],v[232:235]
v_exp_f32 v98,v98
v_mfma_f32_16x16x32_bf16 v[236:239],a[216:219],v[88:91],v[236:239]
ds_read_b64_tr_b16 a[198:199],v14 offset:45056
ds_read_b64_tr_b16 a[200:201],v15 offset:32768
v_mfma_f32_16x16x32_bf16 v[236:239],a[220:223],v[92:95],v[236:239]
v_exp_f32 v99,v99
v_mfma_f32_16x16x32_bf16 v[240:243],a[224:227],v[88:91],v[240:243]
ds_read_b64_tr_b16 a[202:203],v15 offset:36864
v_cvt_pk_bf16_f32 v81,v98,v99
v_mfma_f32_16x16x32_bf16 v[240:243],a[228:231],v[92:95],v[240:243]
v_exp_f32 v100,v100
v_mfma_f32_16x16x32_bf16 v[244:247],a[232:235],v[88:91],v[244:247]
ds_read_b64_tr_b16 a[204:205],v15 offset:40960
ds_read_b64_tr_b16 a[206:207],v15 offset:45056
v_mfma_f32_16x16x32_bf16 v[244:247],a[236:239],v[92:95],v[244:247]
v_exp_f32 v101,v101
v_mfma_f32_16x16x32_bf16 v[248:251],a[240:243],v[88:91],v[248:251]
ds_read_b64_tr_b16 a[208:209],v16 offset:32768
v_cvt_pk_bf16_f32 v82,v100,v101
v_mfma_f32_16x16x32_bf16 v[248:251],a[244:247],v[92:95],v[248:251]
buffer_load_dwordx4 v9,s[12:15],s48 offen offset:3072 nt lds
v_exp_f32 v102,v102
v_mfma_f32_16x16x32_bf16 v[252:255],a[248:251],v[88:91],v[252:255]
ds_read_b64_tr_b16 a[210:211],v16 offset:36864
ds_read_b64_tr_b16 a[212:213],v16 offset:40960
v_mfma_f32_16x16x32_bf16 v[252:255],a[252:255],v[92:95],v[252:255]
v_exp_f32 v103,v103
v_mfma_f32_16x16x32_bf16 v[60:63],v[44:47],v[88:91],v[60:63]
ds_read_b64_tr_b16 a[214:215],v16 offset:45056
v_cvt_pk_bf16_f32 v83,v102,v103
v_mfma_f32_16x16x32_bf16 v[60:63],v[44:47],v[92:95],v[60:63]
v_exp_f32 v104,v104
v_mfma_f32_16x16x32_bf16 v[112:115],a[128:131],a[16:19],v[68:71]
ds_read_b64_tr_b16 a[216:217],v17 offset:32768
ds_read_b64_tr_b16 a[218:219],v17 offset:36864
v_mfma_f32_16x16x32_bf16 v[112:115],a[132:135],a[20:23],v[112:115]
v_exp_f32 v105,v105
v_mfma_f32_16x16x32_bf16 v[112:115],a[136:139],a[24:27],v[112:115]
ds_read_b64_tr_b16 a[220:221],v17 offset:40960
v_cvt_pk_bf16_f32 v84,v104,v105
v_mfma_f32_16x16x32_bf16 v[112:115],a[140:143],a[28:31],v[112:115]
v_exp_f32 v106,v106
v_mfma_f32_16x16x32_bf16 v[116:119],a[144:147],a[16:19],v[68:71]
ds_read_b64_tr_b16 a[222:223],v17 offset:45056
ds_read_b64_tr_b16 a[224:225],v18 offset:32768
v_mfma_f32_16x16x32_bf16 v[116:119],a[148:151],a[20:23],v[116:119]
v_exp_f32 v107,v107
v_mfma_f32_16x16x32_bf16 v[116:119],a[152:155],a[24:27],v[116:119]
ds_read_b64_tr_b16 a[226:227],v18 offset:36864
v_cvt_pk_bf16_f32 v85,v106,v107
v_mfma_f32_16x16x32_bf16 v[116:119],a[156:159],a[28:31],v[116:119]
v_exp_f32 v108,v108
v_mfma_f32_16x16x32_bf16 v[120:123],a[160:163],a[16:19],v[68:71]
ds_read_b64_tr_b16 a[228:229],v18 offset:40960
ds_read_b64_tr_b16 a[230:231],v18 offset:45056
v_mfma_f32_16x16x32_bf16 v[120:123],a[164:167],a[20:23],v[120:123]
v_exp_f32 v109,v109
v_mfma_f32_16x16x32_bf16 v[120:123],a[168:171],a[24:27],v[120:123]
ds_read_b64_tr_b16 a[232:233],v19 offset:32768
v_cvt_pk_bf16_f32 v86,v108,v109
v_mfma_f32_16x16x32_bf16 v[120:123],a[172:175],a[28:31],v[120:123]
s_mov_b32 s48,131072
v_exp_f32 v110,v110
v_mfma_f32_16x16x32_bf16 v[124:127],a[176:179],a[16:19],v[68:71]
ds_read_b64_tr_b16 a[234:235],v19 offset:36864
ds_read_b64_tr_b16 a[236:237],v19 offset:40960
s_add_u32 m0,s39,0
v_mfma_f32_16x16x32_bf16 v[124:127],a[180:183],a[20:23],v[124:127]
buffer_load_dwordx4 v4,s[8:11],s48 offen nt lds
v_exp_f32 v111,v111
v_mfma_f32_16x16x32_bf16 v[124:127],a[184:187],a[24:27],v[124:127]
ds_read_b64_tr_b16 a[238:239],v19 offset:45056
v_cvt_pk_bf16_f32 v87,v110,v111
v_mfma_f32_16x16x32_bf16 v[124:127],a[188:191],a[28:31],v[124:127]
ds_read_b64_tr_b16 a[240:241],v20 offset:32768
ds_read_b64_tr_b16 a[242:243],v20 offset:36864
v_mfma_f32_16x16x32_bf16 v[96:99],a[128:131],a[32:35],v[72:75]
ds_read_b64_tr_b16 a[244:245],v20 offset:40960
ds_read_b64_tr_b16 a[246:247],v20 offset:45056
v_mfma_f32_16x16x32_bf16 v[96:99],a[132:135],a[36:39],v[96:99]
v_exp_f32 v112,v112
v_mfma_f32_16x16x32_bf16 v[96:99],a[136:139],a[40:43],v[96:99]
ds_read_b64_tr_b16 a[248:249],v21 offset:32768
ds_read_b64_tr_b16 a[250:251],v21 offset:36864
v_mfma_f32_16x16x32_bf16 v[96:99],a[140:143],a[44:47],v[96:99]
v_exp_f32 v113,v113
v_mfma_f32_16x16x32_bf16 v[100:103],a[144:147],a[32:35],v[72:75]
ds_read_b64_tr_b16 a[252:253],v21 offset:40960
v_cvt_pk_bf16_f32 v88,v112,v113
v_mfma_f32_16x16x32_bf16 v[100:103],a[148:151],a[36:39],v[100:103]
v_exp_f32 v114,v114
v_mfma_f32_16x16x32_bf16 v[100:103],a[152:155],a[40:43],v[100:103]
ds_read_b64_tr_b16 a[254:255],v21 offset:45056
v_mfma_f32_16x16x32_bf16 v[100:103],a[156:159],a[44:47],v[100:103]
v_exp_f32 v115,v115
v_mfma_f32_16x16x32_bf16 v[104:107],a[160:163],a[32:35],v[72:75]
v_cvt_pk_bf16_f32 v89,v114,v115
v_mfma_f32_16x16x32_bf16 v[104:107],a[164:167],a[36:39],v[104:107]
v_exp_f32 v116,v116
v_mfma_f32_16x16x32_bf16 v[104:107],a[168:171],a[40:43],v[104:107]
v_mfma_f32_16x16x32_bf16 v[104:107],a[172:175],a[44:47],v[104:107]
v_exp_f32 v117,v117
v_mfma_f32_16x16x32_bf16 v[108:111],a[176:179],a[32:35],v[72:75]
buffer_load_dwordx4 v5,s[8:11],s48 offen offset:1024 nt lds
v_cvt_pk_bf16_f32 v90,v116,v117
v_mfma_f32_16x16x32_bf16 v[108:111],a[180:183],a[36:39],v[108:111]
v_exp_f32 v118,v118
v_mfma_f32_16x16x32_bf16 v[108:111],a[184:187],a[40:43],v[108:111]
s_waitcnt lgkmcnt(0)
v_mfma_f32_16x16x32_bf16 v[108:111],a[188:191],a[44:47],v[108:111]
v_exp_f32 v119,v119
v_mfma_f32_16x16x32_bf16 v[128:131],a[192:195],v[80:83],v[128:131]
v_cvt_pk_bf16_f32 v91,v118,v119
v_mfma_f32_16x16x32_bf16 v[128:131],a[196:199],v[84:87],v[128:131]
v_exp_f32 v120,v120
v_mfma_f32_16x16x32_bf16 v[132:135],a[200:203],v[80:83],v[132:135]
v_mfma_f32_16x16x32_bf16 v[132:135],a[204:207],v[84:87],v[132:135]
v_exp_f32 v121,v121
v_mfma_f32_16x16x32_bf16 v[136:139],a[208:211],v[80:83],v[136:139]
v_cvt_pk_bf16_f32 v92,v120,v121
v_mfma_f32_16x16x32_bf16 v[136:139],a[212:215],v[84:87],v[136:139]
v_exp_f32 v122,v122
v_mfma_f32_16x16x32_bf16 v[140:143],a[216:219],v[80:83],v[140:143]
v_mfma_f32_16x16x32_bf16 v[140:143],a[220:223],v[84:87],v[140:143]
v_exp_f32 v123,v123
v_mfma_f32_16x16x32_bf16 v[144:147],a[224:227],v[80:83],v[144:147]
v_cvt_pk_bf16_f32 v93,v122,v123
v_mfma_f32_16x16x32_bf16 v[144:147],a[228:231],v[84:87],v[144:147]
v_exp_f32 v124,v124
v_mfma_f32_16x16x32_bf16 v[148:151],a[232:235],v[80:83],v[148:151]
v_mfma_f32_16x16x32_bf16 v[148:151],a[236:239],v[84:87],v[148:151]
v_exp_f32 v125,v125
v_mfma_f32_16x16x32_bf16 v[152:155],a[240:243],v[80:83],v[152:155]
v_cvt_pk_bf16_f32 v94,v124,v125
v_mfma_f32_16x16x32_bf16 v[152:155],a[244:247],v[84:87],v[152:155]
buffer_load_dwordx4 v6,s[8:11],s48 offen offset:2048 nt lds
v_exp_f32 v126,v126
v_mfma_f32_16x16x32_bf16 v[156:159],a[248:251],v[80:83],v[156:159]
v_mfma_f32_16x16x32_bf16 v[156:159],a[252:255],v[84:87],v[156:159]
v_exp_f32 v127,v127
v_mfma_f32_16x16x32_bf16 v[48:51],v[44:47],v[80:83],v[48:51]
v_cvt_pk_bf16_f32 v95,v126,v127
v_mfma_f32_16x16x32_bf16 v[48:51],v[44:47],v[84:87],v[48:51]
s_waitcnt vmcnt(3)
s_barrier
v_mfma_f32_16x16x32_bf16 v[112:115],a[128:131],a[48:51],v[76:79]
v_mfma_f32_16x16x32_bf16 v[112:115],a[132:135],a[52:55],v[112:115]
v_exp_f32 v96,v96
v_mfma_f32_16x16x32_bf16 v[112:115],a[136:139],a[56:59],v[112:115]
v_mfma_f32_16x16x32_bf16 v[112:115],a[140:143],a[60:63],v[112:115]
v_exp_f32 v97,v97
v_mfma_f32_16x16x32_bf16 v[116:119],a[144:147],a[48:51],v[76:79]
ds_read_b128 a[128:131],v10 offset:49152
v_cvt_pk_bf16_f32 v80,v96,v97
v_mfma_f32_16x16x32_bf16 v[116:119],a[148:151],a[52:55],v[116:119]
v_exp_f32 v98,v98
v_mfma_f32_16x16x32_bf16 v[116:119],a[152:155],a[56:59],v[116:119]
ds_read_b128 a[132:135],v11 offset:49152
v_mfma_f32_16x16x32_bf16 v[116:119],a[156:159],a[60:63],v[116:119]
v_exp_f32 v99,v99
v_mfma_f32_16x16x32_bf16 v[120:123],a[160:163],a[48:51],v[76:79]
ds_read_b128 a[136:139],v12 offset:49152
v_cvt_pk_bf16_f32 v81,v98,v99
v_mfma_f32_16x16x32_bf16 v[120:123],a[164:167],a[52:55],v[120:123]
v_exp_f32 v100,v100
v_mfma_f32_16x16x32_bf16 v[120:123],a[168:171],a[56:59],v[120:123]
ds_read_b128 a[140:143],v13 offset:49152
v_mfma_f32_16x16x32_bf16 v[120:123],a[172:175],a[60:63],v[120:123]
v_exp_f32 v101,v101
v_mfma_f32_16x16x32_bf16 v[124:127],a[176:179],a[48:51],v[76:79]
ds_read_b128 a[144:147],v10 offset:53248
v_cvt_pk_bf16_f32 v82,v100,v101
v_mfma_f32_16x16x32_bf16 v[124:127],a[180:183],a[52:55],v[124:127]
buffer_load_dwordx4 v7,s[8:11],s48 offen offset:3072 nt lds
v_exp_f32 v102,v102
v_mfma_f32_16x16x32_bf16 v[124:127],a[184:187],a[56:59],v[124:127]
ds_read_b128 a[148:151],v11 offset:53248
v_mfma_f32_16x16x32_bf16 v[124:127],a[188:191],a[60:63],v[124:127]
v_exp_f32 v103,v103
v_mfma_f32_16x16x32_bf16 v[160:163],a[192:195],v[88:91],v[160:163]
ds_read_b128 a[152:155],v12 offset:53248
v_cvt_pk_bf16_f32 v83,v102,v103
v_mfma_f32_16x16x32_bf16 v[160:163],a[196:199],v[92:95],v[160:163]
v_exp_f32 v104,v104
v_mfma_f32_16x16x32_bf16 v[164:167],a[200:203],v[88:91],v[164:167]
ds_read_b128 a[156:159],v13 offset:53248
v_mfma_f32_16x16x32_bf16 v[164:167],a[204:207],v[92:95],v[164:167]
v_exp_f32 v105,v105
v_mfma_f32_16x16x32_bf16 v[168:171],a[208:211],v[88:91],v[168:171]
ds_read_b128 a[160:163],v10 offset:57344
v_cvt_pk_bf16_f32 v84,v104,v105
v_mfma_f32_16x16x32_bf16 v[168:171],a[212:215],v[92:95],v[168:171]
v_exp_f32 v106,v106
v_mfma_f32_16x16x32_bf16 v[172:175],a[216:219],v[88:91],v[172:175]
ds_read_b128 a[164:167],v11 offset:57344
v_mfma_f32_16x16x32_bf16 v[172:175],a[220:223],v[92:95],v[172:175]
v_exp_f32 v107,v107
v_mfma_f32_16x16x32_bf16 v[176:179],a[224:227],v[88:91],v[176:179]
ds_read_b128 a[168:171],v12 offset:57344
v_cvt_pk_bf16_f32 v85,v106,v107
v_mfma_f32_16x16x32_bf16 v[176:179],a[228:231],v[92:95],v[176:179]
v_exp_f32 v108,v108
v_mfma_f32_16x16x32_bf16 v[180:183],a[232:235],v[88:91],v[180:183]
ds_read_b128 a[172:175],v13 offset:57344
v_mfma_f32_16x16x32_bf16 v[180:183],a[236:239],v[92:95],v[180:183]
v_exp_f32 v109,v109
v_mfma_f32_16x16x32_bf16 v[184:187],a[240:243],v[88:91],v[184:187]
ds_read_b128 a[176:179],v10 offset:61440
v_cvt_pk_bf16_f32 v86,v108,v109
v_mfma_f32_16x16x32_bf16 v[184:187],a[244:247],v[92:95],v[184:187]
s_add_u32 m0,s39,65536
v_exp_f32 v110,v110
v_mfma_f32_16x16x32_bf16 v[188:191],a[248:251],v[88:91],v[188:191]
ds_read_b128 a[180:183],v11 offset:61440
v_mfma_f32_16x16x32_bf16 v[188:191],a[252:255],v[92:95],v[188:191]
buffer_load_dwordx4 v8,s[12:15],s48 offen nt lds
v_exp_f32 v111,v111
v_mfma_f32_16x16x32_bf16 v[52:55],v[44:47],v[88:91],v[52:55]
ds_read_b128 a[184:187],v12 offset:61440
v_cvt_pk_bf16_f32 v87,v110,v111
v_mfma_f32_16x16x32_bf16 v[52:55],v[44:47],v[92:95],v[52:55]
ds_read_b128 a[188:191],v13 offset:61440
v_mfma_f32_16x16x32_bf16 v[192:195],a[192:195],v[80:83],v[192:195]
v_mfma_f32_16x16x32_bf16 v[192:195],a[196:199],v[84:87],v[192:195]
v_exp_f32 v112,v112
v_mfma_f32_16x16x32_bf16 v[196:199],a[200:203],v[80:83],v[196:199]
v_mfma_f32_16x16x32_bf16 v[196:199],a[204:207],v[84:87],v[196:199]
v_exp_f32 v113,v113
v_mfma_f32_16x16x32_bf16 v[200:203],a[208:211],v[80:83],v[200:203]
v_cvt_pk_bf16_f32 v88,v112,v113
v_mfma_f32_16x16x32_bf16 v[200:203],a[212:215],v[84:87],v[200:203]
v_exp_f32 v114,v114
v_mfma_f32_16x16x32_bf16 v[204:207],a[216:219],v[80:83],v[204:207]
v_mfma_f32_16x16x32_bf16 v[204:207],a[220:223],v[84:87],v[204:207]
v_exp_f32 v115,v115
v_mfma_f32_16x16x32_bf16 v[208:211],a[224:227],v[80:83],v[208:211]
v_cvt_pk_bf16_f32 v89,v114,v115
v_mfma_f32_16x16x32_bf16 v[208:211],a[228:231],v[84:87],v[208:211]
v_exp_f32 v116,v116
v_mfma_f32_16x16x32_bf16 v[212:215],a[232:235],v[80:83],v[212:215]
v_mfma_f32_16x16x32_bf16 v[212:215],a[236:239],v[84:87],v[212:215]
v_exp_f32 v117,v117
v_mfma_f32_16x16x32_bf16 v[216:219],a[240:243],v[80:83],v[216:219]
buffer_load_dwordx4 v9,s[12:15],s48 offen offset:1024 nt lds
v_cvt_pk_bf16_f32 v90,v116,v117
v_mfma_f32_16x16x32_bf16 v[216:219],a[244:247],v[84:87],v[216:219]
v_exp_f32 v118,v118
v_mfma_f32_16x16x32_bf16 v[220:223],a[248:251],v[80:83],v[220:223]
s_waitcnt lgkmcnt(0)
v_mfma_f32_16x16x32_bf16 v[220:223],a[252:255],v[84:87],v[220:223]
v_exp_f32 v119,v119
v_mfma_f32_16x16x32_bf16 v[56:59],v[44:47],v[80:83],v[56:59]
v_cvt_pk_bf16_f32 v91,v118,v119
v_mfma_f32_16x16x32_bf16 v[56:59],v[44:47],v[84:87],v[56:59]
v_exp_f32 v120,v120
v_mfma_f32_16x16x32_bf16 v[96:99],a[128:131],a[0:3],v[64:67]
v_mfma_f32_16x16x32_bf16 v[96:99],a[132:135],a[4:7],v[96:99]
v_exp_f32 v121,v121
v_mfma_f32_16x16x32_bf16 v[96:99],a[136:139],a[8:11],v[96:99]
v_cvt_pk_bf16_f32 v92,v120,v121
v_mfma_f32_16x16x32_bf16 v[96:99],a[140:143],a[12:15],v[96:99]
v_exp_f32 v122,v122
v_mfma_f32_16x16x32_bf16 v[100:103],a[144:147],a[0:3],v[64:67]
v_mfma_f32_16x16x32_bf16 v[100:103],a[148:151],a[4:7],v[100:103]
v_exp_f32 v123,v123
v_mfma_f32_16x16x32_bf16 v[100:103],a[152:155],a[8:11],v[100:103]
v_cvt_pk_bf16_f32 v93,v122,v123
v_mfma_f32_16x16x32_bf16 v[100:103],a[156:159],a[12:15],v[100:103]
v_exp_f32 v124,v124
v_mfma_f32_16x16x32_bf16 v[104:107],a[160:163],a[0:3],v[64:67]
v_mfma_f32_16x16x32_bf16 v[104:107],a[164:167],a[4:7],v[104:107]
v_exp_f32 v125,v125
v_mfma_f32_16x16x32_bf16 v[104:107],a[168:171],a[8:11],v[104:107]
v_cvt_pk_bf16_f32 v94,v124,v125
v_mfma_f32_16x16x32_bf16 v[104:107],a[172:175],a[12:15],v[104:107]
buffer_load_dwordx4 v8,s[12:15],s48 offen offset:2048 nt lds
v_exp_f32 v126,v126
v_mfma_f32_16x16x32_bf16 v[108:111],a[176:179],a[0:3],v[64:67]
v_mfma_f32_16x16x32_bf16 v[108:111],a[180:183],a[4:7],v[108:111]
v_exp_f32 v127,v127
v_mfma_f32_16x16x32_bf16 v[108:111],a[184:187],a[8:11],v[108:111]
v_cvt_pk_bf16_f32 v95,v126,v127
v_mfma_f32_16x16x32_bf16 v[108:111],a[188:191],a[12:15],v[108:111]
v_mfma_f32_16x16x32_bf16 v[224:227],a[192:195],v[88:91],v[224:227]
v_mfma_f32_16x16x32_bf16 v[224:227],a[196:199],v[92:95],v[224:227]
v_exp_f32 v96,v96
v_mfma_f32_16x16x32_bf16 v[228:231],a[200:203],v[88:91],v[228:231]
ds_read_b64_tr_b16 a[192:193],v14 offset:49152
ds_read_b64_tr_b16 a[194:195],v14 offset:53248
v_mfma_f32_16x16x32_bf16 v[228:231],a[204:207],v[92:95],v[228:231]
v_exp_f32 v97,v97
v_mfma_f32_16x16x32_bf16 v[232:235],a[208:211],v[88:91],v[232:235]
ds_read_b64_tr_b16 a[196:197],v14 offset:57344
v_cvt_pk_bf16_f32 v80,v96,v97
v_mfma_f32_16x16x32_bf16 v[232:235],a[212:215],v[92:95],v[232:235]
v_exp_f32 v98,v98
v_mfma_f32_16x16x32_bf16 v[236:239],a[216:219],v[88:91],v[236:239]
ds_read_b64_tr_b16 a[198:199],v14 offset:61440
ds_read_b64_tr_b16 a[200:201],v15 offset:49152
v_mfma_f32_16x16x32_bf16 v[236:239],a[220:223],v[92:95],v[236:239]
v_exp_f32 v99,v99
v_mfma_f32_16x16x32_bf16 v[240:243],a[224:227],v[88:91],v[240:243]
ds_read_b64_tr_b16 a[202:203],v15 offset:53248
v_cvt_pk_bf16_f32 v81,v98,v99
v_mfma_f32_16x16x32_bf16 v[240:243],a[228:231],v[92:95],v[240:243]
v_exp_f32 v100,v100
v_mfma_f32_16x16x32_bf16 v[244:247],a[232:235],v[88:91],v[244:247]
ds_read_b64_tr_b16 a[204:205],v15 offset:57344
ds_read_b64_tr_b16 a[206:207],v15 offset:61440
v_mfma_f32_16x16x32_bf16 v[244:247],a[236:239],v[92:95],v[244:247]
v_exp_f32 v101,v101
v_mfma_f32_16x16x32_bf16 v[248:251],a[240:243],v[88:91],v[248:251]
ds_read_b64_tr_b16 a[208:209],v16 offset:49152
v_cvt_pk_bf16_f32 v82,v100,v101
v_mfma_f32_16x16x32_bf16 v[248:251],a[244:247],v[92:95],v[248:251]
buffer_load_dwordx4 v9,s[12:15],s48 offen offset:3072 nt lds
v_exp_f32 v102,v102
v_mfma_f32_16x16x32_bf16 v[252:255],a[248:251],v[88:91],v[252:255]
ds_read_b64_tr_b16 a[210:211],v16 offset:53248
ds_read_b64_tr_b16 a[212:213],v16 offset:57344
v_mfma_f32_16x16x32_bf16 v[252:255],a[252:255],v[92:95],v[252:255]
v_exp_f32 v103,v103
v_mfma_f32_16x16x32_bf16 v[60:63],v[44:47],v[88:91],v[60:63]
ds_read_b64_tr_b16 a[214:215],v16 offset:61440
v_cvt_pk_bf16_f32 v83,v102,v103
v_mfma_f32_16x16x32_bf16 v[60:63],v[44:47],v[92:95],v[60:63]
v_exp_f32 v104,v104
v_mfma_f32_16x16x32_bf16 v[112:115],a[128:131],a[16:19],v[68:71]
ds_read_b64_tr_b16 a[216:217],v17 offset:49152
ds_read_b64_tr_b16 a[218:219],v17 offset:53248
v_mfma_f32_16x16x32_bf16 v[112:115],a[132:135],a[20:23],v[112:115]
v_exp_f32 v105,v105
v_mfma_f32_16x16x32_bf16 v[112:115],a[136:139],a[24:27],v[112:115]
ds_read_b64_tr_b16 a[220:221],v17 offset:57344
v_cvt_pk_bf16_f32 v84,v104,v105
v_mfma_f32_16x16x32_bf16 v[112:115],a[140:143],a[28:31],v[112:115]
v_exp_f32 v106,v106
v_mfma_f32_16x16x32_bf16 v[116:119],a[144:147],a[16:19],v[68:71]
ds_read_b64_tr_b16 a[222:223],v17 offset:61440
ds_read_b64_tr_b16 a[224:225],v18 offset:49152
v_mfma_f32_16x16x32_bf16 v[116:119],a[148:151],a[20:23],v[116:119]
v_exp_f32 v107,v107
v_mfma_f32_16x16x32_bf16 v[116:119],a[152:155],a[24:27],v[116:119]
ds_read_b64_tr_b16 a[226:227],v18 offset:53248
v_cvt_pk_bf16_f32 v85,v106,v107
v_mfma_f32_16x16x32_bf16 v[116:119],a[156:159],a[28:31],v[116:119]
v_exp_f32 v108,v108
v_mfma_f32_16x16x32_bf16 v[120:123],a[160:163],a[16:19],v[68:71]
ds_read_b64_tr_b16 a[228:229],v18 offset:57344
ds_read_b64_tr_b16 a[230:231],v18 offset:61440
v_mfma_f32_16x16x32_bf16 v[120:123],a[164:167],a[20:23],v[120:123]
v_exp_f32 v109,v109
v_mfma_f32_16x16x32_bf16 v[120:123],a[168:171],a[24:27],v[120:123]
ds_read_b64_tr_b16 a[232:233],v19 offset:49152
v_cvt_pk_bf16_f32 v86,v108,v109
v_mfma_f32_16x16x32_bf16 v[120:123],a[172:175],a[28:31],v[120:123]
s_mov_b32 s48,147456
v_exp_f32 v110,v110
v_mfma_f32_16x16x32_bf16 v[124:127],a[176:179],a[16:19],v[68:71]
ds_read_b64_tr_b16 a[234:235],v19 offset:53248
ds_read_b64_tr_b16 a[236:237],v19 offset:57344
s_add_u32 m0,s39,16384
v_mfma_f32_16x16x32_bf16 v[124:127],a[180:183],a[20:23],v[124:127]
buffer_load_dwordx4 v4,s[8:11],s48 offen nt lds
v_exp_f32 v111,v111
v_mfma_f32_16x16x32_bf16 v[124:127],a[184:187],a[24:27],v[124:127]
ds_read_b64_tr_b16 a[238:239],v19 offset:61440
v_cvt_pk_bf16_f32 v87,v110,v111
v_mfma_f32_16x16x32_bf16 v[124:127],a[188:191],a[28:31],v[124:127]
ds_read_b64_tr_b16 a[240:241],v20 offset:49152
ds_read_b64_tr_b16 a[242:243],v20 offset:53248
v_mfma_f32_16x16x32_bf16 v[96:99],a[128:131],a[32:35],v[72:75]
ds_read_b64_tr_b16 a[244:245],v20 offset:57344
ds_read_b64_tr_b16 a[246:247],v20 offset:61440
v_mfma_f32_16x16x32_bf16 v[96:99],a[132:135],a[36:39],v[96:99]
v_exp_f32 v112,v112
v_mfma_f32_16x16x32_bf16 v[96:99],a[136:139],a[40:43],v[96:99]
ds_read_b64_tr_b16 a[248:249],v21 offset:49152
ds_read_b64_tr_b16 a[250:251],v21 offset:53248
v_mfma_f32_16x16x32_bf16 v[96:99],a[140:143],a[44:47],v[96:99]
v_exp_f32 v113,v113
v_mfma_f32_16x16x32_bf16 v[100:103],a[144:147],a[32:35],v[72:75]
ds_read_b64_tr_b16 a[252:253],v21 offset:57344
v_cvt_pk_bf16_f32 v88,v112,v113
v_mfma_f32_16x16x32_bf16 v[100:103],a[148:151],a[36:39],v[100:103]
v_exp_f32 v114,v114
v_mfma_f32_16x16x32_bf16 v[100:103],a[152:155],a[40:43],v[100:103]
ds_read_b64_tr_b16 a[254:255],v21 offset:61440
v_mfma_f32_16x16x32_bf16 v[100:103],a[156:159],a[44:47],v[100:103]
v_exp_f32 v115,v115
v_mfma_f32_16x16x32_bf16 v[104:107],a[160:163],a[32:35],v[72:75]
v_cvt_pk_bf16_f32 v89,v114,v115
v_mfma_f32_16x16x32_bf16 v[104:107],a[164:167],a[36:39],v[104:107]
v_exp_f32 v116,v116
v_mfma_f32_16x16x32_bf16 v[104:107],a[168:171],a[40:43],v[104:107]
v_mfma_f32_16x16x32_bf16 v[104:107],a[172:175],a[44:47],v[104:107]
v_exp_f32 v117,v117
v_mfma_f32_16x16x32_bf16 v[108:111],a[176:179],a[32:35],v[72:75]
buffer_load_dwordx4 v5,s[8:11],s48 offen offset:1024 nt lds
v_cvt_pk_bf16_f32 v90,v116,v117
v_mfma_f32_16x16x32_bf16 v[108:111],a[180:183],a[36:39],v[108:111]
v_exp_f32 v118,v118
v_mfma_f32_16x16x32_bf16 v[108:111],a[184:187],a[40:43],v[108:111]
s_waitcnt lgkmcnt(0)
v_mfma_f32_16x16x32_bf16 v[108:111],a[188:191],a[44:47],v[108:111]
v_exp_f32 v119,v119
v_mfma_f32_16x16x32_bf16 v[128:131],a[192:195],v[80:83],v[128:131]
v_cvt_pk_bf16_f32 v91,v118,v119
v_mfma_f32_16x16x32_bf16 v[128:131],a[196:199],v[84:87],v[128:131]
v_exp_f32 v120,v120
v_mfma_f32_16x16x32_bf16 v[132:135],a[200:203],v[80:83],v[132:135]
v_mfma_f32_16x16x32_bf16 v[132:135],a[204:207],v[84:87],v[132:135]
v_exp_f32 v121,v121
v_mfma_f32_16x16x32_bf16 v[136:139],a[208:211],v[80:83],v[136:139]
v_cvt_pk_bf16_f32 v92,v120,v121
v_mfma_f32_16x16x32_bf16 v[136:139],a[212:215],v[84:87],v[136:139]
v_exp_f32 v122,v122
v_mfma_f32_16x16x32_bf16 v[140:143],a[216:219],v[80:83],v[140:143]
v_mfma_f32_16x16x32_bf16 v[140:143],a[220:223],v[84:87],v[140:143]
v_exp_f32 v123,v123
v_mfma_f32_16x16x32_bf16 v[144:147],a[224:227],v[80:83],v[144:147]
v_cvt_pk_bf16_f32 v93,v122,v123
v_mfma_f32_16x16x32_bf16 v[144:147],a[228:231],v[84:87],v[144:147]
v_exp_f32 v124,v124
v_mfma_f32_16x16x32_bf16 v[148:151],a[232:235],v[80:83],v[148:151]
v_mfma_f32_16x16x32_bf16 v[148:151],a[236:239],v[84:87],v[148:151]
v_exp_f32 v125,v125
v_mfma_f32_16x16x32_bf16 v[152:155],a[240:243],v[80:83],v[152:155]
v_cvt_pk_bf16_f32 v94,v124,v125
v_mfma_f32_16x16x32_bf16 v[152:155],a[244:247],v[84:87],v[152:155]
buffer_load_dwordx4 v6,s[8:11],s48 offen offset:2048 nt lds
v_exp_f32 v126,v126
v_mfma_f32_16x16x32_bf16 v[156:159],a[248:251],v[80:83],v[156:159]
v_mfma_f32_16x16x32_bf16 v[156:159],a[252:255],v[84:87],v[156:159]
v_exp_f32 v127,v127
v_mfma_f32_16x16x32_bf16 v[48:51],v[44:47],v[80:83],v[48:51]
v_cvt_pk_bf16_f32 v95,v126,v127
v_mfma_f32_16x16x32_bf16 v[48:51],v[44:47],v[84:87],v[48:51]
s_waitcnt vmcnt(3)
s_barrier
v_mfma_f32_16x16x32_bf16 v[112:115],a[128:131],a[48:51],v[76:79]
v_mfma_f32_16x16x32_bf16 v[112:115],a[132:135],a[52:55],v[112:115]
v_exp_f32 v96,v96
v_mfma_f32_16x16x32_bf16 v[112:115],a[136:139],a[56:59],v[112:115]
v_mfma_f32_16x16x32_bf16 v[112:115],a[140:143],a[60:63],v[112:115]
v_exp_f32 v97,v97
v_mfma_f32_16x16x32_bf16 v[116:119],a[144:147],a[48:51],v[76:79]
ds_read_b128 a[128:131],v10 offset:0
v_cvt_pk_bf16_f32 v80,v96,v97
v_mfma_f32_16x16x32_bf16 v[116:119],a[148:151],a[52:55],v[116:119]
v_exp_f32 v98,v98
v_mfma_f32_16x16x32_bf16 v[116:119],a[152:155],a[56:59],v[116:119]
ds_read_b128 a[132:135],v11 offset:0
v_mfma_f32_16x16x32_bf16 v[116:119],a[156:159],a[60:63],v[116:119]
v_exp_f32 v99,v99
v_mfma_f32_16x16x32_bf16 v[120:123],a[160:163],a[48:51],v[76:79]
ds_read_b128 a[136:139],v12 offset:0
v_cvt_pk_bf16_f32 v81,v98,v99
v_mfma_f32_16x16x32_bf16 v[120:123],a[164:167],a[52:55],v[120:123]
v_exp_f32 v100,v100
v_mfma_f32_16x16x32_bf16 v[120:123],a[168:171],a[56:59],v[120:123]
ds_read_b128 a[140:143],v13 offset:0
v_mfma_f32_16x16x32_bf16 v[120:123],a[172:175],a[60:63],v[120:123]
v_exp_f32 v101,v101
v_mfma_f32_16x16x32_bf16 v[124:127],a[176:179],a[48:51],v[76:79]
ds_read_b128 a[144:147],v10 offset:4096
v_cvt_pk_bf16_f32 v82,v100,v101
v_mfma_f32_16x16x32_bf16 v[124:127],a[180:183],a[52:55],v[124:127]
buffer_load_dwordx4 v7,s[8:11],s48 offen offset:3072 nt lds
v_exp_f32 v102,v102
v_mfma_f32_16x16x32_bf16 v[124:127],a[184:187],a[56:59],v[124:127]
ds_read_b128 a[148:151],v11 offset:4096
v_mfma_f32_16x16x32_bf16 v[124:127],a[188:191],a[60:63],v[124:127]
v_exp_f32 v103,v103
v_mfma_f32_16x16x32_bf16 v[160:163],a[192:195],v[88:91],v[160:163]
ds_read_b128 a[152:155],v12 offset:4096
v_cvt_pk_bf16_f32 v83,v102,v103
v_mfma_f32_16x16x32_bf16 v[160:163],a[196:199],v[92:95],v[160:163]
v_exp_f32 v104,v104
v_mfma_f32_16x16x32_bf16 v[164:167],a[200:203],v[88:91],v[164:167]
ds_read_b128 a[156:159],v13 offset:4096
v_mfma_f32_16x16x32_bf16 v[164:167],a[204:207],v[92:95],v[164:167]
v_exp_f32 v105,v105
v_mfma_f32_16x16x32_bf16 v[168:171],a[208:211],v[88:91],v[168:171]
ds_read_b128 a[160:163],v10 offset:8192
v_cvt_pk_bf16_f32 v84,v104,v105
v_mfma_f32_16x16x32_bf16 v[168:171],a[212:215],v[92:95],v[168:171]
v_exp_f32 v106,v106
v_mfma_f32_16x16x32_bf16 v[172:175],a[216:219],v[88:91],v[172:175]
ds_read_b128 a[164:167],v11 offset:8192
v_mfma_f32_16x16x32_bf16 v[172:175],a[220:223],v[92:95],v[172:175]
v_exp_f32 v107,v107
v_mfma_f32_16x16x32_bf16 v[176:179],a[224:227],v[88:91],v[176:179]
ds_read_b128 a[168:171],v12 offset:8192
v_cvt_pk_bf16_f32 v85,v106,v107
v_mfma_f32_16x16x32_bf16 v[176:179],a[228:231],v[92:95],v[176:179]
v_exp_f32 v108,v108
v_mfma_f32_16x16x32_bf16 v[180:183],a[232:235],v[88:91],v[180:183]
ds_read_b128 a[172:175],v13 offset:8192
v_mfma_f32_16x16x32_bf16 v[180:183],a[236:239],v[92:95],v[180:183]
v_exp_f32 v109,v109
v_mfma_f32_16x16x32_bf16 v[184:187],a[240:243],v[88:91],v[184:187]
ds_read_b128 a[176:179],v10 offset:12288
v_cvt_pk_bf16_f32 v86,v108,v109
v_mfma_f32_16x16x32_bf16 v[184:187],a[244:247],v[92:95],v[184:187]
s_add_u32 m0,s39,81920
v_exp_f32 v110,v110
v_mfma_f32_16x16x32_bf16 v[188:191],a[248:251],v[88:91],v[188:191]
ds_read_b128 a[180:183],v11 offset:12288
v_mfma_f32_16x16x32_bf16 v[188:191],a[252:255],v[92:95],v[188:191]
buffer_load_dwordx4 v8,s[12:15],s48 offen nt lds
v_exp_f32 v111,v111
v_mfma_f32_16x16x32_bf16 v[52:55],v[44:47],v[88:91],v[52:55]
ds_read_b128 a[184:187],v12 offset:12288
v_cvt_pk_bf16_f32 v87,v110,v111
v_mfma_f32_16x16x32_bf16 v[52:55],v[44:47],v[92:95],v[52:55]
ds_read_b128 a[188:191],v13 offset:12288
v_mfma_f32_16x16x32_bf16 v[192:195],a[192:195],v[80:83],v[192:195]
v_mfma_f32_16x16x32_bf16 v[192:195],a[196:199],v[84:87],v[192:195]
v_exp_f32 v112,v112
v_mfma_f32_16x16x32_bf16 v[196:199],a[200:203],v[80:83],v[196:199]
v_mfma_f32_16x16x32_bf16 v[196:199],a[204:207],v[84:87],v[196:199]
v_exp_f32 v113,v113
v_mfma_f32_16x16x32_bf16 v[200:203],a[208:211],v[80:83],v[200:203]
v_cvt_pk_bf16_f32 v88,v112,v113
v_mfma_f32_16x16x32_bf16 v[200:203],a[212:215],v[84:87],v[200:203]
v_exp_f32 v114,v114
v_mfma_f32_16x16x32_bf16 v[204:207],a[216:219],v[80:83],v[204:207]
v_mfma_f32_16x16x32_bf16 v[204:207],a[220:223],v[84:87],v[204:207]
v_exp_f32 v115,v115
v_mfma_f32_16x16x32_bf16 v[208:211],a[224:227],v[80:83],v[208:211]
v_cvt_pk_bf16_f32 v89,v114,v115
v_mfma_f32_16x16x32_bf16 v[208:211],a[228:231],v[84:87],v[208:211]
v_exp_f32 v116,v116
v_mfma_f32_16x16x32_bf16 v[212:215],a[232:235],v[80:83],v[212:215]
v_mfma_f32_16x16x32_bf16 v[212:215],a[236:239],v[84:87],v[212:215]
v_exp_f32 v117,v117
v_mfma_f32_16x16x32_bf16 v[216:219],a[240:243],v[80:83],v[216:219]
buffer_load_dwordx4 v9,s[12:15],s48 offen offset:1024 nt lds
v_cvt_pk_bf16_f32 v90,v116,v117
v_mfma_f32_16x16x32_bf16 v[216:219],a[244:247],v[84:87],v[216:219]
v_exp_f32 v118,v118
v_mfma_f32_16x16x32_bf16 v[220:223],a[248:251],v[80:83],v[220:223]
s_waitcnt lgkmcnt(0)
v_mfma_f32_16x16x32_bf16 v[220:223],a[252:255],v[84:87],v[220:223]
v_exp_f32 v119,v119
v_mfma_f32_16x16x32_bf16 v[56:59],v[44:47],v[80:83],v[56:59]
v_cvt_pk_bf16_f32 v91,v118,v119
v_mfma_f32_16x16x32_bf16 v[56:59],v[44:47],v[84:87],v[56:59]
v_exp_f32 v120,v120
v_mfma_f32_16x16x32_bf16 v[96:99],a[128:131],a[0:3],v[64:67]
v_mfma_f32_16x16x32_bf16 v[96:99],a[132:135],a[4:7],v[96:99]
v_exp_f32 v121,v121
v_mfma_f32_16x16x32_bf16 v[96:99],a[136:139],a[8:11],v[96:99]
v_cvt_pk_bf16_f32 v92,v120,v121
v_mfma_f32_16x16x32_bf16 v[96:99],a[140:143],a[12:15],v[96:99]
v_exp_f32 v122,v122
v_mfma_f32_16x16x32_bf16 v[100:103],a[144:147],a[0:3],v[64:67]
v_mfma_f32_16x16x32_bf16 v[100:103],a[148:151],a[4:7],v[100:103]
v_exp_f32 v123,v123
v_mfma_f32_16x16x32_bf16 v[100:103],a[152:155],a[8:11],v[100:103]
v_cvt_pk_bf16_f32 v93,v122,v123
v_mfma_f32_16x16x32_bf16 v[100:103],a[156:159],a[12:15],v[100:103]
v_exp_f32 v124,v124
v_mfma_f32_16x16x32_bf16 v[104:107],a[160:163],a[0:3],v[64:67]
v_mfma_f32_16x16x32_bf16 v[104:107],a[164:167],a[4:7],v[104:107]
v_exp_f32 v125,v125
v_mfma_f32_16x16x32_bf16 v[104:107],a[168:171],a[8:11],v[104:107]
v_cvt_pk_bf16_f32 v94,v124,v125
v_mfma_f32_16x16x32_bf16 v[104:107],a[172:175],a[12:15],v[104:107]
buffer_load_dwordx4 v8,s[12:15],s48 offen offset:2048 nt lds
v_exp_f32 v126,v126
v_mfma_f32_16x16x32_bf16 v[108:111],a[176:179],a[0:3],v[64:67]
v_mfma_f32_16x16x32_bf16 v[108:111],a[180:183],a[4:7],v[108:111]
v_exp_f32 v127,v127
v_mfma_f32_16x16x32_bf16 v[108:111],a[184:187],a[8:11],v[108:111]
v_cvt_pk_bf16_f32 v95,v126,v127
v_mfma_f32_16x16x32_bf16 v[108:111],a[188:191],a[12:15],v[108:111]
v_mfma_f32_16x16x32_bf16 v[224:227],a[192:195],v[88:91],v[224:227]
v_mfma_f32_16x16x32_bf16 v[224:227],a[196:199],v[92:95],v[224:227]
v_exp_f32 v96,v96
v_mfma_f32_16x16x32_bf16 v[228:231],a[200:203],v[88:91],v[228:231]
ds_read_b64_tr_b16 a[192:193],v14 offset:0
ds_read_b64_tr_b16 a[194:195],v14 offset:4096
v_mfma_f32_16x16x32_bf16 v[228:231],a[204:207],v[92:95],v[228:231]
v_exp_f32 v97,v97
v_mfma_f32_16x16x32_bf16 v[232:235],a[208:211],v[88:91],v[232:235]
ds_read_b64_tr_b16 a[196:197],v14 offset:8192
v_cvt_pk_bf16_f32 v80,v96,v97
v_mfma_f32_16x16x32_bf16 v[232:235],a[212:215],v[92:95],v[232:235]
v_exp_f32 v98,v98
v_mfma_f32_16x16x32_bf16 v[236:239],a[216:219],v[88:91],v[236:239]
ds_read_b64_tr_b16 a[198:199],v14 offset:12288
ds_read_b64_tr_b16 a[200:201],v15 offset:0
v_mfma_f32_16x16x32_bf16 v[236:239],a[220:223],v[92:95],v[236:239]
v_exp_f32 v99,v99
v_mfma_f32_16x16x32_bf16 v[240:243],a[224:227],v[88:91],v[240:243]
ds_read_b64_tr_b16 a[202:203],v15 offset:4096
v_cvt_pk_bf16_f32 v81,v98,v99
v_mfma_f32_16x16x32_bf16 v[240:243],a[228:231],v[92:95],v[240:243]
v_exp_f32 v100,v100
v_mfma_f32_16x16x32_bf16 v[244:247],a[232:235],v[88:91],v[244:247]
ds_read_b64_tr_b16 a[204:205],v15 offset:8192
ds_read_b64_tr_b16 a[206:207],v15 offset:12288
v_mfma_f32_16x16x32_bf16 v[244:247],a[236:239],v[92:95],v[244:247]
v_exp_f32 v101,v101
v_mfma_f32_16x16x32_bf16 v[248:251],a[240:243],v[88:91],v[248:251]
ds_read_b64_tr_b16 a[208:209],v16 offset:0
v_cvt_pk_bf16_f32 v82,v100,v101
v_mfma_f32_16x16x32_bf16 v[248:251],a[244:247],v[92:95],v[248:251]
buffer_load_dwordx4 v9,s[12:15],s48 offen offset:3072 nt lds
v_exp_f32 v102,v102
v_mfma_f32_16x16x32_bf16 v[252:255],a[248:251],v[88:91],v[252:255]
ds_read_b64_tr_b16 a[210:211],v16 offset:4096
ds_read_b64_tr_b16 a[212:213],v16 offset:8192
v_mfma_f32_16x16x32_bf16 v[252:255],a[252:255],v[92:95],v[252:255]
v_exp_f32 v103,v103
v_mfma_f32_16x16x32_bf16 v[60:63],v[44:47],v[88:91],v[60:63]
ds_read_b64_tr_b16 a[214:215],v16 offset:12288
v_cvt_pk_bf16_f32 v83,v102,v103
v_mfma_f32_16x16x32_bf16 v[60:63],v[44:47],v[92:95],v[60:63]
v_exp_f32 v104,v104
v_mfma_f32_16x16x32_bf16 v[112:115],a[128:131],a[16:19],v[68:71]
ds_read_b64_tr_b16 a[216:217],v17 offset:0
ds_read_b64_tr_b16 a[218:219],v17 offset:4096
v_mfma_f32_16x16x32_bf16 v[112:115],a[132:135],a[20:23],v[112:115]
v_exp_f32 v105,v105
v_mfma_f32_16x16x32_bf16 v[112:115],a[136:139],a[24:27],v[112:115]
ds_read_b64_tr_b16 a[220:221],v17 offset:8192
v_cvt_pk_bf16_f32 v84,v104,v105
v_mfma_f32_16x16x32_bf16 v[112:115],a[140:143],a[28:31],v[112:115]
v_exp_f32 v106,v106
v_mfma_f32_16x16x32_bf16 v[116:119],a[144:147],a[16:19],v[68:71]
ds_read_b64_tr_b16 a[222:223],v17 offset:12288
ds_read_b64_tr_b16 a[224:225],v18 offset:0
v_mfma_f32_16x16x32_bf16 v[116:119],a[148:151],a[20:23],v[116:119]
v_exp_f32 v107,v107
v_mfma_f32_16x16x32_bf16 v[116:119],a[152:155],a[24:27],v[116:119]
ds_read_b64_tr_b16 a[226:227],v18 offset:4096
v_cvt_pk_bf16_f32 v85,v106,v107
v_mfma_f32_16x16x32_bf16 v[116:119],a[156:159],a[28:31],v[116:119]
v_exp_f32 v108,v108
v_mfma_f32_16x16x32_bf16 v[120:123],a[160:163],a[16:19],v[68:71]
ds_read_b64_tr_b16 a[228:229],v18 offset:8192
ds_read_b64_tr_b16 a[230:231],v18 offset:12288
v_mfma_f32_16x16x32_bf16 v[120:123],a[164:167],a[20:23],v[120:123]
v_exp_f32 v109,v109
v_mfma_f32_16x16x32_bf16 v[120:123],a[168:171],a[24:27],v[120:123]
ds_read_b64_tr_b16 a[232:233],v19 offset:0
v_cvt_pk_bf16_f32 v86,v108,v109
v_mfma_f32_16x16x32_bf16 v[120:123],a[172:175],a[28:31],v[120:123]
s_mov_b32 s48,163840
v_exp_f32 v110,v110
v_mfma_f32_16x16x32_bf16 v[124:127],a[176:179],a[16:19],v[68:71]
ds_read_b64_tr_b16 a[234:235],v19 offset:4096
ds_read_b64_tr_b16 a[236:237],v19 offset:8192
s_add_u32 m0,s39,32768
v_mfma_f32_16x16x32_bf16 v[124:127],a[180:183],a[20:23],v[124:127]
buffer_load_dwordx4 v4,s[8:11],s48 offen nt lds
v_exp_f32 v111,v111
v_mfma_f32_16x16x32_bf16 v[124:127],a[184:187],a[24:27],v[124:127]
ds_read_b64_tr_b16 a[238:239],v19 offset:12288
v_cvt_pk_bf16_f32 v87,v110,v111
v_mfma_f32_16x16x32_bf16 v[124:127],a[188:191],a[28:31],v[124:127]
ds_read_b64_tr_b16 a[240:241],v20 offset:0
ds_read_b64_tr_b16 a[242:243],v20 offset:4096
v_mfma_f32_16x16x32_bf16 v[96:99],a[128:131],a[32:35],v[72:75]
ds_read_b64_tr_b16 a[244:245],v20 offset:8192
ds_read_b64_tr_b16 a[246:247],v20 offset:12288
v_mfma_f32_16x16x32_bf16 v[96:99],a[132:135],a[36:39],v[96:99]
v_exp_f32 v112,v112
v_mfma_f32_16x16x32_bf16 v[96:99],a[136:139],a[40:43],v[96:99]
ds_read_b64_tr_b16 a[248:249],v21 offset:0
ds_read_b64_tr_b16 a[250:251],v21 offset:4096
v_mfma_f32_16x16x32_bf16 v[96:99],a[140:143],a[44:47],v[96:99]
v_exp_f32 v113,v113
v_mfma_f32_16x16x32_bf16 v[100:103],a[144:147],a[32:35],v[72:75]
ds_read_b64_tr_b16 a[252:253],v21 offset:8192
v_cvt_pk_bf16_f32 v88,v112,v113
v_mfma_f32_16x16x32_bf16 v[100:103],a[148:151],a[36:39],v[100:103]
v_exp_f32 v114,v114
v_mfma_f32_16x16x32_bf16 v[100:103],a[152:155],a[40:43],v[100:103]
ds_read_b64_tr_b16 a[254:255],v21 offset:12288
v_mfma_f32_16x16x32_bf16 v[100:103],a[156:159],a[44:47],v[100:103]
v_exp_f32 v115,v115
v_mfma_f32_16x16x32_bf16 v[104:107],a[160:163],a[32:35],v[72:75]
v_cvt_pk_bf16_f32 v89,v114,v115
v_mfma_f32_16x16x32_bf16 v[104:107],a[164:167],a[36:39],v[104:107]
v_exp_f32 v116,v116
v_mfma_f32_16x16x32_bf16 v[104:107],a[168:171],a[40:43],v[104:107]
v_mfma_f32_16x16x32_bf16 v[104:107],a[172:175],a[44:47],v[104:107]
v_exp_f32 v117,v117
v_mfma_f32_16x16x32_bf16 v[108:111],a[176:179],a[32:35],v[72:75]
buffer_load_dwordx4 v5,s[8:11],s48 offen offset:1024 nt lds
v_cvt_pk_bf16_f32 v90,v116,v117
v_mfma_f32_16x16x32_bf16 v[108:111],a[180:183],a[36:39],v[108:111]
v_exp_f32 v118,v118
v_mfma_f32_16x16x32_bf16 v[108:111],a[184:187],a[40:43],v[108:111]
s_waitcnt lgkmcnt(0)
v_mfma_f32_16x16x32_bf16 v[108:111],a[188:191],a[44:47],v[108:111]
v_exp_f32 v119,v119
v_mfma_f32_16x16x32_bf16 v[128:131],a[192:195],v[80:83],v[128:131]
v_cvt_pk_bf16_f32 v91,v118,v119
v_mfma_f32_16x16x32_bf16 v[128:131],a[196:199],v[84:87],v[128:131]
v_exp_f32 v120,v120
v_mfma_f32_16x16x32_bf16 v[132:135],a[200:203],v[80:83],v[132:135]
v_mfma_f32_16x16x32_bf16 v[132:135],a[204:207],v[84:87],v[132:135]
v_exp_f32 v121,v121
v_mfma_f32_16x16x32_bf16 v[136:139],a[208:211],v[80:83],v[136:139]
v_cvt_pk_bf16_f32 v92,v120,v121
v_mfma_f32_16x16x32_bf16 v[136:139],a[212:215],v[84:87],v[136:139]
v_exp_f32 v122,v122
v_mfma_f32_16x16x32_bf16 v[140:143],a[216:219],v[80:83],v[140:143]
v_mfma_f32_16x16x32_bf16 v[140:143],a[220:223],v[84:87],v[140:143]
v_exp_f32 v123,v123
v_mfma_f32_16x16x32_bf16 v[144:147],a[224:227],v[80:83],v[144:147]
v_cvt_pk_bf16_f32 v93,v122,v123
v_mfma_f32_16x16x32_bf16 v[144:147],a[228:231],v[84:87],v[144:147]
v_exp_f32 v124,v124
v_mfma_f32_16x16x32_bf16 v[148:151],a[232:235],v[80:83],v[148:151]
v_mfma_f32_16x16x32_bf16 v[148:151],a[236:239],v[84:87],v[148:151]
v_exp_f32 v125,v125
v_mfma_f32_16x16x32_bf16 v[152:155],a[240:243],v[80:83],v[152:155]
v_cvt_pk_bf16_f32 v94,v124,v125
v_mfma_f32_16x16x32_bf16 v[152:155],a[244:247],v[84:87],v[152:155]
buffer_load_dwordx4 v6,s[8:11],s48 offen offset:2048 nt lds
v_exp_f32 v126,v126
v_mfma_f32_16x16x32_bf16 v[156:159],a[248:251],v[80:83],v[156:159]
v_mfma_f32_16x16x32_bf16 v[156:159],a[252:255],v[84:87],v[156:159]
v_exp_f32 v127,v127
v_mfma_f32_16x16x32_bf16 v[48:51],v[44:47],v[80:83],v[48:51]
v_cvt_pk_bf16_f32 v95,v126,v127
v_mfma_f32_16x16x32_bf16 v[48:51],v[44:47],v[84:87],v[48:51]
s_waitcnt vmcnt(3)
s_barrier
v_mfma_f32_16x16x32_bf16 v[112:115],a[128:131],a[48:51],v[76:79]
v_mfma_f32_16x16x32_bf16 v[112:115],a[132:135],a[52:55],v[112:115]
v_exp_f32 v96,v96
v_mfma_f32_16x16x32_bf16 v[112:115],a[136:139],a[56:59],v[112:115]
v_mfma_f32_16x16x32_bf16 v[112:115],a[140:143],a[60:63],v[112:115]
v_exp_f32 v97,v97
v_mfma_f32_16x16x32_bf16 v[116:119],a[144:147],a[48:51],v[76:79]
ds_read_b128 a[128:131],v10 offset:16384
v_cvt_pk_bf16_f32 v80,v96,v97
v_mfma_f32_16x16x32_bf16 v[116:119],a[148:151],a[52:55],v[116:119]
v_exp_f32 v98,v98
v_mfma_f32_16x16x32_bf16 v[116:119],a[152:155],a[56:59],v[116:119]
ds_read_b128 a[132:135],v11 offset:16384
v_mfma_f32_16x16x32_bf16 v[116:119],a[156:159],a[60:63],v[116:119]
v_exp_f32 v99,v99
v_mfma_f32_16x16x32_bf16 v[120:123],a[160:163],a[48:51],v[76:79]
ds_read_b128 a[136:139],v12 offset:16384
v_cvt_pk_bf16_f32 v81,v98,v99
v_mfma_f32_16x16x32_bf16 v[120:123],a[164:167],a[52:55],v[120:123]
v_exp_f32 v100,v100
v_mfma_f32_16x16x32_bf16 v[120:123],a[168:171],a[56:59],v[120:123]
ds_read_b128 a[140:143],v13 offset:16384
v_mfma_f32_16x16x32_bf16 v[120:123],a[172:175],a[60:63],v[120:123]
v_exp_f32 v101,v101
v_mfma_f32_16x16x32_bf16 v[124:127],a[176:179],a[48:51],v[76:79]
ds_read_b128 a[144:147],v10 offset:20480
v_cvt_pk_bf16_f32 v82,v100,v101
v_mfma_f32_16x16x32_bf16 v[124:127],a[180:183],a[52:55],v[124:127]
buffer_load_dwordx4 v7,s[8:11],s48 offen offset:3072 nt lds
v_exp_f32 v102,v102
v_mfma_f32_16x16x32_bf16 v[124:127],a[184:187],a[56:59],v[124:127]
ds_read_b128 a[148:151],v11 offset:20480
v_mfma_f32_16x16x32_bf16 v[124:127],a[188:191],a[60:63],v[124:127]
v_exp_f32 v103,v103
v_mfma_f32_16x16x32_bf16 v[160:163],a[192:195],v[88:91],v[160:163]
ds_read_b128 a[152:155],v12 offset:20480
v_cvt_pk_bf16_f32 v83,v102,v103
v_mfma_f32_16x16x32_bf16 v[160:163],a[196:199],v[92:95],v[160:163]
v_exp_f32 v104,v104
v_mfma_f32_16x16x32_bf16 v[164:167],a[200:203],v[88:91],v[164:167]
ds_read_b128 a[156:159],v13 offset:20480
v_mfma_f32_16x16x32_bf16 v[164:167],a[204:207],v[92:95],v[164:167]
v_exp_f32 v105,v105
v_mfma_f32_16x16x32_bf16 v[168:171],a[208:211],v[88:91],v[168:171]
ds_read_b128 a[160:163],v10 offset:24576
v_cvt_pk_bf16_f32 v84,v104,v105
v_mfma_f32_16x16x32_bf16 v[168:171],a[212:215],v[92:95],v[168:171]
v_exp_f32 v106,v106
v_mfma_f32_16x16x32_bf16 v[172:175],a[216:219],v[88:91],v[172:175]
ds_read_b128 a[164:167],v11 offset:24576
v_mfma_f32_16x16x32_bf16 v[172:175],a[220:223],v[92:95],v[172:175]
v_exp_f32 v107,v107
v_mfma_f32_16x16x32_bf16 v[176:179],a[224:227],v[88:91],v[176:179]
ds_read_b128 a[168:171],v12 offset:24576
v_cvt_pk_bf16_f32 v85,v106,v107
v_mfma_f32_16x16x32_bf16 v[176:179],a[228:231],v[92:95],v[176:179]
v_exp_f32 v108,v108
v_mfma_f32_16x16x32_bf16 v[180:183],a[232:235],v[88:91],v[180:183]
ds_read_b128 a[172:175],v13 offset:24576
v_mfma_f32_16x16x32_bf16 v[180:183],a[236:239],v[92:95],v[180:183]
v_exp_f32 v109,v109
v_mfma_f32_16x16x32_bf16 v[184:187],a[240:243],v[88:91],v[184:187]
ds_read_b128 a[176:179],v10 offset:28672
v_cvt_pk_bf16_f32 v86,v108,v109
v_mfma_f32_16x16x32_bf16 v[184:187],a[244:247],v[92:95],v[184:187]
s_add_u32 m0,s39,98304
v_exp_f32 v110,v110
v_mfma_f32_16x16x32_bf16 v[188:191],a[248:251],v[88:91],v[188:191]
ds_read_b128 a[180:183],v11 offset:28672
v_mfma_f32_16x16x32_bf16 v[188:191],a[252:255],v[92:95],v[188:191]
buffer_load_dwordx4 v8,s[12:15],s48 offen nt lds
v_exp_f32 v111,v111
v_mfma_f32_16x16x32_bf16 v[52:55],v[44:47],v[88:91],v[52:55]
ds_read_b128 a[184:187],v12 offset:28672
v_cvt_pk_bf16_f32 v87,v110,v111
v_mfma_f32_16x16x32_bf16 v[52:55],v[44:47],v[92:95],v[52:55]
ds_read_b128 a[188:191],v13 offset:28672
v_mfma_f32_16x16x32_bf16 v[192:195],a[192:195],v[80:83],v[192:195]
v_mfma_f32_16x16x32_bf16 v[192:195],a[196:199],v[84:87],v[192:195]
v_exp_f32 v112,v112
v_mfma_f32_16x16x32_bf16 v[196:199],a[200:203],v[80:83],v[196:199]
v_mfma_f32_16x16x32_bf16 v[196:199],a[204:207],v[84:87],v[196:199]
v_exp_f32 v113,v113
v_mfma_f32_16x16x32_bf16 v[200:203],a[208:211],v[80:83],v[200:203]
v_cvt_pk_bf16_f32 v88,v112,v113
v_mfma_f32_16x16x32_bf16 v[200:203],a[212:215],v[84:87],v[200:203]
v_exp_f32 v114,v114
v_mfma_f32_16x16x32_bf16 v[204:207],a[216:219],v[80:83],v[204:207]
v_mfma_f32_16x16x32_bf16 v[204:207],a[220:223],v[84:87],v[204:207]
v_exp_f32 v115,v115
v_mfma_f32_16x16x32_bf16 v[208:211],a[224:227],v[80:83],v[208:211]
v_cvt_pk_bf16_f32 v89,v114,v115
v_mfma_f32_16x16x32_bf16 v[208:211],a[228:231],v[84:87],v[208:211]
v_exp_f32 v116,v116
v_mfma_f32_16x16x32_bf16 v[212:215],a[232:235],v[80:83],v[212:215]
v_mfma_f32_16x16x32_bf16 v[212:215],a[236:239],v[84:87],v[212:215]
v_exp_f32 v117,v117
v_mfma_f32_16x16x32_bf16 v[216:219],a[240:243],v[80:83],v[216:219]
buffer_load_dwordx4 v9,s[12:15],s48 offen offset:1024 nt lds
v_cvt_pk_bf16_f32 v90,v116,v117
v_mfma_f32_16x16x32_bf16 v[216:219],a[244:247],v[84:87],v[216:219]
buffer_load_dword v24,v41,s[92:95],s90 offen
v_exp_f32 v118,v118
v_mfma_f32_16x16x32_bf16 v[220:223],a[248:251],v[80:83],v[220:223]
s_waitcnt lgkmcnt(0)
v_mfma_f32_16x16x32_bf16 v[220:223],a[252:255],v[84:87],v[220:223]
v_exp_f32 v119,v119
v_mfma_f32_16x16x32_bf16 v[56:59],v[44:47],v[80:83],v[56:59]
v_cvt_pk_bf16_f32 v91,v118,v119
v_mfma_f32_16x16x32_bf16 v[56:59],v[44:47],v[84:87],v[56:59]
v_exp_f32 v120,v120
v_mfma_f32_16x16x32_bf16 v[96:99],a[128:131],a[0:3],v[64:67]
v_mfma_f32_16x16x32_bf16 v[96:99],a[132:135],a[4:7],v[96:99]
v_exp_f32 v121,v121
v_mfma_f32_16x16x32_bf16 v[96:99],a[136:139],a[8:11],v[96:99]
v_cvt_pk_bf16_f32 v92,v120,v121
v_mfma_f32_16x16x32_bf16 v[96:99],a[140:143],a[12:15],v[96:99]
v_exp_f32 v122,v122
v_mfma_f32_16x16x32_bf16 v[100:103],a[144:147],a[0:3],v[64:67]
v_mfma_f32_16x16x32_bf16 v[100:103],a[148:151],a[4:7],v[100:103]
v_exp_f32 v123,v123
v_mfma_f32_16x16x32_bf16 v[100:103],a[152:155],a[8:11],v[100:103]
v_cvt_pk_bf16_f32 v93,v122,v123
v_mfma_f32_16x16x32_bf16 v[100:103],a[156:159],a[12:15],v[100:103]
v_exp_f32 v124,v124
v_mfma_f32_16x16x32_bf16 v[104:107],a[160:163],a[0:3],v[64:67]
v_mfma_f32_16x16x32_bf16 v[104:107],a[164:167],a[4:7],v[104:107]
v_exp_f32 v125,v125
v_mfma_f32_16x16x32_bf16 v[104:107],a[168:171],a[8:11],v[104:107]
v_cvt_pk_bf16_f32 v94,v124,v125
v_mfma_f32_16x16x32_bf16 v[104:107],a[172:175],a[12:15],v[104:107]
buffer_load_dwordx4 v8,s[12:15],s48 offen offset:2048 nt lds
v_exp_f32 v126,v126
v_mfma_f32_16x16x32_bf16 v[108:111],a[176:179],a[0:3],v[64:67]
v_mfma_f32_16x16x32_bf16 v[108:111],a[180:183],a[4:7],v[108:111]
v_exp_f32 v127,v127
v_mfma_f32_16x16x32_bf16 v[108:111],a[184:187],a[8:11],v[108:111]
v_cvt_pk_bf16_f32 v95,v126,v127
v_mfma_f32_16x16x32_bf16 v[108:111],a[188:191],a[12:15],v[108:111]
v_mfma_f32_16x16x32_bf16 v[224:227],a[192:195],v[88:91],v[224:227]
v_mfma_f32_16x16x32_bf16 v[224:227],a[196:199],v[92:95],v[224:227]
v_exp_f32 v96,v96
v_mfma_f32_16x16x32_bf16 v[228:231],a[200:203],v[88:91],v[228:231]
ds_read_b64_tr_b16 a[192:193],v14 offset:16384
ds_read_b64_tr_b16 a[194:195],v14 offset:20480
v_mfma_f32_16x16x32_bf16 v[228:231],a[204:207],v[92:95],v[228:231]
v_exp_f32 v97,v97
v_mfma_f32_16x16x32_bf16 v[232:235],a[208:211],v[88:91],v[232:235]
ds_read_b64_tr_b16 a[196:197],v14 offset:24576
v_cvt_pk_bf16_f32 v80,v96,v97
v_mfma_f32_16x16x32_bf16 v[232:235],a[212:215],v[92:95],v[232:235]
v_exp_f32 v98,v98
v_mfma_f32_16x16x32_bf16 v[236:239],a[216:219],v[88:91],v[236:239]
ds_read_b64_tr_b16 a[198:199],v14 offset:28672
ds_read_b64_tr_b16 a[200:201],v15 offset:16384
v_mfma_f32_16x16x32_bf16 v[236:239],a[220:223],v[92:95],v[236:239]
v_exp_f32 v99,v99
v_mfma_f32_16x16x32_bf16 v[240:243],a[224:227],v[88:91],v[240:243]
ds_read_b64_tr_b16 a[202:203],v15 offset:20480
v_cvt_pk_bf16_f32 v81,v98,v99
v_mfma_f32_16x16x32_bf16 v[240:243],a[228:231],v[92:95],v[240:243]
v_exp_f32 v100,v100
v_mfma_f32_16x16x32_bf16 v[244:247],a[232:235],v[88:91],v[244:247]
ds_read_b64_tr_b16 a[204:205],v15 offset:24576
ds_read_b64_tr_b16 a[206:207],v15 offset:28672
v_mfma_f32_16x16x32_bf16 v[244:247],a[236:239],v[92:95],v[244:247]
v_exp_f32 v101,v101
v_mfma_f32_16x16x32_bf16 v[248:251],a[240:243],v[88:91],v[248:251]
ds_read_b64_tr_b16 a[208:209],v16 offset:16384
v_cvt_pk_bf16_f32 v82,v100,v101
v_mfma_f32_16x16x32_bf16 v[248:251],a[244:247],v[92:95],v[248:251]
buffer_load_dwordx4 v9,s[12:15],s48 offen offset:3072 nt lds
v_exp_f32 v102,v102
v_mfma_f32_16x16x32_bf16 v[252:255],a[248:251],v[88:91],v[252:255]
ds_read_b64_tr_b16 a[210:211],v16 offset:20480
ds_read_b64_tr_b16 a[212:213],v16 offset:24576
v_mfma_f32_16x16x32_bf16 v[252:255],a[252:255],v[92:95],v[252:255]
v_exp_f32 v103,v103
v_mfma_f32_16x16x32_bf16 v[60:63],v[44:47],v[88:91],v[60:63]
ds_read_b64_tr_b16 a[214:215],v16 offset:28672
v_cvt_pk_bf16_f32 v83,v102,v103
v_mfma_f32_16x16x32_bf16 v[60:63],v[44:47],v[92:95],v[60:63]
v_exp_f32 v104,v104
v_mfma_f32_16x16x32_bf16 v[112:115],a[128:131],a[16:19],v[68:71]
ds_read_b64_tr_b16 a[216:217],v17 offset:16384
ds_read_b64_tr_b16 a[218:219],v17 offset:20480
v_mfma_f32_16x16x32_bf16 v[112:115],a[132:135],a[20:23],v[112:115]
v_exp_f32 v105,v105
v_mfma_f32_16x16x32_bf16 v[112:115],a[136:139],a[24:27],v[112:115]
ds_read_b64_tr_b16 a[220:221],v17 offset:24576
v_cvt_pk_bf16_f32 v84,v104,v105
v_mfma_f32_16x16x32_bf16 v[112:115],a[140:143],a[28:31],v[112:115]
v_exp_f32 v106,v106
v_mfma_f32_16x16x32_bf16 v[116:119],a[144:147],a[16:19],v[68:71]
ds_read_b64_tr_b16 a[222:223],v17 offset:28672
ds_read_b64_tr_b16 a[224:225],v18 offset:16384
v_mfma_f32_16x16x32_bf16 v[116:119],a[148:151],a[20:23],v[116:119]
v_exp_f32 v107,v107
v_mfma_f32_16x16x32_bf16 v[116:119],a[152:155],a[24:27],v[116:119]
ds_read_b64_tr_b16 a[226:227],v18 offset:20480
v_cvt_pk_bf16_f32 v85,v106,v107
v_mfma_f32_16x16x32_bf16 v[116:119],a[156:159],a[28:31],v[116:119]
v_exp_f32 v108,v108
v_mfma_f32_16x16x32_bf16 v[120:123],a[160:163],a[16:19],v[68:71]
ds_read_b64_tr_b16 a[228:229],v18 offset:24576
ds_read_b64_tr_b16 a[230:231],v18 offset:28672
v_mfma_f32_16x16x32_bf16 v[120:123],a[164:167],a[20:23],v[120:123]
v_exp_f32 v109,v109
v_mfma_f32_16x16x32_bf16 v[120:123],a[168:171],a[24:27],v[120:123]
ds_read_b64_tr_b16 a[232:233],v19 offset:16384
v_cvt_pk_bf16_f32 v86,v108,v109
v_mfma_f32_16x16x32_bf16 v[120:123],a[172:175],a[28:31],v[120:123]
s_mov_b32 s48,180224
v_exp_f32 v110,v110
v_mfma_f32_16x16x32_bf16 v[124:127],a[176:179],a[16:19],v[68:71]
ds_read_b64_tr_b16 a[234:235],v19 offset:20480
ds_read_b64_tr_b16 a[236:237],v19 offset:24576
s_add_u32 m0,s39,49152
v_mfma_f32_16x16x32_bf16 v[124:127],a[180:183],a[20:23],v[124:127]
buffer_load_dwordx4 v4,s[8:11],s48 offen nt lds
v_exp_f32 v111,v111
v_mfma_f32_16x16x32_bf16 v[124:127],a[184:187],a[24:27],v[124:127]
ds_read_b64_tr_b16 a[238:239],v19 offset:28672
v_cvt_pk_bf16_f32 v87,v110,v111
v_mfma_f32_16x16x32_bf16 v[124:127],a[188:191],a[28:31],v[124:127]
ds_read_b64_tr_b16 a[240:241],v20 offset:16384
ds_read_b64_tr_b16 a[242:243],v20 offset:20480
v_mfma_f32_16x16x32_bf16 v[96:99],a[128:131],a[32:35],v[72:75]
ds_read_b64_tr_b16 a[244:245],v20 offset:24576
ds_read_b64_tr_b16 a[246:247],v20 offset:28672
v_mfma_f32_16x16x32_bf16 v[96:99],a[132:135],a[36:39],v[96:99]
v_exp_f32 v112,v112
v_mfma_f32_16x16x32_bf16 v[96:99],a[136:139],a[40:43],v[96:99]
ds_read_b64_tr_b16 a[248:249],v21 offset:16384
ds_read_b64_tr_b16 a[250:251],v21 offset:20480
v_mfma_f32_16x16x32_bf16 v[96:99],a[140:143],a[44:47],v[96:99]
v_exp_f32 v113,v113
v_mfma_f32_16x16x32_bf16 v[100:103],a[144:147],a[32:35],v[72:75]
ds_read_b64_tr_b16 a[252:253],v21 offset:24576
v_cvt_pk_bf16_f32 v88,v112,v113
v_mfma_f32_16x16x32_bf16 v[100:103],a[148:151],a[36:39],v[100:103]
v_exp_f32 v114,v114
v_mfma_f32_16x16x32_bf16 v[100:103],a[152:155],a[40:43],v[100:103]
ds_read_b64_tr_b16 a[254:255],v21 offset:28672
v_mfma_f32_16x16x32_bf16 v[100:103],a[156:159],a[44:47],v[100:103]
v_exp_f32 v115,v115
v_mfma_f32_16x16x32_bf16 v[104:107],a[160:163],a[32:35],v[72:75]
v_cvt_pk_bf16_f32 v89,v114,v115
v_mfma_f32_16x16x32_bf16 v[104:107],a[164:167],a[36:39],v[104:107]
v_exp_f32 v116,v116
v_mfma_f32_16x16x32_bf16 v[104:107],a[168:171],a[40:43],v[104:107]
v_mfma_f32_16x16x32_bf16 v[104:107],a[172:175],a[44:47],v[104:107]
v_exp_f32 v117,v117
v_mfma_f32_16x16x32_bf16 v[108:111],a[176:179],a[32:35],v[72:75]
buffer_load_dwordx4 v5,s[8:11],s48 offen offset:1024 nt lds
v_cvt_pk_bf16_f32 v90,v116,v117
v_mfma_f32_16x16x32_bf16 v[108:111],a[180:183],a[36:39],v[108:111]
v_exp_f32 v118,v118
v_mfma_f32_16x16x32_bf16 v[108:111],a[184:187],a[40:43],v[108:111]
s_waitcnt lgkmcnt(0)
v_mfma_f32_16x16x32_bf16 v[108:111],a[188:191],a[44:47],v[108:111]
v_exp_f32 v119,v119
v_mfma_f32_16x16x32_bf16 v[128:131],a[192:195],v[80:83],v[128:131]
v_cvt_pk_bf16_f32 v91,v118,v119
v_mfma_f32_16x16x32_bf16 v[128:131],a[196:199],v[84:87],v[128:131]
v_exp_f32 v120,v120
v_mfma_f32_16x16x32_bf16 v[132:135],a[200:203],v[80:83],v[132:135]
v_mfma_f32_16x16x32_bf16 v[132:135],a[204:207],v[84:87],v[132:135]
v_exp_f32 v121,v121
v_mfma_f32_16x16x32_bf16 v[136:139],a[208:211],v[80:83],v[136:139]
v_cvt_pk_bf16_f32 v92,v120,v121
v_mfma_f32_16x16x32_bf16 v[136:139],a[212:215],v[84:87],v[136:139]
v_exp_f32 v122,v122
v_mfma_f32_16x16x32_bf16 v[140:143],a[216:219],v[80:83],v[140:143]
v_mfma_f32_16x16x32_bf16 v[140:143],a[220:223],v[84:87],v[140:143]
v_exp_f32 v123,v123
v_mfma_f32_16x16x32_bf16 v[144:147],a[224:227],v[80:83],v[144:147]
v_cvt_pk_bf16_f32 v93,v122,v123
v_mfma_f32_16x16x32_bf16 v[144:147],a[228:231],v[84:87],v[144:147]
v_exp_f32 v124,v124
v_mfma_f32_16x16x32_bf16 v[148:151],a[232:235],v[80:83],v[148:151]
v_mfma_f32_16x16x32_bf16 v[148:151],a[236:239],v[84:87],v[148:151]
v_exp_f32 v125,v125
v_mfma_f32_16x16x32_bf16 v[152:155],a[240:243],v[80:83],v[152:155]
v_cvt_pk_bf16_f32 v94,v124,v125
v_mfma_f32_16x16x32_bf16 v[152:155],a[244:247],v[84:87],v[152:155]
buffer_load_dwordx4 v6,s[8:11],s48 offen offset:2048 nt lds
v_exp_f32 v126,v126
v_mfma_f32_16x16x32_bf16 v[156:159],a[248:251],v[80:83],v[156:159]
v_mfma_f32_16x16x32_bf16 v[156:159],a[252:255],v[84:87],v[156:159]
v_exp_f32 v127,v127
v_mfma_f32_16x16x32_bf16 v[48:51],v[44:47],v[80:83],v[48:51]
v_cvt_pk_bf16_f32 v95,v126,v127
v_mfma_f32_16x16x32_bf16 v[48:51],v[44:47],v[84:87],v[48:51]
s_waitcnt vmcnt(3)
s_barrier
v_mfma_f32_16x16x32_bf16 v[112:115],a[128:131],a[48:51],v[76:79]
v_mfma_f32_16x16x32_bf16 v[112:115],a[132:135],a[52:55],v[112:115]
v_exp_f32 v96,v96
v_mfma_f32_16x16x32_bf16 v[112:115],a[136:139],a[56:59],v[112:115]
v_mfma_f32_16x16x32_bf16 v[112:115],a[140:143],a[60:63],v[112:115]
v_exp_f32 v97,v97
v_mfma_f32_16x16x32_bf16 v[116:119],a[144:147],a[48:51],v[76:79]
ds_read_b128 a[128:131],v10 offset:32768
v_cvt_pk_bf16_f32 v80,v96,v97
v_mfma_f32_16x16x32_bf16 v[116:119],a[148:151],a[52:55],v[116:119]
v_exp_f32 v98,v98
v_mfma_f32_16x16x32_bf16 v[116:119],a[152:155],a[56:59],v[116:119]
ds_read_b128 a[132:135],v11 offset:32768
v_mfma_f32_16x16x32_bf16 v[116:119],a[156:159],a[60:63],v[116:119]
v_exp_f32 v99,v99
v_mfma_f32_16x16x32_bf16 v[120:123],a[160:163],a[48:51],v[76:79]
ds_read_b128 a[136:139],v12 offset:32768
v_cvt_pk_bf16_f32 v81,v98,v99
v_mfma_f32_16x16x32_bf16 v[120:123],a[164:167],a[52:55],v[120:123]
v_exp_f32 v100,v100
v_mfma_f32_16x16x32_bf16 v[120:123],a[168:171],a[56:59],v[120:123]
ds_read_b128 a[140:143],v13 offset:32768
v_mfma_f32_16x16x32_bf16 v[120:123],a[172:175],a[60:63],v[120:123]
v_exp_f32 v101,v101
v_mfma_f32_16x16x32_bf16 v[124:127],a[176:179],a[48:51],v[76:79]
ds_read_b128 a[144:147],v10 offset:36864
v_cvt_pk_bf16_f32 v82,v100,v101
v_mfma_f32_16x16x32_bf16 v[124:127],a[180:183],a[52:55],v[124:127]
buffer_load_dwordx4 v7,s[8:11],s48 offen offset:3072 nt lds
v_exp_f32 v102,v102
v_mfma_f32_16x16x32_bf16 v[124:127],a[184:187],a[56:59],v[124:127]
ds_read_b128 a[148:151],v11 offset:36864
v_mfma_f32_16x16x32_bf16 v[124:127],a[188:191],a[60:63],v[124:127]
v_exp_f32 v103,v103
v_mfma_f32_16x16x32_bf16 v[160:163],a[192:195],v[88:91],v[160:163]
ds_read_b128 a[152:155],v12 offset:36864
v_cvt_pk_bf16_f32 v83,v102,v103
v_mfma_f32_16x16x32_bf16 v[160:163],a[196:199],v[92:95],v[160:163]
v_exp_f32 v104,v104
v_mfma_f32_16x16x32_bf16 v[164:167],a[200:203],v[88:91],v[164:167]
ds_read_b128 a[156:159],v13 offset:36864
v_mfma_f32_16x16x32_bf16 v[164:167],a[204:207],v[92:95],v[164:167]
v_exp_f32 v105,v105
v_mfma_f32_16x16x32_bf16 v[168:171],a[208:211],v[88:91],v[168:171]
ds_read_b128 a[160:163],v10 offset:40960
v_cvt_pk_bf16_f32 v84,v104,v105
v_mfma_f32_16x16x32_bf16 v[168:171],a[212:215],v[92:95],v[168:171]
v_exp_f32 v106,v106
v_mfma_f32_16x16x32_bf16 v[172:175],a[216:219],v[88:91],v[172:175]
ds_read_b128 a[164:167],v11 offset:40960
v_mfma_f32_16x16x32_bf16 v[172:175],a[220:223],v[92:95],v[172:175]
v_exp_f32 v107,v107
v_mfma_f32_16x16x32_bf16 v[176:179],a[224:227],v[88:91],v[176:179]
ds_read_b128 a[168:171],v12 offset:40960
v_cvt_pk_bf16_f32 v85,v106,v107
v_mfma_f32_16x16x32_bf16 v[176:179],a[228:231],v[92:95],v[176:179]
v_exp_f32 v108,v108
v_mfma_f32_16x16x32_bf16 v[180:183],a[232:235],v[88:91],v[180:183]
ds_read_b128 a[172:175],v13 offset:40960
v_mfma_f32_16x16x32_bf16 v[180:183],a[236:239],v[92:95],v[180:183]
v_exp_f32 v109,v109
v_mfma_f32_16x16x32_bf16 v[184:187],a[240:243],v[88:91],v[184:187]
ds_read_b128 a[176:179],v10 offset:45056
v_cvt_pk_bf16_f32 v86,v108,v109
v_mfma_f32_16x16x32_bf16 v[184:187],a[244:247],v[92:95],v[184:187]
s_add_u32 m0,s39,114688
v_exp_f32 v110,v110
v_mfma_f32_16x16x32_bf16 v[188:191],a[248:251],v[88:91],v[188:191]
ds_read_b128 a[180:183],v11 offset:45056
v_mfma_f32_16x16x32_bf16 v[188:191],a[252:255],v[92:95],v[188:191]
buffer_load_dwordx4 v8,s[12:15],s48 offen nt lds
v_exp_f32 v111,v111
v_mfma_f32_16x16x32_bf16 v[52:55],v[44:47],v[88:91],v[52:55]
ds_read_b128 a[184:187],v12 offset:45056
v_cvt_pk_bf16_f32 v87,v110,v111
v_mfma_f32_16x16x32_bf16 v[52:55],v[44:47],v[92:95],v[52:55]
ds_read_b128 a[188:191],v13 offset:45056
v_mfma_f32_16x16x32_bf16 v[192:195],a[192:195],v[80:83],v[192:195]
v_mfma_f32_16x16x32_bf16 v[192:195],a[196:199],v[84:87],v[192:195]
v_exp_f32 v112,v112
v_mfma_f32_16x16x32_bf16 v[196:199],a[200:203],v[80:83],v[196:199]
v_mfma_f32_16x16x32_bf16 v[196:199],a[204:207],v[84:87],v[196:199]
v_exp_f32 v113,v113
v_mfma_f32_16x16x32_bf16 v[200:203],a[208:211],v[80:83],v[200:203]
v_cvt_pk_bf16_f32 v88,v112,v113
v_mfma_f32_16x16x32_bf16 v[200:203],a[212:215],v[84:87],v[200:203]
v_exp_f32 v114,v114
v_mfma_f32_16x16x32_bf16 v[204:207],a[216:219],v[80:83],v[204:207]
v_mfma_f32_16x16x32_bf16 v[204:207],a[220:223],v[84:87],v[204:207]
v_exp_f32 v115,v115
v_mfma_f32_16x16x32_bf16 v[208:211],a[224:227],v[80:83],v[208:211]
v_cvt_pk_bf16_f32 v89,v114,v115
v_mfma_f32_16x16x32_bf16 v[208:211],a[228:231],v[84:87],v[208:211]
v_exp_f32 v116,v116
v_mfma_f32_16x16x32_bf16 v[212:215],a[232:235],v[80:83],v[212:215]
v_mfma_f32_16x16x32_bf16 v[212:215],a[236:239],v[84:87],v[212:215]
v_exp_f32 v117,v117
v_mfma_f32_16x16x32_bf16 v[216:219],a[240:243],v[80:83],v[216:219]
buffer_load_dwordx4 v9,s[12:15],s48 offen offset:1024 nt lds
v_cvt_pk_bf16_f32 v90,v116,v117
v_mfma_f32_16x16x32_bf16 v[216:219],a[244:247],v[84:87],v[216:219]
v_exp_f32 v118,v118
v_mfma_f32_16x16x32_bf16 v[220:223],a[248:251],v[80:83],v[220:223]
s_waitcnt lgkmcnt(0)
v_mfma_f32_16x16x32_bf16 v[220:223],a[252:255],v[84:87],v[220:223]
v_exp_f32 v119,v119
v_mfma_f32_16x16x32_bf16 v[56:59],v[44:47],v[80:83],v[56:59]
v_cvt_pk_bf16_f32 v91,v118,v119
v_mfma_f32_16x16x32_bf16 v[56:59],v[44:47],v[84:87],v[56:59]
v_exp_f32 v120,v120
v_mfma_f32_16x16x32_bf16 v[96:99],a[128:131],a[0:3],v[64:67]
v_mfma_f32_16x16x32_bf16 v[96:99],a[132:135],a[4:7],v[96:99]
v_exp_f32 v121,v121
v_mfma_f32_16x16x32_bf16 v[96:99],a[136:139],a[8:11],v[96:99]
v_cvt_pk_bf16_f32 v92,v120,v121
v_mfma_f32_16x16x32_bf16 v[96:99],a[140:143],a[12:15],v[96:99]
v_exp_f32 v122,v122
v_mfma_f32_16x16x32_bf16 v[100:103],a[144:147],a[0:3],v[64:67]
v_mfma_f32_16x16x32_bf16 v[100:103],a[148:151],a[4:7],v[100:103]
v_exp_f32 v123,v123
v_mfma_f32_16x16x32_bf16 v[100:103],a[152:155],a[8:11],v[100:103]
v_cvt_pk_bf16_f32 v93,v122,v123
v_mfma_f32_16x16x32_bf16 v[100:103],a[156:159],a[12:15],v[100:103]
v_exp_f32 v124,v124
v_mfma_f32_16x16x32_bf16 v[104:107],a[160:163],a[0:3],v[64:67]
v_mfma_f32_16x16x32_bf16 v[104:107],a[164:167],a[4:7],v[104:107]
v_exp_f32 v125,v125
v_mfma_f32_16x16x32_bf16 v[104:107],a[168:171],a[8:11],v[104:107]
v_cvt_pk_bf16_f32 v94,v124,v125
v_mfma_f32_16x16x32_bf16 v[104:107],a[172:175],a[12:15],v[104:107]
buffer_load_dwordx4 v8,s[12:15],s48 offen offset:2048 nt lds
v_exp_f32 v126,v126
v_mfma_f32_16x16x32_bf16 v[108:111],a[176:179],a[0:3],v[64:67]
v_mfma_f32_16x16x32_bf16 v[108:111],a[180:183],a[4:7],v[108:111]
v_exp_f32 v127,v127
v_mfma_f32_16x16x32_bf16 v[108:111],a[184:187],a[8:11],v[108:111]
v_cvt_pk_bf16_f32 v95,v126,v127
v_mfma_f32_16x16x32_bf16 v[108:111],a[188:191],a[12:15],v[108:111]
v_mfma_f32_16x16x32_bf16 v[224:227],a[192:195],v[88:91],v[224:227]
v_mfma_f32_16x16x32_bf16 v[224:227],a[196:199],v[92:95],v[224:227]
v_exp_f32 v96,v96
v_mfma_f32_16x16x32_bf16 v[228:231],a[200:203],v[88:91],v[228:231]
ds_read_b64_tr_b16 a[192:193],v14 offset:32768
ds_read_b64_tr_b16 a[194:195],v14 offset:36864
v_mfma_f32_16x16x32_bf16 v[228:231],a[204:207],v[92:95],v[228:231]
v_exp_f32 v97,v97
v_mfma_f32_16x16x32_bf16 v[232:235],a[208:211],v[88:91],v[232:235]
ds_read_b64_tr_b16 a[196:197],v14 offset:40960
v_cvt_pk_bf16_f32 v80,v96,v97
v_mfma_f32_16x16x32_bf16 v[232:235],a[212:215],v[92:95],v[232:235]
v_exp_f32 v98,v98
v_mfma_f32_16x16x32_bf16 v[236:239],a[216:219],v[88:91],v[236:239]
ds_read_b64_tr_b16 a[198:199],v14 offset:45056
ds_read_b64_tr_b16 a[200:201],v15 offset:32768
v_mfma_f32_16x16x32_bf16 v[236:239],a[220:223],v[92:95],v[236:239]
v_exp_f32 v99,v99
v_mfma_f32_16x16x32_bf16 v[240:243],a[224:227],v[88:91],v[240:243]
ds_read_b64_tr_b16 a[202:203],v15 offset:36864
v_cvt_pk_bf16_f32 v81,v98,v99
v_mfma_f32_16x16x32_bf16 v[240:243],a[228:231],v[92:95],v[240:243]
v_exp_f32 v100,v100
v_mfma_f32_16x16x32_bf16 v[244:247],a[232:235],v[88:91],v[244:247]
ds_read_b64_tr_b16 a[204:205],v15 offset:40960
ds_read_b64_tr_b16 a[206:207],v15 offset:45056
v_mfma_f32_16x16x32_bf16 v[244:247],a[236:239],v[92:95],v[244:247]
v_exp_f32 v101,v101
v_mfma_f32_16x16x32_bf16 v[248:251],a[240:243],v[88:91],v[248:251]
ds_read_b64_tr_b16 a[208:209],v16 offset:32768
v_cvt_pk_bf16_f32 v82,v100,v101
v_mfma_f32_16x16x32_bf16 v[248:251],a[244:247],v[92:95],v[248:251]
buffer_load_dwordx4 v9,s[12:15],s48 offen offset:3072 nt lds
v_exp_f32 v102,v102
v_mfma_f32_16x16x32_bf16 v[252:255],a[248:251],v[88:91],v[252:255]
ds_read_b64_tr_b16 a[210:211],v16 offset:36864
ds_read_b64_tr_b16 a[212:213],v16 offset:40960
v_mfma_f32_16x16x32_bf16 v[252:255],a[252:255],v[92:95],v[252:255]
v_exp_f32 v103,v103
v_mfma_f32_16x16x32_bf16 v[60:63],v[44:47],v[88:91],v[60:63]
ds_read_b64_tr_b16 a[214:215],v16 offset:45056
v_cvt_pk_bf16_f32 v83,v102,v103
v_mfma_f32_16x16x32_bf16 v[60:63],v[44:47],v[92:95],v[60:63]
v_exp_f32 v104,v104
v_mfma_f32_16x16x32_bf16 v[112:115],a[128:131],a[16:19],v[68:71]
ds_read_b64_tr_b16 a[216:217],v17 offset:32768
ds_read_b64_tr_b16 a[218:219],v17 offset:36864
v_mfma_f32_16x16x32_bf16 v[112:115],a[132:135],a[20:23],v[112:115]
v_exp_f32 v105,v105
v_mfma_f32_16x16x32_bf16 v[112:115],a[136:139],a[24:27],v[112:115]
ds_read_b64_tr_b16 a[220:221],v17 offset:40960
v_cvt_pk_bf16_f32 v84,v104,v105
v_mfma_f32_16x16x32_bf16 v[112:115],a[140:143],a[28:31],v[112:115]
v_exp_f32 v106,v106
v_mfma_f32_16x16x32_bf16 v[116:119],a[144:147],a[16:19],v[68:71]
ds_read_b64_tr_b16 a[222:223],v17 offset:45056
ds_read_b64_tr_b16 a[224:225],v18 offset:32768
v_mfma_f32_16x16x32_bf16 v[116:119],a[148:151],a[20:23],v[116:119]
v_exp_f32 v107,v107
v_mfma_f32_16x16x32_bf16 v[116:119],a[152:155],a[24:27],v[116:119]
ds_read_b64_tr_b16 a[226:227],v18 offset:36864
v_cvt_pk_bf16_f32 v85,v106,v107
v_mfma_f32_16x16x32_bf16 v[116:119],a[156:159],a[28:31],v[116:119]
v_exp_f32 v108,v108
v_mfma_f32_16x16x32_bf16 v[120:123],a[160:163],a[16:19],v[68:71]
ds_read_b64_tr_b16 a[228:229],v18 offset:40960
ds_read_b64_tr_b16 a[230:231],v18 offset:45056
v_mfma_f32_16x16x32_bf16 v[120:123],a[164:167],a[20:23],v[120:123]
v_exp_f32 v109,v109
v_mfma_f32_16x16x32_bf16 v[120:123],a[168:171],a[24:27],v[120:123]
ds_read_b64_tr_b16 a[232:233],v19 offset:32768
v_cvt_pk_bf16_f32 v86,v108,v109
v_mfma_f32_16x16x32_bf16 v[120:123],a[172:175],a[28:31],v[120:123]
s_mov_b32 s48,196608
v_exp_f32 v110,v110
v_mfma_f32_16x16x32_bf16 v[124:127],a[176:179],a[16:19],v[68:71]
ds_read_b64_tr_b16 a[234:235],v19 offset:36864
ds_read_b64_tr_b16 a[236:237],v19 offset:40960
s_add_u32 m0,s39,0
v_mfma_f32_16x16x32_bf16 v[124:127],a[180:183],a[20:23],v[124:127]
buffer_load_dwordx4 v4,s[8:11],s48 offen nt lds
v_exp_f32 v111,v111
v_mfma_f32_16x16x32_bf16 v[124:127],a[184:187],a[24:27],v[124:127]
ds_read_b64_tr_b16 a[238:239],v19 offset:45056
v_cvt_pk_bf16_f32 v87,v110,v111
v_mfma_f32_16x16x32_bf16 v[124:127],a[188:191],a[28:31],v[124:127]
ds_read_b64_tr_b16 a[240:241],v20 offset:32768
ds_read_b64_tr_b16 a[242:243],v20 offset:36864
v_mfma_f32_16x16x32_bf16 v[96:99],a[128:131],a[32:35],v[72:75]
ds_read_b64_tr_b16 a[244:245],v20 offset:40960
ds_read_b64_tr_b16 a[246:247],v20 offset:45056
v_mfma_f32_16x16x32_bf16 v[96:99],a[132:135],a[36:39],v[96:99]
v_exp_f32 v112,v112
v_mfma_f32_16x16x32_bf16 v[96:99],a[136:139],a[40:43],v[96:99]
ds_read_b64_tr_b16 a[248:249],v21 offset:32768
ds_read_b64_tr_b16 a[250:251],v21 offset:36864
v_mfma_f32_16x16x32_bf16 v[96:99],a[140:143],a[44:47],v[96:99]
v_exp_f32 v113,v113
v_mfma_f32_16x16x32_bf16 v[100:103],a[144:147],a[32:35],v[72:75]
ds_read_b64_tr_b16 a[252:253],v21 offset:40960
v_cvt_pk_bf16_f32 v88,v112,v113
v_mfma_f32_16x16x32_bf16 v[100:103],a[148:151],a[36:39],v[100:103]
v_exp_f32 v114,v114
v_mfma_f32_16x16x32_bf16 v[100:103],a[152:155],a[40:43],v[100:103]
ds_read_b64_tr_b16 a[254:255],v21 offset:45056
v_mfma_f32_16x16x32_bf16 v[100:103],a[156:159],a[44:47],v[100:103]
v_exp_f32 v115,v115
v_mfma_f32_16x16x32_bf16 v[104:107],a[160:163],a[32:35],v[72:75]
v_cvt_pk_bf16_f32 v89,v114,v115
v_mfma_f32_16x16x32_bf16 v[104:107],a[164:167],a[36:39],v[104:107]
v_exp_f32 v116,v116
v_mfma_f32_16x16x32_bf16 v[104:107],a[168:171],a[40:43],v[104:107]
v_mfma_f32_16x16x32_bf16 v[104:107],a[172:175],a[44:47],v[104:107]
v_exp_f32 v117,v117
v_mfma_f32_16x16x32_bf16 v[108:111],a[176:179],a[32:35],v[72:75]
buffer_load_dwordx4 v5,s[8:11],s48 offen offset:1024 nt lds
v_cvt_pk_bf16_f32 v90,v116,v117
v_mfma_f32_16x16x32_bf16 v[108:111],a[180:183],a[36:39],v[108:111]
v_exp_f32 v118,v118
v_mfma_f32_16x16x32_bf16 v[108:111],a[184:187],a[40:43],v[108:111]
s_waitcnt lgkmcnt(0)
v_mfma_f32_16x16x32_bf16 v[108:111],a[188:191],a[44:47],v[108:111]
v_exp_f32 v119,v119
v_mfma_f32_16x16x32_bf16 v[128:131],a[192:195],v[80:83],v[128:131]
v_cvt_pk_bf16_f32 v91,v118,v119
v_mfma_f32_16x16x32_bf16 v[128:131],a[196:199],v[84:87],v[128:131]
v_exp_f32 v120,v120
v_mfma_f32_16x16x32_bf16 v[132:135],a[200:203],v[80:83],v[132:135]
v_mfma_f32_16x16x32_bf16 v[132:135],a[204:207],v[84:87],v[132:135]
v_exp_f32 v121,v121
v_mfma_f32_16x16x32_bf16 v[136:139],a[208:211],v[80:83],v[136:139]
v_cvt_pk_bf16_f32 v92,v120,v121
v_mfma_f32_16x16x32_bf16 v[136:139],a[212:215],v[84:87],v[136:139]
v_exp_f32 v122,v122
v_mfma_f32_16x16x32_bf16 v[140:143],a[216:219],v[80:83],v[140:143]
v_mfma_f32_16x16x32_bf16 v[140:143],a[220:223],v[84:87],v[140:143]
v_exp_f32 v123,v123
v_mfma_f32_16x16x32_bf16 v[144:147],a[224:227],v[80:83],v[144:147]
v_cvt_pk_bf16_f32 v93,v122,v123
v_mfma_f32_16x16x32_bf16 v[144:147],a[228:231],v[84:87],v[144:147]
v_exp_f32 v124,v124
v_mfma_f32_16x16x32_bf16 v[148:151],a[232:235],v[80:83],v[148:151]
v_mfma_f32_16x16x32_bf16 v[148:151],a[236:239],v[84:87],v[148:151]
v_exp_f32 v125,v125
v_mfma_f32_16x16x32_bf16 v[152:155],a[240:243],v[80:83],v[152:155]
v_cvt_pk_bf16_f32 v94,v124,v125
v_mfma_f32_16x16x32_bf16 v[152:155],a[244:247],v[84:87],v[152:155]
buffer_load_dwordx4 v6,s[8:11],s48 offen offset:2048 nt lds
v_exp_f32 v126,v126
v_mfma_f32_16x16x32_bf16 v[156:159],a[248:251],v[80:83],v[156:159]
v_mfma_f32_16x16x32_bf16 v[156:159],a[252:255],v[84:87],v[156:159]
v_exp_f32 v127,v127
v_mfma_f32_16x16x32_bf16 v[48:51],v[44:47],v[80:83],v[48:51]
v_cvt_pk_bf16_f32 v95,v126,v127
v_mfma_f32_16x16x32_bf16 v[48:51],v[44:47],v[84:87],v[48:51]
s_waitcnt vmcnt(3)
s_barrier
v_mfma_f32_16x16x32_bf16 v[112:115],a[128:131],a[48:51],v[76:79]
v_mfma_f32_16x16x32_bf16 v[112:115],a[132:135],a[52:55],v[112:115]
v_exp_f32 v96,v96
v_mfma_f32_16x16x32_bf16 v[112:115],a[136:139],a[56:59],v[112:115]
v_mfma_f32_16x16x32_bf16 v[112:115],a[140:143],a[60:63],v[112:115]
v_exp_f32 v97,v97
v_mfma_f32_16x16x32_bf16 v[116:119],a[144:147],a[48:51],v[76:79]
ds_read_b128 a[128:131],v10 offset:49152
v_cvt_pk_bf16_f32 v80,v96,v97
v_mfma_f32_16x16x32_bf16 v[116:119],a[148:151],a[52:55],v[116:119]
v_exp_f32 v98,v98
v_mfma_f32_16x16x32_bf16 v[116:119],a[152:155],a[56:59],v[116:119]
ds_read_b128 a[132:135],v11 offset:49152
v_mfma_f32_16x16x32_bf16 v[116:119],a[156:159],a[60:63],v[116:119]
v_exp_f32 v99,v99
v_mfma_f32_16x16x32_bf16 v[120:123],a[160:163],a[48:51],v[76:79]
ds_read_b128 a[136:139],v12 offset:49152
v_cvt_pk_bf16_f32 v81,v98,v99
v_mfma_f32_16x16x32_bf16 v[120:123],a[164:167],a[52:55],v[120:123]
v_exp_f32 v100,v100
v_mfma_f32_16x16x32_bf16 v[120:123],a[168:171],a[56:59],v[120:123]
ds_read_b128 a[140:143],v13 offset:49152
v_mfma_f32_16x16x32_bf16 v[120:123],a[172:175],a[60:63],v[120:123]
v_exp_f32 v101,v101
v_mfma_f32_16x16x32_bf16 v[124:127],a[176:179],a[48:51],v[76:79]
ds_read_b128 a[144:147],v10 offset:53248
v_cvt_pk_bf16_f32 v82,v100,v101
v_mfma_f32_16x16x32_bf16 v[124:127],a[180:183],a[52:55],v[124:127]
buffer_load_dwordx4 v7,s[8:11],s48 offen offset:3072 nt lds
v_exp_f32 v102,v102
v_mfma_f32_16x16x32_bf16 v[124:127],a[184:187],a[56:59],v[124:127]
ds_read_b128 a[148:151],v11 offset:53248
v_mfma_f32_16x16x32_bf16 v[124:127],a[188:191],a[60:63],v[124:127]
v_exp_f32 v103,v103
v_mfma_f32_16x16x32_bf16 v[160:163],a[192:195],v[88:91],v[160:163]
ds_read_b128 a[152:155],v12 offset:53248
v_cvt_pk_bf16_f32 v83,v102,v103
v_mfma_f32_16x16x32_bf16 v[160:163],a[196:199],v[92:95],v[160:163]
v_exp_f32 v104,v104
v_mfma_f32_16x16x32_bf16 v[164:167],a[200:203],v[88:91],v[164:167]
ds_read_b128 a[156:159],v13 offset:53248
v_mfma_f32_16x16x32_bf16 v[164:167],a[204:207],v[92:95],v[164:167]
v_exp_f32 v105,v105
v_mfma_f32_16x16x32_bf16 v[168:171],a[208:211],v[88:91],v[168:171]
ds_read_b128 a[160:163],v10 offset:57344
v_cvt_pk_bf16_f32 v84,v104,v105
v_mfma_f32_16x16x32_bf16 v[168:171],a[212:215],v[92:95],v[168:171]
v_exp_f32 v106,v106
v_mfma_f32_16x16x32_bf16 v[172:175],a[216:219],v[88:91],v[172:175]
ds_read_b128 a[164:167],v11 offset:57344
v_mfma_f32_16x16x32_bf16 v[172:175],a[220:223],v[92:95],v[172:175]
v_exp_f32 v107,v107
v_mfma_f32_16x16x32_bf16 v[176:179],a[224:227],v[88:91],v[176:179]
ds_read_b128 a[168:171],v12 offset:57344
v_cvt_pk_bf16_f32 v85,v106,v107
v_mfma_f32_16x16x32_bf16 v[176:179],a[228:231],v[92:95],v[176:179]
v_exp_f32 v108,v108
v_mfma_f32_16x16x32_bf16 v[180:183],a[232:235],v[88:91],v[180:183]
ds_read_b128 a[172:175],v13 offset:57344
v_mfma_f32_16x16x32_bf16 v[180:183],a[236:239],v[92:95],v[180:183]
v_exp_f32 v109,v109
v_mfma_f32_16x16x32_bf16 v[184:187],a[240:243],v[88:91],v[184:187]
ds_read_b128 a[176:179],v10 offset:61440
v_cvt_pk_bf16_f32 v86,v108,v109
v_mfma_f32_16x16x32_bf16 v[184:187],a[244:247],v[92:95],v[184:187]
s_add_u32 m0,s39,65536
v_exp_f32 v110,v110
v_mfma_f32_16x16x32_bf16 v[188:191],a[248:251],v[88:91],v[188:191]
ds_read_b128 a[180:183],v11 offset:61440
v_mfma_f32_16x16x32_bf16 v[188:191],a[252:255],v[92:95],v[188:191]
buffer_load_dwordx4 v8,s[12:15],s48 offen nt lds
v_exp_f32 v111,v111
v_mfma_f32_16x16x32_bf16 v[52:55],v[44:47],v[88:91],v[52:55]
ds_read_b128 a[184:187],v12 offset:61440
v_cvt_pk_bf16_f32 v87,v110,v111
v_mfma_f32_16x16x32_bf16 v[52:55],v[44:47],v[92:95],v[52:55]
ds_read_b128 a[188:191],v13 offset:61440
v_mfma_f32_16x16x32_bf16 v[192:195],a[192:195],v[80:83],v[192:195]
v_mfma_f32_16x16x32_bf16 v[192:195],a[196:199],v[84:87],v[192:195]
v_exp_f32 v112,v112
v_mfma_f32_16x16x32_bf16 v[196:199],a[200:203],v[80:83],v[196:199]
v_mfma_f32_16x16x32_bf16 v[196:199],a[204:207],v[84:87],v[196:199]
v_exp_f32 v113,v113
v_mfma_f32_16x16x32_bf16 v[200:203],a[208:211],v[80:83],v[200:203]
v_cvt_pk_bf16_f32 v88,v112,v113
v_mfma_f32_16x16x32_bf16 v[200:203],a[212:215],v[84:87],v[200:203]
v_exp_f32 v114,v114
v_mfma_f32_16x16x32_bf16 v[204:207],a[216:219],v[80:83],v[204:207]
v_mfma_f32_16x16x32_bf16 v[204:207],a[220:223],v[84:87],v[204:207]
v_exp_f32 v115,v115
v_mfma_f32_16x16x32_bf16 v[208:211],a[224:227],v[80:83],v[208:211]
v_cvt_pk_bf16_f32 v89,v114,v115
v_mfma_f32_16x16x32_bf16 v[208:211],a[228:231],v[84:87],v[208:211]
v_exp_f32 v116,v116
v_mfma_f32_16x16x32_bf16 v[212:215],a[232:235],v[80:83],v[212:215]
v_mfma_f32_16x16x32_bf16 v[212:215],a[236:239],v[84:87],v[212:215]
v_exp_f32 v117,v117
v_mfma_f32_16x16x32_bf16 v[216:219],a[240:243],v[80:83],v[216:219]
buffer_load_dwordx4 v9,s[12:15],s48 offen offset:1024 nt lds
v_cvt_pk_bf16_f32 v90,v116,v117
v_mfma_f32_16x16x32_bf16 v[216:219],a[244:247],v[84:87],v[216:219]
v_exp_f32 v118,v118
v_mfma_f32_16x16x32_bf16 v[220:223],a[248:251],v[80:83],v[220:223]
s_waitcnt lgkmcnt(0)
v_mfma_f32_16x16x32_bf16 v[220:223],a[252:255],v[84:87],v[220:223]
v_exp_f32 v119,v119
v_mfma_f32_16x16x32_bf16 v[56:59],v[44:47],v[80:83],v[56:59]
v_cvt_pk_bf16_f32 v91,v118,v119
v_mfma_f32_16x16x32_bf16 v[56:59],v[44:47],v[84:87],v[56:59]
v_exp_f32 v120,v120
v_mfma_f32_16x16x32_bf16 v[96:99],a[128:131],a[0:3],v[64:67]
v_mfma_f32_16x16x32_bf16 v[96:99],a[132:135],a[4:7],v[96:99]
v_exp_f32 v121,v121
v_mfma_f32_16x16x32_bf16 v[96:99],a[136:139],a[8:11],v[96:99]
v_cvt_pk_bf16_f32 v92,v120,v121
v_mfma_f32_16x16x32_bf16 v[96:99],a[140:143],a[12:15],v[96:99]
v_exp_f32 v122,v122
v_mfma_f32_16x16x32_bf16 v[100:103],a[144:147],a[0:3],v[64:67]
v_mfma_f32_16x16x32_bf16 v[100:103],a[148:151],a[4:7],v[100:103]
v_exp_f32 v123,v123
v_mfma_f32_16x16x32_bf16 v[100:103],a[152:155],a[8:11],v[100:103]
v_cvt_pk_bf16_f32 v93,v122,v123
v_mfma_f32_16x16x32_bf16 v[100:103],a[156:159],a[12:15],v[100:103]
v_exp_f32 v124,v124
v_mfma_f32_16x16x32_bf16 v[104:107],a[160:163],a[0:3],v[64:67]
v_mfma_f32_16x16x32_bf16 v[104:107],a[164:167],a[4:7],v[104:107]
v_exp_f32 v125,v125
v_mfma_f32_16x16x32_bf16 v[104:107],a[168:171],a[8:11],v[104:107]
v_cvt_pk_bf16_f32 v94,v124,v125
v_mfma_f32_16x16x32_bf16 v[104:107],a[172:175],a[12:15],v[104:107]
buffer_load_dwordx4 v8,s[12:15],s48 offen offset:2048 nt lds
v_exp_f32 v126,v126
v_mfma_f32_16x16x32_bf16 v[108:111],a[176:179],a[0:3],v[64:67]
v_mfma_f32_16x16x32_bf16 v[108:111],a[180:183],a[4:7],v[108:111]
v_exp_f32 v127,v127
v_mfma_f32_16x16x32_bf16 v[108:111],a[184:187],a[8:11],v[108:111]
v_cvt_pk_bf16_f32 v95,v126,v127
v_mfma_f32_16x16x32_bf16 v[108:111],a[188:191],a[12:15],v[108:111]
v_mfma_f32_16x16x32_bf16 v[224:227],a[192:195],v[88:91],v[224:227]
v_mfma_f32_16x16x32_bf16 v[224:227],a[196:199],v[92:95],v[224:227]
v_exp_f32 v96,v96
v_mfma_f32_16x16x32_bf16 v[228:231],a[200:203],v[88:91],v[228:231]
ds_read_b64_tr_b16 a[192:193],v14 offset:49152
ds_read_b64_tr_b16 a[194:195],v14 offset:53248
v_mfma_f32_16x16x32_bf16 v[228:231],a[204:207],v[92:95],v[228:231]
v_exp_f32 v97,v97
v_mfma_f32_16x16x32_bf16 v[232:235],a[208:211],v[88:91],v[232:235]
ds_read_b64_tr_b16 a[196:197],v14 offset:57344
v_cvt_pk_bf16_f32 v80,v96,v97
v_mfma_f32_16x16x32_bf16 v[232:235],a[212:215],v[92:95],v[232:235]
v_exp_f32 v98,v98
v_mfma_f32_16x16x32_bf16 v[236:239],a[216:219],v[88:91],v[236:239]
ds_read_b64_tr_b16 a[198:199],v14 offset:61440
ds_read_b64_tr_b16 a[200:201],v15 offset:49152
v_mfma_f32_16x16x32_bf16 v[236:239],a[220:223],v[92:95],v[236:239]
v_exp_f32 v99,v99
v_mfma_f32_16x16x32_bf16 v[240:243],a[224:227],v[88:91],v[240:243]
ds_read_b64_tr_b16 a[202:203],v15 offset:53248
v_cvt_pk_bf16_f32 v81,v98,v99
v_mfma_f32_16x16x32_bf16 v[240:243],a[228:231],v[92:95],v[240:243]
v_exp_f32 v100,v100
v_mfma_f32_16x16x32_bf16 v[244:247],a[232:235],v[88:91],v[244:247]
ds_read_b64_tr_b16 a[204:205],v15 offset:57344
ds_read_b64_tr_b16 a[206:207],v15 offset:61440
v_mfma_f32_16x16x32_bf16 v[244:247],a[236:239],v[92:95],v[244:247]
v_exp_f32 v101,v101
v_mfma_f32_16x16x32_bf16 v[248:251],a[240:243],v[88:91],v[248:251]
ds_read_b64_tr_b16 a[208:209],v16 offset:49152
v_cvt_pk_bf16_f32 v82,v100,v101
v_mfma_f32_16x16x32_bf16 v[248:251],a[244:247],v[92:95],v[248:251]
buffer_load_dwordx4 v9,s[12:15],s48 offen offset:3072 nt lds
v_exp_f32 v102,v102
v_mfma_f32_16x16x32_bf16 v[252:255],a[248:251],v[88:91],v[252:255]
ds_read_b64_tr_b16 a[210:211],v16 offset:53248
ds_read_b64_tr_b16 a[212:213],v16 offset:57344
v_mfma_f32_16x16x32_bf16 v[252:255],a[252:255],v[92:95],v[252:255]
v_exp_f32 v103,v103
v_mfma_f32_16x16x32_bf16 v[60:63],v[44:47],v[88:91],v[60:63]
ds_read_b64_tr_b16 a[214:215],v16 offset:61440
v_cvt_pk_bf16_f32 v83,v102,v103
v_mfma_f32_16x16x32_bf16 v[60:63],v[44:47],v[92:95],v[60:63]
v_exp_f32 v104,v104
v_mfma_f32_16x16x32_bf16 v[112:115],a[128:131],a[16:19],v[68:71]
ds_read_b64_tr_b16 a[216:217],v17 offset:49152
ds_read_b64_tr_b16 a[218:219],v17 offset:53248
v_mfma_f32_16x16x32_bf16 v[112:115],a[132:135],a[20:23],v[112:115]
v_exp_f32 v105,v105
v_mfma_f32_16x16x32_bf16 v[112:115],a[136:139],a[24:27],v[112:115]
ds_read_b64_tr_b16 a[220:221],v17 offset:57344
v_cvt_pk_bf16_f32 v84,v104,v105
v_mfma_f32_16x16x32_bf16 v[112:115],a[140:143],a[28:31],v[112:115]
v_exp_f32 v106,v106
v_mfma_f32_16x16x32_bf16 v[116:119],a[144:147],a[16:19],v[68:71]
ds_read_b64_tr_b16 a[222:223],v17 offset:61440
ds_read_b64_tr_b16 a[224:225],v18 offset:49152
v_mfma_f32_16x16x32_bf16 v[116:119],a[148:151],a[20:23],v[116:119]
v_exp_f32 v107,v107
v_mfma_f32_16x16x32_bf16 v[116:119],a[152:155],a[24:27],v[116:119]
ds_read_b64_tr_b16 a[226:227],v18 offset:53248
v_cvt_pk_bf16_f32 v85,v106,v107
v_mfma_f32_16x16x32_bf16 v[116:119],a[156:159],a[28:31],v[116:119]
v_exp_f32 v108,v108
v_mfma_f32_16x16x32_bf16 v[120:123],a[160:163],a[16:19],v[68:71]
ds_read_b64_tr_b16 a[228:229],v18 offset:57344
ds_read_b64_tr_b16 a[230:231],v18 offset:61440
v_mfma_f32_16x16x32_bf16 v[120:123],a[164:167],a[20:23],v[120:123]
v_exp_f32 v109,v109
v_mfma_f32_16x16x32_bf16 v[120:123],a[168:171],a[24:27],v[120:123]
ds_read_b64_tr_b16 a[232:233],v19 offset:49152
v_cvt_pk_bf16_f32 v86,v108,v109
v_mfma_f32_16x16x32_bf16 v[120:123],a[172:175],a[28:31],v[120:123]
s_mov_b32 s48,212992
v_exp_f32 v110,v110
v_mfma_f32_16x16x32_bf16 v[124:127],a[176:179],a[16:19],v[68:71]
ds_read_b64_tr_b16 a[234:235],v19 offset:53248
ds_read_b64_tr_b16 a[236:237],v19 offset:57344
s_add_u32 m0,s39,16384
v_mfma_f32_16x16x32_bf16 v[124:127],a[180:183],a[20:23],v[124:127]
buffer_load_dwordx4 v4,s[8:11],s48 offen nt lds
v_exp_f32 v111,v111
v_mfma_f32_16x16x32_bf16 v[124:127],a[184:187],a[24:27],v[124:127]
ds_read_b64_tr_b16 a[238:239],v19 offset:61440
v_cvt_pk_bf16_f32 v87,v110,v111
v_mfma_f32_16x16x32_bf16 v[124:127],a[188:191],a[28:31],v[124:127]
ds_read_b64_tr_b16 a[240:241],v20 offset:49152
ds_read_b64_tr_b16 a[242:243],v20 offset:53248
v_mfma_f32_16x16x32_bf16 v[96:99],a[128:131],a[32:35],v[72:75]
ds_read_b64_tr_b16 a[244:245],v20 offset:57344
ds_read_b64_tr_b16 a[246:247],v20 offset:61440
v_mfma_f32_16x16x32_bf16 v[96:99],a[132:135],a[36:39],v[96:99]
v_exp_f32 v112,v112
v_mfma_f32_16x16x32_bf16 v[96:99],a[136:139],a[40:43],v[96:99]
ds_read_b64_tr_b16 a[248:249],v21 offset:49152
ds_read_b64_tr_b16 a[250:251],v21 offset:53248
v_mfma_f32_16x16x32_bf16 v[96:99],a[140:143],a[44:47],v[96:99]
v_exp_f32 v113,v113
v_mfma_f32_16x16x32_bf16 v[100:103],a[144:147],a[32:35],v[72:75]
ds_read_b64_tr_b16 a[252:253],v21 offset:57344
v_cvt_pk_bf16_f32 v88,v112,v113
v_mfma_f32_16x16x32_bf16 v[100:103],a[148:151],a[36:39],v[100:103]
v_exp_f32 v114,v114
v_mfma_f32_16x16x32_bf16 v[100:103],a[152:155],a[40:43],v[100:103]
ds_read_b64_tr_b16 a[254:255],v21 offset:61440
v_mfma_f32_16x16x32_bf16 v[100:103],a[156:159],a[44:47],v[100:103]
v_exp_f32 v115,v115
v_mfma_f32_16x16x32_bf16 v[104:107],a[160:163],a[32:35],v[72:75]
v_cvt_pk_bf16_f32 v89,v114,v115
v_mfma_f32_16x16x32_bf16 v[104:107],a[164:167],a[36:39],v[104:107]
v_exp_f32 v116,v116
v_mfma_f32_16x16x32_bf16 v[104:107],a[168:171],a[40:43],v[104:107]
v_mfma_f32_16x16x32_bf16 v[104:107],a[172:175],a[44:47],v[104:107]
v_exp_f32 v117,v117
v_mfma_f32_16x16x32_bf16 v[108:111],a[176:179],a[32:35],v[72:75]
buffer_load_dwordx4 v5,s[8:11],s48 offen offset:1024 nt lds
v_cvt_pk_bf16_f32 v90,v116,v117
v_mfma_f32_16x16x32_bf16 v[108:111],a[180:183],a[36:39],v[108:111]
v_exp_f32 v118,v118
v_mfma_f32_16x16x32_bf16 v[108:111],a[184:187],a[40:43],v[108:111]
s_waitcnt lgkmcnt(0)
v_mfma_f32_16x16x32_bf16 v[108:111],a[188:191],a[44:47],v[108:111]
v_exp_f32 v119,v119
v_mfma_f32_16x16x32_bf16 v[128:131],a[192:195],v[80:83],v[128:131]
v_cvt_pk_bf16_f32 v91,v118,v119
v_mfma_f32_16x16x32_bf16 v[128:131],a[196:199],v[84:87],v[128:131]
v_exp_f32 v120,v120
v_mfma_f32_16x16x32_bf16 v[132:135],a[200:203],v[80:83],v[132:135]
v_mfma_f32_16x16x32_bf16 v[132:135],a[204:207],v[84:87],v[132:135]
v_exp_f32 v121,v121
v_mfma_f32_16x16x32_bf16 v[136:139],a[208:211],v[80:83],v[136:139]
v_cvt_pk_bf16_f32 v92,v120,v121
v_mfma_f32_16x16x32_bf16 v[136:139],a[212:215],v[84:87],v[136:139]
v_exp_f32 v122,v122
v_mfma_f32_16x16x32_bf16 v[140:143],a[216:219],v[80:83],v[140:143]
v_mfma_f32_16x16x32_bf16 v[140:143],a[220:223],v[84:87],v[140:143]
v_exp_f32 v123,v123
v_mfma_f32_16x16x32_bf16 v[144:147],a[224:227],v[80:83],v[144:147]
v_cvt_pk_bf16_f32 v93,v122,v123
v_mfma_f32_16x16x32_bf16 v[144:147],a[228:231],v[84:87],v[144:147]
v_exp_f32 v124,v124
v_mfma_f32_16x16x32_bf16 v[148:151],a[232:235],v[80:83],v[148:151]
v_mfma_f32_16x16x32_bf16 v[148:151],a[236:239],v[84:87],v[148:151]
v_exp_f32 v125,v125
v_mfma_f32_16x16x32_bf16 v[152:155],a[240:243],v[80:83],v[152:155]
v_cvt_pk_bf16_f32 v94,v124,v125
v_mfma_f32_16x16x32_bf16 v[152:155],a[244:247],v[84:87],v[152:155]
buffer_load_dwordx4 v6,s[8:11],s48 offen offset:2048 nt lds
v_exp_f32 v126,v126
v_mfma_f32_16x16x32_bf16 v[156:159],a[248:251],v[80:83],v[156:159]
v_mfma_f32_16x16x32_bf16 v[156:159],a[252:255],v[84:87],v[156:159]
v_exp_f32 v127,v127
v_mfma_f32_16x16x32_bf16 v[48:51],v[44:47],v[80:83],v[48:51]
v_cvt_pk_bf16_f32 v95,v126,v127
v_mfma_f32_16x16x32_bf16 v[48:51],v[44:47],v[84:87],v[48:51]
s_waitcnt vmcnt(3)
s_barrier
v_mfma_f32_16x16x32_bf16 v[112:115],a[128:131],a[48:51],v[76:79]
v_mfma_f32_16x16x32_bf16 v[112:115],a[132:135],a[52:55],v[112:115]
v_exp_f32 v96,v96
v_mfma_f32_16x16x32_bf16 v[112:115],a[136:139],a[56:59],v[112:115]
v_mfma_f32_16x16x32_bf16 v[112:115],a[140:143],a[60:63],v[112:115]
v_exp_f32 v97,v97
v_mfma_f32_16x16x32_bf16 v[116:119],a[144:147],a[48:51],v[76:79]
ds_read_b128 a[128:131],v10 offset:0
v_cvt_pk_bf16_f32 v80,v96,v97
v_mfma_f32_16x16x32_bf16 v[116:119],a[148:151],a[52:55],v[116:119]
v_exp_f32 v98,v98
v_mfma_f32_16x16x32_bf16 v[116:119],a[152:155],a[56:59],v[116:119]
ds_read_b128 a[132:135],v11 offset:0
v_mfma_f32_16x16x32_bf16 v[116:119],a[156:159],a[60:63],v[116:119]
v_exp_f32 v99,v99
v_mfma_f32_16x16x32_bf16 v[120:123],a[160:163],a[48:51],v[76:79]
ds_read_b128 a[136:139],v12 offset:0
v_cvt_pk_bf16_f32 v81,v98,v99
v_mfma_f32_16x16x32_bf16 v[120:123],a[164:167],a[52:55],v[120:123]
v_exp_f32 v100,v100
v_mfma_f32_16x16x32_bf16 v[120:123],a[168:171],a[56:59],v[120:123]
ds_read_b128 a[140:143],v13 offset:0
v_mfma_f32_16x16x32_bf16 v[120:123],a[172:175],a[60:63],v[120:123]
v_exp_f32 v101,v101
v_mfma_f32_16x16x32_bf16 v[124:127],a[176:179],a[48:51],v[76:79]
ds_read_b128 a[144:147],v10 offset:4096
v_cvt_pk_bf16_f32 v82,v100,v101
v_mfma_f32_16x16x32_bf16 v[124:127],a[180:183],a[52:55],v[124:127]
buffer_load_dwordx4 v7,s[8:11],s48 offen offset:3072 nt lds
v_exp_f32 v102,v102
v_mfma_f32_16x16x32_bf16 v[124:127],a[184:187],a[56:59],v[124:127]
ds_read_b128 a[148:151],v11 offset:4096
v_mfma_f32_16x16x32_bf16 v[124:127],a[188:191],a[60:63],v[124:127]
v_exp_f32 v103,v103
v_mfma_f32_16x16x32_bf16 v[160:163],a[192:195],v[88:91],v[160:163]
ds_read_b128 a[152:155],v12 offset:4096
v_cvt_pk_bf16_f32 v83,v102,v103
v_mfma_f32_16x16x32_bf16 v[160:163],a[196:199],v[92:95],v[160:163]
v_exp_f32 v104,v104
v_mfma_f32_16x16x32_bf16 v[164:167],a[200:203],v[88:91],v[164:167]
ds_read_b128 a[156:159],v13 offset:4096
v_mfma_f32_16x16x32_bf16 v[164:167],a[204:207],v[92:95],v[164:167]
v_exp_f32 v105,v105
v_mfma_f32_16x16x32_bf16 v[168:171],a[208:211],v[88:91],v[168:171]
ds_read_b128 a[160:163],v10 offset:8192
v_cvt_pk_bf16_f32 v84,v104,v105
v_mfma_f32_16x16x32_bf16 v[168:171],a[212:215],v[92:95],v[168:171]
v_exp_f32 v106,v106
v_mfma_f32_16x16x32_bf16 v[172:175],a[216:219],v[88:91],v[172:175]
ds_read_b128 a[164:167],v11 offset:8192
v_mfma_f32_16x16x32_bf16 v[172:175],a[220:223],v[92:95],v[172:175]
v_exp_f32 v107,v107
v_mfma_f32_16x16x32_bf16 v[176:179],a[224:227],v[88:91],v[176:179]
ds_read_b128 a[168:171],v12 offset:8192
v_cvt_pk_bf16_f32 v85,v106,v107
v_mfma_f32_16x16x32_bf16 v[176:179],a[228:231],v[92:95],v[176:179]
v_exp_f32 v108,v108
v_mfma_f32_16x16x32_bf16 v[180:183],a[232:235],v[88:91],v[180:183]
ds_read_b128 a[172:175],v13 offset:8192
v_mfma_f32_16x16x32_bf16 v[180:183],a[236:239],v[92:95],v[180:183]
v_exp_f32 v109,v109
v_mfma_f32_16x16x32_bf16 v[184:187],a[240:243],v[88:91],v[184:187]
ds_read_b128 a[176:179],v10 offset:12288
v_cvt_pk_bf16_f32 v86,v108,v109
v_mfma_f32_16x16x32_bf16 v[184:187],a[244:247],v[92:95],v[184:187]
s_add_u32 m0,s39,81920
v_exp_f32 v110,v110
v_mfma_f32_16x16x32_bf16 v[188:191],a[248:251],v[88:91],v[188:191]
ds_read_b128 a[180:183],v11 offset:12288
v_mfma_f32_16x16x32_bf16 v[188:191],a[252:255],v[92:95],v[188:191]
buffer_load_dwordx4 v8,s[12:15],s48 offen nt lds
v_exp_f32 v111,v111
v_mfma_f32_16x16x32_bf16 v[52:55],v[44:47],v[88:91],v[52:55]
ds_read_b128 a[184:187],v12 offset:12288
v_cvt_pk_bf16_f32 v87,v110,v111
v_mfma_f32_16x16x32_bf16 v[52:55],v[44:47],v[92:95],v[52:55]
ds_read_b128 a[188:191],v13 offset:12288
v_mfma_f32_16x16x32_bf16 v[192:195],a[192:195],v[80:83],v[192:195]
v_mfma_f32_16x16x32_bf16 v[192:195],a[196:199],v[84:87],v[192:195]
v_exp_f32 v112,v112
v_mfma_f32_16x16x32_bf16 v[196:199],a[200:203],v[80:83],v[196:199]
v_mfma_f32_16x16x32_bf16 v[196:199],a[204:207],v[84:87],v[196:199]
v_exp_f32 v113,v113
v_mfma_f32_16x16x32_bf16 v[200:203],a[208:211],v[80:83],v[200:203]
v_cvt_pk_bf16_f32 v88,v112,v113
v_mfma_f32_16x16x32_bf16 v[200:203],a[212:215],v[84:87],v[200:203]
v_exp_f32 v114,v114
v_mfma_f32_16x16x32_bf16 v[204:207],a[216:219],v[80:83],v[204:207]
v_mfma_f32_16x16x32_bf16 v[204:207],a[220:223],v[84:87],v[204:207]
v_exp_f32 v115,v115
v_mfma_f32_16x16x32_bf16 v[208:211],a[224:227],v[80:83],v[208:211]
v_cvt_pk_bf16_f32 v89,v114,v115
v_mfma_f32_16x16x32_bf16 v[208:211],a[228:231],v[84:87],v[208:211]
v_exp_f32 v116,v116
v_mfma_f32_16x16x32_bf16 v[212:215],a[232:235],v[80:83],v[212:215]
v_mfma_f32_16x16x32_bf16 v[212:215],a[236:239],v[84:87],v[212:215]
v_exp_f32 v117,v117
v_mfma_f32_16x16x32_bf16 v[216:219],a[240:243],v[80:83],v[216:219]
buffer_load_dwordx4 v9,s[12:15],s48 offen offset:1024 nt lds
v_cvt_pk_bf16_f32 v90,v116,v117
v_mfma_f32_16x16x32_bf16 v[216:219],a[244:247],v[84:87],v[216:219]
v_exp_f32 v118,v118
v_mfma_f32_16x16x32_bf16 v[220:223],a[248:251],v[80:83],v[220:223]
s_waitcnt lgkmcnt(0)
v_mfma_f32_16x16x32_bf16 v[220:223],a[252:255],v[84:87],v[220:223]
v_exp_f32 v119,v119
v_mfma_f32_16x16x32_bf16 v[56:59],v[44:47],v[80:83],v[56:59]
v_cvt_pk_bf16_f32 v91,v118,v119
v_mfma_f32_16x16x32_bf16 v[56:59],v[44:47],v[84:87],v[56:59]
v_exp_f32 v120,v120
v_mfma_f32_16x16x32_bf16 v[96:99],a[128:131],a[0:3],v[64:67]
v_mfma_f32_16x16x32_bf16 v[96:99],a[132:135],a[4:7],v[96:99]
v_exp_f32 v121,v121
v_mfma_f32_16x16x32_bf16 v[96:99],a[136:139],a[8:11],v[96:99]
v_cvt_pk_bf16_f32 v92,v120,v121
v_mfma_f32_16x16x32_bf16 v[96:99],a[140:143],a[12:15],v[96:99]
v_exp_f32 v122,v122
v_mfma_f32_16x16x32_bf16 v[100:103],a[144:147],a[0:3],v[64:67]
v_mfma_f32_16x16x32_bf16 v[100:103],a[148:151],a[4:7],v[100:103]
v_exp_f32 v123,v123
v_mfma_f32_16x16x32_bf16 v[100:103],a[152:155],a[8:11],v[100:103]
v_cvt_pk_bf16_f32 v93,v122,v123
v_mfma_f32_16x16x32_bf16 v[100:103],a[156:159],a[12:15],v[100:103]
v_exp_f32 v124,v124
v_mfma_f32_16x16x32_bf16 v[104:107],a[160:163],a[0:3],v[64:67]
v_mfma_f32_16x16x32_bf16 v[104:107],a[164:167],a[4:7],v[104:107]
v_exp_f32 v125,v125
v_mfma_f32_16x16x32_bf16 v[104:107],a[168:171],a[8:11],v[104:107]
v_cvt_pk_bf16_f32 v94,v124,v125
v_mfma_f32_16x16x32_bf16 v[104:107],a[172:175],a[12:15],v[104:107]
buffer_load_dwordx4 v8,s[12:15],s48 offen offset:2048 nt lds
v_exp_f32 v126,v126
v_mfma_f32_16x16x32_bf16 v[108:111],a[176:179],a[0:3],v[64:67]
v_mfma_f32_16x16x32_bf16 v[108:111],a[180:183],a[4:7],v[108:111]
v_exp_f32 v127,v127
v_mfma_f32_16x16x32_bf16 v[108:111],a[184:187],a[8:11],v[108:111]
v_cvt_pk_bf16_f32 v95,v126,v127
v_mfma_f32_16x16x32_bf16 v[108:111],a[188:191],a[12:15],v[108:111]
v_mfma_f32_16x16x32_bf16 v[224:227],a[192:195],v[88:91],v[224:227]
v_mfma_f32_16x16x32_bf16 v[224:227],a[196:199],v[92:95],v[224:227]
v_exp_f32 v96,v96
v_mfma_f32_16x16x32_bf16 v[228:231],a[200:203],v[88:91],v[228:231]
ds_read_b64_tr_b16 a[192:193],v14 offset:0
ds_read_b64_tr_b16 a[194:195],v14 offset:4096
v_mfma_f32_16x16x32_bf16 v[228:231],a[204:207],v[92:95],v[228:231]
v_exp_f32 v97,v97
v_mfma_f32_16x16x32_bf16 v[232:235],a[208:211],v[88:91],v[232:235]
ds_read_b64_tr_b16 a[196:197],v14 offset:8192
v_cvt_pk_bf16_f32 v80,v96,v97
v_mfma_f32_16x16x32_bf16 v[232:235],a[212:215],v[92:95],v[232:235]
v_exp_f32 v98,v98
v_mfma_f32_16x16x32_bf16 v[236:239],a[216:219],v[88:91],v[236:239]
ds_read_b64_tr_b16 a[198:199],v14 offset:12288
ds_read_b64_tr_b16 a[200:201],v15 offset:0
v_mfma_f32_16x16x32_bf16 v[236:239],a[220:223],v[92:95],v[236:239]
v_exp_f32 v99,v99
v_mfma_f32_16x16x32_bf16 v[240:243],a[224:227],v[88:91],v[240:243]
ds_read_b64_tr_b16 a[202:203],v15 offset:4096
v_cvt_pk_bf16_f32 v81,v98,v99
v_mfma_f32_16x16x32_bf16 v[240:243],a[228:231],v[92:95],v[240:243]
v_exp_f32 v100,v100
v_mfma_f32_16x16x32_bf16 v[244:247],a[232:235],v[88:91],v[244:247]
ds_read_b64_tr_b16 a[204:205],v15 offset:8192
ds_read_b64_tr_b16 a[206:207],v15 offset:12288
v_mfma_f32_16x16x32_bf16 v[244:247],a[236:239],v[92:95],v[244:247]
v_exp_f32 v101,v101
v_mfma_f32_16x16x32_bf16 v[248:251],a[240:243],v[88:91],v[248:251]
ds_read_b64_tr_b16 a[208:209],v16 offset:0
v_cvt_pk_bf16_f32 v82,v100,v101
v_mfma_f32_16x16x32_bf16 v[248:251],a[244:247],v[92:95],v[248:251]
buffer_load_dwordx4 v9,s[12:15],s48 offen offset:3072 nt lds
v_exp_f32 v102,v102
v_mfma_f32_16x16x32_bf16 v[252:255],a[248:251],v[88:91],v[252:255]
ds_read_b64_tr_b16 a[210:211],v16 offset:4096
ds_read_b64_tr_b16 a[212:213],v16 offset:8192
v_mfma_f32_16x16x32_bf16 v[252:255],a[252:255],v[92:95],v[252:255]
v_exp_f32 v103,v103
v_mfma_f32_16x16x32_bf16 v[60:63],v[44:47],v[88:91],v[60:63]
ds_read_b64_tr_b16 a[214:215],v16 offset:12288
v_cvt_pk_bf16_f32 v83,v102,v103
v_mfma_f32_16x16x32_bf16 v[60:63],v[44:47],v[92:95],v[60:63]
v_exp_f32 v104,v104
v_mfma_f32_16x16x32_bf16 v[112:115],a[128:131],a[16:19],v[68:71]
ds_read_b64_tr_b16 a[216:217],v17 offset:0
ds_read_b64_tr_b16 a[218:219],v17 offset:4096
v_mfma_f32_16x16x32_bf16 v[112:115],a[132:135],a[20:23],v[112:115]
v_exp_f32 v105,v105
v_mfma_f32_16x16x32_bf16 v[112:115],a[136:139],a[24:27],v[112:115]
ds_read_b64_tr_b16 a[220:221],v17 offset:8192
v_cvt_pk_bf16_f32 v84,v104,v105
v_mfma_f32_16x16x32_bf16 v[112:115],a[140:143],a[28:31],v[112:115]
v_exp_f32 v106,v106
v_mfma_f32_16x16x32_bf16 v[116:119],a[144:147],a[16:19],v[68:71]
ds_read_b64_tr_b16 a[222:223],v17 offset:12288
ds_read_b64_tr_b16 a[224:225],v18 offset:0
v_mfma_f32_16x16x32_bf16 v[116:119],a[148:151],a[20:23],v[116:119]
v_exp_f32 v107,v107
v_mfma_f32_16x16x32_bf16 v[116:119],a[152:155],a[24:27],v[116:119]
ds_read_b64_tr_b16 a[226:227],v18 offset:4096
v_cvt_pk_bf16_f32 v85,v106,v107
v_mfma_f32_16x16x32_bf16 v[116:119],a[156:159],a[28:31],v[116:119]
v_exp_f32 v108,v108
v_mfma_f32_16x16x32_bf16 v[120:123],a[160:163],a[16:19],v[68:71]
ds_read_b64_tr_b16 a[228:229],v18 offset:8192
ds_read_b64_tr_b16 a[230:231],v18 offset:12288
v_mfma_f32_16x16x32_bf16 v[120:123],a[164:167],a[20:23],v[120:123]
v_exp_f32 v109,v109
v_mfma_f32_16x16x32_bf16 v[120:123],a[168:171],a[24:27],v[120:123]
ds_read_b64_tr_b16 a[232:233],v19 offset:0
v_cvt_pk_bf16_f32 v86,v108,v109
v_mfma_f32_16x16x32_bf16 v[120:123],a[172:175],a[28:31],v[120:123]
s_mov_b32 s48,229376
v_exp_f32 v110,v110
v_mfma_f32_16x16x32_bf16 v[124:127],a[176:179],a[16:19],v[68:71]
ds_read_b64_tr_b16 a[234:235],v19 offset:4096
ds_read_b64_tr_b16 a[236:237],v19 offset:8192
s_add_u32 m0,s39,32768
v_mfma_f32_16x16x32_bf16 v[124:127],a[180:183],a[20:23],v[124:127]
buffer_load_dwordx4 v4,s[8:11],s48 offen nt lds
v_exp_f32 v111,v111
v_mfma_f32_16x16x32_bf16 v[124:127],a[184:187],a[24:27],v[124:127]
ds_read_b64_tr_b16 a[238:239],v19 offset:12288
v_cvt_pk_bf16_f32 v87,v110,v111
v_mfma_f32_16x16x32_bf16 v[124:127],a[188:191],a[28:31],v[124:127]
ds_read_b64_tr_b16 a[240:241],v20 offset:0
ds_read_b64_tr_b16 a[242:243],v20 offset:4096
v_mfma_f32_16x16x32_bf16 v[96:99],a[128:131],a[32:35],v[72:75]
ds_read_b64_tr_b16 a[244:245],v20 offset:8192
ds_read_b64_tr_b16 a[246:247],v20 offset:12288
v_mfma_f32_16x16x32_bf16 v[96:99],a[132:135],a[36:39],v[96:99]
v_exp_f32 v112,v112
v_mfma_f32_16x16x32_bf16 v[96:99],a[136:139],a[40:43],v[96:99]
ds_read_b64_tr_b16 a[248:249],v21 offset:0
ds_read_b64_tr_b16 a[250:251],v21 offset:4096
v_mfma_f32_16x16x32_bf16 v[96:99],a[140:143],a[44:47],v[96:99]
v_exp_f32 v113,v113
v_mfma_f32_16x16x32_bf16 v[100:103],a[144:147],a[32:35],v[72:75]
ds_read_b64_tr_b16 a[252:253],v21 offset:8192
v_cvt_pk_bf16_f32 v88,v112,v113
v_mfma_f32_16x16x32_bf16 v[100:103],a[148:151],a[36:39],v[100:103]
v_exp_f32 v114,v114
v_mfma_f32_16x16x32_bf16 v[100:103],a[152:155],a[40:43],v[100:103]
ds_read_b64_tr_b16 a[254:255],v21 offset:12288
v_mfma_f32_16x16x32_bf16 v[100:103],a[156:159],a[44:47],v[100:103]
v_exp_f32 v115,v115
v_mfma_f32_16x16x32_bf16 v[104:107],a[160:163],a[32:35],v[72:75]
v_cvt_pk_bf16_f32 v89,v114,v115
v_mfma_f32_16x16x32_bf16 v[104:107],a[164:167],a[36:39],v[104:107]
v_exp_f32 v116,v116
v_mfma_f32_16x16x32_bf16 v[104:107],a[168:171],a[40:43],v[104:107]
v_mfma_f32_16x16x32_bf16 v[104:107],a[172:175],a[44:47],v[104:107]
v_exp_f32 v117,v117
v_mfma_f32_16x16x32_bf16 v[108:111],a[176:179],a[32:35],v[72:75]
buffer_load_dwordx4 v5,s[8:11],s48 offen offset:1024 nt lds
v_cvt_pk_bf16_f32 v90,v116,v117
v_mfma_f32_16x16x32_bf16 v[108:111],a[180:183],a[36:39],v[108:111]
v_exp_f32 v118,v118
v_mfma_f32_16x16x32_bf16 v[108:111],a[184:187],a[40:43],v[108:111]
s_waitcnt lgkmcnt(0)
v_mfma_f32_16x16x32_bf16 v[108:111],a[188:191],a[44:47],v[108:111]
v_exp_f32 v119,v119
v_mfma_f32_16x16x32_bf16 v[128:131],a[192:195],v[80:83],v[128:131]
v_cvt_pk_bf16_f32 v91,v118,v119
v_mfma_f32_16x16x32_bf16 v[128:131],a[196:199],v[84:87],v[128:131]
v_exp_f32 v120,v120
v_mfma_f32_16x16x32_bf16 v[132:135],a[200:203],v[80:83],v[132:135]
v_mfma_f32_16x16x32_bf16 v[132:135],a[204:207],v[84:87],v[132:135]
v_exp_f32 v121,v121
v_mfma_f32_16x16x32_bf16 v[136:139],a[208:211],v[80:83],v[136:139]
v_cvt_pk_bf16_f32 v92,v120,v121
v_mfma_f32_16x16x32_bf16 v[136:139],a[212:215],v[84:87],v[136:139]
v_exp_f32 v122,v122
v_mfma_f32_16x16x32_bf16 v[140:143],a[216:219],v[80:83],v[140:143]
v_mfma_f32_16x16x32_bf16 v[140:143],a[220:223],v[84:87],v[140:143]
v_exp_f32 v123,v123
v_mfma_f32_16x16x32_bf16 v[144:147],a[224:227],v[80:83],v[144:147]
v_cvt_pk_bf16_f32 v93,v122,v123
v_mfma_f32_16x16x32_bf16 v[144:147],a[228:231],v[84:87],v[144:147]
v_exp_f32 v124,v124
v_mfma_f32_16x16x32_bf16 v[148:151],a[232:235],v[80:83],v[148:151]
v_mfma_f32_16x16x32_bf16 v[148:151],a[236:239],v[84:87],v[148:151]
v_exp_f32 v125,v125
v_mfma_f32_16x16x32_bf16 v[152:155],a[240:243],v[80:83],v[152:155]
v_cvt_pk_bf16_f32 v94,v124,v125
v_mfma_f32_16x16x32_bf16 v[152:155],a[244:247],v[84:87],v[152:155]
buffer_load_dwordx4 v6,s[8:11],s48 offen offset:2048 nt lds
v_exp_f32 v126,v126
v_mfma_f32_16x16x32_bf16 v[156:159],a[248:251],v[80:83],v[156:159]
v_mfma_f32_16x16x32_bf16 v[156:159],a[252:255],v[84:87],v[156:159]
v_exp_f32 v127,v127
v_mfma_f32_16x16x32_bf16 v[48:51],v[44:47],v[80:83],v[48:51]
v_cvt_pk_bf16_f32 v95,v126,v127
v_mfma_f32_16x16x32_bf16 v[48:51],v[44:47],v[84:87],v[48:51]
s_waitcnt vmcnt(3)
s_barrier
v_mfma_f32_16x16x32_bf16 v[112:115],a[128:131],a[48:51],v[76:79]
v_mfma_f32_16x16x32_bf16 v[112:115],a[132:135],a[52:55],v[112:115]
v_exp_f32 v96,v96
v_mfma_f32_16x16x32_bf16 v[112:115],a[136:139],a[56:59],v[112:115]
v_mfma_f32_16x16x32_bf16 v[112:115],a[140:143],a[60:63],v[112:115]
v_exp_f32 v97,v97
v_mfma_f32_16x16x32_bf16 v[116:119],a[144:147],a[48:51],v[76:79]
ds_read_b128 a[128:131],v10 offset:16384
v_cvt_pk_bf16_f32 v80,v96,v97
v_mfma_f32_16x16x32_bf16 v[116:119],a[148:151],a[52:55],v[116:119]
v_exp_f32 v98,v98
v_mfma_f32_16x16x32_bf16 v[116:119],a[152:155],a[56:59],v[116:119]
ds_read_b128 a[132:135],v11 offset:16384
v_mfma_f32_16x16x32_bf16 v[116:119],a[156:159],a[60:63],v[116:119]
v_exp_f32 v99,v99
v_mfma_f32_16x16x32_bf16 v[120:123],a[160:163],a[48:51],v[76:79]
ds_read_b128 a[136:139],v12 offset:16384
v_cvt_pk_bf16_f32 v81,v98,v99
v_mfma_f32_16x16x32_bf16 v[120:123],a[164:167],a[52:55],v[120:123]
v_exp_f32 v100,v100
v_mfma_f32_16x16x32_bf16 v[120:123],a[168:171],a[56:59],v[120:123]
ds_read_b128 a[140:143],v13 offset:16384
v_mfma_f32_16x16x32_bf16 v[120:123],a[172:175],a[60:63],v[120:123]
v_exp_f32 v101,v101
v_mfma_f32_16x16x32_bf16 v[124:127],a[176:179],a[48:51],v[76:79]
ds_read_b128 a[144:147],v10 offset:20480
v_cvt_pk_bf16_f32 v82,v100,v101
v_mfma_f32_16x16x32_bf16 v[124:127],a[180:183],a[52:55],v[124:127]
buffer_load_dwordx4 v7,s[8:11],s48 offen offset:3072 nt lds
v_exp_f32 v102,v102
v_mfma_f32_16x16x32_bf16 v[124:127],a[184:187],a[56:59],v[124:127]
ds_read_b128 a[148:151],v11 offset:20480
v_mfma_f32_16x16x32_bf16 v[124:127],a[188:191],a[60:63],v[124:127]
v_exp_f32 v103,v103
v_mfma_f32_16x16x32_bf16 v[160:163],a[192:195],v[88:91],v[160:163]
ds_read_b128 a[152:155],v12 offset:20480
v_cvt_pk_bf16_f32 v83,v102,v103
v_mfma_f32_16x16x32_bf16 v[160:163],a[196:199],v[92:95],v[160:163]
v_exp_f32 v104,v104
v_mfma_f32_16x16x32_bf16 v[164:167],a[200:203],v[88:91],v[164:167]
ds_read_b128 a[156:159],v13 offset:20480
v_mfma_f32_16x16x32_bf16 v[164:167],a[204:207],v[92:95],v[164:167]
v_exp_f32 v105,v105
v_mfma_f32_16x16x32_bf16 v[168:171],a[208:211],v[88:91],v[168:171]
ds_read_b128 a[160:163],v10 offset:24576
v_cvt_pk_bf16_f32 v84,v104,v105
v_mfma_f32_16x16x32_bf16 v[168:171],a[212:215],v[92:95],v[168:171]
v_exp_f32 v106,v106
v_mfma_f32_16x16x32_bf16 v[172:175],a[216:219],v[88:91],v[172:175]
ds_read_b128 a[164:167],v11 offset:24576
v_mfma_f32_16x16x32_bf16 v[172:175],a[220:223],v[92:95],v[172:175]
v_exp_f32 v107,v107
v_mfma_f32_16x16x32_bf16 v[176:179],a[224:227],v[88:91],v[176:179]
ds_read_b128 a[168:171],v12 offset:24576
v_cvt_pk_bf16_f32 v85,v106,v107
v_mfma_f32_16x16x32_bf16 v[176:179],a[228:231],v[92:95],v[176:179]
v_exp_f32 v108,v108
v_mfma_f32_16x16x32_bf16 v[180:183],a[232:235],v[88:91],v[180:183]
ds_read_b128 a[172:175],v13 offset:24576
v_mfma_f32_16x16x32_bf16 v[180:183],a[236:239],v[92:95],v[180:183]
v_exp_f32 v109,v109
v_mfma_f32_16x16x32_bf16 v[184:187],a[240:243],v[88:91],v[184:187]
ds_read_b128 a[176:179],v10 offset:28672
v_cvt_pk_bf16_f32 v86,v108,v109
v_mfma_f32_16x16x32_bf16 v[184:187],a[244:247],v[92:95],v[184:187]
s_add_u32 m0,s39,98304
v_exp_f32 v110,v110
v_mfma_f32_16x16x32_bf16 v[188:191],a[248:251],v[88:91],v[188:191]
ds_read_b128 a[180:183],v11 offset:28672
v_mfma_f32_16x16x32_bf16 v[188:191],a[252:255],v[92:95],v[188:191]
buffer_load_dwordx4 v8,s[12:15],s48 offen nt lds
v_exp_f32 v111,v111
v_mfma_f32_16x16x32_bf16 v[52:55],v[44:47],v[88:91],v[52:55]
ds_read_b128 a[184:187],v12 offset:28672
v_cvt_pk_bf16_f32 v87,v110,v111
v_mfma_f32_16x16x32_bf16 v[52:55],v[44:47],v[92:95],v[52:55]
ds_read_b128 a[188:191],v13 offset:28672
v_mfma_f32_16x16x32_bf16 v[192:195],a[192:195],v[80:83],v[192:195]
v_mfma_f32_16x16x32_bf16 v[192:195],a[196:199],v[84:87],v[192:195]
v_exp_f32 v112,v112
v_mfma_f32_16x16x32_bf16 v[196:199],a[200:203],v[80:83],v[196:199]
v_mfma_f32_16x16x32_bf16 v[196:199],a[204:207],v[84:87],v[196:199]
v_exp_f32 v113,v113
v_mfma_f32_16x16x32_bf16 v[200:203],a[208:211],v[80:83],v[200:203]
v_cvt_pk_bf16_f32 v88,v112,v113
v_mfma_f32_16x16x32_bf16 v[200:203],a[212:215],v[84:87],v[200:203]
v_exp_f32 v114,v114
v_mfma_f32_16x16x32_bf16 v[204:207],a[216:219],v[80:83],v[204:207]
v_mfma_f32_16x16x32_bf16 v[204:207],a[220:223],v[84:87],v[204:207]
v_exp_f32 v115,v115
v_mfma_f32_16x16x32_bf16 v[208:211],a[224:227],v[80:83],v[208:211]
v_cvt_pk_bf16_f32 v89,v114,v115
v_mfma_f32_16x16x32_bf16 v[208:211],a[228:231],v[84:87],v[208:211]
v_exp_f32 v116,v116
v_mfma_f32_16x16x32_bf16 v[212:215],a[232:235],v[80:83],v[212:215]
v_mfma_f32_16x16x32_bf16 v[212:215],a[236:239],v[84:87],v[212:215]
v_exp_f32 v117,v117
v_mfma_f32_16x16x32_bf16 v[216:219],a[240:243],v[80:83],v[216:219]
buffer_load_dwordx4 v9,s[12:15],s48 offen offset:1024 nt lds
v_cvt_pk_bf16_f32 v90,v116,v117
v_mfma_f32_16x16x32_bf16 v[216:219],a[244:247],v[84:87],v[216:219]
v_exp_f32 v118,v118
v_mfma_f32_16x16x32_bf16 v[220:223],a[248:251],v[80:83],v[220:223]
s_waitcnt lgkmcnt(0)
v_mfma_f32_16x16x32_bf16 v[220:223],a[252:255],v[84:87],v[220:223]
v_exp_f32 v119,v119
v_mfma_f32_16x16x32_bf16 v[56:59],v[44:47],v[80:83],v[56:59]
v_cvt_pk_bf16_f32 v91,v118,v119
v_mfma_f32_16x16x32_bf16 v[56:59],v[44:47],v[84:87],v[56:59]
v_exp_f32 v120,v120
v_mfma_f32_16x16x32_bf16 v[96:99],a[128:131],a[0:3],v[64:67]
v_mfma_f32_16x16x32_bf16 v[96:99],a[132:135],a[4:7],v[96:99]
v_exp_f32 v121,v121
v_mfma_f32_16x16x32_bf16 v[96:99],a[136:139],a[8:11],v[96:99]
v_cvt_pk_bf16_f32 v92,v120,v121
v_mfma_f32_16x16x32_bf16 v[96:99],a[140:143],a[12:15],v[96:99]
v_exp_f32 v122,v122
v_mfma_f32_16x16x32_bf16 v[100:103],a[144:147],a[0:3],v[64:67]
v_mfma_f32_16x16x32_bf16 v[100:103],a[148:151],a[4:7],v[100:103]
v_exp_f32 v123,v123
v_mfma_f32_16x16x32_bf16 v[100:103],a[152:155],a[8:11],v[100:103]
v_cvt_pk_bf16_f32 v93,v122,v123
v_mfma_f32_16x16x32_bf16 v[100:103],a[156:159],a[12:15],v[100:103]
v_exp_f32 v124,v124
v_mfma_f32_16x16x32_bf16 v[104:107],a[160:163],a[0:3],v[64:67]
v_mfma_f32_16x16x32_bf16 v[104:107],a[164:167],a[4:7],v[104:107]
v_exp_f32 v125,v125
v_mfma_f32_16x16x32_bf16 v[104:107],a[168:171],a[8:11],v[104:107]
v_cvt_pk_bf16_f32 v94,v124,v125
v_mfma_f32_16x16x32_bf16 v[104:107],a[172:175],a[12:15],v[104:107]
buffer_load_dwordx4 v8,s[12:15],s48 offen offset:2048 nt lds
v_exp_f32 v126,v126
v_mfma_f32_16x16x32_bf16 v[108:111],a[176:179],a[0:3],v[64:67]
v_mfma_f32_16x16x32_bf16 v[108:111],a[180:183],a[4:7],v[108:111]
v_exp_f32 v127,v127
v_mfma_f32_16x16x32_bf16 v[108:111],a[184:187],a[8:11],v[108:111]
v_cvt_pk_bf16_f32 v95,v126,v127
v_mfma_f32_16x16x32_bf16 v[108:111],a[188:191],a[12:15],v[108:111]
v_mfma_f32_16x16x32_bf16 v[224:227],a[192:195],v[88:91],v[224:227]
v_mfma_f32_16x16x32_bf16 v[224:227],a[196:199],v[92:95],v[224:227]
v_exp_f32 v96,v96
v_mfma_f32_16x16x32_bf16 v[228:231],a[200:203],v[88:91],v[228:231]
ds_read_b64_tr_b16 a[192:193],v14 offset:16384
ds_read_b64_tr_b16 a[194:195],v14 offset:20480
v_mfma_f32_16x16x32_bf16 v[228:231],a[204:207],v[92:95],v[228:231]
v_exp_f32 v97,v97
v_mfma_f32_16x16x32_bf16 v[232:235],a[208:211],v[88:91],v[232:235]
ds_read_b64_tr_b16 a[196:197],v14 offset:24576
v_cvt_pk_bf16_f32 v80,v96,v97
v_mfma_f32_16x16x32_bf16 v[232:235],a[212:215],v[92:95],v[232:235]
v_exp_f32 v98,v98
v_mfma_f32_16x16x32_bf16 v[236:239],a[216:219],v[88:91],v[236:239]
ds_read_b64_tr_b16 a[198:199],v14 offset:28672
ds_read_b64_tr_b16 a[200:201],v15 offset:16384
v_mfma_f32_16x16x32_bf16 v[236:239],a[220:223],v[92:95],v[236:239]
v_exp_f32 v99,v99
v_mfma_f32_16x16x32_bf16 v[240:243],a[224:227],v[88:91],v[240:243]
ds_read_b64_tr_b16 a[202:203],v15 offset:20480
v_cvt_pk_bf16_f32 v81,v98,v99
v_mfma_f32_16x16x32_bf16 v[240:243],a[228:231],v[92:95],v[240:243]
v_exp_f32 v100,v100
v_mfma_f32_16x16x32_bf16 v[244:247],a[232:235],v[88:91],v[244:247]
ds_read_b64_tr_b16 a[204:205],v15 offset:24576
ds_read_b64_tr_b16 a[206:207],v15 offset:28672
v_mfma_f32_16x16x32_bf16 v[244:247],a[236:239],v[92:95],v[244:247]
v_exp_f32 v101,v101
v_mfma_f32_16x16x32_bf16 v[248:251],a[240:243],v[88:91],v[248:251]
ds_read_b64_tr_b16 a[208:209],v16 offset:16384
v_cvt_pk_bf16_f32 v82,v100,v101
v_mfma_f32_16x16x32_bf16 v[248:251],a[244:247],v[92:95],v[248:251]
buffer_load_dwordx4 v9,s[12:15],s48 offen offset:3072 nt lds
v_exp_f32 v102,v102
v_mfma_f32_16x16x32_bf16 v[252:255],a[248:251],v[88:91],v[252:255]
ds_read_b64_tr_b16 a[210:211],v16 offset:20480
ds_read_b64_tr_b16 a[212:213],v16 offset:24576
v_mfma_f32_16x16x32_bf16 v[252:255],a[252:255],v[92:95],v[252:255]
v_exp_f32 v103,v103
v_mfma_f32_16x16x32_bf16 v[60:63],v[44:47],v[88:91],v[60:63]
ds_read_b64_tr_b16 a[214:215],v16 offset:28672
v_cvt_pk_bf16_f32 v83,v102,v103
v_mfma_f32_16x16x32_bf16 v[60:63],v[44:47],v[92:95],v[60:63]
v_exp_f32 v104,v104
v_mfma_f32_16x16x32_bf16 v[112:115],a[128:131],a[16:19],v[68:71]
ds_read_b64_tr_b16 a[216:217],v17 offset:16384
ds_read_b64_tr_b16 a[218:219],v17 offset:20480
v_mfma_f32_16x16x32_bf16 v[112:115],a[132:135],a[20:23],v[112:115]
v_exp_f32 v105,v105
v_mfma_f32_16x16x32_bf16 v[112:115],a[136:139],a[24:27],v[112:115]
ds_read_b64_tr_b16 a[220:221],v17 offset:24576
v_cvt_pk_bf16_f32 v84,v104,v105
v_mfma_f32_16x16x32_bf16 v[112:115],a[140:143],a[28:31],v[112:115]
v_exp_f32 v106,v106
v_mfma_f32_16x16x32_bf16 v[116:119],a[144:147],a[16:19],v[68:71]
ds_read_b64_tr_b16 a[222:223],v17 offset:28672
ds_read_b64_tr_b16 a[224:225],v18 offset:16384
v_mfma_f32_16x16x32_bf16 v[116:119],a[148:151],a[20:23],v[116:119]
v_exp_f32 v107,v107
v_mfma_f32_16x16x32_bf16 v[116:119],a[152:155],a[24:27],v[116:119]
ds_read_b64_tr_b16 a[226:227],v18 offset:20480
v_cvt_pk_bf16_f32 v85,v106,v107
v_mfma_f32_16x16x32_bf16 v[116:119],a[156:159],a[28:31],v[116:119]
v_exp_f32 v108,v108
v_mfma_f32_16x16x32_bf16 v[120:123],a[160:163],a[16:19],v[68:71]
ds_read_b64_tr_b16 a[228:229],v18 offset:24576
ds_read_b64_tr_b16 a[230:231],v18 offset:28672
v_mfma_f32_16x16x32_bf16 v[120:123],a[164:167],a[20:23],v[120:123]
v_exp_f32 v109,v109
v_mfma_f32_16x16x32_bf16 v[120:123],a[168:171],a[24:27],v[120:123]
ds_read_b64_tr_b16 a[232:233],v19 offset:16384
v_cvt_pk_bf16_f32 v86,v108,v109
v_mfma_f32_16x16x32_bf16 v[120:123],a[172:175],a[28:31],v[120:123]
s_mov_b32 s48,245760
v_exp_f32 v110,v110
v_mfma_f32_16x16x32_bf16 v[124:127],a[176:179],a[16:19],v[68:71]
ds_read_b64_tr_b16 a[234:235],v19 offset:20480
ds_read_b64_tr_b16 a[236:237],v19 offset:24576
s_add_u32 m0,s39,49152
v_mfma_f32_16x16x32_bf16 v[124:127],a[180:183],a[20:23],v[124:127]
buffer_load_dwordx4 v4,s[8:11],s48 offen nt lds
v_exp_f32 v111,v111
v_mfma_f32_16x16x32_bf16 v[124:127],a[184:187],a[24:27],v[124:127]
ds_read_b64_tr_b16 a[238:239],v19 offset:28672
v_cvt_pk_bf16_f32 v87,v110,v111
v_mfma_f32_16x16x32_bf16 v[124:127],a[188:191],a[28:31],v[124:127]
ds_read_b64_tr_b16 a[240:241],v20 offset:16384
ds_read_b64_tr_b16 a[242:243],v20 offset:20480
v_mfma_f32_16x16x32_bf16 v[96:99],a[128:131],a[32:35],v[72:75]
ds_read_b64_tr_b16 a[244:245],v20 offset:24576
ds_read_b64_tr_b16 a[246:247],v20 offset:28672
v_mfma_f32_16x16x32_bf16 v[96:99],a[132:135],a[36:39],v[96:99]
v_exp_f32 v112,v112
v_mfma_f32_16x16x32_bf16 v[96:99],a[136:139],a[40:43],v[96:99]
ds_read_b64_tr_b16 a[248:249],v21 offset:16384
ds_read_b64_tr_b16 a[250:251],v21 offset:20480
v_mfma_f32_16x16x32_bf16 v[96:99],a[140:143],a[44:47],v[96:99]
v_exp_f32 v113,v113
v_mfma_f32_16x16x32_bf16 v[100:103],a[144:147],a[32:35],v[72:75]
ds_read_b64_tr_b16 a[252:253],v21 offset:24576
v_cvt_pk_bf16_f32 v88,v112,v113
v_mfma_f32_16x16x32_bf16 v[100:103],a[148:151],a[36:39],v[100:103]
v_exp_f32 v114,v114
v_mfma_f32_16x16x32_bf16 v[100:103],a[152:155],a[40:43],v[100:103]
ds_read_b64_tr_b16 a[254:255],v21 offset:28672
v_mfma_f32_16x16x32_bf16 v[100:103],a[156:159],a[44:47],v[100:103]
v_exp_f32 v115,v115
v_mfma_f32_16x16x32_bf16 v[104:107],a[160:163],a[32:35],v[72:75]
v_cvt_pk_bf16_f32 v89,v114,v115
v_mfma_f32_16x16x32_bf16 v[104:107],a[164:167],a[36:39],v[104:107]
v_exp_f32 v116,v116
v_mfma_f32_16x16x32_bf16 v[104:107],a[168:171],a[40:43],v[104:107]
v_mfma_f32_16x16x32_bf16 v[104:107],a[172:175],a[44:47],v[104:107]
v_exp_f32 v117,v117
v_mfma_f32_16x16x32_bf16 v[108:111],a[176:179],a[32:35],v[72:75]
buffer_load_dwordx4 v5,s[8:11],s48 offen offset:1024 nt lds
v_cvt_pk_bf16_f32 v90,v116,v117
v_mfma_f32_16x16x32_bf16 v[108:111],a[180:183],a[36:39],v[108:111]
v_exp_f32 v118,v118
v_mfma_f32_16x16x32_bf16 v[108:111],a[184:187],a[40:43],v[108:111]
s_waitcnt lgkmcnt(0)
v_mfma_f32_16x16x32_bf16 v[108:111],a[188:191],a[44:47],v[108:111]
v_exp_f32 v119,v119
v_mfma_f32_16x16x32_bf16 v[128:131],a[192:195],v[80:83],v[128:131]
v_cvt_pk_bf16_f32 v91,v118,v119
v_mfma_f32_16x16x32_bf16 v[128:131],a[196:199],v[84:87],v[128:131]
v_exp_f32 v120,v120
v_mfma_f32_16x16x32_bf16 v[132:135],a[200:203],v[80:83],v[132:135]
v_mfma_f32_16x16x32_bf16 v[132:135],a[204:207],v[84:87],v[132:135]
v_exp_f32 v121,v121
v_mfma_f32_16x16x32_bf16 v[136:139],a[208:211],v[80:83],v[136:139]
v_cvt_pk_bf16_f32 v92,v120,v121
v_mfma_f32_16x16x32_bf16 v[136:139],a[212:215],v[84:87],v[136:139]
v_exp_f32 v122,v122
v_mfma_f32_16x16x32_bf16 v[140:143],a[216:219],v[80:83],v[140:143]
v_mfma_f32_16x16x32_bf16 v[140:143],a[220:223],v[84:87],v[140:143]
v_exp_f32 v123,v123
v_mfma_f32_16x16x32_bf16 v[144:147],a[224:227],v[80:83],v[144:147]
v_cvt_pk_bf16_f32 v93,v122,v123
v_mfma_f32_16x16x32_bf16 v[144:147],a[228:231],v[84:87],v[144:147]
v_exp_f32 v124,v124
v_mfma_f32_16x16x32_bf16 v[148:151],a[232:235],v[80:83],v[148:151]
v_mfma_f32_16x16x32_bf16 v[148:151],a[236:239],v[84:87],v[148:151]
v_exp_f32 v125,v125
v_mfma_f32_16x16x32_bf16 v[152:155],a[240:243],v[80:83],v[152:155]
v_cvt_pk_bf16_f32 v94,v124,v125
v_mfma_f32_16x16x32_bf16 v[152:155],a[244:247],v[84:87],v[152:155]
buffer_load_dwordx4 v6,s[8:11],s48 offen offset:2048 nt lds
v_exp_f32 v126,v126
v_mfma_f32_16x16x32_bf16 v[156:159],a[248:251],v[80:83],v[156:159]
v_mfma_f32_16x16x32_bf16 v[156:159],a[252:255],v[84:87],v[156:159]
v_exp_f32 v127,v127
v_mfma_f32_16x16x32_bf16 v[48:51],v[44:47],v[80:83],v[48:51]
v_cvt_pk_bf16_f32 v95,v126,v127
v_mfma_f32_16x16x32_bf16 v[48:51],v[44:47],v[84:87],v[48:51]
s_waitcnt vmcnt(3)
s_barrier
v_mfma_f32_16x16x32_bf16 v[112:115],a[128:131],a[48:51],v[76:79]
v_mfma_f32_16x16x32_bf16 v[112:115],a[132:135],a[52:55],v[112:115]
v_exp_f32 v96,v96
v_mfma_f32_16x16x32_bf16 v[112:115],a[136:139],a[56:59],v[112:115]
v_mfma_f32_16x16x32_bf16 v[112:115],a[140:143],a[60:63],v[112:115]
v_exp_f32 v97,v97
v_mfma_f32_16x16x32_bf16 v[116:119],a[144:147],a[48:51],v[76:79]
ds_read_b128 a[128:131],v10 offset:32768
v_cvt_pk_bf16_f32 v80,v96,v97
v_mfma_f32_16x16x32_bf16 v[116:119],a[148:151],a[52:55],v[116:119]
v_exp_f32 v98,v98
v_mfma_f32_16x16x32_bf16 v[116:119],a[152:155],a[56:59],v[116:119]
ds_read_b128 a[132:135],v11 offset:32768
v_mfma_f32_16x16x32_bf16 v[116:119],a[156:159],a[60:63],v[116:119]
v_exp_f32 v99,v99
v_mfma_f32_16x16x32_bf16 v[120:123],a[160:163],a[48:51],v[76:79]
ds_read_b128 a[136:139],v12 offset:32768
v_cvt_pk_bf16_f32 v81,v98,v99
v_mfma_f32_16x16x32_bf16 v[120:123],a[164:167],a[52:55],v[120:123]
v_exp_f32 v100,v100
v_mfma_f32_16x16x32_bf16 v[120:123],a[168:171],a[56:59],v[120:123]
ds_read_b128 a[140:143],v13 offset:32768
v_mfma_f32_16x16x32_bf16 v[120:123],a[172:175],a[60:63],v[120:123]
v_exp_f32 v101,v101
v_mfma_f32_16x16x32_bf16 v[124:127],a[176:179],a[48:51],v[76:79]
ds_read_b128 a[144:147],v10 offset:36864
v_cvt_pk_bf16_f32 v82,v100,v101
v_mfma_f32_16x16x32_bf16 v[124:127],a[180:183],a[52:55],v[124:127]
buffer_load_dwordx4 v7,s[8:11],s48 offen offset:3072 nt lds
v_exp_f32 v102,v102
v_mfma_f32_16x16x32_bf16 v[124:127],a[184:187],a[56:59],v[124:127]
ds_read_b128 a[148:151],v11 offset:36864
v_mfma_f32_16x16x32_bf16 v[124:127],a[188:191],a[60:63],v[124:127]
v_exp_f32 v103,v103
v_mfma_f32_16x16x32_bf16 v[160:163],a[192:195],v[88:91],v[160:163]
ds_read_b128 a[152:155],v12 offset:36864
v_cvt_pk_bf16_f32 v83,v102,v103
v_mfma_f32_16x16x32_bf16 v[160:163],a[196:199],v[92:95],v[160:163]
v_exp_f32 v104,v104
v_mfma_f32_16x16x32_bf16 v[164:167],a[200:203],v[88:91],v[164:167]
ds_read_b128 a[156:159],v13 offset:36864
v_mfma_f32_16x16x32_bf16 v[164:167],a[204:207],v[92:95],v[164:167]
v_exp_f32 v105,v105
v_mfma_f32_16x16x32_bf16 v[168:171],a[208:211],v[88:91],v[168:171]
ds_read_b128 a[160:163],v10 offset:40960
v_cvt_pk_bf16_f32 v84,v104,v105
v_mfma_f32_16x16x32_bf16 v[168:171],a[212:215],v[92:95],v[168:171]
v_exp_f32 v106,v106
v_mfma_f32_16x16x32_bf16 v[172:175],a[216:219],v[88:91],v[172:175]
ds_read_b128 a[164:167],v11 offset:40960
v_mfma_f32_16x16x32_bf16 v[172:175],a[220:223],v[92:95],v[172:175]
v_exp_f32 v107,v107
v_mfma_f32_16x16x32_bf16 v[176:179],a[224:227],v[88:91],v[176:179]
ds_read_b128 a[168:171],v12 offset:40960
v_cvt_pk_bf16_f32 v85,v106,v107
v_mfma_f32_16x16x32_bf16 v[176:179],a[228:231],v[92:95],v[176:179]
v_exp_f32 v108,v108
v_mfma_f32_16x16x32_bf16 v[180:183],a[232:235],v[88:91],v[180:183]
ds_read_b128 a[172:175],v13 offset:40960
v_mfma_f32_16x16x32_bf16 v[180:183],a[236:239],v[92:95],v[180:183]
v_exp_f32 v109,v109
v_mfma_f32_16x16x32_bf16 v[184:187],a[240:243],v[88:91],v[184:187]
ds_read_b128 a[176:179],v10 offset:45056
v_cvt_pk_bf16_f32 v86,v108,v109
v_mfma_f32_16x16x32_bf16 v[184:187],a[244:247],v[92:95],v[184:187]
s_add_u32 m0,s39,114688
v_exp_f32 v110,v110
v_mfma_f32_16x16x32_bf16 v[188:191],a[248:251],v[88:91],v[188:191]
ds_read_b128 a[180:183],v11 offset:45056
v_mfma_f32_16x16x32_bf16 v[188:191],a[252:255],v[92:95],v[188:191]
buffer_load_dwordx4 v8,s[12:15],s48 offen nt lds
v_exp_f32 v111,v111
v_mfma_f32_16x16x32_bf16 v[52:55],v[44:47],v[88:91],v[52:55]
ds_read_b128 a[184:187],v12 offset:45056
v_cvt_pk_bf16_f32 v87,v110,v111
v_mfma_f32_16x16x32_bf16 v[52:55],v[44:47],v[92:95],v[52:55]
ds_read_b128 a[188:191],v13 offset:45056
v_mfma_f32_16x16x32_bf16 v[192:195],a[192:195],v[80:83],v[192:195]
v_mfma_f32_16x16x32_bf16 v[192:195],a[196:199],v[84:87],v[192:195]
v_exp_f32 v112,v112
v_mfma_f32_16x16x32_bf16 v[196:199],a[200:203],v[80:83],v[196:199]
v_mfma_f32_16x16x32_bf16 v[196:199],a[204:207],v[84:87],v[196:199]
v_exp_f32 v113,v113
v_mfma_f32_16x16x32_bf16 v[200:203],a[208:211],v[80:83],v[200:203]
v_cvt_pk_bf16_f32 v88,v112,v113
v_mfma_f32_16x16x32_bf16 v[200:203],a[212:215],v[84:87],v[200:203]
v_exp_f32 v114,v114
v_mfma_f32_16x16x32_bf16 v[204:207],a[216:219],v[80:83],v[204:207]
v_mfma_f32_16x16x32_bf16 v[204:207],a[220:223],v[84:87],v[204:207]
v_exp_f32 v115,v115
v_mfma_f32_16x16x32_bf16 v[208:211],a[224:227],v[80:83],v[208:211]
v_cvt_pk_bf16_f32 v89,v114,v115
v_mfma_f32_16x16x32_bf16 v[208:211],a[228:231],v[84:87],v[208:211]
v_exp_f32 v116,v116
v_mfma_f32_16x16x32_bf16 v[212:215],a[232:235],v[80:83],v[212:215]
v_mfma_f32_16x16x32_bf16 v[212:215],a[236:239],v[84:87],v[212:215]
v_exp_f32 v117,v117
v_mfma_f32_16x16x32_bf16 v[216:219],a[240:243],v[80:83],v[216:219]
buffer_load_dwordx4 v9,s[12:15],s48 offen offset:1024 nt lds
v_cvt_pk_bf16_f32 v90,v116,v117
v_mfma_f32_16x16x32_bf16 v[216:219],a[244:247],v[84:87],v[216:219]
v_exp_f32 v118,v118
v_mfma_f32_16x16x32_bf16 v[220:223],a[248:251],v[80:83],v[220:223]
s_waitcnt lgkmcnt(0)
v_mfma_f32_16x16x32_bf16 v[220:223],a[252:255],v[84:87],v[220:223]
v_exp_f32 v119,v119
v_mfma_f32_16x16x32_bf16 v[56:59],v[44:47],v[80:83],v[56:59]
v_cvt_pk_bf16_f32 v91,v118,v119
v_mfma_f32_16x16x32_bf16 v[56:59],v[44:47],v[84:87],v[56:59]
v_exp_f32 v120,v120
v_mfma_f32_16x16x32_bf16 v[96:99],a[128:131],a[0:3],v[64:67]
v_mfma_f32_16x16x32_bf16 v[96:99],a[132:135],a[4:7],v[96:99]
v_exp_f32 v121,v121
v_mfma_f32_16x16x32_bf16 v[96:99],a[136:139],a[8:11],v[96:99]
v_cvt_pk_bf16_f32 v92,v120,v121
v_mfma_f32_16x16x32_bf16 v[96:99],a[140:143],a[12:15],v[96:99]
v_exp_f32 v122,v122
v_mfma_f32_16x16x32_bf16 v[100:103],a[144:147],a[0:3],v[64:67]
v_mfma_f32_16x16x32_bf16 v[100:103],a[148:151],a[4:7],v[100:103]
v_exp_f32 v123,v123
v_mfma_f32_16x16x32_bf16 v[100:103],a[152:155],a[8:11],v[100:103]
v_cvt_pk_bf16_f32 v93,v122,v123
v_mfma_f32_16x16x32_bf16 v[100:103],a[156:159],a[12:15],v[100:103]
v_exp_f32 v124,v124
v_mfma_f32_16x16x32_bf16 v[104:107],a[160:163],a[0:3],v[64:67]
v_mfma_f32_16x16x32_bf16 v[104:107],a[164:167],a[4:7],v[104:107]
v_exp_f32 v125,v125
v_mfma_f32_16x16x32_bf16 v[104:107],a[168:171],a[8:11],v[104:107]
v_cvt_pk_bf16_f32 v94,v124,v125
v_mfma_f32_16x16x32_bf16 v[104:107],a[172:175],a[12:15],v[104:107]
buffer_load_dwordx4 v8,s[12:15],s48 offen offset:2048 nt lds
v_exp_f32 v126,v126
v_mfma_f32_16x16x32_bf16 v[108:111],a[176:179],a[0:3],v[64:67]
v_mfma_f32_16x16x32_bf16 v[108:111],a[180:183],a[4:7],v[108:111]
v_exp_f32 v127,v127
v_mfma_f32_16x16x32_bf16 v[108:111],a[184:187],a[8:11],v[108:111]
v_cvt_pk_bf16_f32 v95,v126,v127
v_mfma_f32_16x16x32_bf16 v[108:111],a[188:191],a[12:15],v[108:111]
v_mfma_f32_16x16x32_bf16 v[224:227],a[192:195],v[88:91],v[224:227]
v_mfma_f32_16x16x32_bf16 v[224:227],a[196:199],v[92:95],v[224:227]
v_exp_f32 v96,v96
v_mfma_f32_16x16x32_bf16 v[228:231],a[200:203],v[88:91],v[228:231]
ds_read_b64_tr_b16 a[192:193],v14 offset:32768
ds_read_b64_tr_b16 a[194:195],v14 offset:36864
v_mfma_f32_16x16x32_bf16 v[228:231],a[204:207],v[92:95],v[228:231]
v_exp_f32 v97,v97
v_mfma_f32_16x16x32_bf16 v[232:235],a[208:211],v[88:91],v[232:235]
ds_read_b64_tr_b16 a[196:197],v14 offset:40960
v_cvt_pk_bf16_f32 v80,v96,v97
v_mfma_f32_16x16x32_bf16 v[232:235],a[212:215],v[92:95],v[232:235]
v_exp_f32 v98,v98
v_mfma_f32_16x16x32_bf16 v[236:239],a[216:219],v[88:91],v[236:239]
ds_read_b64_tr_b16 a[198:199],v14 offset:45056
ds_read_b64_tr_b16 a[200:201],v15 offset:32768
v_mfma_f32_16x16x32_bf16 v[236:239],a[220:223],v[92:95],v[236:239]
v_exp_f32 v99,v99
v_mfma_f32_16x16x32_bf16 v[240:243],a[224:227],v[88:91],v[240:243]
ds_read_b64_tr_b16 a[202:203],v15 offset:36864
v_cvt_pk_bf16_f32 v81,v98,v99
v_mfma_f32_16x16x32_bf16 v[240:243],a[228:231],v[92:95],v[240:243]
v_exp_f32 v100,v100
v_mfma_f32_16x16x32_bf16 v[244:247],a[232:235],v[88:91],v[244:247]
ds_read_b64_tr_b16 a[204:205],v15 offset:40960
ds_read_b64_tr_b16 a[206:207],v15 offset:45056
v_mfma_f32_16x16x32_bf16 v[244:247],a[236:239],v[92:95],v[244:247]
v_exp_f32 v101,v101
v_mfma_f32_16x16x32_bf16 v[248:251],a[240:243],v[88:91],v[248:251]
ds_read_b64_tr_b16 a[208:209],v16 offset:32768
v_cvt_pk_bf16_f32 v82,v100,v101
v_mfma_f32_16x16x32_bf16 v[248:251],a[244:247],v[92:95],v[248:251]
buffer_load_dwordx4 v9,s[12:15],s48 offen offset:3072 nt lds
v_exp_f32 v102,v102
v_mfma_f32_16x16x32_bf16 v[252:255],a[248:251],v[88:91],v[252:255]
ds_read_b64_tr_b16 a[210:211],v16 offset:36864
ds_read_b64_tr_b16 a[212:213],v16 offset:40960
v_mfma_f32_16x16x32_bf16 v[252:255],a[252:255],v[92:95],v[252:255]
v_exp_f32 v103,v103
v_mfma_f32_16x16x32_bf16 v[60:63],v[44:47],v[88:91],v[60:63]
ds_read_b64_tr_b16 a[214:215],v16 offset:45056
v_cvt_pk_bf16_f32 v83,v102,v103
v_mfma_f32_16x16x32_bf16 v[60:63],v[44:47],v[92:95],v[60:63]
v_exp_f32 v104,v104
v_mfma_f32_16x16x32_bf16 v[112:115],a[128:131],a[16:19],v[68:71]
ds_read_b64_tr_b16 a[216:217],v17 offset:32768
ds_read_b64_tr_b16 a[218:219],v17 offset:36864
v_mfma_f32_16x16x32_bf16 v[112:115],a[132:135],a[20:23],v[112:115]
v_exp_f32 v105,v105
v_mfma_f32_16x16x32_bf16 v[112:115],a[136:139],a[24:27],v[112:115]
ds_read_b64_tr_b16 a[220:221],v17 offset:40960
v_cvt_pk_bf16_f32 v84,v104,v105
v_mfma_f32_16x16x32_bf16 v[112:115],a[140:143],a[28:31],v[112:115]
v_exp_f32 v106,v106
v_mfma_f32_16x16x32_bf16 v[116:119],a[144:147],a[16:19],v[68:71]
ds_read_b64_tr_b16 a[222:223],v17 offset:45056
ds_read_b64_tr_b16 a[224:225],v18 offset:32768
v_mfma_f32_16x16x32_bf16 v[116:119],a[148:151],a[20:23],v[116:119]
v_exp_f32 v107,v107
v_mfma_f32_16x16x32_bf16 v[116:119],a[152:155],a[24:27],v[116:119]
ds_read_b64_tr_b16 a[226:227],v18 offset:36864
v_cvt_pk_bf16_f32 v85,v106,v107
v_mfma_f32_16x16x32_bf16 v[116:119],a[156:159],a[28:31],v[116:119]
v_exp_f32 v108,v108
v_mfma_f32_16x16x32_bf16 v[120:123],a[160:163],a[16:19],v[68:71]
ds_read_b64_tr_b16 a[228:229],v18 offset:40960
ds_read_b64_tr_b16 a[230:231],v18 offset:45056
v_mfma_f32_16x16x32_bf16 v[120:123],a[164:167],a[20:23],v[120:123]
v_exp_f32 v109,v109
v_mfma_f32_16x16x32_bf16 v[120:123],a[168:171],a[24:27],v[120:123]
ds_read_b64_tr_b16 a[232:233],v19 offset:32768
v_cvt_pk_bf16_f32 v86,v108,v109
v_mfma_f32_16x16x32_bf16 v[120:123],a[172:175],a[28:31],v[120:123]
s_mov_b32 s48,262144
v_exp_f32 v110,v110
v_mfma_f32_16x16x32_bf16 v[124:127],a[176:179],a[16:19],v[68:71]
ds_read_b64_tr_b16 a[234:235],v19 offset:36864
ds_read_b64_tr_b16 a[236:237],v19 offset:40960
s_add_u32 m0,s39,0
v_mfma_f32_16x16x32_bf16 v[124:127],a[180:183],a[20:23],v[124:127]
buffer_load_dwordx4 v4,s[8:11],s48 offen nt lds
v_exp_f32 v111,v111
v_mfma_f32_16x16x32_bf16 v[124:127],a[184:187],a[24:27],v[124:127]
ds_read_b64_tr_b16 a[238:239],v19 offset:45056
v_cvt_pk_bf16_f32 v87,v110,v111
v_mfma_f32_16x16x32_bf16 v[124:127],a[188:191],a[28:31],v[124:127]
ds_read_b64_tr_b16 a[240:241],v20 offset:32768
ds_read_b64_tr_b16 a[242:243],v20 offset:36864
v_mfma_f32_16x16x32_bf16 v[96:99],a[128:131],a[32:35],v[72:75]
ds_read_b64_tr_b16 a[244:245],v20 offset:40960
ds_read_b64_tr_b16 a[246:247],v20 offset:45056
v_mfma_f32_16x16x32_bf16 v[96:99],a[132:135],a[36:39],v[96:99]
v_exp_f32 v112,v112
v_mfma_f32_16x16x32_bf16 v[96:99],a[136:139],a[40:43],v[96:99]
ds_read_b64_tr_b16 a[248:249],v21 offset:32768
ds_read_b64_tr_b16 a[250:251],v21 offset:36864
v_mfma_f32_16x16x32_bf16 v[96:99],a[140:143],a[44:47],v[96:99]
v_exp_f32 v113,v113
v_mfma_f32_16x16x32_bf16 v[100:103],a[144:147],a[32:35],v[72:75]
ds_read_b64_tr_b16 a[252:253],v21 offset:40960
v_cvt_pk_bf16_f32 v88,v112,v113
v_mfma_f32_16x16x32_bf16 v[100:103],a[148:151],a[36:39],v[100:103]
v_exp_f32 v114,v114
v_mfma_f32_16x16x32_bf16 v[100:103],a[152:155],a[40:43],v[100:103]
ds_read_b64_tr_b16 a[254:255],v21 offset:45056
v_mfma_f32_16x16x32_bf16 v[100:103],a[156:159],a[44:47],v[100:103]
v_exp_f32 v115,v115
v_mfma_f32_16x16x32_bf16 v[104:107],a[160:163],a[32:35],v[72:75]
v_cvt_pk_bf16_f32 v89,v114,v115
v_mfma_f32_16x16x32_bf16 v[104:107],a[164:167],a[36:39],v[104:107]
v_exp_f32 v116,v116
v_mfma_f32_16x16x32_bf16 v[104:107],a[168:171],a[40:43],v[104:107]
v_mfma_f32_16x16x32_bf16 v[104:107],a[172:175],a[44:47],v[104:107]
v_exp_f32 v117,v117
v_mfma_f32_16x16x32_bf16 v[108:111],a[176:179],a[32:35],v[72:75]
buffer_load_dwordx4 v5,s[8:11],s48 offen offset:1024 nt lds
v_cvt_pk_bf16_f32 v90,v116,v117
v_mfma_f32_16x16x32_bf16 v[108:111],a[180:183],a[36:39],v[108:111]
v_exp_f32 v118,v118
v_mfma_f32_16x16x32_bf16 v[108:111],a[184:187],a[40:43],v[108:111]
s_waitcnt lgkmcnt(0)
v_mfma_f32_16x16x32_bf16 v[108:111],a[188:191],a[44:47],v[108:111]
v_exp_f32 v119,v119
v_mfma_f32_16x16x32_bf16 v[128:131],a[192:195],v[80:83],v[128:131]
v_cvt_pk_bf16_f32 v91,v118,v119
v_mfma_f32_16x16x32_bf16 v[128:131],a[196:199],v[84:87],v[128:131]
v_exp_f32 v120,v120
v_mfma_f32_16x16x32_bf16 v[132:135],a[200:203],v[80:83],v[132:135]
v_mfma_f32_16x16x32_bf16 v[132:135],a[204:207],v[84:87],v[132:135]
v_exp_f32 v121,v121
v_mfma_f32_16x16x32_bf16 v[136:139],a[208:211],v[80:83],v[136:139]
v_cvt_pk_bf16_f32 v92,v120,v121
v_mfma_f32_16x16x32_bf16 v[136:139],a[212:215],v[84:87],v[136:139]
v_exp_f32 v122,v122
v_mfma_f32_16x16x32_bf16 v[140:143],a[216:219],v[80:83],v[140:143]
v_mfma_f32_16x16x32_bf16 v[140:143],a[220:223],v[84:87],v[140:143]
v_exp_f32 v123,v123
v_mfma_f32_16x16x32_bf16 v[144:147],a[224:227],v[80:83],v[144:147]
v_cvt_pk_bf16_f32 v93,v122,v123
v_mfma_f32_16x16x32_bf16 v[144:147],a[228:231],v[84:87],v[144:147]
v_exp_f32 v124,v124
v_mfma_f32_16x16x32_bf16 v[148:151],a[232:235],v[80:83],v[148:151]
v_mfma_f32_16x16x32_bf16 v[148:151],a[236:239],v[84:87],v[148:151]
v_exp_f32 v125,v125
v_mfma_f32_16x16x32_bf16 v[152:155],a[240:243],v[80:83],v[152:155]
v_cvt_pk_bf16_f32 v94,v124,v125
v_mfma_f32_16x16x32_bf16 v[152:155],a[244:247],v[84:87],v[152:155]
buffer_load_dwordx4 v6,s[8:11],s48 offen offset:2048 nt lds
v_exp_f32 v126,v126
v_mfma_f32_16x16x32_bf16 v[156:159],a[248:251],v[80:83],v[156:159]
v_mfma_f32_16x16x32_bf16 v[156:159],a[252:255],v[84:87],v[156:159]
v_exp_f32 v127,v127
v_mfma_f32_16x16x32_bf16 v[48:51],v[44:47],v[80:83],v[48:51]
v_cvt_pk_bf16_f32 v95,v126,v127
v_mfma_f32_16x16x32_bf16 v[48:51],v[44:47],v[84:87],v[48:51]
s_waitcnt vmcnt(3)
s_barrier
v_mfma_f32_16x16x32_bf16 v[112:115],a[128:131],a[48:51],v[76:79]
v_mfma_f32_16x16x32_bf16 v[112:115],a[132:135],a[52:55],v[112:115]
v_exp_f32 v96,v96
v_mfma_f32_16x16x32_bf16 v[112:115],a[136:139],a[56:59],v[112:115]
v_mfma_f32_16x16x32_bf16 v[112:115],a[140:143],a[60:63],v[112:115]
v_exp_f32 v97,v97
v_mfma_f32_16x16x32_bf16 v[116:119],a[144:147],a[48:51],v[76:79]
ds_read_b128 a[128:131],v10 offset:49152
v_cvt_pk_bf16_f32 v80,v96,v97
v_mfma_f32_16x16x32_bf16 v[116:119],a[148:151],a[52:55],v[116:119]
v_exp_f32 v98,v98
v_mfma_f32_16x16x32_bf16 v[116:119],a[152:155],a[56:59],v[116:119]
ds_read_b128 a[132:135],v11 offset:49152
v_mfma_f32_16x16x32_bf16 v[116:119],a[156:159],a[60:63],v[116:119]
v_exp_f32 v99,v99
v_mfma_f32_16x16x32_bf16 v[120:123],a[160:163],a[48:51],v[76:79]
ds_read_b128 a[136:139],v12 offset:49152
v_cvt_pk_bf16_f32 v81,v98,v99
v_mfma_f32_16x16x32_bf16 v[120:123],a[164:167],a[52:55],v[120:123]
v_exp_f32 v100,v100
v_mfma_f32_16x16x32_bf16 v[120:123],a[168:171],a[56:59],v[120:123]
ds_read_b128 a[140:143],v13 offset:49152
v_mfma_f32_16x16x32_bf16 v[120:123],a[172:175],a[60:63],v[120:123]
v_exp_f32 v101,v101
v_mfma_f32_16x16x32_bf16 v[124:127],a[176:179],a[48:51],v[76:79]
ds_read_b128 a[144:147],v10 offset:53248
v_cvt_pk_bf16_f32 v82,v100,v101
v_mfma_f32_16x16x32_bf16 v[124:127],a[180:183],a[52:55],v[124:127]
buffer_load_dwordx4 v7,s[8:11],s48 offen offset:3072 nt lds
v_exp_f32 v102,v102
v_mfma_f32_16x16x32_bf16 v[124:127],a[184:187],a[56:59],v[124:127]
ds_read_b128 a[148:151],v11 offset:53248
v_mfma_f32_16x16x32_bf16 v[124:127],a[188:191],a[60:63],v[124:127]
v_exp_f32 v103,v103
v_mfma_f32_16x16x32_bf16 v[160:163],a[192:195],v[88:91],v[160:163]
ds_read_b128 a[152:155],v12 offset:53248
v_cvt_pk_bf16_f32 v83,v102,v103
v_mfma_f32_16x16x32_bf16 v[160:163],a[196:199],v[92:95],v[160:163]
v_exp_f32 v104,v104
v_mfma_f32_16x16x32_bf16 v[164:167],a[200:203],v[88:91],v[164:167]
ds_read_b128 a[156:159],v13 offset:53248
v_mfma_f32_16x16x32_bf16 v[164:167],a[204:207],v[92:95],v[164:167]
v_exp_f32 v105,v105
v_mfma_f32_16x16x32_bf16 v[168:171],a[208:211],v[88:91],v[168:171]
ds_read_b128 a[160:163],v10 offset:57344
v_cvt_pk_bf16_f32 v84,v104,v105
v_mfma_f32_16x16x32_bf16 v[168:171],a[212:215],v[92:95],v[168:171]
v_exp_f32 v106,v106
v_mfma_f32_16x16x32_bf16 v[172:175],a[216:219],v[88:91],v[172:175]
ds_read_b128 a[164:167],v11 offset:57344
v_mfma_f32_16x16x32_bf16 v[172:175],a[220:223],v[92:95],v[172:175]
v_exp_f32 v107,v107
v_mfma_f32_16x16x32_bf16 v[176:179],a[224:227],v[88:91],v[176:179]
ds_read_b128 a[168:171],v12 offset:57344
v_cvt_pk_bf16_f32 v85,v106,v107
v_mfma_f32_16x16x32_bf16 v[176:179],a[228:231],v[92:95],v[176:179]
v_exp_f32 v108,v108
v_mfma_f32_16x16x32_bf16 v[180:183],a[232:235],v[88:91],v[180:183]
ds_read_b128 a[172:175],v13 offset:57344
v_mfma_f32_16x16x32_bf16 v[180:183],a[236:239],v[92:95],v[180:183]
v_exp_f32 v109,v109
v_mfma_f32_16x16x32_bf16 v[184:187],a[240:243],v[88:91],v[184:187]
ds_read_b128 a[176:179],v10 offset:61440
v_cvt_pk_bf16_f32 v86,v108,v109
v_mfma_f32_16x16x32_bf16 v[184:187],a[244:247],v[92:95],v[184:187]
s_add_u32 m0,s39,65536
v_exp_f32 v110,v110
v_mfma_f32_16x16x32_bf16 v[188:191],a[248:251],v[88:91],v[188:191]
ds_read_b128 a[180:183],v11 offset:61440
v_mfma_f32_16x16x32_bf16 v[188:191],a[252:255],v[92:95],v[188:191]
buffer_load_dwordx4 v8,s[12:15],s48 offen nt lds
v_exp_f32 v111,v111
v_mfma_f32_16x16x32_bf16 v[52:55],v[44:47],v[88:91],v[52:55]
ds_read_b128 a[184:187],v12 offset:61440
v_cvt_pk_bf16_f32 v87,v110,v111
v_mfma_f32_16x16x32_bf16 v[52:55],v[44:47],v[92:95],v[52:55]
ds_read_b128 a[188:191],v13 offset:61440
v_mfma_f32_16x16x32_bf16 v[192:195],a[192:195],v[80:83],v[192:195]
v_mfma_f32_16x16x32_bf16 v[192:195],a[196:199],v[84:87],v[192:195]
v_exp_f32 v112,v112
v_mfma_f32_16x16x32_bf16 v[196:199],a[200:203],v[80:83],v[196:199]
v_mfma_f32_16x16x32_bf16 v[196:199],a[204:207],v[84:87],v[196:199]
v_exp_f32 v113,v113
v_mfma_f32_16x16x32_bf16 v[200:203],a[208:211],v[80:83],v[200:203]
v_cvt_pk_bf16_f32 v88,v112,v113
v_mfma_f32_16x16x32_bf16 v[200:203],a[212:215],v[84:87],v[200:203]
v_exp_f32 v114,v114
v_mfma_f32_16x16x32_bf16 v[204:207],a[216:219],v[80:83],v[204:207]
v_mfma_f32_16x16x32_bf16 v[204:207],a[220:223],v[84:87],v[204:207]
v_exp_f32 v115,v115
v_mfma_f32_16x16x32_bf16 v[208:211],a[224:227],v[80:83],v[208:211]
v_cvt_pk_bf16_f32 v89,v114,v115
v_mfma_f32_16x16x32_bf16 v[208:211],a[228:231],v[84:87],v[208:211]
v_exp_f32 v116,v116
v_mfma_f32_16x16x32_bf16 v[212:215],a[232:235],v[80:83],v[212:215]
v_mfma_f32_16x16x32_bf16 v[212:215],a[236:239],v[84:87],v[212:215]
v_exp_f32 v117,v117
v_mfma_f32_16x16x32_bf16 v[216:219],a[240:243],v[80:83],v[216:219]
buffer_load_dwordx4 v9,s[12:15],s48 offen offset:1024 nt lds
v_cvt_pk_bf16_f32 v90,v116,v117
v_mfma_f32_16x16x32_bf16 v[216:219],a[244:247],v[84:87],v[216:219]
v_exp_f32 v118,v118
v_mfma_f32_16x16x32_bf16 v[220:223],a[248:251],v[80:83],v[220:223]
s_waitcnt lgkmcnt(0)
v_mfma_f32_16x16x32_bf16 v[220:223],a[252:255],v[84:87],v[220:223]
v_exp_f32 v119,v119
v_mfma_f32_16x16x32_bf16 v[56:59],v[44:47],v[80:83],v[56:59]
v_cvt_pk_bf16_f32 v91,v118,v119
v_mfma_f32_16x16x32_bf16 v[56:59],v[44:47],v[84:87],v[56:59]
v_exp_f32 v120,v120
v_mfma_f32_16x16x32_bf16 v[96:99],a[128:131],a[0:3],v[64:67]
v_mfma_f32_16x16x32_bf16 v[96:99],a[132:135],a[4:7],v[96:99]
v_exp_f32 v121,v121
v_mfma_f32_16x16x32_bf16 v[96:99],a[136:139],a[8:11],v[96:99]
v_cvt_pk_bf16_f32 v92,v120,v121
v_mfma_f32_16x16x32_bf16 v[96:99],a[140:143],a[12:15],v[96:99]
v_exp_f32 v122,v122
v_mfma_f32_16x16x32_bf16 v[100:103],a[144:147],a[0:3],v[64:67]
v_mfma_f32_16x16x32_bf16 v[100:103],a[148:151],a[4:7],v[100:103]
v_exp_f32 v123,v123
v_mfma_f32_16x16x32_bf16 v[100:103],a[152:155],a[8:11],v[100:103]
v_cvt_pk_bf16_f32 v93,v122,v123
v_mfma_f32_16x16x32_bf16 v[100:103],a[156:159],a[12:15],v[100:103]
v_exp_f32 v124,v124
v_mfma_f32_16x16x32_bf16 v[104:107],a[160:163],a[0:3],v[64:67]
v_mfma_f32_16x16x32_bf16 v[104:107],a[164:167],a[4:7],v[104:107]
v_exp_f32 v125,v125
v_mfma_f32_16x16x32_bf16 v[104:107],a[168:171],a[8:11],v[104:107]
v_cvt_pk_bf16_f32 v94,v124,v125
v_mfma_f32_16x16x32_bf16 v[104:107],a[172:175],a[12:15],v[104:107]
buffer_load_dwordx4 v8,s[12:15],s48 offen offset:2048 nt lds
v_exp_f32 v126,v126
v_mfma_f32_16x16x32_bf16 v[108:111],a[176:179],a[0:3],v[64:67]
v_mfma_f32_16x16x32_bf16 v[108:111],a[180:183],a[4:7],v[108:111]
v_exp_f32 v127,v127
v_mfma_f32_16x16x32_bf16 v[108:111],a[184:187],a[8:11],v[108:111]
v_cvt_pk_bf16_f32 v95,v126,v127
v_mfma_f32_16x16x32_bf16 v[108:111],a[188:191],a[12:15],v[108:111]
v_mfma_f32_16x16x32_bf16 v[224:227],a[192:195],v[88:91],v[224:227]
v_mfma_f32_16x16x32_bf16 v[224:227],a[196:199],v[92:95],v[224:227]
v_exp_f32 v96,v96
v_mfma_f32_16x16x32_bf16 v[228:231],a[200:203],v[88:91],v[228:231]
ds_read_b64_tr_b16 a[192:193],v14 offset:49152
ds_read_b64_tr_b16 a[194:195],v14 offset:53248
v_mfma_f32_16x16x32_bf16 v[228:231],a[204:207],v[92:95],v[228:231]
v_exp_f32 v97,v97
v_mfma_f32_16x16x32_bf16 v[232:235],a[208:211],v[88:91],v[232:235]
ds_read_b64_tr_b16 a[196:197],v14 offset:57344
v_cvt_pk_bf16_f32 v80,v96,v97
v_mfma_f32_16x16x32_bf16 v[232:235],a[212:215],v[92:95],v[232:235]
v_exp_f32 v98,v98
v_mfma_f32_16x16x32_bf16 v[236:239],a[216:219],v[88:91],v[236:239]
ds_read_b64_tr_b16 a[198:199],v14 offset:61440
ds_read_b64_tr_b16 a[200:201],v15 offset:49152
v_mfma_f32_16x16x32_bf16 v[236:239],a[220:223],v[92:95],v[236:239]
v_exp_f32 v99,v99
v_mfma_f32_16x16x32_bf16 v[240:243],a[224:227],v[88:91],v[240:243]
ds_read_b64_tr_b16 a[202:203],v15 offset:53248
v_cvt_pk_bf16_f32 v81,v98,v99
v_mfma_f32_16x16x32_bf16 v[240:243],a[228:231],v[92:95],v[240:243]
v_exp_f32 v100,v100
v_mfma_f32_16x16x32_bf16 v[244:247],a[232:235],v[88:91],v[244:247]
ds_read_b64_tr_b16 a[204:205],v15 offset:57344
ds_read_b64_tr_b16 a[206:207],v15 offset:61440
v_mfma_f32_16x16x32_bf16 v[244:247],a[236:239],v[92:95],v[244:247]
v_exp_f32 v101,v101
v_mfma_f32_16x16x32_bf16 v[248:251],a[240:243],v[88:91],v[248:251]
ds_read_b64_tr_b16 a[208:209],v16 offset:49152
v_cvt_pk_bf16_f32 v82,v100,v101
v_mfma_f32_16x16x32_bf16 v[248:251],a[244:247],v[92:95],v[248:251]
buffer_load_dwordx4 v9,s[12:15],s48 offen offset:3072 nt lds
v_exp_f32 v102,v102
v_mfma_f32_16x16x32_bf16 v[252:255],a[248:251],v[88:91],v[252:255]
ds_read_b64_tr_b16 a[210:211],v16 offset:53248
ds_read_b64_tr_b16 a[212:213],v16 offset:57344
v_mfma_f32_16x16x32_bf16 v[252:255],a[252:255],v[92:95],v[252:255]
v_exp_f32 v103,v103
v_mfma_f32_16x16x32_bf16 v[60:63],v[44:47],v[88:91],v[60:63]
ds_read_b64_tr_b16 a[214:215],v16 offset:61440
v_cvt_pk_bf16_f32 v83,v102,v103
v_mfma_f32_16x16x32_bf16 v[60:63],v[44:47],v[92:95],v[60:63]
v_exp_f32 v104,v104
v_mfma_f32_16x16x32_bf16 v[112:115],a[128:131],a[16:19],v[68:71]
ds_read_b64_tr_b16 a[216:217],v17 offset:49152
ds_read_b64_tr_b16 a[218:219],v17 offset:53248
v_mfma_f32_16x16x32_bf16 v[112:115],a[132:135],a[20:23],v[112:115]
v_exp_f32 v105,v105
v_mfma_f32_16x16x32_bf16 v[112:115],a[136:139],a[24:27],v[112:115]
ds_read_b64_tr_b16 a[220:221],v17 offset:57344
v_cvt_pk_bf16_f32 v84,v104,v105
v_mfma_f32_16x16x32_bf16 v[112:115],a[140:143],a[28:31],v[112:115]
v_exp_f32 v106,v106
v_mfma_f32_16x16x32_bf16 v[116:119],a[144:147],a[16:19],v[68:71]
ds_read_b64_tr_b16 a[222:223],v17 offset:61440
ds_read_b64_tr_b16 a[224:225],v18 offset:49152
v_mfma_f32_16x16x32_bf16 v[116:119],a[148:151],a[20:23],v[116:119]
v_exp_f32 v107,v107
v_mfma_f32_16x16x32_bf16 v[116:119],a[152:155],a[24:27],v[116:119]
ds_read_b64_tr_b16 a[226:227],v18 offset:53248
v_cvt_pk_bf16_f32 v85,v106,v107
v_mfma_f32_16x16x32_bf16 v[116:119],a[156:159],a[28:31],v[116:119]
v_exp_f32 v108,v108
v_mfma_f32_16x16x32_bf16 v[120:123],a[160:163],a[16:19],v[68:71]
ds_read_b64_tr_b16 a[228:229],v18 offset:57344
ds_read_b64_tr_b16 a[230:231],v18 offset:61440
v_mfma_f32_16x16x32_bf16 v[120:123],a[164:167],a[20:23],v[120:123]
v_exp_f32 v109,v109
v_mfma_f32_16x16x32_bf16 v[120:123],a[168:171],a[24:27],v[120:123]
ds_read_b64_tr_b16 a[232:233],v19 offset:49152
v_cvt_pk_bf16_f32 v86,v108,v109
v_mfma_f32_16x16x32_bf16 v[120:123],a[172:175],a[28:31],v[120:123]
s_mov_b32 s48,278528
v_exp_f32 v110,v110
v_mfma_f32_16x16x32_bf16 v[124:127],a[176:179],a[16:19],v[68:71]
ds_read_b64_tr_b16 a[234:235],v19 offset:53248
ds_read_b64_tr_b16 a[236:237],v19 offset:57344
s_add_u32 m0,s39,16384
v_mfma_f32_16x16x32_bf16 v[124:127],a[180:183],a[20:23],v[124:127]
buffer_load_dwordx4 v4,s[8:11],s48 offen nt lds
v_exp_f32 v111,v111
v_mfma_f32_16x16x32_bf16 v[124:127],a[184:187],a[24:27],v[124:127]
ds_read_b64_tr_b16 a[238:239],v19 offset:61440
v_cvt_pk_bf16_f32 v87,v110,v111
v_mfma_f32_16x16x32_bf16 v[124:127],a[188:191],a[28:31],v[124:127]
ds_read_b64_tr_b16 a[240:241],v20 offset:49152
ds_read_b64_tr_b16 a[242:243],v20 offset:53248
v_mfma_f32_16x16x32_bf16 v[96:99],a[128:131],a[32:35],v[72:75]
ds_read_b64_tr_b16 a[244:245],v20 offset:57344
ds_read_b64_tr_b16 a[246:247],v20 offset:61440
v_mfma_f32_16x16x32_bf16 v[96:99],a[132:135],a[36:39],v[96:99]
v_exp_f32 v112,v112
v_mfma_f32_16x16x32_bf16 v[96:99],a[136:139],a[40:43],v[96:99]
ds_read_b64_tr_b16 a[248:249],v21 offset:49152
ds_read_b64_tr_b16 a[250:251],v21 offset:53248
v_mfma_f32_16x16x32_bf16 v[96:99],a[140:143],a[44:47],v[96:99]
v_exp_f32 v113,v113
v_mfma_f32_16x16x32_bf16 v[100:103],a[144:147],a[32:35],v[72:75]
ds_read_b64_tr_b16 a[252:253],v21 offset:57344
v_cvt_pk_bf16_f32 v88,v112,v113
v_mfma_f32_16x16x32_bf16 v[100:103],a[148:151],a[36:39],v[100:103]
v_exp_f32 v114,v114
v_mfma_f32_16x16x32_bf16 v[100:103],a[152:155],a[40:43],v[100:103]
ds_read_b64_tr_b16 a[254:255],v21 offset:61440
v_mfma_f32_16x16x32_bf16 v[100:103],a[156:159],a[44:47],v[100:103]
v_exp_f32 v115,v115
v_mfma_f32_16x16x32_bf16 v[104:107],a[160:163],a[32:35],v[72:75]
v_cvt_pk_bf16_f32 v89,v114,v115
v_mfma_f32_16x16x32_bf16 v[104:107],a[164:167],a[36:39],v[104:107]
v_exp_f32 v116,v116
v_mfma_f32_16x16x32_bf16 v[104:107],a[168:171],a[40:43],v[104:107]
v_mfma_f32_16x16x32_bf16 v[104:107],a[172:175],a[44:47],v[104:107]
v_exp_f32 v117,v117
v_mfma_f32_16x16x32_bf16 v[108:111],a[176:179],a[32:35],v[72:75]
buffer_load_dwordx4 v5,s[8:11],s48 offen offset:1024 nt lds
v_cvt_pk_bf16_f32 v90,v116,v117
v_mfma_f32_16x16x32_bf16 v[108:111],a[180:183],a[36:39],v[108:111]
v_exp_f32 v118,v118
v_mfma_f32_16x16x32_bf16 v[108:111],a[184:187],a[40:43],v[108:111]
s_waitcnt lgkmcnt(0)
v_mfma_f32_16x16x32_bf16 v[108:111],a[188:191],a[44:47],v[108:111]
v_exp_f32 v119,v119
v_mfma_f32_16x16x32_bf16 v[128:131],a[192:195],v[80:83],v[128:131]
v_cvt_pk_bf16_f32 v91,v118,v119
v_mfma_f32_16x16x32_bf16 v[128:131],a[196:199],v[84:87],v[128:131]
v_exp_f32 v120,v120
v_mfma_f32_16x16x32_bf16 v[132:135],a[200:203],v[80:83],v[132:135]
v_mfma_f32_16x16x32_bf16 v[132:135],a[204:207],v[84:87],v[132:135]
v_exp_f32 v121,v121
v_mfma_f32_16x16x32_bf16 v[136:139],a[208:211],v[80:83],v[136:139]
v_cvt_pk_bf16_f32 v92,v120,v121
v_mfma_f32_16x16x32_bf16 v[136:139],a[212:215],v[84:87],v[136:139]
v_exp_f32 v122,v122
v_mfma_f32_16x16x32_bf16 v[140:143],a[216:219],v[80:83],v[140:143]
v_mfma_f32_16x16x32_bf16 v[140:143],a[220:223],v[84:87],v[140:143]
v_exp_f32 v123,v123
v_mfma_f32_16x16x32_bf16 v[144:147],a[224:227],v[80:83],v[144:147]
v_cvt_pk_bf16_f32 v93,v122,v123
v_mfma_f32_16x16x32_bf16 v[144:147],a[228:231],v[84:87],v[144:147]
v_exp_f32 v124,v124
v_mfma_f32_16x16x32_bf16 v[148:151],a[232:235],v[80:83],v[148:151]
v_mfma_f32_16x16x32_bf16 v[148:151],a[236:239],v[84:87],v[148:151]
v_exp_f32 v125,v125
v_mfma_f32_16x16x32_bf16 v[152:155],a[240:243],v[80:83],v[152:155]
v_cvt_pk_bf16_f32 v94,v124,v125
v_mfma_f32_16x16x32_bf16 v[152:155],a[244:247],v[84:87],v[152:155]
buffer_load_dwordx4 v6,s[8:11],s48 offen offset:2048 nt lds
v_exp_f32 v126,v126
v_mfma_f32_16x16x32_bf16 v[156:159],a[248:251],v[80:83],v[156:159]
v_mfma_f32_16x16x32_bf16 v[156:159],a[252:255],v[84:87],v[156:159]
v_exp_f32 v127,v127
v_mfma_f32_16x16x32_bf16 v[48:51],v[44:47],v[80:83],v[48:51]
v_cvt_pk_bf16_f32 v95,v126,v127
v_mfma_f32_16x16x32_bf16 v[48:51],v[44:47],v[84:87],v[48:51]
s_waitcnt vmcnt(3)
s_barrier
v_mfma_f32_16x16x32_bf16 v[112:115],a[128:131],a[48:51],v[76:79]
v_mfma_f32_16x16x32_bf16 v[112:115],a[132:135],a[52:55],v[112:115]
v_exp_f32 v96,v96
v_mfma_f32_16x16x32_bf16 v[112:115],a[136:139],a[56:59],v[112:115]
v_mfma_f32_16x16x32_bf16 v[112:115],a[140:143],a[60:63],v[112:115]
v_exp_f32 v97,v97
v_mfma_f32_16x16x32_bf16 v[116:119],a[144:147],a[48:51],v[76:79]
ds_read_b128 a[128:131],v10 offset:0
v_cvt_pk_bf16_f32 v80,v96,v97
v_mfma_f32_16x16x32_bf16 v[116:119],a[148:151],a[52:55],v[116:119]
v_exp_f32 v98,v98
v_mfma_f32_16x16x32_bf16 v[116:119],a[152:155],a[56:59],v[116:119]
ds_read_b128 a[132:135],v11 offset:0
v_mfma_f32_16x16x32_bf16 v[116:119],a[156:159],a[60:63],v[116:119]
v_exp_f32 v99,v99
v_mfma_f32_16x16x32_bf16 v[120:123],a[160:163],a[48:51],v[76:79]
ds_read_b128 a[136:139],v12 offset:0
v_cvt_pk_bf16_f32 v81,v98,v99
v_mfma_f32_16x16x32_bf16 v[120:123],a[164:167],a[52:55],v[120:123]
v_exp_f32 v100,v100
v_mfma_f32_16x16x32_bf16 v[120:123],a[168:171],a[56:59],v[120:123]
ds_read_b128 a[140:143],v13 offset:0
v_mfma_f32_16x16x32_bf16 v[120:123],a[172:175],a[60:63],v[120:123]
v_exp_f32 v101,v101
v_mfma_f32_16x16x32_bf16 v[124:127],a[176:179],a[48:51],v[76:79]
ds_read_b128 a[144:147],v10 offset:4096
v_cvt_pk_bf16_f32 v82,v100,v101
v_mfma_f32_16x16x32_bf16 v[124:127],a[180:183],a[52:55],v[124:127]
buffer_load_dwordx4 v7,s[8:11],s48 offen offset:3072 nt lds
v_exp_f32 v102,v102
v_mfma_f32_16x16x32_bf16 v[124:127],a[184:187],a[56:59],v[124:127]
ds_read_b128 a[148:151],v11 offset:4096
v_mfma_f32_16x16x32_bf16 v[124:127],a[188:191],a[60:63],v[124:127]
v_exp_f32 v103,v103
v_mfma_f32_16x16x32_bf16 v[160:163],a[192:195],v[88:91],v[160:163]
ds_read_b128 a[152:155],v12 offset:4096
v_cvt_pk_bf16_f32 v83,v102,v103
v_mfma_f32_16x16x32_bf16 v[160:163],a[196:199],v[92:95],v[160:163]
v_exp_f32 v104,v104
v_mfma_f32_16x16x32_bf16 v[164:167],a[200:203],v[88:91],v[164:167]
ds_read_b128 a[156:159],v13 offset:4096
v_mfma_f32_16x16x32_bf16 v[164:167],a[204:207],v[92:95],v[164:167]
v_exp_f32 v105,v105
v_mfma_f32_16x16x32_bf16 v[168:171],a[208:211],v[88:91],v[168:171]
ds_read_b128 a[160:163],v10 offset:8192
v_cvt_pk_bf16_f32 v84,v104,v105
v_mfma_f32_16x16x32_bf16 v[168:171],a[212:215],v[92:95],v[168:171]
v_exp_f32 v106,v106
v_mfma_f32_16x16x32_bf16 v[172:175],a[216:219],v[88:91],v[172:175]
ds_read_b128 a[164:167],v11 offset:8192
v_mfma_f32_16x16x32_bf16 v[172:175],a[220:223],v[92:95],v[172:175]
v_exp_f32 v107,v107
v_mfma_f32_16x16x32_bf16 v[176:179],a[224:227],v[88:91],v[176:179]
ds_read_b128 a[168:171],v12 offset:8192
v_cvt_pk_bf16_f32 v85,v106,v107
v_mfma_f32_16x16x32_bf16 v[176:179],a[228:231],v[92:95],v[176:179]
v_exp_f32 v108,v108
v_mfma_f32_16x16x32_bf16 v[180:183],a[232:235],v[88:91],v[180:183]
ds_read_b128 a[172:175],v13 offset:8192
v_mfma_f32_16x16x32_bf16 v[180:183],a[236:239],v[92:95],v[180:183]
v_exp_f32 v109,v109
v_mfma_f32_16x16x32_bf16 v[184:187],a[240:243],v[88:91],v[184:187]
ds_read_b128 a[176:179],v10 offset:12288
v_cvt_pk_bf16_f32 v86,v108,v109
v_mfma_f32_16x16x32_bf16 v[184:187],a[244:247],v[92:95],v[184:187]
s_add_u32 m0,s39,81920
v_exp_f32 v110,v110
v_mfma_f32_16x16x32_bf16 v[188:191],a[248:251],v[88:91],v[188:191]
ds_read_b128 a[180:183],v11 offset:12288
v_mfma_f32_16x16x32_bf16 v[188:191],a[252:255],v[92:95],v[188:191]
buffer_load_dwordx4 v8,s[12:15],s48 offen nt lds
v_exp_f32 v111,v111
v_mfma_f32_16x16x32_bf16 v[52:55],v[44:47],v[88:91],v[52:55]
ds_read_b128 a[184:187],v12 offset:12288
v_cvt_pk_bf16_f32 v87,v110,v111
v_mfma_f32_16x16x32_bf16 v[52:55],v[44:47],v[92:95],v[52:55]
ds_read_b128 a[188:191],v13 offset:12288
v_mfma_f32_16x16x32_bf16 v[192:195],a[192:195],v[80:83],v[192:195]
v_mfma_f32_16x16x32_bf16 v[192:195],a[196:199],v[84:87],v[192:195]
v_exp_f32 v112,v112
v_mfma_f32_16x16x32_bf16 v[196:199],a[200:203],v[80:83],v[196:199]
v_mfma_f32_16x16x32_bf16 v[196:199],a[204:207],v[84:87],v[196:199]
v_exp_f32 v113,v113
v_mfma_f32_16x16x32_bf16 v[200:203],a[208:211],v[80:83],v[200:203]
v_cvt_pk_bf16_f32 v88,v112,v113
v_mfma_f32_16x16x32_bf16 v[200:203],a[212:215],v[84:87],v[200:203]
v_exp_f32 v114,v114
v_mfma_f32_16x16x32_bf16 v[204:207],a[216:219],v[80:83],v[204:207]
v_mfma_f32_16x16x32_bf16 v[204:207],a[220:223],v[84:87],v[204:207]
v_exp_f32 v115,v115
v_mfma_f32_16x16x32_bf16 v[208:211],a[224:227],v[80:83],v[208:211]
v_cvt_pk_bf16_f32 v89,v114,v115
v_mfma_f32_16x16x32_bf16 v[208:211],a[228:231],v[84:87],v[208:211]
v_exp_f32 v116,v116
v_mfma_f32_16x16x32_bf16 v[212:215],a[232:235],v[80:83],v[212:215]
v_mfma_f32_16x16x32_bf16 v[212:215],a[236:239],v[84:87],v[212:215]
v_exp_f32 v117,v117
v_mfma_f32_16x16x32_bf16 v[216:219],a[240:243],v[80:83],v[216:219]
buffer_load_dwordx4 v9,s[12:15],s48 offen offset:1024 nt lds
v_cvt_pk_bf16_f32 v90,v116,v117
v_mfma_f32_16x16x32_bf16 v[216:219],a[244:247],v[84:87],v[216:219]
v_exp_f32 v118,v118
v_mfma_f32_16x16x32_bf16 v[220:223],a[248:251],v[80:83],v[220:223]
s_waitcnt lgkmcnt(0)
v_mfma_f32_16x16x32_bf16 v[220:223],a[252:255],v[84:87],v[220:223]
v_exp_f32 v119,v119
v_mfma_f32_16x16x32_bf16 v[56:59],v[44:47],v[80:83],v[56:59]
v_cvt_pk_bf16_f32 v91,v118,v119
v_mfma_f32_16x16x32_bf16 v[56:59],v[44:47],v[84:87],v[56:59]
v_exp_f32 v120,v120
v_mfma_f32_16x16x32_bf16 v[96:99],a[128:131],a[64:67],0
v_mfma_f32_16x16x32_bf16 v[96:99],a[132:135],a[68:71],v[96:99]
v_exp_f32 v121,v121
v_mfma_f32_16x16x32_bf16 v[96:99],a[136:139],a[72:75],v[96:99]
v_cvt_pk_bf16_f32 v92,v120,v121
v_mfma_f32_16x16x32_bf16 v[96:99],a[140:143],a[76:79],v[96:99]
v_exp_f32 v122,v122
v_mfma_f32_16x16x32_bf16 v[100:103],a[128:131],a[80:83],0
v_mfma_f32_16x16x32_bf16 v[100:103],a[132:135],a[84:87],v[100:103]
v_exp_f32 v123,v123
v_mfma_f32_16x16x32_bf16 v[100:103],a[136:139],a[88:91],v[100:103]
v_cvt_pk_bf16_f32 v93,v122,v123
v_mfma_f32_16x16x32_bf16 v[100:103],a[140:143],a[92:95],v[100:103]
v_exp_f32 v124,v124
v_mfma_f32_16x16x32_bf16 v[104:107],a[128:131],a[96:99],0
v_mfma_f32_16x16x32_bf16 v[104:107],a[132:135],a[100:103],v[104:107]
v_exp_f32 v125,v125
v_mfma_f32_16x16x32_bf16 v[104:107],a[136:139],a[104:107],v[104:107]
v_cvt_pk_bf16_f32 v94,v124,v125
v_mfma_f32_16x16x32_bf16 v[104:107],a[140:143],a[108:111],v[104:107]
buffer_load_dwordx4 v8,s[12:15],s48 offen offset:2048 nt lds
v_exp_f32 v126,v126
v_mfma_f32_16x16x32_bf16 v[108:111],a[128:131],a[112:115],0
v_mfma_f32_16x16x32_bf16 v[108:111],a[132:135],a[116:119],v[108:111]
v_exp_f32 v127,v127
v_mfma_f32_16x16x32_bf16 v[108:111],a[136:139],a[120:123],v[108:111]
v_cvt_pk_bf16_f32 v95,v126,v127
v_mfma_f32_16x16x32_bf16 v[108:111],a[140:143],a[124:127],v[108:111]
v_mfma_f32_16x16x32_bf16 v[224:227],a[192:195],v[88:91],v[224:227]
v_mfma_f32_16x16x32_bf16 v[224:227],a[196:199],v[92:95],v[224:227]
v_mfma_f32_16x16x32_bf16 v[228:231],a[200:203],v[88:91],v[228:231]
v_mfma_f32_16x16x32_bf16 v[228:231],a[204:207],v[92:95],v[228:231]
v_mfma_f32_16x16x32_bf16 v[232:235],a[208:211],v[88:91],v[232:235]
v_max3_f32 v34,v96,v97,v98
v_max3_f32 v35,v100,v101,v102
v_max3_f32 v36,v104,v105,v106
v_mfma_f32_16x16x32_bf16 v[232:235],a[212:215],v[92:95],v[232:235]
v_max3_f32 v37,v108,v109,v110
v_max_f32 v34,v34,v99
v_max_f32 v35,v35,v103
v_mfma_f32_16x16x32_bf16 v[236:239],a[216:219],v[88:91],v[236:239]
v_max_f32 v36,v36,v107
v_max_f32 v37,v37,v111
v_mov_b32 v96,v34
v_mfma_f32_16x16x32_bf16 v[236:239],a[220:223],v[92:95],v[236:239]
v_mov_b32 v100,v35
v_mov_b32 v104,v36
v_mov_b32 v108,v37
v_mfma_f32_16x16x32_bf16 v[240:243],a[224:227],v[88:91],v[240:243]
v_permlane16_swap_b32 v34,v96
v_permlane16_swap_b32 v35,v100
v_permlane16_swap_b32 v36,v104
v_mfma_f32_16x16x32_bf16 v[240:243],a[228:231],v[92:95],v[240:243]
v_permlane16_swap_b32 v37,v108
v_max_f32 v34,v34,v96
v_max_f32 v35,v35,v100
v_mfma_f32_16x16x32_bf16 v[244:247],a[232:235],v[88:91],v[244:247]
v_max_f32 v36,v36,v104
v_max_f32 v37,v37,v108
v_mov_b32 v96,v34
v_mfma_f32_16x16x32_bf16 v[244:247],a[236:239],v[92:95],v[244:247]
v_mov_b32 v100,v35
v_mov_b32 v104,v36
v_mov_b32 v108,v37
v_mfma_f32_16x16x32_bf16 v[248:251],a[240:243],v[88:91],v[248:251]
v_permlane32_swap_b32 v34,v96
v_permlane32_swap_b32 v35,v100
v_permlane32_swap_b32 v36,v104
v_mfma_f32_16x16x32_bf16 v[248:251],a[244:247],v[92:95],v[248:251]
v_permlane32_swap_b32 v37,v108
v_max_f32 v34,v34,v96
v_max_f32 v35,v35,v100
v_mfma_f32_16x16x32_bf16 v[252:255],a[248:251],v[88:91],v[252:255]
v_max_f32 v36,v36,v104
v_max_f32 v37,v37,v108
v_sub_f32 v64,0,v34
v_mfma_f32_16x16x32_bf16 v[252:255],a[252:255],v[92:95],v[252:255]
v_sub_f32 v65,0,v34
v_sub_f32 v66,0,v34
v_sub_f32 v67,0,v34
v_mfma_f32_16x16x32_bf16 v[60:63],v[44:47],v[88:91],v[60:63]
v_sub_f32 v68,0,v35
v_sub_f32 v69,0,v35
v_sub_f32 v70,0,v35
v_mfma_f32_16x16x32_bf16 v[60:63],v[44:47],v[92:95],v[60:63]
v_sub_f32 v71,0,v35
v_sub_f32 v72,0,v36
v_sub_f32 v73,0,v36
v_sub_f32 v74,0,v36
v_sub_f32 v75,0,v36
v_sub_f32 v76,0,v37
v_sub_f32 v77,0,v37
v_sub_f32 v78,0,v37
v_sub_f32 v79,0,v37
s_nop 7
v_cmp_nge_f32 s[4:5],s52,v48
v_cmp_nge_f32 s[6:7],s52,v52
v_cmp_nge_f32 vcc,s52,v56
v_cmp_nge_f32 s[100:101],s52,v60
s_nop 0
s_or_b64 s[4:5],s[4:5],s[6:7]
s_or_b64 vcc,vcc,s[100:101]
s_or_b64 s[4:5],s[4:5],vcc
s_cbranch_scc1 FB0
FB0_RET:
v_rcp_f32 v112,v48
v_rcp_f32 v114,v52
v_rcp_f32 v116,v56
v_rcp_f32 v118,v60
v_mov_b32 v26,1
s_nop 0
buffer_atomic_add v26,v25,s[60:63],s71 offen sc1
ds_read_b64_tr_b16 a[192:193],v14 offset:0
ds_read_b64_tr_b16 a[194:195],v14 offset:4096
ds_read_b64_tr_b16 a[196:197],v14 offset:8192
ds_read_b64_tr_b16 a[198:199],v14 offset:12288
ds_read_b64_tr_b16 a[200:201],v15 offset:0
ds_read_b64_tr_b16 a[202:203],v15 offset:4096
ds_read_b64_tr_b16 a[204:205],v15 offset:8192
ds_read_b64_tr_b16 a[206:207],v15 offset:12288
ds_read_b64_tr_b16 a[208:209],v16 offset:0
ds_read_b64_tr_b16 a[210:211],v16 offset:4096
ds_read_b64_tr_b16 a[212:213],v16 offset:8192
ds_read_b64_tr_b16 a[214:215],v16 offset:12288
ds_read_b64_tr_b16 a[216:217],v17 offset:0
ds_read_b64_tr_b16 a[218:219],v17 offset:4096
ds_read_b64_tr_b16 a[220:221],v17 offset:8192
ds_read_b64_tr_b16 a[222:223],v17 offset:12288
ds_read_b64_tr_b16 a[224:225],v18 offset:0
ds_read_b64_tr_b16 a[226:227],v18 offset:4096
ds_read_b64_tr_b16 a[228:229],v18 offset:8192
ds_read_b64_tr_b16 a[230:231],v18 offset:12288
ds_read_b64_tr_b16 a[232:233],v19 offset:0
ds_read_b64_tr_b16 a[234:235],v19 offset:4096
ds_read_b64_tr_b16 a[236:237],v19 offset:8192
ds_read_b64_tr_b16 a[238:239],v19 offset:12288
ds_read_b64_tr_b16 a[240:241],v20 offset:0
ds_read_b64_tr_b16 a[242:243],v20 offset:4096
ds_read_b64_tr_b16 a[244:245],v20 offset:8192
ds_read_b64_tr_b16 a[246:247],v20 offset:12288
ds_read_b64_tr_b16 a[248:249],v21 offset:0
ds_read_b64_tr_b16 a[250:251],v21 offset:4096
ds_read_b64_tr_b16 a[252:253],v21 offset:8192
ds_read_b64_tr_b16 a[254:255],v21 offset:12288
v_pk_mul_f32 v[128:129],v[128:129],v[112:113] op_sel_hi:[1,0]
v_pk_mul_f32 v[130:131],v[130:131],v[112:113] op_sel_hi:[1,0]
v_pk_mul_f32 v[132:133],v[132:133],v[112:113] op_sel_hi:[1,0]
v_pk_mul_f32 v[134:135],v[134:135],v[112:113] op_sel_hi:[1,0]
v_pk_mul_f32 v[136:137],v[136:137],v[112:113] op_sel_hi:[1,0]
v_pk_mul_f32 v[138:139],v[138:139],v[112:113] op_sel_hi:[1,0]
v_pk_mul_f32 v[140:141],v[140:141],v[112:113] op_sel_hi:[1,0]
v_pk_mul_f32 v[142:143],v[142:143],v[112:113] op_sel_hi:[1,0]
v_pk_mul_f32 v[144:145],v[144:145],v[112:113] op_sel_hi:[1,0]
v_pk_mul_f32 v[146:147],v[146:147],v[112:113] op_sel_hi:[1,0]
v_pk_mul_f32 v[148:149],v[148:149],v[112:113] op_sel_hi:[1,0]
v_pk_mul_f32 v[150:151],v[150:151],v[112:113] op_sel_hi:[1,0]
v_pk_mul_f32 v[152:153],v[152:153],v[112:113] op_sel_hi:[1,0]
v_pk_mul_f32 v[154:155],v[154:155],v[112:113] op_sel_hi:[1,0]
v_pk_mul_f32 v[156:157],v[156:157],v[112:113] op_sel_hi:[1,0]
v_pk_mul_f32 v[158:159],v[158:159],v[112:113] op_sel_hi:[1,0]
v_pk_mul_f32 v[160:161],v[160:161],v[114:115] op_sel_hi:[1,0]
v_pk_mul_f32 v[162:163],v[162:163],v[114:115] op_sel_hi:[1,0]
v_pk_mul_f32 v[164:165],v[164:165],v[114:115] op_sel_hi:[1,0]
v_pk_mul_f32 v[166:167],v[166:167],v[114:115] op_sel_hi:[1,0]
v_pk_mul_f32 v[168:169],v[168:169],v[114:115] op_sel_hi:[1,0]
v_pk_mul_f32 v[170:171],v[170:171],v[114:115] op_sel_hi:[1,0]
v_pk_mul_f32 v[172:173],v[172:173],v[114:115] op_sel_hi:[1,0]
v_pk_mul_f32 v[174:175],v[174:175],v[114:115] op_sel_hi:[1,0]
v_pk_mul_f32 v[176:177],v[176:177],v[114:115] op_sel_hi:[1,0]
v_pk_mul_f32 v[178:179],v[178:179],v[114:115] op_sel_hi:[1,0]
v_pk_mul_f32 v[180:181],v[180:181],v[114:115] op_sel_hi:[1,0]
v_pk_mul_f32 v[182:183],v[182:183],v[114:115] op_sel_hi:[1,0]
v_pk_mul_f32 v[184:185],v[184:185],v[114:115] op_sel_hi:[1,0]
v_pk_mul_f32 v[186:187],v[186:187],v[114:115] op_sel_hi:[1,0]
v_pk_mul_f32 v[188:189],v[188:189],v[114:115] op_sel_hi:[1,0]
v_pk_mul_f32 v[190:191],v[190:191],v[114:115] op_sel_hi:[1,0]
v_pk_mul_f32 v[192:193],v[192:193],v[116:117] op_sel_hi:[1,0]
v_pk_mul_f32 v[194:195],v[194:195],v[116:117] op_sel_hi:[1,0]
v_pk_mul_f32 v[196:197],v[196:197],v[116:117] op_sel_hi:[1,0]
v_pk_mul_f32 v[198:199],v[198:199],v[116:117] op_sel_hi:[1,0]
v_pk_mul_f32 v[200:201],v[200:201],v[116:117] op_sel_hi:[1,0]
v_pk_mul_f32 v[202:203],v[202:203],v[116:117] op_sel_hi:[1,0]
v_pk_mul_f32 v[204:205],v[204:205],v[116:117] op_sel_hi:[1,0]
v_pk_mul_f32 v[206:207],v[206:207],v[116:117] op_sel_hi:[1,0]
v_pk_mul_f32 v[208:209],v[208:209],v[116:117] op_sel_hi:[1,0]
v_pk_mul_f32 v[210:211],v[210:211],v[116:117] op_sel_hi:[1,0]
v_pk_mul_f32 v[212:213],v[212:213],v[116:117] op_sel_hi:[1,0]
v_pk_mul_f32 v[214:215],v[214:215],v[116:117] op_sel_hi:[1,0]
v_pk_mul_f32 v[216:217],v[216:217],v[116:117] op_sel_hi:[1,0]
v_pk_mul_f32 v[218:219],v[218:219],v[116:117] op_sel_hi:[1,0]
v_pk_mul_f32 v[220:221],v[220:221],v[116:117] op_sel_hi:[1,0]
v_pk_mul_f32 v[222:223],v[222:223],v[116:117] op_sel_hi:[1,0]
v_pk_mul_f32 v[224:225],v[224:225],v[118:119] op_sel_hi:[1,0]
v_pk_mul_f32 v[226:227],v[226:227],v[118:119] op_sel_hi:[1,0]
v_pk_mul_f32 v[228:229],v[228:229],v[118:119] op_sel_hi:[1,0]
v_pk_mul_f32 v[230:231],v[230:231],v[118:119] op_sel_hi:[1,0]
v_pk_mul_f32 v[232:233],v[232:233],v[118:119] op_sel_hi:[1,0]
v_pk_mul_f32 v[234:235],v[234:235],v[118:119] op_sel_hi:[1,0]
v_pk_mul_f32 v[236:237],v[236:237],v[118:119] op_sel_hi:[1,0]
v_pk_mul_f32 v[238:239],v[238:239],v[118:119] op_sel_hi:[1,0]
v_pk_mul_f32 v[240:241],v[240:241],v[118:119] op_sel_hi:[1,0]
v_pk_mul_f32 v[242:243],v[242:243],v[118:119] op_sel_hi:[1,0]
v_pk_mul_f32 v[244:245],v[244:245],v[118:119] op_sel_hi:[1,0]
v_pk_mul_f32 v[246:247],v[246:247],v[118:119] op_sel_hi:[1,0]
v_pk_mul_f32 v[248:249],v[248:249],v[118:119] op_sel_hi:[1,0]
v_pk_mul_f32 v[250:251],v[250:251],v[118:119] op_sel_hi:[1,0]
v_pk_mul_f32 v[252:253],v[252:253],v[118:119] op_sel_hi:[1,0]
v_pk_mul_f32 v[254:255],v[254:255],v[118:119] op_sel_hi:[1,0]
v_mfma_f32_16x16x32_bf16 v[96:99],a[128:131],a[64:67],v[64:67]
v_cvt_pk_bf16_f32 v128,v128,v129
v_cvt_pk_bf16_f32 v129,v130,v131
v_cvt_pk_bf16_f32 v130,v132,v133
v_cvt_pk_bf16_f32 v131,v134,v135
v_mfma_f32_16x16x32_bf16 v[96:99],a[132:135],a[68:71],v[96:99]
v_cvt_pk_bf16_f32 v132,v136,v137
v_cvt_pk_bf16_f32 v133,v138,v139
v_cvt_pk_bf16_f32 v134,v140,v141
v_cvt_pk_bf16_f32 v135,v142,v143
v_mfma_f32_16x16x32_bf16 v[96:99],a[136:139],a[72:75],v[96:99]
v_cvt_pk_bf16_f32 v136,v144,v145
v_cvt_pk_bf16_f32 v137,v146,v147
v_cvt_pk_bf16_f32 v138,v148,v149
v_cvt_pk_bf16_f32 v139,v150,v151
v_mfma_f32_16x16x32_bf16 v[96:99],a[140:143],a[76:79],v[96:99]
v_cvt_pk_bf16_f32 v140,v152,v153
v_cvt_pk_bf16_f32 v141,v154,v155
v_cvt_pk_bf16_f32 v142,v156,v157
v_cvt_pk_bf16_f32 v143,v158,v159
v_mfma_f32_16x16x32_bf16 v[100:103],a[144:147],a[64:67],v[64:67]
v_accvgpr_write_b32 a0,v128
v_accvgpr_write_b32 a1,v129
v_accvgpr_write_b32 a2,v130
v_accvgpr_write_b32 a3,v131
v_mfma_f32_16x16x32_bf16 v[100:103],a[148:151],a[68:71],v[100:103]
v_accvgpr_write_b32 a4,v132
v_accvgpr_write_b32 a5,v133
v_accvgpr_write_b32 a6,v134
v_accvgpr_write_b32 a7,v135
v_mfma_f32_16x16x32_bf16 v[100:103],a[152:155],a[72:75],v[100:103]
v_accvgpr_write_b32 a8,v136
v_accvgpr_write_b32 a9,v137
v_accvgpr_write_b32 a10,v138
v_accvgpr_write_b32 a11,v139
v_mfma_f32_16x16x32_bf16 v[100:103],a[156:159],a[76:79],v[100:103]
v_accvgpr_write_b32 a12,v140
v_accvgpr_write_b32 a13,v141
v_accvgpr_write_b32 a14,v142
v_accvgpr_write_b32 a15,v143
v_mfma_f32_16x16x32_bf16 v[104:107],a[160:163],a[64:67],v[64:67]
v_cvt_pk_bf16_f32 v160,v160,v161
v_cvt_pk_bf16_f32 v161,v162,v163
v_cvt_pk_bf16_f32 v162,v164,v165
v_cvt_pk_bf16_f32 v163,v166,v167
v_mfma_f32_16x16x32_bf16 v[104:107],a[164:167],a[68:71],v[104:107]
v_cvt_pk_bf16_f32 v164,v168,v169
v_cvt_pk_bf16_f32 v165,v170,v171
v_cvt_pk_bf16_f32 v166,v172,v173
v_cvt_pk_bf16_f32 v167,v174,v175
v_mfma_f32_16x16x32_bf16 v[104:107],a[168:171],a[72:75],v[104:107]
v_cvt_pk_bf16_f32 v168,v176,v177
v_cvt_pk_bf16_f32 v169,v178,v179
v_cvt_pk_bf16_f32 v170,v180,v181
v_cvt_pk_bf16_f32 v171,v182,v183
v_mfma_f32_16x16x32_bf16 v[104:107],a[172:175],a[76:79],v[104:107]
v_cvt_pk_bf16_f32 v172,v184,v185
v_cvt_pk_bf16_f32 v173,v186,v187
v_cvt_pk_bf16_f32 v174,v188,v189
v_cvt_pk_bf16_f32 v175,v190,v191
v_mfma_f32_16x16x32_bf16 v[108:111],a[176:179],a[64:67],v[64:67]
v_accvgpr_write_b32 a16,v160
v_accvgpr_write_b32 a17,v161
v_accvgpr_write_b32 a18,v162
v_accvgpr_write_b32 a19,v163
v_mfma_f32_16x16x32_bf16 v[108:111],a[180:183],a[68:71],v[108:111]
v_accvgpr_write_b32 a20,v164
v_accvgpr_write_b32 a21,v165
v_accvgpr_write_b32 a22,v166
v_accvgpr_write_b32 a23,v167
v_mfma_f32_16x16x32_bf16 v[108:111],a[184:187],a[72:75],v[108:111]
v_accvgpr_write_b32 a24,v168
v_accvgpr_write_b32 a25,v169
v_accvgpr_write_b32 a26,v170
v_accvgpr_write_b32 a27,v171
v_mfma_f32_16x16x32_bf16 v[108:111],a[188:191],a[76:79],v[108:111]
v_accvgpr_write_b32 a28,v172
v_accvgpr_write_b32 a29,v173
v_accvgpr_write_b32 a30,v174
v_accvgpr_write_b32 a31,v175
v_mfma_f32_16x16x32_bf16 v[112:115],a[128:131],a[80:83],v[68:71]
buffer_load_dwordx4 v9,s[12:15],s48 offen offset:3072 nt lds
v_exp_f32 v96,v96
v_mfma_f32_16x16x32_bf16 v[112:115],a[132:135],a[84:87],v[112:115]
v_exp_f32 v97,v97
v_mfma_f32_16x16x32_bf16 v[112:115],a[136:139],a[88:91],v[112:115]
v_exp_f32 v98,v98
v_cvt_pk_bf16_f32 v80,v96,v97
v_mfma_f32_16x16x32_bf16 v[112:115],a[140:143],a[92:95],v[112:115]
v_exp_f32 v99,v99
v_mfma_f32_16x16x32_bf16 v[116:119],a[144:147],a[80:83],v[68:71]
v_exp_f32 v100,v100
v_cvt_pk_bf16_f32 v81,v98,v99
v_mfma_f32_16x16x32_bf16 v[116:119],a[148:151],a[84:87],v[116:119]
v_exp_f32 v101,v101
v_mfma_f32_16x16x32_bf16 v[116:119],a[152:155],a[88:91],v[116:119]
v_exp_f32 v102,v102
v_cvt_pk_bf16_f32 v82,v100,v101
v_mfma_f32_16x16x32_bf16 v[116:119],a[156:159],a[92:95],v[116:119]
v_exp_f32 v103,v103
v_mfma_f32_16x16x32_bf16 v[120:123],a[160:163],a[80:83],v[68:71]
v_exp_f32 v104,v104
v_cvt_pk_bf16_f32 v83,v102,v103
v_mfma_f32_16x16x32_bf16 v[120:123],a[164:167],a[84:87],v[120:123]
v_exp_f32 v105,v105
v_mfma_f32_16x16x32_bf16 v[120:123],a[168:171],a[88:91],v[120:123]
v_exp_f32 v106,v106
v_cvt_pk_bf16_f32 v84,v104,v105
v_mfma_f32_16x16x32_bf16 v[120:123],a[172:175],a[92:95],v[120:123]
s_mov_b32 s48,294912
v_exp_f32 v107,v107
v_mfma_f32_16x16x32_bf16 v[124:127],a[176:179],a[80:83],v[68:71]
v_exp_f32 v108,v108
v_cvt_pk_bf16_f32 v85,v106,v107
v_mfma_f32_16x16x32_bf16 v[124:127],a[180:183],a[84:87],v[124:127]
s_add_u32 m0,s39,32768
v_exp_f32 v109,v109
v_mfma_f32_16x16x32_bf16 v[124:127],a[184:187],a[88:91],v[124:127]
v_exp_f32 v110,v110
v_cvt_pk_bf16_f32 v86,v108,v109
v_mfma_f32_16x16x32_bf16 v[124:127],a[188:191],a[92:95],v[124:127]
v_exp_f32 v111,v111
s_nop 0
v_cvt_pk_bf16_f32 v87,v110,v111
v_mfma_f32_16x16x32_bf16 v[96:99],a[128:131],a[96:99],v[72:75]
v_cvt_pk_bf16_f32 v192,v192,v193
v_cvt_pk_bf16_f32 v193,v194,v195
v_cvt_pk_bf16_f32 v194,v196,v197
v_mfma_f32_16x16x32_bf16 v[96:99],a[132:135],a[100:103],v[96:99]
v_exp_f32 v112,v112
v_cvt_pk_bf16_f32 v195,v198,v199
v_mfma_f32_16x16x32_bf16 v[96:99],a[136:139],a[104:107],v[96:99]
v_cvt_pk_bf16_f32 v196,v200,v201
v_cvt_pk_bf16_f32 v197,v202,v203
v_cvt_pk_bf16_f32 v198,v204,v205
v_mfma_f32_16x16x32_bf16 v[96:99],a[140:143],a[108:111],v[96:99]
v_exp_f32 v113,v113
v_cvt_pk_bf16_f32 v199,v206,v207
v_mfma_f32_16x16x32_bf16 v[100:103],a[144:147],a[96:99],v[72:75]
v_cvt_pk_bf16_f32 v88,v112,v113
v_cvt_pk_bf16_f32 v200,v208,v209
v_cvt_pk_bf16_f32 v201,v210,v211
v_mfma_f32_16x16x32_bf16 v[100:103],a[148:151],a[100:103],v[100:103]
v_exp_f32 v114,v114
v_cvt_pk_bf16_f32 v202,v212,v213
v_mfma_f32_16x16x32_bf16 v[100:103],a[152:155],a[104:107],v[100:103]
v_cvt_pk_bf16_f32 v203,v214,v215
v_cvt_pk_bf16_f32 v204,v216,v217
v_cvt_pk_bf16_f32 v205,v218,v219
v_mfma_f32_16x16x32_bf16 v[100:103],a[156:159],a[108:111],v[100:103]
v_exp_f32 v115,v115
v_cvt_pk_bf16_f32 v206,v220,v221
v_mfma_f32_16x16x32_bf16 v[104:107],a[160:163],a[96:99],v[72:75]
v_cvt_pk_bf16_f32 v89,v114,v115
v_cvt_pk_bf16_f32 v207,v222,v223
v_accvgpr_write_b32 a32,v192
v_mfma_f32_16x16x32_bf16 v[104:107],a[164:167],a[100:103],v[104:107]
v_exp_f32 v116,v116
v_accvgpr_write_b32 a33,v193
v_mfma_f32_16x16x32_bf16 v[104:107],a[168:171],a[104:107],v[104:107]
v_accvgpr_write_b32 a34,v194
v_accvgpr_write_b32 a35,v195
v_accvgpr_write_b32 a36,v196
v_mfma_f32_16x16x32_bf16 v[104:107],a[172:175],a[108:111],v[104:107]
v_exp_f32 v117,v117
v_accvgpr_write_b32 a37,v197
v_mfma_f32_16x16x32_bf16 v[108:111],a[176:179],a[96:99],v[72:75]
v_cvt_pk_bf16_f32 v90,v116,v117
v_accvgpr_write_b32 a38,v198
v_accvgpr_write_b32 a39,v199
v_mfma_f32_16x16x32_bf16 v[108:111],a[180:183],a[100:103],v[108:111]
v_exp_f32 v118,v118
v_accvgpr_write_b32 a40,v200
v_mfma_f32_16x16x32_bf16 v[108:111],a[184:187],a[104:107],v[108:111]
v_accvgpr_write_b32 a41,v201
v_accvgpr_write_b32 a42,v202
v_accvgpr_write_b32 a43,v203
v_mfma_f32_16x16x32_bf16 v[108:111],a[188:191],a[108:111],v[108:111]
v_exp_f32 v119,v119
v_accvgpr_write_b32 a44,v204
s_waitcnt lgkmcnt(0)
v_mfma_f32_16x16x32_bf16 v[128:131],a[192:195],v[80:83],0
v_cvt_pk_bf16_f32 v91,v118,v119
v_accvgpr_write_b32 a45,v205
v_accvgpr_write_b32 a46,v206
v_mfma_f32_16x16x32_bf16 v[128:131],a[196:199],v[84:87],v[128:131]
v_exp_f32 v120,v120
v_accvgpr_write_b32 a47,v207
v_mfma_f32_16x16x32_bf16 v[132:135],a[200:203],v[80:83],0
buffer_load_dwordx4 v4,s[8:11],s48 offen nt lds
v_mfma_f32_16x16x32_bf16 v[132:135],a[204:207],v[84:87],v[132:135]
buffer_load_dwordx4 v5,s[8:11],s48 offen offset:1024 nt lds
v_exp_f32 v121,v121
v_mfma_f32_16x16x32_bf16 v[136:139],a[208:211],v[80:83],0
v_cvt_pk_bf16_f32 v92,v120,v121
v_mfma_f32_16x16x32_bf16 v[136:139],a[212:215],v[84:87],v[136:139]
v_exp_f32 v122,v122
v_mfma_f32_16x16x32_bf16 v[140:143],a[216:219],v[80:83],0
v_mfma_f32_16x16x32_bf16 v[140:143],a[220:223],v[84:87],v[140:143]
v_exp_f32 v123,v123
v_mfma_f32_16x16x32_bf16 v[144:147],a[224:227],v[80:83],0
v_cvt_pk_bf16_f32 v93,v122,v123
v_mfma_f32_16x16x32_bf16 v[144:147],a[228:231],v[84:87],v[144:147]
v_exp_f32 v124,v124
v_mfma_f32_16x16x32_bf16 v[148:151],a[232:235],v[80:83],0
v_mfma_f32_16x16x32_bf16 v[148:151],a[236:239],v[84:87],v[148:151]
v_exp_f32 v125,v125
v_mfma_f32_16x16x32_bf16 v[152:155],a[240:243],v[80:83],0
v_cvt_pk_bf16_f32 v94,v124,v125
v_mfma_f32_16x16x32_bf16 v[152:155],a[244:247],v[84:87],v[152:155]
buffer_load_dwordx4 v6,s[8:11],s48 offen offset:2048 nt lds
v_exp_f32 v126,v126
v_mfma_f32_16x16x32_bf16 v[156:159],a[248:251],v[80:83],0
v_mfma_f32_16x16x32_bf16 v[156:159],a[252:255],v[84:87],v[156:159]
v_exp_f32 v127,v127
v_mfma_f32_16x16x32_bf16 v[48:51],v[44:47],v[80:83],0
v_cvt_pk_bf16_f32 v95,v126,v127
v_mfma_f32_16x16x32_bf16 v[48:51],v[44:47],v[84:87],v[48:51]
s_waitcnt vmcnt(3)
s_barrier
v_mfma_f32_16x16x32_bf16 v[112:115],a[128:131],a[112:115],v[76:79]
v_cvt_pk_bf16_f32 v224,v224,v225
v_cvt_pk_bf16_f32 v225,v226,v227
v_mfma_f32_16x16x32_bf16 v[112:115],a[132:135],a[116:119],v[112:115]
v_exp_f32 v96,v96
v_mfma_f32_16x16x32_bf16 v[112:115],a[136:139],a[120:123],v[112:115]
v_cvt_pk_bf16_f32 v226,v228,v229
v_cvt_pk_bf16_f32 v227,v230,v231
v_mfma_f32_16x16x32_bf16 v[112:115],a[140:143],a[124:127],v[112:115]
v_exp_f32 v97,v97
v_mfma_f32_16x16x32_bf16 v[116:119],a[144:147],a[112:115],v[76:79]
ds_read_b128 a[128:131],v10 offset:16384
v_cvt_pk_bf16_f32 v80,v96,v97
v_mfma_f32_16x16x32_bf16 v[116:119],a[148:151],a[116:119],v[116:119]
v_exp_f32 v98,v98
v_mfma_f32_16x16x32_bf16 v[116:119],a[152:155],a[120:123],v[116:119]
ds_read_b128 a[132:135],v11 offset:16384
v_cvt_pk_bf16_f32 v228,v232,v233
v_mfma_f32_16x16x32_bf16 v[116:119],a[156:159],a[124:127],v[116:119]
v_exp_f32 v99,v99
v_mfma_f32_16x16x32_bf16 v[120:123],a[160:163],a[112:115],v[76:79]
ds_read_b128 a[136:139],v12 offset:16384
v_cvt_pk_bf16_f32 v81,v98,v99
v_mfma_f32_16x16x32_bf16 v[120:123],a[164:167],a[116:119],v[120:123]
v_exp_f32 v100,v100
v_mfma_f32_16x16x32_bf16 v[120:123],a[168:171],a[120:123],v[120:123]
ds_read_b128 a[140:143],v13 offset:16384
v_cvt_pk_bf16_f32 v229,v234,v235
v_mfma_f32_16x16x32_bf16 v[120:123],a[172:175],a[124:127],v[120:123]
v_exp_f32 v101,v101
v_mfma_f32_16x16x32_bf16 v[124:127],a[176:179],a[112:115],v[76:79]
ds_read_b128 a[144:147],v10 offset:20480
v_cvt_pk_bf16_f32 v82,v100,v101
v_mfma_f32_16x16x32_bf16 v[124:127],a[180:183],a[116:119],v[124:127]
buffer_load_dwordx4 v7,s[8:11],s48 offen offset:3072 nt lds
v_exp_f32 v102,v102
v_mfma_f32_16x16x32_bf16 v[124:127],a[184:187],a[120:123],v[124:127]
ds_read_b128 a[148:151],v11 offset:20480
v_cvt_pk_bf16_f32 v230,v236,v237
v_mfma_f32_16x16x32_bf16 v[124:127],a[188:191],a[124:127],v[124:127]
v_exp_f32 v103,v103
v_mfma_f32_16x16x32_bf16 v[160:163],a[192:195],v[88:91],0
ds_read_b128 a[152:155],v12 offset:20480
v_cvt_pk_bf16_f32 v83,v102,v103
v_mfma_f32_16x16x32_bf16 v[160:163],a[196:199],v[92:95],v[160:163]
v_exp_f32 v104,v104
v_mfma_f32_16x16x32_bf16 v[164:167],a[200:203],v[88:91],0
ds_read_b128 a[156:159],v13 offset:20480
v_cvt_pk_bf16_f32 v231,v238,v239
v_mfma_f32_16x16x32_bf16 v[164:167],a[204:207],v[92:95],v[164:167]
v_exp_f32 v105,v105
v_mfma_f32_16x16x32_bf16 v[168:171],a[208:211],v[88:91],0
ds_read_b128 a[160:163],v10 offset:24576
v_cvt_pk_bf16_f32 v84,v104,v105
v_mfma_f32_16x16x32_bf16 v[168:171],a[212:215],v[92:95],v[168:171]
v_exp_f32 v106,v106
v_mfma_f32_16x16x32_bf16 v[172:175],a[216:219],v[88:91],0
ds_read_b128 a[164:167],v11 offset:24576
v_cvt_pk_bf16_f32 v232,v240,v241
v_mfma_f32_16x16x32_bf16 v[172:175],a[220:223],v[92:95],v[172:175]
v_exp_f32 v107,v107
v_mfma_f32_16x16x32_bf16 v[176:179],a[224:227],v[88:91],0
ds_read_b128 a[168:171],v12 offset:24576
v_cvt_pk_bf16_f32 v85,v106,v107
v_mfma_f32_16x16x32_bf16 v[176:179],a[228:231],v[92:95],v[176:179]
v_exp_f32 v108,v108
v_mfma_f32_16x16x32_bf16 v[180:183],a[232:235],v[88:91],0
ds_read_b128 a[172:175],v13 offset:24576
v_cvt_pk_bf16_f32 v233,v242,v243
v_mfma_f32_16x16x32_bf16 v[180:183],a[236:239],v[92:95],v[180:183]
v_exp_f32 v109,v109
v_mfma_f32_16x16x32_bf16 v[184:187],a[240:243],v[88:91],0
ds_read_b128 a[176:179],v10 offset:28672
v_cvt_pk_bf16_f32 v86,v108,v109
v_mfma_f32_16x16x32_bf16 v[184:187],a[244:247],v[92:95],v[184:187]
s_add_u32 m0,s39,98304
v_exp_f32 v110,v110
v_mfma_f32_16x16x32_bf16 v[188:191],a[248:251],v[88:91],0
ds_read_b128 a[180:183],v11 offset:28672
v_cvt_pk_bf16_f32 v234,v244,v245
v_mfma_f32_16x16x32_bf16 v[188:191],a[252:255],v[92:95],v[188:191]
buffer_load_dwordx4 v8,s[12:15],s48 offen nt lds
v_exp_f32 v111,v111
v_mfma_f32_16x16x32_bf16 v[52:55],v[44:47],v[88:91],0
ds_read_b128 a[184:187],v12 offset:28672
v_cvt_pk_bf16_f32 v87,v110,v111
v_mfma_f32_16x16x32_bf16 v[52:55],v[44:47],v[92:95],v[52:55]
ds_read_b128 a[188:191],v13 offset:28672
v_cvt_pk_bf16_f32 v235,v246,v247
v_mfma_f32_16x16x32_bf16 v[192:195],a[192:195],v[80:83],0
v_cvt_pk_bf16_f32 v236,v248,v249
v_cvt_pk_bf16_f32 v237,v250,v251
v_mfma_f32_16x16x32_bf16 v[192:195],a[196:199],v[84:87],v[192:195]
v_exp_f32 v112,v112
v_mfma_f32_16x16x32_bf16 v[196:199],a[200:203],v[80:83],0
v_cvt_pk_bf16_f32 v238,v252,v253
v_cvt_pk_bf16_f32 v239,v254,v255
v_mfma_f32_16x16x32_bf16 v[196:199],a[204:207],v[84:87],v[196:199]
v_exp_f32 v113,v113
v_mfma_f32_16x16x32_bf16 v[200:203],a[208:211],v[80:83],0
v_cvt_pk_bf16_f32 v88,v112,v113
v_accvgpr_write_b32 a48,v224
v_mfma_f32_16x16x32_bf16 v[200:203],a[212:215],v[84:87],v[200:203]
v_exp_f32 v114,v114
v_mfma_f32_16x16x32_bf16 v[204:207],a[216:219],v[80:83],0
v_accvgpr_write_b32 a49,v225
v_accvgpr_write_b32 a50,v226
v_mfma_f32_16x16x32_bf16 v[204:207],a[220:223],v[84:87],v[204:207]
v_exp_f32 v115,v115
v_mfma_f32_16x16x32_bf16 v[208:211],a[224:227],v[80:83],0
v_cvt_pk_bf16_f32 v89,v114,v115
v_accvgpr_write_b32 a51,v227
v_mfma_f32_16x16x32_bf16 v[208:211],a[228:231],v[84:87],v[208:211]
v_exp_f32 v116,v116
v_mfma_f32_16x16x32_bf16 v[212:215],a[232:235],v[80:83],0
v_accvgpr_write_b32 a52,v228
v_accvgpr_write_b32 a53,v229
v_mfma_f32_16x16x32_bf16 v[212:215],a[236:239],v[84:87],v[212:215]
v_exp_f32 v117,v117
v_mfma_f32_16x16x32_bf16 v[216:219],a[240:243],v[80:83],0
buffer_load_dwordx4 v9,s[12:15],s48 offen offset:1024 nt lds
v_cvt_pk_bf16_f32 v90,v116,v117
v_accvgpr_write_b32 a54,v230
v_mfma_f32_16x16x32_bf16 v[216:219],a[244:247],v[84:87],v[216:219]
v_exp_f32 v118,v118
v_mfma_f32_16x16x32_bf16 v[220:223],a[248:251],v[80:83],0
s_waitcnt lgkmcnt(0)
v_accvgpr_write_b32 a55,v231
v_mfma_f32_16x16x32_bf16 v[220:223],a[252:255],v[84:87],v[220:223]
v_exp_f32 v119,v119
v_mfma_f32_16x16x32_bf16 v[56:59],v[44:47],v[80:83],0
v_cvt_pk_bf16_f32 v91,v118,v119
v_accvgpr_write_b32 a56,v232
v_mfma_f32_16x16x32_bf16 v[56:59],v[44:47],v[84:87],v[56:59]
v_exp_f32 v120,v120
v_mfma_f32_16x16x32_bf16 v[96:99],a[128:131],a[64:67],v[64:67]
v_accvgpr_write_b32 a57,v233
v_accvgpr_write_b32 a58,v234
v_mfma_f32_16x16x32_bf16 v[96:99],a[132:135],a[68:71],v[96:99]
v_exp_f32 v121,v121
v_mfma_f32_16x16x32_bf16 v[96:99],a[136:139],a[72:75],v[96:99]
v_cvt_pk_bf16_f32 v92,v120,v121
v_accvgpr_write_b32 a59,v235
v_mfma_f32_16x16x32_bf16 v[96:99],a[140:143],a[76:79],v[96:99]
v_exp_f32 v122,v122
v_mfma_f32_16x16x32_bf16 v[100:103],a[144:147],a[64:67],v[64:67]
v_accvgpr_write_b32 a60,v236
v_accvgpr_write_b32 a61,v237
v_mfma_f32_16x16x32_bf16 v[100:103],a[148:151],a[68:71],v[100:103]
v_exp_f32 v123,v123
v_mfma_f32_16x16x32_bf16 v[100:103],a[152:155],a[72:75],v[100:103]
v_cvt_pk_bf16_f32 v93,v122,v123
v_accvgpr_write_b32 a62,v238
v_mfma_f32_16x16x32_bf16 v[100:103],a[156:159],a[76:79],v[100:103]
v_exp_f32 v124,v124
v_mfma_f32_16x16x32_bf16 v[104:107],a[160:163],a[64:67],v[64:67]
v_accvgpr_write_b32 a63,v239
v_mfma_f32_16x16x32_bf16 v[104:107],a[164:167],a[68:71],v[104:107]
v_exp_f32 v125,v125
v_mfma_f32_16x16x32_bf16 v[104:107],a[168:171],a[72:75],v[104:107]
v_cvt_pk_bf16_f32 v94,v124,v125
v_mfma_f32_16x16x32_bf16 v[104:107],a[172:175],a[76:79],v[104:107]
buffer_load_dwordx4 v8,s[12:15],s48 offen offset:2048 nt lds
v_exp_f32 v126,v126
v_mfma_f32_16x16x32_bf16 v[108:111],a[176:179],a[64:67],v[64:67]
v_mfma_f32_16x16x32_bf16 v[108:111],a[180:183],a[68:71],v[108:111]
v_exp_f32 v127,v127
v_mfma_f32_16x16x32_bf16 v[108:111],a[184:187],a[72:75],v[108:111]
v_cvt_pk_bf16_f32 v95,v126,v127
v_mfma_f32_16x16x32_bf16 v[108:111],a[188:191],a[76:79],v[108:111]
v_mfma_f32_16x16x32_bf16 v[224:227],a[192:195],v[88:91],0
v_mfma_f32_16x16x32_bf16 v[224:227],a[196:199],v[92:95],v[224:227]
v_exp_f32 v96,v96
v_mfma_f32_16x16x32_bf16 v[228:231],a[200:203],v[88:91],0
ds_read_b64_tr_b16 a[192:193],v14 offset:16384
ds_read_b64_tr_b16 a[194:195],v14 offset:20480
v_mfma_f32_16x16x32_bf16 v[228:231],a[204:207],v[92:95],v[228:231]
v_exp_f32 v97,v97
v_mfma_f32_16x16x32_bf16 v[232:235],a[208:211],v[88:91],0
ds_read_b64_tr_b16 a[196:197],v14 offset:24576
v_cvt_pk_bf16_f32 v80,v96,v97
v_mfma_f32_16x16x32_bf16 v[232:235],a[212:215],v[92:95],v[232:235]
v_exp_f32 v98,v98
v_mfma_f32_16x16x32_bf16 v[236:239],a[216:219],v[88:91],0
ds_read_b64_tr_b16 a[198:199],v14 offset:28672
ds_read_b64_tr_b16 a[200:201],v15 offset:16384
v_mfma_f32_16x16x32_bf16 v[236:239],a[220:223],v[92:95],v[236:239]
v_exp_f32 v99,v99
v_mfma_f32_16x16x32_bf16 v[240:243],a[224:227],v[88:91],0
ds_read_b64_tr_b16 a[202:203],v15 offset:20480
v_cvt_pk_bf16_f32 v81,v98,v99
v_mfma_f32_16x16x32_bf16 v[240:243],a[228:231],v[92:95],v[240:243]
v_exp_f32 v100,v100
v_mfma_f32_16x16x32_bf16 v[244:247],a[232:235],v[88:91],0
ds_read_b64_tr_b16 a[204:205],v15 offset:24576
ds_read_b64_tr_b16 a[206:207],v15 offset:28672
v_mfma_f32_16x16x32_bf16 v[244:247],a[236:239],v[92:95],v[244:247]
v_exp_f32 v101,v101
v_mfma_f32_16x16x32_bf16 v[248:251],a[240:243],v[88:91],0
ds_read_b64_tr_b16 a[208:209],v16 offset:16384
v_cvt_pk_bf16_f32 v82,v100,v101
v_mfma_f32_16x16x32_bf16 v[248:251],a[244:247],v[92:95],v[248:251]
buffer_load_dwordx4 v9,s[12:15],s48 offen offset:3072 nt lds
v_exp_f32 v102,v102
v_mfma_f32_16x16x32_bf16 v[252:255],a[248:251],v[88:91],0
ds_read_b64_tr_b16 a[210:211],v16 offset:20480
ds_read_b64_tr_b16 a[212:213],v16 offset:24576
v_mfma_f32_16x16x32_bf16 v[252:255],a[252:255],v[92:95],v[252:255]
v_exp_f32 v103,v103
v_mfma_f32_16x16x32_bf16 v[60:63],v[44:47],v[88:91],0
ds_read_b64_tr_b16 a[214:215],v16 offset:28672
v_cvt_pk_bf16_f32 v83,v102,v103
v_mfma_f32_16x16x32_bf16 v[60:63],v[44:47],v[92:95],v[60:63]
v_exp_f32 v104,v104
v_mfma_f32_16x16x32_bf16 v[112:115],a[128:131],a[80:83],v[68:71]
ds_read_b64_tr_b16 a[216:217],v17 offset:16384
ds_read_b64_tr_b16 a[218:219],v17 offset:20480
v_mfma_f32_16x16x32_bf16 v[112:115],a[132:135],a[84:87],v[112:115]
v_exp_f32 v105,v105
v_mfma_f32_16x16x32_bf16 v[112:115],a[136:139],a[88:91],v[112:115]
ds_read_b64_tr_b16 a[220:221],v17 offset:24576
v_cvt_pk_bf16_f32 v84,v104,v105
v_mfma_f32_16x16x32_bf16 v[112:115],a[140:143],a[92:95],v[112:115]
v_exp_f32 v106,v106
v_mfma_f32_16x16x32_bf16 v[116:119],a[144:147],a[80:83],v[68:71]
ds_read_b64_tr_b16 a[222:223],v17 offset:28672
ds_read_b64_tr_b16 a[224:225],v18 offset:16384
v_mfma_f32_16x16x32_bf16 v[116:119],a[148:151],a[84:87],v[116:119]
v_exp_f32 v107,v107
v_mfma_f32_16x16x32_bf16 v[116:119],a[152:155],a[88:91],v[116:119]
ds_read_b64_tr_b16 a[226:227],v18 offset:20480
v_cvt_pk_bf16_f32 v85,v106,v107
v_mfma_f32_16x16x32_bf16 v[116:119],a[156:159],a[92:95],v[116:119]
v_exp_f32 v108,v108
v_mfma_f32_16x16x32_bf16 v[120:123],a[160:163],a[80:83],v[68:71]
ds_read_b64_tr_b16 a[228:229],v18 offset:24576
ds_read_b64_tr_b16 a[230:231],v18 offset:28672
v_mfma_f32_16x16x32_bf16 v[120:123],a[164:167],a[84:87],v[120:123]
v_exp_f32 v109,v109
v_mfma_f32_16x16x32_bf16 v[120:123],a[168:171],a[88:91],v[120:123]
ds_read_b64_tr_b16 a[232:233],v19 offset:16384
v_cvt_pk_bf16_f32 v86,v108,v109
v_mfma_f32_16x16x32_bf16 v[120:123],a[172:175],a[92:95],v[120:123]
s_mov_b32 s48,311296
v_exp_f32 v110,v110
v_mfma_f32_16x16x32_bf16 v[124:127],a[176:179],a[80:83],v[68:71]
ds_read_b64_tr_b16 a[234:235],v19 offset:20480
ds_read_b64_tr_b16 a[236:237],v19 offset:24576
s_add_u32 m0,s39,49152
v_mfma_f32_16x16x32_bf16 v[124:127],a[180:183],a[84:87],v[124:127]
buffer_load_dwordx4 v4,s[8:11],s48 offen nt lds
v_exp_f32 v111,v111
v_mfma_f32_16x16x32_bf16 v[124:127],a[184:187],a[88:91],v[124:127]
ds_read_b64_tr_b16 a[238:239],v19 offset:28672
v_cvt_pk_bf16_f32 v87,v110,v111
v_mfma_f32_16x16x32_bf16 v[124:127],a[188:191],a[92:95],v[124:127]
ds_read_b64_tr_b16 a[240:241],v20 offset:16384
ds_read_b64_tr_b16 a[242:243],v20 offset:20480
v_mfma_f32_16x16x32_bf16 v[96:99],a[128:131],a[96:99],v[72:75]
ds_read_b64_tr_b16 a[244:245],v20 offset:24576
ds_read_b64_tr_b16 a[246:247],v20 offset:28672
v_mfma_f32_16x16x32_bf16 v[96:99],a[132:135],a[100:103],v[96:99]
v_exp_f32 v112,v112
v_mfma_f32_16x16x32_bf16 v[96:99],a[136:139],a[104:107],v[96:99]
ds_read_b64_tr_b16 a[248:249],v21 offset:16384
ds_read_b64_tr_b16 a[250:251],v21 offset:20480
v_mfma_f32_16x16x32_bf16 v[96:99],a[140:143],a[108:111],v[96:99]
v_exp_f32 v113,v113
v_mfma_f32_16x16x32_bf16 v[100:103],a[144:147],a[96:99],v[72:75]
ds_read_b64_tr_b16 a[252:253],v21 offset:24576
v_cvt_pk_bf16_f32 v88,v112,v113
v_mfma_f32_16x16x32_bf16 v[100:103],a[148:151],a[100:103],v[100:103]
v_exp_f32 v114,v114
v_mfma_f32_16x16x32_bf16 v[100:103],a[152:155],a[104:107],v[100:103]
ds_read_b64_tr_b16 a[254:255],v21 offset:28672
v_mfma_f32_16x16x32_bf16 v[100:103],a[156:159],a[108:111],v[100:103]
v_exp_f32 v115,v115
v_mfma_f32_16x16x32_bf16 v[104:107],a[160:163],a[96:99],v[72:75]
v_cvt_pk_bf16_f32 v89,v114,v115
v_mfma_f32_16x16x32_bf16 v[104:107],a[164:167],a[100:103],v[104:107]
v_exp_f32 v116,v116
v_mfma_f32_16x16x32_bf16 v[104:107],a[168:171],a[104:107],v[104:107]
v_mfma_f32_16x16x32_bf16 v[104:107],a[172:175],a[108:111],v[104:107]
v_exp_f32 v117,v117
v_mfma_f32_16x16x32_bf16 v[108:111],a[176:179],a[96:99],v[72:75]
buffer_load_dwordx4 v5,s[8:11],s48 offen offset:1024 nt lds
v_cvt_pk_bf16_f32 v90,v116,v117
v_mfma_f32_16x16x32_bf16 v[108:111],a[180:183],a[100:103],v[108:111]
v_exp_f32 v118,v118
v_mfma_f32_16x16x32_bf16 v[108:111],a[184:187],a[104:107],v[108:111]
s_waitcnt lgkmcnt(0)
v_mfma_f32_16x16x32_bf16 v[108:111],a[188:191],a[108:111],v[108:111]
v_exp_f32 v119,v119
v_mfma_f32_16x16x32_bf16 v[128:131],a[192:195],v[80:83],v[128:131]
v_cvt_pk_bf16_f32 v91,v118,v119
v_mfma_f32_16x16x32_bf16 v[128:131],a[196:199],v[84:87],v[128:131]
v_exp_f32 v120,v120
v_mfma_f32_16x16x32_bf16 v[132:135],a[200:203],v[80:83],v[132:135]
v_mfma_f32_16x16x32_bf16 v[132:135],a[204:207],v[84:87],v[132:135]
v_exp_f32 v121,v121
v_mfma_f32_16x16x32_bf16 v[136:139],a[208:211],v[80:83],v[136:139]
v_cvt_pk_bf16_f32 v92,v120,v121
v_mfma_f32_16x16x32_bf16 v[136:139],a[212:215],v[84:87],v[136:139]
v_exp_f32 v122,v122
v_mfma_f32_16x16x32_bf16 v[140:143],a[216:219],v[80:83],v[140:143]
v_mfma_f32_16x16x32_bf16 v[140:143],a[220:223],v[84:87],v[140:143]
v_exp_f32 v123,v123
v_mfma_f32_16x16x32_bf16 v[144:147],a[224:227],v[80:83],v[144:147]
v_cvt_pk_bf16_f32 v93,v122,v123
v_mfma_f32_16x16x32_bf16 v[144:147],a[228:231],v[84:87],v[144:147]
v_exp_f32 v124,v124
v_mfma_f32_16x16x32_bf16 v[148:151],a[232:235],v[80:83],v[148:151]
v_mfma_f32_16x16x32_bf16 v[148:151],a[236:239],v[84:87],v[148:151]
v_exp_f32 v125,v125
v_mfma_f32_16x16x32_bf16 v[152:155],a[240:243],v[80:83],v[152:155]
v_cvt_pk_bf16_f32 v94,v124,v125
v_mfma_f32_16x16x32_bf16 v[152:155],a[244:247],v[84:87],v[152:155]
buffer_load_dwordx4 v6,s[8:11],s48 offen offset:2048 nt lds
v_exp_f32 v126,v126
v_mfma_f32_16x16x32_bf16 v[156:159],a[248:251],v[80:83],v[156:159]
v_mfma_f32_16x16x32_bf16 v[156:159],a[252:255],v[84:87],v[156:159]
v_exp_f32 v127,v127
v_mfma_f32_16x16x32_bf16 v[48:51],v[44:47],v[80:83],v[48:51]
v_cvt_pk_bf16_f32 v95,v126,v127
v_mfma_f32_16x16x32_bf16 v[48:51],v[44:47],v[84:87],v[48:51]
s_waitcnt vmcnt(3)
s_barrier
v_mfma_f32_16x16x32_bf16 v[112:115],a[128:131],a[112:115],v[76:79]
v_mfma_f32_16x16x32_bf16 v[112:115],a[132:135],a[116:119],v[112:115]
v_exp_f32 v96,v96
v_mfma_f32_16x16x32_bf16 v[112:115],a[136:139],a[120:123],v[112:115]
v_mfma_f32_16x16x32_bf16 v[112:115],a[140:143],a[124:127],v[112:115]
v_exp_f32 v97,v97
v_mfma_f32_16x16x32_bf16 v[116:119],a[144:147],a[112:115],v[76:79]
ds_read_b128 a[128:131],v10 offset:32768
v_cvt_pk_bf16_f32 v80,v96,v97
v_mfma_f32_16x16x32_bf16 v[116:119],a[148:151],a[116:119],v[116:119]
v_exp_f32 v98,v98
v_mfma_f32_16x16x32_bf16 v[116:119],a[152:155],a[120:123],v[116:119]
ds_read_b128 a[132:135],v11 offset:32768
v_mfma_f32_16x16x32_bf16 v[116:119],a[156:159],a[124:127],v[116:119]
v_exp_f32 v99,v99
v_mfma_f32_16x16x32_bf16 v[120:123],a[160:163],a[112:115],v[76:79]
ds_read_b128 a[136:139],v12 offset:32768
v_cvt_pk_bf16_f32 v81,v98,v99
v_mfma_f32_16x16x32_bf16 v[120:123],a[164:167],a[116:119],v[120:123]
v_exp_f32 v100,v100
v_mfma_f32_16x16x32_bf16 v[120:123],a[168:171],a[120:123],v[120:123]
ds_read_b128 a[140:143],v13 offset:32768
v_mfma_f32_16x16x32_bf16 v[120:123],a[172:175],a[124:127],v[120:123]
v_exp_f32 v101,v101
v_mfma_f32_16x16x32_bf16 v[124:127],a[176:179],a[112:115],v[76:79]
ds_read_b128 a[144:147],v10 offset:36864
v_cvt_pk_bf16_f32 v82,v100,v101
v_mfma_f32_16x16x32_bf16 v[124:127],a[180:183],a[116:119],v[124:127]
buffer_load_dwordx4 v7,s[8:11],s48 offen offset:3072 nt lds
v_exp_f32 v102,v102
v_mfma_f32_16x16x32_bf16 v[124:127],a[184:187],a[120:123],v[124:127]
ds_read_b128 a[148:151],v11 offset:36864
v_mfma_f32_16x16x32_bf16 v[124:127],a[188:191],a[124:127],v[124:127]
v_exp_f32 v103,v103
v_mfma_f32_16x16x32_bf16 v[160:163],a[192:195],v[88:91],v[160:163]
ds_read_b128 a[152:155],v12 offset:36864
v_cvt_pk_bf16_f32 v83,v102,v103
v_mfma_f32_16x16x32_bf16 v[160:163],a[196:199],v[92:95],v[160:163]
v_exp_f32 v104,v104
v_mfma_f32_16x16x32_bf16 v[164:167],a[200:203],v[88:91],v[164:167]
ds_read_b128 a[156:159],v13 offset:36864
v_mfma_f32_16x16x32_bf16 v[164:167],a[204:207],v[92:95],v[164:167]
v_exp_f32 v105,v105
v_mfma_f32_16x16x32_bf16 v[168:171],a[208:211],v[88:91],v[168:171]
ds_read_b128 a[160:163],v10 offset:40960
v_cvt_pk_bf16_f32 v84,v104,v105
v_mfma_f32_16x16x32_bf16 v[168:171],a[212:215],v[92:95],v[168:171]
v_exp_f32 v106,v106
v_mfma_f32_16x16x32_bf16 v[172:175],a[216:219],v[88:91],v[172:175]
ds_read_b128 a[164:167],v11 offset:40960
v_mfma_f32_16x16x32_bf16 v[172:175],a[220:223],v[92:95],v[172:175]
v_exp_f32 v107,v107
v_mfma_f32_16x16x32_bf16 v[176:179],a[224:227],v[88:91],v[176:179]
ds_read_b128 a[168:171],v12 offset:40960
v_cvt_pk_bf16_f32 v85,v106,v107
v_mfma_f32_16x16x32_bf16 v[176:179],a[228:231],v[92:95],v[176:179]
v_exp_f32 v108,v108
v_mfma_f32_16x16x32_bf16 v[180:183],a[232:235],v[88:91],v[180:183]
ds_read_b128 a[172:175],v13 offset:40960
v_mfma_f32_16x16x32_bf16 v[180:183],a[236:239],v[92:95],v[180:183]
v_exp_f32 v109,v109
v_mfma_f32_16x16x32_bf16 v[184:187],a[240:243],v[88:91],v[184:187]
ds_read_b128 a[176:179],v10 offset:45056
v_cvt_pk_bf16_f32 v86,v108,v109
v_mfma_f32_16x16x32_bf16 v[184:187],a[244:247],v[92:95],v[184:187]
s_add_u32 m0,s39,114688
v_exp_f32 v110,v110
v_mfma_f32_16x16x32_bf16 v[188:191],a[248:251],v[88:91],v[188:191]
ds_read_b128 a[180:183],v11 offset:45056
v_mfma_f32_16x16x32_bf16 v[188:191],a[252:255],v[92:95],v[188:191]
buffer_load_dwordx4 v8,s[12:15],s48 offen nt lds
v_exp_f32 v111,v111
v_mfma_f32_16x16x32_bf16 v[52:55],v[44:47],v[88:91],v[52:55]
ds_read_b128 a[184:187],v12 offset:45056
v_cvt_pk_bf16_f32 v87,v110,v111
v_mfma_f32_16x16x32_bf16 v[52:55],v[44:47],v[92:95],v[52:55]
ds_read_b128 a[188:191],v13 offset:45056
v_mfma_f32_16x16x32_bf16 v[192:195],a[192:195],v[80:83],v[192:195]
v_mfma_f32_16x16x32_bf16 v[192:195],a[196:199],v[84:87],v[192:195]
v_exp_f32 v112,v112
v_mfma_f32_16x16x32_bf16 v[196:199],a[200:203],v[80:83],v[196:199]
v_mfma_f32_16x16x32_bf16 v[196:199],a[204:207],v[84:87],v[196:199]
v_exp_f32 v113,v113
v_mfma_f32_16x16x32_bf16 v[200:203],a[208:211],v[80:83],v[200:203]
v_cvt_pk_bf16_f32 v88,v112,v113
v_mfma_f32_16x16x32_bf16 v[200:203],a[212:215],v[84:87],v[200:203]
v_exp_f32 v114,v114
v_mfma_f32_16x16x32_bf16 v[204:207],a[216:219],v[80:83],v[204:207]
v_mfma_f32_16x16x32_bf16 v[204:207],a[220:223],v[84:87],v[204:207]
v_exp_f32 v115,v115
v_mfma_f32_16x16x32_bf16 v[208:211],a[224:227],v[80:83],v[208:211]
v_cvt_pk_bf16_f32 v89,v114,v115
v_mfma_f32_16x16x32_bf16 v[208:211],a[228:231],v[84:87],v[208:211]
v_exp_f32 v116,v116
v_mfma_f32_16x16x32_bf16 v[212:215],a[232:235],v[80:83],v[212:215]
v_mfma_f32_16x16x32_bf16 v[212:215],a[236:239],v[84:87],v[212:215]
v_exp_f32 v117,v117
v_mfma_f32_16x16x32_bf16 v[216:219],a[240:243],v[80:83],v[216:219]
buffer_load_dwordx4 v9,s[12:15],s48 offen offset:1024 nt lds
v_cvt_pk_bf16_f32 v90,v116,v117
v_mfma_f32_16x16x32_bf16 v[216:219],a[244:247],v[84:87],v[216:219]
v_exp_f32 v118,v118
v_mfma_f32_16x16x32_bf16 v[220:223],a[248:251],v[80:83],v[220:223]
s_waitcnt lgkmcnt(0)
v_mfma_f32_16x16x32_bf16 v[220:223],a[252:255],v[84:87],v[220:223]
v_exp_f32 v119,v119
v_mfma_f32_16x16x32_bf16 v[56:59],v[44:47],v[80:83],v[56:59]
v_cvt_pk_bf16_f32 v91,v118,v119
v_mfma_f32_16x16x32_bf16 v[56:59],v[44:47],v[84:87],v[56:59]
v_exp_f32 v120,v120
v_mfma_f32_16x16x32_bf16 v[96:99],a[128:131],a[64:67],v[64:67]
v_mfma_f32_16x16x32_bf16 v[96:99],a[132:135],a[68:71],v[96:99]
v_exp_f32 v121,v121
v_mfma_f32_16x16x32_bf16 v[96:99],a[136:139],a[72:75],v[96:99]
v_cvt_pk_bf16_f32 v92,v120,v121
v_mfma_f32_16x16x32_bf16 v[96:99],a[140:143],a[76:79],v[96:99]
v_exp_f32 v122,v122
v_mfma_f32_16x16x32_bf16 v[100:103],a[144:147],a[64:67],v[64:67]
v_mfma_f32_16x16x32_bf16 v[100:103],a[148:151],a[68:71],v[100:103]
v_exp_f32 v123,v123
v_mfma_f32_16x16x32_bf16 v[100:103],a[152:155],a[72:75],v[100:103]
v_cvt_pk_bf16_f32 v93,v122,v123
v_mfma_f32_16x16x32_bf16 v[100:103],a[156:159],a[76:79],v[100:103]
v_exp_f32 v124,v124
v_mfma_f32_16x16x32_bf16 v[104:107],a[160:163],a[64:67],v[64:67]
v_mfma_f32_16x16x32_bf16 v[104:107],a[164:167],a[68:71],v[104:107]
v_exp_f32 v125,v125
v_mfma_f32_16x16x32_bf16 v[104:107],a[168:171],a[72:75],v[104:107]
v_cvt_pk_bf16_f32 v94,v124,v125
v_mfma_f32_16x16x32_bf16 v[104:107],a[172:175],a[76:79],v[104:107]
buffer_load_dwordx4 v8,s[12:15],s48 offen offset:2048 nt lds
v_exp_f32 v126,v126
v_mfma_f32_16x16x32_bf16 v[108:111],a[176:179],a[64:67],v[64:67]
v_mfma_f32_16x16x32_bf16 v[108:111],a[180:183],a[68:71],v[108:111]
v_exp_f32 v127,v127
v_mfma_f32_16x16x32_bf16 v[108:111],a[184:187],a[72:75],v[108:111]
v_cvt_pk_bf16_f32 v95,v126,v127
v_mfma_f32_16x16x32_bf16 v[108:111],a[188:191],a[76:79],v[108:111]
v_mfma_f32_16x16x32_bf16 v[224:227],a[192:195],v[88:91],v[224:227]
v_mfma_f32_16x16x32_bf16 v[224:227],a[196:199],v[92:95],v[224:227]
v_exp_f32 v96,v96
v_mfma_f32_16x16x32_bf16 v[228:231],a[200:203],v[88:91],v[228:231]
ds_read_b64_tr_b16 a[192:193],v14 offset:32768
ds_read_b64_tr_b16 a[194:195],v14 offset:36864
v_mfma_f32_16x16x32_bf16 v[228:231],a[204:207],v[92:95],v[228:231]
v_exp_f32 v97,v97
v_mfma_f32_16x16x32_bf16 v[232:235],a[208:211],v[88:91],v[232:235]
ds_read_b64_tr_b16 a[196:197],v14 offset:40960
v_cvt_pk_bf16_f32 v80,v96,v97
v_mfma_f32_16x16x32_bf16 v[232:235],a[212:215],v[92:95],v[232:235]
v_exp_f32 v98,v98
v_mfma_f32_16x16x32_bf16 v[236:239],a[216:219],v[88:91],v[236:239]
ds_read_b64_tr_b16 a[198:199],v14 offset:45056
ds_read_b64_tr_b16 a[200:201],v15 offset:32768
v_mfma_f32_16x16x32_bf16 v[236:239],a[220:223],v[92:95],v[236:239]
v_exp_f32 v99,v99
v_mfma_f32_16x16x32_bf16 v[240:243],a[224:227],v[88:91],v[240:243]
ds_read_b64_tr_b16 a[202:203],v15 offset:36864
v_cvt_pk_bf16_f32 v81,v98,v99
v_mfma_f32_16x16x32_bf16 v[240:243],a[228:231],v[92:95],v[240:243]
v_exp_f32 v100,v100
v_mfma_f32_16x16x32_bf16 v[244:247],a[232:235],v[88:91],v[244:247]
ds_read_b64_tr_b16 a[204:205],v15 offset:40960
ds_read_b64_tr_b16 a[206:207],v15 offset:45056
v_mfma_f32_16x16x32_bf16 v[244:247],a[236:239],v[92:95],v[244:247]
v_exp_f32 v101,v101
v_mfma_f32_16x16x32_bf16 v[248:251],a[240:243],v[88:91],v[248:251]
ds_read_b64_tr_b16 a[208:209],v16 offset:32768
v_cvt_pk_bf16_f32 v82,v100,v101
v_mfma_f32_16x16x32_bf16 v[248:251],a[244:247],v[92:95],v[248:251]
buffer_load_dwordx4 v9,s[12:15],s48 offen offset:3072 nt lds
v_exp_f32 v102,v102
v_mfma_f32_16x16x32_bf16 v[252:255],a[248:251],v[88:91],v[252:255]
ds_read_b64_tr_b16 a[210:211],v16 offset:36864
ds_read_b64_tr_b16 a[212:213],v16 offset:40960
v_mfma_f32_16x16x32_bf16 v[252:255],a[252:255],v[92:95],v[252:255]
v_exp_f32 v103,v103
v_mfma_f32_16x16x32_bf16 v[60:63],v[44:47],v[88:91],v[60:63]
ds_read_b64_tr_b16 a[214:215],v16 offset:45056
v_cvt_pk_bf16_f32 v83,v102,v103
v_mfma_f32_16x16x32_bf16 v[60:63],v[44:47],v[92:95],v[60:63]
v_exp_f32 v104,v104
v_mfma_f32_16x16x32_bf16 v[112:115],a[128:131],a[80:83],v[68:71]
ds_read_b64_tr_b16 a[216:217],v17 offset:32768
ds_read_b64_tr_b16 a[218:219],v17 offset:36864
v_mfma_f32_16x16x32_bf16 v[112:115],a[132:135],a[84:87],v[112:115]
v_exp_f32 v105,v105
v_mfma_f32_16x16x32_bf16 v[112:115],a[136:139],a[88:91],v[112:115]
ds_read_b64_tr_b16 a[220:221],v17 offset:40960
v_cvt_pk_bf16_f32 v84,v104,v105
v_mfma_f32_16x16x32_bf16 v[112:115],a[140:143],a[92:95],v[112:115]
v_exp_f32 v106,v106
v_mfma_f32_16x16x32_bf16 v[116:119],a[144:147],a[80:83],v[68:71]
ds_read_b64_tr_b16 a[222:223],v17 offset:45056
ds_read_b64_tr_b16 a[224:225],v18 offset:32768
v_mfma_f32_16x16x32_bf16 v[116:119],a[148:151],a[84:87],v[116:119]
v_exp_f32 v107,v107
v_mfma_f32_16x16x32_bf16 v[116:119],a[152:155],a[88:91],v[116:119]
ds_read_b64_tr_b16 a[226:227],v18 offset:36864
v_cvt_pk_bf16_f32 v85,v106,v107
v_mfma_f32_16x16x32_bf16 v[116:119],a[156:159],a[92:95],v[116:119]
v_exp_f32 v108,v108
v_mfma_f32_16x16x32_bf16 v[120:123],a[160:163],a[80:83],v[68:71]
ds_read_b64_tr_b16 a[228:229],v18 offset:40960
ds_read_b64_tr_b16 a[230:231],v18 offset:45056
v_mfma_f32_16x16x32_bf16 v[120:123],a[164:167],a[84:87],v[120:123]
v_exp_f32 v109,v109
v_mfma_f32_16x16x32_bf16 v[120:123],a[168:171],a[88:91],v[120:123]
ds_read_b64_tr_b16 a[232:233],v19 offset:32768
v_cvt_pk_bf16_f32 v86,v108,v109
v_mfma_f32_16x16x32_bf16 v[120:123],a[172:175],a[92:95],v[120:123]
s_mov_b32 s48,327680
v_exp_f32 v110,v110
v_mfma_f32_16x16x32_bf16 v[124:127],a[176:179],a[80:83],v[68:71]
ds_read_b64_tr_b16 a[234:235],v19 offset:36864
ds_read_b64_tr_b16 a[236:237],v19 offset:40960
s_add_u32 m0,s39,0
v_mfma_f32_16x16x32_bf16 v[124:127],a[180:183],a[84:87],v[124:127]
buffer_load_dwordx4 v4,s[8:11],s48 offen nt lds
v_exp_f32 v111,v111
v_mfma_f32_16x16x32_bf16 v[124:127],a[184:187],a[88:91],v[124:127]
ds_read_b64_tr_b16 a[238:239],v19 offset:45056
v_cvt_pk_bf16_f32 v87,v110,v111
v_mfma_f32_16x16x32_bf16 v[124:127],a[188:191],a[92:95],v[124:127]
ds_read_b64_tr_b16 a[240:241],v20 offset:32768
ds_read_b64_tr_b16 a[242:243],v20 offset:36864
v_mfma_f32_16x16x32_bf16 v[96:99],a[128:131],a[96:99],v[72:75]
ds_read_b64_tr_b16 a[244:245],v20 offset:40960
ds_read_b64_tr_b16 a[246:247],v20 offset:45056
v_mfma_f32_16x16x32_bf16 v[96:99],a[132:135],a[100:103],v[96:99]
v_exp_f32 v112,v112
v_mfma_f32_16x16x32_bf16 v[96:99],a[136:139],a[104:107],v[96:99]
ds_read_b64_tr_b16 a[248:249],v21 offset:32768
ds_read_b64_tr_b16 a[250:251],v21 offset:36864
v_mfma_f32_16x16x32_bf16 v[96:99],a[140:143],a[108:111],v[96:99]
v_exp_f32 v113,v113
v_mfma_f32_16x16x32_bf16 v[100:103],a[144:147],a[96:99],v[72:75]
ds_read_b64_tr_b16 a[252:253],v21 offset:40960
v_cvt_pk_bf16_f32 v88,v112,v113
v_mfma_f32_16x16x32_bf16 v[100:103],a[148:151],a[100:103],v[100:103]
v_exp_f32 v114,v114
v_mfma_f32_16x16x32_bf16 v[100:103],a[152:155],a[104:107],v[100:103]
ds_read_b64_tr_b16 a[254:255],v21 offset:45056
v_mfma_f32_16x16x32_bf16 v[100:103],a[156:159],a[108:111],v[100:103]
v_exp_f32 v115,v115
v_mfma_f32_16x16x32_bf16 v[104:107],a[160:163],a[96:99],v[72:75]
v_cvt_pk_bf16_f32 v89,v114,v115
v_mfma_f32_16x16x32_bf16 v[104:107],a[164:167],a[100:103],v[104:107]
v_exp_f32 v116,v116
v_mfma_f32_16x16x32_bf16 v[104:107],a[168:171],a[104:107],v[104:107]
v_mfma_f32_16x16x32_bf16 v[104:107],a[172:175],a[108:111],v[104:107]
v_exp_f32 v117,v117
v_mfma_f32_16x16x32_bf16 v[108:111],a[176:179],a[96:99],v[72:75]
buffer_load_dwordx4 v5,s[8:11],s48 offen offset:1024 nt lds
v_cvt_pk_bf16_f32 v90,v116,v117
v_mfma_f32_16x16x32_bf16 v[108:111],a[180:183],a[100:103],v[108:111]
v_exp_f32 v118,v118
v_mfma_f32_16x16x32_bf16 v[108:111],a[184:187],a[104:107],v[108:111]
s_waitcnt lgkmcnt(0)
v_mfma_f32_16x16x32_bf16 v[108:111],a[188:191],a[108:111],v[108:111]
v_exp_f32 v119,v119
v_mfma_f32_16x16x32_bf16 v[128:131],a[192:195],v[80:83],v[128:131]
v_cvt_pk_bf16_f32 v91,v118,v119
v_mfma_f32_16x16x32_bf16 v[128:131],a[196:199],v[84:87],v[128:131]
v_exp_f32 v120,v120
v_mfma_f32_16x16x32_bf16 v[132:135],a[200:203],v[80:83],v[132:135]
v_mfma_f32_16x16x32_bf16 v[132:135],a[204:207],v[84:87],v[132:135]
v_exp_f32 v121,v121
v_mfma_f32_16x16x32_bf16 v[136:139],a[208:211],v[80:83],v[136:139]
v_cvt_pk_bf16_f32 v92,v120,v121
v_mfma_f32_16x16x32_bf16 v[136:139],a[212:215],v[84:87],v[136:139]
v_exp_f32 v122,v122
v_mfma_f32_16x16x32_bf16 v[140:143],a[216:219],v[80:83],v[140:143]
v_mfma_f32_16x16x32_bf16 v[140:143],a[220:223],v[84:87],v[140:143]
v_exp_f32 v123,v123
v_mfma_f32_16x16x32_bf16 v[144:147],a[224:227],v[80:83],v[144:147]
v_cvt_pk_bf16_f32 v93,v122,v123
v_mfma_f32_16x16x32_bf16 v[144:147],a[228:231],v[84:87],v[144:147]
v_exp_f32 v124,v124
v_mfma_f32_16x16x32_bf16 v[148:151],a[232:235],v[80:83],v[148:151]
v_mfma_f32_16x16x32_bf16 v[148:151],a[236:239],v[84:87],v[148:151]
v_exp_f32 v125,v125
v_mfma_f32_16x16x32_bf16 v[152:155],a[240:243],v[80:83],v[152:155]
v_cvt_pk_bf16_f32 v94,v124,v125
v_mfma_f32_16x16x32_bf16 v[152:155],a[244:247],v[84:87],v[152:155]
buffer_load_dwordx4 v6,s[8:11],s48 offen offset:2048 nt lds
v_exp_f32 v126,v126
v_mfma_f32_16x16x32_bf16 v[156:159],a[248:251],v[80:83],v[156:159]
v_mfma_f32_16x16x32_bf16 v[156:159],a[252:255],v[84:87],v[156:159]
v_exp_f32 v127,v127
v_mfma_f32_16x16x32_bf16 v[48:51],v[44:47],v[80:83],v[48:51]
v_cvt_pk_bf16_f32 v95,v126,v127
v_mfma_f32_16x16x32_bf16 v[48:51],v[44:47],v[84:87],v[48:51]
s_waitcnt vmcnt(3)
s_barrier
v_mfma_f32_16x16x32_bf16 v[112:115],a[128:131],a[112:115],v[76:79]
v_mfma_f32_16x16x32_bf16 v[112:115],a[132:135],a[116:119],v[112:115]
v_exp_f32 v96,v96
v_mfma_f32_16x16x32_bf16 v[112:115],a[136:139],a[120:123],v[112:115]
v_mfma_f32_16x16x32_bf16 v[112:115],a[140:143],a[124:127],v[112:115]
v_exp_f32 v97,v97
v_mfma_f32_16x16x32_bf16 v[116:119],a[144:147],a[112:115],v[76:79]
ds_read_b128 a[128:131],v10 offset:49152
v_cvt_pk_bf16_f32 v80,v96,v97
v_mfma_f32_16x16x32_bf16 v[116:119],a[148:151],a[116:119],v[116:119]
v_exp_f32 v98,v98
v_mfma_f32_16x16x32_bf16 v[116:119],a[152:155],a[120:123],v[116:119]
ds_read_b128 a[132:135],v11 offset:49152
v_mfma_f32_16x16x32_bf16 v[116:119],a[156:159],a[124:127],v[116:119]
v_exp_f32 v99,v99
v_mfma_f32_16x16x32_bf16 v[120:123],a[160:163],a[112:115],v[76:79]
ds_read_b128 a[136:139],v12 offset:49152
v_cvt_pk_bf16_f32 v81,v98,v99
v_mfma_f32_16x16x32_bf16 v[120:123],a[164:167],a[116:119],v[120:123]
v_exp_f32 v100,v100
v_mfma_f32_16x16x32_bf16 v[120:123],a[168:171],a[120:123],v[120:123]
ds_read_b128 a[140:143],v13 offset:49152
v_mfma_f32_16x16x32_bf16 v[120:123],a[172:175],a[124:127],v[120:123]
v_exp_f32 v101,v101
v_mfma_f32_16x16x32_bf16 v[124:127],a[176:179],a[112:115],v[76:79]
ds_read_b128 a[144:147],v10 offset:53248
v_cvt_pk_bf16_f32 v82,v100,v101
v_mfma_f32_16x16x32_bf16 v[124:127],a[180:183],a[116:119],v[124:127]
buffer_load_dwordx4 v7,s[8:11],s48 offen offset:3072 nt lds
v_exp_f32 v102,v102
v_mfma_f32_16x16x32_bf16 v[124:127],a[184:187],a[120:123],v[124:127]
ds_read_b128 a[148:151],v11 offset:53248
v_mfma_f32_16x16x32_bf16 v[124:127],a[188:191],a[124:127],v[124:127]
v_exp_f32 v103,v103
v_mfma_f32_16x16x32_bf16 v[160:163],a[192:195],v[88:91],v[160:163]
ds_read_b128 a[152:155],v12 offset:53248
v_cvt_pk_bf16_f32 v83,v102,v103
v_mfma_f32_16x16x32_bf16 v[160:163],a[196:199],v[92:95],v[160:163]
v_exp_f32 v104,v104
v_mfma_f32_16x16x32_bf16 v[164:167],a[200:203],v[88:91],v[164:167]
ds_read_b128 a[156:159],v13 offset:53248
v_mfma_f32_16x16x32_bf16 v[164:167],a[204:207],v[92:95],v[164:167]
v_exp_f32 v105,v105
v_mfma_f32_16x16x32_bf16 v[168:171],a[208:211],v[88:91],v[168:171]
ds_read_b128 a[160:163],v10 offset:57344
v_cvt_pk_bf16_f32 v84,v104,v105
v_mfma_f32_16x16x32_bf16 v[168:171],a[212:215],v[92:95],v[168:171]
v_exp_f32 v106,v106
v_mfma_f32_16x16x32_bf16 v[172:175],a[216:219],v[88:91],v[172:175]
ds_read_b128 a[164:167],v11 offset:57344
v_mfma_f32_16x16x32_bf16 v[172:175],a[220:223],v[92:95],v[172:175]
v_exp_f32 v107,v107
v_mfma_f32_16x16x32_bf16 v[176:179],a[224:227],v[88:91],v[176:179]
ds_read_b128 a[168:171],v12 offset:57344
v_cvt_pk_bf16_f32 v85,v106,v107
v_mfma_f32_16x16x32_bf16 v[176:179],a[228:231],v[92:95],v[176:179]
v_exp_f32 v108,v108
v_mfma_f32_16x16x32_bf16 v[180:183],a[232:235],v[88:91],v[180:183]
ds_read_b128 a[172:175],v13 offset:57344
v_mfma_f32_16x16x32_bf16 v[180:183],a[236:239],v[92:95],v[180:183]
v_exp_f32 v109,v109
v_mfma_f32_16x16x32_bf16 v[184:187],a[240:243],v[88:91],v[184:187]
ds_read_b128 a[176:179],v10 offset:61440
v_cvt_pk_bf16_f32 v86,v108,v109
v_mfma_f32_16x16x32_bf16 v[184:187],a[244:247],v[92:95],v[184:187]
s_add_u32 m0,s39,65536
v_exp_f32 v110,v110
v_mfma_f32_16x16x32_bf16 v[188:191],a[248:251],v[88:91],v[188:191]
ds_read_b128 a[180:183],v11 offset:61440
v_mfma_f32_16x16x32_bf16 v[188:191],a[252:255],v[92:95],v[188:191]
buffer_load_dwordx4 v8,s[12:15],s48 offen nt lds
v_exp_f32 v111,v111
v_mfma_f32_16x16x32_bf16 v[52:55],v[44:47],v[88:91],v[52:55]
ds_read_b128 a[184:187],v12 offset:61440
v_cvt_pk_bf16_f32 v87,v110,v111
v_mfma_f32_16x16x32_bf16 v[52:55],v[44:47],v[92:95],v[52:55]
ds_read_b128 a[188:191],v13 offset:61440
v_mfma_f32_16x16x32_bf16 v[192:195],a[192:195],v[80:83],v[192:195]
v_mfma_f32_16x16x32_bf16 v[192:195],a[196:199],v[84:87],v[192:195]
v_exp_f32 v112,v112
v_mfma_f32_16x16x32_bf16 v[196:199],a[200:203],v[80:83],v[196:199]
v_mfma_f32_16x16x32_bf16 v[196:199],a[204:207],v[84:87],v[196:199]
v_exp_f32 v113,v113
v_mfma_f32_16x16x32_bf16 v[200:203],a[208:211],v[80:83],v[200:203]
v_cvt_pk_bf16_f32 v88,v112,v113
v_mfma_f32_16x16x32_bf16 v[200:203],a[212:215],v[84:87],v[200:203]
v_exp_f32 v114,v114
v_mfma_f32_16x16x32_bf16 v[204:207],a[216:219],v[80:83],v[204:207]
v_mfma_f32_16x16x32_bf16 v[204:207],a[220:223],v[84:87],v[204:207]
v_exp_f32 v115,v115
v_mfma_f32_16x16x32_bf16 v[208:211],a[224:227],v[80:83],v[208:211]
v_cvt_pk_bf16_f32 v89,v114,v115
v_mfma_f32_16x16x32_bf16 v[208:211],a[228:231],v[84:87],v[208:211]
v_exp_f32 v116,v116
v_mfma_f32_16x16x32_bf16 v[212:215],a[232:235],v[80:83],v[212:215]
v_mfma_f32_16x16x32_bf16 v[212:215],a[236:239],v[84:87],v[212:215]
v_exp_f32 v117,v117
v_mfma_f32_16x16x32_bf16 v[216:219],a[240:243],v[80:83],v[216:219]
buffer_load_dwordx4 v9,s[12:15],s48 offen offset:1024 nt lds
v_cvt_pk_bf16_f32 v90,v116,v117
v_mfma_f32_16x16x32_bf16 v[216:219],a[244:247],v[84:87],v[216:219]
v_exp_f32 v118,v118
v_mfma_f32_16x16x32_bf16 v[220:223],a[248:251],v[80:83],v[220:223]
s_waitcnt lgkmcnt(0)
v_mfma_f32_16x16x32_bf16 v[220:223],a[252:255],v[84:87],v[220:223]
v_exp_f32 v119,v119
v_mfma_f32_16x16x32_bf16 v[56:59],v[44:47],v[80:83],v[56:59]
v_cvt_pk_bf16_f32 v91,v118,v119
v_mfma_f32_16x16x32_bf16 v[56:59],v[44:47],v[84:87],v[56:59]
v_exp_f32 v120,v120
v_mfma_f32_16x16x32_bf16 v[96:99],a[128:131],a[64:67],v[64:67]
v_mfma_f32_16x16x32_bf16 v[96:99],a[132:135],a[68:71],v[96:99]
v_exp_f32 v121,v121
v_mfma_f32_16x16x32_bf16 v[96:99],a[136:139],a[72:75],v[96:99]
v_cvt_pk_bf16_f32 v92,v120,v121
v_mfma_f32_16x16x32_bf16 v[96:99],a[140:143],a[76:79],v[96:99]
v_exp_f32 v122,v122
v_mfma_f32_16x16x32_bf16 v[100:103],a[144:147],a[64:67],v[64:67]
v_mfma_f32_16x16x32_bf16 v[100:103],a[148:151],a[68:71],v[100:103]
v_exp_f32 v123,v123
v_mfma_f32_16x16x32_bf16 v[100:103],a[152:155],a[72:75],v[100:103]
v_cvt_pk_bf16_f32 v93,v122,v123
v_mfma_f32_16x16x32_bf16 v[100:103],a[156:159],a[76:79],v[100:103]
v_exp_f32 v124,v124
v_mfma_f32_16x16x32_bf16 v[104:107],a[160:163],a[64:67],v[64:67]
v_mfma_f32_16x16x32_bf16 v[104:107],a[164:167],a[68:71],v[104:107]
v_exp_f32 v125,v125
v_mfma_f32_16x16x32_bf16 v[104:107],a[168:171],a[72:75],v[104:107]
v_cvt_pk_bf16_f32 v94,v124,v125
v_mfma_f32_16x16x32_bf16 v[104:107],a[172:175],a[76:79],v[104:107]
buffer_load_dwordx4 v8,s[12:15],s48 offen offset:2048 nt lds
v_exp_f32 v126,v126
v_mfma_f32_16x16x32_bf16 v[108:111],a[176:179],a[64:67],v[64:67]
v_mfma_f32_16x16x32_bf16 v[108:111],a[180:183],a[68:71],v[108:111]
v_exp_f32 v127,v127
v_mfma_f32_16x16x32_bf16 v[108:111],a[184:187],a[72:75],v[108:111]
v_cvt_pk_bf16_f32 v95,v126,v127
v_mfma_f32_16x16x32_bf16 v[108:111],a[188:191],a[76:79],v[108:111]
v_mfma_f32_16x16x32_bf16 v[224:227],a[192:195],v[88:91],v[224:227]
v_mfma_f32_16x16x32_bf16 v[224:227],a[196:199],v[92:95],v[224:227]
v_exp_f32 v96,v96
v_mfma_f32_16x16x32_bf16 v[228:231],a[200:203],v[88:91],v[228:231]
ds_read_b64_tr_b16 a[192:193],v14 offset:49152
ds_read_b64_tr_b16 a[194:195],v14 offset:53248
v_mfma_f32_16x16x32_bf16 v[228:231],a[204:207],v[92:95],v[228:231]
v_exp_f32 v97,v97
v_mfma_f32_16x16x32_bf16 v[232:235],a[208:211],v[88:91],v[232:235]
ds_read_b64_tr_b16 a[196:197],v14 offset:57344
v_cvt_pk_bf16_f32 v80,v96,v97
v_mfma_f32_16x16x32_bf16 v[232:235],a[212:215],v[92:95],v[232:235]
v_exp_f32 v98,v98
v_mfma_f32_16x16x32_bf16 v[236:239],a[216:219],v[88:91],v[236:239]
ds_read_b64_tr_b16 a[198:199],v14 offset:61440
ds_read_b64_tr_b16 a[200:201],v15 offset:49152
v_mfma_f32_16x16x32_bf16 v[236:239],a[220:223],v[92:95],v[236:239]
v_exp_f32 v99,v99
v_mfma_f32_16x16x32_bf16 v[240:243],a[224:227],v[88:91],v[240:243]
ds_read_b64_tr_b16 a[202:203],v15 offset:53248
v_cvt_pk_bf16_f32 v81,v98,v99
v_mfma_f32_16x16x32_bf16 v[240:243],a[228:231],v[92:95],v[240:243]
v_exp_f32 v100,v100
v_mfma_f32_16x16x32_bf16 v[244:247],a[232:235],v[88:91],v[244:247]
ds_read_b64_tr_b16 a[204:205],v15 offset:57344
ds_read_b64_tr_b16 a[206:207],v15 offset:61440
v_mfma_f32_16x16x32_bf16 v[244:247],a[236:239],v[92:95],v[244:247]
v_exp_f32 v101,v101
v_mfma_f32_16x16x32_bf16 v[248:251],a[240:243],v[88:91],v[248:251]
ds_read_b64_tr_b16 a[208:209],v16 offset:49152
v_cvt_pk_bf16_f32 v82,v100,v101
v_mfma_f32_16x16x32_bf16 v[248:251],a[244:247],v[92:95],v[248:251]
buffer_load_dwordx4 v9,s[12:15],s48 offen offset:3072 nt lds
v_exp_f32 v102,v102
v_mfma_f32_16x16x32_bf16 v[252:255],a[248:251],v[88:91],v[252:255]
ds_read_b64_tr_b16 a[210:211],v16 offset:53248
ds_read_b64_tr_b16 a[212:213],v16 offset:57344
v_mfma_f32_16x16x32_bf16 v[252:255],a[252:255],v[92:95],v[252:255]
v_exp_f32 v103,v103
v_mfma_f32_16x16x32_bf16 v[60:63],v[44:47],v[88:91],v[60:63]
ds_read_b64_tr_b16 a[214:215],v16 offset:61440
v_cvt_pk_bf16_f32 v83,v102,v103
v_mfma_f32_16x16x32_bf16 v[60:63],v[44:47],v[92:95],v[60:63]
v_exp_f32 v104,v104
v_mfma_f32_16x16x32_bf16 v[112:115],a[128:131],a[80:83],v[68:71]
ds_read_b64_tr_b16 a[216:217],v17 offset:49152
ds_read_b64_tr_b16 a[218:219],v17 offset:53248
v_mfma_f32_16x16x32_bf16 v[112:115],a[132:135],a[84:87],v[112:115]
v_exp_f32 v105,v105
v_mfma_f32_16x16x32_bf16 v[112:115],a[136:139],a[88:91],v[112:115]
ds_read_b64_tr_b16 a[220:221],v17 offset:57344
v_cvt_pk_bf16_f32 v84,v104,v105
v_mfma_f32_16x16x32_bf16 v[112:115],a[140:143],a[92:95],v[112:115]
v_exp_f32 v106,v106
v_mfma_f32_16x16x32_bf16 v[116:119],a[144:147],a[80:83],v[68:71]
ds_read_b64_tr_b16 a[222:223],v17 offset:61440
ds_read_b64_tr_b16 a[224:225],v18 offset:49152
v_mfma_f32_16x16x32_bf16 v[116:119],a[148:151],a[84:87],v[116:119]
v_exp_f32 v107,v107
v_mfma_f32_16x16x32_bf16 v[116:119],a[152:155],a[88:91],v[116:119]
ds_read_b64_tr_b16 a[226:227],v18 offset:53248
v_cvt_pk_bf16_f32 v85,v106,v107
v_mfma_f32_16x16x32_bf16 v[116:119],a[156:159],a[92:95],v[116:119]
v_exp_f32 v108,v108
v_mfma_f32_16x16x32_bf16 v[120:123],a[160:163],a[80:83],v[68:71]
ds_read_b64_tr_b16 a[228:229],v18 offset:57344
ds_read_b64_tr_b16 a[230:231],v18 offset:61440
v_mfma_f32_16x16x32_bf16 v[120:123],a[164:167],a[84:87],v[120:123]
v_exp_f32 v109,v109
v_mfma_f32_16x16x32_bf16 v[120:123],a[168:171],a[88:91],v[120:123]
ds_read_b64_tr_b16 a[232:233],v19 offset:49152
v_cvt_pk_bf16_f32 v86,v108,v109
v_mfma_f32_16x16x32_bf16 v[120:123],a[172:175],a[92:95],v[120:123]
s_mov_b32 s48,344064
v_exp_f32 v110,v110
v_mfma_f32_16x16x32_bf16 v[124:127],a[176:179],a[80:83],v[68:71]
ds_read_b64_tr_b16 a[234:235],v19 offset:53248
ds_read_b64_tr_b16 a[236:237],v19 offset:57344
s_add_u32 m0,s39,16384
v_mfma_f32_16x16x32_bf16 v[124:127],a[180:183],a[84:87],v[124:127]
buffer_load_dwordx4 v4,s[8:11],s48 offen nt lds
v_exp_f32 v111,v111
v_mfma_f32_16x16x32_bf16 v[124:127],a[184:187],a[88:91],v[124:127]
ds_read_b64_tr_b16 a[238:239],v19 offset:61440
v_cvt_pk_bf16_f32 v87,v110,v111
v_mfma_f32_16x16x32_bf16 v[124:127],a[188:191],a[92:95],v[124:127]
ds_read_b64_tr_b16 a[240:241],v20 offset:49152
ds_read_b64_tr_b16 a[242:243],v20 offset:53248
v_mfma_f32_16x16x32_bf16 v[96:99],a[128:131],a[96:99],v[72:75]
ds_read_b64_tr_b16 a[244:245],v20 offset:57344
ds_read_b64_tr_b16 a[246:247],v20 offset:61440
v_mfma_f32_16x16x32_bf16 v[96:99],a[132:135],a[100:103],v[96:99]
v_exp_f32 v112,v112
v_mfma_f32_16x16x32_bf16 v[96:99],a[136:139],a[104:107],v[96:99]
ds_read_b64_tr_b16 a[248:249],v21 offset:49152
ds_read_b64_tr_b16 a[250:251],v21 offset:53248
v_mfma_f32_16x16x32_bf16 v[96:99],a[140:143],a[108:111],v[96:99]
v_exp_f32 v113,v113
v_mfma_f32_16x16x32_bf16 v[100:103],a[144:147],a[96:99],v[72:75]
ds_read_b64_tr_b16 a[252:253],v21 offset:57344
v_cvt_pk_bf16_f32 v88,v112,v113
v_mfma_f32_16x16x32_bf16 v[100:103],a[148:151],a[100:103],v[100:103]
v_exp_f32 v114,v114
v_mfma_f32_16x16x32_bf16 v[100:103],a[152:155],a[104:107],v[100:103]
ds_read_b64_tr_b16 a[254:255],v21 offset:61440
v_mfma_f32_16x16x32_bf16 v[100:103],a[156:159],a[108:111],v[100:103]
v_exp_f32 v115,v115
v_mfma_f32_16x16x32_bf16 v[104:107],a[160:163],a[96:99],v[72:75]
v_cvt_pk_bf16_f32 v89,v114,v115
v_mfma_f32_16x16x32_bf16 v[104:107],a[164:167],a[100:103],v[104:107]
v_exp_f32 v116,v116
v_mfma_f32_16x16x32_bf16 v[104:107],a[168:171],a[104:107],v[104:107]
v_mfma_f32_16x16x32_bf16 v[104:107],a[172:175],a[108:111],v[104:107]
v_exp_f32 v117,v117
v_mfma_f32_16x16x32_bf16 v[108:111],a[176:179],a[96:99],v[72:75]
buffer_load_dwordx4 v5,s[8:11],s48 offen offset:1024 nt lds
v_cvt_pk_bf16_f32 v90,v116,v117
v_mfma_f32_16x16x32_bf16 v[108:111],a[180:183],a[100:103],v[108:111]
v_exp_f32 v118,v118
v_mfma_f32_16x16x32_bf16 v[108:111],a[184:187],a[104:107],v[108:111]
s_waitcnt lgkmcnt(0)
v_mfma_f32_16x16x32_bf16 v[108:111],a[188:191],a[108:111],v[108:111]
v_exp_f32 v119,v119
v_mfma_f32_16x16x32_bf16 v[128:131],a[192:195],v[80:83],v[128:131]
v_cvt_pk_bf16_f32 v91,v118,v119
v_mfma_f32_16x16x32_bf16 v[128:131],a[196:199],v[84:87],v[128:131]
v_exp_f32 v120,v120
v_mfma_f32_16x16x32_bf16 v[132:135],a[200:203],v[80:83],v[132:135]
v_mfma_f32_16x16x32_bf16 v[132:135],a[204:207],v[84:87],v[132:135]
v_exp_f32 v121,v121
v_mfma_f32_16x16x32_bf16 v[136:139],a[208:211],v[80:83],v[136:139]
v_cvt_pk_bf16_f32 v92,v120,v121
v_mfma_f32_16x16x32_bf16 v[136:139],a[212:215],v[84:87],v[136:139]
v_exp_f32 v122,v122
v_mfma_f32_16x16x32_bf16 v[140:143],a[216:219],v[80:83],v[140:143]
v_mfma_f32_16x16x32_bf16 v[140:143],a[220:223],v[84:87],v[140:143]
v_exp_f32 v123,v123
v_mfma_f32_16x16x32_bf16 v[144:147],a[224:227],v[80:83],v[144:147]
v_cvt_pk_bf16_f32 v93,v122,v123
v_mfma_f32_16x16x32_bf16 v[144:147],a[228:231],v[84:87],v[144:147]
v_exp_f32 v124,v124
v_mfma_f32_16x16x32_bf16 v[148:151],a[232:235],v[80:83],v[148:151]
v_mfma_f32_16x16x32_bf16 v[148:151],a[236:239],v[84:87],v[148:151]
v_exp_f32 v125,v125
v_mfma_f32_16x16x32_bf16 v[152:155],a[240:243],v[80:83],v[152:155]
v_cvt_pk_bf16_f32 v94,v124,v125
v_mfma_f32_16x16x32_bf16 v[152:155],a[244:247],v[84:87],v[152:155]
buffer_load_dwordx4 v6,s[8:11],s48 offen offset:2048 nt lds
v_exp_f32 v126,v126
v_mfma_f32_16x16x32_bf16 v[156:159],a[248:251],v[80:83],v[156:159]
v_mfma_f32_16x16x32_bf16 v[156:159],a[252:255],v[84:87],v[156:159]
v_exp_f32 v127,v127
v_mfma_f32_16x16x32_bf16 v[48:51],v[44:47],v[80:83],v[48:51]
v_cvt_pk_bf16_f32 v95,v126,v127
v_mfma_f32_16x16x32_bf16 v[48:51],v[44:47],v[84:87],v[48:51]
s_waitcnt vmcnt(3)
s_barrier
v_mfma_f32_16x16x32_bf16 v[112:115],a[128:131],a[112:115],v[76:79]
v_mfma_f32_16x16x32_bf16 v[112:115],a[132:135],a[116:119],v[112:115]
v_exp_f32 v96,v96
v_mfma_f32_16x16x32_bf16 v[112:115],a[136:139],a[120:123],v[112:115]
v_mfma_f32_16x16x32_bf16 v[112:115],a[140:143],a[124:127],v[112:115]
v_exp_f32 v97,v97
v_mfma_f32_16x16x32_bf16 v[116:119],a[144:147],a[112:115],v[76:79]
ds_read_b128 a[128:131],v10 offset:0
v_cvt_pk_bf16_f32 v80,v96,v97
v_mfma_f32_16x16x32_bf16 v[116:119],a[148:151],a[116:119],v[116:119]
v_exp_f32 v98,v98
v_mfma_f32_16x16x32_bf16 v[116:119],a[152:155],a[120:123],v[116:119]
ds_read_b128 a[132:135],v11 offset:0
v_mfma_f32_16x16x32_bf16 v[116:119],a[156:159],a[124:127],v[116:119]
v_exp_f32 v99,v99
v_mfma_f32_16x16x32_bf16 v[120:123],a[160:163],a[112:115],v[76:79]
ds_read_b128 a[136:139],v12 offset:0
v_cvt_pk_bf16_f32 v81,v98,v99
v_mfma_f32_16x16x32_bf16 v[120:123],a[164:167],a[116:119],v[120:123]
v_exp_f32 v100,v100
v_mfma_f32_16x16x32_bf16 v[120:123],a[168:171],a[120:123],v[120:123]
ds_read_b128 a[140:143],v13 offset:0
v_mfma_f32_16x16x32_bf16 v[120:123],a[172:175],a[124:127],v[120:123]
v_exp_f32 v101,v101
v_mfma_f32_16x16x32_bf16 v[124:127],a[176:179],a[112:115],v[76:79]
ds_read_b128 a[144:147],v10 offset:4096
v_cvt_pk_bf16_f32 v82,v100,v101
v_mfma_f32_16x16x32_bf16 v[124:127],a[180:183],a[116:119],v[124:127]
buffer_load_dwordx4 v7,s[8:11],s48 offen offset:3072 nt lds
v_exp_f32 v102,v102
v_mfma_f32_16x16x32_bf16 v[124:127],a[184:187],a[120:123],v[124:127]
ds_read_b128 a[148:151],v11 offset:4096
v_mfma_f32_16x16x32_bf16 v[124:127],a[188:191],a[124:127],v[124:127]
v_exp_f32 v103,v103
v_mfma_f32_16x16x32_bf16 v[160:163],a[192:195],v[88:91],v[160:163]
ds_read_b128 a[152:155],v12 offset:4096
v_cvt_pk_bf16_f32 v83,v102,v103
v_mfma_f32_16x16x32_bf16 v[160:163],a[196:199],v[92:95],v[160:163]
v_exp_f32 v104,v104
v_mfma_f32_16x16x32_bf16 v[164:167],a[200:203],v[88:91],v[164:167]
ds_read_b128 a[156:159],v13 offset:4096
v_mfma_f32_16x16x32_bf16 v[164:167],a[204:207],v[92:95],v[164:167]
v_exp_f32 v105,v105
v_mfma_f32_16x16x32_bf16 v[168:171],a[208:211],v[88:91],v[168:171]
ds_read_b128 a[160:163],v10 offset:8192
v_cvt_pk_bf16_f32 v84,v104,v105
v_mfma_f32_16x16x32_bf16 v[168:171],a[212:215],v[92:95],v[168:171]
v_exp_f32 v106,v106
v_mfma_f32_16x16x32_bf16 v[172:175],a[216:219],v[88:91],v[172:175]
ds_read_b128 a[164:167],v11 offset:8192
v_mfma_f32_16x16x32_bf16 v[172:175],a[220:223],v[92:95],v[172:175]
v_exp_f32 v107,v107
v_mfma_f32_16x16x32_bf16 v[176:179],a[224:227],v[88:91],v[176:179]
ds_read_b128 a[168:171],v12 offset:8192
v_cvt_pk_bf16_f32 v85,v106,v107
v_mfma_f32_16x16x32_bf16 v[176:179],a[228:231],v[92:95],v[176:179]
v_exp_f32 v108,v108
v_mfma_f32_16x16x32_bf16 v[180:183],a[232:235],v[88:91],v[180:183]
ds_read_b128 a[172:175],v13 offset:8192
v_add_u32 v34,0,v0
v_mfma_f32_16x16x32_bf16 v[180:183],a[236:239],v[92:95],v[180:183]
v_exp_f32 v109,v109
v_mfma_f32_16x16x32_bf16 v[184:187],a[240:243],v[88:91],v[184:187]
ds_read_b128 a[176:179],v10 offset:12288
v_cvt_pk_bf16_f32 v86,v108,v109
v_mfma_f32_16x16x32_bf16 v[184:187],a[244:247],v[92:95],v[184:187]
s_add_u32 m0,s39,81920
v_exp_f32 v110,v110
v_mfma_f32_16x16x32_bf16 v[188:191],a[248:251],v[88:91],v[188:191]
ds_read_b128 a[180:183],v11 offset:12288
v_mul_u32_u24 v35,3641,v34
v_mfma_f32_16x16x32_bf16 v[188:191],a[252:255],v[92:95],v[188:191]
buffer_load_dwordx4 v8,s[12:15],s48 offen nt lds
v_exp_f32 v111,v111
v_mfma_f32_16x16x32_bf16 v[52:55],v[44:47],v[88:91],v[52:55]
ds_read_b128 a[184:187],v12 offset:12288
v_cvt_pk_bf16_f32 v87,v110,v111
v_mfma_f32_16x16x32_bf16 v[52:55],v[44:47],v[92:95],v[52:55]
ds_read_b128 a[188:191],v13 offset:12288
v_lshrrev_b32 v35,16,v35
v_mfma_f32_16x16x32_bf16 v[192:195],a[192:195],v[80:83],v[192:195]
v_mul_u32_u24 v36,864,v35
v_lshl_add_u32 v36,v34,4,v36
v_mfma_f32_16x16x32_bf16 v[192:195],a[196:199],v[84:87],v[192:195]
v_exp_f32 v112,v112
v_mfma_f32_16x16x32_bf16 v[196:199],a[200:203],v[80:83],v[196:199]
v_add_u32 v1,s66,v36
v_subrev_u32 v1,0,v1
v_mfma_f32_16x16x32_bf16 v[196:199],a[204:207],v[84:87],v[196:199]
v_exp_f32 v113,v113
v_mfma_f32_16x16x32_bf16 v[200:203],a[208:211],v[80:83],v[200:203]
v_cvt_pk_bf16_f32 v88,v112,v113
v_add_u32 v34,64,v0
v_mfma_f32_16x16x32_bf16 v[200:203],a[212:215],v[84:87],v[200:203]
v_exp_f32 v114,v114
v_mfma_f32_16x16x32_bf16 v[204:207],a[216:219],v[80:83],v[204:207]
v_mul_u32_u24 v35,3641,v34
v_lshrrev_b32 v35,16,v35
v_mfma_f32_16x16x32_bf16 v[204:207],a[220:223],v[84:87],v[204:207]
v_exp_f32 v115,v115
v_mfma_f32_16x16x32_bf16 v[208:211],a[224:227],v[80:83],v[208:211]
v_cvt_pk_bf16_f32 v89,v114,v115
v_mul_u32_u24 v36,864,v35
v_mfma_f32_16x16x32_bf16 v[208:211],a[228:231],v[84:87],v[208:211]
v_exp_f32 v116,v116
v_mfma_f32_16x16x32_bf16 v[212:215],a[232:235],v[80:83],v[212:215]
v_lshl_add_u32 v36,v34,4,v36
v_add_u32 v2,s66,v36
v_mfma_f32_16x16x32_bf16 v[212:215],a[236:239],v[84:87],v[212:215]
v_exp_f32 v117,v117
v_mfma_f32_16x16x32_bf16 v[216:219],a[240:243],v[80:83],v[216:219]
buffer_load_dwordx4 v9,s[12:15],s48 offen offset:1024 nt lds
v_cvt_pk_bf16_f32 v90,v116,v117
v_mfma_f32_16x16x32_bf16 v[216:219],a[244:247],v[84:87],v[216:219]
v_exp_f32 v118,v118
v_mfma_f32_16x16x32_bf16 v[220:223],a[248:251],v[80:83],v[220:223]
s_waitcnt lgkmcnt(0)
v_subrev_u32 v2,1024,v2
v_mfma_f32_16x16x32_bf16 v[220:223],a[252:255],v[84:87],v[220:223]
v_exp_f32 v119,v119
v_mfma_f32_16x16x32_bf16 v[56:59],v[44:47],v[80:83],v[56:59]
v_cvt_pk_bf16_f32 v91,v118,v119
v_add_u32 v34,128,v0
v_mfma_f32_16x16x32_bf16 v[56:59],v[44:47],v[84:87],v[56:59]
v_exp_f32 v120,v120
v_mfma_f32_16x16x32_bf16 v[96:99],a[128:131],a[64:67],v[64:67]
v_mul_u32_u24 v35,3641,v34
v_lshrrev_b32 v35,16,v35
v_mfma_f32_16x16x32_bf16 v[96:99],a[132:135],a[68:71],v[96:99]
v_exp_f32 v121,v121
v_mfma_f32_16x16x32_bf16 v[96:99],a[136:139],a[72:75],v[96:99]
v_cvt_pk_bf16_f32 v92,v120,v121
v_mul_u32_u24 v36,864,v35
v_mfma_f32_16x16x32_bf16 v[96:99],a[140:143],a[76:79],v[96:99]
v_exp_f32 v122,v122
v_mfma_f32_16x16x32_bf16 v[100:103],a[144:147],a[64:67],v[64:67]
v_lshl_add_u32 v36,v34,4,v36
v_add_u32 v22,s66,v36
v_mfma_f32_16x16x32_bf16 v[100:103],a[148:151],a[68:71],v[100:103]
v_exp_f32 v123,v123
v_mfma_f32_16x16x32_bf16 v[100:103],a[152:155],a[72:75],v[100:103]
v_cvt_pk_bf16_f32 v93,v122,v123
v_subrev_u32 v22,2048,v22
v_mfma_f32_16x16x32_bf16 v[100:103],a[156:159],a[76:79],v[100:103]
v_exp_f32 v124,v124
v_mfma_f32_16x16x32_bf16 v[104:107],a[160:163],a[64:67],v[64:67]
v_add_u32 v34,192,v0
v_mul_u32_u24 v35,3641,v34
v_mfma_f32_16x16x32_bf16 v[104:107],a[164:167],a[68:71],v[104:107]
v_exp_f32 v125,v125
v_mfma_f32_16x16x32_bf16 v[104:107],a[168:171],a[72:75],v[104:107]
v_cvt_pk_bf16_f32 v94,v124,v125
v_lshrrev_b32 v35,16,v35
v_mfma_f32_16x16x32_bf16 v[104:107],a[172:175],a[76:79],v[104:107]
buffer_load_dwordx4 v8,s[12:15],s48 offen offset:2048 nt lds
v_exp_f32 v126,v126
v_mfma_f32_16x16x32_bf16 v[108:111],a[176:179],a[64:67],v[64:67]
v_mul_u32_u24 v36,864,v35
v_lshl_add_u32 v36,v34,4,v36
v_mfma_f32_16x16x32_bf16 v[108:111],a[180:183],a[68:71],v[108:111]
v_exp_f32 v127,v127
v_mfma_f32_16x16x32_bf16 v[108:111],a[184:187],a[72:75],v[108:111]
v_cvt_pk_bf16_f32 v95,v126,v127
v_add_u32 v29,s66,v36
v_mfma_f32_16x16x32_bf16 v[108:111],a[188:191],a[76:79],v[108:111]
v_subrev_u32 v29,3072,v29
v_add_u32 v34,256,v0
v_mfma_f32_16x16x32_bf16 v[224:227],a[192:195],v[88:91],v[224:227]
v_mul_u32_u24 v35,3641,v34
v_lshrrev_b32 v35,16,v35
v_mfma_f32_16x16x32_bf16 v[224:227],a[196:199],v[92:95],v[224:227]
v_exp_f32 v96,v96
v_mfma_f32_16x16x32_bf16 v[228:231],a[200:203],v[88:91],v[228:231]
ds_read_b64_tr_b16 a[192:193],v14 offset:0
ds_read_b64_tr_b16 a[194:195],v14 offset:4096
v_mfma_f32_16x16x32_bf16 v[228:231],a[204:207],v[92:95],v[228:231]
v_exp_f32 v97,v97
v_mfma_f32_16x16x32_bf16 v[232:235],a[208:211],v[88:91],v[232:235]
ds_read_b64_tr_b16 a[196:197],v14 offset:8192
v_cvt_pk_bf16_f32 v80,v96,v97
v_mfma_f32_16x16x32_bf16 v[232:235],a[212:215],v[92:95],v[232:235]
v_exp_f32 v98,v98
v_mfma_f32_16x16x32_bf16 v[236:239],a[216:219],v[88:91],v[236:239]
ds_read_b64_tr_b16 a[198:199],v14 offset:12288
ds_read_b64_tr_b16 a[200:201],v15 offset:0
v_mfma_f32_16x16x32_bf16 v[236:239],a[220:223],v[92:95],v[236:239]
v_exp_f32 v99,v99
v_mfma_f32_16x16x32_bf16 v[240:243],a[224:227],v[88:91],v[240:243]
ds_read_b64_tr_b16 a[202:203],v15 offset:4096
v_cvt_pk_bf16_f32 v81,v98,v99
v_mfma_f32_16x16x32_bf16 v[240:243],a[228:231],v[92:95],v[240:243]
v_exp_f32 v100,v100
v_mfma_f32_16x16x32_bf16 v[244:247],a[232:235],v[88:91],v[244:247]
ds_read_b64_tr_b16 a[204:205],v15 offset:8192
ds_read_b64_tr_b16 a[206:207],v15 offset:12288
v_mfma_f32_16x16x32_bf16 v[244:247],a[236:239],v[92:95],v[244:247]
v_exp_f32 v101,v101
v_mfma_f32_16x16x32_bf16 v[248:251],a[240:243],v[88:91],v[248:251]
ds_read_b64_tr_b16 a[208:209],v16 offset:0
v_cvt_pk_bf16_f32 v82,v100,v101
v_mfma_f32_16x16x32_bf16 v[248:251],a[244:247],v[92:95],v[248:251]
buffer_load_dwordx4 v9,s[12:15],s48 offen offset:3072 nt lds
v_exp_f32 v102,v102
v_mfma_f32_16x16x32_bf16 v[252:255],a[248:251],v[88:91],v[252:255]
ds_read_b64_tr_b16 a[210:211],v16 offset:4096
ds_read_b64_tr_b16 a[212:213],v16 offset:8192
v_mfma_f32_16x16x32_bf16 v[252:255],a[252:255],v[92:95],v[252:255]
v_exp_f32 v103,v103
v_mfma_f32_16x16x32_bf16 v[60:63],v[44:47],v[88:91],v[60:63]
ds_read_b64_tr_b16 a[214:215],v16 offset:12288
v_cvt_pk_bf16_f32 v83,v102,v103
v_mfma_f32_16x16x32_bf16 v[60:63],v[44:47],v[92:95],v[60:63]
v_exp_f32 v104,v104
v_mfma_f32_16x16x32_bf16 v[112:115],a[128:131],a[80:83],v[68:71]
ds_read_b64_tr_b16 a[216:217],v17 offset:0
ds_read_b64_tr_b16 a[218:219],v17 offset:4096
v_mfma_f32_16x16x32_bf16 v[112:115],a[132:135],a[84:87],v[112:115]
v_exp_f32 v105,v105
v_mfma_f32_16x16x32_bf16 v[112:115],a[136:139],a[88:91],v[112:115]
ds_read_b64_tr_b16 a[220:221],v17 offset:8192
v_cvt_pk_bf16_f32 v84,v104,v105
v_mfma_f32_16x16x32_bf16 v[112:115],a[140:143],a[92:95],v[112:115]
v_exp_f32 v106,v106
v_mfma_f32_16x16x32_bf16 v[116:119],a[144:147],a[80:83],v[68:71]
ds_read_b64_tr_b16 a[222:223],v17 offset:12288
ds_read_b64_tr_b16 a[224:225],v18 offset:0
v_mfma_f32_16x16x32_bf16 v[116:119],a[148:151],a[84:87],v[116:119]
v_exp_f32 v107,v107
v_mfma_f32_16x16x32_bf16 v[116:119],a[152:155],a[88:91],v[116:119]
ds_read_b64_tr_b16 a[226:227],v18 offset:4096
v_cvt_pk_bf16_f32 v85,v106,v107
v_mfma_f32_16x16x32_bf16 v[116:119],a[156:159],a[92:95],v[116:119]
v_exp_f32 v108,v108
v_mfma_f32_16x16x32_bf16 v[120:123],a[160:163],a[80:83],v[68:71]
ds_read_b64_tr_b16 a[228:229],v18 offset:8192
ds_read_b64_tr_b16 a[230:231],v18 offset:12288
v_mfma_f32_16x16x32_bf16 v[120:123],a[164:167],a[84:87],v[120:123]
v_exp_f32 v109,v109
v_mfma_f32_16x16x32_bf16 v[120:123],a[168:171],a[88:91],v[120:123]
ds_read_b64_tr_b16 a[232:233],v19 offset:0
v_cvt_pk_bf16_f32 v86,v108,v109
v_mfma_f32_16x16x32_bf16 v[120:123],a[172:175],a[92:95],v[120:123]
s_mov_b32 s48,360448
v_exp_f32 v110,v110
v_mfma_f32_16x16x32_bf16 v[124:127],a[176:179],a[80:83],v[68:71]
ds_read_b64_tr_b16 a[234:235],v19 offset:4096
ds_read_b64_tr_b16 a[236:237],v19 offset:8192
s_add_u32 m0,s39,32768
v_mfma_f32_16x16x32_bf16 v[124:127],a[180:183],a[84:87],v[124:127]
buffer_load_dwordx4 v4,s[8:11],s48 offen nt lds
v_exp_f32 v111,v111
v_mfma_f32_16x16x32_bf16 v[124:127],a[184:187],a[88:91],v[124:127]
ds_read_b64_tr_b16 a[238:239],v19 offset:12288
v_cvt_pk_bf16_f32 v87,v110,v111
v_mfma_f32_16x16x32_bf16 v[124:127],a[188:191],a[92:95],v[124:127]
ds_read_b64_tr_b16 a[240:241],v20 offset:0
ds_read_b64_tr_b16 a[242:243],v20 offset:4096
v_mfma_f32_16x16x32_bf16 v[96:99],a[128:131],a[96:99],v[72:75]
ds_read_b64_tr_b16 a[244:245],v20 offset:8192
ds_read_b64_tr_b16 a[246:247],v20 offset:12288
v_mfma_f32_16x16x32_bf16 v[96:99],a[132:135],a[100:103],v[96:99]
v_exp_f32 v112,v112
v_mfma_f32_16x16x32_bf16 v[96:99],a[136:139],a[104:107],v[96:99]
ds_read_b64_tr_b16 a[248:249],v21 offset:0
ds_read_b64_tr_b16 a[250:251],v21 offset:4096
v_mfma_f32_16x16x32_bf16 v[96:99],a[140:143],a[108:111],v[96:99]
v_exp_f32 v113,v113
v_mfma_f32_16x16x32_bf16 v[100:103],a[144:147],a[96:99],v[72:75]
ds_read_b64_tr_b16 a[252:253],v21 offset:8192
v_cvt_pk_bf16_f32 v88,v112,v113
v_mfma_f32_16x16x32_bf16 v[100:103],a[148:151],a[100:103],v[100:103]
v_exp_f32 v114,v114
v_mfma_f32_16x16x32_bf16 v[100:103],a[152:155],a[104:107],v[100:103]
ds_read_b64_tr_b16 a[254:255],v21 offset:12288
v_mul_u32_u24 v36,864,v35
v_mfma_f32_16x16x32_bf16 v[100:103],a[156:159],a[108:111],v[100:103]
v_exp_f32 v115,v115
v_mfma_f32_16x16x32_bf16 v[104:107],a[160:163],a[96:99],v[72:75]
v_cvt_pk_bf16_f32 v89,v114,v115
v_lshl_add_u32 v36,v34,4,v36
v_mfma_f32_16x16x32_bf16 v[104:107],a[164:167],a[100:103],v[104:107]
v_exp_f32 v116,v116
v_mfma_f32_16x16x32_bf16 v[104:107],a[168:171],a[104:107],v[104:107]
v_add_u32 v42,s66,v36
v_subrev_u32 v42,0,v42
v_mfma_f32_16x16x32_bf16 v[104:107],a[172:175],a[108:111],v[104:107]
v_exp_f32 v117,v117
v_mfma_f32_16x16x32_bf16 v[108:111],a[176:179],a[96:99],v[72:75]
buffer_load_dwordx4 v5,s[8:11],s48 offen offset:1024 nt lds
v_cvt_pk_bf16_f32 v90,v116,v117
v_mfma_f32_16x16x32_bf16 v[108:111],a[180:183],a[100:103],v[108:111]
v_exp_f32 v118,v118
v_mfma_f32_16x16x32_bf16 v[108:111],a[184:187],a[104:107],v[108:111]
s_waitcnt lgkmcnt(0)
v_add_u32 v34,320,v0
v_mfma_f32_16x16x32_bf16 v[108:111],a[188:191],a[108:111],v[108:111]
v_exp_f32 v119,v119
v_mfma_f32_16x16x32_bf16 v[128:131],a[192:195],v[80:83],v[128:131]
v_cvt_pk_bf16_f32 v91,v118,v119
v_mul_u32_u24 v35,3641,v34
v_mfma_f32_16x16x32_bf16 v[128:131],a[196:199],v[84:87],v[128:131]
v_exp_f32 v120,v120
v_mfma_f32_16x16x32_bf16 v[132:135],a[200:203],v[80:83],v[132:135]
v_lshrrev_b32 v35,16,v35
v_mul_u32_u24 v36,864,v35
v_mfma_f32_16x16x32_bf16 v[132:135],a[204:207],v[84:87],v[132:135]
v_exp_f32 v121,v121
v_mfma_f32_16x16x32_bf16 v[136:139],a[208:211],v[80:83],v[136:139]
v_cvt_pk_bf16_f32 v92,v120,v121
v_lshl_add_u32 v36,v34,4,v36
v_mfma_f32_16x16x32_bf16 v[136:139],a[212:215],v[84:87],v[136:139]
v_exp_f32 v122,v122
v_mfma_f32_16x16x32_bf16 v[140:143],a[216:219],v[80:83],v[140:143]
v_add_u32 v37,s66,v36
v_subrev_u32 v37,1024,v37
v_mfma_f32_16x16x32_bf16 v[140:143],a[220:223],v[84:87],v[140:143]
v_exp_f32 v123,v123
v_mfma_f32_16x16x32_bf16 v[144:147],a[224:227],v[80:83],v[144:147]
v_cvt_pk_bf16_f32 v93,v122,v123
v_add_u32 v34,384,v0
v_mfma_f32_16x16x32_bf16 v[144:147],a[228:231],v[84:87],v[144:147]
v_exp_f32 v124,v124
v_mfma_f32_16x16x32_bf16 v[148:151],a[232:235],v[80:83],v[148:151]
v_mul_u32_u24 v35,3641,v34
v_lshrrev_b32 v35,16,v35
v_mfma_f32_16x16x32_bf16 v[148:151],a[236:239],v[84:87],v[148:151]
v_exp_f32 v125,v125
v_mfma_f32_16x16x32_bf16 v[152:155],a[240:243],v[80:83],v[152:155]
v_cvt_pk_bf16_f32 v94,v124,v125
v_mul_u32_u24 v36,864,v35
v_mfma_f32_16x16x32_bf16 v[152:155],a[244:247],v[84:87],v[152:155]
buffer_load_dwordx4 v6,s[8:11],s48 offen offset:2048 nt lds
v_exp_f32 v126,v126
v_mfma_f32_16x16x32_bf16 v[156:159],a[248:251],v[80:83],v[156:159]
v_lshl_add_u32 v36,v34,4,v36
v_add_u32 v38,s66,v36
v_mfma_f32_16x16x32_bf16 v[156:159],a[252:255],v[84:87],v[156:159]
v_exp_f32 v127,v127
v_mfma_f32_16x16x32_bf16 v[48:51],v[44:47],v[80:83],v[48:51]
v_cvt_pk_bf16_f32 v95,v126,v127
v_subrev_u32 v38,2048,v38
v_mfma_f32_16x16x32_bf16 v[48:51],v[44:47],v[84:87],v[48:51]
s_waitcnt vmcnt(3)
s_barrier
v_mfma_f32_16x16x32_bf16 v[112:115],a[128:131],a[112:115],v[76:79]
v_add_u32 v34,448,v0
v_mul_u32_u24 v35,3641,v34
v_mfma_f32_16x16x32_bf16 v[112:115],a[132:135],a[116:119],v[112:115]
v_exp_f32 v96,v96
v_mfma_f32_16x16x32_bf16 v[112:115],a[136:139],a[120:123],v[112:115]
v_lshrrev_b32 v35,16,v35
v_mul_u32_u24 v36,864,v35
v_mfma_f32_16x16x32_bf16 v[112:115],a[140:143],a[124:127],v[112:115]
v_exp_f32 v97,v97
v_mfma_f32_16x16x32_bf16 v[116:119],a[144:147],a[112:115],v[76:79]
ds_read_b128 a[128:131],v10 offset:16384
v_cvt_pk_bf16_f32 v80,v96,v97
v_mfma_f32_16x16x32_bf16 v[116:119],a[148:151],a[116:119],v[116:119]
v_exp_f32 v98,v98
v_mfma_f32_16x16x32_bf16 v[116:119],a[152:155],a[120:123],v[116:119]
ds_read_b128 a[132:135],v11 offset:16384
v_lshl_add_u32 v36,v34,4,v36
v_mfma_f32_16x16x32_bf16 v[116:119],a[156:159],a[124:127],v[116:119]
v_exp_f32 v99,v99
v_mfma_f32_16x16x32_bf16 v[120:123],a[160:163],a[112:115],v[76:79]
ds_read_b128 a[136:139],v12 offset:16384
v_cvt_pk_bf16_f32 v81,v98,v99
v_mfma_f32_16x16x32_bf16 v[120:123],a[164:167],a[116:119],v[120:123]
v_exp_f32 v100,v100
v_mfma_f32_16x16x32_bf16 v[120:123],a[168:171],a[120:123],v[120:123]
ds_read_b128 a[140:143],v13 offset:16384
v_add_u32 v39,s66,v36
v_mfma_f32_16x16x32_bf16 v[120:123],a[172:175],a[124:127],v[120:123]
v_exp_f32 v101,v101
v_mfma_f32_16x16x32_bf16 v[124:127],a[176:179],a[112:115],v[76:79]
ds_read_b128 a[144:147],v10 offset:20480
v_cvt_pk_bf16_f32 v82,v100,v101
v_mfma_f32_16x16x32_bf16 v[124:127],a[180:183],a[116:119],v[124:127]
buffer_load_dwordx4 v7,s[8:11],s48 offen offset:3072 nt lds
v_exp_f32 v102,v102
v_mfma_f32_16x16x32_bf16 v[124:127],a[184:187],a[120:123],v[124:127]
ds_read_b128 a[148:151],v11 offset:20480
v_subrev_u32 v39,3072,v39
v_mfma_f32_16x16x32_bf16 v[124:127],a[188:191],a[124:127],v[124:127]
v_exp_f32 v103,v103
v_mfma_f32_16x16x32_bf16 v[160:163],a[192:195],v[88:91],v[160:163]
ds_read_b128 a[152:155],v12 offset:20480
v_cvt_pk_bf16_f32 v83,v102,v103
v_mfma_f32_16x16x32_bf16 v[160:163],a[196:199],v[92:95],v[160:163]
v_exp_f32 v104,v104
v_mfma_f32_16x16x32_bf16 v[164:167],a[200:203],v[88:91],v[164:167]
ds_read_b128 a[156:159],v13 offset:20480
v_add_u32 v34,512,v0
v_mfma_f32_16x16x32_bf16 v[164:167],a[204:207],v[92:95],v[164:167]
v_exp_f32 v105,v105
v_mfma_f32_16x16x32_bf16 v[168:171],a[208:211],v[88:91],v[168:171]
ds_read_b128 a[160:163],v10 offset:24576
v_cvt_pk_bf16_f32 v84,v104,v105
v_mfma_f32_16x16x32_bf16 v[168:171],a[212:215],v[92:95],v[168:171]
v_exp_f32 v106,v106
v_mfma_f32_16x16x32_bf16 v[172:175],a[216:219],v[88:91],v[172:175]
ds_read_b128 a[164:167],v11 offset:24576
v_mul_u32_u24 v35,3641,v34
v_mfma_f32_16x16x32_bf16 v[172:175],a[220:223],v[92:95],v[172:175]
v_exp_f32 v107,v107
v_mfma_f32_16x16x32_bf16 v[176:179],a[224:227],v[88:91],v[176:179]
ds_read_b128 a[168:171],v12 offset:24576
v_cvt_pk_bf16_f32 v85,v106,v107
v_mfma_f32_16x16x32_bf16 v[176:179],a[228:231],v[92:95],v[176:179]
v_exp_f32 v108,v108
v_mfma_f32_16x16x32_bf16 v[180:183],a[232:235],v[88:91],v[180:183]
ds_read_b128 a[172:175],v13 offset:24576
v_lshrrev_b32 v35,16,v35
v_mfma_f32_16x16x32_bf16 v[180:183],a[236:239],v[92:95],v[180:183]
v_exp_f32 v109,v109
v_mfma_f32_16x16x32_bf16 v[184:187],a[240:243],v[88:91],v[184:187]
ds_read_b128 a[176:179],v10 offset:28672
v_cvt_pk_bf16_f32 v86,v108,v109
v_mfma_f32_16x16x32_bf16 v[184:187],a[244:247],v[92:95],v[184:187]
s_add_u32 m0,s39,98304
v_exp_f32 v110,v110
v_mfma_f32_16x16x32_bf16 v[188:191],a[248:251],v[88:91],v[188:191]
ds_read_b128 a[180:183],v11 offset:28672
v_mul_u32_u24 v36,864,v35
v_mfma_f32_16x16x32_bf16 v[188:191],a[252:255],v[92:95],v[188:191]
buffer_load_dwordx4 v8,s[12:15],s48 offen nt lds
v_exp_f32 v111,v111
v_mfma_f32_16x16x32_bf16 v[52:55],v[44:47],v[88:91],v[52:55]
ds_read_b128 a[184:187],v12 offset:28672
v_cvt_pk_bf16_f32 v87,v110,v111
v_mfma_f32_16x16x32_bf16 v[52:55],v[44:47],v[92:95],v[52:55]
ds_read_b128 a[188:191],v13 offset:28672
v_lshl_add_u32 v36,v34,4,v36
v_mfma_f32_16x16x32_bf16 v[192:195],a[192:195],v[80:83],v[192:195]
v_add_u32 v40,s66,v36
v_subrev_u32 v40,0,v40
v_mfma_f32_16x16x32_bf16 v[192:195],a[196:199],v[84:87],v[192:195]
v_exp_f32 v112,v112
v_mfma_f32_16x16x32_bf16 v[196:199],a[200:203],v[80:83],v[196:199]
v_mfma_f32_16x16x32_bf16 v[196:199],a[204:207],v[84:87],v[196:199]
v_exp_f32 v113,v113
v_mfma_f32_16x16x32_bf16 v[200:203],a[208:211],v[80:83],v[200:203]
v_cvt_pk_bf16_f32 v88,v112,v113
v_mfma_f32_16x16x32_bf16 v[200:203],a[212:215],v[84:87],v[200:203]
v_exp_f32 v114,v114
v_mfma_f32_16x16x32_bf16 v[204:207],a[216:219],v[80:83],v[204:207]
v_mfma_f32_16x16x32_bf16 v[204:207],a[220:223],v[84:87],v[204:207]
v_exp_f32 v115,v115
v_mfma_f32_16x16x32_bf16 v[208:211],a[224:227],v[80:83],v[208:211]
v_cvt_pk_bf16_f32 v89,v114,v115
v_mfma_f32_16x16x32_bf16 v[208:211],a[228:231],v[84:87],v[208:211]
v_exp_f32 v116,v116
v_mfma_f32_16x16x32_bf16 v[212:215],a[232:235],v[80:83],v[212:215]
v_mfma_f32_16x16x32_bf16 v[212:215],a[236:239],v[84:87],v[212:215]
v_exp_f32 v117,v117
v_mfma_f32_16x16x32_bf16 v[216:219],a[240:243],v[80:83],v[216:219]
buffer_load_dwordx4 v9,s[12:15],s48 offen offset:1024 nt lds
v_cvt_pk_bf16_f32 v90,v116,v117
v_mfma_f32_16x16x32_bf16 v[216:219],a[244:247],v[84:87],v[216:219]
v_exp_f32 v118,v118
v_mfma_f32_16x16x32_bf16 v[220:223],a[248:251],v[80:83],v[220:223]
s_waitcnt lgkmcnt(0)
v_mfma_f32_16x16x32_bf16 v[220:223],a[252:255],v[84:87],v[220:223]
v_exp_f32 v119,v119
v_mfma_f32_16x16x32_bf16 v[56:59],v[44:47],v[80:83],v[56:59]
v_cvt_pk_bf16_f32 v91,v118,v119
v_mfma_f32_16x16x32_bf16 v[56:59],v[44:47],v[84:87],v[56:59]
v_exp_f32 v120,v120
v_mfma_f32_16x16x32_bf16 v[96:99],a[128:131],a[64:67],v[64:67]
v_mfma_f32_16x16x32_bf16 v[96:99],a[132:135],a[68:71],v[96:99]
v_exp_f32 v121,v121
v_mfma_f32_16x16x32_bf16 v[96:99],a[136:139],a[72:75],v[96:99]
v_cvt_pk_bf16_f32 v92,v120,v121
v_mfma_f32_16x16x32_bf16 v[96:99],a[140:143],a[76:79],v[96:99]
v_exp_f32 v122,v122
v_mfma_f32_16x16x32_bf16 v[100:103],a[144:147],a[64:67],v[64:67]
v_mfma_f32_16x16x32_bf16 v[100:103],a[148:151],a[68:71],v[100:103]
v_exp_f32 v123,v123
v_mfma_f32_16x16x32_bf16 v[100:103],a[152:155],a[72:75],v[100:103]
v_cvt_pk_bf16_f32 v93,v122,v123
v_mfma_f32_16x16x32_bf16 v[100:103],a[156:159],a[76:79],v[100:103]
v_exp_f32 v124,v124
v_mfma_f32_16x16x32_bf16 v[104:107],a[160:163],a[64:67],v[64:67]
v_mfma_f32_16x16x32_bf16 v[104:107],a[164:167],a[68:71],v[104:107]
v_exp_f32 v125,v125
v_mfma_f32_16x16x32_bf16 v[104:107],a[168:171],a[72:75],v[104:107]
v_cvt_pk_bf16_f32 v94,v124,v125
v_mfma_f32_16x16x32_bf16 v[104:107],a[172:175],a[76:79],v[104:107]
buffer_load_dwordx4 v8,s[12:15],s48 offen offset:2048 nt lds
v_exp_f32 v126,v126
v_mfma_f32_16x16x32_bf16 v[108:111],a[176:179],a[64:67],v[64:67]
v_mfma_f32_16x16x32_bf16 v[108:111],a[180:183],a[68:71],v[108:111]
v_exp_f32 v127,v127
v_mfma_f32_16x16x32_bf16 v[108:111],a[184:187],a[72:75],v[108:111]
v_cvt_pk_bf16_f32 v95,v126,v127
v_mfma_f32_16x16x32_bf16 v[108:111],a[188:191],a[76:79],v[108:111]
v_mfma_f32_16x16x32_bf16 v[224:227],a[192:195],v[88:91],v[224:227]
v_mfma_f32_16x16x32_bf16 v[224:227],a[196:199],v[92:95],v[224:227]
v_exp_f32 v96,v96
v_mfma_f32_16x16x32_bf16 v[228:231],a[200:203],v[88:91],v[228:231]
ds_read_b64_tr_b16 a[192:193],v14 offset:16384
ds_read_b64_tr_b16 a[194:195],v14 offset:20480
v_mfma_f32_16x16x32_bf16 v[228:231],a[204:207],v[92:95],v[228:231]
v_exp_f32 v97,v97
v_mfma_f32_16x16x32_bf16 v[232:235],a[208:211],v[88:91],v[232:235]
ds_read_b64_tr_b16 a[196:197],v14 offset:24576
v_cvt_pk_bf16_f32 v80,v96,v97
v_mfma_f32_16x16x32_bf16 v[232:235],a[212:215],v[92:95],v[232:235]
v_exp_f32 v98,v98
v_mfma_f32_16x16x32_bf16 v[236:239],a[216:219],v[88:91],v[236:239]
ds_read_b64_tr_b16 a[198:199],v14 offset:28672
ds_read_b64_tr_b16 a[200:201],v15 offset:16384
v_mfma_f32_16x16x32_bf16 v[236:239],a[220:223],v[92:95],v[236:239]
v_exp_f32 v99,v99
v_mfma_f32_16x16x32_bf16 v[240:243],a[224:227],v[88:91],v[240:243]
ds_read_b64_tr_b16 a[202:203],v15 offset:20480
v_cvt_pk_bf16_f32 v81,v98,v99
v_mfma_f32_16x16x32_bf16 v[240:243],a[228:231],v[92:95],v[240:243]
v_exp_f32 v100,v100
v_mfma_f32_16x16x32_bf16 v[244:247],a[232:235],v[88:91],v[244:247]
ds_read_b64_tr_b16 a[204:205],v15 offset:24576
ds_read_b64_tr_b16 a[206:207],v15 offset:28672
v_mfma_f32_16x16x32_bf16 v[244:247],a[236:239],v[92:95],v[244:247]
v_exp_f32 v101,v101
v_mfma_f32_16x16x32_bf16 v[248:251],a[240:243],v[88:91],v[248:251]
ds_read_b64_tr_b16 a[208:209],v16 offset:16384
v_cvt_pk_bf16_f32 v82,v100,v101
v_mfma_f32_16x16x32_bf16 v[248:251],a[244:247],v[92:95],v[248:251]
buffer_load_dwordx4 v9,s[12:15],s48 offen offset:3072 nt lds
v_exp_f32 v102,v102
v_mfma_f32_16x16x32_bf16 v[252:255],a[248:251],v[88:91],v[252:255]
ds_read_b64_tr_b16 a[210:211],v16 offset:20480
ds_read_b64_tr_b16 a[212:213],v16 offset:24576
v_mfma_f32_16x16x32_bf16 v[252:255],a[252:255],v[92:95],v[252:255]
v_exp_f32 v103,v103
v_mfma_f32_16x16x32_bf16 v[60:63],v[44:47],v[88:91],v[60:63]
ds_read_b64_tr_b16 a[214:215],v16 offset:28672
v_cvt_pk_bf16_f32 v83,v102,v103
v_mfma_f32_16x16x32_bf16 v[60:63],v[44:47],v[92:95],v[60:63]
v_exp_f32 v104,v104
v_mfma_f32_16x16x32_bf16 v[112:115],a[128:131],a[80:83],v[68:71]
ds_read_b64_tr_b16 a[216:217],v17 offset:16384
ds_read_b64_tr_b16 a[218:219],v17 offset:20480
v_mfma_f32_16x16x32_bf16 v[112:115],a[132:135],a[84:87],v[112:115]
v_exp_f32 v105,v105
v_mfma_f32_16x16x32_bf16 v[112:115],a[136:139],a[88:91],v[112:115]
ds_read_b64_tr_b16 a[220:221],v17 offset:24576
v_cvt_pk_bf16_f32 v84,v104,v105
v_mfma_f32_16x16x32_bf16 v[112:115],a[140:143],a[92:95],v[112:115]
v_exp_f32 v106,v106
v_mfma_f32_16x16x32_bf16 v[116:119],a[144:147],a[80:83],v[68:71]
ds_read_b64_tr_b16 a[222:223],v17 offset:28672
ds_read_b64_tr_b16 a[224:225],v18 offset:16384
v_mfma_f32_16x16x32_bf16 v[116:119],a[148:151],a[84:87],v[116:119]
v_exp_f32 v107,v107
v_mfma_f32_16x16x32_bf16 v[116:119],a[152:155],a[88:91],v[116:119]
ds_read_b64_tr_b16 a[226:227],v18 offset:20480
v_cvt_pk_bf16_f32 v85,v106,v107
v_mfma_f32_16x16x32_bf16 v[116:119],a[156:159],a[92:95],v[116:119]
v_exp_f32 v108,v108
v_mfma_f32_16x16x32_bf16 v[120:123],a[160:163],a[80:83],v[68:71]
ds_read_b64_tr_b16 a[228:229],v18 offset:24576
ds_read_b64_tr_b16 a[230:231],v18 offset:28672
v_mfma_f32_16x16x32_bf16 v[120:123],a[164:167],a[84:87],v[120:123]
v_exp_f32 v109,v109
v_mfma_f32_16x16x32_bf16 v[120:123],a[168:171],a[88:91],v[120:123]
ds_read_b64_tr_b16 a[232:233],v19 offset:16384
v_cvt_pk_bf16_f32 v86,v108,v109
v_mfma_f32_16x16x32_bf16 v[120:123],a[172:175],a[92:95],v[120:123]
s_mov_b32 s48,376832
v_exp_f32 v110,v110
v_mfma_f32_16x16x32_bf16 v[124:127],a[176:179],a[80:83],v[68:71]
ds_read_b64_tr_b16 a[234:235],v19 offset:20480
ds_read_b64_tr_b16 a[236:237],v19 offset:24576
s_add_u32 m0,s39,49152
v_mfma_f32_16x16x32_bf16 v[124:127],a[180:183],a[84:87],v[124:127]
buffer_load_dwordx4 v4,s[8:11],s48 offen nt lds
v_exp_f32 v111,v111
v_mfma_f32_16x16x32_bf16 v[124:127],a[184:187],a[88:91],v[124:127]
ds_read_b64_tr_b16 a[238:239],v19 offset:28672
v_cvt_pk_bf16_f32 v87,v110,v111
v_mfma_f32_16x16x32_bf16 v[124:127],a[188:191],a[92:95],v[124:127]
ds_read_b64_tr_b16 a[240:241],v20 offset:16384
ds_read_b64_tr_b16 a[242:243],v20 offset:20480
v_mfma_f32_16x16x32_bf16 v[96:99],a[128:131],a[96:99],v[72:75]
ds_read_b64_tr_b16 a[244:245],v20 offset:24576
ds_read_b64_tr_b16 a[246:247],v20 offset:28672
v_mfma_f32_16x16x32_bf16 v[96:99],a[132:135],a[100:103],v[96:99]
v_exp_f32 v112,v112
v_mfma_f32_16x16x32_bf16 v[96:99],a[136:139],a[104:107],v[96:99]
ds_read_b64_tr_b16 a[248:249],v21 offset:16384
ds_read_b64_tr_b16 a[250:251],v21 offset:20480
v_mfma_f32_16x16x32_bf16 v[96:99],a[140:143],a[108:111],v[96:99]
v_exp_f32 v113,v113
v_mfma_f32_16x16x32_bf16 v[100:103],a[144:147],a[96:99],v[72:75]
ds_read_b64_tr_b16 a[252:253],v21 offset:24576
v_cvt_pk_bf16_f32 v88,v112,v113
v_mfma_f32_16x16x32_bf16 v[100:103],a[148:151],a[100:103],v[100:103]
v_exp_f32 v114,v114
v_mfma_f32_16x16x32_bf16 v[100:103],a[152:155],a[104:107],v[100:103]
ds_read_b64_tr_b16 a[254:255],v21 offset:28672
s_mov_b32 s20,s50
v_mfma_f32_16x16x32_bf16 v[100:103],a[156:159],a[108:111],v[100:103]
v_exp_f32 v115,v115
v_mfma_f32_16x16x32_bf16 v[104:107],a[160:163],a[96:99],v[72:75]
s_mov_b32 s21,s51
v_cvt_pk_bf16_f32 v89,v114,v115
v_mfma_f32_16x16x32_bf16 v[104:107],a[164:167],a[100:103],v[104:107]
v_exp_f32 v116,v116
v_mfma_f32_16x16x32_bf16 v[104:107],a[168:171],a[104:107],v[104:107]
s_mov_b32 s22,1178784
s_mov_b32 s23,0x20000
v_mfma_f32_16x16x32_bf16 v[104:107],a[172:175],a[108:111],v[104:107]
v_exp_f32 v117,v117
v_mfma_f32_16x16x32_bf16 v[108:111],a[176:179],a[96:99],v[72:75]
s_mov_b32 s24,s84
v_cvt_pk_bf16_f32 v90,v116,v117
v_mfma_f32_16x16x32_bf16 v[108:111],a[180:183],a[100:103],v[108:111]
buffer_load_dwordx4 v5,s[8:11],s48 offen offset:1024 nt lds
v_exp_f32 v118,v118
v_mfma_f32_16x16x32_bf16 v[108:111],a[184:187],a[104:107],v[108:111]
s_waitcnt lgkmcnt(0)
s_mov_b32 s25,s85
v_mfma_f32_16x16x32_bf16 v[108:111],a[188:191],a[108:111],v[108:111]
v_exp_f32 v119,v119
v_mfma_f32_16x16x32_bf16 v[128:131],a[192:195],v[80:83],v[128:131]
s_mov_b32 s26,4718592
v_cvt_pk_bf16_f32 v91,v118,v119
v_mfma_f32_16x16x32_bf16 v[128:131],a[196:199],v[84:87],v[128:131]
v_exp_f32 v120,v120
v_mfma_f32_16x16x32_bf16 v[132:135],a[200:203],v[80:83],v[132:135]
s_mov_b32 s27,0x20000
v_mfma_f32_16x16x32_bf16 v[132:135],a[204:207],v[84:87],v[132:135]
v_exp_f32 v121,v121
v_mfma_f32_16x16x32_bf16 v[136:139],a[208:211],v[80:83],v[136:139]
v_cvt_pk_bf16_f32 v92,v120,v121
v_mfma_f32_16x16x32_bf16 v[136:139],a[212:215],v[84:87],v[136:139]
v_exp_f32 v122,v122
v_mfma_f32_16x16x32_bf16 v[140:143],a[216:219],v[80:83],v[140:143]
v_mfma_f32_16x16x32_bf16 v[140:143],a[220:223],v[84:87],v[140:143]
v_exp_f32 v123,v123
v_mfma_f32_16x16x32_bf16 v[144:147],a[224:227],v[80:83],v[144:147]
v_cvt_pk_bf16_f32 v93,v122,v123
v_mfma_f32_16x16x32_bf16 v[144:147],a[228:231],v[84:87],v[144:147]
v_exp_f32 v124,v124
v_mfma_f32_16x16x32_bf16 v[148:151],a[232:235],v[80:83],v[148:151]
v_mfma_f32_16x16x32_bf16 v[148:151],a[236:239],v[84:87],v[148:151]
v_exp_f32 v125,v125
v_mfma_f32_16x16x32_bf16 v[152:155],a[240:243],v[80:83],v[152:155]
v_cvt_pk_bf16_f32 v94,v124,v125
v_mfma_f32_16x16x32_bf16 v[152:155],a[244:247],v[84:87],v[152:155]
buffer_load_dwordx4 v6,s[8:11],s48 offen offset:2048 nt lds
v_exp_f32 v126,v126
v_mfma_f32_16x16x32_bf16 v[156:159],a[248:251],v[80:83],v[156:159]
v_mfma_f32_16x16x32_bf16 v[156:159],a[252:255],v[84:87],v[156:159]
v_exp_f32 v127,v127
v_mfma_f32_16x16x32_bf16 v[48:51],v[44:47],v[80:83],v[48:51]
v_cvt_pk_bf16_f32 v95,v126,v127
v_mfma_f32_16x16x32_bf16 v[48:51],v[44:47],v[84:87],v[48:51]
s_waitcnt vmcnt(3)
s_barrier
v_mfma_f32_16x16x32_bf16 v[112:115],a[128:131],a[112:115],v[76:79]
v_mfma_f32_16x16x32_bf16 v[112:115],a[132:135],a[116:119],v[112:115]
v_exp_f32 v96,v96
v_mfma_f32_16x16x32_bf16 v[112:115],a[136:139],a[120:123],v[112:115]
v_mfma_f32_16x16x32_bf16 v[112:115],a[140:143],a[124:127],v[112:115]
v_exp_f32 v97,v97
v_mfma_f32_16x16x32_bf16 v[116:119],a[144:147],a[112:115],v[76:79]
ds_read_b128 a[128:131],v10 offset:32768
v_cvt_pk_bf16_f32 v80,v96,v97
v_mfma_f32_16x16x32_bf16 v[116:119],a[148:151],a[116:119],v[116:119]
v_exp_f32 v98,v98
v_mfma_f32_16x16x32_bf16 v[116:119],a[152:155],a[120:123],v[116:119]
ds_read_b128 a[132:135],v11 offset:32768
v_mfma_f32_16x16x32_bf16 v[116:119],a[156:159],a[124:127],v[116:119]
v_exp_f32 v99,v99
v_mfma_f32_16x16x32_bf16 v[120:123],a[160:163],a[112:115],v[76:79]
ds_read_b128 a[136:139],v12 offset:32768
v_cvt_pk_bf16_f32 v81,v98,v99
v_mfma_f32_16x16x32_bf16 v[120:123],a[164:167],a[116:119],v[120:123]
v_exp_f32 v100,v100
v_mfma_f32_16x16x32_bf16 v[120:123],a[168:171],a[120:123],v[120:123]
ds_read_b128 a[140:143],v13 offset:32768
v_mfma_f32_16x16x32_bf16 v[120:123],a[172:175],a[124:127],v[120:123]
v_exp_f32 v101,v101
v_mfma_f32_16x16x32_bf16 v[124:127],a[176:179],a[112:115],v[76:79]
ds_read_b128 a[144:147],v10 offset:36864
v_cvt_pk_bf16_f32 v82,v100,v101
v_mfma_f32_16x16x32_bf16 v[124:127],a[180:183],a[116:119],v[124:127]
buffer_load_dwordx4 v7,s[8:11],s48 offen offset:3072 nt lds
v_exp_f32 v102,v102
v_mfma_f32_16x16x32_bf16 v[124:127],a[184:187],a[120:123],v[124:127]
ds_read_b128 a[148:151],v11 offset:36864
v_mfma_f32_16x16x32_bf16 v[124:127],a[188:191],a[124:127],v[124:127]
v_exp_f32 v103,v103
v_mfma_f32_16x16x32_bf16 v[160:163],a[192:195],v[88:91],v[160:163]
ds_read_b128 a[152:155],v12 offset:36864
v_cvt_pk_bf16_f32 v83,v102,v103
v_mfma_f32_16x16x32_bf16 v[160:163],a[196:199],v[92:95],v[160:163]
v_exp_f32 v104,v104
v_mfma_f32_16x16x32_bf16 v[164:167],a[200:203],v[88:91],v[164:167]
ds_read_b128 a[156:159],v13 offset:36864
v_mfma_f32_16x16x32_bf16 v[164:167],a[204:207],v[92:95],v[164:167]
v_exp_f32 v105,v105
v_mfma_f32_16x16x32_bf16 v[168:171],a[208:211],v[88:91],v[168:171]
ds_read_b128 a[160:163],v10 offset:40960
v_cvt_pk_bf16_f32 v84,v104,v105
v_mfma_f32_16x16x32_bf16 v[168:171],a[212:215],v[92:95],v[168:171]
v_exp_f32 v106,v106
v_mfma_f32_16x16x32_bf16 v[172:175],a[216:219],v[88:91],v[172:175]
ds_read_b128 a[164:167],v11 offset:40960
v_mfma_f32_16x16x32_bf16 v[172:175],a[220:223],v[92:95],v[172:175]
v_exp_f32 v107,v107
v_mfma_f32_16x16x32_bf16 v[176:179],a[224:227],v[88:91],v[176:179]
ds_read_b128 a[168:171],v12 offset:40960
v_cvt_pk_bf16_f32 v85,v106,v107
v_mfma_f32_16x16x32_bf16 v[176:179],a[228:231],v[92:95],v[176:179]
v_exp_f32 v108,v108
v_mfma_f32_16x16x32_bf16 v[180:183],a[232:235],v[88:91],v[180:183]
ds_read_b128 a[172:175],v13 offset:40960
v_mfma_f32_16x16x32_bf16 v[180:183],a[236:239],v[92:95],v[180:183]
v_exp_f32 v109,v109
v_mfma_f32_16x16x32_bf16 v[184:187],a[240:243],v[88:91],v[184:187]
ds_read_b128 a[176:179],v10 offset:45056
v_cvt_pk_bf16_f32 v86,v108,v109
v_mfma_f32_16x16x32_bf16 v[184:187],a[244:247],v[92:95],v[184:187]
s_add_u32 m0,s39,114688
v_exp_f32 v110,v110
v_mfma_f32_16x16x32_bf16 v[188:191],a[248:251],v[88:91],v[188:191]
ds_read_b128 a[180:183],v11 offset:45056
v_mfma_f32_16x16x32_bf16 v[188:191],a[252:255],v[92:95],v[188:191]
buffer_load_dwordx4 v8,s[12:15],s48 offen nt lds
v_exp_f32 v111,v111
v_mfma_f32_16x16x32_bf16 v[52:55],v[44:47],v[88:91],v[52:55]
ds_read_b128 a[184:187],v12 offset:45056
v_cvt_pk_bf16_f32 v87,v110,v111
v_mfma_f32_16x16x32_bf16 v[52:55],v[44:47],v[92:95],v[52:55]
ds_read_b128 a[188:191],v13 offset:45056
v_mfma_f32_16x16x32_bf16 v[192:195],a[192:195],v[80:83],v[192:195]
v_mfma_f32_16x16x32_bf16 v[192:195],a[196:199],v[84:87],v[192:195]
v_exp_f32 v112,v112
v_mfma_f32_16x16x32_bf16 v[196:199],a[200:203],v[80:83],v[196:199]
v_mfma_f32_16x16x32_bf16 v[196:199],a[204:207],v[84:87],v[196:199]
v_exp_f32 v113,v113
v_mfma_f32_16x16x32_bf16 v[200:203],a[208:211],v[80:83],v[200:203]
v_cvt_pk_bf16_f32 v88,v112,v113
v_mfma_f32_16x16x32_bf16 v[200:203],a[212:215],v[84:87],v[200:203]
v_exp_f32 v114,v114
v_mfma_f32_16x16x32_bf16 v[204:207],a[216:219],v[80:83],v[204:207]
v_mfma_f32_16x16x32_bf16 v[204:207],a[220:223],v[84:87],v[204:207]
v_exp_f32 v115,v115
v_mfma_f32_16x16x32_bf16 v[208:211],a[224:227],v[80:83],v[208:211]
v_cvt_pk_bf16_f32 v89,v114,v115
v_mfma_f32_16x16x32_bf16 v[208:211],a[228:231],v[84:87],v[208:211]
v_exp_f32 v116,v116
v_mfma_f32_16x16x32_bf16 v[212:215],a[232:235],v[80:83],v[212:215]
v_mfma_f32_16x16x32_bf16 v[212:215],a[236:239],v[84:87],v[212:215]
v_exp_f32 v117,v117
v_mfma_f32_16x16x32_bf16 v[216:219],a[240:243],v[80:83],v[216:219]
buffer_load_dwordx4 v9,s[12:15],s48 offen offset:1024 nt lds
v_cvt_pk_bf16_f32 v90,v116,v117
v_mfma_f32_16x16x32_bf16 v[216:219],a[244:247],v[84:87],v[216:219]
v_exp_f32 v118,v118
v_mfma_f32_16x16x32_bf16 v[220:223],a[248:251],v[80:83],v[220:223]
s_waitcnt lgkmcnt(0)
v_mfma_f32_16x16x32_bf16 v[220:223],a[252:255],v[84:87],v[220:223]
v_exp_f32 v119,v119
v_mfma_f32_16x16x32_bf16 v[56:59],v[44:47],v[80:83],v[56:59]
v_cvt_pk_bf16_f32 v91,v118,v119
v_mfma_f32_16x16x32_bf16 v[56:59],v[44:47],v[84:87],v[56:59]
v_exp_f32 v120,v120
v_mfma_f32_16x16x32_bf16 v[96:99],a[128:131],a[64:67],v[64:67]
v_mfma_f32_16x16x32_bf16 v[96:99],a[132:135],a[68:71],v[96:99]
v_exp_f32 v121,v121
v_mfma_f32_16x16x32_bf16 v[96:99],a[136:139],a[72:75],v[96:99]
v_cvt_pk_bf16_f32 v92,v120,v121
v_mfma_f32_16x16x32_bf16 v[96:99],a[140:143],a[76:79],v[96:99]
v_exp_f32 v122,v122
v_mfma_f32_16x16x32_bf16 v[100:103],a[144:147],a[64:67],v[64:67]
v_mfma_f32_16x16x32_bf16 v[100:103],a[148:151],a[68:71],v[100:103]
v_exp_f32 v123,v123
v_mfma_f32_16x16x32_bf16 v[100:103],a[152:155],a[72:75],v[100:103]
v_cvt_pk_bf16_f32 v93,v122,v123
v_mfma_f32_16x16x32_bf16 v[100:103],a[156:159],a[76:79],v[100:103]
v_exp_f32 v124,v124
v_mfma_f32_16x16x32_bf16 v[104:107],a[160:163],a[64:67],v[64:67]
v_mfma_f32_16x16x32_bf16 v[104:107],a[164:167],a[68:71],v[104:107]
v_exp_f32 v125,v125
v_mfma_f32_16x16x32_bf16 v[104:107],a[168:171],a[72:75],v[104:107]
v_cvt_pk_bf16_f32 v94,v124,v125
v_mfma_f32_16x16x32_bf16 v[104:107],a[172:175],a[76:79],v[104:107]
buffer_load_dwordx4 v8,s[12:15],s48 offen offset:2048 nt lds
v_exp_f32 v126,v126
v_mfma_f32_16x16x32_bf16 v[108:111],a[176:179],a[64:67],v[64:67]
v_mfma_f32_16x16x32_bf16 v[108:111],a[180:183],a[68:71],v[108:111]
v_exp_f32 v127,v127
v_mfma_f32_16x16x32_bf16 v[108:111],a[184:187],a[72:75],v[108:111]
v_cvt_pk_bf16_f32 v95,v126,v127
v_mfma_f32_16x16x32_bf16 v[108:111],a[188:191],a[76:79],v[108:111]
v_mfma_f32_16x16x32_bf16 v[224:227],a[192:195],v[88:91],v[224:227]
v_mfma_f32_16x16x32_bf16 v[224:227],a[196:199],v[92:95],v[224:227]
v_exp_f32 v96,v96
v_mfma_f32_16x16x32_bf16 v[228:231],a[200:203],v[88:91],v[228:231]
ds_read_b64_tr_b16 a[192:193],v14 offset:32768
ds_read_b64_tr_b16 a[194:195],v14 offset:36864
v_mfma_f32_16x16x32_bf16 v[228:231],a[204:207],v[92:95],v[228:231]
v_exp_f32 v97,v97
v_mfma_f32_16x16x32_bf16 v[232:235],a[208:211],v[88:91],v[232:235]
ds_read_b64_tr_b16 a[196:197],v14 offset:40960
v_cvt_pk_bf16_f32 v80,v96,v97
v_mfma_f32_16x16x32_bf16 v[232:235],a[212:215],v[92:95],v[232:235]
v_exp_f32 v98,v98
v_mfma_f32_16x16x32_bf16 v[236:239],a[216:219],v[88:91],v[236:239]
ds_read_b64_tr_b16 a[198:199],v14 offset:45056
ds_read_b64_tr_b16 a[200:201],v15 offset:32768
v_mfma_f32_16x16x32_bf16 v[236:239],a[220:223],v[92:95],v[236:239]
v_exp_f32 v99,v99
v_mfma_f32_16x16x32_bf16 v[240:243],a[224:227],v[88:91],v[240:243]
ds_read_b64_tr_b16 a[202:203],v15 offset:36864
v_cvt_pk_bf16_f32 v81,v98,v99
v_mfma_f32_16x16x32_bf16 v[240:243],a[228:231],v[92:95],v[240:243]
v_exp_f32 v100,v100
v_mfma_f32_16x16x32_bf16 v[244:247],a[232:235],v[88:91],v[244:247]
ds_read_b64_tr_b16 a[204:205],v15 offset:40960
ds_read_b64_tr_b16 a[206:207],v15 offset:45056
v_mfma_f32_16x16x32_bf16 v[244:247],a[236:239],v[92:95],v[244:247]
v_exp_f32 v101,v101
v_mfma_f32_16x16x32_bf16 v[248:251],a[240:243],v[88:91],v[248:251]
ds_read_b64_tr_b16 a[208:209],v16 offset:32768
v_cvt_pk_bf16_f32 v82,v100,v101
v_mfma_f32_16x16x32_bf16 v[248:251],a[244:247],v[92:95],v[248:251]
buffer_load_dwordx4 v9,s[12:15],s48 offen offset:3072 nt lds
v_exp_f32 v102,v102
v_mfma_f32_16x16x32_bf16 v[252:255],a[248:251],v[88:91],v[252:255]
ds_read_b64_tr_b16 a[210:211],v16 offset:36864
ds_read_b64_tr_b16 a[212:213],v16 offset:40960
v_mfma_f32_16x16x32_bf16 v[252:255],a[252:255],v[92:95],v[252:255]
v_exp_f32 v103,v103
v_mfma_f32_16x16x32_bf16 v[60:63],v[44:47],v[88:91],v[60:63]
ds_read_b64_tr_b16 a[214:215],v16 offset:45056
v_cvt_pk_bf16_f32 v83,v102,v103
v_mfma_f32_16x16x32_bf16 v[60:63],v[44:47],v[92:95],v[60:63]
v_exp_f32 v104,v104
v_mfma_f32_16x16x32_bf16 v[112:115],a[128:131],a[80:83],v[68:71]
ds_read_b64_tr_b16 a[216:217],v17 offset:32768
ds_read_b64_tr_b16 a[218:219],v17 offset:36864
v_mfma_f32_16x16x32_bf16 v[112:115],a[132:135],a[84:87],v[112:115]
v_exp_f32 v105,v105
v_mfma_f32_16x16x32_bf16 v[112:115],a[136:139],a[88:91],v[112:115]
ds_read_b64_tr_b16 a[220:221],v17 offset:40960
v_cvt_pk_bf16_f32 v84,v104,v105
v_mfma_f32_16x16x32_bf16 v[112:115],a[140:143],a[92:95],v[112:115]
v_exp_f32 v106,v106
v_mfma_f32_16x16x32_bf16 v[116:119],a[144:147],a[80:83],v[68:71]
ds_read_b64_tr_b16 a[222:223],v17 offset:45056
ds_read_b64_tr_b16 a[224:225],v18 offset:32768
v_mfma_f32_16x16x32_bf16 v[116:119],a[148:151],a[84:87],v[116:119]
v_exp_f32 v107,v107
v_mfma_f32_16x16x32_bf16 v[116:119],a[152:155],a[88:91],v[116:119]
ds_read_b64_tr_b16 a[226:227],v18 offset:36864
v_cvt_pk_bf16_f32 v85,v106,v107
v_mfma_f32_16x16x32_bf16 v[116:119],a[156:159],a[92:95],v[116:119]
v_exp_f32 v108,v108
v_mfma_f32_16x16x32_bf16 v[120:123],a[160:163],a[80:83],v[68:71]
ds_read_b64_tr_b16 a[228:229],v18 offset:40960
ds_read_b64_tr_b16 a[230:231],v18 offset:45056
v_mfma_f32_16x16x32_bf16 v[120:123],a[164:167],a[84:87],v[120:123]
v_exp_f32 v109,v109
v_mfma_f32_16x16x32_bf16 v[120:123],a[168:171],a[88:91],v[120:123]
ds_read_b64_tr_b16 a[232:233],v19 offset:32768
v_cvt_pk_bf16_f32 v86,v108,v109
v_mfma_f32_16x16x32_bf16 v[120:123],a[172:175],a[92:95],v[120:123]
s_mov_b32 s48,393216
v_exp_f32 v110,v110
v_mfma_f32_16x16x32_bf16 v[124:127],a[176:179],a[80:83],v[68:71]
ds_read_b64_tr_b16 a[234:235],v19 offset:36864
ds_read_b64_tr_b16 a[236:237],v19 offset:40960
s_add_u32 m0,s39,0
v_mfma_f32_16x16x32_bf16 v[124:127],a[180:183],a[84:87],v[124:127]
buffer_load_dwordx4 v4,s[8:11],s48 offen nt lds
v_exp_f32 v111,v111
v_mfma_f32_16x16x32_bf16 v[124:127],a[184:187],a[88:91],v[124:127]
ds_read_b64_tr_b16 a[238:239],v19 offset:45056
v_cvt_pk_bf16_f32 v87,v110,v111
v_mfma_f32_16x16x32_bf16 v[124:127],a[188:191],a[92:95],v[124:127]
ds_read_b64_tr_b16 a[240:241],v20 offset:32768
ds_read_b64_tr_b16 a[242:243],v20 offset:36864
v_mfma_f32_16x16x32_bf16 v[96:99],a[128:131],a[96:99],v[72:75]
ds_read_b64_tr_b16 a[244:245],v20 offset:40960
ds_read_b64_tr_b16 a[246:247],v20 offset:45056
v_mfma_f32_16x16x32_bf16 v[96:99],a[132:135],a[100:103],v[96:99]
v_exp_f32 v112,v112
v_mfma_f32_16x16x32_bf16 v[96:99],a[136:139],a[104:107],v[96:99]
ds_read_b64_tr_b16 a[248:249],v21 offset:32768
ds_read_b64_tr_b16 a[250:251],v21 offset:36864
v_mfma_f32_16x16x32_bf16 v[96:99],a[140:143],a[108:111],v[96:99]
v_exp_f32 v113,v113
v_mfma_f32_16x16x32_bf16 v[100:103],a[144:147],a[96:99],v[72:75]
ds_read_b64_tr_b16 a[252:253],v21 offset:40960
v_cvt_pk_bf16_f32 v88,v112,v113
v_mfma_f32_16x16x32_bf16 v[100:103],a[148:151],a[100:103],v[100:103]
v_exp_f32 v114,v114
v_mfma_f32_16x16x32_bf16 v[100:103],a[152:155],a[104:107],v[100:103]
ds_read_b64_tr_b16 a[254:255],v21 offset:45056
v_mfma_f32_16x16x32_bf16 v[100:103],a[156:159],a[108:111],v[100:103]
v_exp_f32 v115,v115
v_mfma_f32_16x16x32_bf16 v[104:107],a[160:163],a[96:99],v[72:75]
v_cvt_pk_bf16_f32 v89,v114,v115
v_mfma_f32_16x16x32_bf16 v[104:107],a[164:167],a[100:103],v[104:107]
v_exp_f32 v116,v116
v_mfma_f32_16x16x32_bf16 v[104:107],a[168:171],a[104:107],v[104:107]
v_mfma_f32_16x16x32_bf16 v[104:107],a[172:175],a[108:111],v[104:107]
v_exp_f32 v117,v117
v_mfma_f32_16x16x32_bf16 v[108:111],a[176:179],a[96:99],v[72:75]
buffer_load_dwordx4 v5,s[8:11],s48 offen offset:1024 nt lds
v_cvt_pk_bf16_f32 v90,v116,v117
v_mfma_f32_16x16x32_bf16 v[108:111],a[180:183],a[100:103],v[108:111]
v_exp_f32 v118,v118
v_mfma_f32_16x16x32_bf16 v[108:111],a[184:187],a[104:107],v[108:111]
s_waitcnt lgkmcnt(0)
v_mfma_f32_16x16x32_bf16 v[108:111],a[188:191],a[108:111],v[108:111]
v_exp_f32 v119,v119
v_mfma_f32_16x16x32_bf16 v[128:131],a[192:195],v[80:83],v[128:131]
v_cvt_pk_bf16_f32 v91,v118,v119
v_mfma_f32_16x16x32_bf16 v[128:131],a[196:199],v[84:87],v[128:131]
v_exp_f32 v120,v120
v_mfma_f32_16x16x32_bf16 v[132:135],a[200:203],v[80:83],v[132:135]
v_mfma_f32_16x16x32_bf16 v[132:135],a[204:207],v[84:87],v[132:135]
v_exp_f32 v121,v121
v_mfma_f32_16x16x32_bf16 v[136:139],a[208:211],v[80:83],v[136:139]
v_cvt_pk_bf16_f32 v92,v120,v121
v_mfma_f32_16x16x32_bf16 v[136:139],a[212:215],v[84:87],v[136:139]
v_exp_f32 v122,v122
v_mfma_f32_16x16x32_bf16 v[140:143],a[216:219],v[80:83],v[140:143]
v_mfma_f32_16x16x32_bf16 v[140:143],a[220:223],v[84:87],v[140:143]
v_exp_f32 v123,v123
v_mfma_f32_16x16x32_bf16 v[144:147],a[224:227],v[80:83],v[144:147]
v_cvt_pk_bf16_f32 v93,v122,v123
v_mfma_f32_16x16x32_bf16 v[144:147],a[228:231],v[84:87],v[144:147]
v_exp_f32 v124,v124
v_mfma_f32_16x16x32_bf16 v[148:151],a[232:235],v[80:83],v[148:151]
v_mfma_f32_16x16x32_bf16 v[148:151],a[236:239],v[84:87],v[148:151]
v_exp_f32 v125,v125
v_mfma_f32_16x16x32_bf16 v[152:155],a[240:243],v[80:83],v[152:155]
v_cvt_pk_bf16_f32 v94,v124,v125
v_mfma_f32_16x16x32_bf16 v[152:155],a[244:247],v[84:87],v[152:155]
buffer_load_dwordx4 v6,s[8:11],s48 offen offset:2048 nt lds
v_exp_f32 v126,v126
v_mfma_f32_16x16x32_bf16 v[156:159],a[248:251],v[80:83],v[156:159]
v_mfma_f32_16x16x32_bf16 v[156:159],a[252:255],v[84:87],v[156:159]
v_exp_f32 v127,v127
v_mfma_f32_16x16x32_bf16 v[48:51],v[44:47],v[80:83],v[48:51]
v_cvt_pk_bf16_f32 v95,v126,v127
v_mfma_f32_16x16x32_bf16 v[48:51],v[44:47],v[84:87],v[48:51]
s_waitcnt vmcnt(3)
s_barrier
v_mfma_f32_16x16x32_bf16 v[112:115],a[128:131],a[112:115],v[76:79]
v_mfma_f32_16x16x32_bf16 v[112:115],a[132:135],a[116:119],v[112:115]
v_exp_f32 v96,v96
v_mfma_f32_16x16x32_bf16 v[112:115],a[136:139],a[120:123],v[112:115]
v_mfma_f32_16x16x32_bf16 v[112:115],a[140:143],a[124:127],v[112:115]
v_exp_f32 v97,v97
v_mfma_f32_16x16x32_bf16 v[116:119],a[144:147],a[112:115],v[76:79]
ds_read_b128 a[128:131],v10 offset:49152
v_cvt_pk_bf16_f32 v80,v96,v97
v_mfma_f32_16x16x32_bf16 v[116:119],a[148:151],a[116:119],v[116:119]
v_exp_f32 v98,v98
v_mfma_f32_16x16x32_bf16 v[116:119],a[152:155],a[120:123],v[116:119]
ds_read_b128 a[132:135],v11 offset:49152
v_mfma_f32_16x16x32_bf16 v[116:119],a[156:159],a[124:127],v[116:119]
v_exp_f32 v99,v99
v_mfma_f32_16x16x32_bf16 v[120:123],a[160:163],a[112:115],v[76:79]
ds_read_b128 a[136:139],v12 offset:49152
v_cvt_pk_bf16_f32 v81,v98,v99
v_mfma_f32_16x16x32_bf16 v[120:123],a[164:167],a[116:119],v[120:123]
v_exp_f32 v100,v100
v_mfma_f32_16x16x32_bf16 v[120:123],a[168:171],a[120:123],v[120:123]
ds_read_b128 a[140:143],v13 offset:49152
v_mfma_f32_16x16x32_bf16 v[120:123],a[172:175],a[124:127],v[120:123]
v_exp_f32 v101,v101
v_mfma_f32_16x16x32_bf16 v[124:127],a[176:179],a[112:115],v[76:79]
ds_read_b128 a[144:147],v10 offset:53248
v_cvt_pk_bf16_f32 v82,v100,v101
v_mfma_f32_16x16x32_bf16 v[124:127],a[180:183],a[116:119],v[124:127]
buffer_load_dwordx4 v7,s[8:11],s48 offen offset:3072 nt lds
v_exp_f32 v102,v102
v_mfma_f32_16x16x32_bf16 v[124:127],a[184:187],a[120:123],v[124:127]
ds_read_b128 a[148:151],v11 offset:53248
v_mfma_f32_16x16x32_bf16 v[124:127],a[188:191],a[124:127],v[124:127]
v_exp_f32 v103,v103
v_mfma_f32_16x16x32_bf16 v[160:163],a[192:195],v[88:91],v[160:163]
ds_read_b128 a[152:155],v12 offset:53248
v_cvt_pk_bf16_f32 v83,v102,v103
v_mfma_f32_16x16x32_bf16 v[160:163],a[196:199],v[92:95],v[160:163]
v_exp_f32 v104,v104
v_mfma_f32_16x16x32_bf16 v[164:167],a[200:203],v[88:91],v[164:167]
ds_read_b128 a[156:159],v13 offset:53248
v_mfma_f32_16x16x32_bf16 v[164:167],a[204:207],v[92:95],v[164:167]
v_exp_f32 v105,v105
v_mfma_f32_16x16x32_bf16 v[168:171],a[208:211],v[88:91],v[168:171]
ds_read_b128 a[160:163],v10 offset:57344
v_cvt_pk_bf16_f32 v84,v104,v105
v_mfma_f32_16x16x32_bf16 v[168:171],a[212:215],v[92:95],v[168:171]
v_exp_f32 v106,v106
v_mfma_f32_16x16x32_bf16 v[172:175],a[216:219],v[88:91],v[172:175]
ds_read_b128 a[164:167],v11 offset:57344
v_mfma_f32_16x16x32_bf16 v[172:175],a[220:223],v[92:95],v[172:175]
v_exp_f32 v107,v107
v_mfma_f32_16x16x32_bf16 v[176:179],a[224:227],v[88:91],v[176:179]
ds_read_b128 a[168:171],v12 offset:57344
v_cvt_pk_bf16_f32 v85,v106,v107
v_mfma_f32_16x16x32_bf16 v[176:179],a[228:231],v[92:95],v[176:179]
v_exp_f32 v108,v108
v_mfma_f32_16x16x32_bf16 v[180:183],a[232:235],v[88:91],v[180:183]
ds_read_b128 a[172:175],v13 offset:57344
v_mfma_f32_16x16x32_bf16 v[180:183],a[236:239],v[92:95],v[180:183]
v_exp_f32 v109,v109
v_mfma_f32_16x16x32_bf16 v[184:187],a[240:243],v[88:91],v[184:187]
ds_read_b128 a[176:179],v10 offset:61440
v_cvt_pk_bf16_f32 v86,v108,v109
v_mfma_f32_16x16x32_bf16 v[184:187],a[244:247],v[92:95],v[184:187]
s_add_u32 m0,s39,65536
v_exp_f32 v110,v110
v_mfma_f32_16x16x32_bf16 v[188:191],a[248:251],v[88:91],v[188:191]
ds_read_b128 a[180:183],v11 offset:61440
v_mfma_f32_16x16x32_bf16 v[188:191],a[252:255],v[92:95],v[188:191]
buffer_load_dwordx4 v8,s[12:15],s48 offen nt lds
v_exp_f32 v111,v111
v_mfma_f32_16x16x32_bf16 v[52:55],v[44:47],v[88:91],v[52:55]
ds_read_b128 a[184:187],v12 offset:61440
v_cvt_pk_bf16_f32 v87,v110,v111
v_mfma_f32_16x16x32_bf16 v[52:55],v[44:47],v[92:95],v[52:55]
ds_read_b128 a[188:191],v13 offset:61440
v_mfma_f32_16x16x32_bf16 v[192:195],a[192:195],v[80:83],v[192:195]
v_mfma_f32_16x16x32_bf16 v[192:195],a[196:199],v[84:87],v[192:195]
v_exp_f32 v112,v112
v_mfma_f32_16x16x32_bf16 v[196:199],a[200:203],v[80:83],v[196:199]
v_mfma_f32_16x16x32_bf16 v[196:199],a[204:207],v[84:87],v[196:199]
v_exp_f32 v113,v113
v_mfma_f32_16x16x32_bf16 v[200:203],a[208:211],v[80:83],v[200:203]
v_cvt_pk_bf16_f32 v88,v112,v113
v_mfma_f32_16x16x32_bf16 v[200:203],a[212:215],v[84:87],v[200:203]
v_exp_f32 v114,v114
v_mfma_f32_16x16x32_bf16 v[204:207],a[216:219],v[80:83],v[204:207]
v_mfma_f32_16x16x32_bf16 v[204:207],a[220:223],v[84:87],v[204:207]
v_exp_f32 v115,v115
v_mfma_f32_16x16x32_bf16 v[208:211],a[224:227],v[80:83],v[208:211]
v_cvt_pk_bf16_f32 v89,v114,v115
v_mfma_f32_16x16x32_bf16 v[208:211],a[228:231],v[84:87],v[208:211]
v_exp_f32 v116,v116
v_mfma_f32_16x16x32_bf16 v[212:215],a[232:235],v[80:83],v[212:215]
v_mfma_f32_16x16x32_bf16 v[212:215],a[236:239],v[84:87],v[212:215]
v_exp_f32 v117,v117
v_mfma_f32_16x16x32_bf16 v[216:219],a[240:243],v[80:83],v[216:219]
buffer_load_dwordx4 v9,s[12:15],s48 offen offset:1024 nt lds
v_cvt_pk_bf16_f32 v90,v116,v117
v_mfma_f32_16x16x32_bf16 v[216:219],a[244:247],v[84:87],v[216:219]
v_exp_f32 v118,v118
v_mfma_f32_16x16x32_bf16 v[220:223],a[248:251],v[80:83],v[220:223]
s_waitcnt lgkmcnt(0)
v_mfma_f32_16x16x32_bf16 v[220:223],a[252:255],v[84:87],v[220:223]
v_exp_f32 v119,v119
v_mfma_f32_16x16x32_bf16 v[56:59],v[44:47],v[80:83],v[56:59]
v_cvt_pk_bf16_f32 v91,v118,v119
v_mfma_f32_16x16x32_bf16 v[56:59],v[44:47],v[84:87],v[56:59]
v_exp_f32 v120,v120
v_mfma_f32_16x16x32_bf16 v[96:99],a[128:131],a[64:67],v[64:67]
v_mfma_f32_16x16x32_bf16 v[96:99],a[132:135],a[68:71],v[96:99]
v_exp_f32 v121,v121
v_mfma_f32_16x16x32_bf16 v[96:99],a[136:139],a[72:75],v[96:99]
v_cvt_pk_bf16_f32 v92,v120,v121
v_mfma_f32_16x16x32_bf16 v[96:99],a[140:143],a[76:79],v[96:99]
v_exp_f32 v122,v122
v_mfma_f32_16x16x32_bf16 v[100:103],a[144:147],a[64:67],v[64:67]
v_mfma_f32_16x16x32_bf16 v[100:103],a[148:151],a[68:71],v[100:103]
v_exp_f32 v123,v123
v_mfma_f32_16x16x32_bf16 v[100:103],a[152:155],a[72:75],v[100:103]
v_cvt_pk_bf16_f32 v93,v122,v123
v_mfma_f32_16x16x32_bf16 v[100:103],a[156:159],a[76:79],v[100:103]
v_exp_f32 v124,v124
v_mfma_f32_16x16x32_bf16 v[104:107],a[160:163],a[64:67],v[64:67]
v_mfma_f32_16x16x32_bf16 v[104:107],a[164:167],a[68:71],v[104:107]
v_exp_f32 v125,v125
v_mfma_f32_16x16x32_bf16 v[104:107],a[168:171],a[72:75],v[104:107]
v_cvt_pk_bf16_f32 v94,v124,v125
v_mfma_f32_16x16x32_bf16 v[104:107],a[172:175],a[76:79],v[104:107]
buffer_load_dwordx4 v8,s[12:15],s48 offen offset:2048 nt lds
v_exp_f32 v126,v126
v_mfma_f32_16x16x32_bf16 v[108:111],a[176:179],a[64:67],v[64:67]
v_mfma_f32_16x16x32_bf16 v[108:111],a[180:183],a[68:71],v[108:111]
v_exp_f32 v127,v127
v_mfma_f32_16x16x32_bf16 v[108:111],a[184:187],a[72:75],v[108:111]
v_cvt_pk_bf16_f32 v95,v126,v127
v_mfma_f32_16x16x32_bf16 v[108:111],a[188:191],a[76:79],v[108:111]
v_mfma_f32_16x16x32_bf16 v[224:227],a[192:195],v[88:91],v[224:227]
v_mfma_f32_16x16x32_bf16 v[224:227],a[196:199],v[92:95],v[224:227]
v_exp_f32 v96,v96
v_mfma_f32_16x16x32_bf16 v[228:231],a[200:203],v[88:91],v[228:231]
ds_read_b64_tr_b16 a[192:193],v14 offset:49152
ds_read_b64_tr_b16 a[194:195],v14 offset:53248
v_mfma_f32_16x16x32_bf16 v[228:231],a[204:207],v[92:95],v[228:231]
v_exp_f32 v97,v97
v_mfma_f32_16x16x32_bf16 v[232:235],a[208:211],v[88:91],v[232:235]
ds_read_b64_tr_b16 a[196:197],v14 offset:57344
v_cvt_pk_bf16_f32 v80,v96,v97
v_mfma_f32_16x16x32_bf16 v[232:235],a[212:215],v[92:95],v[232:235]
v_exp_f32 v98,v98
v_mfma_f32_16x16x32_bf16 v[236:239],a[216:219],v[88:91],v[236:239]
ds_read_b64_tr_b16 a[198:199],v14 offset:61440
ds_read_b64_tr_b16 a[200:201],v15 offset:49152
v_mfma_f32_16x16x32_bf16 v[236:239],a[220:223],v[92:95],v[236:239]
v_exp_f32 v99,v99
v_mfma_f32_16x16x32_bf16 v[240:243],a[224:227],v[88:91],v[240:243]
ds_read_b64_tr_b16 a[202:203],v15 offset:53248
v_cvt_pk_bf16_f32 v81,v98,v99
v_mfma_f32_16x16x32_bf16 v[240:243],a[228:231],v[92:95],v[240:243]
v_exp_f32 v100,v100
v_mfma_f32_16x16x32_bf16 v[244:247],a[232:235],v[88:91],v[244:247]
ds_read_b64_tr_b16 a[204:205],v15 offset:57344
ds_read_b64_tr_b16 a[206:207],v15 offset:61440
v_mfma_f32_16x16x32_bf16 v[244:247],a[236:239],v[92:95],v[244:247]
v_exp_f32 v101,v101
v_mfma_f32_16x16x32_bf16 v[248:251],a[240:243],v[88:91],v[248:251]
ds_read_b64_tr_b16 a[208:209],v16 offset:49152
v_cvt_pk_bf16_f32 v82,v100,v101
v_mfma_f32_16x16x32_bf16 v[248:251],a[244:247],v[92:95],v[248:251]
buffer_load_dwordx4 v9,s[12:15],s48 offen offset:3072 nt lds
v_exp_f32 v102,v102
v_mfma_f32_16x16x32_bf16 v[252:255],a[248:251],v[88:91],v[252:255]
ds_read_b64_tr_b16 a[210:211],v16 offset:53248
ds_read_b64_tr_b16 a[212:213],v16 offset:57344
v_mfma_f32_16x16x32_bf16 v[252:255],a[252:255],v[92:95],v[252:255]
v_exp_f32 v103,v103
v_mfma_f32_16x16x32_bf16 v[60:63],v[44:47],v[88:91],v[60:63]
ds_read_b64_tr_b16 a[214:215],v16 offset:61440
v_cvt_pk_bf16_f32 v83,v102,v103
v_mfma_f32_16x16x32_bf16 v[60:63],v[44:47],v[92:95],v[60:63]
v_exp_f32 v104,v104
v_mfma_f32_16x16x32_bf16 v[112:115],a[128:131],a[80:83],v[68:71]
ds_read_b64_tr_b16 a[216:217],v17 offset:49152
ds_read_b64_tr_b16 a[218:219],v17 offset:53248
v_mfma_f32_16x16x32_bf16 v[112:115],a[132:135],a[84:87],v[112:115]
v_exp_f32 v105,v105
v_mfma_f32_16x16x32_bf16 v[112:115],a[136:139],a[88:91],v[112:115]
ds_read_b64_tr_b16 a[220:221],v17 offset:57344
v_cvt_pk_bf16_f32 v84,v104,v105
v_mfma_f32_16x16x32_bf16 v[112:115],a[140:143],a[92:95],v[112:115]
v_exp_f32 v106,v106
v_mfma_f32_16x16x32_bf16 v[116:119],a[144:147],a[80:83],v[68:71]
ds_read_b64_tr_b16 a[222:223],v17 offset:61440
ds_read_b64_tr_b16 a[224:225],v18 offset:49152
v_mfma_f32_16x16x32_bf16 v[116:119],a[148:151],a[84:87],v[116:119]
v_exp_f32 v107,v107
v_mfma_f32_16x16x32_bf16 v[116:119],a[152:155],a[88:91],v[116:119]
ds_read_b64_tr_b16 a[226:227],v18 offset:53248
v_cvt_pk_bf16_f32 v85,v106,v107
v_mfma_f32_16x16x32_bf16 v[116:119],a[156:159],a[92:95],v[116:119]
v_exp_f32 v108,v108
v_mfma_f32_16x16x32_bf16 v[120:123],a[160:163],a[80:83],v[68:71]
ds_read_b64_tr_b16 a[228:229],v18 offset:57344
ds_read_b64_tr_b16 a[230:231],v18 offset:61440
v_mfma_f32_16x16x32_bf16 v[120:123],a[164:167],a[84:87],v[120:123]
v_exp_f32 v109,v109
v_mfma_f32_16x16x32_bf16 v[120:123],a[168:171],a[88:91],v[120:123]
ds_read_b64_tr_b16 a[232:233],v19 offset:49152
v_cvt_pk_bf16_f32 v86,v108,v109
v_mfma_f32_16x16x32_bf16 v[120:123],a[172:175],a[92:95],v[120:123]
s_mov_b32 s48,409600
v_exp_f32 v110,v110
v_mfma_f32_16x16x32_bf16 v[124:127],a[176:179],a[80:83],v[68:71]
ds_read_b64_tr_b16 a[234:235],v19 offset:53248
ds_read_b64_tr_b16 a[236:237],v19 offset:57344
s_add_u32 m0,s39,16384
v_mfma_f32_16x16x32_bf16 v[124:127],a[180:183],a[84:87],v[124:127]
buffer_load_dwordx4 v4,s[8:11],s48 offen nt lds
v_exp_f32 v111,v111
v_mfma_f32_16x16x32_bf16 v[124:127],a[184:187],a[88:91],v[124:127]
ds_read_b64_tr_b16 a[238:239],v19 offset:61440
v_cvt_pk_bf16_f32 v87,v110,v111
v_mfma_f32_16x16x32_bf16 v[124:127],a[188:191],a[92:95],v[124:127]
ds_read_b64_tr_b16 a[240:241],v20 offset:49152
ds_read_b64_tr_b16 a[242:243],v20 offset:53248
v_mfma_f32_16x16x32_bf16 v[96:99],a[128:131],a[96:99],v[72:75]
ds_read_b64_tr_b16 a[244:245],v20 offset:57344
ds_read_b64_tr_b16 a[246:247],v20 offset:61440
v_mfma_f32_16x16x32_bf16 v[96:99],a[132:135],a[100:103],v[96:99]
v_exp_f32 v112,v112
v_mfma_f32_16x16x32_bf16 v[96:99],a[136:139],a[104:107],v[96:99]
ds_read_b64_tr_b16 a[248:249],v21 offset:49152
ds_read_b64_tr_b16 a[250:251],v21 offset:53248
v_mfma_f32_16x16x32_bf16 v[96:99],a[140:143],a[108:111],v[96:99]
v_exp_f32 v113,v113
v_mfma_f32_16x16x32_bf16 v[100:103],a[144:147],a[96:99],v[72:75]
ds_read_b64_tr_b16 a[252:253],v21 offset:57344
v_cvt_pk_bf16_f32 v88,v112,v113
v_mfma_f32_16x16x32_bf16 v[100:103],a[148:151],a[100:103],v[100:103]
v_exp_f32 v114,v114
v_mfma_f32_16x16x32_bf16 v[100:103],a[152:155],a[104:107],v[100:103]
ds_read_b64_tr_b16 a[254:255],v21 offset:61440
v_mfma_f32_16x16x32_bf16 v[100:103],a[156:159],a[108:111],v[100:103]
v_exp_f32 v115,v115
v_mfma_f32_16x16x32_bf16 v[104:107],a[160:163],a[96:99],v[72:75]
v_cvt_pk_bf16_f32 v89,v114,v115
v_mfma_f32_16x16x32_bf16 v[104:107],a[164:167],a[100:103],v[104:107]
v_exp_f32 v116,v116
v_mfma_f32_16x16x32_bf16 v[104:107],a[168:171],a[104:107],v[104:107]
buffer_load_dwordx4 v5,s[8:11],s48 offen offset:1024 nt lds
v_mfma_f32_16x16x32_bf16 v[104:107],a[172:175],a[108:111],v[104:107]
v_exp_f32 v117,v117
v_mfma_f32_16x16x32_bf16 v[108:111],a[176:179],a[96:99],v[72:75]
v_cvt_pk_bf16_f32 v90,v116,v117
v_mfma_f32_16x16x32_bf16 v[108:111],a[180:183],a[100:103],v[108:111]
v_exp_f32 v118,v118
v_mfma_f32_16x16x32_bf16 v[108:111],a[184:187],a[104:107],v[108:111]
s_waitcnt lgkmcnt(0)
v_mfma_f32_16x16x32_bf16 v[108:111],a[188:191],a[108:111],v[108:111]
v_exp_f32 v119,v119
v_mfma_f32_16x16x32_bf16 v[128:131],a[192:195],v[80:83],v[128:131]
v_cvt_pk_bf16_f32 v91,v118,v119
v_mfma_f32_16x16x32_bf16 v[128:131],a[196:199],v[84:87],v[128:131]
v_exp_f32 v120,v120
v_mfma_f32_16x16x32_bf16 v[132:135],a[200:203],v[80:83],v[132:135]
v_mfma_f32_16x16x32_bf16 v[132:135],a[204:207],v[84:87],v[132:135]
v_exp_f32 v121,v121
v_mfma_f32_16x16x32_bf16 v[136:139],a[208:211],v[80:83],v[136:139]
v_cvt_pk_bf16_f32 v92,v120,v121
v_mfma_f32_16x16x32_bf16 v[136:139],a[212:215],v[84:87],v[136:139]
v_exp_f32 v122,v122
v_mfma_f32_16x16x32_bf16 v[140:143],a[216:219],v[80:83],v[140:143]
v_mfma_f32_16x16x32_bf16 v[140:143],a[220:223],v[84:87],v[140:143]
v_exp_f32 v123,v123
v_mfma_f32_16x16x32_bf16 v[144:147],a[224:227],v[80:83],v[144:147]
buffer_load_dwordx4 v6,s[8:11],s48 offen offset:2048 nt lds
v_cvt_pk_bf16_f32 v93,v122,v123
v_mfma_f32_16x16x32_bf16 v[144:147],a[228:231],v[84:87],v[144:147]
v_exp_f32 v124,v124
v_mfma_f32_16x16x32_bf16 v[148:151],a[232:235],v[80:83],v[148:151]
v_mfma_f32_16x16x32_bf16 v[148:151],a[236:239],v[84:87],v[148:151]
v_exp_f32 v125,v125
v_mfma_f32_16x16x32_bf16 v[152:155],a[240:243],v[80:83],v[152:155]
v_cvt_pk_bf16_f32 v94,v124,v125
v_mfma_f32_16x16x32_bf16 v[152:155],a[244:247],v[84:87],v[152:155]
v_exp_f32 v126,v126
v_mfma_f32_16x16x32_bf16 v[156:159],a[248:251],v[80:83],v[156:159]
v_mfma_f32_16x16x32_bf16 v[156:159],a[252:255],v[84:87],v[156:159]
v_exp_f32 v127,v127
v_mfma_f32_16x16x32_bf16 v[48:51],v[44:47],v[80:83],v[48:51]
v_cvt_pk_bf16_f32 v95,v126,v127
v_mfma_f32_16x16x32_bf16 v[48:51],v[44:47],v[84:87],v[48:51]
s_waitcnt vmcnt(3)
s_barrier
v_mfma_f32_16x16x32_bf16 v[112:115],a[128:131],a[112:115],v[76:79]
v_mfma_f32_16x16x32_bf16 v[112:115],a[132:135],a[116:119],v[112:115]
v_exp_f32 v96,v96
v_mfma_f32_16x16x32_bf16 v[112:115],a[136:139],a[120:123],v[112:115]
v_mfma_f32_16x16x32_bf16 v[112:115],a[140:143],a[124:127],v[112:115]
v_exp_f32 v97,v97
v_mfma_f32_16x16x32_bf16 v[116:119],a[144:147],a[112:115],v[76:79]
ds_read_b128 a[128:131],v10 offset:0
v_cvt_pk_bf16_f32 v80,v96,v97
v_mfma_f32_16x16x32_bf16 v[116:119],a[148:151],a[116:119],v[116:119]
buffer_load_dwordx4 v7,s[8:11],s48 offen offset:3072 nt lds
v_exp_f32 v98,v98
v_mfma_f32_16x16x32_bf16 v[116:119],a[152:155],a[120:123],v[116:119]
ds_read_b128 a[132:135],v11 offset:0
v_mfma_f32_16x16x32_bf16 v[116:119],a[156:159],a[124:127],v[116:119]
v_exp_f32 v99,v99
v_mfma_f32_16x16x32_bf16 v[120:123],a[160:163],a[112:115],v[76:79]
ds_read_b128 a[136:139],v12 offset:0
v_cvt_pk_bf16_f32 v81,v98,v99
v_mfma_f32_16x16x32_bf16 v[120:123],a[164:167],a[116:119],v[120:123]
v_exp_f32 v100,v100
v_mfma_f32_16x16x32_bf16 v[120:123],a[168:171],a[120:123],v[120:123]
ds_read_b128 a[140:143],v13 offset:0
v_mfma_f32_16x16x32_bf16 v[120:123],a[172:175],a[124:127],v[120:123]
v_exp_f32 v101,v101
v_mfma_f32_16x16x32_bf16 v[124:127],a[176:179],a[112:115],v[76:79]
ds_read_b128 a[144:147],v10 offset:4096
v_cvt_pk_bf16_f32 v82,v100,v101
v_mfma_f32_16x16x32_bf16 v[124:127],a[180:183],a[116:119],v[124:127]
v_exp_f32 v102,v102
v_mfma_f32_16x16x32_bf16 v[124:127],a[184:187],a[120:123],v[124:127]
ds_read_b128 a[148:151],v11 offset:4096
v_mfma_f32_16x16x32_bf16 v[124:127],a[188:191],a[124:127],v[124:127]
v_exp_f32 v103,v103
v_mfma_f32_16x16x32_bf16 v[160:163],a[192:195],v[88:91],v[160:163]
ds_read_b128 a[152:155],v12 offset:4096
v_cvt_pk_bf16_f32 v83,v102,v103
v_mfma_f32_16x16x32_bf16 v[160:163],a[196:199],v[92:95],v[160:163]
v_exp_f32 v104,v104
v_mfma_f32_16x16x32_bf16 v[164:167],a[200:203],v[88:91],v[164:167]
ds_read_b128 a[156:159],v13 offset:4096
v_mfma_f32_16x16x32_bf16 v[164:167],a[204:207],v[92:95],v[164:167]
s_add_u32 m0,s39,81920
v_exp_f32 v105,v105
v_mfma_f32_16x16x32_bf16 v[168:171],a[208:211],v[88:91],v[168:171]
ds_read_b128 a[160:163],v10 offset:8192
v_cvt_pk_bf16_f32 v84,v104,v105
v_mfma_f32_16x16x32_bf16 v[168:171],a[212:215],v[92:95],v[168:171]
buffer_load_dwordx4 v8,s[12:15],s48 offen nt lds
v_exp_f32 v106,v106
v_mfma_f32_16x16x32_bf16 v[172:175],a[216:219],v[88:91],v[172:175]
ds_read_b128 a[164:167],v11 offset:8192
v_mfma_f32_16x16x32_bf16 v[172:175],a[220:223],v[92:95],v[172:175]
v_exp_f32 v107,v107
v_mfma_f32_16x16x32_bf16 v[176:179],a[224:227],v[88:91],v[176:179]
ds_read_b128 a[168:171],v12 offset:8192
v_cvt_pk_bf16_f32 v85,v106,v107
v_mfma_f32_16x16x32_bf16 v[176:179],a[228:231],v[92:95],v[176:179]
v_exp_f32 v108,v108
v_mfma_f32_16x16x32_bf16 v[180:183],a[232:235],v[88:91],v[180:183]
ds_read_b128 a[172:175],v13 offset:8192
v_mfma_f32_16x16x32_bf16 v[180:183],a[236:239],v[92:95],v[180:183]
v_exp_f32 v109,v109
v_mfma_f32_16x16x32_bf16 v[184:187],a[240:243],v[88:91],v[184:187]
ds_read_b128 a[176:179],v10 offset:12288
v_cvt_pk_bf16_f32 v86,v108,v109
v_mfma_f32_16x16x32_bf16 v[184:187],a[244:247],v[92:95],v[184:187]
v_exp_f32 v110,v110
v_mfma_f32_16x16x32_bf16 v[188:191],a[248:251],v[88:91],v[188:191]
ds_read_b128 a[180:183],v11 offset:12288
v_mfma_f32_16x16x32_bf16 v[188:191],a[252:255],v[92:95],v[188:191]
v_exp_f32 v111,v111
v_mfma_f32_16x16x32_bf16 v[52:55],v[44:47],v[88:91],v[52:55]
ds_read_b128 a[184:187],v12 offset:12288
v_cvt_pk_bf16_f32 v87,v110,v111
v_mfma_f32_16x16x32_bf16 v[52:55],v[44:47],v[92:95],v[52:55]
ds_read_b128 a[188:191],v13 offset:12288
v_mfma_f32_16x16x32_bf16 v[192:195],a[192:195],v[80:83],v[192:195]
buffer_load_dwordx4 v9,s[12:15],s48 offen offset:1024 nt lds
v_mfma_f32_16x16x32_bf16 v[192:195],a[196:199],v[84:87],v[192:195]
v_exp_f32 v112,v112
v_mfma_f32_16x16x32_bf16 v[196:199],a[200:203],v[80:83],v[196:199]
v_mfma_f32_16x16x32_bf16 v[196:199],a[204:207],v[84:87],v[196:199]
v_exp_f32 v113,v113
v_mfma_f32_16x16x32_bf16 v[200:203],a[208:211],v[80:83],v[200:203]
v_cvt_pk_bf16_f32 v88,v112,v113
v_mfma_f32_16x16x32_bf16 v[200:203],a[212:215],v[84:87],v[200:203]
v_exp_f32 v114,v114
v_mfma_f32_16x16x32_bf16 v[204:207],a[216:219],v[80:83],v[204:207]
v_mfma_f32_16x16x32_bf16 v[204:207],a[220:223],v[84:87],v[204:207]
v_exp_f32 v115,v115
v_mfma_f32_16x16x32_bf16 v[208:211],a[224:227],v[80:83],v[208:211]
v_cvt_pk_bf16_f32 v89,v114,v115
v_mfma_f32_16x16x32_bf16 v[208:211],a[228:231],v[84:87],v[208:211]
v_exp_f32 v116,v116
v_mfma_f32_16x16x32_bf16 v[212:215],a[232:235],v[80:83],v[212:215]
v_mfma_f32_16x16x32_bf16 v[212:215],a[236:239],v[84:87],v[212:215]
v_exp_f32 v117,v117
v_mfma_f32_16x16x32_bf16 v[216:219],a[240:243],v[80:83],v[216:219]
v_cvt_pk_bf16_f32 v90,v116,v117
v_mfma_f32_16x16x32_bf16 v[216:219],a[244:247],v[84:87],v[216:219]
buffer_load_dwordx4 v8,s[12:15],s48 offen offset:2048 nt lds
v_exp_f32 v118,v118
v_mfma_f32_16x16x32_bf16 v[220:223],a[248:251],v[80:83],v[220:223]
s_waitcnt lgkmcnt(0)
v_mfma_f32_16x16x32_bf16 v[220:223],a[252:255],v[84:87],v[220:223]
v_exp_f32 v119,v119
v_mfma_f32_16x16x32_bf16 v[56:59],v[44:47],v[80:83],v[56:59]
v_cvt_pk_bf16_f32 v91,v118,v119
v_mfma_f32_16x16x32_bf16 v[56:59],v[44:47],v[84:87],v[56:59]
v_exp_f32 v120,v120
v_mfma_f32_16x16x32_bf16 v[96:99],a[128:131],a[64:67],v[64:67]
v_mfma_f32_16x16x32_bf16 v[96:99],a[132:135],a[68:71],v[96:99]
v_exp_f32 v121,v121
v_mfma_f32_16x16x32_bf16 v[96:99],a[136:139],a[72:75],v[96:99]
v_cvt_pk_bf16_f32 v92,v120,v121
v_mfma_f32_16x16x32_bf16 v[96:99],a[140:143],a[76:79],v[96:99]
v_exp_f32 v122,v122
v_mfma_f32_16x16x32_bf16 v[100:103],a[144:147],a[64:67],v[64:67]
v_mfma_f32_16x16x32_bf16 v[100:103],a[148:151],a[68:71],v[100:103]
v_exp_f32 v123,v123
v_mfma_f32_16x16x32_bf16 v[100:103],a[152:155],a[72:75],v[100:103]
v_cvt_pk_bf16_f32 v93,v122,v123
v_mfma_f32_16x16x32_bf16 v[100:103],a[156:159],a[76:79],v[100:103]
v_exp_f32 v124,v124
v_mfma_f32_16x16x32_bf16 v[104:107],a[160:163],a[64:67],v[64:67]
v_mfma_f32_16x16x32_bf16 v[104:107],a[164:167],a[68:71],v[104:107]
buffer_load_dwordx4 v9,s[12:15],s48 offen offset:3072 nt lds
v_exp_f32 v125,v125
v_mfma_f32_16x16x32_bf16 v[104:107],a[168:171],a[72:75],v[104:107]
v_cvt_pk_bf16_f32 v94,v124,v125
v_mfma_f32_16x16x32_bf16 v[104:107],a[172:175],a[76:79],v[104:107]
v_exp_f32 v126,v126
v_mfma_f32_16x16x32_bf16 v[108:111],a[176:179],a[64:67],v[64:67]
v_mfma_f32_16x16x32_bf16 v[108:111],a[180:183],a[68:71],v[108:111]
v_exp_f32 v127,v127
v_mfma_f32_16x16x32_bf16 v[108:111],a[184:187],a[72:75],v[108:111]
v_cvt_pk_bf16_f32 v95,v126,v127
v_mfma_f32_16x16x32_bf16 v[108:111],a[188:191],a[76:79],v[108:111]
v_mfma_f32_16x16x32_bf16 v[224:227],a[192:195],v[88:91],v[224:227]
v_mfma_f32_16x16x32_bf16 v[224:227],a[196:199],v[92:95],v[224:227]
v_exp_f32 v96,v96
v_mfma_f32_16x16x32_bf16 v[228:231],a[200:203],v[88:91],v[228:231]
ds_read_b64_tr_b16 a[192:193],v14 offset:0
ds_read_b64_tr_b16 a[194:195],v14 offset:4096
v_mfma_f32_16x16x32_bf16 v[228:231],a[204:207],v[92:95],v[228:231]
v_exp_f32 v97,v97
v_mfma_f32_16x16x32_bf16 v[232:235],a[208:211],v[88:91],v[232:235]
ds_read_b64_tr_b16 a[196:197],v14 offset:8192
v_cvt_pk_bf16_f32 v80,v96,v97
v_mfma_f32_16x16x32_bf16 v[232:235],a[212:215],v[92:95],v[232:235]
v_exp_f32 v98,v98
v_mfma_f32_16x16x32_bf16 v[236:239],a[216:219],v[88:91],v[236:239]
ds_read_b64_tr_b16 a[198:199],v14 offset:12288
ds_read_b64_tr_b16 a[200:201],v15 offset:0
v_mfma_f32_16x16x32_bf16 v[236:239],a[220:223],v[92:95],v[236:239]
v_exp_f32 v99,v99
v_mfma_f32_16x16x32_bf16 v[240:243],a[224:227],v[88:91],v[240:243]
ds_read_b64_tr_b16 a[202:203],v15 offset:4096
s_mov_b32 s48,425984
v_cvt_pk_bf16_f32 v81,v98,v99
v_mfma_f32_16x16x32_bf16 v[240:243],a[228:231],v[92:95],v[240:243]
s_add_u32 m0,s39,32768
v_exp_f32 v100,v100
v_mfma_f32_16x16x32_bf16 v[244:247],a[232:235],v[88:91],v[244:247]
ds_read_b64_tr_b16 a[204:205],v15 offset:8192
ds_read_b64_tr_b16 a[206:207],v15 offset:12288
v_mfma_f32_16x16x32_bf16 v[244:247],a[236:239],v[92:95],v[244:247]
buffer_load_dwordx4 v4,s[8:11],s48 offen nt lds
v_exp_f32 v101,v101
v_mfma_f32_16x16x32_bf16 v[248:251],a[240:243],v[88:91],v[248:251]
ds_read_b64_tr_b16 a[208:209],v16 offset:0
v_cvt_pk_bf16_f32 v82,v100,v101
v_mfma_f32_16x16x32_bf16 v[248:251],a[244:247],v[92:95],v[248:251]
v_exp_f32 v102,v102
v_mfma_f32_16x16x32_bf16 v[252:255],a[248:251],v[88:91],v[252:255]
ds_read_b64_tr_b16 a[210:211],v16 offset:4096
ds_read_b64_tr_b16 a[212:213],v16 offset:8192
v_mfma_f32_16x16x32_bf16 v[252:255],a[252:255],v[92:95],v[252:255]
v_exp_f32 v103,v103
v_mfma_f32_16x16x32_bf16 v[60:63],v[44:47],v[88:91],v[60:63]
ds_read_b64_tr_b16 a[214:215],v16 offset:12288
v_cvt_pk_bf16_f32 v83,v102,v103
v_mfma_f32_16x16x32_bf16 v[60:63],v[44:47],v[92:95],v[60:63]
v_exp_f32 v104,v104
v_mfma_f32_16x16x32_bf16 v[112:115],a[128:131],a[80:83],v[68:71]
ds_read_b64_tr_b16 a[216:217],v17 offset:0
ds_read_b64_tr_b16 a[218:219],v17 offset:4096
v_mfma_f32_16x16x32_bf16 v[112:115],a[132:135],a[84:87],v[112:115]
v_exp_f32 v105,v105
v_mfma_f32_16x16x32_bf16 v[112:115],a[136:139],a[88:91],v[112:115]
ds_read_b64_tr_b16 a[220:221],v17 offset:8192
v_cvt_pk_bf16_f32 v84,v104,v105
v_mfma_f32_16x16x32_bf16 v[112:115],a[140:143],a[92:95],v[112:115]
v_exp_f32 v106,v106
v_mfma_f32_16x16x32_bf16 v[116:119],a[144:147],a[80:83],v[68:71]
ds_read_b64_tr_b16 a[222:223],v17 offset:12288
ds_read_b64_tr_b16 a[224:225],v18 offset:0
v_mfma_f32_16x16x32_bf16 v[116:119],a[148:151],a[84:87],v[116:119]
buffer_load_dwordx4 v5,s[8:11],s48 offen offset:1024 nt lds
v_exp_f32 v107,v107
v_mfma_f32_16x16x32_bf16 v[116:119],a[152:155],a[88:91],v[116:119]
ds_read_b64_tr_b16 a[226:227],v18 offset:4096
v_cvt_pk_bf16_f32 v85,v106,v107
v_mfma_f32_16x16x32_bf16 v[116:119],a[156:159],a[92:95],v[116:119]
v_exp_f32 v108,v108
v_mfma_f32_16x16x32_bf16 v[120:123],a[160:163],a[80:83],v[68:71]
ds_read_b64_tr_b16 a[228:229],v18 offset:8192
ds_read_b64_tr_b16 a[230:231],v18 offset:12288
v_mfma_f32_16x16x32_bf16 v[120:123],a[164:167],a[84:87],v[120:123]
v_exp_f32 v109,v109
v_mfma_f32_16x16x32_bf16 v[120:123],a[168:171],a[88:91],v[120:123]
ds_read_b64_tr_b16 a[232:233],v19 offset:0
v_cvt_pk_bf16_f32 v86,v108,v109
v_mfma_f32_16x16x32_bf16 v[120:123],a[172:175],a[92:95],v[120:123]
v_exp_f32 v110,v110
v_mfma_f32_16x16x32_bf16 v[124:127],a[176:179],a[80:83],v[68:71]
ds_read_b64_tr_b16 a[234:235],v19 offset:4096
ds_read_b64_tr_b16 a[236:237],v19 offset:8192
v_mfma_f32_16x16x32_bf16 v[124:127],a[180:183],a[84:87],v[124:127]
v_exp_f32 v111,v111
v_mfma_f32_16x16x32_bf16 v[124:127],a[184:187],a[88:91],v[124:127]
ds_read_b64_tr_b16 a[238:239],v19 offset:12288
v_cvt_pk_bf16_f32 v87,v110,v111
v_mfma_f32_16x16x32_bf16 v[124:127],a[188:191],a[92:95],v[124:127]
ds_read_b64_tr_b16 a[240:241],v20 offset:0
ds_read_b64_tr_b16 a[242:243],v20 offset:4096
v_mfma_f32_16x16x32_bf16 v[96:99],a[128:131],a[96:99],v[72:75]
ds_read_b64_tr_b16 a[244:245],v20 offset:8192
ds_read_b64_tr_b16 a[246:247],v20 offset:12288
v_mfma_f32_16x16x32_bf16 v[96:99],a[132:135],a[100:103],v[96:99]
v_exp_f32 v112,v112
v_mfma_f32_16x16x32_bf16 v[96:99],a[136:139],a[104:107],v[96:99]
ds_read_b64_tr_b16 a[248:249],v21 offset:0
ds_read_b64_tr_b16 a[250:251],v21 offset:4096
v_mfma_f32_16x16x32_bf16 v[96:99],a[140:143],a[108:111],v[96:99]
buffer_load_dwordx4 v6,s[8:11],s48 offen offset:2048 nt lds
v_exp_f32 v113,v113
v_mfma_f32_16x16x32_bf16 v[100:103],a[144:147],a[96:99],v[72:75]
ds_read_b64_tr_b16 a[252:253],v21 offset:8192
v_cvt_pk_bf16_f32 v88,v112,v113
v_mfma_f32_16x16x32_bf16 v[100:103],a[148:151],a[100:103],v[100:103]
v_exp_f32 v114,v114
v_mfma_f32_16x16x32_bf16 v[100:103],a[152:155],a[104:107],v[100:103]
ds_read_b64_tr_b16 a[254:255],v21 offset:12288
v_mfma_f32_16x16x32_bf16 v[100:103],a[156:159],a[108:111],v[100:103]
v_exp_f32 v115,v115
v_mfma_f32_16x16x32_bf16 v[104:107],a[160:163],a[96:99],v[72:75]
v_cvt_pk_bf16_f32 v89,v114,v115
v_mfma_f32_16x16x32_bf16 v[104:107],a[164:167],a[100:103],v[104:107]
v_exp_f32 v116,v116
v_mfma_f32_16x16x32_bf16 v[104:107],a[168:171],a[104:107],v[104:107]
v_mfma_f32_16x16x32_bf16 v[104:107],a[172:175],a[108:111],v[104:107]
v_exp_f32 v117,v117
v_mfma_f32_16x16x32_bf16 v[108:111],a[176:179],a[96:99],v[72:75]
v_cvt_pk_bf16_f32 v90,v116,v117
v_mfma_f32_16x16x32_bf16 v[108:111],a[180:183],a[100:103],v[108:111]
v_exp_f32 v118,v118
v_mfma_f32_16x16x32_bf16 v[108:111],a[184:187],a[104:107],v[108:111]
s_waitcnt lgkmcnt(0)
v_mfma_f32_16x16x32_bf16 v[108:111],a[188:191],a[108:111],v[108:111]
v_exp_f32 v119,v119
v_mfma_f32_16x16x32_bf16 v[128:131],a[192:195],v[80:83],v[128:131]
v_cvt_pk_bf16_f32 v91,v118,v119
v_mfma_f32_16x16x32_bf16 v[128:131],a[196:199],v[84:87],v[128:131]
buffer_load_dwordx4 v7,s[8:11],s48 offen offset:3072 nt lds
v_exp_f32 v120,v120
v_mfma_f32_16x16x32_bf16 v[132:135],a[200:203],v[80:83],v[132:135]
v_mfma_f32_16x16x32_bf16 v[132:135],a[204:207],v[84:87],v[132:135]
v_exp_f32 v121,v121
v_mfma_f32_16x16x32_bf16 v[136:139],a[208:211],v[80:83],v[136:139]
v_cvt_pk_bf16_f32 v92,v120,v121
v_mfma_f32_16x16x32_bf16 v[136:139],a[212:215],v[84:87],v[136:139]
v_exp_f32 v122,v122
v_mfma_f32_16x16x32_bf16 v[140:143],a[216:219],v[80:83],v[140:143]
v_mfma_f32_16x16x32_bf16 v[140:143],a[220:223],v[84:87],v[140:143]
v_exp_f32 v123,v123
v_mfma_f32_16x16x32_bf16 v[144:147],a[224:227],v[80:83],v[144:147]
v_cvt_pk_bf16_f32 v93,v122,v123
v_mfma_f32_16x16x32_bf16 v[144:147],a[228:231],v[84:87],v[144:147]
v_exp_f32 v124,v124
v_mfma_f32_16x16x32_bf16 v[148:151],a[232:235],v[80:83],v[148:151]
v_mfma_f32_16x16x32_bf16 v[148:151],a[236:239],v[84:87],v[148:151]
v_exp_f32 v125,v125
v_mfma_f32_16x16x32_bf16 v[152:155],a[240:243],v[80:83],v[152:155]
v_cvt_pk_bf16_f32 v94,v124,v125
v_mfma_f32_16x16x32_bf16 v[152:155],a[244:247],v[84:87],v[152:155]
v_exp_f32 v126,v126
v_mfma_f32_16x16x32_bf16 v[156:159],a[248:251],v[80:83],v[156:159]
v_mfma_f32_16x16x32_bf16 v[156:159],a[252:255],v[84:87],v[156:159]
s_add_u32 m0,s39,98304
v_exp_f32 v127,v127
v_mfma_f32_16x16x32_bf16 v[48:51],v[44:47],v[80:83],v[48:51]
buffer_load_dwordx4 v8,s[12:15],s48 offen nt lds
v_cvt_pk_bf16_f32 v95,v126,v127
v_mfma_f32_16x16x32_bf16 v[48:51],v[44:47],v[84:87],v[48:51]
s_waitcnt vmcnt(5)
s_barrier
v_mfma_f32_16x16x32_bf16 v[112:115],a[128:131],a[112:115],v[76:79]
v_mfma_f32_16x16x32_bf16 v[112:115],a[132:135],a[116:119],v[112:115]
v_exp_f32 v96,v96
v_mfma_f32_16x16x32_bf16 v[112:115],a[136:139],a[120:123],v[112:115]
v_mfma_f32_16x16x32_bf16 v[112:115],a[140:143],a[124:127],v[112:115]
v_exp_f32 v97,v97
v_mfma_f32_16x16x32_bf16 v[116:119],a[144:147],a[112:115],v[76:79]
ds_read_b128 a[128:131],v10 offset:16384
v_cvt_pk_bf16_f32 v80,v96,v97
v_mfma_f32_16x16x32_bf16 v[116:119],a[148:151],a[116:119],v[116:119]
v_exp_f32 v98,v98
v_mfma_f32_16x16x32_bf16 v[116:119],a[152:155],a[120:123],v[116:119]
ds_read_b128 a[132:135],v11 offset:16384
v_mfma_f32_16x16x32_bf16 v[116:119],a[156:159],a[124:127],v[116:119]
v_exp_f32 v99,v99
v_mfma_f32_16x16x32_bf16 v[120:123],a[160:163],a[112:115],v[76:79]
ds_read_b128 a[136:139],v12 offset:16384
v_cvt_pk_bf16_f32 v81,v98,v99
v_mfma_f32_16x16x32_bf16 v[120:123],a[164:167],a[116:119],v[120:123]
v_exp_f32 v100,v100
v_mfma_f32_16x16x32_bf16 v[120:123],a[168:171],a[120:123],v[120:123]
ds_read_b128 a[140:143],v13 offset:16384
v_mfma_f32_16x16x32_bf16 v[120:123],a[172:175],a[124:127],v[120:123]
buffer_load_dwordx4 v9,s[12:15],s48 offen offset:1024 nt lds
v_exp_f32 v101,v101
v_mfma_f32_16x16x32_bf16 v[124:127],a[176:179],a[112:115],v[76:79]
ds_read_b128 a[144:147],v10 offset:20480
v_cvt_pk_bf16_f32 v82,v100,v101
v_mfma_f32_16x16x32_bf16 v[124:127],a[180:183],a[116:119],v[124:127]
v_exp_f32 v102,v102
v_mfma_f32_16x16x32_bf16 v[124:127],a[184:187],a[120:123],v[124:127]
ds_read_b128 a[148:151],v11 offset:20480
v_mfma_f32_16x16x32_bf16 v[124:127],a[188:191],a[124:127],v[124:127]
v_exp_f32 v103,v103
v_mfma_f32_16x16x32_bf16 v[160:163],a[192:195],v[88:91],v[160:163]
ds_read_b128 a[152:155],v12 offset:20480
v_cvt_pk_bf16_f32 v83,v102,v103
v_mfma_f32_16x16x32_bf16 v[160:163],a[196:199],v[92:95],v[160:163]
v_exp_f32 v104,v104
v_mfma_f32_16x16x32_bf16 v[164:167],a[200:203],v[88:91],v[164:167]
ds_read_b128 a[156:159],v13 offset:20480
v_mfma_f32_16x16x32_bf16 v[164:167],a[204:207],v[92:95],v[164:167]
v_exp_f32 v105,v105
v_mfma_f32_16x16x32_bf16 v[168:171],a[208:211],v[88:91],v[168:171]
ds_read_b128 a[160:163],v10 offset:24576
v_cvt_pk_bf16_f32 v84,v104,v105
v_mfma_f32_16x16x32_bf16 v[168:171],a[212:215],v[92:95],v[168:171]
v_exp_f32 v106,v106
v_mfma_f32_16x16x32_bf16 v[172:175],a[216:219],v[88:91],v[172:175]
ds_read_b128 a[164:167],v11 offset:24576
v_mfma_f32_16x16x32_bf16 v[172:175],a[220:223],v[92:95],v[172:175]
v_exp_f32 v107,v107
v_mfma_f32_16x16x32_bf16 v[176:179],a[224:227],v[88:91],v[176:179]
ds_read_b128 a[168:171],v12 offset:24576
v_cvt_pk_bf16_f32 v85,v106,v107
v_mfma_f32_16x16x32_bf16 v[176:179],a[228:231],v[92:95],v[176:179]
buffer_load_dwordx4 v8,s[12:15],s48 offen offset:2048 nt lds
v_exp_f32 v108,v108
v_mfma_f32_16x16x32_bf16 v[180:183],a[232:235],v[88:91],v[180:183]
ds_read_b128 a[172:175],v13 offset:24576
v_mfma_f32_16x16x32_bf16 v[180:183],a[236:239],v[92:95],v[180:183]
v_exp_f32 v109,v109
v_mfma_f32_16x16x32_bf16 v[184:187],a[240:243],v[88:91],v[184:187]
ds_read_b128 a[176:179],v10 offset:28672
v_cvt_pk_bf16_f32 v86,v108,v109
v_mfma_f32_16x16x32_bf16 v[184:187],a[244:247],v[92:95],v[184:187]
v_exp_f32 v110,v110
v_mfma_f32_16x16x32_bf16 v[188:191],a[248:251],v[88:91],v[188:191]
ds_read_b128 a[180:183],v11 offset:28672
v_mfma_f32_16x16x32_bf16 v[188:191],a[252:255],v[92:95],v[188:191]
v_exp_f32 v111,v111
v_mfma_f32_16x16x32_bf16 v[52:55],v[44:47],v[88:91],v[52:55]
ds_read_b128 a[184:187],v12 offset:28672
v_cvt_pk_bf16_f32 v87,v110,v111
v_mfma_f32_16x16x32_bf16 v[52:55],v[44:47],v[92:95],v[52:55]
ds_read_b128 a[188:191],v13 offset:28672
v_mfma_f32_16x16x32_bf16 v[192:195],a[192:195],v[80:83],v[192:195]
v_mfma_f32_16x16x32_bf16 v[192:195],a[196:199],v[84:87],v[192:195]
v_exp_f32 v112,v112
v_mfma_f32_16x16x32_bf16 v[196:199],a[200:203],v[80:83],v[196:199]
v_mfma_f32_16x16x32_bf16 v[196:199],a[204:207],v[84:87],v[196:199]
v_exp_f32 v113,v113
v_mfma_f32_16x16x32_bf16 v[200:203],a[208:211],v[80:83],v[200:203]
v_cvt_pk_bf16_f32 v88,v112,v113
v_mfma_f32_16x16x32_bf16 v[200:203],a[212:215],v[84:87],v[200:203]
v_exp_f32 v114,v114
v_mfma_f32_16x16x32_bf16 v[204:207],a[216:219],v[80:83],v[204:207]
buffer_load_dwordx4 v9,s[12:15],s48 offen offset:3072 nt lds
v_mfma_f32_16x16x32_bf16 v[204:207],a[220:223],v[84:87],v[204:207]
v_exp_f32 v115,v115
v_mfma_f32_16x16x32_bf16 v[208:211],a[224:227],v[80:83],v[208:211]
v_cvt_pk_bf16_f32 v89,v114,v115
v_mfma_f32_16x16x32_bf16 v[208:211],a[228:231],v[84:87],v[208:211]
v_exp_f32 v116,v116
v_mfma_f32_16x16x32_bf16 v[212:215],a[232:235],v[80:83],v[212:215]
v_mfma_f32_16x16x32_bf16 v[212:215],a[236:239],v[84:87],v[212:215]
v_exp_f32 v117,v117
v_mfma_f32_16x16x32_bf16 v[216:219],a[240:243],v[80:83],v[216:219]
buffer_load_dword v24,v41,s[92:95],s90 offen
v_cvt_pk_bf16_f32 v90,v116,v117
v_mfma_f32_16x16x32_bf16 v[216:219],a[244:247],v[84:87],v[216:219]
v_exp_f32 v118,v118
v_mfma_f32_16x16x32_bf16 v[220:223],a[248:251],v[80:83],v[220:223]
s_waitcnt lgkmcnt(0)
v_mfma_f32_16x16x32_bf16 v[220:223],a[252:255],v[84:87],v[220:223]
v_exp_f32 v119,v119
v_mfma_f32_16x16x32_bf16 v[56:59],v[44:47],v[80:83],v[56:59]
v_cvt_pk_bf16_f32 v91,v118,v119
v_mfma_f32_16x16x32_bf16 v[56:59],v[44:47],v[84:87],v[56:59]
v_exp_f32 v120,v120
v_mfma_f32_16x16x32_bf16 v[96:99],a[128:131],a[64:67],v[64:67]
v_mfma_f32_16x16x32_bf16 v[96:99],a[132:135],a[68:71],v[96:99]
v_exp_f32 v121,v121
v_mfma_f32_16x16x32_bf16 v[96:99],a[136:139],a[72:75],v[96:99]
s_mov_b32 s48,442368
s_add_u32 m0,s39,49152
v_cvt_pk_bf16_f32 v92,v120,v121
v_mfma_f32_16x16x32_bf16 v[96:99],a[140:143],a[76:79],v[96:99]
buffer_load_dwordx4 v4,s[8:11],s48 offen nt lds
v_exp_f32 v122,v122
v_mfma_f32_16x16x32_bf16 v[100:103],a[144:147],a[64:67],v[64:67]
v_mfma_f32_16x16x32_bf16 v[100:103],a[148:151],a[68:71],v[100:103]
v_exp_f32 v123,v123
v_mfma_f32_16x16x32_bf16 v[100:103],a[152:155],a[72:75],v[100:103]
v_cvt_pk_bf16_f32 v93,v122,v123
v_mfma_f32_16x16x32_bf16 v[100:103],a[156:159],a[76:79],v[100:103]
v_exp_f32 v124,v124
v_mfma_f32_16x16x32_bf16 v[104:107],a[160:163],a[64:67],v[64:67]
v_mfma_f32_16x16x32_bf16 v[104:107],a[164:167],a[68:71],v[104:107]
v_exp_f32 v125,v125
v_mfma_f32_16x16x32_bf16 v[104:107],a[168:171],a[72:75],v[104:107]
v_cvt_pk_bf16_f32 v94,v124,v125
v_mfma_f32_16x16x32_bf16 v[104:107],a[172:175],a[76:79],v[104:107]
v_exp_f32 v126,v126
v_mfma_f32_16x16x32_bf16 v[108:111],a[176:179],a[64:67],v[64:67]
v_mfma_f32_16x16x32_bf16 v[108:111],a[180:183],a[68:71],v[108:111]
v_exp_f32 v127,v127
v_mfma_f32_16x16x32_bf16 v[108:111],a[184:187],a[72:75],v[108:111]
v_cvt_pk_bf16_f32 v95,v126,v127
v_mfma_f32_16x16x32_bf16 v[108:111],a[188:191],a[76:79],v[108:111]
v_mfma_f32_16x16x32_bf16 v[224:227],a[192:195],v[88:91],v[224:227]
buffer_load_dwordx4 v5,s[8:11],s48 offen offset:1024 nt lds
v_mfma_f32_16x16x32_bf16 v[224:227],a[196:199],v[92:95],v[224:227]
v_exp_f32 v96,v96
v_mfma_f32_16x16x32_bf16 v[228:231],a[200:203],v[88:91],v[228:231]
ds_read_b64_tr_b16 a[192:193],v14 offset:16384
ds_read_b64_tr_b16 a[194:195],v14 offset:20480
v_mfma_f32_16x16x32_bf16 v[228:231],a[204:207],v[92:95],v[228:231]
v_exp_f32 v97,v97
v_mfma_f32_16x16x32_bf16 v[232:235],a[208:211],v[88:91],v[232:235]
ds_read_b64_tr_b16 a[196:197],v14 offset:24576
v_cvt_pk_bf16_f32 v80,v96,v97
v_mfma_f32_16x16x32_bf16 v[232:235],a[212:215],v[92:95],v[232:235]
v_exp_f32 v98,v98
v_mfma_f32_16x16x32_bf16 v[236:239],a[216:219],v[88:91],v[236:239]
ds_read_b64_tr_b16 a[198:199],v14 offset:28672
ds_read_b64_tr_b16 a[200:201],v15 offset:16384
v_mfma_f32_16x16x32_bf16 v[236:239],a[220:223],v[92:95],v[236:239]
v_exp_f32 v99,v99
v_mfma_f32_16x16x32_bf16 v[240:243],a[224:227],v[88:91],v[240:243]
ds_read_b64_tr_b16 a[202:203],v15 offset:20480
v_cvt_pk_bf16_f32 v81,v98,v99
v_mfma_f32_16x16x32_bf16 v[240:243],a[228:231],v[92:95],v[240:243]
v_exp_f32 v100,v100
v_mfma_f32_16x16x32_bf16 v[244:247],a[232:235],v[88:91],v[244:247]
ds_read_b64_tr_b16 a[204:205],v15 offset:24576
ds_read_b64_tr_b16 a[206:207],v15 offset:28672
v_mfma_f32_16x16x32_bf16 v[244:247],a[236:239],v[92:95],v[244:247]
v_exp_f32 v101,v101
v_mfma_f32_16x16x32_bf16 v[248:251],a[240:243],v[88:91],v[248:251]
ds_read_b64_tr_b16 a[208:209],v16 offset:16384
v_cvt_pk_bf16_f32 v82,v100,v101
v_mfma_f32_16x16x32_bf16 v[248:251],a[244:247],v[92:95],v[248:251]
v_exp_f32 v102,v102
v_mfma_f32_16x16x32_bf16 v[252:255],a[248:251],v[88:91],v[252:255]
ds_read_b64_tr_b16 a[210:211],v16 offset:20480
ds_read_b64_tr_b16 a[212:213],v16 offset:24576
v_mfma_f32_16x16x32_bf16 v[252:255],a[252:255],v[92:95],v[252:255]
buffer_load_dwordx4 v6,s[8:11],s48 offen offset:2048 nt lds
v_exp_f32 v103,v103
v_mfma_f32_16x16x32_bf16 v[60:63],v[44:47],v[88:91],v[60:63]
ds_read_b64_tr_b16 a[214:215],v16 offset:28672
v_cvt_pk_bf16_f32 v83,v102,v103
v_mfma_f32_16x16x32_bf16 v[60:63],v[44:47],v[92:95],v[60:63]
v_exp_f32 v104,v104
v_mfma_f32_16x16x32_bf16 v[112:115],a[128:131],a[80:83],v[68:71]
ds_read_b64_tr_b16 a[216:217],v17 offset:16384
ds_read_b64_tr_b16 a[218:219],v17 offset:20480
v_mfma_f32_16x16x32_bf16 v[112:115],a[132:135],a[84:87],v[112:115]
v_exp_f32 v105,v105
v_mfma_f32_16x16x32_bf16 v[112:115],a[136:139],a[88:91],v[112:115]
ds_read_b64_tr_b16 a[220:221],v17 offset:24576
v_cvt_pk_bf16_f32 v84,v104,v105
v_mfma_f32_16x16x32_bf16 v[112:115],a[140:143],a[92:95],v[112:115]
v_exp_f32 v106,v106
v_mfma_f32_16x16x32_bf16 v[116:119],a[144:147],a[80:83],v[68:71]
ds_read_b64_tr_b16 a[222:223],v17 offset:28672
ds_read_b64_tr_b16 a[224:225],v18 offset:16384
v_mfma_f32_16x16x32_bf16 v[116:119],a[148:151],a[84:87],v[116:119]
v_exp_f32 v107,v107
v_mfma_f32_16x16x32_bf16 v[116:119],a[152:155],a[88:91],v[116:119]
ds_read_b64_tr_b16 a[226:227],v18 offset:20480
v_cvt_pk_bf16_f32 v85,v106,v107
v_mfma_f32_16x16x32_bf16 v[116:119],a[156:159],a[92:95],v[116:119]
v_exp_f32 v108,v108
v_mfma_f32_16x16x32_bf16 v[120:123],a[160:163],a[80:83],v[68:71]
ds_read_b64_tr_b16 a[228:229],v18 offset:24576
ds_read_b64_tr_b16 a[230:231],v18 offset:28672
v_mfma_f32_16x16x32_bf16 v[120:123],a[164:167],a[84:87],v[120:123]
v_exp_f32 v109,v109
v_mfma_f32_16x16x32_bf16 v[120:123],a[168:171],a[88:91],v[120:123]
ds_read_b64_tr_b16 a[232:233],v19 offset:16384
v_cvt_pk_bf16_f32 v86,v108,v109
v_mfma_f32_16x16x32_bf16 v[120:123],a[172:175],a[92:95],v[120:123]
buffer_load_dwordx4 v7,s[8:11],s48 offen offset:3072 nt lds
v_exp_f32 v110,v110
v_mfma_f32_16x16x32_bf16 v[124:127],a[176:179],a[80:83],v[68:71]
ds_read_b64_tr_b16 a[234:235],v19 offset:20480
ds_read_b64_tr_b16 a[236:237],v19 offset:24576
v_mfma_f32_16x16x32_bf16 v[124:127],a[180:183],a[84:87],v[124:127]
v_exp_f32 v111,v111
v_mfma_f32_16x16x32_bf16 v[124:127],a[184:187],a[88:91],v[124:127]
ds_read_b64_tr_b16 a[238:239],v19 offset:28672
v_cvt_pk_bf16_f32 v87,v110,v111
v_mfma_f32_16x16x32_bf16 v[124:127],a[188:191],a[92:95],v[124:127]
ds_read_b64_tr_b16 a[240:241],v20 offset:16384
ds_read_b64_tr_b16 a[242:243],v20 offset:20480
v_mfma_f32_16x16x32_bf16 v[96:99],a[128:131],a[96:99],v[72:75]
ds_read_b64_tr_b16 a[244:245],v20 offset:24576
ds_read_b64_tr_b16 a[246:247],v20 offset:28672
v_mfma_f32_16x16x32_bf16 v[96:99],a[132:135],a[100:103],v[96:99]
v_exp_f32 v112,v112
v_mfma_f32_16x16x32_bf16 v[96:99],a[136:139],a[104:107],v[96:99]
ds_read_b64_tr_b16 a[248:249],v21 offset:16384
ds_read_b64_tr_b16 a[250:251],v21 offset:20480
v_mfma_f32_16x16x32_bf16 v[96:99],a[140:143],a[108:111],v[96:99]
v_exp_f32 v113,v113
v_mfma_f32_16x16x32_bf16 v[100:103],a[144:147],a[96:99],v[72:75]
ds_read_b64_tr_b16 a[252:253],v21 offset:24576
v_cvt_pk_bf16_f32 v88,v112,v113
v_mfma_f32_16x16x32_bf16 v[100:103],a[148:151],a[100:103],v[100:103]
v_exp_f32 v114,v114
v_mfma_f32_16x16x32_bf16 v[100:103],a[152:155],a[104:107],v[100:103]
ds_read_b64_tr_b16 a[254:255],v21 offset:28672
v_mfma_f32_16x16x32_bf16 v[100:103],a[156:159],a[108:111],v[100:103]
v_exp_f32 v115,v115
v_mfma_f32_16x16x32_bf16 v[104:107],a[160:163],a[96:99],v[72:75]
v_cvt_pk_bf16_f32 v89,v114,v115
v_mfma_f32_16x16x32_bf16 v[104:107],a[164:167],a[100:103],v[104:107]
s_add_u32 m0,s39,114688
v_exp_f32 v116,v116
v_mfma_f32_16x16x32_bf16 v[104:107],a[168:171],a[104:107],v[104:107]
buffer_load_dwordx4 v8,s[12:15],s48 offen nt lds
v_mfma_f32_16x16x32_bf16 v[104:107],a[172:175],a[108:111],v[104:107]
v_exp_f32 v117,v117
v_mfma_f32_16x16x32_bf16 v[108:111],a[176:179],a[96:99],v[72:75]
v_cvt_pk_bf16_f32 v90,v116,v117
v_mfma_f32_16x16x32_bf16 v[108:111],a[180:183],a[100:103],v[108:111]
v_exp_f32 v118,v118
v_mfma_f32_16x16x32_bf16 v[108:111],a[184:187],a[104:107],v[108:111]
s_waitcnt lgkmcnt(0)
v_mfma_f32_16x16x32_bf16 v[108:111],a[188:191],a[108:111],v[108:111]
v_exp_f32 v119,v119
v_mfma_f32_16x16x32_bf16 v[128:131],a[192:195],v[80:83],v[128:131]
v_cvt_pk_bf16_f32 v91,v118,v119
v_mfma_f32_16x16x32_bf16 v[128:131],a[196:199],v[84:87],v[128:131]
v_exp_f32 v120,v120
v_mfma_f32_16x16x32_bf16 v[132:135],a[200:203],v[80:83],v[132:135]
v_mfma_f32_16x16x32_bf16 v[132:135],a[204:207],v[84:87],v[132:135]
v_exp_f32 v121,v121
v_mfma_f32_16x16x32_bf16 v[136:139],a[208:211],v[80:83],v[136:139]
v_cvt_pk_bf16_f32 v92,v120,v121
v_mfma_f32_16x16x32_bf16 v[136:139],a[212:215],v[84:87],v[136:139]
v_exp_f32 v122,v122
v_mfma_f32_16x16x32_bf16 v[140:143],a[216:219],v[80:83],v[140:143]
v_mfma_f32_16x16x32_bf16 v[140:143],a[220:223],v[84:87],v[140:143]
buffer_load_dwordx4 v9,s[12:15],s48 offen offset:1024 nt lds
v_exp_f32 v123,v123
v_mfma_f32_16x16x32_bf16 v[144:147],a[224:227],v[80:83],v[144:147]
v_cvt_pk_bf16_f32 v93,v122,v123
v_mfma_f32_16x16x32_bf16 v[144:147],a[228:231],v[84:87],v[144:147]
v_exp_f32 v124,v124
v_mfma_f32_16x16x32_bf16 v[148:151],a[232:235],v[80:83],v[148:151]
v_mfma_f32_16x16x32_bf16 v[148:151],a[236:239],v[84:87],v[148:151]
v_exp_f32 v125,v125
v_mfma_f32_16x16x32_bf16 v[152:155],a[240:243],v[80:83],v[152:155]
v_cvt_pk_bf16_f32 v94,v124,v125
v_mfma_f32_16x16x32_bf16 v[152:155],a[244:247],v[84:87],v[152:155]
v_exp_f32 v126,v126
v_mfma_f32_16x16x32_bf16 v[156:159],a[248:251],v[80:83],v[156:159]
v_mfma_f32_16x16x32_bf16 v[156:159],a[252:255],v[84:87],v[156:159]
v_exp_f32 v127,v127
v_mfma_f32_16x16x32_bf16 v[48:51],v[44:47],v[80:83],v[48:51]
v_cvt_pk_bf16_f32 v95,v126,v127
v_mfma_f32_16x16x32_bf16 v[48:51],v[44:47],v[84:87],v[48:51]
s_waitcnt vmcnt(7)
s_barrier
v_mfma_f32_16x16x32_bf16 v[112:115],a[128:131],a[112:115],v[76:79]
v_mfma_f32_16x16x32_bf16 v[112:115],a[132:135],a[116:119],v[112:115]
v_exp_f32 v96,v96
v_mfma_f32_16x16x32_bf16 v[112:115],a[136:139],a[120:123],v[112:115]
v_mfma_f32_16x16x32_bf16 v[112:115],a[140:143],a[124:127],v[112:115]
v_exp_f32 v97,v97
v_mfma_f32_16x16x32_bf16 v[116:119],a[144:147],a[112:115],v[76:79]
ds_read_b128 a[128:131],v10 offset:32768
v_cvt_pk_bf16_f32 v80,v96,v97
v_mfma_f32_16x16x32_bf16 v[116:119],a[148:151],a[116:119],v[116:119]
buffer_load_dwordx4 v8,s[12:15],s48 offen offset:2048 nt lds
v_exp_f32 v98,v98
v_mfma_f32_16x16x32_bf16 v[116:119],a[152:155],a[120:123],v[116:119]
ds_read_b128 a[132:135],v11 offset:32768
v_mfma_f32_16x16x32_bf16 v[116:119],a[156:159],a[124:127],v[116:119]
v_exp_f32 v99,v99
v_mfma_f32_16x16x32_bf16 v[120:123],a[160:163],a[112:115],v[76:79]
ds_read_b128 a[136:139],v12 offset:32768
v_cvt_pk_bf16_f32 v81,v98,v99
v_mfma_f32_16x16x32_bf16 v[120:123],a[164:167],a[116:119],v[120:123]
v_exp_f32 v100,v100
v_mfma_f32_16x16x32_bf16 v[120:123],a[168:171],a[120:123],v[120:123]
ds_read_b128 a[140:143],v13 offset:32768
v_mfma_f32_16x16x32_bf16 v[120:123],a[172:175],a[124:127],v[120:123]
v_exp_f32 v101,v101
v_mfma_f32_16x16x32_bf16 v[124:127],a[176:179],a[112:115],v[76:79]
ds_read_b128 a[144:147],v10 offset:36864
v_cvt_pk_bf16_f32 v82,v100,v101
v_mfma_f32_16x16x32_bf16 v[124:127],a[180:183],a[116:119],v[124:127]
v_exp_f32 v102,v102
v_mfma_f32_16x16x32_bf16 v[124:127],a[184:187],a[120:123],v[124:127]
ds_read_b128 a[148:151],v11 offset:36864
v_mfma_f32_16x16x32_bf16 v[124:127],a[188:191],a[124:127],v[124:127]
v_exp_f32 v103,v103
v_mfma_f32_16x16x32_bf16 v[160:163],a[192:195],v[88:91],v[160:163]
ds_read_b128 a[152:155],v12 offset:36864
v_cvt_pk_bf16_f32 v83,v102,v103
v_mfma_f32_16x16x32_bf16 v[160:163],a[196:199],v[92:95],v[160:163]
v_exp_f32 v104,v104
v_mfma_f32_16x16x32_bf16 v[164:167],a[200:203],v[88:91],v[164:167]
ds_read_b128 a[156:159],v13 offset:36864
v_mfma_f32_16x16x32_bf16 v[164:167],a[204:207],v[92:95],v[164:167]
buffer_load_dwordx4 v9,s[12:15],s48 offen offset:3072 nt lds
v_exp_f32 v105,v105
v_mfma_f32_16x16x32_bf16 v[168:171],a[208:211],v[88:91],v[168:171]
ds_read_b128 a[160:163],v10 offset:40960
v_cvt_pk_bf16_f32 v84,v104,v105
v_mfma_f32_16x16x32_bf16 v[168:171],a[212:215],v[92:95],v[168:171]
v_exp_f32 v106,v106
v_mfma_f32_16x16x32_bf16 v[172:175],a[216:219],v[88:91],v[172:175]
ds_read_b128 a[164:167],v11 offset:40960
v_mfma_f32_16x16x32_bf16 v[172:175],a[220:223],v[92:95],v[172:175]
v_exp_f32 v107,v107
v_mfma_f32_16x16x32_bf16 v[176:179],a[224:227],v[88:91],v[176:179]
ds_read_b128 a[168:171],v12 offset:40960
v_cvt_pk_bf16_f32 v85,v106,v107
v_mfma_f32_16x16x32_bf16 v[176:179],a[228:231],v[92:95],v[176:179]
v_exp_f32 v108,v108
v_mfma_f32_16x16x32_bf16 v[180:183],a[232:235],v[88:91],v[180:183]
ds_read_b128 a[172:175],v13 offset:40960
v_mfma_f32_16x16x32_bf16 v[180:183],a[236:239],v[92:95],v[180:183]
v_exp_f32 v109,v109
v_mfma_f32_16x16x32_bf16 v[184:187],a[240:243],v[88:91],v[184:187]
ds_read_b128 a[176:179],v10 offset:45056
v_cvt_pk_bf16_f32 v86,v108,v109
v_mfma_f32_16x16x32_bf16 v[184:187],a[244:247],v[92:95],v[184:187]
v_exp_f32 v110,v110
v_mfma_f32_16x16x32_bf16 v[188:191],a[248:251],v[88:91],v[188:191]
ds_read_b128 a[180:183],v11 offset:45056
v_mfma_f32_16x16x32_bf16 v[188:191],a[252:255],v[92:95],v[188:191]
v_exp_f32 v111,v111
v_mfma_f32_16x16x32_bf16 v[52:55],v[44:47],v[88:91],v[52:55]
ds_read_b128 a[184:187],v12 offset:45056
s_mov_b32 s48,458752
v_cvt_pk_bf16_f32 v87,v110,v111
v_mfma_f32_16x16x32_bf16 v[52:55],v[44:47],v[92:95],v[52:55]
ds_read_b128 a[188:191],v13 offset:45056
s_add_u32 m0,s39,0
v_mfma_f32_16x16x32_bf16 v[192:195],a[192:195],v[80:83],v[192:195]
buffer_load_dwordx4 v4,s[8:11],s48 offen nt lds
v_mfma_f32_16x16x32_bf16 v[192:195],a[196:199],v[84:87],v[192:195]
v_exp_f32 v112,v112
v_mfma_f32_16x16x32_bf16 v[196:199],a[200:203],v[80:83],v[196:199]
v_mfma_f32_16x16x32_bf16 v[196:199],a[204:207],v[84:87],v[196:199]
v_exp_f32 v113,v113
v_mfma_f32_16x16x32_bf16 v[200:203],a[208:211],v[80:83],v[200:203]
v_cvt_pk_bf16_f32 v88,v112,v113
v_mfma_f32_16x16x32_bf16 v[200:203],a[212:215],v[84:87],v[200:203]
v_exp_f32 v114,v114
v_mfma_f32_16x16x32_bf16 v[204:207],a[216:219],v[80:83],v[204:207]
v_mfma_f32_16x16x32_bf16 v[204:207],a[220:223],v[84:87],v[204:207]
v_exp_f32 v115,v115
v_mfma_f32_16x16x32_bf16 v[208:211],a[224:227],v[80:83],v[208:211]
v_cvt_pk_bf16_f32 v89,v114,v115
v_mfma_f32_16x16x32_bf16 v[208:211],a[228:231],v[84:87],v[208:211]
v_exp_f32 v116,v116
v_mfma_f32_16x16x32_bf16 v[212:215],a[232:235],v[80:83],v[212:215]
v_mfma_f32_16x16x32_bf16 v[212:215],a[236:239],v[84:87],v[212:215]
v_exp_f32 v117,v117
v_mfma_f32_16x16x32_bf16 v[216:219],a[240:243],v[80:83],v[216:219]
buffer_load_dwordx4 v5,s[8:11],s48 offen offset:1024 nt lds
v_cvt_pk_bf16_f32 v90,v116,v117
v_mfma_f32_16x16x32_bf16 v[216:219],a[244:247],v[84:87],v[216:219]
v_exp_f32 v118,v118
v_mfma_f32_16x16x32_bf16 v[220:223],a[248:251],v[80:83],v[220:223]
s_waitcnt lgkmcnt(0)
v_mfma_f32_16x16x32_bf16 v[220:223],a[252:255],v[84:87],v[220:223]
v_exp_f32 v119,v119
v_mfma_f32_16x16x32_bf16 v[56:59],v[44:47],v[80:83],v[56:59]
v_cvt_pk_bf16_f32 v91,v118,v119
v_mfma_f32_16x16x32_bf16 v[56:59],v[44:47],v[84:87],v[56:59]
v_exp_f32 v120,v120
v_mfma_f32_16x16x32_bf16 v[96:99],a[128:131],a[64:67],v[64:67]
v_mfma_f32_16x16x32_bf16 v[96:99],a[132:135],a[68:71],v[96:99]
v_exp_f32 v121,v121
v_mfma_f32_16x16x32_bf16 v[96:99],a[136:139],a[72:75],v[96:99]
v_cvt_pk_bf16_f32 v92,v120,v121
v_mfma_f32_16x16x32_bf16 v[96:99],a[140:143],a[76:79],v[96:99]
v_exp_f32 v122,v122
v_mfma_f32_16x16x32_bf16 v[100:103],a[144:147],a[64:67],v[64:67]
v_mfma_f32_16x16x32_bf16 v[100:103],a[148:151],a[68:71],v[100:103]
v_exp_f32 v123,v123
v_mfma_f32_16x16x32_bf16 v[100:103],a[152:155],a[72:75],v[100:103]
v_cvt_pk_bf16_f32 v93,v122,v123
v_mfma_f32_16x16x32_bf16 v[100:103],a[156:159],a[76:79],v[100:103]
v_exp_f32 v124,v124
v_mfma_f32_16x16x32_bf16 v[104:107],a[160:163],a[64:67],v[64:67]
v_mfma_f32_16x16x32_bf16 v[104:107],a[164:167],a[68:71],v[104:107]
buffer_load_dwordx4 v6,s[8:11],s48 offen offset:2048 nt lds
v_exp_f32 v125,v125
v_mfma_f32_16x16x32_bf16 v[104:107],a[168:171],a[72:75],v[104:107]
v_cvt_pk_bf16_f32 v94,v124,v125
v_mfma_f32_16x16x32_bf16 v[104:107],a[172:175],a[76:79],v[104:107]
v_exp_f32 v126,v126
v_mfma_f32_16x16x32_bf16 v[108:111],a[176:179],a[64:67],v[64:67]
v_mfma_f32_16x16x32_bf16 v[108:111],a[180:183],a[68:71],v[108:111]
v_exp_f32 v127,v127
v_mfma_f32_16x16x32_bf16 v[108:111],a[184:187],a[72:75],v[108:111]
v_cvt_pk_bf16_f32 v95,v126,v127
v_mfma_f32_16x16x32_bf16 v[108:111],a[188:191],a[76:79],v[108:111]
v_mfma_f32_16x16x32_bf16 v[224:227],a[192:195],v[88:91],v[224:227]
v_mfma_f32_16x16x32_bf16 v[224:227],a[196:199],v[92:95],v[224:227]
v_exp_f32 v96,v96
v_mfma_f32_16x16x32_bf16 v[228:231],a[200:203],v[88:91],v[228:231]
ds_read_b64_tr_b16 a[192:193],v14 offset:32768
ds_read_b64_tr_b16 a[194:195],v14 offset:36864
v_mfma_f32_16x16x32_bf16 v[228:231],a[204:207],v[92:95],v[228:231]
v_exp_f32 v97,v97
v_mfma_f32_16x16x32_bf16 v[232:235],a[208:211],v[88:91],v[232:235]
ds_read_b64_tr_b16 a[196:197],v14 offset:40960
v_cvt_pk_bf16_f32 v80,v96,v97
v_mfma_f32_16x16x32_bf16 v[232:235],a[212:215],v[92:95],v[232:235]
v_exp_f32 v98,v98
v_mfma_f32_16x16x32_bf16 v[236:239],a[216:219],v[88:91],v[236:239]
ds_read_b64_tr_b16 a[198:199],v14 offset:45056
ds_read_b64_tr_b16 a[200:201],v15 offset:32768
v_mfma_f32_16x16x32_bf16 v[236:239],a[220:223],v[92:95],v[236:239]
buffer_load_dwordx4 v7,s[8:11],s48 offen offset:3072 nt lds
v_exp_f32 v99,v99
v_mfma_f32_16x16x32_bf16 v[240:243],a[224:227],v[88:91],v[240:243]
ds_read_b64_tr_b16 a[202:203],v15 offset:36864
v_cvt_pk_bf16_f32 v81,v98,v99
v_mfma_f32_16x16x32_bf16 v[240:243],a[228:231],v[92:95],v[240:243]
v_exp_f32 v100,v100
v_mfma_f32_16x16x32_bf16 v[244:247],a[232:235],v[88:91],v[244:247]
ds_read_b64_tr_b16 a[204:205],v15 offset:40960
ds_read_b64_tr_b16 a[206:207],v15 offset:45056
v_mfma_f32_16x16x32_bf16 v[244:247],a[236:239],v[92:95],v[244:247]
v_exp_f32 v101,v101
v_mfma_f32_16x16x32_bf16 v[248:251],a[240:243],v[88:91],v[248:251]
ds_read_b64_tr_b16 a[208:209],v16 offset:32768
v_cvt_pk_bf16_f32 v82,v100,v101
v_mfma_f32_16x16x32_bf16 v[248:251],a[244:247],v[92:95],v[248:251]
v_exp_f32 v102,v102
v_mfma_f32_16x16x32_bf16 v[252:255],a[248:251],v[88:91],v[252:255]
ds_read_b64_tr_b16 a[210:211],v16 offset:36864
ds_read_b64_tr_b16 a[212:213],v16 offset:40960
v_mfma_f32_16x16x32_bf16 v[252:255],a[252:255],v[92:95],v[252:255]
v_exp_f32 v103,v103
v_mfma_f32_16x16x32_bf16 v[60:63],v[44:47],v[88:91],v[60:63]
ds_read_b64_tr_b16 a[214:215],v16 offset:45056
v_cvt_pk_bf16_f32 v83,v102,v103
v_mfma_f32_16x16x32_bf16 v[60:63],v[44:47],v[92:95],v[60:63]
v_exp_f32 v104,v104
v_mfma_f32_16x16x32_bf16 v[112:115],a[128:131],a[80:83],v[68:71]
ds_read_b64_tr_b16 a[216:217],v17 offset:32768
ds_read_b64_tr_b16 a[218:219],v17 offset:36864
v_mfma_f32_16x16x32_bf16 v[112:115],a[132:135],a[84:87],v[112:115]
v_exp_f32 v105,v105
v_mfma_f32_16x16x32_bf16 v[112:115],a[136:139],a[88:91],v[112:115]
ds_read_b64_tr_b16 a[220:221],v17 offset:40960
v_cvt_pk_bf16_f32 v84,v104,v105
v_mfma_f32_16x16x32_bf16 v[112:115],a[140:143],a[92:95],v[112:115]
s_add_u32 m0,s39,65536
v_exp_f32 v106,v106
v_mfma_f32_16x16x32_bf16 v[116:119],a[144:147],a[80:83],v[68:71]
ds_read_b64_tr_b16 a[222:223],v17 offset:45056
ds_read_b64_tr_b16 a[224:225],v18 offset:32768
v_mfma_f32_16x16x32_bf16 v[116:119],a[148:151],a[84:87],v[116:119]
buffer_load_dwordx4 v8,s[12:15],s48 offen nt lds
v_exp_f32 v107,v107
v_mfma_f32_16x16x32_bf16 v[116:119],a[152:155],a[88:91],v[116:119]
ds_read_b64_tr_b16 a[226:227],v18 offset:36864
v_cvt_pk_bf16_f32 v85,v106,v107
v_mfma_f32_16x16x32_bf16 v[116:119],a[156:159],a[92:95],v[116:119]
v_exp_f32 v108,v108
v_mfma_f32_16x16x32_bf16 v[120:123],a[160:163],a[80:83],v[68:71]
ds_read_b64_tr_b16 a[228:229],v18 offset:40960
ds_read_b64_tr_b16 a[230:231],v18 offset:45056
v_mfma_f32_16x16x32_bf16 v[120:123],a[164:167],a[84:87],v[120:123]
v_exp_f32 v109,v109
v_mfma_f32_16x16x32_bf16 v[120:123],a[168:171],a[88:91],v[120:123]
ds_read_b64_tr_b16 a[232:233],v19 offset:32768
v_cvt_pk_bf16_f32 v86,v108,v109
v_mfma_f32_16x16x32_bf16 v[120:123],a[172:175],a[92:95],v[120:123]
v_exp_f32 v110,v110
v_mfma_f32_16x16x32_bf16 v[124:127],a[176:179],a[80:83],v[68:71]
ds_read_b64_tr_b16 a[234:235],v19 offset:36864
ds_read_b64_tr_b16 a[236:237],v19 offset:40960
v_mfma_f32_16x16x32_bf16 v[124:127],a[180:183],a[84:87],v[124:127]
v_exp_f32 v111,v111
v_mfma_f32_16x16x32_bf16 v[124:127],a[184:187],a[88:91],v[124:127]
ds_read_b64_tr_b16 a[238:239],v19 offset:45056
v_cvt_pk_bf16_f32 v87,v110,v111
v_mfma_f32_16x16x32_bf16 v[124:127],a[188:191],a[92:95],v[124:127]
ds_read_b64_tr_b16 a[240:241],v20 offset:32768
ds_read_b64_tr_b16 a[242:243],v20 offset:36864
v_mfma_f32_16x16x32_bf16 v[96:99],a[128:131],a[96:99],v[72:75]
ds_read_b64_tr_b16 a[244:245],v20 offset:40960
ds_read_b64_tr_b16 a[246:247],v20 offset:45056
v_mfma_f32_16x16x32_bf16 v[96:99],a[132:135],a[100:103],v[96:99]
v_exp_f32 v112,v112
v_mfma_f32_16x16x32_bf16 v[96:99],a[136:139],a[104:107],v[96:99]
ds_read_b64_tr_b16 a[248:249],v21 offset:32768
ds_read_b64_tr_b16 a[250:251],v21 offset:36864
v_mfma_f32_16x16x32_bf16 v[96:99],a[140:143],a[108:111],v[96:99]
buffer_load_dwordx4 v9,s[12:15],s48 offen offset:1024 nt lds
v_exp_f32 v113,v113
v_mfma_f32_16x16x32_bf16 v[100:103],a[144:147],a[96:99],v[72:75]
ds_read_b64_tr_b16 a[252:253],v21 offset:40960
v_cvt_pk_bf16_f32 v88,v112,v113
v_mfma_f32_16x16x32_bf16 v[100:103],a[148:151],a[100:103],v[100:103]
v_exp_f32 v114,v114
v_mfma_f32_16x16x32_bf16 v[100:103],a[152:155],a[104:107],v[100:103]
ds_read_b64_tr_b16 a[254:255],v21 offset:45056
v_mfma_f32_16x16x32_bf16 v[100:103],a[156:159],a[108:111],v[100:103]
v_exp_f32 v115,v115
v_mfma_f32_16x16x32_bf16 v[104:107],a[160:163],a[96:99],v[72:75]
v_cvt_pk_bf16_f32 v89,v114,v115
v_mfma_f32_16x16x32_bf16 v[104:107],a[164:167],a[100:103],v[104:107]
v_exp_f32 v116,v116
v_mfma_f32_16x16x32_bf16 v[104:107],a[168:171],a[104:107],v[104:107]
v_mfma_f32_16x16x32_bf16 v[104:107],a[172:175],a[108:111],v[104:107]
v_exp_f32 v117,v117
v_mfma_f32_16x16x32_bf16 v[108:111],a[176:179],a[96:99],v[72:75]
v_cvt_pk_bf16_f32 v90,v116,v117
v_mfma_f32_16x16x32_bf16 v[108:111],a[180:183],a[100:103],v[108:111]
v_exp_f32 v118,v118
v_mfma_f32_16x16x32_bf16 v[108:111],a[184:187],a[104:107],v[108:111]
s_waitcnt lgkmcnt(0)
v_mfma_f32_16x16x32_bf16 v[108:111],a[188:191],a[108:111],v[108:111]
v_exp_f32 v119,v119
v_mfma_f32_16x16x32_bf16 v[128:131],a[192:195],v[80:83],v[128:131]
buffer_load_dwordx4 v8,s[12:15],s48 offen offset:2048 nt lds
v_cvt_pk_bf16_f32 v91,v118,v119
v_mfma_f32_16x16x32_bf16 v[128:131],a[196:199],v[84:87],v[128:131]
v_exp_f32 v120,v120
v_mfma_f32_16x16x32_bf16 v[132:135],a[200:203],v[80:83],v[132:135]
v_mfma_f32_16x16x32_bf16 v[132:135],a[204:207],v[84:87],v[132:135]
v_exp_f32 v121,v121
v_mfma_f32_16x16x32_bf16 v[136:139],a[208:211],v[80:83],v[136:139]
v_cvt_pk_bf16_f32 v92,v120,v121
v_mfma_f32_16x16x32_bf16 v[136:139],a[212:215],v[84:87],v[136:139]
v_exp_f32 v122,v122
v_mfma_f32_16x16x32_bf16 v[140:143],a[216:219],v[80:83],v[140:143]
v_mfma_f32_16x16x32_bf16 v[140:143],a[220:223],v[84:87],v[140:143]
v_exp_f32 v123,v123
v_mfma_f32_16x16x32_bf16 v[144:147],a[224:227],v[80:83],v[144:147]
v_cvt_pk_bf16_f32 v93,v122,v123
v_mfma_f32_16x16x32_bf16 v[144:147],a[228:231],v[84:87],v[144:147]
v_exp_f32 v124,v124
v_mfma_f32_16x16x32_bf16 v[148:151],a[232:235],v[80:83],v[148:151]
v_mfma_f32_16x16x32_bf16 v[148:151],a[236:239],v[84:87],v[148:151]
v_exp_f32 v125,v125
v_mfma_f32_16x16x32_bf16 v[152:155],a[240:243],v[80:83],v[152:155]
v_cvt_pk_bf16_f32 v94,v124,v125
v_mfma_f32_16x16x32_bf16 v[152:155],a[244:247],v[84:87],v[152:155]
v_exp_f32 v126,v126
v_mfma_f32_16x16x32_bf16 v[156:159],a[248:251],v[80:83],v[156:159]
buffer_load_dwordx4 v9,s[12:15],s48 offen offset:3072 nt lds
v_mfma_f32_16x16x32_bf16 v[156:159],a[252:255],v[84:87],v[156:159]
v_exp_f32 v127,v127
v_mfma_f32_16x16x32_bf16 v[48:51],v[44:47],v[80:83],v[48:51]
v_cvt_pk_bf16_f32 v95,v126,v127
v_mfma_f32_16x16x32_bf16 v[48:51],v[44:47],v[84:87],v[48:51]
s_waitcnt vmcnt(8)
s_barrier
v_mfma_f32_16x16x32_bf16 v[112:115],a[128:131],a[112:115],v[76:79]
v_mfma_f32_16x16x32_bf16 v[112:115],a[132:135],a[116:119],v[112:115]
v_exp_f32 v96,v96
v_mfma_f32_16x16x32_bf16 v[112:115],a[136:139],a[120:123],v[112:115]
v_mfma_f32_16x16x32_bf16 v[112:115],a[140:143],a[124:127],v[112:115]
v_exp_f32 v97,v97
v_mfma_f32_16x16x32_bf16 v[116:119],a[144:147],a[112:115],v[76:79]
ds_read_b128 a[128:131],v10 offset:49152
v_cvt_pk_bf16_f32 v80,v96,v97
v_mfma_f32_16x16x32_bf16 v[116:119],a[148:151],a[116:119],v[116:119]
v_exp_f32 v98,v98
v_mfma_f32_16x16x32_bf16 v[116:119],a[152:155],a[120:123],v[116:119]
ds_read_b128 a[132:135],v11 offset:49152
v_mfma_f32_16x16x32_bf16 v[116:119],a[156:159],a[124:127],v[116:119]
v_exp_f32 v99,v99
v_mfma_f32_16x16x32_bf16 v[120:123],a[160:163],a[112:115],v[76:79]
ds_read_b128 a[136:139],v12 offset:49152
v_cvt_pk_bf16_f32 v81,v98,v99
v_mfma_f32_16x16x32_bf16 v[120:123],a[164:167],a[116:119],v[120:123]
v_exp_f32 v100,v100
v_mfma_f32_16x16x32_bf16 v[120:123],a[168:171],a[120:123],v[120:123]
ds_read_b128 a[140:143],v13 offset:49152
s_mov_b32 s48,475136
s_add_u32 m0,s39,16384
v_mfma_f32_16x16x32_bf16 v[120:123],a[172:175],a[124:127],v[120:123]
buffer_load_dwordx4 v4,s[8:11],s48 offen nt lds
v_exp_f32 v101,v101
v_mfma_f32_16x16x32_bf16 v[124:127],a[176:179],a[112:115],v[76:79]
ds_read_b128 a[144:147],v10 offset:53248
v_cvt_pk_bf16_f32 v82,v100,v101
v_mfma_f32_16x16x32_bf16 v[124:127],a[180:183],a[116:119],v[124:127]
v_exp_f32 v102,v102
v_mfma_f32_16x16x32_bf16 v[124:127],a[184:187],a[120:123],v[124:127]
ds_read_b128 a[148:151],v11 offset:53248
v_mfma_f32_16x16x32_bf16 v[124:127],a[188:191],a[124:127],v[124:127]
v_exp_f32 v103,v103
v_mfma_f32_16x16x32_bf16 v[160:163],a[192:195],v[88:91],v[160:163]
ds_read_b128 a[152:155],v12 offset:53248
v_cvt_pk_bf16_f32 v83,v102,v103
v_mfma_f32_16x16x32_bf16 v[160:163],a[196:199],v[92:95],v[160:163]
v_exp_f32 v104,v104
v_mfma_f32_16x16x32_bf16 v[164:167],a[200:203],v[88:91],v[164:167]
ds_read_b128 a[156:159],v13 offset:53248
v_mfma_f32_16x16x32_bf16 v[164:167],a[204:207],v[92:95],v[164:167]
v_exp_f32 v105,v105
v_mfma_f32_16x16x32_bf16 v[168:171],a[208:211],v[88:91],v[168:171]
ds_read_b128 a[160:163],v10 offset:57344
v_cvt_pk_bf16_f32 v84,v104,v105
v_mfma_f32_16x16x32_bf16 v[168:171],a[212:215],v[92:95],v[168:171]
v_exp_f32 v106,v106
v_mfma_f32_16x16x32_bf16 v[172:175],a[216:219],v[88:91],v[172:175]
ds_read_b128 a[164:167],v11 offset:57344
v_mfma_f32_16x16x32_bf16 v[172:175],a[220:223],v[92:95],v[172:175]
v_exp_f32 v107,v107
v_mfma_f32_16x16x32_bf16 v[176:179],a[224:227],v[88:91],v[176:179]
ds_read_b128 a[168:171],v12 offset:57344
v_cvt_pk_bf16_f32 v85,v106,v107
v_mfma_f32_16x16x32_bf16 v[176:179],a[228:231],v[92:95],v[176:179]
s_add_u32 m0,s39,16384
v_exp_f32 v108,v108
v_mfma_f32_16x16x32_bf16 v[180:183],a[232:235],v[88:91],v[180:183]
ds_read_b128 a[172:175],v13 offset:57344
v_mfma_f32_16x16x32_bf16 v[180:183],a[236:239],v[92:95],v[180:183]
buffer_load_dwordx4 v5,s[8:11],s48 offen offset:1024 nt lds
v_exp_f32 v109,v109
v_mfma_f32_16x16x32_bf16 v[184:187],a[240:243],v[88:91],v[184:187]
ds_read_b128 a[176:179],v10 offset:61440
v_cvt_pk_bf16_f32 v86,v108,v109
v_mfma_f32_16x16x32_bf16 v[184:187],a[244:247],v[92:95],v[184:187]
v_exp_f32 v110,v110
v_mfma_f32_16x16x32_bf16 v[188:191],a[248:251],v[88:91],v[188:191]
ds_read_b128 a[180:183],v11 offset:61440
v_mfma_f32_16x16x32_bf16 v[188:191],a[252:255],v[92:95],v[188:191]
v_exp_f32 v111,v111
v_mfma_f32_16x16x32_bf16 v[52:55],v[44:47],v[88:91],v[52:55]
ds_read_b128 a[184:187],v12 offset:61440
v_cvt_pk_bf16_f32 v87,v110,v111
v_mfma_f32_16x16x32_bf16 v[52:55],v[44:47],v[92:95],v[52:55]
ds_read_b128 a[188:191],v13 offset:61440
v_mfma_f32_16x16x32_bf16 v[192:195],a[192:195],v[80:83],v[192:195]
v_mfma_f32_16x16x32_bf16 v[192:195],a[196:199],v[84:87],v[192:195]
v_exp_f32 v112,v112
v_mfma_f32_16x16x32_bf16 v[196:199],a[200:203],v[80:83],v[196:199]
v_mfma_f32_16x16x32_bf16 v[196:199],a[204:207],v[84:87],v[196:199]
v_exp_f32 v113,v113
v_mfma_f32_16x16x32_bf16 v[200:203],a[208:211],v[80:83],v[200:203]
v_cvt_pk_bf16_f32 v88,v112,v113
v_mfma_f32_16x16x32_bf16 v[200:203],a[212:215],v[84:87],v[200:203]
s_add_u32 m0,s39,16384
v_exp_f32 v114,v114
v_mfma_f32_16x16x32_bf16 v[204:207],a[216:219],v[80:83],v[204:207]
buffer_load_dwordx4 v6,s[8:11],s48 offen offset:2048 nt lds
v_mfma_f32_16x16x32_bf16 v[204:207],a[220:223],v[84:87],v[204:207]
v_exp_f32 v115,v115
v_mfma_f32_16x16x32_bf16 v[208:211],a[224:227],v[80:83],v[208:211]
v_cvt_pk_bf16_f32 v89,v114,v115
v_mfma_f32_16x16x32_bf16 v[208:211],a[228:231],v[84:87],v[208:211]
v_exp_f32 v116,v116
v_mfma_f32_16x16x32_bf16 v[212:215],a[232:235],v[80:83],v[212:215]
v_mfma_f32_16x16x32_bf16 v[212:215],a[236:239],v[84:87],v[212:215]
v_exp_f32 v117,v117
v_mfma_f32_16x16x32_bf16 v[216:219],a[240:243],v[80:83],v[216:219]
v_cvt_pk_bf16_f32 v90,v116,v117
v_mfma_f32_16x16x32_bf16 v[216:219],a[244:247],v[84:87],v[216:219]
v_exp_f32 v118,v118
v_mfma_f32_16x16x32_bf16 v[220:223],a[248:251],v[80:83],v[220:223]
s_waitcnt lgkmcnt(0)
v_mfma_f32_16x16x32_bf16 v[220:223],a[252:255],v[84:87],v[220:223]
v_exp_f32 v119,v119
v_mfma_f32_16x16x32_bf16 v[56:59],v[44:47],v[80:83],v[56:59]
v_cvt_pk_bf16_f32 v91,v118,v119
v_mfma_f32_16x16x32_bf16 v[56:59],v[44:47],v[84:87],v[56:59]
v_exp_f32 v120,v120
v_mfma_f32_16x16x32_bf16 v[96:99],a[128:131],a[64:67],v[64:67]
v_mfma_f32_16x16x32_bf16 v[96:99],a[132:135],a[68:71],v[96:99]
s_add_u32 m0,s39,16384
v_exp_f32 v121,v121
v_mfma_f32_16x16x32_bf16 v[96:99],a[136:139],a[72:75],v[96:99]
buffer_load_dwordx4 v7,s[8:11],s48 offen offset:3072 nt lds
v_cvt_pk_bf16_f32 v92,v120,v121
v_mfma_f32_16x16x32_bf16 v[96:99],a[140:143],a[76:79],v[96:99]
v_exp_f32 v122,v122
v_mfma_f32_16x16x32_bf16 v[100:103],a[144:147],a[64:67],v[64:67]
v_mfma_f32_16x16x32_bf16 v[100:103],a[148:151],a[68:71],v[100:103]
v_exp_f32 v123,v123
v_mfma_f32_16x16x32_bf16 v[100:103],a[152:155],a[72:75],v[100:103]
v_cvt_pk_bf16_f32 v93,v122,v123
v_mfma_f32_16x16x32_bf16 v[100:103],a[156:159],a[76:79],v[100:103]
v_exp_f32 v124,v124
v_mfma_f32_16x16x32_bf16 v[104:107],a[160:163],a[64:67],v[64:67]
v_mfma_f32_16x16x32_bf16 v[104:107],a[164:167],a[68:71],v[104:107]
v_exp_f32 v125,v125
v_mfma_f32_16x16x32_bf16 v[104:107],a[168:171],a[72:75],v[104:107]
v_cvt_pk_bf16_f32 v94,v124,v125
v_mfma_f32_16x16x32_bf16 v[104:107],a[172:175],a[76:79],v[104:107]
v_exp_f32 v126,v126
v_mfma_f32_16x16x32_bf16 v[108:111],a[176:179],a[64:67],v[64:67]
v_mfma_f32_16x16x32_bf16 v[108:111],a[180:183],a[68:71],v[108:111]
v_exp_f32 v127,v127
v_mfma_f32_16x16x32_bf16 v[108:111],a[184:187],a[72:75],v[108:111]
v_cvt_pk_bf16_f32 v95,v126,v127
v_mfma_f32_16x16x32_bf16 v[108:111],a[188:191],a[76:79],v[108:111]
v_mfma_f32_16x16x32_bf16 v[224:227],a[192:195],v[88:91],v[224:227]
s_add_u32 m0,s39,81920
v_mfma_f32_16x16x32_bf16 v[224:227],a[196:199],v[92:95],v[224:227]
buffer_load_dwordx4 v8,s[12:15],s48 offen nt lds
v_exp_f32 v96,v96
v_mfma_f32_16x16x32_bf16 v[228:231],a[200:203],v[88:91],v[228:231]
ds_read_b64_tr_b16 a[192:193],v14 offset:49152
ds_read_b64_tr_b16 a[194:195],v14 offset:53248
v_mfma_f32_16x16x32_bf16 v[228:231],a[204:207],v[92:95],v[228:231]
v_exp_f32 v97,v97
v_mfma_f32_16x16x32_bf16 v[232:235],a[208:211],v[88:91],v[232:235]
ds_read_b64_tr_b16 a[196:197],v14 offset:57344
v_cvt_pk_bf16_f32 v80,v96,v97
v_mfma_f32_16x16x32_bf16 v[232:235],a[212:215],v[92:95],v[232:235]
v_exp_f32 v98,v98
v_mfma_f32_16x16x32_bf16 v[236:239],a[216:219],v[88:91],v[236:239]
ds_read_b64_tr_b16 a[198:199],v14 offset:61440
ds_read_b64_tr_b16 a[200:201],v15 offset:49152
v_mfma_f32_16x16x32_bf16 v[236:239],a[220:223],v[92:95],v[236:239]
v_exp_f32 v99,v99
v_mfma_f32_16x16x32_bf16 v[240:243],a[224:227],v[88:91],v[240:243]
ds_read_b64_tr_b16 a[202:203],v15 offset:53248
v_cvt_pk_bf16_f32 v81,v98,v99
v_mfma_f32_16x16x32_bf16 v[240:243],a[228:231],v[92:95],v[240:243]
v_exp_f32 v100,v100
v_mfma_f32_16x16x32_bf16 v[244:247],a[232:235],v[88:91],v[244:247]
ds_read_b64_tr_b16 a[204:205],v15 offset:57344
ds_read_b64_tr_b16 a[206:207],v15 offset:61440
v_mfma_f32_16x16x32_bf16 v[244:247],a[236:239],v[92:95],v[244:247]
v_exp_f32 v101,v101
v_mfma_f32_16x16x32_bf16 v[248:251],a[240:243],v[88:91],v[248:251]
ds_read_b64_tr_b16 a[208:209],v16 offset:49152
v_cvt_pk_bf16_f32 v82,v100,v101
v_mfma_f32_16x16x32_bf16 v[248:251],a[244:247],v[92:95],v[248:251]
v_exp_f32 v102,v102
v_mfma_f32_16x16x32_bf16 v[252:255],a[248:251],v[88:91],v[252:255]
ds_read_b64_tr_b16 a[210:211],v16 offset:53248
ds_read_b64_tr_b16 a[212:213],v16 offset:57344
s_add_u32 m0,s39,81920
v_mfma_f32_16x16x32_bf16 v[252:255],a[252:255],v[92:95],v[252:255]
buffer_load_dwordx4 v9,s[12:15],s48 offen offset:1024 nt lds
v_exp_f32 v103,v103
v_mfma_f32_16x16x32_bf16 v[60:63],v[44:47],v[88:91],v[60:63]
ds_read_b64_tr_b16 a[214:215],v16 offset:61440
v_cvt_pk_bf16_f32 v83,v102,v103
v_mfma_f32_16x16x32_bf16 v[60:63],v[44:47],v[92:95],v[60:63]
v_exp_f32 v104,v104
v_mfma_f32_16x16x32_bf16 v[112:115],a[128:131],a[80:83],v[68:71]
ds_read_b64_tr_b16 a[216:217],v17 offset:49152
ds_read_b64_tr_b16 a[218:219],v17 offset:53248
v_mfma_f32_16x16x32_bf16 v[112:115],a[132:135],a[84:87],v[112:115]
v_exp_f32 v105,v105
v_mfma_f32_16x16x32_bf16 v[112:115],a[136:139],a[88:91],v[112:115]
ds_read_b64_tr_b16 a[220:221],v17 offset:57344
v_cvt_pk_bf16_f32 v84,v104,v105
v_mfma_f32_16x16x32_bf16 v[112:115],a[140:143],a[92:95],v[112:115]
v_exp_f32 v106,v106
v_mfma_f32_16x16x32_bf16 v[116:119],a[144:147],a[80:83],v[68:71]
ds_read_b64_tr_b16 a[222:223],v17 offset:61440
ds_read_b64_tr_b16 a[224:225],v18 offset:49152
v_mfma_f32_16x16x32_bf16 v[116:119],a[148:151],a[84:87],v[116:119]
v_exp_f32 v107,v107
v_mfma_f32_16x16x32_bf16 v[116:119],a[152:155],a[88:91],v[116:119]
ds_read_b64_tr_b16 a[226:227],v18 offset:53248
v_cvt_pk_bf16_f32 v85,v106,v107
v_mfma_f32_16x16x32_bf16 v[116:119],a[156:159],a[92:95],v[116:119]
v_exp_f32 v108,v108
v_mfma_f32_16x16x32_bf16 v[120:123],a[160:163],a[80:83],v[68:71]
ds_read_b64_tr_b16 a[228:229],v18 offset:57344
ds_read_b64_tr_b16 a[230:231],v18 offset:61440
v_mfma_f32_16x16x32_bf16 v[120:123],a[164:167],a[84:87],v[120:123]
v_exp_f32 v109,v109
v_mfma_f32_16x16x32_bf16 v[120:123],a[168:171],a[88:91],v[120:123]
ds_read_b64_tr_b16 a[232:233],v19 offset:49152
s_add_u32 m0,s39,81920
v_cvt_pk_bf16_f32 v86,v108,v109
v_mfma_f32_16x16x32_bf16 v[120:123],a[172:175],a[92:95],v[120:123]
buffer_load_dwordx4 v8,s[12:15],s48 offen offset:2048 nt lds
v_exp_f32 v110,v110
v_mfma_f32_16x16x32_bf16 v[124:127],a[176:179],a[80:83],v[68:71]
ds_read_b64_tr_b16 a[234:235],v19 offset:53248
ds_read_b64_tr_b16 a[236:237],v19 offset:57344
v_mfma_f32_16x16x32_bf16 v[124:127],a[180:183],a[84:87],v[124:127]
v_exp_f32 v111,v111
v_mfma_f32_16x16x32_bf16 v[124:127],a[184:187],a[88:91],v[124:127]
ds_read_b64_tr_b16 a[238:239],v19 offset:61440
v_cvt_pk_bf16_f32 v87,v110,v111
v_mfma_f32_16x16x32_bf16 v[124:127],a[188:191],a[92:95],v[124:127]
ds_read_b64_tr_b16 a[240:241],v20 offset:49152
ds_read_b64_tr_b16 a[242:243],v20 offset:53248
v_mfma_f32_16x16x32_bf16 v[96:99],a[128:131],a[96:99],v[72:75]
ds_read_b64_tr_b16 a[244:245],v20 offset:57344
ds_read_b64_tr_b16 a[246:247],v20 offset:61440
v_mfma_f32_16x16x32_bf16 v[96:99],a[132:135],a[100:103],v[96:99]
v_exp_f32 v112,v112
v_mfma_f32_16x16x32_bf16 v[96:99],a[136:139],a[104:107],v[96:99]
ds_read_b64_tr_b16 a[248:249],v21 offset:49152
ds_read_b64_tr_b16 a[250:251],v21 offset:53248
v_mfma_f32_16x16x32_bf16 v[96:99],a[140:143],a[108:111],v[96:99]
v_exp_f32 v113,v113
v_mfma_f32_16x16x32_bf16 v[100:103],a[144:147],a[96:99],v[72:75]
ds_read_b64_tr_b16 a[252:253],v21 offset:57344
v_cvt_pk_bf16_f32 v88,v112,v113
v_mfma_f32_16x16x32_bf16 v[100:103],a[148:151],a[100:103],v[100:103]
v_exp_f32 v114,v114
v_mfma_f32_16x16x32_bf16 v[100:103],a[152:155],a[104:107],v[100:103]
ds_read_b64_tr_b16 a[254:255],v21 offset:61440
v_mfma_f32_16x16x32_bf16 v[100:103],a[156:159],a[108:111],v[100:103]
v_exp_f32 v115,v115
v_mfma_f32_16x16x32_bf16 v[104:107],a[160:163],a[96:99],v[72:75]
s_add_u32 m0,s39,81920
v_cvt_pk_bf16_f32 v89,v114,v115
v_mfma_f32_16x16x32_bf16 v[104:107],a[164:167],a[100:103],v[104:107]
buffer_load_dwordx4 v9,s[12:15],s48 offen offset:3072 nt lds
v_exp_f32 v116,v116
v_mfma_f32_16x16x32_bf16 v[104:107],a[168:171],a[104:107],v[104:107]
v_mfma_f32_16x16x32_bf16 v[104:107],a[172:175],a[108:111],v[104:107]
v_exp_f32 v117,v117
v_mfma_f32_16x16x32_bf16 v[108:111],a[176:179],a[96:99],v[72:75]
v_cvt_pk_bf16_f32 v90,v116,v117
v_mfma_f32_16x16x32_bf16 v[108:111],a[180:183],a[100:103],v[108:111]
v_exp_f32 v118,v118
v_mfma_f32_16x16x32_bf16 v[108:111],a[184:187],a[104:107],v[108:111]
s_waitcnt lgkmcnt(0)
v_mfma_f32_16x16x32_bf16 v[108:111],a[188:191],a[108:111],v[108:111]
v_exp_f32 v119,v119
v_mfma_f32_16x16x32_bf16 v[128:131],a[192:195],v[80:83],v[128:131]
v_cvt_pk_bf16_f32 v91,v118,v119
v_mfma_f32_16x16x32_bf16 v[128:131],a[196:199],v[84:87],v[128:131]
v_exp_f32 v120,v120
v_mfma_f32_16x16x32_bf16 v[132:135],a[200:203],v[80:83],v[132:135]
v_mfma_f32_16x16x32_bf16 v[132:135],a[204:207],v[84:87],v[132:135]
v_exp_f32 v121,v121
v_mfma_f32_16x16x32_bf16 v[136:139],a[208:211],v[80:83],v[136:139]
v_cvt_pk_bf16_f32 v92,v120,v121
v_mfma_f32_16x16x32_bf16 v[136:139],a[212:215],v[84:87],v[136:139]
v_exp_f32 v122,v122
v_mfma_f32_16x16x32_bf16 v[140:143],a[216:219],v[80:83],v[140:143]
v_mfma_f32_16x16x32_bf16 v[140:143],a[220:223],v[84:87],v[140:143]
s_mov_b32 s48,491520
v_exp_f32 v123,v123
v_mfma_f32_16x16x32_bf16 v[144:147],a[224:227],v[80:83],v[144:147]
s_add_u32 m0,s39,32768
v_cvt_pk_bf16_f32 v93,v122,v123
v_mfma_f32_16x16x32_bf16 v[144:147],a[228:231],v[84:87],v[144:147]
buffer_load_dwordx4 v4,s[8:11],s48 offen nt lds
v_exp_f32 v124,v124
v_mfma_f32_16x16x32_bf16 v[148:151],a[232:235],v[80:83],v[148:151]
v_mfma_f32_16x16x32_bf16 v[148:151],a[236:239],v[84:87],v[148:151]
v_exp_f32 v125,v125
v_mfma_f32_16x16x32_bf16 v[152:155],a[240:243],v[80:83],v[152:155]
v_cvt_pk_bf16_f32 v94,v124,v125
v_mfma_f32_16x16x32_bf16 v[152:155],a[244:247],v[84:87],v[152:155]
v_exp_f32 v126,v126
v_mfma_f32_16x16x32_bf16 v[156:159],a[248:251],v[80:83],v[156:159]
v_mfma_f32_16x16x32_bf16 v[156:159],a[252:255],v[84:87],v[156:159]
v_exp_f32 v127,v127
v_mfma_f32_16x16x32_bf16 v[48:51],v[44:47],v[80:83],v[48:51]
v_cvt_pk_bf16_f32 v95,v126,v127
v_mfma_f32_16x16x32_bf16 v[48:51],v[44:47],v[84:87],v[48:51]
s_waitcnt vmcnt(9)
s_barrier
v_mfma_f32_16x16x32_bf16 v[112:115],a[128:131],a[112:115],v[76:79]
v_mfma_f32_16x16x32_bf16 v[112:115],a[132:135],a[116:119],v[112:115]
v_exp_f32 v96,v96
v_mfma_f32_16x16x32_bf16 v[112:115],a[136:139],a[120:123],v[112:115]
v_mfma_f32_16x16x32_bf16 v[112:115],a[140:143],a[124:127],v[112:115]
s_add_u32 m0,s39,32768
v_exp_f32 v97,v97
v_mfma_f32_16x16x32_bf16 v[116:119],a[144:147],a[112:115],v[76:79]
ds_read_b128 a[128:131],v10 offset:0
v_cvt_pk_bf16_f32 v80,v96,v97
v_mfma_f32_16x16x32_bf16 v[116:119],a[148:151],a[116:119],v[116:119]
buffer_load_dwordx4 v5,s[8:11],s48 offen offset:1024 nt lds
v_exp_f32 v98,v98
v_mfma_f32_16x16x32_bf16 v[116:119],a[152:155],a[120:123],v[116:119]
ds_read_b128 a[132:135],v11 offset:0
v_mfma_f32_16x16x32_bf16 v[116:119],a[156:159],a[124:127],v[116:119]
v_exp_f32 v99,v99
v_mfma_f32_16x16x32_bf16 v[120:123],a[160:163],a[112:115],v[76:79]
ds_read_b128 a[136:139],v12 offset:0
v_cvt_pk_bf16_f32 v81,v98,v99
v_mfma_f32_16x16x32_bf16 v[120:123],a[164:167],a[116:119],v[120:123]
v_exp_f32 v100,v100
v_mfma_f32_16x16x32_bf16 v[120:123],a[168:171],a[120:123],v[120:123]
ds_read_b128 a[140:143],v13 offset:0
v_mfma_f32_16x16x32_bf16 v[120:123],a[172:175],a[124:127],v[120:123]
v_exp_f32 v101,v101
v_mfma_f32_16x16x32_bf16 v[124:127],a[176:179],a[112:115],v[76:79]
ds_read_b128 a[144:147],v10 offset:4096
v_cvt_pk_bf16_f32 v82,v100,v101
v_mfma_f32_16x16x32_bf16 v[124:127],a[180:183],a[116:119],v[124:127]
v_exp_f32 v102,v102
v_mfma_f32_16x16x32_bf16 v[124:127],a[184:187],a[120:123],v[124:127]
ds_read_b128 a[148:151],v11 offset:4096
v_mfma_f32_16x16x32_bf16 v[124:127],a[188:191],a[124:127],v[124:127]
v_exp_f32 v103,v103
v_mfma_f32_16x16x32_bf16 v[160:163],a[192:195],v[88:91],v[160:163]
ds_read_b128 a[152:155],v12 offset:4096
v_cvt_pk_bf16_f32 v83,v102,v103
v_mfma_f32_16x16x32_bf16 v[160:163],a[196:199],v[92:95],v[160:163]
s_add_u32 m0,s39,32768
v_exp_f32 v104,v104
v_mfma_f32_16x16x32_bf16 v[164:167],a[200:203],v[88:91],v[164:167]
ds_read_b128 a[156:159],v13 offset:4096
v_mfma_f32_16x16x32_bf16 v[164:167],a[204:207],v[92:95],v[164:167]
buffer_load_dwordx4 v6,s[8:11],s48 offen offset:2048 nt lds
v_exp_f32 v105,v105
v_mfma_f32_16x16x32_bf16 v[168:171],a[208:211],v[88:91],v[168:171]
ds_read_b128 a[160:163],v10 offset:8192
v_cvt_pk_bf16_f32 v84,v104,v105
v_mfma_f32_16x16x32_bf16 v[168:171],a[212:215],v[92:95],v[168:171]
v_exp_f32 v106,v106
v_mfma_f32_16x16x32_bf16 v[172:175],a[216:219],v[88:91],v[172:175]
ds_read_b128 a[164:167],v11 offset:8192
v_mfma_f32_16x16x32_bf16 v[172:175],a[220:223],v[92:95],v[172:175]
v_exp_f32 v107,v107
v_mfma_f32_16x16x32_bf16 v[176:179],a[224:227],v[88:91],v[176:179]
ds_read_b128 a[168:171],v12 offset:8192
v_cvt_pk_bf16_f32 v85,v106,v107
v_mfma_f32_16x16x32_bf16 v[176:179],a[228:231],v[92:95],v[176:179]
v_exp_f32 v108,v108
v_mfma_f32_16x16x32_bf16 v[180:183],a[232:235],v[88:91],v[180:183]
ds_read_b128 a[172:175],v13 offset:8192
v_mfma_f32_16x16x32_bf16 v[180:183],a[236:239],v[92:95],v[180:183]
v_exp_f32 v109,v109
v_mfma_f32_16x16x32_bf16 v[184:187],a[240:243],v[88:91],v[184:187]
ds_read_b128 a[176:179],v10 offset:12288
v_cvt_pk_bf16_f32 v86,v108,v109
v_mfma_f32_16x16x32_bf16 v[184:187],a[244:247],v[92:95],v[184:187]
v_exp_f32 v110,v110
v_mfma_f32_16x16x32_bf16 v[188:191],a[248:251],v[88:91],v[188:191]
ds_read_b128 a[180:183],v11 offset:12288
v_mfma_f32_16x16x32_bf16 v[188:191],a[252:255],v[92:95],v[188:191]
s_add_u32 m0,s39,32768
v_exp_f32 v111,v111
v_mfma_f32_16x16x32_bf16 v[52:55],v[44:47],v[88:91],v[52:55]
ds_read_b128 a[184:187],v12 offset:12288
v_cvt_pk_bf16_f32 v87,v110,v111
v_mfma_f32_16x16x32_bf16 v[52:55],v[44:47],v[92:95],v[52:55]
ds_read_b128 a[188:191],v13 offset:12288
v_mfma_f32_16x16x32_bf16 v[192:195],a[192:195],v[80:83],v[192:195]
buffer_load_dwordx4 v7,s[8:11],s48 offen offset:3072 nt lds
v_mfma_f32_16x16x32_bf16 v[192:195],a[196:199],v[84:87],v[192:195]
v_exp_f32 v112,v112
v_mfma_f32_16x16x32_bf16 v[196:199],a[200:203],v[80:83],v[196:199]
v_mfma_f32_16x16x32_bf16 v[196:199],a[204:207],v[84:87],v[196:199]
v_exp_f32 v113,v113
v_mfma_f32_16x16x32_bf16 v[200:203],a[208:211],v[80:83],v[200:203]
v_cvt_pk_bf16_f32 v88,v112,v113
v_mfma_f32_16x16x32_bf16 v[200:203],a[212:215],v[84:87],v[200:203]
v_exp_f32 v114,v114
v_mfma_f32_16x16x32_bf16 v[204:207],a[216:219],v[80:83],v[204:207]
v_mfma_f32_16x16x32_bf16 v[204:207],a[220:223],v[84:87],v[204:207]
v_exp_f32 v115,v115
v_mfma_f32_16x16x32_bf16 v[208:211],a[224:227],v[80:83],v[208:211]
v_cvt_pk_bf16_f32 v89,v114,v115
v_mfma_f32_16x16x32_bf16 v[208:211],a[228:231],v[84:87],v[208:211]
v_exp_f32 v116,v116
v_mfma_f32_16x16x32_bf16 v[212:215],a[232:235],v[80:83],v[212:215]
v_mfma_f32_16x16x32_bf16 v[212:215],a[236:239],v[84:87],v[212:215]
v_exp_f32 v117,v117
v_mfma_f32_16x16x32_bf16 v[216:219],a[240:243],v[80:83],v[216:219]
s_add_u32 m0,s39,98304
v_cvt_pk_bf16_f32 v90,v116,v117
v_mfma_f32_16x16x32_bf16 v[216:219],a[244:247],v[84:87],v[216:219]
buffer_load_dwordx4 v8,s[12:15],s48 offen nt lds
v_exp_f32 v118,v118
v_mfma_f32_16x16x32_bf16 v[220:223],a[248:251],v[80:83],v[220:223]
s_waitcnt lgkmcnt(0)
v_mfma_f32_16x16x32_bf16 v[220:223],a[252:255],v[84:87],v[220:223]
v_exp_f32 v119,v119
v_mfma_f32_16x16x32_bf16 v[56:59],v[44:47],v[80:83],v[56:59]
v_cvt_pk_bf16_f32 v91,v118,v119
v_mfma_f32_16x16x32_bf16 v[56:59],v[44:47],v[84:87],v[56:59]
v_exp_f32 v120,v120
v_mfma_f32_16x16x32_bf16 v[96:99],a[128:131],a[64:67],v[64:67]
v_mfma_f32_16x16x32_bf16 v[96:99],a[132:135],a[68:71],v[96:99]
v_exp_f32 v121,v121
v_mfma_f32_16x16x32_bf16 v[96:99],a[136:139],a[72:75],v[96:99]
v_cvt_pk_bf16_f32 v92,v120,v121
v_mfma_f32_16x16x32_bf16 v[96:99],a[140:143],a[76:79],v[96:99]
v_exp_f32 v122,v122
v_mfma_f32_16x16x32_bf16 v[100:103],a[144:147],a[64:67],v[64:67]
v_mfma_f32_16x16x32_bf16 v[100:103],a[148:151],a[68:71],v[100:103]
v_exp_f32 v123,v123
v_mfma_f32_16x16x32_bf16 v[100:103],a[152:155],a[72:75],v[100:103]
v_cvt_pk_bf16_f32 v93,v122,v123
v_mfma_f32_16x16x32_bf16 v[100:103],a[156:159],a[76:79],v[100:103]
v_exp_f32 v124,v124
v_mfma_f32_16x16x32_bf16 v[104:107],a[160:163],a[64:67],v[64:67]
s_add_u32 m0,s39,98304
v_mfma_f32_16x16x32_bf16 v[104:107],a[164:167],a[68:71],v[104:107]
buffer_load_dwordx4 v9,s[12:15],s48 offen offset:1024 nt lds
v_exp_f32 v125,v125
v_mfma_f32_16x16x32_bf16 v[104:107],a[168:171],a[72:75],v[104:107]
v_cvt_pk_bf16_f32 v94,v124,v125
v_mfma_f32_16x16x32_bf16 v[104:107],a[172:175],a[76:79],v[104:107]
v_exp_f32 v126,v126
v_mfma_f32_16x16x32_bf16 v[108:111],a[176:179],a[64:67],v[64:67]
v_mfma_f32_16x16x32_bf16 v[108:111],a[180:183],a[68:71],v[108:111]
v_exp_f32 v127,v127
v_mfma_f32_16x16x32_bf16 v[108:111],a[184:187],a[72:75],v[108:111]
v_cvt_pk_bf16_f32 v95,v126,v127
v_mfma_f32_16x16x32_bf16 v[108:111],a[188:191],a[76:79],v[108:111]
v_mfma_f32_16x16x32_bf16 v[224:227],a[192:195],v[88:91],v[224:227]
v_mfma_f32_16x16x32_bf16 v[224:227],a[196:199],v[92:95],v[224:227]
v_exp_f32 v96,v96
v_mfma_f32_16x16x32_bf16 v[228:231],a[200:203],v[88:91],v[228:231]
ds_read_b64_tr_b16 a[192:193],v14 offset:0
ds_read_b64_tr_b16 a[194:195],v14 offset:4096
v_mfma_f32_16x16x32_bf16 v[228:231],a[204:207],v[92:95],v[228:231]
v_exp_f32 v97,v97
v_mfma_f32_16x16x32_bf16 v[232:235],a[208:211],v[88:91],v[232:235]
ds_read_b64_tr_b16 a[196:197],v14 offset:8192
v_cvt_pk_bf16_f32 v80,v96,v97
v_mfma_f32_16x16x32_bf16 v[232:235],a[212:215],v[92:95],v[232:235]
v_exp_f32 v98,v98
v_mfma_f32_16x16x32_bf16 v[236:239],a[216:219],v[88:91],v[236:239]
ds_read_b64_tr_b16 a[198:199],v14 offset:12288
ds_read_b64_tr_b16 a[200:201],v15 offset:0
s_add_u32 m0,s39,98304
v_mfma_f32_16x16x32_bf16 v[236:239],a[220:223],v[92:95],v[236:239]
buffer_load_dwordx4 v8,s[12:15],s48 offen offset:2048 nt lds
v_exp_f32 v99,v99
v_mfma_f32_16x16x32_bf16 v[240:243],a[224:227],v[88:91],v[240:243]
ds_read_b64_tr_b16 a[202:203],v15 offset:4096
v_cvt_pk_bf16_f32 v81,v98,v99
v_mfma_f32_16x16x32_bf16 v[240:243],a[228:231],v[92:95],v[240:243]
v_exp_f32 v100,v100
v_mfma_f32_16x16x32_bf16 v[244:247],a[232:235],v[88:91],v[244:247]
ds_read_b64_tr_b16 a[204:205],v15 offset:8192
ds_read_b64_tr_b16 a[206:207],v15 offset:12288
v_mfma_f32_16x16x32_bf16 v[244:247],a[236:239],v[92:95],v[244:247]
v_exp_f32 v101,v101
v_mfma_f32_16x16x32_bf16 v[248:251],a[240:243],v[88:91],v[248:251]
ds_read_b64_tr_b16 a[208:209],v16 offset:0
v_cvt_pk_bf16_f32 v82,v100,v101
v_mfma_f32_16x16x32_bf16 v[248:251],a[244:247],v[92:95],v[248:251]
v_exp_f32 v102,v102
v_mfma_f32_16x16x32_bf16 v[252:255],a[248:251],v[88:91],v[252:255]
ds_read_b64_tr_b16 a[210:211],v16 offset:4096
ds_read_b64_tr_b16 a[212:213],v16 offset:8192
v_mfma_f32_16x16x32_bf16 v[252:255],a[252:255],v[92:95],v[252:255]
v_exp_f32 v103,v103
v_mfma_f32_16x16x32_bf16 v[60:63],v[44:47],v[88:91],v[60:63]
ds_read_b64_tr_b16 a[214:215],v16 offset:12288
v_cvt_pk_bf16_f32 v83,v102,v103
v_mfma_f32_16x16x32_bf16 v[60:63],v[44:47],v[92:95],v[60:63]
v_exp_f32 v104,v104
v_mfma_f32_16x16x32_bf16 v[112:115],a[128:131],a[80:83],v[68:71]
ds_read_b64_tr_b16 a[216:217],v17 offset:0
ds_read_b64_tr_b16 a[218:219],v17 offset:4096
v_mfma_f32_16x16x32_bf16 v[112:115],a[132:135],a[84:87],v[112:115]
v_exp_f32 v105,v105
v_mfma_f32_16x16x32_bf16 v[112:115],a[136:139],a[88:91],v[112:115]
ds_read_b64_tr_b16 a[220:221],v17 offset:8192
v_cvt_pk_bf16_f32 v84,v104,v105
v_mfma_f32_16x16x32_bf16 v[112:115],a[140:143],a[92:95],v[112:115]
s_add_u32 m0,s39,98304
v_exp_f32 v106,v106
v_mfma_f32_16x16x32_bf16 v[116:119],a[144:147],a[80:83],v[68:71]
ds_read_b64_tr_b16 a[222:223],v17 offset:12288
ds_read_b64_tr_b16 a[224:225],v18 offset:0
v_mfma_f32_16x16x32_bf16 v[116:119],a[148:151],a[84:87],v[116:119]
buffer_load_dwordx4 v9,s[12:15],s48 offen offset:3072 nt lds
v_exp_f32 v107,v107
v_mfma_f32_16x16x32_bf16 v[116:119],a[152:155],a[88:91],v[116:119]
ds_read_b64_tr_b16 a[226:227],v18 offset:4096
v_cvt_pk_bf16_f32 v85,v106,v107
v_mfma_f32_16x16x32_bf16 v[116:119],a[156:159],a[92:95],v[116:119]
v_exp_f32 v108,v108
v_mfma_f32_16x16x32_bf16 v[120:123],a[160:163],a[80:83],v[68:71]
ds_read_b64_tr_b16 a[228:229],v18 offset:8192
ds_read_b64_tr_b16 a[230:231],v18 offset:12288
v_mfma_f32_16x16x32_bf16 v[120:123],a[164:167],a[84:87],v[120:123]
v_exp_f32 v109,v109
v_mfma_f32_16x16x32_bf16 v[120:123],a[168:171],a[88:91],v[120:123]
ds_read_b64_tr_b16 a[232:233],v19 offset:0
v_cvt_pk_bf16_f32 v86,v108,v109
v_mfma_f32_16x16x32_bf16 v[120:123],a[172:175],a[92:95],v[120:123]
v_exp_f32 v110,v110
v_mfma_f32_16x16x32_bf16 v[124:127],a[176:179],a[80:83],v[68:71]
ds_read_b64_tr_b16 a[234:235],v19 offset:4096
ds_read_b64_tr_b16 a[236:237],v19 offset:8192
v_mfma_f32_16x16x32_bf16 v[124:127],a[180:183],a[84:87],v[124:127]
v_exp_f32 v111,v111
v_mfma_f32_16x16x32_bf16 v[124:127],a[184:187],a[88:91],v[124:127]
ds_read_b64_tr_b16 a[238:239],v19 offset:12288
v_cvt_pk_bf16_f32 v87,v110,v111
v_mfma_f32_16x16x32_bf16 v[124:127],a[188:191],a[92:95],v[124:127]
ds_read_b64_tr_b16 a[240:241],v20 offset:0
ds_read_b64_tr_b16 a[242:243],v20 offset:4096
v_mfma_f32_16x16x32_bf16 v[96:99],a[128:131],a[96:99],v[72:75]
ds_read_b64_tr_b16 a[244:245],v20 offset:8192
ds_read_b64_tr_b16 a[246:247],v20 offset:12288
v_mfma_f32_16x16x32_bf16 v[96:99],a[132:135],a[100:103],v[96:99]
s_mov_b32 s48,507904
v_exp_f32 v112,v112
v_mfma_f32_16x16x32_bf16 v[96:99],a[136:139],a[104:107],v[96:99]
ds_read_b64_tr_b16 a[248:249],v21 offset:0
ds_read_b64_tr_b16 a[250:251],v21 offset:4096
s_add_u32 m0,s39,49152
v_mfma_f32_16x16x32_bf16 v[96:99],a[140:143],a[108:111],v[96:99]
buffer_load_dwordx4 v4,s[8:11],s48 offen nt lds
v_exp_f32 v113,v113
v_mfma_f32_16x16x32_bf16 v[100:103],a[144:147],a[96:99],v[72:75]
ds_read_b64_tr_b16 a[252:253],v21 offset:8192
v_cvt_pk_bf16_f32 v88,v112,v113
v_mfma_f32_16x16x32_bf16 v[100:103],a[148:151],a[100:103],v[100:103]
v_exp_f32 v114,v114
v_mfma_f32_16x16x32_bf16 v[100:103],a[152:155],a[104:107],v[100:103]
ds_read_b64_tr_b16 a[254:255],v21 offset:12288
v_mfma_f32_16x16x32_bf16 v[100:103],a[156:159],a[108:111],v[100:103]
v_exp_f32 v115,v115
v_mfma_f32_16x16x32_bf16 v[104:107],a[160:163],a[96:99],v[72:75]
v_cvt_pk_bf16_f32 v89,v114,v115
v_mfma_f32_16x16x32_bf16 v[104:107],a[164:167],a[100:103],v[104:107]
v_exp_f32 v116,v116
v_mfma_f32_16x16x32_bf16 v[104:107],a[168:171],a[104:107],v[104:107]
v_mfma_f32_16x16x32_bf16 v[104:107],a[172:175],a[108:111],v[104:107]
v_exp_f32 v117,v117
v_mfma_f32_16x16x32_bf16 v[108:111],a[176:179],a[96:99],v[72:75]
v_cvt_pk_bf16_f32 v90,v116,v117
v_mfma_f32_16x16x32_bf16 v[108:111],a[180:183],a[100:103],v[108:111]
v_exp_f32 v118,v118
v_mfma_f32_16x16x32_bf16 v[108:111],a[184:187],a[104:107],v[108:111]
s_waitcnt lgkmcnt(0)
v_mfma_f32_16x16x32_bf16 v[108:111],a[188:191],a[108:111],v[108:111]
s_add_u32 m0,s39,49152
v_exp_f32 v119,v119
v_mfma_f32_16x16x32_bf16 v[128:131],a[192:195],v[80:83],v[128:131]
buffer_load_dwordx4 v5,s[8:11],s48 offen offset:1024 nt lds
v_cvt_pk_bf16_f32 v91,v118,v119
v_mfma_f32_16x16x32_bf16 v[128:131],a[196:199],v[84:87],v[128:131]
v_exp_f32 v120,v120
v_mfma_f32_16x16x32_bf16 v[132:135],a[200:203],v[80:83],v[132:135]
v_mfma_f32_16x16x32_bf16 v[132:135],a[204:207],v[84:87],v[132:135]
v_exp_f32 v121,v121
v_mfma_f32_16x16x32_bf16 v[136:139],a[208:211],v[80:83],v[136:139]
v_cvt_pk_bf16_f32 v92,v120,v121
v_mfma_f32_16x16x32_bf16 v[136:139],a[212:215],v[84:87],v[136:139]
v_exp_f32 v122,v122
v_mfma_f32_16x16x32_bf16 v[140:143],a[216:219],v[80:83],v[140:143]
v_mfma_f32_16x16x32_bf16 v[140:143],a[220:223],v[84:87],v[140:143]
v_exp_f32 v123,v123
v_mfma_f32_16x16x32_bf16 v[144:147],a[224:227],v[80:83],v[144:147]
v_cvt_pk_bf16_f32 v93,v122,v123
v_mfma_f32_16x16x32_bf16 v[144:147],a[228:231],v[84:87],v[144:147]
v_exp_f32 v124,v124
v_mfma_f32_16x16x32_bf16 v[148:151],a[232:235],v[80:83],v[148:151]
v_mfma_f32_16x16x32_bf16 v[148:151],a[236:239],v[84:87],v[148:151]
v_exp_f32 v125,v125
v_mfma_f32_16x16x32_bf16 v[152:155],a[240:243],v[80:83],v[152:155]
v_cvt_pk_bf16_f32 v94,v124,v125
v_mfma_f32_16x16x32_bf16 v[152:155],a[244:247],v[84:87],v[152:155]
s_add_u32 m0,s39,49152
v_exp_f32 v126,v126
v_mfma_f32_16x16x32_bf16 v[156:159],a[248:251],v[80:83],v[156:159]
buffer_load_dwordx4 v6,s[8:11],s48 offen offset:2048 nt lds
v_mfma_f32_16x16x32_bf16 v[156:159],a[252:255],v[84:87],v[156:159]
v_exp_f32 v127,v127
v_mfma_f32_16x16x32_bf16 v[48:51],v[44:47],v[80:83],v[48:51]
v_cvt_pk_bf16_f32 v95,v126,v127
v_mfma_f32_16x16x32_bf16 v[48:51],v[44:47],v[84:87],v[48:51]
s_waitcnt vmcnt(11)
s_barrier
v_mfma_f32_16x16x32_bf16 v[112:115],a[128:131],a[112:115],v[76:79]
buffer_load_dword v24,v27,s[60:63],s83 offen sc1
v_mfma_f32_16x16x32_bf16 v[112:115],a[132:135],a[116:119],v[112:115]
v_exp_f32 v96,v96
v_mfma_f32_16x16x32_bf16 v[112:115],a[136:139],a[120:123],v[112:115]
v_mfma_f32_16x16x32_bf16 v[112:115],a[140:143],a[124:127],v[112:115]
v_exp_f32 v97,v97
v_mfma_f32_16x16x32_bf16 v[116:119],a[144:147],a[112:115],v[76:79]
ds_read_b128 a[128:131],v10 offset:16384
v_cvt_pk_bf16_f32 v80,v96,v97
v_mfma_f32_16x16x32_bf16 v[116:119],a[148:151],a[116:119],v[116:119]
v_exp_f32 v98,v98
v_mfma_f32_16x16x32_bf16 v[116:119],a[152:155],a[120:123],v[116:119]
ds_read_b128 a[132:135],v11 offset:16384
v_mfma_f32_16x16x32_bf16 v[116:119],a[156:159],a[124:127],v[116:119]
v_exp_f32 v99,v99
v_mfma_f32_16x16x32_bf16 v[120:123],a[160:163],a[112:115],v[76:79]
ds_read_b128 a[136:139],v12 offset:16384
v_cvt_pk_bf16_f32 v81,v98,v99
v_mfma_f32_16x16x32_bf16 v[120:123],a[164:167],a[116:119],v[120:123]
v_exp_f32 v100,v100
v_mfma_f32_16x16x32_bf16 v[120:123],a[168:171],a[120:123],v[120:123]
ds_read_b128 a[140:143],v13 offset:16384
s_add_u32 m0,s39,49152
v_mfma_f32_16x16x32_bf16 v[120:123],a[172:175],a[124:127],v[120:123]
buffer_load_dwordx4 v7,s[8:11],s48 offen offset:3072 nt lds
v_exp_f32 v101,v101
v_mfma_f32_16x16x32_bf16 v[124:127],a[176:179],a[112:115],v[76:79]
ds_read_b128 a[144:147],v10 offset:20480
v_cvt_pk_bf16_f32 v82,v100,v101
v_mfma_f32_16x16x32_bf16 v[124:127],a[180:183],a[116:119],v[124:127]
v_exp_f32 v102,v102
v_mfma_f32_16x16x32_bf16 v[124:127],a[184:187],a[120:123],v[124:127]
ds_read_b128 a[148:151],v11 offset:20480
v_mfma_f32_16x16x32_bf16 v[124:127],a[188:191],a[124:127],v[124:127]
v_exp_f32 v103,v103
v_mfma_f32_16x16x32_bf16 v[160:163],a[192:195],v[88:91],v[160:163]
ds_read_b128 a[152:155],v12 offset:20480
v_cvt_pk_bf16_f32 v83,v102,v103
v_mfma_f32_16x16x32_bf16 v[160:163],a[196:199],v[92:95],v[160:163]
v_exp_f32 v104,v104
v_mfma_f32_16x16x32_bf16 v[164:167],a[200:203],v[88:91],v[164:167]
ds_read_b128 a[156:159],v13 offset:20480
v_mfma_f32_16x16x32_bf16 v[164:167],a[204:207],v[92:95],v[164:167]
v_exp_f32 v105,v105
v_mfma_f32_16x16x32_bf16 v[168:171],a[208:211],v[88:91],v[168:171]
ds_read_b128 a[160:163],v10 offset:24576
s_add_u32 s72,s78,0
v_cvt_pk_bf16_f32 v84,v104,v105
v_mfma_f32_16x16x32_bf16 v[168:171],a[212:215],v[92:95],v[168:171]
buffer_store_dwordx4 a[0:3],v3,s[28:31],s72 offen sc1
v_exp_f32 v106,v106
v_mfma_f32_16x16x32_bf16 v[172:175],a[216:219],v[88:91],v[172:175]
ds_read_b128 a[164:167],v11 offset:24576
v_mfma_f32_16x16x32_bf16 v[172:175],a[220:223],v[92:95],v[172:175]
v_exp_f32 v107,v107
v_mfma_f32_16x16x32_bf16 v[176:179],a[224:227],v[88:91],v[176:179]
ds_read_b128 a[168:171],v12 offset:24576
s_add_u32 m0,s39,114688
v_cvt_pk_bf16_f32 v85,v106,v107
v_mfma_f32_16x16x32_bf16 v[176:179],a[228:231],v[92:95],v[176:179]
buffer_load_dwordx4 v8,s[12:15],s48 offen nt lds
v_exp_f32 v108,v108
v_mfma_f32_16x16x32_bf16 v[180:183],a[232:235],v[88:91],v[180:183]
ds_read_b128 a[172:175],v13 offset:24576
v_mfma_f32_16x16x32_bf16 v[180:183],a[236:239],v[92:95],v[180:183]
v_exp_f32 v109,v109
v_mfma_f32_16x16x32_bf16 v[184:187],a[240:243],v[88:91],v[184:187]
ds_read_b128 a[176:179],v10 offset:28672
v_cvt_pk_bf16_f32 v86,v108,v109
v_mfma_f32_16x16x32_bf16 v[184:187],a[244:247],v[92:95],v[184:187]
v_exp_f32 v110,v110
v_mfma_f32_16x16x32_bf16 v[188:191],a[248:251],v[88:91],v[188:191]
ds_read_b128 a[180:183],v11 offset:28672
v_mfma_f32_16x16x32_bf16 v[188:191],a[252:255],v[92:95],v[188:191]
v_exp_f32 v111,v111
v_mfma_f32_16x16x32_bf16 v[52:55],v[44:47],v[88:91],v[52:55]
ds_read_b128 a[184:187],v12 offset:28672
v_cvt_pk_bf16_f32 v87,v110,v111
v_mfma_f32_16x16x32_bf16 v[52:55],v[44:47],v[92:95],v[52:55]
ds_read_b128 a[188:191],v13 offset:28672
v_mfma_f32_16x16x32_bf16 v[192:195],a[192:195],v[80:83],v[192:195]
v_mfma_f32_16x16x32_bf16 v[192:195],a[196:199],v[84:87],v[192:195]
s_add_u32 s72,s78,0
v_exp_f32 v112,v112
v_mfma_f32_16x16x32_bf16 v[196:199],a[200:203],v[80:83],v[196:199]
buffer_store_dwordx4 a[16:19],v3,s[28:31],s72 offen offset:1024 sc1
v_mfma_f32_16x16x32_bf16 v[196:199],a[204:207],v[84:87],v[196:199]
v_exp_f32 v113,v113
v_mfma_f32_16x16x32_bf16 v[200:203],a[208:211],v[80:83],v[200:203]
s_add_u32 m0,s39,114688
v_cvt_pk_bf16_f32 v88,v112,v113
v_mfma_f32_16x16x32_bf16 v[200:203],a[212:215],v[84:87],v[200:203]
buffer_load_dwordx4 v9,s[12:15],s48 offen offset:1024 nt lds
v_exp_f32 v114,v114
v_mfma_f32_16x16x32_bf16 v[204:207],a[216:219],v[80:83],v[204:207]
v_mfma_f32_16x16x32_bf16 v[204:207],a[220:223],v[84:87],v[204:207]
v_exp_f32 v115,v115
v_mfma_f32_16x16x32_bf16 v[208:211],a[224:227],v[80:83],v[208:211]
v_cvt_pk_bf16_f32 v89,v114,v115
v_mfma_f32_16x16x32_bf16 v[208:211],a[228:231],v[84:87],v[208:211]
v_exp_f32 v116,v116
v_mfma_f32_16x16x32_bf16 v[212:215],a[232:235],v[80:83],v[212:215]
v_mfma_f32_16x16x32_bf16 v[212:215],a[236:239],v[84:87],v[212:215]
v_exp_f32 v117,v117
v_mfma_f32_16x16x32_bf16 v[216:219],a[240:243],v[80:83],v[216:219]
v_cvt_pk_bf16_f32 v90,v116,v117
v_mfma_f32_16x16x32_bf16 v[216:219],a[244:247],v[84:87],v[216:219]
v_exp_f32 v118,v118
v_mfma_f32_16x16x32_bf16 v[220:223],a[248:251],v[80:83],v[220:223]
s_waitcnt lgkmcnt(0)
v_mfma_f32_16x16x32_bf16 v[220:223],a[252:255],v[84:87],v[220:223]
v_exp_f32 v119,v119
v_mfma_f32_16x16x32_bf16 v[56:59],v[44:47],v[80:83],v[56:59]
s_add_u32 s72,s78,0
v_cvt_pk_bf16_f32 v91,v118,v119
v_mfma_f32_16x16x32_bf16 v[56:59],v[44:47],v[84:87],v[56:59]
buffer_store_dwordx4 a[32:35],v3,s[28:31],s72 offen offset:2048 sc1
v_exp_f32 v120,v120
v_mfma_f32_16x16x32_bf16 v[96:99],a[128:131],a[64:67],v[64:67]
v_mfma_f32_16x16x32_bf16 v[96:99],a[132:135],a[68:71],v[96:99]
s_add_u32 m0,s39,114688
v_exp_f32 v121,v121
v_mfma_f32_16x16x32_bf16 v[96:99],a[136:139],a[72:75],v[96:99]
buffer_load_dwordx4 v8,s[12:15],s48 offen offset:2048 nt lds
v_cvt_pk_bf16_f32 v92,v120,v121
v_mfma_f32_16x16x32_bf16 v[96:99],a[140:143],a[76:79],v[96:99]
v_exp_f32 v122,v122
v_mfma_f32_16x16x32_bf16 v[100:103],a[144:147],a[64:67],v[64:67]
v_mfma_f32_16x16x32_bf16 v[100:103],a[148:151],a[68:71],v[100:103]
v_exp_f32 v123,v123
v_mfma_f32_16x16x32_bf16 v[100:103],a[152:155],a[72:75],v[100:103]
v_cvt_pk_bf16_f32 v93,v122,v123
v_mfma_f32_16x16x32_bf16 v[100:103],a[156:159],a[76:79],v[100:103]
v_exp_f32 v124,v124
v_mfma_f32_16x16x32_bf16 v[104:107],a[160:163],a[64:67],v[64:67]
v_mfma_f32_16x16x32_bf16 v[104:107],a[164:167],a[68:71],v[104:107]
v_exp_f32 v125,v125
v_mfma_f32_16x16x32_bf16 v[104:107],a[168:171],a[72:75],v[104:107]
v_cvt_pk_bf16_f32 v94,v124,v125
v_mfma_f32_16x16x32_bf16 v[104:107],a[172:175],a[76:79],v[104:107]
v_exp_f32 v126,v126
v_mfma_f32_16x16x32_bf16 v[108:111],a[176:179],a[64:67],v[64:67]
v_mfma_f32_16x16x32_bf16 v[108:111],a[180:183],a[68:71],v[108:111]
s_add_u32 s72,s78,0
v_exp_f32 v127,v127
v_mfma_f32_16x16x32_bf16 v[108:111],a[184:187],a[72:75],v[108:111]
buffer_store_dwordx4 a[48:51],v3,s[28:31],s72 offen offset:3072 sc1
v_cvt_pk_bf16_f32 v95,v126,v127
v_mfma_f32_16x16x32_bf16 v[108:111],a[188:191],a[76:79],v[108:111]
s_add_u32 m0,s39,114688
v_mfma_f32_16x16x32_bf16 v[224:227],a[192:195],v[88:91],v[224:227]
buffer_load_dwordx4 v9,s[12:15],s48 offen offset:3072 nt lds
v_mfma_f32_16x16x32_bf16 v[224:227],a[196:199],v[92:95],v[224:227]
v_exp_f32 v96,v96
v_mfma_f32_16x16x32_bf16 v[228:231],a[200:203],v[88:91],v[228:231]
ds_read_b64_tr_b16 a[192:193],v14 offset:16384
ds_read_b64_tr_b16 a[194:195],v14 offset:20480
v_mfma_f32_16x16x32_bf16 v[228:231],a[204:207],v[92:95],v[228:231]
v_exp_f32 v97,v97
v_mfma_f32_16x16x32_bf16 v[232:235],a[208:211],v[88:91],v[232:235]
ds_read_b64_tr_b16 a[196:197],v14 offset:24576
v_cvt_pk_bf16_f32 v80,v96,v97
v_mfma_f32_16x16x32_bf16 v[232:235],a[212:215],v[92:95],v[232:235]
v_exp_f32 v98,v98
v_mfma_f32_16x16x32_bf16 v[236:239],a[216:219],v[88:91],v[236:239]
ds_read_b64_tr_b16 a[198:199],v14 offset:28672
ds_read_b64_tr_b16 a[200:201],v15 offset:16384
v_mfma_f32_16x16x32_bf16 v[236:239],a[220:223],v[92:95],v[236:239]
v_exp_f32 v99,v99
v_mfma_f32_16x16x32_bf16 v[240:243],a[224:227],v[88:91],v[240:243]
ds_read_b64_tr_b16 a[202:203],v15 offset:20480
v_cvt_pk_bf16_f32 v81,v98,v99
v_mfma_f32_16x16x32_bf16 v[240:243],a[228:231],v[92:95],v[240:243]
v_exp_f32 v100,v100
v_mfma_f32_16x16x32_bf16 v[244:247],a[232:235],v[88:91],v[244:247]
ds_read_b64_tr_b16 a[204:205],v15 offset:24576
ds_read_b64_tr_b16 a[206:207],v15 offset:28672
v_mfma_f32_16x16x32_bf16 v[244:247],a[236:239],v[92:95],v[244:247]
v_exp_f32 v101,v101
v_mfma_f32_16x16x32_bf16 v[248:251],a[240:243],v[88:91],v[248:251]
ds_read_b64_tr_b16 a[208:209],v16 offset:16384
s_add_u32 s72,s78,4096
v_cvt_pk_bf16_f32 v82,v100,v101
v_mfma_f32_16x16x32_bf16 v[248:251],a[244:247],v[92:95],v[248:251]
buffer_store_dwordx4 a[4:7],v3,s[28:31],s72 offen sc1
v_exp_f32 v102,v102
v_mfma_f32_16x16x32_bf16 v[252:255],a[248:251],v[88:91],v[252:255]
ds_read_b64_tr_b16 a[210:211],v16 offset:20480
ds_read_b64_tr_b16 a[212:213],v16 offset:24576
v_mfma_f32_16x16x32_bf16 v[252:255],a[252:255],v[92:95],v[252:255]
v_exp_f32 v103,v103
v_mfma_f32_16x16x32_bf16 v[60:63],v[44:47],v[88:91],v[60:63]
ds_read_b64_tr_b16 a[214:215],v16 offset:28672
v_cvt_pk_bf16_f32 v83,v102,v103
v_mfma_f32_16x16x32_bf16 v[60:63],v[44:47],v[92:95],v[60:63]
v_exp_f32 v104,v104
v_mfma_f32_16x16x32_bf16 v[112:115],a[128:131],a[80:83],v[68:71]
ds_read_b64_tr_b16 a[216:217],v17 offset:16384
ds_read_b64_tr_b16 a[218:219],v17 offset:20480
v_mfma_f32_16x16x32_bf16 v[112:115],a[132:135],a[84:87],v[112:115]
v_exp_f32 v105,v105
v_mfma_f32_16x16x32_bf16 v[112:115],a[136:139],a[88:91],v[112:115]
ds_read_b64_tr_b16 a[220:221],v17 offset:24576
v_cvt_pk_bf16_f32 v84,v104,v105
v_mfma_f32_16x16x32_bf16 v[112:115],a[140:143],a[92:95],v[112:115]
v_exp_f32 v106,v106
v_mfma_f32_16x16x32_bf16 v[116:119],a[144:147],a[80:83],v[68:71]
ds_read_b64_tr_b16 a[222:223],v17 offset:28672
ds_read_b64_tr_b16 a[224:225],v18 offset:16384
v_mfma_f32_16x16x32_bf16 v[116:119],a[148:151],a[84:87],v[116:119]
v_exp_f32 v107,v107
v_mfma_f32_16x16x32_bf16 v[116:119],a[152:155],a[88:91],v[116:119]
ds_read_b64_tr_b16 a[226:227],v18 offset:20480
v_cvt_pk_bf16_f32 v85,v106,v107
v_mfma_f32_16x16x32_bf16 v[116:119],a[156:159],a[92:95],v[116:119]
v_exp_f32 v108,v108
v_mfma_f32_16x16x32_bf16 v[120:123],a[160:163],a[80:83],v[68:71]
ds_read_b64_tr_b16 a[228:229],v18 offset:24576
ds_read_b64_tr_b16 a[230:231],v18 offset:28672
v_mfma_f32_16x16x32_bf16 v[120:123],a[164:167],a[84:87],v[120:123]
s_add_u32 s72,s78,4096
v_exp_f32 v109,v109
v_mfma_f32_16x16x32_bf16 v[120:123],a[168:171],a[88:91],v[120:123]
ds_read_b64_tr_b16 a[232:233],v19 offset:16384
v_cvt_pk_bf16_f32 v86,v108,v109
v_mfma_f32_16x16x32_bf16 v[120:123],a[172:175],a[92:95],v[120:123]
buffer_store_dwordx4 a[20:23],v3,s[28:31],s72 offen offset:1024 sc1
v_exp_f32 v110,v110
v_mfma_f32_16x16x32_bf16 v[124:127],a[176:179],a[80:83],v[68:71]
ds_read_b64_tr_b16 a[234:235],v19 offset:20480
ds_read_b64_tr_b16 a[236:237],v19 offset:24576
v_mfma_f32_16x16x32_bf16 v[124:127],a[180:183],a[84:87],v[124:127]
v_exp_f32 v111,v111
v_mfma_f32_16x16x32_bf16 v[124:127],a[184:187],a[88:91],v[124:127]
ds_read_b64_tr_b16 a[238:239],v19 offset:28672
v_cvt_pk_bf16_f32 v87,v110,v111
v_mfma_f32_16x16x32_bf16 v[124:127],a[188:191],a[92:95],v[124:127]
ds_read_b64_tr_b16 a[240:241],v20 offset:16384
ds_read_b64_tr_b16 a[242:243],v20 offset:20480
v_mfma_f32_16x16x32_bf16 v[96:99],a[128:131],a[96:99],v[72:75]
ds_read_b64_tr_b16 a[244:245],v20 offset:24576
ds_read_b64_tr_b16 a[246:247],v20 offset:28672
v_mfma_f32_16x16x32_bf16 v[96:99],a[132:135],a[100:103],v[96:99]
v_exp_f32 v112,v112
v_mfma_f32_16x16x32_bf16 v[96:99],a[136:139],a[104:107],v[96:99]
ds_read_b64_tr_b16 a[248:249],v21 offset:16384
ds_read_b64_tr_b16 a[250:251],v21 offset:20480
v_mfma_f32_16x16x32_bf16 v[96:99],a[140:143],a[108:111],v[96:99]
v_exp_f32 v113,v113
v_mfma_f32_16x16x32_bf16 v[100:103],a[144:147],a[96:99],v[72:75]
ds_read_b64_tr_b16 a[252:253],v21 offset:24576
v_cvt_pk_bf16_f32 v88,v112,v113
v_mfma_f32_16x16x32_bf16 v[100:103],a[148:151],a[100:103],v[100:103]
v_exp_f32 v114,v114
v_mfma_f32_16x16x32_bf16 v[100:103],a[152:155],a[104:107],v[100:103]
ds_read_b64_tr_b16 a[254:255],v21 offset:28672
v_mfma_f32_16x16x32_bf16 v[100:103],a[156:159],a[108:111],v[100:103]
v_exp_f32 v115,v115
v_mfma_f32_16x16x32_bf16 v[104:107],a[160:163],a[96:99],v[72:75]
s_add_u32 s72,s78,4096
v_cvt_pk_bf16_f32 v89,v114,v115
v_mfma_f32_16x16x32_bf16 v[104:107],a[164:167],a[100:103],v[104:107]
buffer_store_dwordx4 a[36:39],v3,s[28:31],s72 offen offset:2048 sc1
v_exp_f32 v116,v116
v_mfma_f32_16x16x32_bf16 v[104:107],a[168:171],a[104:107],v[104:107]
v_mfma_f32_16x16x32_bf16 v[104:107],a[172:175],a[108:111],v[104:107]
v_exp_f32 v117,v117
v_mfma_f32_16x16x32_bf16 v[108:111],a[176:179],a[96:99],v[72:75]
v_cvt_pk_bf16_f32 v90,v116,v117
v_mfma_f32_16x16x32_bf16 v[108:111],a[180:183],a[100:103],v[108:111]
v_exp_f32 v118,v118
v_mfma_f32_16x16x32_bf16 v[108:111],a[184:187],a[104:107],v[108:111]
s_waitcnt lgkmcnt(0)
v_mfma_f32_16x16x32_bf16 v[108:111],a[188:191],a[108:111],v[108:111]
v_exp_f32 v119,v119
v_mfma_f32_16x16x32_bf16 v[128:131],a[192:195],v[80:83],v[128:131]
v_cvt_pk_bf16_f32 v91,v118,v119
v_mfma_f32_16x16x32_bf16 v[128:131],a[196:199],v[84:87],v[128:131]
v_exp_f32 v120,v120
v_mfma_f32_16x16x32_bf16 v[132:135],a[200:203],v[80:83],v[132:135]
v_mfma_f32_16x16x32_bf16 v[132:135],a[204:207],v[84:87],v[132:135]
v_exp_f32 v121,v121
v_mfma_f32_16x16x32_bf16 v[136:139],a[208:211],v[80:83],v[136:139]
v_cvt_pk_bf16_f32 v92,v120,v121
v_mfma_f32_16x16x32_bf16 v[136:139],a[212:215],v[84:87],v[136:139]
v_exp_f32 v122,v122
v_mfma_f32_16x16x32_bf16 v[140:143],a[216:219],v[80:83],v[140:143]
v_mfma_f32_16x16x32_bf16 v[140:143],a[220:223],v[84:87],v[140:143]
s_add_u32 s72,s78,4096
v_exp_f32 v123,v123
v_mfma_f32_16x16x32_bf16 v[144:147],a[224:227],v[80:83],v[144:147]
buffer_store_dwordx4 a[52:55],v3,s[28:31],s72 offen offset:3072 sc1
v_cvt_pk_bf16_f32 v93,v122,v123
v_mfma_f32_16x16x32_bf16 v[144:147],a[228:231],v[84:87],v[144:147]
v_exp_f32 v124,v124
v_mfma_f32_16x16x32_bf16 v[148:151],a[232:235],v[80:83],v[148:151]
v_mfma_f32_16x16x32_bf16 v[148:151],a[236:239],v[84:87],v[148:151]
v_exp_f32 v125,v125
v_mfma_f32_16x16x32_bf16 v[152:155],a[240:243],v[80:83],v[152:155]
v_cvt_pk_bf16_f32 v94,v124,v125
v_mfma_f32_16x16x32_bf16 v[152:155],a[244:247],v[84:87],v[152:155]
v_exp_f32 v126,v126
v_mfma_f32_16x16x32_bf16 v[156:159],a[248:251],v[80:83],v[156:159]
v_mfma_f32_16x16x32_bf16 v[156:159],a[252:255],v[84:87],v[156:159]
v_exp_f32 v127,v127
v_mfma_f32_16x16x32_bf16 v[48:51],v[44:47],v[80:83],v[48:51]
v_cvt_pk_bf16_f32 v95,v126,v127
v_mfma_f32_16x16x32_bf16 v[48:51],v[44:47],v[84:87],v[48:51]
s_waitcnt vmcnt(13)
s_mov_b32 s55,0x20000
FC1_RE:
v_readfirstlane_b32 s53,v24
s_nop 0
s_bfe_u32 s53,s53,524288
s_cmp_ge_u32 s53,128
s_cbranch_scc0 FC1_SPIN
FC1_OK:
s_barrier
v_mfma_f32_16x16x32_bf16 v[112:115],a[128:131],a[112:115],v[76:79]
v_mfma_f32_16x16x32_bf16 v[112:115],a[132:135],a[116:119],v[112:115]
v_exp_f32 v96,v96
v_mfma_f32_16x16x32_bf16 v[112:115],a[136:139],a[120:123],v[112:115]
v_mfma_f32_16x16x32_bf16 v[112:115],a[140:143],a[124:127],v[112:115]
v_exp_f32 v97,v97
v_mfma_f32_16x16x32_bf16 v[116:119],a[144:147],a[112:115],v[76:79]
ds_read_b128 a[128:131],v10 offset:32768
s_add_u32 s72,s78,8192
v_cvt_pk_bf16_f32 v80,v96,v97
v_mfma_f32_16x16x32_bf16 v[116:119],a[148:151],a[116:119],v[116:119]
buffer_store_dwordx4 a[8:11],v3,s[28:31],s72 offen sc1
v_exp_f32 v98,v98
v_mfma_f32_16x16x32_bf16 v[116:119],a[152:155],a[120:123],v[116:119]
ds_read_b128 a[132:135],v11 offset:32768
v_mfma_f32_16x16x32_bf16 v[116:119],a[156:159],a[124:127],v[116:119]
v_exp_f32 v99,v99
v_mfma_f32_16x16x32_bf16 v[120:123],a[160:163],a[112:115],v[76:79]
ds_read_b128 a[136:139],v12 offset:32768
v_cvt_pk_bf16_f32 v81,v98,v99
v_mfma_f32_16x16x32_bf16 v[120:123],a[164:167],a[116:119],v[120:123]
v_exp_f32 v100,v100
v_mfma_f32_16x16x32_bf16 v[120:123],a[168:171],a[120:123],v[120:123]
ds_read_b128 a[140:143],v13 offset:32768
v_mfma_f32_16x16x32_bf16 v[120:123],a[172:175],a[124:127],v[120:123]
v_exp_f32 v101,v101
v_mfma_f32_16x16x32_bf16 v[124:127],a[176:179],a[112:115],v[76:79]
ds_read_b128 a[144:147],v10 offset:36864
v_cvt_pk_bf16_f32 v82,v100,v101
v_mfma_f32_16x16x32_bf16 v[124:127],a[180:183],a[116:119],v[124:127]
v_exp_f32 v102,v102
v_mfma_f32_16x16x32_bf16 v[124:127],a[184:187],a[120:123],v[124:127]
ds_read_b128 a[148:151],v11 offset:36864
v_mfma_f32_16x16x32_bf16 v[124:127],a[188:191],a[124:127],v[124:127]
v_exp_f32 v103,v103
v_mfma_f32_16x16x32_bf16 v[160:163],a[192:195],v[88:91],v[160:163]
ds_read_b128 a[152:155],v12 offset:36864
v_cvt_pk_bf16_f32 v83,v102,v103
v_mfma_f32_16x16x32_bf16 v[160:163],a[196:199],v[92:95],v[160:163]
v_exp_f32 v104,v104
v_mfma_f32_16x16x32_bf16 v[164:167],a[200:203],v[88:91],v[164:167]
ds_read_b128 a[156:159],v13 offset:36864
v_mfma_f32_16x16x32_bf16 v[164:167],a[204:207],v[92:95],v[164:167]
s_add_u32 s72,s78,8192
v_exp_f32 v105,v105
v_mfma_f32_16x16x32_bf16 v[168:171],a[208:211],v[88:91],v[168:171]
ds_read_b128 a[160:163],v10 offset:40960
v_cvt_pk_bf16_f32 v84,v104,v105
v_mfma_f32_16x16x32_bf16 v[168:171],a[212:215],v[92:95],v[168:171]
buffer_store_dwordx4 a[24:27],v3,s[28:31],s72 offen offset:1024 sc1
v_exp_f32 v106,v106
v_mfma_f32_16x16x32_bf16 v[172:175],a[216:219],v[88:91],v[172:175]
ds_read_b128 a[164:167],v11 offset:40960
v_mfma_f32_16x16x32_bf16 v[172:175],a[220:223],v[92:95],v[172:175]
v_exp_f32 v107,v107
v_mfma_f32_16x16x32_bf16 v[176:179],a[224:227],v[88:91],v[176:179]
ds_read_b128 a[168:171],v12 offset:40960
v_cvt_pk_bf16_f32 v85,v106,v107
v_mfma_f32_16x16x32_bf16 v[176:179],a[228:231],v[92:95],v[176:179]
v_exp_f32 v108,v108
v_mfma_f32_16x16x32_bf16 v[180:183],a[232:235],v[88:91],v[180:183]
ds_read_b128 a[172:175],v13 offset:40960
v_mfma_f32_16x16x32_bf16 v[180:183],a[236:239],v[92:95],v[180:183]
v_exp_f32 v109,v109
v_mfma_f32_16x16x32_bf16 v[184:187],a[240:243],v[88:91],v[184:187]
ds_read_b128 a[176:179],v10 offset:45056
v_cvt_pk_bf16_f32 v86,v108,v109
v_mfma_f32_16x16x32_bf16 v[184:187],a[244:247],v[92:95],v[184:187]
v_exp_f32 v110,v110
v_mfma_f32_16x16x32_bf16 v[188:191],a[248:251],v[88:91],v[188:191]
ds_read_b128 a[180:183],v11 offset:45056
v_mfma_f32_16x16x32_bf16 v[188:191],a[252:255],v[92:95],v[188:191]
v_exp_f32 v111,v111
v_mfma_f32_16x16x32_bf16 v[52:55],v[44:47],v[88:91],v[52:55]
ds_read_b128 a[184:187],v12 offset:45056
v_cvt_pk_bf16_f32 v87,v110,v111
v_mfma_f32_16x16x32_bf16 v[52:55],v[44:47],v[92:95],v[52:55]
ds_read_b128 a[188:191],v13 offset:45056
v_mfma_f32_16x16x32_bf16 v[192:195],a[192:195],v[80:83],v[192:195]
s_add_u32 s72,s78,8192
v_mfma_f32_16x16x32_bf16 v[192:195],a[196:199],v[84:87],v[192:195]
buffer_store_dwordx4 a[40:43],v3,s[28:31],s72 offen offset:2048 sc1
v_exp_f32 v112,v112
v_mfma_f32_16x16x32_bf16 v[196:199],a[200:203],v[80:83],v[196:199]
s_add_u32 m0,s65,0
v_mfma_f32_16x16x32_bf16 v[196:199],a[204:207],v[84:87],v[196:199]
s_add_u32 s41,s74,0
v_exp_f32 v113,v113
v_mfma_f32_16x16x32_bf16 v[200:203],a[208:211],v[80:83],v[200:203]
buffer_load_dwordx4 v1,s[20:23],s41 offen lds
v_cvt_pk_bf16_f32 v88,v112,v113
v_mfma_f32_16x16x32_bf16 v[200:203],a[212:215],v[84:87],v[200:203]
buffer_load_dwordx4 v2,s[20:23],s41 offen offset:1024 lds
v_exp_f32 v114,v114
v_mfma_f32_16x16x32_bf16 v[204:207],a[216:219],v[80:83],v[204:207]
buffer_load_dwordx4 v22,s[20:23],s41 offen offset:2048 lds
v_mfma_f32_16x16x32_bf16 v[204:207],a[220:223],v[84:87],v[204:207]
buffer_load_dwordx4 v29,s[20:23],s41 offen offset:3072 lds
v_exp_f32 v115,v115
v_mfma_f32_16x16x32_bf16 v[208:211],a[224:227],v[80:83],v[208:211]
v_cvt_pk_bf16_f32 v89,v114,v115
v_mfma_f32_16x16x32_bf16 v[208:211],a[228:231],v[84:87],v[208:211]
v_exp_f32 v116,v116
v_mfma_f32_16x16x32_bf16 v[212:215],a[232:235],v[80:83],v[212:215]
v_mfma_f32_16x16x32_bf16 v[212:215],a[236:239],v[84:87],v[212:215]
v_exp_f32 v117,v117
v_mfma_f32_16x16x32_bf16 v[216:219],a[240:243],v[80:83],v[216:219]
v_cvt_pk_bf16_f32 v90,v116,v117
v_mfma_f32_16x16x32_bf16 v[216:219],a[244:247],v[84:87],v[216:219]
v_exp_f32 v118,v118
v_mfma_f32_16x16x32_bf16 v[220:223],a[248:251],v[80:83],v[220:223]
s_waitcnt lgkmcnt(0)
s_add_u32 m0,s65,4096
v_mfma_f32_16x16x32_bf16 v[220:223],a[252:255],v[84:87],v[220:223]
s_add_u32 s41,s74,0
v_exp_f32 v119,v119
v_mfma_f32_16x16x32_bf16 v[56:59],v[44:47],v[80:83],v[56:59]
buffer_load_dwordx4 v42,s[20:23],s41 offen lds
v_cvt_pk_bf16_f32 v91,v118,v119
v_mfma_f32_16x16x32_bf16 v[56:59],v[44:47],v[84:87],v[56:59]
buffer_load_dwordx4 v37,s[20:23],s41 offen offset:1024 lds
v_exp_f32 v120,v120
v_mfma_f32_16x16x32_bf16 v[96:99],a[128:131],a[64:67],v[64:67]
buffer_load_dwordx4 v38,s[20:23],s41 offen offset:2048 lds
v_mfma_f32_16x16x32_bf16 v[96:99],a[132:135],a[68:71],v[96:99]
buffer_load_dwordx4 v39,s[20:23],s41 offen offset:3072 lds
v_exp_f32 v121,v121
v_mfma_f32_16x16x32_bf16 v[96:99],a[136:139],a[72:75],v[96:99]
s_add_u32 s72,s78,8192
v_cvt_pk_bf16_f32 v92,v120,v121
v_mfma_f32_16x16x32_bf16 v[96:99],a[140:143],a[76:79],v[96:99]
buffer_store_dwordx4 a[56:59],v3,s[28:31],s72 offen offset:3072 sc1
v_exp_f32 v122,v122
v_mfma_f32_16x16x32_bf16 v[100:103],a[144:147],a[64:67],v[64:67]
v_mfma_f32_16x16x32_bf16 v[100:103],a[148:151],a[68:71],v[100:103]
v_exp_f32 v123,v123
v_mfma_f32_16x16x32_bf16 v[100:103],a[152:155],a[72:75],v[100:103]
v_cvt_pk_bf16_f32 v93,v122,v123
v_mfma_f32_16x16x32_bf16 v[100:103],a[156:159],a[76:79],v[100:103]
v_exp_f32 v124,v124
v_mfma_f32_16x16x32_bf16 v[104:107],a[160:163],a[64:67],v[64:67]
s_add_u32 m0,s65,8192
v_mfma_f32_16x16x32_bf16 v[104:107],a[164:167],a[68:71],v[104:107]
s_add_u32 s41,s74,0
v_exp_f32 v125,v125
v_mfma_f32_16x16x32_bf16 v[104:107],a[168:171],a[72:75],v[104:107]
buffer_load_dwordx4 v40,s[20:23],s41 offen lds
v_cvt_pk_bf16_f32 v94,v124,v125
v_mfma_f32_16x16x32_bf16 v[104:107],a[172:175],a[76:79],v[104:107]
v_exp_f32 v126,v126
v_mfma_f32_16x16x32_bf16 v[108:111],a[176:179],a[64:67],v[64:67]
s_add_u32 s72,s78,12288
v_mfma_f32_16x16x32_bf16 v[108:111],a[180:183],a[68:71],v[108:111]
buffer_store_dwordx4 a[12:15],v3,s[28:31],s72 offen sc1
v_exp_f32 v127,v127
v_mfma_f32_16x16x32_bf16 v[108:111],a[184:187],a[72:75],v[108:111]
v_cvt_pk_bf16_f32 v95,v126,v127
v_mfma_f32_16x16x32_bf16 v[108:111],a[188:191],a[76:79],v[108:111]
v_mfma_f32_16x16x32_bf16 v[224:227],a[192:195],v[88:91],v[224:227]
v_mfma_f32_16x16x32_bf16 v[224:227],a[196:199],v[92:95],v[224:227]
v_exp_f32 v96,v96
v_mfma_f32_16x16x32_bf16 v[228:231],a[200:203],v[88:91],v[228:231]
ds_read_b64_tr_b16 a[192:193],v14 offset:32768
ds_read_b64_tr_b16 a[194:195],v14 offset:36864
v_mfma_f32_16x16x32_bf16 v[228:231],a[204:207],v[92:95],v[228:231]
v_exp_f32 v97,v97
v_mfma_f32_16x16x32_bf16 v[232:235],a[208:211],v[88:91],v[232:235]
ds_read_b64_tr_b16 a[196:197],v14 offset:40960
v_cvt_pk_bf16_f32 v80,v96,v97
v_mfma_f32_16x16x32_bf16 v[232:235],a[212:215],v[92:95],v[232:235]
v_exp_f32 v98,v98
v_mfma_f32_16x16x32_bf16 v[236:239],a[216:219],v[88:91],v[236:239]
ds_read_b64_tr_b16 a[198:199],v14 offset:45056
ds_read_b64_tr_b16 a[200:201],v15 offset:32768
v_mfma_f32_16x16x32_bf16 v[236:239],a[220:223],v[92:95],v[236:239]
v_exp_f32 v99,v99
v_mfma_f32_16x16x32_bf16 v[240:243],a[224:227],v[88:91],v[240:243]
ds_read_b64_tr_b16 a[202:203],v15 offset:36864
v_cvt_pk_bf16_f32 v81,v98,v99
v_mfma_f32_16x16x32_bf16 v[240:243],a[228:231],v[92:95],v[240:243]
v_exp_f32 v100,v100
v_mfma_f32_16x16x32_bf16 v[244:247],a[232:235],v[88:91],v[244:247]
ds_read_b64_tr_b16 a[204:205],v15 offset:40960
ds_read_b64_tr_b16 a[206:207],v15 offset:45056
v_mfma_f32_16x16x32_bf16 v[244:247],a[236:239],v[92:95],v[244:247]
s_add_u32 s72,s78,12288
v_exp_f32 v101,v101
v_mfma_f32_16x16x32_bf16 v[248:251],a[240:243],v[88:91],v[248:251]
ds_read_b64_tr_b16 a[208:209],v16 offset:32768
v_cvt_pk_bf16_f32 v82,v100,v101
v_mfma_f32_16x16x32_bf16 v[248:251],a[244:247],v[92:95],v[248:251]
buffer_store_dwordx4 a[28:31],v3,s[28:31],s72 offen offset:1024 sc1
v_exp_f32 v102,v102
v_mfma_f32_16x16x32_bf16 v[252:255],a[248:251],v[88:91],v[252:255]
ds_read_b64_tr_b16 a[210:211],v16 offset:36864
ds_read_b64_tr_b16 a[212:213],v16 offset:40960
v_mfma_f32_16x16x32_bf16 v[252:255],a[252:255],v[92:95],v[252:255]
v_exp_f32 v103,v103
v_mfma_f32_16x16x32_bf16 v[60:63],v[44:47],v[88:91],v[60:63]
ds_read_b64_tr_b16 a[214:215],v16 offset:45056
v_cvt_pk_bf16_f32 v83,v102,v103
v_mfma_f32_16x16x32_bf16 v[60:63],v[44:47],v[92:95],v[60:63]
v_exp_f32 v104,v104
v_mfma_f32_16x16x32_bf16 v[112:115],a[128:131],a[80:83],v[68:71]
ds_read_b64_tr_b16 a[216:217],v17 offset:32768
ds_read_b64_tr_b16 a[218:219],v17 offset:36864
v_mfma_f32_16x16x32_bf16 v[112:115],a[132:135],a[84:87],v[112:115]
v_exp_f32 v105,v105
v_mfma_f32_16x16x32_bf16 v[112:115],a[136:139],a[88:91],v[112:115]
ds_read_b64_tr_b16 a[220:221],v17 offset:40960
v_cvt_pk_bf16_f32 v84,v104,v105
v_mfma_f32_16x16x32_bf16 v[112:115],a[140:143],a[92:95],v[112:115]
v_exp_f32 v106,v106
v_mfma_f32_16x16x32_bf16 v[116:119],a[144:147],a[80:83],v[68:71]
ds_read_b64_tr_b16 a[222:223],v17 offset:45056
ds_read_b64_tr_b16 a[224:225],v18 offset:32768
v_mfma_f32_16x16x32_bf16 v[116:119],a[148:151],a[84:87],v[116:119]
v_exp_f32 v107,v107
v_mfma_f32_16x16x32_bf16 v[116:119],a[152:155],a[88:91],v[116:119]
ds_read_b64_tr_b16 a[226:227],v18 offset:36864
v_cvt_pk_bf16_f32 v85,v106,v107
v_mfma_f32_16x16x32_bf16 v[116:119],a[156:159],a[92:95],v[116:119]
v_exp_f32 v108,v108
v_mfma_f32_16x16x32_bf16 v[120:123],a[160:163],a[80:83],v[68:71]
ds_read_b64_tr_b16 a[228:229],v18 offset:40960
ds_read_b64_tr_b16 a[230:231],v18 offset:45056
s_add_u32 s72,s78,12288
v_mfma_f32_16x16x32_bf16 v[120:123],a[164:167],a[84:87],v[120:123]
buffer_store_dwordx4 a[44:47],v3,s[28:31],s72 offen offset:2048 sc1
v_exp_f32 v109,v109
v_mfma_f32_16x16x32_bf16 v[120:123],a[168:171],a[88:91],v[120:123]
ds_read_b64_tr_b16 a[232:233],v19 offset:32768
v_cvt_pk_bf16_f32 v86,v108,v109
v_mfma_f32_16x16x32_bf16 v[120:123],a[172:175],a[92:95],v[120:123]
v_exp_f32 v110,v110
v_mfma_f32_16x16x32_bf16 v[124:127],a[176:179],a[80:83],v[68:71]
ds_read_b64_tr_b16 a[234:235],v19 offset:36864
ds_read_b64_tr_b16 a[236:237],v19 offset:40960
v_mfma_f32_16x16x32_bf16 v[124:127],a[180:183],a[84:87],v[124:127]
v_exp_f32 v111,v111
v_mfma_f32_16x16x32_bf16 v[124:127],a[184:187],a[88:91],v[124:127]
ds_read_b64_tr_b16 a[238:239],v19 offset:45056
v_cvt_pk_bf16_f32 v87,v110,v111
v_mfma_f32_16x16x32_bf16 v[124:127],a[188:191],a[92:95],v[124:127]
ds_read_b64_tr_b16 a[240:241],v20 offset:32768
ds_read_b64_tr_b16 a[242:243],v20 offset:36864
v_mfma_f32_16x16x32_bf16 v[96:99],a[128:131],a[96:99],v[72:75]
ds_read_b64_tr_b16 a[244:245],v20 offset:40960
ds_read_b64_tr_b16 a[246:247],v20 offset:45056
v_mfma_f32_16x16x32_bf16 v[96:99],a[132:135],a[100:103],v[96:99]
v_exp_f32 v112,v112
v_mfma_f32_16x16x32_bf16 v[96:99],a[136:139],a[104:107],v[96:99]
ds_read_b64_tr_b16 a[248:249],v21 offset:32768
ds_read_b64_tr_b16 a[250:251],v21 offset:36864
v_mfma_f32_16x16x32_bf16 v[96:99],a[140:143],a[108:111],v[96:99]
v_exp_f32 v113,v113
v_mfma_f32_16x16x32_bf16 v[100:103],a[144:147],a[96:99],v[72:75]
ds_read_b64_tr_b16 a[252:253],v21 offset:40960
v_cvt_pk_bf16_f32 v88,v112,v113
v_mfma_f32_16x16x32_bf16 v[100:103],a[148:151],a[100:103],v[100:103]
v_exp_f32 v114,v114
v_mfma_f32_16x16x32_bf16 v[100:103],a[152:155],a[104:107],v[100:103]
ds_read_b64_tr_b16 a[254:255],v21 offset:45056
v_mfma_f32_16x16x32_bf16 v[100:103],a[156:159],a[108:111],v[100:103]
s_add_u32 s72,s78,12288
v_exp_f32 v115,v115
v_mfma_f32_16x16x32_bf16 v[104:107],a[160:163],a[96:99],v[72:75]
buffer_store_dwordx4 a[60:63],v3,s[28:31],s72 offen offset:3072 sc1
v_cvt_pk_bf16_f32 v89,v114,v115
v_mfma_f32_16x16x32_bf16 v[104:107],a[164:167],a[100:103],v[104:107]
v_exp_f32 v116,v116
v_mfma_f32_16x16x32_bf16 v[104:107],a[168:171],a[104:107],v[104:107]
v_mfma_f32_16x16x32_bf16 v[104:107],a[172:175],a[108:111],v[104:107]
v_exp_f32 v117,v117
v_mfma_f32_16x16x32_bf16 v[108:111],a[176:179],a[96:99],v[72:75]
v_cvt_pk_bf16_f32 v90,v116,v117
v_mfma_f32_16x16x32_bf16 v[108:111],a[180:183],a[100:103],v[108:111]
v_exp_f32 v118,v118
v_mfma_f32_16x16x32_bf16 v[108:111],a[184:187],a[104:107],v[108:111]
s_waitcnt lgkmcnt(0)
v_mfma_f32_16x16x32_bf16 v[108:111],a[188:191],a[108:111],v[108:111]
v_exp_f32 v119,v119
v_mfma_f32_16x16x32_bf16 v[128:131],a[192:195],v[80:83],v[128:131]
v_cvt_pk_bf16_f32 v91,v118,v119
v_mfma_f32_16x16x32_bf16 v[128:131],a[196:199],v[84:87],v[128:131]
v_exp_f32 v120,v120
v_mfma_f32_16x16x32_bf16 v[132:135],a[200:203],v[80:83],v[132:135]
v_mfma_f32_16x16x32_bf16 v[132:135],a[204:207],v[84:87],v[132:135]
v_exp_f32 v121,v121
v_mfma_f32_16x16x32_bf16 v[136:139],a[208:211],v[80:83],v[136:139]
v_cvt_pk_bf16_f32 v92,v120,v121
v_mfma_f32_16x16x32_bf16 v[136:139],a[212:215],v[84:87],v[136:139]
v_exp_f32 v122,v122
v_mfma_f32_16x16x32_bf16 v[140:143],a[216:219],v[80:83],v[140:143]
v_mfma_f32_16x16x32_bf16 v[140:143],a[220:223],v[84:87],v[140:143]
v_exp_f32 v123,v123
v_mfma_f32_16x16x32_bf16 v[144:147],a[224:227],v[80:83],v[144:147]
v_cvt_pk_bf16_f32 v93,v122,v123
v_mfma_f32_16x16x32_bf16 v[144:147],a[228:231],v[84:87],v[144:147]
v_exp_f32 v124,v124
v_mfma_f32_16x16x32_bf16 v[148:151],a[232:235],v[80:83],v[148:151]
v_mfma_f32_16x16x32_bf16 v[148:151],a[236:239],v[84:87],v[148:151]
v_exp_f32 v125,v125
v_mfma_f32_16x16x32_bf16 v[152:155],a[240:243],v[80:83],v[152:155]
v_cvt_pk_bf16_f32 v94,v124,v125
v_mfma_f32_16x16x32_bf16 v[152:155],a[244:247],v[84:87],v[152:155]
v_exp_f32 v126,v126
v_mfma_f32_16x16x32_bf16 v[156:159],a[248:251],v[80:83],v[156:159]
v_mfma_f32_16x16x32_bf16 v[156:159],a[252:255],v[84:87],v[156:159]
v_exp_f32 v127,v127
v_mfma_f32_16x16x32_bf16 v[48:51],v[44:47],v[80:83],v[48:51]
v_cvt_pk_bf16_f32 v95,v126,v127
v_mfma_f32_16x16x32_bf16 v[48:51],v[44:47],v[84:87],v[48:51]
s_waitcnt vmcnt(21)
s_barrier
v_mfma_f32_16x16x32_bf16 v[112:115],a[128:131],a[112:115],v[76:79]
v_mfma_f32_16x16x32_bf16 v[112:115],a[132:135],a[116:119],v[112:115]
v_exp_f32 v96,v96
v_mfma_f32_16x16x32_bf16 v[112:115],a[136:139],a[120:123],v[112:115]
v_mfma_f32_16x16x32_bf16 v[112:115],a[140:143],a[124:127],v[112:115]
v_exp_f32 v97,v97
v_mfma_f32_16x16x32_bf16 v[116:119],a[144:147],a[112:115],v[76:79]
ds_read_b128 a[128:131],v10 offset:49152
v_cvt_pk_bf16_f32 v80,v96,v97
v_mfma_f32_16x16x32_bf16 v[116:119],a[148:151],a[116:119],v[116:119]
v_exp_f32 v98,v98
v_mfma_f32_16x16x32_bf16 v[116:119],a[152:155],a[120:123],v[116:119]
ds_read_b128 a[132:135],v11 offset:49152
v_mfma_f32_16x16x32_bf16 v[116:119],a[156:159],a[124:127],v[116:119]
v_exp_f32 v99,v99
v_mfma_f32_16x16x32_bf16 v[120:123],a[160:163],a[112:115],v[76:79]
ds_read_b128 a[136:139],v12 offset:49152
v_cvt_pk_bf16_f32 v81,v98,v99
v_mfma_f32_16x16x32_bf16 v[120:123],a[164:167],a[116:119],v[120:123]
v_exp_f32 v100,v100
v_mfma_f32_16x16x32_bf16 v[120:123],a[168:171],a[120:123],v[120:123]
ds_read_b128 a[140:143],v13 offset:49152
v_mfma_f32_16x16x32_bf16 v[120:123],a[172:175],a[124:127],v[120:123]
v_exp_f32 v101,v101
v_mfma_f32_16x16x32_bf16 v[124:127],a[176:179],a[112:115],v[76:79]
ds_read_b128 a[144:147],v10 offset:53248
v_cvt_pk_bf16_f32 v82,v100,v101
v_mfma_f32_16x16x32_bf16 v[124:127],a[180:183],a[116:119],v[124:127]
v_exp_f32 v102,v102
v_mfma_f32_16x16x32_bf16 v[124:127],a[184:187],a[120:123],v[124:127]
ds_read_b128 a[148:151],v11 offset:53248
v_mfma_f32_16x16x32_bf16 v[124:127],a[188:191],a[124:127],v[124:127]
v_exp_f32 v103,v103
v_mfma_f32_16x16x32_bf16 v[160:163],a[192:195],v[88:91],v[160:163]
ds_read_b128 a[152:155],v12 offset:53248
v_cvt_pk_bf16_f32 v83,v102,v103
v_mfma_f32_16x16x32_bf16 v[160:163],a[196:199],v[92:95],v[160:163]
v_exp_f32 v104,v104
v_mfma_f32_16x16x32_bf16 v[164:167],a[200:203],v[88:91],v[164:167]
ds_read_b128 a[156:159],v13 offset:53248
v_mfma_f32_16x16x32_bf16 v[164:167],a[204:207],v[92:95],v[164:167]
v_exp_f32 v105,v105
v_mfma_f32_16x16x32_bf16 v[168:171],a[208:211],v[88:91],v[168:171]
ds_read_b128 a[160:163],v10 offset:57344
v_cvt_pk_bf16_f32 v84,v104,v105
v_mfma_f32_16x16x32_bf16 v[168:171],a[212:215],v[92:95],v[168:171]
v_exp_f32 v106,v106
v_mfma_f32_16x16x32_bf16 v[172:175],a[216:219],v[88:91],v[172:175]
ds_read_b128 a[164:167],v11 offset:57344
v_mfma_f32_16x16x32_bf16 v[172:175],a[220:223],v[92:95],v[172:175]
v_exp_f32 v107,v107
v_mfma_f32_16x16x32_bf16 v[176:179],a[224:227],v[88:91],v[176:179]
ds_read_b128 a[168:171],v12 offset:57344
v_cvt_pk_bf16_f32 v85,v106,v107
v_mfma_f32_16x16x32_bf16 v[176:179],a[228:231],v[92:95],v[176:179]
v_exp_f32 v108,v108
v_mfma_f32_16x16x32_bf16 v[180:183],a[232:235],v[88:91],v[180:183]
ds_read_b128 a[172:175],v13 offset:57344
v_mfma_f32_16x16x32_bf16 v[180:183],a[236:239],v[92:95],v[180:183]
v_exp_f32 v109,v109
v_mfma_f32_16x16x32_bf16 v[184:187],a[240:243],v[88:91],v[184:187]
ds_read_b128 a[176:179],v10 offset:61440
v_cvt_pk_bf16_f32 v86,v108,v109
v_mfma_f32_16x16x32_bf16 v[184:187],a[244:247],v[92:95],v[184:187]
v_exp_f32 v110,v110
v_mfma_f32_16x16x32_bf16 v[188:191],a[248:251],v[88:91],v[188:191]
ds_read_b128 a[180:183],v11 offset:61440
v_mfma_f32_16x16x32_bf16 v[188:191],a[252:255],v[92:95],v[188:191]
v_exp_f32 v111,v111
v_mfma_f32_16x16x32_bf16 v[52:55],v[44:47],v[88:91],v[52:55]
ds_read_b128 a[184:187],v12 offset:61440
v_cvt_pk_bf16_f32 v87,v110,v111
v_mfma_f32_16x16x32_bf16 v[52:55],v[44:47],v[92:95],v[52:55]
ds_read_b128 a[188:191],v13 offset:61440
v_mfma_f32_16x16x32_bf16 v[192:195],a[192:195],v[80:83],v[192:195]
v_mfma_f32_16x16x32_bf16 v[192:195],a[196:199],v[84:87],v[192:195]
v_exp_f32 v112,v112
v_mfma_f32_16x16x32_bf16 v[196:199],a[200:203],v[80:83],v[196:199]
s_add_u32 m0,s65,18432
v_mfma_f32_16x16x32_bf16 v[196:199],a[204:207],v[84:87],v[196:199]
s_add_u32 s41,s74,147456
v_exp_f32 v113,v113
v_mfma_f32_16x16x32_bf16 v[200:203],a[208:211],v[80:83],v[200:203]
buffer_load_dwordx4 v1,s[20:23],s41 offen lds
v_cvt_pk_bf16_f32 v88,v112,v113
v_mfma_f32_16x16x32_bf16 v[200:203],a[212:215],v[84:87],v[200:203]
buffer_load_dwordx4 v2,s[20:23],s41 offen offset:1024 lds
v_exp_f32 v114,v114
v_mfma_f32_16x16x32_bf16 v[204:207],a[216:219],v[80:83],v[204:207]
buffer_load_dwordx4 v22,s[20:23],s41 offen offset:2048 lds
v_mfma_f32_16x16x32_bf16 v[204:207],a[220:223],v[84:87],v[204:207]
buffer_load_dwordx4 v29,s[20:23],s41 offen offset:3072 lds
v_exp_f32 v115,v115
v_mfma_f32_16x16x32_bf16 v[208:211],a[224:227],v[80:83],v[208:211]
v_cvt_pk_bf16_f32 v89,v114,v115
v_mfma_f32_16x16x32_bf16 v[208:211],a[228:231],v[84:87],v[208:211]
v_exp_f32 v116,v116
v_mfma_f32_16x16x32_bf16 v[212:215],a[232:235],v[80:83],v[212:215]
v_mfma_f32_16x16x32_bf16 v[212:215],a[236:239],v[84:87],v[212:215]
v_exp_f32 v117,v117
v_mfma_f32_16x16x32_bf16 v[216:219],a[240:243],v[80:83],v[216:219]
v_cvt_pk_bf16_f32 v90,v116,v117
v_mfma_f32_16x16x32_bf16 v[216:219],a[244:247],v[84:87],v[216:219]
v_exp_f32 v118,v118
v_mfma_f32_16x16x32_bf16 v[220:223],a[248:251],v[80:83],v[220:223]
s_waitcnt lgkmcnt(0)
s_add_u32 m0,s65,22528
v_mfma_f32_16x16x32_bf16 v[220:223],a[252:255],v[84:87],v[220:223]
s_add_u32 s41,s74,147456
v_exp_f32 v119,v119
v_mfma_f32_16x16x32_bf16 v[56:59],v[44:47],v[80:83],v[56:59]
buffer_load_dwordx4 v42,s[20:23],s41 offen lds
v_cvt_pk_bf16_f32 v91,v118,v119
v_mfma_f32_16x16x32_bf16 v[56:59],v[44:47],v[84:87],v[56:59]
buffer_load_dwordx4 v37,s[20:23],s41 offen offset:1024 lds
v_exp_f32 v120,v120
v_mfma_f32_16x16x32_bf16 v[96:99],a[128:131],a[64:67],v[64:67]
buffer_load_dwordx4 v38,s[20:23],s41 offen offset:2048 lds
v_mfma_f32_16x16x32_bf16 v[96:99],a[132:135],a[68:71],v[96:99]
buffer_load_dwordx4 v39,s[20:23],s41 offen offset:3072 lds
v_exp_f32 v121,v121
v_mfma_f32_16x16x32_bf16 v[96:99],a[136:139],a[72:75],v[96:99]
v_cvt_pk_bf16_f32 v92,v120,v121
v_mfma_f32_16x16x32_bf16 v[96:99],a[140:143],a[76:79],v[96:99]
v_exp_f32 v122,v122
v_mfma_f32_16x16x32_bf16 v[100:103],a[144:147],a[64:67],v[64:67]
v_mfma_f32_16x16x32_bf16 v[100:103],a[148:151],a[68:71],v[100:103]
v_exp_f32 v123,v123
v_mfma_f32_16x16x32_bf16 v[100:103],a[152:155],a[72:75],v[100:103]
v_cvt_pk_bf16_f32 v93,v122,v123
v_mfma_f32_16x16x32_bf16 v[100:103],a[156:159],a[76:79],v[100:103]
v_exp_f32 v124,v124
v_mfma_f32_16x16x32_bf16 v[104:107],a[160:163],a[64:67],v[64:67]
s_add_u32 m0,s65,26624
v_mfma_f32_16x16x32_bf16 v[104:107],a[164:167],a[68:71],v[104:107]
s_add_u32 s41,s74,147456
v_exp_f32 v125,v125
v_mfma_f32_16x16x32_bf16 v[104:107],a[168:171],a[72:75],v[104:107]
buffer_load_dwordx4 v40,s[20:23],s41 offen lds
v_cvt_pk_bf16_f32 v94,v124,v125
v_mfma_f32_16x16x32_bf16 v[104:107],a[172:175],a[76:79],v[104:107]
v_exp_f32 v126,v126
v_mfma_f32_16x16x32_bf16 v[108:111],a[176:179],a[64:67],v[64:67]
v_mfma_f32_16x16x32_bf16 v[108:111],a[180:183],a[68:71],v[108:111]
v_exp_f32 v127,v127
v_mfma_f32_16x16x32_bf16 v[108:111],a[184:187],a[72:75],v[108:111]
v_cvt_pk_bf16_f32 v95,v126,v127
v_mfma_f32_16x16x32_bf16 v[108:111],a[188:191],a[76:79],v[108:111]
v_mfma_f32_16x16x32_bf16 v[224:227],a[192:195],v[88:91],v[224:227]
v_mfma_f32_16x16x32_bf16 v[224:227],a[196:199],v[92:95],v[224:227]
v_exp_f32 v96,v96
v_mfma_f32_16x16x32_bf16 v[228:231],a[200:203],v[88:91],v[228:231]
ds_read_b64_tr_b16 a[192:193],v14 offset:49152
ds_read_b64_tr_b16 a[194:195],v14 offset:53248
s_waitcnt vmcnt(9)
buffer_atomic_add v26,v25,s[32:35],s69 offen sc1
s_add_u32 s69,s69,0x10000
v_mfma_f32_16x16x32_bf16 v[228:231],a[204:207],v[92:95],v[228:231]
v_exp_f32 v97,v97
v_mfma_f32_16x16x32_bf16 v[232:235],a[208:211],v[88:91],v[232:235]
ds_read_b64_tr_b16 a[196:197],v14 offset:57344
v_cvt_pk_bf16_f32 v80,v96,v97
v_mfma_f32_16x16x32_bf16 v[232:235],a[212:215],v[92:95],v[232:235]
v_exp_f32 v98,v98
v_mfma_f32_16x16x32_bf16 v[236:239],a[216:219],v[88:91],v[236:239]
ds_read_b64_tr_b16 a[198:199],v14 offset:61440
ds_read_b64_tr_b16 a[200:201],v15 offset:49152
v_mfma_f32_16x16x32_bf16 v[236:239],a[220:223],v[92:95],v[236:239]
v_exp_f32 v99,v99
v_mfma_f32_16x16x32_bf16 v[240:243],a[224:227],v[88:91],v[240:243]
ds_read_b64_tr_b16 a[202:203],v15 offset:53248
v_cvt_pk_bf16_f32 v81,v98,v99
v_mfma_f32_16x16x32_bf16 v[240:243],a[228:231],v[92:95],v[240:243]
v_exp_f32 v100,v100
v_mfma_f32_16x16x32_bf16 v[244:247],a[232:235],v[88:91],v[244:247]
ds_read_b64_tr_b16 a[204:205],v15 offset:57344
ds_read_b64_tr_b16 a[206:207],v15 offset:61440
v_mfma_f32_16x16x32_bf16 v[244:247],a[236:239],v[92:95],v[244:247]
v_exp_f32 v101,v101
v_mfma_f32_16x16x32_bf16 v[248:251],a[240:243],v[88:91],v[248:251]
ds_read_b64_tr_b16 a[208:209],v16 offset:49152
v_cvt_pk_bf16_f32 v82,v100,v101
v_mfma_f32_16x16x32_bf16 v[248:251],a[244:247],v[92:95],v[248:251]
v_exp_f32 v102,v102
v_mfma_f32_16x16x32_bf16 v[252:255],a[248:251],v[88:91],v[252:255]
ds_read_b64_tr_b16 a[210:211],v16 offset:53248
ds_read_b64_tr_b16 a[212:213],v16 offset:57344
v_mfma_f32_16x16x32_bf16 v[252:255],a[252:255],v[92:95],v[252:255]
v_exp_f32 v103,v103
v_mfma_f32_16x16x32_bf16 v[60:63],v[44:47],v[88:91],v[60:63]
ds_read_b64_tr_b16 a[214:215],v16 offset:61440
v_cvt_pk_bf16_f32 v83,v102,v103
v_mfma_f32_16x16x32_bf16 v[60:63],v[44:47],v[92:95],v[60:63]
v_exp_f32 v104,v104
v_mfma_f32_16x16x32_bf16 v[112:115],a[128:131],a[80:83],v[68:71]
ds_read_b64_tr_b16 a[216:217],v17 offset:49152
ds_read_b64_tr_b16 a[218:219],v17 offset:53248
v_mfma_f32_16x16x32_bf16 v[112:115],a[132:135],a[84:87],v[112:115]
v_exp_f32 v105,v105
v_mfma_f32_16x16x32_bf16 v[112:115],a[136:139],a[88:91],v[112:115]
ds_read_b64_tr_b16 a[220:221],v17 offset:57344
v_cvt_pk_bf16_f32 v84,v104,v105
v_mfma_f32_16x16x32_bf16 v[112:115],a[140:143],a[92:95],v[112:115]
v_exp_f32 v106,v106
v_mfma_f32_16x16x32_bf16 v[116:119],a[144:147],a[80:83],v[68:71]
ds_read_b64_tr_b16 a[222:223],v17 offset:61440
ds_read_b64_tr_b16 a[224:225],v18 offset:49152
v_mfma_f32_16x16x32_bf16 v[116:119],a[148:151],a[84:87],v[116:119]
v_exp_f32 v107,v107
v_mfma_f32_16x16x32_bf16 v[116:119],a[152:155],a[88:91],v[116:119]
ds_read_b64_tr_b16 a[226:227],v18 offset:53248
v_cvt_pk_bf16_f32 v85,v106,v107
v_mfma_f32_16x16x32_bf16 v[116:119],a[156:159],a[92:95],v[116:119]
v_exp_f32 v108,v108
v_mfma_f32_16x16x32_bf16 v[120:123],a[160:163],a[80:83],v[68:71]
ds_read_b64_tr_b16 a[228:229],v18 offset:57344
ds_read_b64_tr_b16 a[230:231],v18 offset:61440
v_mfma_f32_16x16x32_bf16 v[120:123],a[164:167],a[84:87],v[120:123]
v_exp_f32 v109,v109
v_mfma_f32_16x16x32_bf16 v[120:123],a[168:171],a[88:91],v[120:123]
ds_read_b64_tr_b16 a[232:233],v19 offset:49152
v_cvt_pk_bf16_f32 v86,v108,v109
v_mfma_f32_16x16x32_bf16 v[120:123],a[172:175],a[92:95],v[120:123]
v_exp_f32 v110,v110
v_mfma_f32_16x16x32_bf16 v[124:127],a[176:179],a[80:83],v[68:71]
ds_read_b64_tr_b16 a[234:235],v19 offset:53248
ds_read_b64_tr_b16 a[236:237],v19 offset:57344
v_mfma_f32_16x16x32_bf16 v[124:127],a[180:183],a[84:87],v[124:127]
v_exp_f32 v111,v111
v_mfma_f32_16x16x32_bf16 v[124:127],a[184:187],a[88:91],v[124:127]
ds_read_b64_tr_b16 a[238:239],v19 offset:61440
v_cvt_pk_bf16_f32 v87,v110,v111
v_mfma_f32_16x16x32_bf16 v[124:127],a[188:191],a[92:95],v[124:127]
ds_read_b64_tr_b16 a[240:241],v20 offset:49152
ds_read_b64_tr_b16 a[242:243],v20 offset:53248
v_mfma_f32_16x16x32_bf16 v[96:99],a[128:131],a[96:99],v[72:75]
ds_read_b64_tr_b16 a[244:245],v20 offset:57344
ds_read_b64_tr_b16 a[246:247],v20 offset:61440
v_mfma_f32_16x16x32_bf16 v[96:99],a[132:135],a[100:103],v[96:99]
v_exp_f32 v112,v112
v_mfma_f32_16x16x32_bf16 v[96:99],a[136:139],a[104:107],v[96:99]
ds_read_b64_tr_b16 a[248:249],v21 offset:49152
ds_read_b64_tr_b16 a[250:251],v21 offset:53248
v_mfma_f32_16x16x32_bf16 v[96:99],a[140:143],a[108:111],v[96:99]
v_exp_f32 v113,v113
v_mfma_f32_16x16x32_bf16 v[100:103],a[144:147],a[96:99],v[72:75]
ds_read_b64_tr_b16 a[252:253],v21 offset:57344
v_cvt_pk_bf16_f32 v88,v112,v113
v_mfma_f32_16x16x32_bf16 v[100:103],a[148:151],a[100:103],v[100:103]
v_exp_f32 v114,v114
v_mfma_f32_16x16x32_bf16 v[100:103],a[152:155],a[104:107],v[100:103]
ds_read_b64_tr_b16 a[254:255],v21 offset:61440
v_mfma_f32_16x16x32_bf16 v[100:103],a[156:159],a[108:111],v[100:103]
v_exp_f32 v115,v115
v_mfma_f32_16x16x32_bf16 v[104:107],a[160:163],a[96:99],v[72:75]
v_cvt_pk_bf16_f32 v89,v114,v115
v_mfma_f32_16x16x32_bf16 v[104:107],a[164:167],a[100:103],v[104:107]
v_exp_f32 v116,v116
v_mfma_f32_16x16x32_bf16 v[104:107],a[168:171],a[104:107],v[104:107]
v_mfma_f32_16x16x32_bf16 v[104:107],a[172:175],a[108:111],v[104:107]
v_exp_f32 v117,v117
v_mfma_f32_16x16x32_bf16 v[108:111],a[176:179],a[96:99],v[72:75]
v_cvt_pk_bf16_f32 v90,v116,v117
v_mfma_f32_16x16x32_bf16 v[108:111],a[180:183],a[100:103],v[108:111]
v_exp_f32 v118,v118
v_mfma_f32_16x16x32_bf16 v[108:111],a[184:187],a[104:107],v[108:111]
s_waitcnt lgkmcnt(0)
v_mfma_f32_16x16x32_bf16 v[108:111],a[188:191],a[108:111],v[108:111]
v_exp_f32 v119,v119
v_mfma_f32_16x16x32_bf16 v[128:131],a[192:195],v[80:83],v[128:131]
v_cvt_pk_bf16_f32 v91,v118,v119
v_mfma_f32_16x16x32_bf16 v[128:131],a[196:199],v[84:87],v[128:131]
v_exp_f32 v120,v120
v_mfma_f32_16x16x32_bf16 v[132:135],a[200:203],v[80:83],v[132:135]
v_mfma_f32_16x16x32_bf16 v[132:135],a[204:207],v[84:87],v[132:135]
v_exp_f32 v121,v121
v_mfma_f32_16x16x32_bf16 v[136:139],a[208:211],v[80:83],v[136:139]
v_cvt_pk_bf16_f32 v92,v120,v121
v_mfma_f32_16x16x32_bf16 v[136:139],a[212:215],v[84:87],v[136:139]
v_exp_f32 v122,v122
v_mfma_f32_16x16x32_bf16 v[140:143],a[216:219],v[80:83],v[140:143]
v_mfma_f32_16x16x32_bf16 v[140:143],a[220:223],v[84:87],v[140:143]
v_exp_f32 v123,v123
v_mfma_f32_16x16x32_bf16 v[144:147],a[224:227],v[80:83],v[144:147]
v_cvt_pk_bf16_f32 v93,v122,v123
v_mfma_f32_16x16x32_bf16 v[144:147],a[228:231],v[84:87],v[144:147]
v_exp_f32 v124,v124
v_mfma_f32_16x16x32_bf16 v[148:151],a[232:235],v[80:83],v[148:151]
v_mfma_f32_16x16x32_bf16 v[148:151],a[236:239],v[84:87],v[148:151]
v_exp_f32 v125,v125
v_mfma_f32_16x16x32_bf16 v[152:155],a[240:243],v[80:83],v[152:155]
v_cvt_pk_bf16_f32 v94,v124,v125
v_mfma_f32_16x16x32_bf16 v[152:155],a[244:247],v[84:87],v[152:155]
v_exp_f32 v126,v126
v_mfma_f32_16x16x32_bf16 v[156:159],a[248:251],v[80:83],v[156:159]
v_mfma_f32_16x16x32_bf16 v[156:159],a[252:255],v[84:87],v[156:159]
v_exp_f32 v127,v127
v_mfma_f32_16x16x32_bf16 v[48:51],v[44:47],v[80:83],v[48:51]
v_cvt_pk_bf16_f32 v95,v126,v127
v_mfma_f32_16x16x32_bf16 v[48:51],v[44:47],v[84:87],v[48:51]
s_barrier
v_mfma_f32_16x16x32_bf16 v[112:115],a[128:131],a[112:115],v[76:79]
s_add_u32 m0,s65,36864
v_mfma_f32_16x16x32_bf16 v[112:115],a[132:135],a[116:119],v[112:115]
s_add_u32 s41,s75,0
v_exp_f32 v96,v96
v_mfma_f32_16x16x32_bf16 v[112:115],a[136:139],a[120:123],v[112:115]
buffer_load_dwordx4 v1,s[20:23],s41 offen lds
v_mfma_f32_16x16x32_bf16 v[112:115],a[140:143],a[124:127],v[112:115]
buffer_load_dwordx4 v2,s[20:23],s41 offen offset:1024 lds
v_exp_f32 v97,v97
v_mfma_f32_16x16x32_bf16 v[116:119],a[144:147],a[112:115],v[76:79]
buffer_load_dwordx4 v22,s[20:23],s41 offen offset:2048 lds
v_cvt_pk_bf16_f32 v80,v96,v97
v_mfma_f32_16x16x32_bf16 v[116:119],a[148:151],a[116:119],v[116:119]
buffer_load_dwordx4 v29,s[20:23],s41 offen offset:3072 lds
v_exp_f32 v98,v98
v_mfma_f32_16x16x32_bf16 v[116:119],a[152:155],a[120:123],v[116:119]
buffer_load_dword v24,v27,s[32:35],s82 offen sc1
v_mfma_f32_16x16x32_bf16 v[116:119],a[156:159],a[124:127],v[116:119]
v_exp_f32 v99,v99
v_mfma_f32_16x16x32_bf16 v[120:123],a[160:163],a[112:115],v[76:79]
v_cvt_pk_bf16_f32 v81,v98,v99
v_mfma_f32_16x16x32_bf16 v[120:123],a[164:167],a[116:119],v[120:123]
v_exp_f32 v100,v100
v_mfma_f32_16x16x32_bf16 v[120:123],a[168:171],a[120:123],v[120:123]
v_mfma_f32_16x16x32_bf16 v[120:123],a[172:175],a[124:127],v[120:123]
v_exp_f32 v101,v101
v_mfma_f32_16x16x32_bf16 v[124:127],a[176:179],a[112:115],v[76:79]
s_add_u32 m0,s65,40960
v_cvt_pk_bf16_f32 v82,v100,v101
v_mfma_f32_16x16x32_bf16 v[124:127],a[180:183],a[116:119],v[124:127]
s_add_u32 s41,s75,0
v_exp_f32 v102,v102
v_mfma_f32_16x16x32_bf16 v[124:127],a[184:187],a[120:123],v[124:127]
buffer_load_dwordx4 v42,s[20:23],s41 offen lds
v_mfma_f32_16x16x32_bf16 v[124:127],a[188:191],a[124:127],v[124:127]
buffer_load_dwordx4 v37,s[20:23],s41 offen offset:1024 lds
v_exp_f32 v103,v103
v_mfma_f32_16x16x32_bf16 v[160:163],a[192:195],v[88:91],v[160:163]
buffer_load_dwordx4 v38,s[20:23],s41 offen offset:2048 lds
v_cvt_pk_bf16_f32 v83,v102,v103
v_mfma_f32_16x16x32_bf16 v[160:163],a[196:199],v[92:95],v[160:163]
buffer_load_dwordx4 v39,s[20:23],s41 offen offset:3072 lds
v_exp_f32 v104,v104
v_mfma_f32_16x16x32_bf16 v[164:167],a[200:203],v[88:91],v[164:167]
v_mfma_f32_16x16x32_bf16 v[164:167],a[204:207],v[92:95],v[164:167]
v_exp_f32 v105,v105
v_mfma_f32_16x16x32_bf16 v[168:171],a[208:211],v[88:91],v[168:171]
v_cvt_pk_bf16_f32 v84,v104,v105
v_mfma_f32_16x16x32_bf16 v[168:171],a[212:215],v[92:95],v[168:171]
v_exp_f32 v106,v106
v_mfma_f32_16x16x32_bf16 v[172:175],a[216:219],v[88:91],v[172:175]
v_mfma_f32_16x16x32_bf16 v[172:175],a[220:223],v[92:95],v[172:175]
v_exp_f32 v107,v107
v_mfma_f32_16x16x32_bf16 v[176:179],a[224:227],v[88:91],v[176:179]
s_add_u32 m0,s65,45056
v_cvt_pk_bf16_f32 v85,v106,v107
v_mfma_f32_16x16x32_bf16 v[176:179],a[228:231],v[92:95],v[176:179]
s_add_u32 s41,s75,0
v_exp_f32 v108,v108
v_mfma_f32_16x16x32_bf16 v[180:183],a[232:235],v[88:91],v[180:183]
buffer_load_dwordx4 v40,s[20:23],s41 offen lds
v_mfma_f32_16x16x32_bf16 v[180:183],a[236:239],v[92:95],v[180:183]
v_exp_f32 v109,v109
v_mfma_f32_16x16x32_bf16 v[184:187],a[240:243],v[88:91],v[184:187]
v_cvt_pk_bf16_f32 v86,v108,v109
v_mfma_f32_16x16x32_bf16 v[184:187],a[244:247],v[92:95],v[184:187]
v_exp_f32 v110,v110
v_mfma_f32_16x16x32_bf16 v[188:191],a[248:251],v[88:91],v[188:191]
v_mfma_f32_16x16x32_bf16 v[188:191],a[252:255],v[92:95],v[188:191]
v_exp_f32 v111,v111
v_mfma_f32_16x16x32_bf16 v[52:55],v[44:47],v[88:91],v[52:55]
v_cvt_pk_bf16_f32 v87,v110,v111
v_mfma_f32_16x16x32_bf16 v[52:55],v[44:47],v[92:95],v[52:55]
v_mfma_f32_16x16x32_bf16 v[192:195],a[192:195],v[80:83],v[192:195]
v_exp_f32 v112,v112
v_mfma_f32_16x16x32_bf16 v[192:195],a[196:199],v[84:87],v[192:195]
v_exp_f32 v113,v113
v_mfma_f32_16x16x32_bf16 v[196:199],a[200:203],v[80:83],v[196:199]
v_exp_f32 v114,v114
v_cvt_pk_bf16_f32 v88,v112,v113
v_mfma_f32_16x16x32_bf16 v[196:199],a[204:207],v[84:87],v[196:199]
v_exp_f32 v115,v115
v_mfma_f32_16x16x32_bf16 v[200:203],a[208:211],v[80:83],v[200:203]
v_exp_f32 v116,v116
v_cvt_pk_bf16_f32 v89,v114,v115
v_mfma_f32_16x16x32_bf16 v[200:203],a[212:215],v[84:87],v[200:203]
v_exp_f32 v117,v117
v_mfma_f32_16x16x32_bf16 v[204:207],a[216:219],v[80:83],v[204:207]
v_exp_f32 v118,v118
v_cvt_pk_bf16_f32 v90,v116,v117
v_mfma_f32_16x16x32_bf16 v[204:207],a[220:223],v[84:87],v[204:207]
v_exp_f32 v119,v119
v_mfma_f32_16x16x32_bf16 v[208:211],a[224:227],v[80:83],v[208:211]
v_exp_f32 v120,v120
v_cvt_pk_bf16_f32 v91,v118,v119
s_waitcnt vmcnt(5)
s_mov_b32 s55,0x20000
FO0_RE:
v_readfirstlane_b32 s53,v24
s_nop 0
s_bfe_u32 s53,s53,524288
s_cmp_ge_u32 s53,4
s_cbranch_scc0 FO0_SPIN
FO0_OK:
s_add_u32 s82,s82,0x10000
v_mfma_f32_16x16x32_bf16 v[208:211],a[228:231],v[84:87],v[208:211]
v_exp_f32 v121,v121
v_mfma_f32_16x16x32_bf16 v[212:215],a[232:235],v[80:83],v[212:215]
v_exp_f32 v122,v122
v_cvt_pk_bf16_f32 v92,v120,v121
v_mfma_f32_16x16x32_bf16 v[212:215],a[236:239],v[84:87],v[212:215]
s_add_u32 s68,s79,0
v_exp_f32 v123,v123
v_mfma_f32_16x16x32_bf16 v[216:219],a[240:243],v[80:83],v[216:219]
v_exp_f32 v124,v124
v_cvt_pk_bf16_f32 v93,v122,v123
v_mfma_f32_16x16x32_bf16 v[216:219],a[244:247],v[84:87],v[216:219]
buffer_load_dwordx4 a[128:131],v3,s[28:31],s68 offen sc1
v_exp_f32 v125,v125
v_mfma_f32_16x16x32_bf16 v[220:223],a[248:251],v[80:83],v[220:223]
v_exp_f32 v126,v126
v_cvt_pk_bf16_f32 v94,v124,v125
v_mfma_f32_16x16x32_bf16 v[220:223],a[252:255],v[84:87],v[220:223]
buffer_load_dwordx4 a[144:147],v3,s[28:31],s68 offen offset:1024 sc1
v_exp_f32 v127,v127
v_mfma_f32_16x16x32_bf16 v[56:59],v[44:47],v[80:83],v[56:59]
v_cvt_pk_bf16_f32 v95,v126,v127
v_mfma_f32_16x16x32_bf16 v[56:59],v[44:47],v[84:87],v[56:59]
s_nop 1
v_mfma_f32_16x16x32_bf16 v[224:227],a[192:195],v[88:91],v[224:227]
buffer_load_dwordx4 a[160:163],v3,s[28:31],s68 offen offset:2048 sc1
v_mfma_f32_16x16x32_bf16 v[224:227],a[196:199],v[92:95],v[224:227]
v_mfma_f32_16x16x32_bf16 v[228:231],a[200:203],v[88:91],v[228:231]
v_mfma_f32_16x16x32_bf16 v[228:231],a[204:207],v[92:95],v[228:231]
v_mfma_f32_16x16x32_bf16 v[232:235],a[208:211],v[88:91],v[232:235]
buffer_load_dwordx4 a[176:179],v3,s[28:31],s68 offen offset:3072 sc1
v_mfma_f32_16x16x32_bf16 v[232:235],a[212:215],v[92:95],v[232:235]
v_mfma_f32_16x16x32_bf16 v[236:239],a[216:219],v[88:91],v[236:239]
v_mfma_f32_16x16x32_bf16 v[236:239],a[220:223],v[92:95],v[236:239]
v_mfma_f32_16x16x32_bf16 v[240:243],a[224:227],v[88:91],v[240:243]
v_mfma_f32_16x16x32_bf16 v[240:243],a[228:231],v[92:95],v[240:243]
v_mfma_f32_16x16x32_bf16 v[244:247],a[232:235],v[88:91],v[244:247]
v_mfma_f32_16x16x32_bf16 v[244:247],a[236:239],v[92:95],v[244:247]
v_mfma_f32_16x16x32_bf16 v[248:251],a[240:243],v[88:91],v[248:251]
v_mfma_f32_16x16x32_bf16 v[248:251],a[244:247],v[92:95],v[248:251]
v_mfma_f32_16x16x32_bf16 v[252:255],a[248:251],v[88:91],v[252:255]
v_mfma_f32_16x16x32_bf16 v[252:255],a[252:255],v[92:95],v[252:255]
v_mfma_f32_16x16x32_bf16 v[60:63],v[44:47],v[88:91],v[60:63]
v_mfma_f32_16x16x32_bf16 v[60:63],v[44:47],v[92:95],v[60:63]
s_nop 7
v_cmp_nge_f32 s[4:5],s52,v48
v_cmp_nge_f32 s[6:7],s52,v52
v_cmp_nge_f32 vcc,s52,v56
v_cmp_nge_f32 s[100:101],s52,v60
s_nop 0
s_or_b64 s[4:5],s[4:5],s[6:7]
s_or_b64 vcc,vcc,s[100:101]
s_or_b64 s[4:5],s[4:5],vcc
s_cbranch_scc1 FB1
FB1_RET:
v_rcp_f32 v112,v48
v_rcp_f32 v114,v52
v_rcp_f32 v116,v56
v_rcp_f32 v118,v60
v_pk_mul_f32 v[128:129],v[128:129],v[112:113] op_sel_hi:[1,0]
v_pk_mul_f32 v[130:131],v[130:131],v[112:113] op_sel_hi:[1,0]
v_pk_mul_f32 v[132:133],v[132:133],v[112:113] op_sel_hi:[1,0]
v_pk_mul_f32 v[134:135],v[134:135],v[112:113] op_sel_hi:[1,0]
v_pk_mul_f32 v[136:137],v[136:137],v[112:113] op_sel_hi:[1,0]
v_pk_mul_f32 v[138:139],v[138:139],v[112:113] op_sel_hi:[1,0]
v_pk_mul_f32 v[140:141],v[140:141],v[112:113] op_sel_hi:[1,0]
v_pk_mul_f32 v[142:143],v[142:143],v[112:113] op_sel_hi:[1,0]
v_pk_mul_f32 v[144:145],v[144:145],v[112:113] op_sel_hi:[1,0]
v_pk_mul_f32 v[146:147],v[146:147],v[112:113] op_sel_hi:[1,0]
v_pk_mul_f32 v[148:149],v[148:149],v[112:113] op_sel_hi:[1,0]
v_pk_mul_f32 v[150:151],v[150:151],v[112:113] op_sel_hi:[1,0]
v_pk_mul_f32 v[152:153],v[152:153],v[112:113] op_sel_hi:[1,0]
v_pk_mul_f32 v[154:155],v[154:155],v[112:113] op_sel_hi:[1,0]
v_pk_mul_f32 v[156:157],v[156:157],v[112:113] op_sel_hi:[1,0]
v_pk_mul_f32 v[158:159],v[158:159],v[112:113] op_sel_hi:[1,0]
v_cvt_pk_bf16_f32 v48,v128,v129
v_cvt_pk_bf16_f32 v49,v130,v131
v_cvt_pk_bf16_f32 v50,v132,v133
v_cvt_pk_bf16_f32 v51,v134,v135
v_cvt_pk_bf16_f32 v52,v136,v137
v_cvt_pk_bf16_f32 v53,v138,v139
v_cvt_pk_bf16_f32 v54,v140,v141
v_cvt_pk_bf16_f32 v55,v142,v143
v_cvt_pk_bf16_f32 v56,v144,v145
v_cvt_pk_bf16_f32 v57,v146,v147
v_cvt_pk_bf16_f32 v58,v148,v149
v_cvt_pk_bf16_f32 v59,v150,v151
v_cvt_pk_bf16_f32 v60,v152,v153
v_cvt_pk_bf16_f32 v61,v154,v155
v_cvt_pk_bf16_f32 v62,v156,v157
v_cvt_pk_bf16_f32 v63,v158,v159
v_pk_mul_f32 v[160:161],v[160:161],v[114:115] op_sel_hi:[1,0]
v_pk_mul_f32 v[162:163],v[162:163],v[114:115] op_sel_hi:[1,0]
v_pk_mul_f32 v[164:165],v[164:165],v[114:115] op_sel_hi:[1,0]
v_pk_mul_f32 v[166:167],v[166:167],v[114:115] op_sel_hi:[1,0]
v_pk_mul_f32 v[168:169],v[168:169],v[114:115] op_sel_hi:[1,0]
v_pk_mul_f32 v[170:171],v[170:171],v[114:115] op_sel_hi:[1,0]
v_pk_mul_f32 v[172:173],v[172:173],v[114:115] op_sel_hi:[1,0]
v_pk_mul_f32 v[174:175],v[174:175],v[114:115] op_sel_hi:[1,0]
v_pk_mul_f32 v[176:177],v[176:177],v[114:115] op_sel_hi:[1,0]
v_pk_mul_f32 v[178:179],v[178:179],v[114:115] op_sel_hi:[1,0]
v_pk_mul_f32 v[180:181],v[180:181],v[114:115] op_sel_hi:[1,0]
v_pk_mul_f32 v[182:183],v[182:183],v[114:115] op_sel_hi:[1,0]
v_pk_mul_f32 v[184:185],v[184:185],v[114:115] op_sel_hi:[1,0]
v_pk_mul_f32 v[186:187],v[186:187],v[114:115] op_sel_hi:[1,0]
v_pk_mul_f32 v[188:189],v[188:189],v[114:115] op_sel_hi:[1,0]
v_pk_mul_f32 v[190:191],v[190:191],v[114:115] op_sel_hi:[1,0]
v_cvt_pk_bf16_f32 v64,v160,v161
v_cvt_pk_bf16_f32 v65,v162,v163
v_cvt_pk_bf16_f32 v66,v164,v165
v_cvt_pk_bf16_f32 v67,v166,v167
v_cvt_pk_bf16_f32 v68,v168,v169
v_cvt_pk_bf16_f32 v69,v170,v171
v_cvt_pk_bf16_f32 v70,v172,v173
v_cvt_pk_bf16_f32 v71,v174,v175
v_cvt_pk_bf16_f32 v72,v176,v177
v_cvt_pk_bf16_f32 v73,v178,v179
v_cvt_pk_bf16_f32 v74,v180,v181
v_cvt_pk_bf16_f32 v75,v182,v183
v_cvt_pk_bf16_f32 v76,v184,v185
v_cvt_pk_bf16_f32 v77,v186,v187
v_cvt_pk_bf16_f32 v78,v188,v189
v_cvt_pk_bf16_f32 v79,v190,v191
v_pk_mul_f32 v[192:193],v[192:193],v[116:117] op_sel_hi:[1,0]
v_pk_mul_f32 v[194:195],v[194:195],v[116:117] op_sel_hi:[1,0]
v_pk_mul_f32 v[196:197],v[196:197],v[116:117] op_sel_hi:[1,0]
v_pk_mul_f32 v[198:199],v[198:199],v[116:117] op_sel_hi:[1,0]
v_pk_mul_f32 v[200:201],v[200:201],v[116:117] op_sel_hi:[1,0]
v_pk_mul_f32 v[202:203],v[202:203],v[116:117] op_sel_hi:[1,0]
v_pk_mul_f32 v[204:205],v[204:205],v[116:117] op_sel_hi:[1,0]
v_pk_mul_f32 v[206:207],v[206:207],v[116:117] op_sel_hi:[1,0]
v_pk_mul_f32 v[208:209],v[208:209],v[116:117] op_sel_hi:[1,0]
v_pk_mul_f32 v[210:211],v[210:211],v[116:117] op_sel_hi:[1,0]
v_pk_mul_f32 v[212:213],v[212:213],v[116:117] op_sel_hi:[1,0]
v_pk_mul_f32 v[214:215],v[214:215],v[116:117] op_sel_hi:[1,0]
v_pk_mul_f32 v[216:217],v[216:217],v[116:117] op_sel_hi:[1,0]
v_pk_mul_f32 v[218:219],v[218:219],v[116:117] op_sel_hi:[1,0]
v_pk_mul_f32 v[220:221],v[220:221],v[116:117] op_sel_hi:[1,0]
v_pk_mul_f32 v[222:223],v[222:223],v[116:117] op_sel_hi:[1,0]
v_cvt_pk_bf16_f32 v80,v192,v193
v_cvt_pk_bf16_f32 v81,v194,v195
v_cvt_pk_bf16_f32 v82,v196,v197
v_cvt_pk_bf16_f32 v83,v198,v199
v_cvt_pk_bf16_f32 v84,v200,v201
v_cvt_pk_bf16_f32 v85,v202,v203
v_cvt_pk_bf16_f32 v86,v204,v205
v_cvt_pk_bf16_f32 v87,v206,v207
v_cvt_pk_bf16_f32 v88,v208,v209
v_cvt_pk_bf16_f32 v89,v210,v211
v_cvt_pk_bf16_f32 v90,v212,v213
v_cvt_pk_bf16_f32 v91,v214,v215
v_cvt_pk_bf16_f32 v92,v216,v217
v_cvt_pk_bf16_f32 v93,v218,v219
v_cvt_pk_bf16_f32 v94,v220,v221
v_cvt_pk_bf16_f32 v95,v222,v223
v_pk_mul_f32 v[224:225],v[224:225],v[118:119] op_sel_hi:[1,0]
v_pk_mul_f32 v[226:227],v[226:227],v[118:119] op_sel_hi:[1,0]
v_pk_mul_f32 v[228:229],v[228:229],v[118:119] op_sel_hi:[1,0]
v_pk_mul_f32 v[230:231],v[230:231],v[118:119] op_sel_hi:[1,0]
v_pk_mul_f32 v[232:233],v[232:233],v[118:119] op_sel_hi:[1,0]
v_pk_mul_f32 v[234:235],v[234:235],v[118:119] op_sel_hi:[1,0]
v_pk_mul_f32 v[236:237],v[236:237],v[118:119] op_sel_hi:[1,0]
v_pk_mul_f32 v[238:239],v[238:239],v[118:119] op_sel_hi:[1,0]
v_pk_mul_f32 v[240:241],v[240:241],v[118:119] op_sel_hi:[1,0]
v_pk_mul_f32 v[242:243],v[242:243],v[118:119] op_sel_hi:[1,0]
v_pk_mul_f32 v[244:245],v[244:245],v[118:119] op_sel_hi:[1,0]
v_pk_mul_f32 v[246:247],v[246:247],v[118:119] op_sel_hi:[1,0]
v_pk_mul_f32 v[248:249],v[248:249],v[118:119] op_sel_hi:[1,0]
v_pk_mul_f32 v[250:251],v[250:251],v[118:119] op_sel_hi:[1,0]
v_pk_mul_f32 v[252:253],v[252:253],v[118:119] op_sel_hi:[1,0]
v_pk_mul_f32 v[254:255],v[254:255],v[118:119] op_sel_hi:[1,0]
v_cvt_pk_bf16_f32 v96,v224,v225
v_cvt_pk_bf16_f32 v97,v226,v227
v_cvt_pk_bf16_f32 v98,v228,v229
v_cvt_pk_bf16_f32 v99,v230,v231
v_cvt_pk_bf16_f32 v100,v232,v233
v_cvt_pk_bf16_f32 v101,v234,v235
v_cvt_pk_bf16_f32 v102,v236,v237
v_cvt_pk_bf16_f32 v103,v238,v239
v_cvt_pk_bf16_f32 v104,v240,v241
v_cvt_pk_bf16_f32 v105,v242,v243
v_cvt_pk_bf16_f32 v106,v244,v245
v_cvt_pk_bf16_f32 v107,v246,v247
v_cvt_pk_bf16_f32 v108,v248,v249
v_cvt_pk_bf16_f32 v109,v250,v251
v_cvt_pk_bf16_f32 v110,v252,v253
v_cvt_pk_bf16_f32 v111,v254,v255
ds_read_b64_tr_b16 a[192:193],v23 offset:0
ds_read_b64_tr_b16 a[194:195],v23 offset:4608
ds_read_b64_tr_b16 a[196:197],v23 offset:9216
ds_read_b64_tr_b16 a[198:199],v23 offset:13824
ds_read_b64_tr_b16 a[200:201],v23 offset:32
ds_read_b64_tr_b16 a[202:203],v23 offset:4640
ds_read_b64_tr_b16 a[204:205],v23 offset:9248
ds_read_b64_tr_b16 a[206:207],v23 offset:13856
s_waitcnt lgkmcnt(6)
v_mfma_f32_16x16x32_bf16 v[112:115],a[192:195],a[0:3],0
ds_read_b64_tr_b16 a[208:209],v23 offset:64
s_waitcnt lgkmcnt(5)
v_mfma_f32_16x16x32_bf16 v[112:115],a[196:199],a[4:7],v[112:115]
ds_read_b64_tr_b16 a[210:211],v23 offset:4672
s_add_u32 s68,s79,4096
v_mfma_f32_16x16x32_bf16 v[148:151],a[192:195],a[16:19],0
ds_read_b64_tr_b16 a[212:213],v23 offset:9280
v_mfma_f32_16x16x32_bf16 v[148:151],a[196:199],a[20:23],v[148:151]
ds_read_b64_tr_b16 a[214:215],v23 offset:13888
v_mfma_f32_16x16x32_bf16 v[184:187],a[192:195],a[32:35],0
buffer_load_dwordx4 a[132:135],v3,s[28:31],s68 offen sc1
v_mfma_f32_16x16x32_bf16 v[184:187],a[196:199],a[36:39],v[184:187]
buffer_load_dwordx4 a[148:151],v3,s[28:31],s68 offen offset:1024 sc1
v_mfma_f32_16x16x32_bf16 v[220:223],a[192:195],a[48:51],0
v_mfma_f32_16x16x32_bf16 v[220:223],a[196:199],a[52:55],v[220:223]
s_waitcnt lgkmcnt(4)
v_mfma_f32_16x16x32_bf16 v[116:119],a[200:203],a[0:3],0
ds_read_b64_tr_b16 a[216:217],v23 offset:96
v_mfma_f32_16x16x32_bf16 v[116:119],a[204:207],a[4:7],v[116:119]
ds_read_b64_tr_b16 a[218:219],v23 offset:4704
v_mfma_f32_16x16x32_bf16 v[152:155],a[200:203],a[16:19],0
ds_read_b64_tr_b16 a[220:221],v23 offset:9312
v_mfma_f32_16x16x32_bf16 v[152:155],a[204:207],a[20:23],v[152:155]
ds_read_b64_tr_b16 a[222:223],v23 offset:13920
v_mfma_f32_16x16x32_bf16 v[188:191],a[200:203],a[32:35],0
buffer_load_dwordx4 a[164:167],v3,s[28:31],s68 offen offset:2048 sc1
v_mfma_f32_16x16x32_bf16 v[188:191],a[204:207],a[36:39],v[188:191]
buffer_load_dwordx4 a[180:183],v3,s[28:31],s68 offen offset:3072 sc1
v_mfma_f32_16x16x32_bf16 v[224:227],a[200:203],a[48:51],0
v_mfma_f32_16x16x32_bf16 v[224:227],a[204:207],a[52:55],v[224:227]
s_waitcnt lgkmcnt(4)
v_mfma_f32_16x16x32_bf16 v[120:123],a[208:211],a[0:3],0
ds_read_b64_tr_b16 a[192:193],v23 offset:128
v_mfma_f32_16x16x32_bf16 v[120:123],a[212:215],a[4:7],v[120:123]
ds_read_b64_tr_b16 a[194:195],v23 offset:4736
s_add_u32 s68,s79,8192
v_mfma_f32_16x16x32_bf16 v[156:159],a[208:211],a[16:19],0
ds_read_b64_tr_b16 a[196:197],v23 offset:9344
v_mfma_f32_16x16x32_bf16 v[156:159],a[212:215],a[20:23],v[156:159]
ds_read_b64_tr_b16 a[198:199],v23 offset:13952
v_mfma_f32_16x16x32_bf16 v[192:195],a[208:211],a[32:35],0
buffer_load_dwordx4 a[136:139],v3,s[28:31],s68 offen sc1
v_mfma_f32_16x16x32_bf16 v[192:195],a[212:215],a[36:39],v[192:195]
buffer_load_dwordx4 a[152:155],v3,s[28:31],s68 offen offset:1024 sc1
v_mfma_f32_16x16x32_bf16 v[228:231],a[208:211],a[48:51],0
v_mfma_f32_16x16x32_bf16 v[228:231],a[212:215],a[52:55],v[228:231]
s_waitcnt lgkmcnt(4)
v_mfma_f32_16x16x32_bf16 v[124:127],a[216:219],a[0:3],0
ds_read_b64_tr_b16 a[200:201],v23 offset:160
v_mfma_f32_16x16x32_bf16 v[124:127],a[220:223],a[4:7],v[124:127]
ds_read_b64_tr_b16 a[202:203],v23 offset:4768
v_mfma_f32_16x16x32_bf16 v[160:163],a[216:219],a[16:19],0
ds_read_b64_tr_b16 a[204:205],v23 offset:9376
v_mfma_f32_16x16x32_bf16 v[160:163],a[220:223],a[20:23],v[160:163]
ds_read_b64_tr_b16 a[206:207],v23 offset:13984
v_mfma_f32_16x16x32_bf16 v[196:199],a[216:219],a[32:35],0
buffer_load_dwordx4 a[168:171],v3,s[28:31],s68 offen offset:2048 sc1
v_mfma_f32_16x16x32_bf16 v[196:199],a[220:223],a[36:39],v[196:199]
buffer_load_dwordx4 a[184:187],v3,s[28:31],s68 offen offset:3072 sc1
v_mfma_f32_16x16x32_bf16 v[232:235],a[216:219],a[48:51],0
v_mfma_f32_16x16x32_bf16 v[232:235],a[220:223],a[52:55],v[232:235]
s_waitcnt lgkmcnt(4)
v_mfma_f32_16x16x32_bf16 v[128:131],a[192:195],a[0:3],0
ds_read_b64_tr_b16 a[208:209],v23 offset:192
v_mfma_f32_16x16x32_bf16 v[128:131],a[196:199],a[4:7],v[128:131]
ds_read_b64_tr_b16 a[210:211],v23 offset:4800
s_add_u32 s68,s79,12288
v_mfma_f32_16x16x32_bf16 v[164:167],a[192:195],a[16:19],0
ds_read_b64_tr_b16 a[212:213],v23 offset:9408
v_mfma_f32_16x16x32_bf16 v[164:167],a[196:199],a[20:23],v[164:167]
ds_read_b64_tr_b16 a[214:215],v23 offset:14016
v_mfma_f32_16x16x32_bf16 v[200:203],a[192:195],a[32:35],0
buffer_load_dwordx4 a[140:143],v3,s[28:31],s68 offen sc1
v_mfma_f32_16x16x32_bf16 v[200:203],a[196:199],a[36:39],v[200:203]
buffer_load_dwordx4 a[156:159],v3,s[28:31],s68 offen offset:1024 sc1
v_mfma_f32_16x16x32_bf16 v[236:239],a[192:195],a[48:51],0
v_mfma_f32_16x16x32_bf16 v[236:239],a[196:199],a[52:55],v[236:239]
s_waitcnt lgkmcnt(4)
v_mfma_f32_16x16x32_bf16 v[132:135],a[200:203],a[0:3],0
ds_read_b64_tr_b16 a[216:217],v23 offset:224
v_mfma_f32_16x16x32_bf16 v[132:135],a[204:207],a[4:7],v[132:135]
ds_read_b64_tr_b16 a[218:219],v23 offset:4832
v_mfma_f32_16x16x32_bf16 v[168:171],a[200:203],a[16:19],0
ds_read_b64_tr_b16 a[220:221],v23 offset:9440
v_mfma_f32_16x16x32_bf16 v[168:171],a[204:207],a[20:23],v[168:171]
ds_read_b64_tr_b16 a[222:223],v23 offset:14048
v_mfma_f32_16x16x32_bf16 v[204:207],a[200:203],a[32:35],0
buffer_load_dwordx4 a[172:175],v3,s[28:31],s68 offen offset:2048 sc1
v_mfma_f32_16x16x32_bf16 v[204:207],a[204:207],a[36:39],v[204:207]
buffer_load_dwordx4 a[188:191],v3,s[28:31],s68 offen offset:3072 sc1
v_mfma_f32_16x16x32_bf16 v[240:243],a[200:203],a[48:51],0
v_mfma_f32_16x16x32_bf16 v[240:243],a[204:207],a[52:55],v[240:243]
s_waitcnt lgkmcnt(4)
v_mfma_f32_16x16x32_bf16 v[136:139],a[208:211],a[0:3],0
ds_read_b64_tr_b16 a[192:193],v23 offset:256
v_mfma_f32_16x16x32_bf16 v[136:139],a[212:215],a[4:7],v[136:139]
ds_read_b64_tr_b16 a[194:195],v23 offset:4864
v_mfma_f32_16x16x32_bf16 v[172:175],a[208:211],a[16:19],0
ds_read_b64_tr_b16 a[196:197],v23 offset:9472
s_add_u32 s72,s78,16384
v_mfma_f32_16x16x32_bf16 v[172:175],a[212:215],a[20:23],v[172:175]
ds_read_b64_tr_b16 a[198:199],v23 offset:14080
v_mfma_f32_16x16x32_bf16 v[208:211],a[208:211],a[32:35],0
buffer_store_dwordx4 v[48:51],v3,s[28:31],s72 offen sc1
v_mfma_f32_16x16x32_bf16 v[208:211],a[212:215],a[36:39],v[208:211]
v_mfma_f32_16x16x32_bf16 v[244:247],a[208:211],a[48:51],0
v_mfma_f32_16x16x32_bf16 v[244:247],a[212:215],a[52:55],v[244:247]
s_waitcnt lgkmcnt(4)
v_mfma_f32_16x16x32_bf16 v[140:143],a[216:219],a[0:3],0
ds_read_b64_tr_b16 a[200:201],v28 offset:0
v_mfma_f32_16x16x32_bf16 v[140:143],a[220:223],a[4:7],v[140:143]
ds_read_b64_tr_b16 a[202:203],v28 offset:4608
v_mfma_f32_16x16x32_bf16 v[176:179],a[216:219],a[16:19],0
ds_read_b64_tr_b16 a[204:205],v28 offset:9216
v_mfma_f32_16x16x32_bf16 v[176:179],a[220:223],a[20:23],v[176:179]
ds_read_b64_tr_b16 a[206:207],v28 offset:13824
v_mfma_f32_16x16x32_bf16 v[212:215],a[216:219],a[32:35],0
v_mfma_f32_16x16x32_bf16 v[212:215],a[220:223],a[36:39],v[212:215]
v_mfma_f32_16x16x32_bf16 v[248:251],a[216:219],a[48:51],0
v_mfma_f32_16x16x32_bf16 v[248:251],a[220:223],a[52:55],v[248:251]
s_waitcnt lgkmcnt(4)
v_mfma_f32_16x16x32_bf16 v[144:147],a[192:195],a[0:3],0
ds_read_b64_tr_b16 a[208:209],v28 offset:32
s_add_u32 s72,s78,16384
v_mfma_f32_16x16x32_bf16 v[144:147],a[196:199],a[4:7],v[144:147]
ds_read_b64_tr_b16 a[210:211],v28 offset:4640
v_mfma_f32_16x16x32_bf16 v[180:183],a[192:195],a[16:19],0
ds_read_b64_tr_b16 a[212:213],v28 offset:9248
v_mfma_f32_16x16x32_bf16 v[180:183],a[196:199],a[20:23],v[180:183]
ds_read_b64_tr_b16 a[214:215],v28 offset:13856
v_mfma_f32_16x16x32_bf16 v[216:219],a[192:195],a[32:35],0
buffer_store_dwordx4 v[64:67],v3,s[28:31],s72 offen offset:1024 sc1
v_mfma_f32_16x16x32_bf16 v[216:219],a[196:199],a[36:39],v[216:219]
v_mfma_f32_16x16x32_bf16 v[252:255],a[192:195],a[48:51],0
v_mfma_f32_16x16x32_bf16 v[252:255],a[196:199],a[52:55],v[252:255]
s_waitcnt lgkmcnt(4)
v_mfma_f32_16x16x32_bf16 v[112:115],a[200:203],a[8:11],v[112:115]
ds_read_b64_tr_b16 a[216:217],v28 offset:64
v_mfma_f32_16x16x32_bf16 v[112:115],a[204:207],a[12:15],v[112:115]
ds_read_b64_tr_b16 a[218:219],v28 offset:4672
v_mfma_f32_16x16x32_bf16 v[148:151],a[200:203],a[24:27],v[148:151]
ds_read_b64_tr_b16 a[220:221],v28 offset:9280
v_mfma_f32_16x16x32_bf16 v[148:151],a[204:207],a[28:31],v[148:151]
ds_read_b64_tr_b16 a[222:223],v28 offset:13888
v_mfma_f32_16x16x32_bf16 v[184:187],a[200:203],a[40:43],v[184:187]
v_mfma_f32_16x16x32_bf16 v[184:187],a[204:207],a[44:47],v[184:187]
v_mfma_f32_16x16x32_bf16 v[220:223],a[200:203],a[56:59],v[220:223]
s_add_u32 s72,s78,16384
v_mfma_f32_16x16x32_bf16 v[220:223],a[204:207],a[60:63],v[220:223]
buffer_store_dwordx4 v[80:83],v3,s[28:31],s72 offen offset:2048 sc1
s_waitcnt lgkmcnt(4)
v_mfma_f32_16x16x32_bf16 v[116:119],a[208:211],a[8:11],v[116:119]
ds_read_b64_tr_b16 a[192:193],v28 offset:96
v_mfma_f32_16x16x32_bf16 v[116:119],a[212:215],a[12:15],v[116:119]
ds_read_b64_tr_b16 a[194:195],v28 offset:4704
v_mfma_f32_16x16x32_bf16 v[152:155],a[208:211],a[24:27],v[152:155]
ds_read_b64_tr_b16 a[196:197],v28 offset:9312
v_mfma_f32_16x16x32_bf16 v[152:155],a[212:215],a[28:31],v[152:155]
ds_read_b64_tr_b16 a[198:199],v28 offset:13920
v_mfma_f32_16x16x32_bf16 v[188:191],a[208:211],a[40:43],v[188:191]
v_mfma_f32_16x16x32_bf16 v[188:191],a[212:215],a[44:47],v[188:191]
v_mfma_f32_16x16x32_bf16 v[224:227],a[208:211],a[56:59],v[224:227]
v_mfma_f32_16x16x32_bf16 v[224:227],a[212:215],a[60:63],v[224:227]
s_waitcnt lgkmcnt(4)
v_mfma_f32_16x16x32_bf16 v[120:123],a[216:219],a[8:11],v[120:123]
ds_read_b64_tr_b16 a[200:201],v28 offset:128
v_mfma_f32_16x16x32_bf16 v[120:123],a[220:223],a[12:15],v[120:123]
ds_read_b64_tr_b16 a[202:203],v28 offset:4736
v_mfma_f32_16x16x32_bf16 v[156:159],a[216:219],a[24:27],v[156:159]
ds_read_b64_tr_b16 a[204:205],v28 offset:9344
v_mfma_f32_16x16x32_bf16 v[156:159],a[220:223],a[28:31],v[156:159]
ds_read_b64_tr_b16 a[206:207],v28 offset:13952
v_mfma_f32_16x16x32_bf16 v[192:195],a[216:219],a[40:43],v[192:195]
s_add_u32 s72,s78,16384
v_mfma_f32_16x16x32_bf16 v[192:195],a[220:223],a[44:47],v[192:195]
buffer_store_dwordx4 v[96:99],v3,s[28:31],s72 offen offset:3072 sc1
v_mfma_f32_16x16x32_bf16 v[228:231],a[216:219],a[56:59],v[228:231]
v_mfma_f32_16x16x32_bf16 v[228:231],a[220:223],a[60:63],v[228:231]
s_waitcnt lgkmcnt(4)
v_mfma_f32_16x16x32_bf16 v[124:127],a[192:195],a[8:11],v[124:127]
ds_read_b64_tr_b16 a[208:209],v28 offset:160
v_mfma_f32_16x16x32_bf16 v[124:127],a[196:199],a[12:15],v[124:127]
ds_read_b64_tr_b16 a[210:211],v28 offset:4768
v_mfma_f32_16x16x32_bf16 v[160:163],a[192:195],a[24:27],v[160:163]
ds_read_b64_tr_b16 a[212:213],v28 offset:9376
v_mfma_f32_16x16x32_bf16 v[160:163],a[196:199],a[28:31],v[160:163]
ds_read_b64_tr_b16 a[214:215],v28 offset:13984
v_mfma_f32_16x16x32_bf16 v[196:199],a[192:195],a[40:43],v[196:199]
v_mfma_f32_16x16x32_bf16 v[196:199],a[196:199],a[44:47],v[196:199]
v_mfma_f32_16x16x32_bf16 v[232:235],a[192:195],a[56:59],v[232:235]
v_mfma_f32_16x16x32_bf16 v[232:235],a[196:199],a[60:63],v[232:235]
s_waitcnt lgkmcnt(4)
v_mfma_f32_16x16x32_bf16 v[128:131],a[200:203],a[8:11],v[128:131]
ds_read_b64_tr_b16 a[216:217],v28 offset:192
v_mfma_f32_16x16x32_bf16 v[128:131],a[204:207],a[12:15],v[128:131]
ds_read_b64_tr_b16 a[218:219],v28 offset:4800
v_mfma_f32_16x16x32_bf16 v[164:167],a[200:203],a[24:27],v[164:167]
ds_read_b64_tr_b16 a[220:221],v28 offset:9408
s_add_u32 s72,s78,20480
v_mfma_f32_16x16x32_bf16 v[164:167],a[204:207],a[28:31],v[164:167]
ds_read_b64_tr_b16 a[222:223],v28 offset:14016
v_mfma_f32_16x16x32_bf16 v[200:203],a[200:203],a[40:43],v[200:203]
buffer_store_dwordx4 v[52:55],v3,s[28:31],s72 offen sc1
v_mfma_f32_16x16x32_bf16 v[200:203],a[204:207],a[44:47],v[200:203]
v_mfma_f32_16x16x32_bf16 v[236:239],a[200:203],a[56:59],v[236:239]
v_mfma_f32_16x16x32_bf16 v[236:239],a[204:207],a[60:63],v[236:239]
s_waitcnt lgkmcnt(4)
v_mfma_f32_16x16x32_bf16 v[132:135],a[208:211],a[8:11],v[132:135]
ds_read_b64_tr_b16 a[192:193],v28 offset:224
v_mfma_f32_16x16x32_bf16 v[132:135],a[212:215],a[12:15],v[132:135]
ds_read_b64_tr_b16 a[194:195],v28 offset:4832
v_mfma_f32_16x16x32_bf16 v[168:171],a[208:211],a[24:27],v[168:171]
ds_read_b64_tr_b16 a[196:197],v28 offset:9440
v_mfma_f32_16x16x32_bf16 v[168:171],a[212:215],a[28:31],v[168:171]
ds_read_b64_tr_b16 a[198:199],v28 offset:14048
v_mfma_f32_16x16x32_bf16 v[204:207],a[208:211],a[40:43],v[204:207]
v_mfma_f32_16x16x32_bf16 v[204:207],a[212:215],a[44:47],v[204:207]
v_mfma_f32_16x16x32_bf16 v[240:243],a[208:211],a[56:59],v[240:243]
v_mfma_f32_16x16x32_bf16 v[240:243],a[212:215],a[60:63],v[240:243]
s_waitcnt lgkmcnt(4)
v_mfma_f32_16x16x32_bf16 v[136:139],a[216:219],a[8:11],v[136:139]
ds_read_b64_tr_b16 a[200:201],v28 offset:256
s_add_u32 s72,s78,20480
v_mfma_f32_16x16x32_bf16 v[136:139],a[220:223],a[12:15],v[136:139]
ds_read_b64_tr_b16 a[202:203],v28 offset:4864
v_mfma_f32_16x16x32_bf16 v[172:175],a[216:219],a[24:27],v[172:175]
ds_read_b64_tr_b16 a[204:205],v28 offset:9472
v_mfma_f32_16x16x32_bf16 v[172:175],a[220:223],a[28:31],v[172:175]
ds_read_b64_tr_b16 a[206:207],v28 offset:14080
v_mfma_f32_16x16x32_bf16 v[208:211],a[216:219],a[40:43],v[208:211]
buffer_store_dwordx4 v[68:71],v3,s[28:31],s72 offen offset:1024 sc1
v_mfma_f32_16x16x32_bf16 v[208:211],a[220:223],a[44:47],v[208:211]
v_mfma_f32_16x16x32_bf16 v[244:247],a[216:219],a[56:59],v[244:247]
v_mfma_f32_16x16x32_bf16 v[244:247],a[220:223],a[60:63],v[244:247]
s_waitcnt lgkmcnt(0)
s_barrier
v_mfma_f32_16x16x32_bf16 v[140:143],a[192:195],a[8:11],v[140:143]
ds_read_b64_tr_b16 a[208:209],v23 offset:18432
s_add_u32 m0,s65,0
v_mfma_f32_16x16x32_bf16 v[140:143],a[196:199],a[12:15],v[140:143]
ds_read_b64_tr_b16 a[210:211],v23 offset:23040
s_add_u32 s41,s76,0
v_mfma_f32_16x16x32_bf16 v[176:179],a[192:195],a[24:27],v[176:179]
ds_read_b64_tr_b16 a[212:213],v23 offset:27648
v_mfma_f32_16x16x32_bf16 v[176:179],a[196:199],a[28:31],v[176:179]
ds_read_b64_tr_b16 a[214:215],v23 offset:32256
v_mfma_f32_16x16x32_bf16 v[212:215],a[192:195],a[40:43],v[212:215]
buffer_load_dwordx4 v1,s[20:23],s41 offen lds
v_mfma_f32_16x16x32_bf16 v[212:215],a[196:199],a[44:47],v[212:215]
v_mfma_f32_16x16x32_bf16 v[248:251],a[192:195],a[56:59],v[248:251]
s_add_u32 s72,s78,20480
v_mfma_f32_16x16x32_bf16 v[248:251],a[196:199],a[60:63],v[248:251]
buffer_store_dwordx4 v[84:87],v3,s[28:31],s72 offen offset:2048 sc1
v_mfma_f32_16x16x32_bf16 v[144:147],a[200:203],a[8:11],v[144:147]
ds_read_b64_tr_b16 a[216:217],v23 offset:18464
v_mfma_f32_16x16x32_bf16 v[144:147],a[204:207],a[12:15],v[144:147]
ds_read_b64_tr_b16 a[218:219],v23 offset:23072
v_mfma_f32_16x16x32_bf16 v[180:183],a[200:203],a[24:27],v[180:183]
ds_read_b64_tr_b16 a[220:221],v23 offset:27680
v_mfma_f32_16x16x32_bf16 v[180:183],a[204:207],a[28:31],v[180:183]
ds_read_b64_tr_b16 a[222:223],v23 offset:32288
v_mfma_f32_16x16x32_bf16 v[216:219],a[200:203],a[40:43],v[216:219]
v_mfma_f32_16x16x32_bf16 v[216:219],a[204:207],a[44:47],v[216:219]
v_mfma_f32_16x16x32_bf16 v[252:255],a[200:203],a[56:59],v[252:255]
buffer_load_dwordx4 v2,s[20:23],s41 offen offset:1024 lds
v_mfma_f32_16x16x32_bf16 v[252:255],a[204:207],a[60:63],v[252:255]
s_waitcnt lgkmcnt(4)
v_mfma_f32_16x16x32_bf16 v[112:115],a[208:211],v[48:51],v[112:115]
ds_read_b64_tr_b16 a[192:193],v23 offset:18496
v_mfma_f32_16x16x32_bf16 v[112:115],a[212:215],v[52:55],v[112:115]
ds_read_b64_tr_b16 a[194:195],v23 offset:23104
v_mfma_f32_16x16x32_bf16 v[148:151],a[208:211],v[64:67],v[148:151]
ds_read_b64_tr_b16 a[196:197],v23 offset:27712
v_mfma_f32_16x16x32_bf16 v[148:151],a[212:215],v[68:71],v[148:151]
ds_read_b64_tr_b16 a[198:199],v23 offset:32320
v_mfma_f32_16x16x32_bf16 v[184:187],a[208:211],v[80:83],v[184:187]
s_add_u32 s72,s78,20480
v_mfma_f32_16x16x32_bf16 v[184:187],a[212:215],v[84:87],v[184:187]
buffer_store_dwordx4 v[100:103],v3,s[28:31],s72 offen offset:3072 sc1
v_mfma_f32_16x16x32_bf16 v[220:223],a[208:211],v[96:99],v[220:223]
v_mfma_f32_16x16x32_bf16 v[220:223],a[212:215],v[100:103],v[220:223]
s_waitcnt lgkmcnt(4)
v_mfma_f32_16x16x32_bf16 v[116:119],a[216:219],v[48:51],v[116:119]
ds_read_b64_tr_b16 a[200:201],v23 offset:18528
v_mfma_f32_16x16x32_bf16 v[116:119],a[220:223],v[52:55],v[116:119]
ds_read_b64_tr_b16 a[202:203],v23 offset:23136
v_mfma_f32_16x16x32_bf16 v[152:155],a[216:219],v[64:67],v[152:155]
ds_read_b64_tr_b16 a[204:205],v23 offset:27744
v_mfma_f32_16x16x32_bf16 v[152:155],a[220:223],v[68:71],v[152:155]
ds_read_b64_tr_b16 a[206:207],v23 offset:32352
v_mfma_f32_16x16x32_bf16 v[188:191],a[216:219],v[80:83],v[188:191]
buffer_load_dwordx4 v22,s[20:23],s41 offen offset:2048 lds
v_mfma_f32_16x16x32_bf16 v[188:191],a[220:223],v[84:87],v[188:191]
v_mfma_f32_16x16x32_bf16 v[224:227],a[216:219],v[96:99],v[224:227]
v_mfma_f32_16x16x32_bf16 v[224:227],a[220:223],v[100:103],v[224:227]
s_waitcnt lgkmcnt(4)
v_mfma_f32_16x16x32_bf16 v[120:123],a[192:195],v[48:51],v[120:123]
ds_read_b64_tr_b16 a[208:209],v23 offset:18560
v_mfma_f32_16x16x32_bf16 v[120:123],a[196:199],v[52:55],v[120:123]
ds_read_b64_tr_b16 a[210:211],v23 offset:23168
v_mfma_f32_16x16x32_bf16 v[156:159],a[192:195],v[64:67],v[156:159]
ds_read_b64_tr_b16 a[212:213],v23 offset:27776
s_add_u32 s72,s78,24576
v_mfma_f32_16x16x32_bf16 v[156:159],a[196:199],v[68:71],v[156:159]
ds_read_b64_tr_b16 a[214:215],v23 offset:32384
v_mfma_f32_16x16x32_bf16 v[192:195],a[192:195],v[80:83],v[192:195]
buffer_store_dwordx4 v[56:59],v3,s[28:31],s72 offen sc1
v_mfma_f32_16x16x32_bf16 v[192:195],a[196:199],v[84:87],v[192:195]
v_mfma_f32_16x16x32_bf16 v[228:231],a[192:195],v[96:99],v[228:231]
v_mfma_f32_16x16x32_bf16 v[228:231],a[196:199],v[100:103],v[228:231]
s_waitcnt lgkmcnt(4)
v_mfma_f32_16x16x32_bf16 v[124:127],a[200:203],v[48:51],v[124:127]
ds_read_b64_tr_b16 a[216:217],v23 offset:18592
v_mfma_f32_16x16x32_bf16 v[124:127],a[204:207],v[52:55],v[124:127]
ds_read_b64_tr_b16 a[218:219],v23 offset:23200
v_mfma_f32_16x16x32_bf16 v[160:163],a[200:203],v[64:67],v[160:163]
ds_read_b64_tr_b16 a[220:221],v23 offset:27808
v_mfma_f32_16x16x32_bf16 v[160:163],a[204:207],v[68:71],v[160:163]
ds_read_b64_tr_b16 a[222:223],v23 offset:32416
v_mfma_f32_16x16x32_bf16 v[196:199],a[200:203],v[80:83],v[196:199]
buffer_load_dwordx4 v29,s[20:23],s41 offen offset:3072 lds
v_mfma_f32_16x16x32_bf16 v[196:199],a[204:207],v[84:87],v[196:199]
v_mfma_f32_16x16x32_bf16 v[232:235],a[200:203],v[96:99],v[232:235]
v_mfma_f32_16x16x32_bf16 v[232:235],a[204:207],v[100:103],v[232:235]
s_waitcnt lgkmcnt(4)
v_mfma_f32_16x16x32_bf16 v[128:131],a[208:211],v[48:51],v[128:131]
ds_read_b64_tr_b16 a[192:193],v23 offset:18624
s_add_u32 s72,s78,24576
v_mfma_f32_16x16x32_bf16 v[128:131],a[212:215],v[52:55],v[128:131]
ds_read_b64_tr_b16 a[194:195],v23 offset:23232
v_mfma_f32_16x16x32_bf16 v[164:167],a[208:211],v[64:67],v[164:167]
ds_read_b64_tr_b16 a[196:197],v23 offset:27840
v_mfma_f32_16x16x32_bf16 v[164:167],a[212:215],v[68:71],v[164:167]
ds_read_b64_tr_b16 a[198:199],v23 offset:32448
v_mfma_f32_16x16x32_bf16 v[200:203],a[208:211],v[80:83],v[200:203]
buffer_store_dwordx4 v[72:75],v3,s[28:31],s72 offen offset:1024 sc1
v_mfma_f32_16x16x32_bf16 v[200:203],a[212:215],v[84:87],v[200:203]
v_mfma_f32_16x16x32_bf16 v[236:239],a[208:211],v[96:99],v[236:239]
v_mfma_f32_16x16x32_bf16 v[236:239],a[212:215],v[100:103],v[236:239]
s_waitcnt lgkmcnt(4)
v_mfma_f32_16x16x32_bf16 v[132:135],a[216:219],v[48:51],v[132:135]
ds_read_b64_tr_b16 a[200:201],v23 offset:18656
s_add_u32 m0,s65,4096
v_mfma_f32_16x16x32_bf16 v[132:135],a[220:223],v[52:55],v[132:135]
ds_read_b64_tr_b16 a[202:203],v23 offset:23264
s_add_u32 s41,s76,0
v_mfma_f32_16x16x32_bf16 v[168:171],a[216:219],v[64:67],v[168:171]
ds_read_b64_tr_b16 a[204:205],v23 offset:27872
v_mfma_f32_16x16x32_bf16 v[168:171],a[220:223],v[68:71],v[168:171]
ds_read_b64_tr_b16 a[206:207],v23 offset:32480
v_mfma_f32_16x16x32_bf16 v[204:207],a[216:219],v[80:83],v[204:207]
buffer_load_dwordx4 v42,s[20:23],s41 offen lds
v_mfma_f32_16x16x32_bf16 v[204:207],a[220:223],v[84:87],v[204:207]
v_mfma_f32_16x16x32_bf16 v[240:243],a[216:219],v[96:99],v[240:243]
s_add_u32 s72,s78,24576
v_mfma_f32_16x16x32_bf16 v[240:243],a[220:223],v[100:103],v[240:243]
buffer_store_dwordx4 v[88:91],v3,s[28:31],s72 offen offset:2048 sc1
s_waitcnt lgkmcnt(3)
v_mfma_f32_16x16x32_bf16 v[136:139],a[192:195],v[48:51],v[136:139]
ds_read_b64_tr_b16 a[208:209],v23 offset:18688
v_mfma_f32_16x16x32_bf16 v[136:139],a[196:199],v[52:55],v[136:139]
ds_read_b64_tr_b16 a[210:211],v23 offset:23296
v_mfma_f32_16x16x32_bf16 v[172:175],a[192:195],v[64:67],v[172:175]
ds_read_b64_tr_b16 a[212:213],v23 offset:27904
v_mfma_f32_16x16x32_bf16 v[172:175],a[196:199],v[68:71],v[172:175]
ds_read_b64_tr_b16 a[214:215],v23 offset:32512
v_mfma_f32_16x16x32_bf16 v[208:211],a[192:195],v[80:83],v[208:211]
v_mfma_f32_16x16x32_bf16 v[208:211],a[196:199],v[84:87],v[208:211]
v_mfma_f32_16x16x32_bf16 v[244:247],a[192:195],v[96:99],v[244:247]
buffer_load_dwordx4 v37,s[20:23],s41 offen offset:1024 lds
v_mfma_f32_16x16x32_bf16 v[244:247],a[196:199],v[100:103],v[244:247]
s_waitcnt lgkmcnt(4)
v_mfma_f32_16x16x32_bf16 v[140:143],a[200:203],v[48:51],v[140:143]
ds_read_b64_tr_b16 a[216:217],v28 offset:18432
v_mfma_f32_16x16x32_bf16 v[140:143],a[204:207],v[52:55],v[140:143]
ds_read_b64_tr_b16 a[218:219],v28 offset:23040
v_mfma_f32_16x16x32_bf16 v[176:179],a[200:203],v[64:67],v[176:179]
ds_read_b64_tr_b16 a[220:221],v28 offset:27648
v_mfma_f32_16x16x32_bf16 v[176:179],a[204:207],v[68:71],v[176:179]
ds_read_b64_tr_b16 a[222:223],v28 offset:32256
v_mfma_f32_16x16x32_bf16 v[212:215],a[200:203],v[80:83],v[212:215]
s_add_u32 s72,s78,24576
v_mfma_f32_16x16x32_bf16 v[212:215],a[204:207],v[84:87],v[212:215]
buffer_store_dwordx4 v[104:107],v3,s[28:31],s72 offen offset:3072 sc1
v_mfma_f32_16x16x32_bf16 v[248:251],a[200:203],v[96:99],v[248:251]
v_mfma_f32_16x16x32_bf16 v[248:251],a[204:207],v[100:103],v[248:251]
s_waitcnt lgkmcnt(4)
v_mfma_f32_16x16x32_bf16 v[144:147],a[208:211],v[48:51],v[144:147]
ds_read_b64_tr_b16 a[192:193],v28 offset:18464
v_mfma_f32_16x16x32_bf16 v[144:147],a[212:215],v[52:55],v[144:147]
ds_read_b64_tr_b16 a[194:195],v28 offset:23072
v_mfma_f32_16x16x32_bf16 v[180:183],a[208:211],v[64:67],v[180:183]
ds_read_b64_tr_b16 a[196:197],v28 offset:27680
v_mfma_f32_16x16x32_bf16 v[180:183],a[212:215],v[68:71],v[180:183]
ds_read_b64_tr_b16 a[198:199],v28 offset:32288
v_mfma_f32_16x16x32_bf16 v[216:219],a[208:211],v[80:83],v[216:219]
buffer_load_dwordx4 v38,s[20:23],s41 offen offset:2048 lds
v_mfma_f32_16x16x32_bf16 v[216:219],a[212:215],v[84:87],v[216:219]
v_mfma_f32_16x16x32_bf16 v[252:255],a[208:211],v[96:99],v[252:255]
v_mfma_f32_16x16x32_bf16 v[252:255],a[212:215],v[100:103],v[252:255]
s_waitcnt lgkmcnt(4)
v_mfma_f32_16x16x32_bf16 v[112:115],a[216:219],v[56:59],v[112:115]
ds_read_b64_tr_b16 a[200:201],v28 offset:18496
v_mfma_f32_16x16x32_bf16 v[112:115],a[220:223],v[60:63],v[112:115]
ds_read_b64_tr_b16 a[202:203],v28 offset:23104
v_mfma_f32_16x16x32_bf16 v[148:151],a[216:219],v[72:75],v[148:151]
ds_read_b64_tr_b16 a[204:205],v28 offset:27712
s_add_u32 s72,s78,28672
v_mfma_f32_16x16x32_bf16 v[148:151],a[220:223],v[76:79],v[148:151]
ds_read_b64_tr_b16 a[206:207],v28 offset:32320
v_mfma_f32_16x16x32_bf16 v[184:187],a[216:219],v[88:91],v[184:187]
buffer_store_dwordx4 v[60:63],v3,s[28:31],s72 offen sc1
v_mfma_f32_16x16x32_bf16 v[184:187],a[220:223],v[92:95],v[184:187]
v_mfma_f32_16x16x32_bf16 v[220:223],a[216:219],v[104:107],v[220:223]
v_mfma_f32_16x16x32_bf16 v[220:223],a[220:223],v[108:111],v[220:223]
s_waitcnt lgkmcnt(4)
v_mfma_f32_16x16x32_bf16 v[116:119],a[192:195],v[56:59],v[116:119]
ds_read_b64_tr_b16 a[208:209],v28 offset:18528
v_mfma_f32_16x16x32_bf16 v[116:119],a[196:199],v[60:63],v[116:119]
ds_read_b64_tr_b16 a[210:211],v28 offset:23136
v_mfma_f32_16x16x32_bf16 v[152:155],a[192:195],v[72:75],v[152:155]
ds_read_b64_tr_b16 a[212:213],v28 offset:27744
v_mfma_f32_16x16x32_bf16 v[152:155],a[196:199],v[76:79],v[152:155]
ds_read_b64_tr_b16 a[214:215],v28 offset:32352
v_mfma_f32_16x16x32_bf16 v[188:191],a[192:195],v[88:91],v[188:191]
buffer_load_dwordx4 v39,s[20:23],s41 offen offset:3072 lds
v_mfma_f32_16x16x32_bf16 v[188:191],a[196:199],v[92:95],v[188:191]
v_mfma_f32_16x16x32_bf16 v[224:227],a[192:195],v[104:107],v[224:227]
s_add_u32 s68,s80,0
v_mfma_f32_16x16x32_bf16 v[224:227],a[196:199],v[108:111],v[224:227]
buffer_load_dwordx4 a[64:67],v3,s[28:31],s68 offen sc1
s_waitcnt lgkmcnt(4)
v_mfma_f32_16x16x32_bf16 v[120:123],a[200:203],v[56:59],v[120:123]
ds_read_b64_tr_b16 a[216:217],v28 offset:18560
s_add_u32 s72,s78,28672
v_mfma_f32_16x16x32_bf16 v[120:123],a[204:207],v[60:63],v[120:123]
ds_read_b64_tr_b16 a[218:219],v28 offset:23168
v_mfma_f32_16x16x32_bf16 v[156:159],a[200:203],v[72:75],v[156:159]
ds_read_b64_tr_b16 a[220:221],v28 offset:27776
v_mfma_f32_16x16x32_bf16 v[156:159],a[204:207],v[76:79],v[156:159]
ds_read_b64_tr_b16 a[222:223],v28 offset:32384
v_mfma_f32_16x16x32_bf16 v[192:195],a[200:203],v[88:91],v[192:195]
buffer_store_dwordx4 v[76:79],v3,s[28:31],s72 offen offset:1024 sc1
v_mfma_f32_16x16x32_bf16 v[192:195],a[204:207],v[92:95],v[192:195]
v_mfma_f32_16x16x32_bf16 v[228:231],a[200:203],v[104:107],v[228:231]
buffer_load_dwordx4 a[80:83],v3,s[28:31],s68 offen offset:1024 sc1
v_mfma_f32_16x16x32_bf16 v[228:231],a[204:207],v[108:111],v[228:231]
s_waitcnt lgkmcnt(4)
v_mfma_f32_16x16x32_bf16 v[124:127],a[208:211],v[56:59],v[124:127]
ds_read_b64_tr_b16 a[192:193],v28 offset:18592
s_add_u32 m0,s65,8192
v_mfma_f32_16x16x32_bf16 v[124:127],a[212:215],v[60:63],v[124:127]
ds_read_b64_tr_b16 a[194:195],v28 offset:23200
s_add_u32 s41,s76,0
v_mfma_f32_16x16x32_bf16 v[160:163],a[208:211],v[72:75],v[160:163]
ds_read_b64_tr_b16 a[196:197],v28 offset:27808
v_mfma_f32_16x16x32_bf16 v[160:163],a[212:215],v[76:79],v[160:163]
ds_read_b64_tr_b16 a[198:199],v28 offset:32416
v_mfma_f32_16x16x32_bf16 v[196:199],a[208:211],v[88:91],v[196:199]
buffer_load_dwordx4 v40,s[20:23],s41 offen lds
v_mfma_f32_16x16x32_bf16 v[196:199],a[212:215],v[92:95],v[196:199]
v_mfma_f32_16x16x32_bf16 v[232:235],a[208:211],v[104:107],v[232:235]
s_add_u32 s72,s78,28672
v_mfma_f32_16x16x32_bf16 v[232:235],a[212:215],v[108:111],v[232:235]
buffer_store_dwordx4 v[92:95],v3,s[28:31],s72 offen offset:2048 sc1
s_waitcnt lgkmcnt(3)
v_mfma_f32_16x16x32_bf16 v[128:131],a[216:219],v[56:59],v[128:131]
ds_read_b64_tr_b16 a[200:201],v28 offset:18624
v_mfma_f32_16x16x32_bf16 v[128:131],a[220:223],v[60:63],v[128:131]
ds_read_b64_tr_b16 a[202:203],v28 offset:23232
v_mfma_f32_16x16x32_bf16 v[164:167],a[216:219],v[72:75],v[164:167]
ds_read_b64_tr_b16 a[204:205],v28 offset:27840
v_mfma_f32_16x16x32_bf16 v[164:167],a[220:223],v[76:79],v[164:167]
ds_read_b64_tr_b16 a[206:207],v28 offset:32448
v_mfma_f32_16x16x32_bf16 v[200:203],a[216:219],v[88:91],v[200:203]
buffer_load_dwordx4 a[96:99],v3,s[28:31],s68 offen offset:2048 sc1
v_mfma_f32_16x16x32_bf16 v[200:203],a[220:223],v[92:95],v[200:203]
v_mfma_f32_16x16x32_bf16 v[236:239],a[216:219],v[104:107],v[236:239]
buffer_load_dwordx4 a[112:115],v3,s[28:31],s68 offen offset:3072 sc1
v_mfma_f32_16x16x32_bf16 v[236:239],a[220:223],v[108:111],v[236:239]
s_waitcnt lgkmcnt(4)
v_mfma_f32_16x16x32_bf16 v[132:135],a[192:195],v[56:59],v[132:135]
ds_read_b64_tr_b16 a[208:209],v28 offset:18656
v_mfma_f32_16x16x32_bf16 v[132:135],a[196:199],v[60:63],v[132:135]
ds_read_b64_tr_b16 a[210:211],v28 offset:23264
v_mfma_f32_16x16x32_bf16 v[168:171],a[192:195],v[72:75],v[168:171]
ds_read_b64_tr_b16 a[212:213],v28 offset:27872
v_mfma_f32_16x16x32_bf16 v[168:171],a[196:199],v[76:79],v[168:171]
ds_read_b64_tr_b16 a[214:215],v28 offset:32480
v_mfma_f32_16x16x32_bf16 v[204:207],a[192:195],v[88:91],v[204:207]
s_add_u32 s72,s78,28672
v_mfma_f32_16x16x32_bf16 v[204:207],a[196:199],v[92:95],v[204:207]
buffer_store_dwordx4 v[108:111],v3,s[28:31],s72 offen offset:3072 sc1
v_mfma_f32_16x16x32_bf16 v[240:243],a[192:195],v[104:107],v[240:243]
s_add_u32 s68,s80,4096
v_mfma_f32_16x16x32_bf16 v[240:243],a[196:199],v[108:111],v[240:243]
buffer_load_dwordx4 a[68:71],v3,s[28:31],s68 offen sc1
s_waitcnt lgkmcnt(4)
v_mfma_f32_16x16x32_bf16 v[136:139],a[200:203],v[56:59],v[136:139]
ds_read_b64_tr_b16 a[216:217],v28 offset:18688
v_mfma_f32_16x16x32_bf16 v[136:139],a[204:207],v[60:63],v[136:139]
ds_read_b64_tr_b16 a[218:219],v28 offset:23296
v_mfma_f32_16x16x32_bf16 v[172:175],a[200:203],v[72:75],v[172:175]
ds_read_b64_tr_b16 a[220:221],v28 offset:27904
v_mfma_f32_16x16x32_bf16 v[172:175],a[204:207],v[76:79],v[172:175]
ds_read_b64_tr_b16 a[222:223],v28 offset:32512
v_mfma_f32_16x16x32_bf16 v[208:211],a[200:203],v[88:91],v[208:211]
v_mfma_f32_16x16x32_bf16 v[208:211],a[204:207],v[92:95],v[208:211]
v_mfma_f32_16x16x32_bf16 v[244:247],a[200:203],v[104:107],v[244:247]
s_waitcnt vmcnt(46)
v_mfma_f32_16x16x32_bf16 v[244:247],a[204:207],v[108:111],v[244:247]
s_waitcnt lgkmcnt(0)
s_barrier
v_mfma_f32_16x16x32_bf16 v[140:143],a[208:211],v[56:59],v[140:143]
ds_read_b64_tr_b16 a[192:193],v23 offset:36864
v_mfma_f32_16x16x32_bf16 v[140:143],a[212:215],v[60:63],v[140:143]
ds_read_b64_tr_b16 a[194:195],v23 offset:41472
v_mfma_f32_16x16x32_bf16 v[176:179],a[208:211],v[72:75],v[176:179]
ds_read_b64_tr_b16 a[196:197],v23 offset:46080
v_mfma_f32_16x16x32_bf16 v[176:179],a[212:215],v[76:79],v[176:179]
ds_read_b64_tr_b16 a[198:199],v23 offset:50688
v_mfma_f32_16x16x32_bf16 v[212:215],a[208:211],v[88:91],v[212:215]
buffer_load_dwordx4 a[84:87],v3,s[28:31],s68 offen offset:1024 sc1
v_mfma_f32_16x16x32_bf16 v[212:215],a[212:215],v[92:95],v[212:215]
s_add_u32 m0,s65,18432
v_mfma_f32_16x16x32_bf16 v[248:251],a[208:211],v[104:107],v[248:251]
s_add_u32 s41,s77,0
v_mfma_f32_16x16x32_bf16 v[248:251],a[212:215],v[108:111],v[248:251]
buffer_load_dwordx4 v1,s[20:23],s41 offen lds
v_mfma_f32_16x16x32_bf16 v[144:147],a[216:219],v[56:59],v[144:147]
ds_read_b64_tr_b16 a[200:201],v23 offset:36896
v_mfma_f32_16x16x32_bf16 v[144:147],a[220:223],v[60:63],v[144:147]
ds_read_b64_tr_b16 a[202:203],v23 offset:41504
v_mfma_f32_16x16x32_bf16 v[180:183],a[216:219],v[72:75],v[180:183]
ds_read_b64_tr_b16 a[204:205],v23 offset:46112
v_mfma_f32_16x16x32_bf16 v[180:183],a[220:223],v[76:79],v[180:183]
ds_read_b64_tr_b16 a[206:207],v23 offset:50720
v_mfma_f32_16x16x32_bf16 v[216:219],a[216:219],v[88:91],v[216:219]
buffer_load_dwordx4 a[100:103],v3,s[28:31],s68 offen offset:2048 sc1
v_mfma_f32_16x16x32_bf16 v[216:219],a[220:223],v[92:95],v[216:219]
v_mfma_f32_16x16x32_bf16 v[252:255],a[216:219],v[104:107],v[252:255]
buffer_load_dwordx4 v2,s[20:23],s41 offen offset:1024 lds
v_mfma_f32_16x16x32_bf16 v[252:255],a[220:223],v[108:111],v[252:255]
s_waitcnt vmcnt(42)
s_waitcnt lgkmcnt(4)
v_mfma_f32_16x16x32_bf16 v[112:115],a[192:195],a[128:131],v[112:115]
ds_read_b64_tr_b16 a[208:209],v23 offset:36928
v_mfma_f32_16x16x32_bf16 v[112:115],a[196:199],a[132:135],v[112:115]
ds_read_b64_tr_b16 a[210:211],v23 offset:41536
v_mfma_f32_16x16x32_bf16 v[148:151],a[192:195],a[144:147],v[148:151]
ds_read_b64_tr_b16 a[212:213],v23 offset:46144
v_mfma_f32_16x16x32_bf16 v[148:151],a[196:199],a[148:151],v[148:151]
ds_read_b64_tr_b16 a[214:215],v23 offset:50752
v_mfma_f32_16x16x32_bf16 v[184:187],a[192:195],a[160:163],v[184:187]
buffer_load_dwordx4 a[116:119],v3,s[28:31],s68 offen offset:3072 sc1
v_mfma_f32_16x16x32_bf16 v[184:187],a[196:199],a[164:167],v[184:187]
v_mfma_f32_16x16x32_bf16 v[220:223],a[192:195],a[176:179],v[220:223]
s_add_u32 s68,s80,8192
v_mfma_f32_16x16x32_bf16 v[220:223],a[196:199],a[180:183],v[220:223]
buffer_load_dwordx4 a[72:75],v3,s[28:31],s68 offen sc1
s_waitcnt lgkmcnt(4)
v_mfma_f32_16x16x32_bf16 v[116:119],a[200:203],a[128:131],v[116:119]
ds_read_b64_tr_b16 a[216:217],v23 offset:36960
v_mfma_f32_16x16x32_bf16 v[116:119],a[204:207],a[132:135],v[116:119]
ds_read_b64_tr_b16 a[218:219],v23 offset:41568
v_mfma_f32_16x16x32_bf16 v[152:155],a[200:203],a[144:147],v[152:155]
ds_read_b64_tr_b16 a[220:221],v23 offset:46176
v_mfma_f32_16x16x32_bf16 v[152:155],a[204:207],a[148:151],v[152:155]
ds_read_b64_tr_b16 a[222:223],v23 offset:50784
v_mfma_f32_16x16x32_bf16 v[188:191],a[200:203],a[160:163],v[188:191]
buffer_load_dwordx4 v22,s[20:23],s41 offen offset:2048 lds
v_mfma_f32_16x16x32_bf16 v[188:191],a[204:207],a[164:167],v[188:191]
v_mfma_f32_16x16x32_bf16 v[224:227],a[200:203],a[176:179],v[224:227]
buffer_load_dwordx4 a[88:91],v3,s[28:31],s68 offen offset:1024 sc1
v_mfma_f32_16x16x32_bf16 v[224:227],a[204:207],a[180:183],v[224:227]
s_waitcnt lgkmcnt(4)
v_mfma_f32_16x16x32_bf16 v[120:123],a[208:211],a[128:131],v[120:123]
ds_read_b64_tr_b16 a[192:193],v23 offset:36992
v_mfma_f32_16x16x32_bf16 v[120:123],a[212:215],a[132:135],v[120:123]
ds_read_b64_tr_b16 a[194:195],v23 offset:41600
v_mfma_f32_16x16x32_bf16 v[156:159],a[208:211],a[144:147],v[156:159]
ds_read_b64_tr_b16 a[196:197],v23 offset:46208
v_mfma_f32_16x16x32_bf16 v[156:159],a[212:215],a[148:151],v[156:159]
ds_read_b64_tr_b16 a[198:199],v23 offset:50816
v_mfma_f32_16x16x32_bf16 v[192:195],a[208:211],a[160:163],v[192:195]
v_mfma_f32_16x16x32_bf16 v[192:195],a[212:215],a[164:167],v[192:195]
v_mfma_f32_16x16x32_bf16 v[228:231],a[208:211],a[176:179],v[228:231]
buffer_load_dwordx4 a[104:107],v3,s[28:31],s68 offen offset:2048 sc1
v_mfma_f32_16x16x32_bf16 v[228:231],a[212:215],a[180:183],v[228:231]
s_waitcnt lgkmcnt(4)
v_mfma_f32_16x16x32_bf16 v[124:127],a[216:219],a[128:131],v[124:127]
ds_read_b64_tr_b16 a[200:201],v23 offset:37024
v_mfma_f32_16x16x32_bf16 v[124:127],a[220:223],a[132:135],v[124:127]
ds_read_b64_tr_b16 a[202:203],v23 offset:41632
v_mfma_f32_16x16x32_bf16 v[160:163],a[216:219],a[144:147],v[160:163]
ds_read_b64_tr_b16 a[204:205],v23 offset:46240
v_mfma_f32_16x16x32_bf16 v[160:163],a[220:223],a[148:151],v[160:163]
ds_read_b64_tr_b16 a[206:207],v23 offset:50848
v_mfma_f32_16x16x32_bf16 v[196:199],a[216:219],a[160:163],v[196:199]
buffer_load_dwordx4 v29,s[20:23],s41 offen offset:3072 lds
v_mfma_f32_16x16x32_bf16 v[196:199],a[220:223],a[164:167],v[196:199]
v_mfma_f32_16x16x32_bf16 v[232:235],a[216:219],a[176:179],v[232:235]
buffer_load_dwordx4 a[120:123],v3,s[28:31],s68 offen offset:3072 sc1
v_mfma_f32_16x16x32_bf16 v[232:235],a[220:223],a[180:183],v[232:235]
s_waitcnt lgkmcnt(4)
v_mfma_f32_16x16x32_bf16 v[128:131],a[192:195],a[128:131],v[128:131]
ds_read_b64_tr_b16 a[208:209],v23 offset:37056
v_mfma_f32_16x16x32_bf16 v[128:131],a[196:199],a[132:135],v[128:131]
ds_read_b64_tr_b16 a[210:211],v23 offset:41664
v_mfma_f32_16x16x32_bf16 v[164:167],a[192:195],a[144:147],v[164:167]
ds_read_b64_tr_b16 a[212:213],v23 offset:46272
v_mfma_f32_16x16x32_bf16 v[164:167],a[196:199],a[148:151],v[164:167]
ds_read_b64_tr_b16 a[214:215],v23 offset:50880
v_mfma_f32_16x16x32_bf16 v[200:203],a[192:195],a[160:163],v[200:203]
v_mfma_f32_16x16x32_bf16 v[200:203],a[196:199],a[164:167],v[200:203]
v_mfma_f32_16x16x32_bf16 v[236:239],a[192:195],a[176:179],v[236:239]
s_add_u32 s68,s80,12288
v_mfma_f32_16x16x32_bf16 v[236:239],a[196:199],a[180:183],v[236:239]
buffer_load_dwordx4 a[76:79],v3,s[28:31],s68 offen sc1
s_waitcnt lgkmcnt(4)
v_mfma_f32_16x16x32_bf16 v[132:135],a[200:203],a[128:131],v[132:135]
ds_read_b64_tr_b16 a[216:217],v23 offset:37088
s_add_u32 m0,s65,22528
v_mfma_f32_16x16x32_bf16 v[132:135],a[204:207],a[132:135],v[132:135]
ds_read_b64_tr_b16 a[218:219],v23 offset:41696
s_add_u32 s41,s77,0
v_mfma_f32_16x16x32_bf16 v[168:171],a[200:203],a[144:147],v[168:171]
ds_read_b64_tr_b16 a[220:221],v23 offset:46304
v_mfma_f32_16x16x32_bf16 v[168:171],a[204:207],a[148:151],v[168:171]
ds_read_b64_tr_b16 a[222:223],v23 offset:50912
v_mfma_f32_16x16x32_bf16 v[204:207],a[200:203],a[160:163],v[204:207]
buffer_load_dwordx4 v42,s[20:23],s41 offen lds
v_mfma_f32_16x16x32_bf16 v[204:207],a[204:207],a[164:167],v[204:207]
s_waitcnt vmcnt(14)
buffer_atomic_add v26,v25,s[32:35],s69 offen sc1
s_add_u32 s69,s69,0x10000
v_mfma_f32_16x16x32_bf16 v[240:243],a[200:203],a[176:179],v[240:243]
buffer_load_dwordx4 a[92:95],v3,s[28:31],s68 offen offset:1024 sc1
v_mfma_f32_16x16x32_bf16 v[240:243],a[204:207],a[180:183],v[240:243]
s_waitcnt lgkmcnt(3)
v_mfma_f32_16x16x32_bf16 v[136:139],a[208:211],a[128:131],v[136:139]
ds_read_b64_tr_b16 a[192:193],v23 offset:37120
v_mfma_f32_16x16x32_bf16 v[136:139],a[212:215],a[132:135],v[136:139]
ds_read_b64_tr_b16 a[194:195],v23 offset:41728
v_mfma_f32_16x16x32_bf16 v[172:175],a[208:211],a[144:147],v[172:175]
ds_read_b64_tr_b16 a[196:197],v23 offset:46336
v_mfma_f32_16x16x32_bf16 v[172:175],a[212:215],a[148:151],v[172:175]
ds_read_b64_tr_b16 a[198:199],v23 offset:50944
v_mfma_f32_16x16x32_bf16 v[208:211],a[208:211],a[160:163],v[208:211]
v_mfma_f32_16x16x32_bf16 v[208:211],a[212:215],a[164:167],v[208:211]
v_mfma_f32_16x16x32_bf16 v[244:247],a[208:211],a[176:179],v[244:247]
buffer_load_dwordx4 v37,s[20:23],s41 offen offset:1024 lds
v_mfma_f32_16x16x32_bf16 v[244:247],a[212:215],a[180:183],v[244:247]
buffer_load_dwordx4 a[108:111],v3,s[28:31],s68 offen offset:2048 sc1
s_waitcnt lgkmcnt(4)
v_mfma_f32_16x16x32_bf16 v[140:143],a[216:219],a[128:131],v[140:143]
ds_read_b64_tr_b16 a[200:201],v28 offset:36864
v_mfma_f32_16x16x32_bf16 v[140:143],a[220:223],a[132:135],v[140:143]
ds_read_b64_tr_b16 a[202:203],v28 offset:41472
v_mfma_f32_16x16x32_bf16 v[176:179],a[216:219],a[144:147],v[176:179]
ds_read_b64_tr_b16 a[204:205],v28 offset:46080
v_mfma_f32_16x16x32_bf16 v[176:179],a[220:223],a[148:151],v[176:179]
ds_read_b64_tr_b16 a[206:207],v28 offset:50688
v_mfma_f32_16x16x32_bf16 v[212:215],a[216:219],a[160:163],v[212:215]
v_mfma_f32_16x16x32_bf16 v[212:215],a[220:223],a[164:167],v[212:215]
v_mfma_f32_16x16x32_bf16 v[248:251],a[216:219],a[176:179],v[248:251]
buffer_load_dwordx4 a[124:127],v3,s[28:31],s68 offen offset:3072 sc1
v_mfma_f32_16x16x32_bf16 v[248:251],a[220:223],a[180:183],v[248:251]
s_waitcnt lgkmcnt(4)
v_mfma_f32_16x16x32_bf16 v[144:147],a[192:195],a[128:131],v[144:147]
ds_read_b64_tr_b16 a[208:209],v28 offset:36896
v_mfma_f32_16x16x32_bf16 v[144:147],a[196:199],a[132:135],v[144:147]
ds_read_b64_tr_b16 a[210:211],v28 offset:41504
v_mfma_f32_16x16x32_bf16 v[180:183],a[192:195],a[144:147],v[180:183]
ds_read_b64_tr_b16 a[212:213],v28 offset:46112
v_mfma_f32_16x16x32_bf16 v[180:183],a[196:199],a[148:151],v[180:183]
ds_read_b64_tr_b16 a[214:215],v28 offset:50720
v_mfma_f32_16x16x32_bf16 v[216:219],a[192:195],a[160:163],v[216:219]
buffer_load_dwordx4 v38,s[20:23],s41 offen offset:2048 lds
v_mfma_f32_16x16x32_bf16 v[216:219],a[196:199],a[164:167],v[216:219]
v_mfma_f32_16x16x32_bf16 v[252:255],a[192:195],a[176:179],v[252:255]
s_add_u32 s68,s81,0
v_mfma_f32_16x16x32_bf16 v[252:255],a[196:199],a[180:183],v[252:255]
s_waitcnt lgkmcnt(4)
v_mfma_f32_16x16x32_bf16 v[112:115],a[200:203],a[136:139],v[112:115]
ds_read_b64_tr_b16 a[216:217],v28 offset:36928
v_mfma_f32_16x16x32_bf16 v[112:115],a[204:207],a[140:143],v[112:115]
ds_read_b64_tr_b16 a[218:219],v28 offset:41536
v_mfma_f32_16x16x32_bf16 v[148:151],a[200:203],a[152:155],v[148:151]
ds_read_b64_tr_b16 a[220:221],v28 offset:46144
v_mfma_f32_16x16x32_bf16 v[148:151],a[204:207],a[156:159],v[148:151]
ds_read_b64_tr_b16 a[222:223],v28 offset:50752
v_mfma_f32_16x16x32_bf16 v[184:187],a[200:203],a[168:171],v[184:187]
buffer_load_dwordx4 a[0:3],v3,s[28:31],s68 offen sc1
v_mfma_f32_16x16x32_bf16 v[184:187],a[204:207],a[172:175],v[184:187]
v_mfma_f32_16x16x32_bf16 v[220:223],a[200:203],a[184:187],v[220:223]
buffer_load_dwordx4 a[16:19],v3,s[28:31],s68 offen offset:1024 sc1
v_mfma_f32_16x16x32_bf16 v[220:223],a[204:207],a[188:191],v[220:223]
s_waitcnt lgkmcnt(4)
v_mfma_f32_16x16x32_bf16 v[116:119],a[208:211],a[136:139],v[116:119]
ds_read_b64_tr_b16 a[192:193],v28 offset:36960
v_mfma_f32_16x16x32_bf16 v[116:119],a[212:215],a[140:143],v[116:119]
ds_read_b64_tr_b16 a[194:195],v28 offset:41568
v_mfma_f32_16x16x32_bf16 v[152:155],a[208:211],a[152:155],v[152:155]
ds_read_b64_tr_b16 a[196:197],v28 offset:46176
v_mfma_f32_16x16x32_bf16 v[152:155],a[212:215],a[156:159],v[152:155]
ds_read_b64_tr_b16 a[198:199],v28 offset:50784
v_mfma_f32_16x16x32_bf16 v[188:191],a[208:211],a[168:171],v[188:191]
buffer_load_dwordx4 v39,s[20:23],s41 offen offset:3072 lds
v_mfma_f32_16x16x32_bf16 v[188:191],a[212:215],a[172:175],v[188:191]
v_mfma_f32_16x16x32_bf16 v[224:227],a[208:211],a[184:187],v[224:227]
buffer_load_dwordx4 a[32:35],v3,s[28:31],s68 offen offset:2048 sc1
v_mfma_f32_16x16x32_bf16 v[224:227],a[212:215],a[188:191],v[224:227]
s_waitcnt lgkmcnt(4)
v_mfma_f32_16x16x32_bf16 v[120:123],a[216:219],a[136:139],v[120:123]
ds_read_b64_tr_b16 a[200:201],v28 offset:36992
v_mfma_f32_16x16x32_bf16 v[120:123],a[220:223],a[140:143],v[120:123]
ds_read_b64_tr_b16 a[202:203],v28 offset:41600
v_mfma_f32_16x16x32_bf16 v[156:159],a[216:219],a[152:155],v[156:159]
ds_read_b64_tr_b16 a[204:205],v28 offset:46208
v_mfma_f32_16x16x32_bf16 v[156:159],a[220:223],a[156:159],v[156:159]
ds_read_b64_tr_b16 a[206:207],v28 offset:50816
v_mfma_f32_16x16x32_bf16 v[192:195],a[216:219],a[168:171],v[192:195]
v_mfma_f32_16x16x32_bf16 v[192:195],a[220:223],a[172:175],v[192:195]
v_mfma_f32_16x16x32_bf16 v[228:231],a[216:219],a[184:187],v[228:231]
buffer_load_dwordx4 a[48:51],v3,s[28:31],s68 offen offset:3072 sc1
v_mfma_f32_16x16x32_bf16 v[228:231],a[220:223],a[188:191],v[228:231]
s_waitcnt lgkmcnt(4)
v_mfma_f32_16x16x32_bf16 v[124:127],a[192:195],a[136:139],v[124:127]
ds_read_b64_tr_b16 a[208:209],v28 offset:37024
s_add_u32 m0,s65,26624
v_mfma_f32_16x16x32_bf16 v[124:127],a[196:199],a[140:143],v[124:127]
ds_read_b64_tr_b16 a[210:211],v28 offset:41632
s_add_u32 s41,s77,0
v_mfma_f32_16x16x32_bf16 v[160:163],a[192:195],a[152:155],v[160:163]
ds_read_b64_tr_b16 a[212:213],v28 offset:46240
v_mfma_f32_16x16x32_bf16 v[160:163],a[196:199],a[156:159],v[160:163]
ds_read_b64_tr_b16 a[214:215],v28 offset:50848
v_mfma_f32_16x16x32_bf16 v[196:199],a[192:195],a[168:171],v[196:199]
buffer_load_dwordx4 v40,s[20:23],s41 offen lds
v_mfma_f32_16x16x32_bf16 v[196:199],a[196:199],a[172:175],v[196:199]
v_mfma_f32_16x16x32_bf16 v[232:235],a[192:195],a[184:187],v[232:235]
s_add_u32 s68,s81,4096
v_mfma_f32_16x16x32_bf16 v[232:235],a[196:199],a[188:191],v[232:235]
buffer_load_dwordx4 a[4:7],v3,s[28:31],s68 offen sc1
s_waitcnt lgkmcnt(3)
v_mfma_f32_16x16x32_bf16 v[128:131],a[200:203],a[136:139],v[128:131]
ds_read_b64_tr_b16 a[216:217],v28 offset:37056
v_mfma_f32_16x16x32_bf16 v[128:131],a[204:207],a[140:143],v[128:131]
ds_read_b64_tr_b16 a[218:219],v28 offset:41664
v_mfma_f32_16x16x32_bf16 v[164:167],a[200:203],a[152:155],v[164:167]
ds_read_b64_tr_b16 a[220:221],v28 offset:46272
v_mfma_f32_16x16x32_bf16 v[164:167],a[204:207],a[156:159],v[164:167]
ds_read_b64_tr_b16 a[222:223],v28 offset:50880
v_mfma_f32_16x16x32_bf16 v[200:203],a[200:203],a[168:171],v[200:203]
v_mfma_f32_16x16x32_bf16 v[200:203],a[204:207],a[172:175],v[200:203]
v_mfma_f32_16x16x32_bf16 v[236:239],a[200:203],a[184:187],v[236:239]
buffer_load_dwordx4 a[20:23],v3,s[28:31],s68 offen offset:1024 sc1
v_mfma_f32_16x16x32_bf16 v[236:239],a[204:207],a[188:191],v[236:239]
s_waitcnt lgkmcnt(4)
v_mfma_f32_16x16x32_bf16 v[132:135],a[208:211],a[136:139],v[132:135]
ds_read_b64_tr_b16 a[192:193],v28 offset:37088
v_mfma_f32_16x16x32_bf16 v[132:135],a[212:215],a[140:143],v[132:135]
ds_read_b64_tr_b16 a[194:195],v28 offset:41696
v_mfma_f32_16x16x32_bf16 v[168:171],a[208:211],a[152:155],v[168:171]
ds_read_b64_tr_b16 a[196:197],v28 offset:46304
v_mfma_f32_16x16x32_bf16 v[168:171],a[212:215],a[156:159],v[168:171]
ds_read_b64_tr_b16 a[198:199],v28 offset:50912
v_mfma_f32_16x16x32_bf16 v[204:207],a[208:211],a[168:171],v[204:207]
v_mfma_f32_16x16x32_bf16 v[204:207],a[212:215],a[172:175],v[204:207]
v_mfma_f32_16x16x32_bf16 v[240:243],a[208:211],a[184:187],v[240:243]
buffer_load_dwordx4 a[36:39],v3,s[28:31],s68 offen offset:2048 sc1
v_mfma_f32_16x16x32_bf16 v[240:243],a[212:215],a[188:191],v[240:243]
s_waitcnt lgkmcnt(4)
v_mfma_f32_16x16x32_bf16 v[136:139],a[216:219],a[136:139],v[136:139]
ds_read_b64_tr_b16 a[200:201],v28 offset:37120
v_mfma_f32_16x16x32_bf16 v[136:139],a[220:223],a[140:143],v[136:139]
ds_read_b64_tr_b16 a[202:203],v28 offset:41728
v_mfma_f32_16x16x32_bf16 v[172:175],a[216:219],a[152:155],v[172:175]
ds_read_b64_tr_b16 a[204:205],v28 offset:46336
v_mfma_f32_16x16x32_bf16 v[172:175],a[220:223],a[156:159],v[172:175]
ds_read_b64_tr_b16 a[206:207],v28 offset:50944
v_mfma_f32_16x16x32_bf16 v[208:211],a[216:219],a[168:171],v[208:211]
v_mfma_f32_16x16x32_bf16 v[208:211],a[220:223],a[172:175],v[208:211]
v_mfma_f32_16x16x32_bf16 v[244:247],a[216:219],a[184:187],v[244:247]
v_mfma_f32_16x16x32_bf16 v[244:247],a[220:223],a[188:191],v[244:247]
s_waitcnt lgkmcnt(0)
s_barrier
v_mfma_f32_16x16x32_bf16 v[140:143],a[192:195],a[136:139],v[140:143]
ds_read_b64_tr_b16 a[208:209],v23 offset:0
v_mfma_f32_16x16x32_bf16 v[140:143],a[196:199],a[140:143],v[140:143]
ds_read_b64_tr_b16 a[210:211],v23 offset:4608
v_mfma_f32_16x16x32_bf16 v[176:179],a[192:195],a[152:155],v[176:179]
ds_read_b64_tr_b16 a[212:213],v23 offset:9216
v_mfma_f32_16x16x32_bf16 v[176:179],a[196:199],a[156:159],v[176:179]
ds_read_b64_tr_b16 a[214:215],v23 offset:13824
v_mfma_f32_16x16x32_bf16 v[212:215],a[192:195],a[168:171],v[212:215]
buffer_load_dwordx4 a[52:55],v3,s[28:31],s68 offen offset:3072 sc1
v_mfma_f32_16x16x32_bf16 v[212:215],a[196:199],a[172:175],v[212:215]
s_add_u32 m0,s65,36864
v_mfma_f32_16x16x32_bf16 v[248:251],a[192:195],a[184:187],v[248:251]
s_add_u32 s41,s75,147456
v_mfma_f32_16x16x32_bf16 v[248:251],a[196:199],a[188:191],v[248:251]
buffer_load_dwordx4 v1,s[20:23],s41 offen lds
v_mfma_f32_16x16x32_bf16 v[144:147],a[200:203],a[136:139],v[144:147]
ds_read_b64_tr_b16 a[216:217],v23 offset:32
s_add_u32 s68,s81,8192
v_mfma_f32_16x16x32_bf16 v[144:147],a[204:207],a[140:143],v[144:147]
ds_read_b64_tr_b16 a[218:219],v23 offset:4640
v_mfma_f32_16x16x32_bf16 v[180:183],a[200:203],a[152:155],v[180:183]
ds_read_b64_tr_b16 a[220:221],v23 offset:9248
v_mfma_f32_16x16x32_bf16 v[180:183],a[204:207],a[156:159],v[180:183]
ds_read_b64_tr_b16 a[222:223],v23 offset:13856
v_mfma_f32_16x16x32_bf16 v[216:219],a[200:203],a[168:171],v[216:219]
buffer_load_dwordx4 a[8:11],v3,s[28:31],s68 offen sc1
v_mfma_f32_16x16x32_bf16 v[216:219],a[204:207],a[172:175],v[216:219]
v_mfma_f32_16x16x32_bf16 v[252:255],a[200:203],a[184:187],v[252:255]
buffer_load_dwordx4 v2,s[20:23],s41 offen offset:1024 lds
v_mfma_f32_16x16x32_bf16 v[252:255],a[204:207],a[188:191],v[252:255]
s_waitcnt vmcnt(27)
s_waitcnt lgkmcnt(4)
v_mfma_f32_16x16x32_bf16 v[112:115],a[208:211],a[64:67],v[112:115]
ds_read_b64_tr_b16 a[192:193],v23 offset:64
v_mfma_f32_16x16x32_bf16 v[112:115],a[212:215],a[68:71],v[112:115]
ds_read_b64_tr_b16 a[194:195],v23 offset:4672
v_mfma_f32_16x16x32_bf16 v[148:151],a[208:211],a[80:83],v[148:151]
ds_read_b64_tr_b16 a[196:197],v23 offset:9280
v_mfma_f32_16x16x32_bf16 v[148:151],a[212:215],a[84:87],v[148:151]
ds_read_b64_tr_b16 a[198:199],v23 offset:13888
v_mfma_f32_16x16x32_bf16 v[184:187],a[208:211],a[96:99],v[184:187]
buffer_load_dwordx4 a[24:27],v3,s[28:31],s68 offen offset:1024 sc1
v_mfma_f32_16x16x32_bf16 v[184:187],a[212:215],a[100:103],v[184:187]
v_mfma_f32_16x16x32_bf16 v[220:223],a[208:211],a[112:115],v[220:223]
buffer_load_dwordx4 a[40:43],v3,s[28:31],s68 offen offset:2048 sc1
v_mfma_f32_16x16x32_bf16 v[220:223],a[212:215],a[116:119],v[220:223]
s_waitcnt lgkmcnt(4)
v_mfma_f32_16x16x32_bf16 v[116:119],a[216:219],a[64:67],v[116:119]
ds_read_b64_tr_b16 a[200:201],v23 offset:96
v_mfma_f32_16x16x32_bf16 v[116:119],a[220:223],a[68:71],v[116:119]
ds_read_b64_tr_b16 a[202:203],v23 offset:4704
v_mfma_f32_16x16x32_bf16 v[152:155],a[216:219],a[80:83],v[152:155]
ds_read_b64_tr_b16 a[204:205],v23 offset:9312
v_mfma_f32_16x16x32_bf16 v[152:155],a[220:223],a[84:87],v[152:155]
ds_read_b64_tr_b16 a[206:207],v23 offset:13920
v_mfma_f32_16x16x32_bf16 v[188:191],a[216:219],a[96:99],v[188:191]
buffer_load_dword v24,v27,s[32:35],s82 offen sc1
v_mfma_f32_16x16x32_bf16 v[188:191],a[220:223],a[100:103],v[188:191]
buffer_load_dwordx4 v22,s[20:23],s41 offen offset:2048 lds
v_mfma_f32_16x16x32_bf16 v[224:227],a[216:219],a[112:115],v[224:227]
buffer_load_dwordx4 a[56:59],v3,s[28:31],s68 offen offset:3072 sc1
v_mfma_f32_16x16x32_bf16 v[224:227],a[220:223],a[116:119],v[224:227]
s_waitcnt lgkmcnt(4)
v_mfma_f32_16x16x32_bf16 v[120:123],a[192:195],a[64:67],v[120:123]
ds_read_b64_tr_b16 a[208:209],v23 offset:128
v_mfma_f32_16x16x32_bf16 v[120:123],a[196:199],a[68:71],v[120:123]
ds_read_b64_tr_b16 a[210:211],v23 offset:4736
v_mfma_f32_16x16x32_bf16 v[156:159],a[192:195],a[80:83],v[156:159]
ds_read_b64_tr_b16 a[212:213],v23 offset:9344
v_mfma_f32_16x16x32_bf16 v[156:159],a[196:199],a[84:87],v[156:159]
ds_read_b64_tr_b16 a[214:215],v23 offset:13952
v_mfma_f32_16x16x32_bf16 v[192:195],a[192:195],a[96:99],v[192:195]
v_mfma_f32_16x16x32_bf16 v[192:195],a[196:199],a[100:103],v[192:195]
v_mfma_f32_16x16x32_bf16 v[228:231],a[192:195],a[112:115],v[228:231]
s_add_u32 s68,s81,12288
v_mfma_f32_16x16x32_bf16 v[228:231],a[196:199],a[116:119],v[228:231]
buffer_load_dwordx4 a[12:15],v3,s[28:31],s68 offen sc1
s_waitcnt lgkmcnt(4)
v_mfma_f32_16x16x32_bf16 v[124:127],a[200:203],a[64:67],v[124:127]
ds_read_b64_tr_b16 a[216:217],v23 offset:160
v_mfma_f32_16x16x32_bf16 v[124:127],a[204:207],a[68:71],v[124:127]
ds_read_b64_tr_b16 a[218:219],v23 offset:4768
v_mfma_f32_16x16x32_bf16 v[160:163],a[200:203],a[80:83],v[160:163]
ds_read_b64_tr_b16 a[220:221],v23 offset:9376
v_mfma_f32_16x16x32_bf16 v[160:163],a[204:207],a[84:87],v[160:163]
ds_read_b64_tr_b16 a[222:223],v23 offset:13984
v_mfma_f32_16x16x32_bf16 v[196:199],a[200:203],a[96:99],v[196:199]
buffer_load_dwordx4 v29,s[20:23],s41 offen offset:3072 lds
v_mfma_f32_16x16x32_bf16 v[196:199],a[204:207],a[100:103],v[196:199]
v_mfma_f32_16x16x32_bf16 v[232:235],a[200:203],a[112:115],v[232:235]
buffer_load_dwordx4 a[28:31],v3,s[28:31],s68 offen offset:1024 sc1
v_mfma_f32_16x16x32_bf16 v[232:235],a[204:207],a[116:119],v[232:235]
s_waitcnt lgkmcnt(4)
v_mfma_f32_16x16x32_bf16 v[128:131],a[208:211],a[64:67],v[128:131]
ds_read_b64_tr_b16 a[192:193],v23 offset:192
v_mfma_f32_16x16x32_bf16 v[128:131],a[212:215],a[68:71],v[128:131]
ds_read_b64_tr_b16 a[194:195],v23 offset:4800
v_mfma_f32_16x16x32_bf16 v[164:167],a[208:211],a[80:83],v[164:167]
ds_read_b64_tr_b16 a[196:197],v23 offset:9408
v_mfma_f32_16x16x32_bf16 v[164:167],a[212:215],a[84:87],v[164:167]
ds_read_b64_tr_b16 a[198:199],v23 offset:14016
v_mfma_f32_16x16x32_bf16 v[200:203],a[208:211],a[96:99],v[200:203]
v_mfma_f32_16x16x32_bf16 v[200:203],a[212:215],a[100:103],v[200:203]
v_mfma_f32_16x16x32_bf16 v[236:239],a[208:211],a[112:115],v[236:239]
buffer_load_dwordx4 a[44:47],v3,s[28:31],s68 offen offset:2048 sc1
v_mfma_f32_16x16x32_bf16 v[236:239],a[212:215],a[116:119],v[236:239]
s_waitcnt lgkmcnt(4)
v_mfma_f32_16x16x32_bf16 v[132:135],a[216:219],a[64:67],v[132:135]
ds_read_b64_tr_b16 a[200:201],v23 offset:224
s_add_u32 m0,s65,40960
v_mfma_f32_16x16x32_bf16 v[132:135],a[220:223],a[68:71],v[132:135]
ds_read_b64_tr_b16 a[202:203],v23 offset:4832
s_add_u32 s41,s75,147456
v_mfma_f32_16x16x32_bf16 v[168:171],a[216:219],a[80:83],v[168:171]
ds_read_b64_tr_b16 a[204:205],v23 offset:9440
v_mfma_f32_16x16x32_bf16 v[168:171],a[220:223],a[84:87],v[168:171]
ds_read_b64_tr_b16 a[206:207],v23 offset:14048
v_mfma_f32_16x16x32_bf16 v[204:207],a[216:219],a[96:99],v[204:207]
buffer_load_dwordx4 v42,s[20:23],s41 offen lds
v_mfma_f32_16x16x32_bf16 v[204:207],a[220:223],a[100:103],v[204:207]
v_mfma_f32_16x16x32_bf16 v[240:243],a[216:219],a[112:115],v[240:243]
buffer_load_dwordx4 a[60:63],v3,s[28:31],s68 offen offset:3072 sc1
v_mfma_f32_16x16x32_bf16 v[240:243],a[220:223],a[116:119],v[240:243]
s_waitcnt lgkmcnt(4)
v_mfma_f32_16x16x32_bf16 v[136:139],a[192:195],a[64:67],v[136:139]
ds_read_b64_tr_b16 a[208:209],v23 offset:256
v_mfma_f32_16x16x32_bf16 v[136:139],a[196:199],a[68:71],v[136:139]
ds_read_b64_tr_b16 a[210:211],v23 offset:4864
v_mfma_f32_16x16x32_bf16 v[172:175],a[192:195],a[80:83],v[172:175]
ds_read_b64_tr_b16 a[212:213],v23 offset:9472
v_mfma_f32_16x16x32_bf16 v[172:175],a[196:199],a[84:87],v[172:175]
ds_read_b64_tr_b16 a[214:215],v23 offset:14080
v_mfma_f32_16x16x32_bf16 v[208:211],a[192:195],a[96:99],v[208:211]
v_mfma_f32_16x16x32_bf16 v[208:211],a[196:199],a[100:103],v[208:211]
v_mfma_f32_16x16x32_bf16 v[244:247],a[192:195],a[112:115],v[244:247]
buffer_load_dwordx4 v37,s[20:23],s41 offen offset:1024 lds
v_mfma_f32_16x16x32_bf16 v[244:247],a[196:199],a[116:119],v[244:247]
s_waitcnt lgkmcnt(4)
v_mfma_f32_16x16x32_bf16 v[140:143],a[200:203],a[64:67],v[140:143]
ds_read_b64_tr_b16 a[216:217],v28 offset:0
v_mfma_f32_16x16x32_bf16 v[140:143],a[204:207],a[68:71],v[140:143]
ds_read_b64_tr_b16 a[218:219],v28 offset:4608
v_mfma_f32_16x16x32_bf16 v[176:179],a[200:203],a[80:83],v[176:179]
ds_read_b64_tr_b16 a[220:221],v28 offset:9216
v_mfma_f32_16x16x32_bf16 v[176:179],a[204:207],a[84:87],v[176:179]
ds_read_b64_tr_b16 a[222:223],v28 offset:13824
v_mfma_f32_16x16x32_bf16 v[212:215],a[200:203],a[96:99],v[212:215]
v_mfma_f32_16x16x32_bf16 v[212:215],a[204:207],a[100:103],v[212:215]
v_mfma_f32_16x16x32_bf16 v[248:251],a[200:203],a[112:115],v[248:251]
v_mfma_f32_16x16x32_bf16 v[248:251],a[204:207],a[116:119],v[248:251]
s_waitcnt lgkmcnt(4)
v_mfma_f32_16x16x32_bf16 v[144:147],a[208:211],a[64:67],v[144:147]
ds_read_b64_tr_b16 a[192:193],v28 offset:32
v_mfma_f32_16x16x32_bf16 v[144:147],a[212:215],a[68:71],v[144:147]
ds_read_b64_tr_b16 a[194:195],v28 offset:4640
v_mfma_f32_16x16x32_bf16 v[180:183],a[208:211],a[80:83],v[180:183]
ds_read_b64_tr_b16 a[196:197],v28 offset:9248
v_mfma_f32_16x16x32_bf16 v[180:183],a[212:215],a[84:87],v[180:183]
ds_read_b64_tr_b16 a[198:199],v28 offset:13856
v_mfma_f32_16x16x32_bf16 v[216:219],a[208:211],a[96:99],v[216:219]
buffer_load_dwordx4 v38,s[20:23],s41 offen offset:2048 lds
v_mfma_f32_16x16x32_bf16 v[216:219],a[212:215],a[100:103],v[216:219]
v_mfma_f32_16x16x32_bf16 v[252:255],a[208:211],a[112:115],v[252:255]
v_mfma_f32_16x16x32_bf16 v[252:255],a[212:215],a[116:119],v[252:255]
s_waitcnt vmcnt(27)
s_waitcnt lgkmcnt(4)
v_mfma_f32_16x16x32_bf16 v[112:115],a[216:219],a[72:75],v[112:115]
ds_read_b64_tr_b16 a[200:201],v28 offset:64
v_mfma_f32_16x16x32_bf16 v[112:115],a[220:223],a[76:79],v[112:115]
ds_read_b64_tr_b16 a[202:203],v28 offset:4672
v_mfma_f32_16x16x32_bf16 v[148:151],a[216:219],a[88:91],v[148:151]
ds_read_b64_tr_b16 a[204:205],v28 offset:9280
v_mfma_f32_16x16x32_bf16 v[148:151],a[220:223],a[92:95],v[148:151]
ds_read_b64_tr_b16 a[206:207],v28 offset:13888
v_mfma_f32_16x16x32_bf16 v[184:187],a[216:219],a[104:107],v[184:187]
v_mfma_f32_16x16x32_bf16 v[184:187],a[220:223],a[108:111],v[184:187]
v_mfma_f32_16x16x32_bf16 v[220:223],a[216:219],a[120:123],v[220:223]
v_mfma_f32_16x16x32_bf16 v[220:223],a[220:223],a[124:127],v[220:223]
s_waitcnt lgkmcnt(4)
v_mfma_f32_16x16x32_bf16 v[116:119],a[192:195],a[72:75],v[116:119]
ds_read_b64_tr_b16 a[208:209],v28 offset:96
v_mfma_f32_16x16x32_bf16 v[116:119],a[196:199],a[76:79],v[116:119]
ds_read_b64_tr_b16 a[210:211],v28 offset:4704
v_mfma_f32_16x16x32_bf16 v[152:155],a[192:195],a[88:91],v[152:155]
ds_read_b64_tr_b16 a[212:213],v28 offset:9312
v_mfma_f32_16x16x32_bf16 v[152:155],a[196:199],a[92:95],v[152:155]
ds_read_b64_tr_b16 a[214:215],v28 offset:13920
v_mfma_f32_16x16x32_bf16 v[188:191],a[192:195],a[104:107],v[188:191]
buffer_load_dwordx4 v39,s[20:23],s41 offen offset:3072 lds
v_mfma_f32_16x16x32_bf16 v[188:191],a[196:199],a[108:111],v[188:191]
v_mfma_f32_16x16x32_bf16 v[224:227],a[192:195],a[120:123],v[224:227]
v_mfma_f32_16x16x32_bf16 v[224:227],a[196:199],a[124:127],v[224:227]
s_waitcnt lgkmcnt(4)
v_mfma_f32_16x16x32_bf16 v[120:123],a[200:203],a[72:75],v[120:123]
ds_read_b64_tr_b16 a[216:217],v28 offset:128
s_waitcnt vmcnt(11)
s_mov_b32 s55,0x20000
FO1_RE:
v_readfirstlane_b32 s53,v24
s_nop 0
s_bfe_u32 s53,s53,524288
s_cmp_ge_u32 s53,4
s_cbranch_scc0 FO1_SPIN
FO1_OK:
s_add_u32 s82,s82,0x10000
v_mfma_f32_16x16x32_bf16 v[120:123],a[204:207],a[76:79],v[120:123]
ds_read_b64_tr_b16 a[218:219],v28 offset:4736
v_mfma_f32_16x16x32_bf16 v[156:159],a[200:203],a[88:91],v[156:159]
ds_read_b64_tr_b16 a[220:221],v28 offset:9344
s_add_u32 s68,s79,16384
v_mfma_f32_16x16x32_bf16 v[156:159],a[204:207],a[92:95],v[156:159]
ds_read_b64_tr_b16 a[222:223],v28 offset:13952
v_mfma_f32_16x16x32_bf16 v[192:195],a[200:203],a[104:107],v[192:195]
buffer_load_dwordx4 a[128:131],v3,s[28:31],s68 offen sc1
v_mfma_f32_16x16x32_bf16 v[192:195],a[204:207],a[108:111],v[192:195]
v_mfma_f32_16x16x32_bf16 v[228:231],a[200:203],a[120:123],v[228:231]
v_mfma_f32_16x16x32_bf16 v[228:231],a[204:207],a[124:127],v[228:231]
s_waitcnt lgkmcnt(3)
v_mfma_f32_16x16x32_bf16 v[124:127],a[208:211],a[72:75],v[124:127]
ds_read_b64_tr_b16 a[192:193],v28 offset:160
s_add_u32 m0,s65,45056
v_mfma_f32_16x16x32_bf16 v[124:127],a[212:215],a[76:79],v[124:127]
ds_read_b64_tr_b16 a[194:195],v28 offset:4768
s_add_u32 s41,s75,147456
v_mfma_f32_16x16x32_bf16 v[160:163],a[208:211],a[88:91],v[160:163]
ds_read_b64_tr_b16 a[196:197],v28 offset:9376
v_mfma_f32_16x16x32_bf16 v[160:163],a[212:215],a[92:95],v[160:163]
ds_read_b64_tr_b16 a[198:199],v28 offset:13984
v_mfma_f32_16x16x32_bf16 v[196:199],a[208:211],a[104:107],v[196:199]
buffer_load_dwordx4 v40,s[20:23],s41 offen lds
v_mfma_f32_16x16x32_bf16 v[196:199],a[212:215],a[108:111],v[196:199]
buffer_load_dwordx4 a[144:147],v3,s[28:31],s68 offen offset:1024 sc1
v_mfma_f32_16x16x32_bf16 v[232:235],a[208:211],a[120:123],v[232:235]
v_mfma_f32_16x16x32_bf16 v[232:235],a[212:215],a[124:127],v[232:235]
s_waitcnt lgkmcnt(4)
v_mfma_f32_16x16x32_bf16 v[128:131],a[216:219],a[72:75],v[128:131]
ds_read_b64_tr_b16 a[200:201],v28 offset:192
v_mfma_f32_16x16x32_bf16 v[128:131],a[220:223],a[76:79],v[128:131]
ds_read_b64_tr_b16 a[202:203],v28 offset:4800
v_mfma_f32_16x16x32_bf16 v[164:167],a[216:219],a[88:91],v[164:167]
ds_read_b64_tr_b16 a[204:205],v28 offset:9408
v_mfma_f32_16x16x32_bf16 v[164:167],a[220:223],a[92:95],v[164:167]
ds_read_b64_tr_b16 a[206:207],v28 offset:14016
v_mfma_f32_16x16x32_bf16 v[200:203],a[216:219],a[104:107],v[200:203]
buffer_load_dwordx4 a[160:163],v3,s[28:31],s68 offen offset:2048 sc1
v_mfma_f32_16x16x32_bf16 v[200:203],a[220:223],a[108:111],v[200:203]
v_mfma_f32_16x16x32_bf16 v[236:239],a[216:219],a[120:123],v[236:239]
v_mfma_f32_16x16x32_bf16 v[236:239],a[220:223],a[124:127],v[236:239]
s_waitcnt lgkmcnt(4)
v_mfma_f32_16x16x32_bf16 v[132:135],a[192:195],a[72:75],v[132:135]
ds_read_b64_tr_b16 a[208:209],v28 offset:224
v_mfma_f32_16x16x32_bf16 v[132:135],a[196:199],a[76:79],v[132:135]
ds_read_b64_tr_b16 a[210:211],v28 offset:4832
v_mfma_f32_16x16x32_bf16 v[168:171],a[192:195],a[88:91],v[168:171]
ds_read_b64_tr_b16 a[212:213],v28 offset:9440
v_mfma_f32_16x16x32_bf16 v[168:171],a[196:199],a[92:95],v[168:171]
ds_read_b64_tr_b16 a[214:215],v28 offset:14048
v_mfma_f32_16x16x32_bf16 v[204:207],a[192:195],a[104:107],v[204:207]
buffer_load_dwordx4 a[176:179],v3,s[28:31],s68 offen offset:3072 sc1
v_mfma_f32_16x16x32_bf16 v[204:207],a[196:199],a[108:111],v[204:207]
v_mfma_f32_16x16x32_bf16 v[240:243],a[192:195],a[120:123],v[240:243]
v_mfma_f32_16x16x32_bf16 v[240:243],a[196:199],a[124:127],v[240:243]
s_waitcnt lgkmcnt(4)
v_mfma_f32_16x16x32_bf16 v[136:139],a[200:203],a[72:75],v[136:139]
ds_read_b64_tr_b16 a[216:217],v28 offset:256
v_mfma_f32_16x16x32_bf16 v[136:139],a[204:207],a[76:79],v[136:139]
ds_read_b64_tr_b16 a[218:219],v28 offset:4864
v_mfma_f32_16x16x32_bf16 v[172:175],a[200:203],a[88:91],v[172:175]
ds_read_b64_tr_b16 a[220:221],v28 offset:9472
s_add_u32 s68,s79,20480
v_mfma_f32_16x16x32_bf16 v[172:175],a[204:207],a[92:95],v[172:175]
ds_read_b64_tr_b16 a[222:223],v28 offset:14080
v_mfma_f32_16x16x32_bf16 v[208:211],a[200:203],a[104:107],v[208:211]
buffer_load_dwordx4 a[132:135],v3,s[28:31],s68 offen sc1
v_mfma_f32_16x16x32_bf16 v[208:211],a[204:207],a[108:111],v[208:211]
v_mfma_f32_16x16x32_bf16 v[244:247],a[200:203],a[120:123],v[244:247]
v_mfma_f32_16x16x32_bf16 v[244:247],a[204:207],a[124:127],v[244:247]
s_waitcnt lgkmcnt(0)
s_barrier
v_mfma_f32_16x16x32_bf16 v[140:143],a[208:211],a[72:75],v[140:143]
ds_read_b64_tr_b16 a[192:193],v23 offset:18432
s_add_u32 m0,s65,0
v_mfma_f32_16x16x32_bf16 v[140:143],a[212:215],a[76:79],v[140:143]
ds_read_b64_tr_b16 a[194:195],v23 offset:23040
s_add_u32 s41,s76,147456
v_mfma_f32_16x16x32_bf16 v[176:179],a[208:211],a[88:91],v[176:179]
ds_read_b64_tr_b16 a[196:197],v23 offset:27648
v_mfma_f32_16x16x32_bf16 v[176:179],a[212:215],a[92:95],v[176:179]
ds_read_b64_tr_b16 a[198:199],v23 offset:32256
v_mfma_f32_16x16x32_bf16 v[212:215],a[208:211],a[104:107],v[212:215]
buffer_load_dwordx4 v1,s[20:23],s41 offen lds
v_mfma_f32_16x16x32_bf16 v[212:215],a[212:215],a[108:111],v[212:215]
buffer_load_dwordx4 a[148:151],v3,s[28:31],s68 offen offset:1024 sc1
v_mfma_f32_16x16x32_bf16 v[248:251],a[208:211],a[120:123],v[248:251]
v_mfma_f32_16x16x32_bf16 v[248:251],a[212:215],a[124:127],v[248:251]
v_mfma_f32_16x16x32_bf16 v[144:147],a[216:219],a[72:75],v[144:147]
ds_read_b64_tr_b16 a[200:201],v23 offset:18464
v_mfma_f32_16x16x32_bf16 v[144:147],a[220:223],a[76:79],v[144:147]
ds_read_b64_tr_b16 a[202:203],v23 offset:23072
v_mfma_f32_16x16x32_bf16 v[180:183],a[216:219],a[88:91],v[180:183]
ds_read_b64_tr_b16 a[204:205],v23 offset:27680
v_mfma_f32_16x16x32_bf16 v[180:183],a[220:223],a[92:95],v[180:183]
ds_read_b64_tr_b16 a[206:207],v23 offset:32288
v_mfma_f32_16x16x32_bf16 v[216:219],a[216:219],a[104:107],v[216:219]
buffer_load_dwordx4 a[164:167],v3,s[28:31],s68 offen offset:2048 sc1
v_mfma_f32_16x16x32_bf16 v[216:219],a[220:223],a[108:111],v[216:219]
v_mfma_f32_16x16x32_bf16 v[252:255],a[216:219],a[120:123],v[252:255]
buffer_load_dwordx4 v2,s[20:23],s41 offen offset:1024 lds
v_mfma_f32_16x16x32_bf16 v[252:255],a[220:223],a[124:127],v[252:255]
s_waitcnt lgkmcnt(4)
v_mfma_f32_16x16x32_bf16 v[112:115],a[192:195],a[0:3],v[112:115]
ds_read_b64_tr_b16 a[208:209],v23 offset:18496
v_mfma_f32_16x16x32_bf16 v[112:115],a[196:199],a[4:7],v[112:115]
ds_read_b64_tr_b16 a[210:211],v23 offset:23104
v_mfma_f32_16x16x32_bf16 v[148:151],a[192:195],a[16:19],v[148:151]
ds_read_b64_tr_b16 a[212:213],v23 offset:27712
v_mfma_f32_16x16x32_bf16 v[148:151],a[196:199],a[20:23],v[148:151]
ds_read_b64_tr_b16 a[214:215],v23 offset:32320
v_mfma_f32_16x16x32_bf16 v[184:187],a[192:195],a[32:35],v[184:187]
buffer_load_dwordx4 a[180:183],v3,s[28:31],s68 offen offset:3072 sc1
v_mfma_f32_16x16x32_bf16 v[184:187],a[196:199],a[36:39],v[184:187]
v_mfma_f32_16x16x32_bf16 v[220:223],a[192:195],a[48:51],v[220:223]
v_mfma_f32_16x16x32_bf16 v[220:223],a[196:199],a[52:55],v[220:223]
s_waitcnt lgkmcnt(4)
v_mfma_f32_16x16x32_bf16 v[116:119],a[200:203],a[0:3],v[116:119]
ds_read_b64_tr_b16 a[216:217],v23 offset:18528
v_mfma_f32_16x16x32_bf16 v[116:119],a[204:207],a[4:7],v[116:119]
ds_read_b64_tr_b16 a[218:219],v23 offset:23136
v_mfma_f32_16x16x32_bf16 v[152:155],a[200:203],a[16:19],v[152:155]
ds_read_b64_tr_b16 a[220:221],v23 offset:27744
s_add_u32 s68,s79,24576
v_mfma_f32_16x16x32_bf16 v[152:155],a[204:207],a[20:23],v[152:155]
ds_read_b64_tr_b16 a[222:223],v23 offset:32352
v_mfma_f32_16x16x32_bf16 v[188:191],a[200:203],a[32:35],v[188:191]
buffer_load_dwordx4 a[136:139],v3,s[28:31],s68 offen sc1
v_mfma_f32_16x16x32_bf16 v[188:191],a[204:207],a[36:39],v[188:191]
buffer_load_dwordx4 v22,s[20:23],s41 offen offset:2048 lds
v_mfma_f32_16x16x32_bf16 v[224:227],a[200:203],a[48:51],v[224:227]
v_mfma_f32_16x16x32_bf16 v[224:227],a[204:207],a[52:55],v[224:227]
s_waitcnt lgkmcnt(4)
v_mfma_f32_16x16x32_bf16 v[120:123],a[208:211],a[0:3],v[120:123]
ds_read_b64_tr_b16 a[192:193],v23 offset:18560
v_mfma_f32_16x16x32_bf16 v[120:123],a[212:215],a[4:7],v[120:123]
ds_read_b64_tr_b16 a[194:195],v23 offset:23168
v_mfma_f32_16x16x32_bf16 v[156:159],a[208:211],a[16:19],v[156:159]
ds_read_b64_tr_b16 a[196:197],v23 offset:27776
v_mfma_f32_16x16x32_bf16 v[156:159],a[212:215],a[20:23],v[156:159]
ds_read_b64_tr_b16 a[198:199],v23 offset:32384
v_mfma_f32_16x16x32_bf16 v[192:195],a[208:211],a[32:35],v[192:195]
buffer_load_dwordx4 a[152:155],v3,s[28:31],s68 offen offset:1024 sc1
v_mfma_f32_16x16x32_bf16 v[192:195],a[212:215],a[36:39],v[192:195]
v_mfma_f32_16x16x32_bf16 v[228:231],a[208:211],a[48:51],v[228:231]
v_mfma_f32_16x16x32_bf16 v[228:231],a[212:215],a[52:55],v[228:231]
s_waitcnt lgkmcnt(4)
v_mfma_f32_16x16x32_bf16 v[124:127],a[216:219],a[0:3],v[124:127]
ds_read_b64_tr_b16 a[200:201],v23 offset:18592
v_mfma_f32_16x16x32_bf16 v[124:127],a[220:223],a[4:7],v[124:127]
ds_read_b64_tr_b16 a[202:203],v23 offset:23200
v_mfma_f32_16x16x32_bf16 v[160:163],a[216:219],a[16:19],v[160:163]
ds_read_b64_tr_b16 a[204:205],v23 offset:27808
v_mfma_f32_16x16x32_bf16 v[160:163],a[220:223],a[20:23],v[160:163]
ds_read_b64_tr_b16 a[206:207],v23 offset:32416
v_mfma_f32_16x16x32_bf16 v[196:199],a[216:219],a[32:35],v[196:199]
buffer_load_dwordx4 v29,s[20:23],s41 offen offset:3072 lds
v_mfma_f32_16x16x32_bf16 v[196:199],a[220:223],a[36:39],v[196:199]
buffer_load_dwordx4 a[168:171],v3,s[28:31],s68 offen offset:2048 sc1
v_mfma_f32_16x16x32_bf16 v[232:235],a[216:219],a[48:51],v[232:235]
v_mfma_f32_16x16x32_bf16 v[232:235],a[220:223],a[52:55],v[232:235]
s_waitcnt lgkmcnt(4)
v_mfma_f32_16x16x32_bf16 v[128:131],a[192:195],a[0:3],v[128:131]
ds_read_b64_tr_b16 a[208:209],v23 offset:18624
v_mfma_f32_16x16x32_bf16 v[128:131],a[196:199],a[4:7],v[128:131]
ds_read_b64_tr_b16 a[210:211],v23 offset:23232
v_mfma_f32_16x16x32_bf16 v[164:167],a[192:195],a[16:19],v[164:167]
ds_read_b64_tr_b16 a[212:213],v23 offset:27840
v_mfma_f32_16x16x32_bf16 v[164:167],a[196:199],a[20:23],v[164:167]
ds_read_b64_tr_b16 a[214:215],v23 offset:32448
v_mfma_f32_16x16x32_bf16 v[200:203],a[192:195],a[32:35],v[200:203]
buffer_load_dwordx4 a[184:187],v3,s[28:31],s68 offen offset:3072 sc1
v_mfma_f32_16x16x32_bf16 v[200:203],a[196:199],a[36:39],v[200:203]
v_mfma_f32_16x16x32_bf16 v[236:239],a[192:195],a[48:51],v[236:239]
v_mfma_f32_16x16x32_bf16 v[236:239],a[196:199],a[52:55],v[236:239]
s_waitcnt lgkmcnt(4)
v_mfma_f32_16x16x32_bf16 v[132:135],a[200:203],a[0:3],v[132:135]
ds_read_b64_tr_b16 a[216:217],v23 offset:18656
s_add_u32 m0,s65,4096
v_mfma_f32_16x16x32_bf16 v[132:135],a[204:207],a[4:7],v[132:135]
ds_read_b64_tr_b16 a[218:219],v23 offset:23264
s_add_u32 s41,s76,147456
v_mfma_f32_16x16x32_bf16 v[168:171],a[200:203],a[16:19],v[168:171]
ds_read_b64_tr_b16 a[220:221],v23 offset:27872
v_mfma_f32_16x16x32_bf16 v[168:171],a[204:207],a[20:23],v[168:171]
ds_read_b64_tr_b16 a[222:223],v23 offset:32480
v_mfma_f32_16x16x32_bf16 v[204:207],a[200:203],a[32:35],v[204:207]
buffer_load_dwordx4 v42,s[20:23],s41 offen lds
v_mfma_f32_16x16x32_bf16 v[204:207],a[204:207],a[36:39],v[204:207]
s_add_u32 s68,s79,28672
v_mfma_f32_16x16x32_bf16 v[240:243],a[200:203],a[48:51],v[240:243]
buffer_load_dwordx4 a[140:143],v3,s[28:31],s68 offen sc1
v_mfma_f32_16x16x32_bf16 v[240:243],a[204:207],a[52:55],v[240:243]
s_waitcnt lgkmcnt(3)
v_mfma_f32_16x16x32_bf16 v[136:139],a[208:211],a[0:3],v[136:139]
ds_read_b64_tr_b16 a[192:193],v23 offset:18688
v_mfma_f32_16x16x32_bf16 v[136:139],a[212:215],a[4:7],v[136:139]
ds_read_b64_tr_b16 a[194:195],v23 offset:23296
v_mfma_f32_16x16x32_bf16 v[172:175],a[208:211],a[16:19],v[172:175]
ds_read_b64_tr_b16 a[196:197],v23 offset:27904
v_mfma_f32_16x16x32_bf16 v[172:175],a[212:215],a[20:23],v[172:175]
ds_read_b64_tr_b16 a[198:199],v23 offset:32512
v_mfma_f32_16x16x32_bf16 v[208:211],a[208:211],a[32:35],v[208:211]
buffer_load_dwordx4 a[156:159],v3,s[28:31],s68 offen offset:1024 sc1
v_mfma_f32_16x16x32_bf16 v[208:211],a[212:215],a[36:39],v[208:211]
v_mfma_f32_16x16x32_bf16 v[244:247],a[208:211],a[48:51],v[244:247]
buffer_load_dwordx4 v37,s[20:23],s41 offen offset:1024 lds
v_mfma_f32_16x16x32_bf16 v[244:247],a[212:215],a[52:55],v[244:247]
s_waitcnt lgkmcnt(4)
v_mfma_f32_16x16x32_bf16 v[140:143],a[216:219],a[0:3],v[140:143]
ds_read_b64_tr_b16 a[200:201],v28 offset:18432
v_mfma_f32_16x16x32_bf16 v[140:143],a[220:223],a[4:7],v[140:143]
ds_read_b64_tr_b16 a[202:203],v28 offset:23040
v_mfma_f32_16x16x32_bf16 v[176:179],a[216:219],a[16:19],v[176:179]
ds_read_b64_tr_b16 a[204:205],v28 offset:27648
v_mfma_f32_16x16x32_bf16 v[176:179],a[220:223],a[20:23],v[176:179]
ds_read_b64_tr_b16 a[206:207],v28 offset:32256
v_mfma_f32_16x16x32_bf16 v[212:215],a[216:219],a[32:35],v[212:215]
buffer_load_dwordx4 a[172:175],v3,s[28:31],s68 offen offset:2048 sc1
v_mfma_f32_16x16x32_bf16 v[212:215],a[220:223],a[36:39],v[212:215]
v_mfma_f32_16x16x32_bf16 v[248:251],a[216:219],a[48:51],v[248:251]
v_mfma_f32_16x16x32_bf16 v[248:251],a[220:223],a[52:55],v[248:251]
s_waitcnt lgkmcnt(4)
v_mfma_f32_16x16x32_bf16 v[144:147],a[192:195],a[0:3],v[144:147]
ds_read_b64_tr_b16 a[208:209],v28 offset:18464
v_mfma_f32_16x16x32_bf16 v[144:147],a[196:199],a[4:7],v[144:147]
ds_read_b64_tr_b16 a[210:211],v28 offset:23072
v_mfma_f32_16x16x32_bf16 v[180:183],a[192:195],a[16:19],v[180:183]
ds_read_b64_tr_b16 a[212:213],v28 offset:27680
v_mfma_f32_16x16x32_bf16 v[180:183],a[196:199],a[20:23],v[180:183]
ds_read_b64_tr_b16 a[214:215],v28 offset:32288
v_mfma_f32_16x16x32_bf16 v[216:219],a[192:195],a[32:35],v[216:219]
buffer_load_dwordx4 a[188:191],v3,s[28:31],s68 offen offset:3072 sc1
v_mfma_f32_16x16x32_bf16 v[216:219],a[196:199],a[36:39],v[216:219]
buffer_load_dwordx4 v38,s[20:23],s41 offen offset:2048 lds
v_mfma_f32_16x16x32_bf16 v[252:255],a[192:195],a[48:51],v[252:255]
v_mfma_f32_16x16x32_bf16 v[252:255],a[196:199],a[52:55],v[252:255]
s_waitcnt vmcnt(27)
s_waitcnt lgkmcnt(4)
v_mfma_f32_16x16x32_bf16 v[112:115],a[200:203],a[8:11],v[112:115]
ds_read_b64_tr_b16 a[216:217],v28 offset:18496
v_mfma_f32_16x16x32_bf16 v[112:115],a[204:207],a[12:15],v[112:115]
ds_read_b64_tr_b16 a[218:219],v28 offset:23104
v_mfma_f32_16x16x32_bf16 v[148:151],a[200:203],a[24:27],v[148:151]
ds_read_b64_tr_b16 a[220:221],v28 offset:27712
s_add_u32 s68,s80,16384
v_mfma_f32_16x16x32_bf16 v[148:151],a[204:207],a[28:31],v[148:151]
ds_read_b64_tr_b16 a[222:223],v28 offset:32320
v_mfma_f32_16x16x32_bf16 v[184:187],a[200:203],a[40:43],v[184:187]
buffer_load_dwordx4 a[64:67],v3,s[28:31],s68 offen sc1
v_mfma_f32_16x16x32_bf16 v[184:187],a[204:207],a[44:47],v[184:187]
v_mfma_f32_16x16x32_bf16 v[220:223],a[200:203],a[56:59],v[220:223]
v_mfma_f32_16x16x32_bf16 v[220:223],a[204:207],a[60:63],v[220:223]
s_waitcnt lgkmcnt(4)
v_mfma_f32_16x16x32_bf16 v[116:119],a[208:211],a[8:11],v[116:119]
ds_read_b64_tr_b16 a[192:193],v28 offset:18528
v_mfma_f32_16x16x32_bf16 v[116:119],a[212:215],a[12:15],v[116:119]
ds_read_b64_tr_b16 a[194:195],v28 offset:23136
v_mfma_f32_16x16x32_bf16 v[152:155],a[208:211],a[24:27],v[152:155]
ds_read_b64_tr_b16 a[196:197],v28 offset:27744
v_mfma_f32_16x16x32_bf16 v[152:155],a[212:215],a[28:31],v[152:155]
ds_read_b64_tr_b16 a[198:199],v28 offset:32352
v_mfma_f32_16x16x32_bf16 v[188:191],a[208:211],a[40:43],v[188:191]
buffer_load_dwordx4 v39,s[20:23],s41 offen offset:3072 lds
v_mfma_f32_16x16x32_bf16 v[188:191],a[212:215],a[44:47],v[188:191]
buffer_load_dwordx4 a[80:83],v3,s[28:31],s68 offen offset:1024 sc1
v_mfma_f32_16x16x32_bf16 v[224:227],a[208:211],a[56:59],v[224:227]
v_mfma_f32_16x16x32_bf16 v[224:227],a[212:215],a[60:63],v[224:227]
s_waitcnt lgkmcnt(4)
v_mfma_f32_16x16x32_bf16 v[120:123],a[216:219],a[8:11],v[120:123]
ds_read_b64_tr_b16 a[200:201],v28 offset:18560
v_mfma_f32_16x16x32_bf16 v[120:123],a[220:223],a[12:15],v[120:123]
ds_read_b64_tr_b16 a[202:203],v28 offset:23168
v_mfma_f32_16x16x32_bf16 v[156:159],a[216:219],a[24:27],v[156:159]
ds_read_b64_tr_b16 a[204:205],v28 offset:27776
v_mfma_f32_16x16x32_bf16 v[156:159],a[220:223],a[28:31],v[156:159]
ds_read_b64_tr_b16 a[206:207],v28 offset:32384
v_mfma_f32_16x16x32_bf16 v[192:195],a[216:219],a[40:43],v[192:195]
buffer_load_dwordx4 a[96:99],v3,s[28:31],s68 offen offset:2048 sc1
v_mfma_f32_16x16x32_bf16 v[192:195],a[220:223],a[44:47],v[192:195]
v_mfma_f32_16x16x32_bf16 v[228:231],a[216:219],a[56:59],v[228:231]
v_mfma_f32_16x16x32_bf16 v[228:231],a[220:223],a[60:63],v[228:231]
s_waitcnt lgkmcnt(4)
v_mfma_f32_16x16x32_bf16 v[124:127],a[192:195],a[8:11],v[124:127]
ds_read_b64_tr_b16 a[208:209],v28 offset:18592
s_add_u32 m0,s65,8192
v_mfma_f32_16x16x32_bf16 v[124:127],a[196:199],a[12:15],v[124:127]
ds_read_b64_tr_b16 a[210:211],v28 offset:23200
s_add_u32 s41,s76,147456
v_mfma_f32_16x16x32_bf16 v[160:163],a[192:195],a[24:27],v[160:163]
ds_read_b64_tr_b16 a[212:213],v28 offset:27808
v_mfma_f32_16x16x32_bf16 v[160:163],a[196:199],a[28:31],v[160:163]
ds_read_b64_tr_b16 a[214:215],v28 offset:32416
v_mfma_f32_16x16x32_bf16 v[196:199],a[192:195],a[40:43],v[196:199]
buffer_load_dwordx4 v40,s[20:23],s41 offen lds
v_mfma_f32_16x16x32_bf16 v[196:199],a[196:199],a[44:47],v[196:199]
buffer_load_dwordx4 a[112:115],v3,s[28:31],s68 offen offset:3072 sc1
v_mfma_f32_16x16x32_bf16 v[232:235],a[192:195],a[56:59],v[232:235]
v_mfma_f32_16x16x32_bf16 v[232:235],a[196:199],a[60:63],v[232:235]
s_waitcnt lgkmcnt(4)
v_mfma_f32_16x16x32_bf16 v[128:131],a[200:203],a[8:11],v[128:131]
ds_read_b64_tr_b16 a[216:217],v28 offset:18624
v_mfma_f32_16x16x32_bf16 v[128:131],a[204:207],a[12:15],v[128:131]
ds_read_b64_tr_b16 a[218:219],v28 offset:23232
v_mfma_f32_16x16x32_bf16 v[164:167],a[200:203],a[24:27],v[164:167]
ds_read_b64_tr_b16 a[220:221],v28 offset:27840
s_add_u32 s68,s80,20480
v_mfma_f32_16x16x32_bf16 v[164:167],a[204:207],a[28:31],v[164:167]
ds_read_b64_tr_b16 a[222:223],v28 offset:32448
v_mfma_f32_16x16x32_bf16 v[200:203],a[200:203],a[40:43],v[200:203]
buffer_load_dwordx4 a[68:71],v3,s[28:31],s68 offen sc1
v_mfma_f32_16x16x32_bf16 v[200:203],a[204:207],a[44:47],v[200:203]
v_mfma_f32_16x16x32_bf16 v[236:239],a[200:203],a[56:59],v[236:239]
v_mfma_f32_16x16x32_bf16 v[236:239],a[204:207],a[60:63],v[236:239]
s_waitcnt lgkmcnt(4)
v_mfma_f32_16x16x32_bf16 v[132:135],a[208:211],a[8:11],v[132:135]
ds_read_b64_tr_b16 a[192:193],v28 offset:18656
v_mfma_f32_16x16x32_bf16 v[132:135],a[212:215],a[12:15],v[132:135]
ds_read_b64_tr_b16 a[194:195],v28 offset:23264
v_mfma_f32_16x16x32_bf16 v[168:171],a[208:211],a[24:27],v[168:171]
ds_read_b64_tr_b16 a[196:197],v28 offset:27872
v_mfma_f32_16x16x32_bf16 v[168:171],a[212:215],a[28:31],v[168:171]
ds_read_b64_tr_b16 a[198:199],v28 offset:32480
v_mfma_f32_16x16x32_bf16 v[204:207],a[208:211],a[40:43],v[204:207]
buffer_load_dwordx4 a[84:87],v3,s[28:31],s68 offen offset:1024 sc1
v_mfma_f32_16x16x32_bf16 v[204:207],a[212:215],a[44:47],v[204:207]
v_mfma_f32_16x16x32_bf16 v[240:243],a[208:211],a[56:59],v[240:243]
v_mfma_f32_16x16x32_bf16 v[240:243],a[212:215],a[60:63],v[240:243]
s_waitcnt lgkmcnt(4)
v_mfma_f32_16x16x32_bf16 v[136:139],a[216:219],a[8:11],v[136:139]
ds_read_b64_tr_b16 a[200:201],v28 offset:18688
v_mfma_f32_16x16x32_bf16 v[136:139],a[220:223],a[12:15],v[136:139]
ds_read_b64_tr_b16 a[202:203],v28 offset:23296
v_mfma_f32_16x16x32_bf16 v[172:175],a[216:219],a[24:27],v[172:175]
ds_read_b64_tr_b16 a[204:205],v28 offset:27904
v_mfma_f32_16x16x32_bf16 v[172:175],a[220:223],a[28:31],v[172:175]
ds_read_b64_tr_b16 a[206:207],v28 offset:32512
v_mfma_f32_16x16x32_bf16 v[208:211],a[216:219],a[40:43],v[208:211]
buffer_load_dwordx4 a[100:103],v3,s[28:31],s68 offen offset:2048 sc1
v_mfma_f32_16x16x32_bf16 v[208:211],a[220:223],a[44:47],v[208:211]
v_mfma_f32_16x16x32_bf16 v[244:247],a[216:219],a[56:59],v[244:247]
s_waitcnt vmcnt(31)
v_mfma_f32_16x16x32_bf16 v[244:247],a[220:223],a[60:63],v[244:247]
s_waitcnt lgkmcnt(0)
s_barrier
v_mfma_f32_16x16x32_bf16 v[140:143],a[192:195],a[8:11],v[140:143]
ds_read_b64_tr_b16 a[208:209],v23 offset:36864
s_add_u32 m0,s65,18432
v_mfma_f32_16x16x32_bf16 v[140:143],a[196:199],a[12:15],v[140:143]
ds_read_b64_tr_b16 a[210:211],v23 offset:41472
s_add_u32 s41,s77,147456
v_mfma_f32_16x16x32_bf16 v[176:179],a[192:195],a[24:27],v[176:179]
ds_read_b64_tr_b16 a[212:213],v23 offset:46080
v_mfma_f32_16x16x32_bf16 v[176:179],a[196:199],a[28:31],v[176:179]
ds_read_b64_tr_b16 a[214:215],v23 offset:50688
v_mfma_f32_16x16x32_bf16 v[212:215],a[192:195],a[40:43],v[212:215]
buffer_load_dwordx4 v1,s[20:23],s41 offen lds
v_mfma_f32_16x16x32_bf16 v[212:215],a[196:199],a[44:47],v[212:215]
buffer_load_dwordx4 a[116:119],v3,s[28:31],s68 offen offset:3072 sc1
v_mfma_f32_16x16x32_bf16 v[248:251],a[192:195],a[56:59],v[248:251]
v_mfma_f32_16x16x32_bf16 v[248:251],a[196:199],a[60:63],v[248:251]
v_mfma_f32_16x16x32_bf16 v[144:147],a[200:203],a[8:11],v[144:147]
ds_read_b64_tr_b16 a[216:217],v23 offset:36896
v_mfma_f32_16x16x32_bf16 v[144:147],a[204:207],a[12:15],v[144:147]
ds_read_b64_tr_b16 a[218:219],v23 offset:41504
v_mfma_f32_16x16x32_bf16 v[180:183],a[200:203],a[24:27],v[180:183]
ds_read_b64_tr_b16 a[220:221],v23 offset:46112
v_mfma_f32_16x16x32_bf16 v[180:183],a[204:207],a[28:31],v[180:183]
ds_read_b64_tr_b16 a[222:223],v23 offset:50720
v_mfma_f32_16x16x32_bf16 v[216:219],a[200:203],a[40:43],v[216:219]
buffer_load_dwordx4 v2,s[20:23],s41 offen offset:1024 lds
v_mfma_f32_16x16x32_bf16 v[216:219],a[204:207],a[44:47],v[216:219]
s_add_u32 s68,s80,24576
v_mfma_f32_16x16x32_bf16 v[252:255],a[200:203],a[56:59],v[252:255]
buffer_load_dwordx4 a[72:75],v3,s[28:31],s68 offen sc1
v_mfma_f32_16x16x32_bf16 v[252:255],a[204:207],a[60:63],v[252:255]
s_waitcnt vmcnt(26)
s_waitcnt lgkmcnt(4)
v_mfma_f32_16x16x32_bf16 v[148:151],a[208:211],a[144:147],v[148:151]
ds_read_b64_tr_b16 a[192:193],v23 offset:36928
v_mfma_f32_16x16x32_bf16 v[148:151],a[212:215],a[148:151],v[148:151]
ds_read_b64_tr_b16 a[194:195],v23 offset:41536
v_mfma_f32_16x16x32_bf16 v[184:187],a[208:211],a[160:163],v[184:187]
ds_read_b64_tr_b16 a[196:197],v23 offset:46144
v_mfma_f32_16x16x32_bf16 v[184:187],a[212:215],a[164:167],v[184:187]
ds_read_b64_tr_b16 a[198:199],v23 offset:50752
v_mfma_f32_16x16x32_bf16 v[220:223],a[208:211],a[176:179],v[220:223]
buffer_load_dwordx4 v22,s[20:23],s41 offen offset:2048 lds
v_mfma_f32_16x16x32_bf16 v[220:223],a[212:215],a[180:183],v[220:223]
buffer_load_dwordx4 a[88:91],v3,s[28:31],s68 offen offset:1024 sc1
s_waitcnt lgkmcnt(4)
v_mfma_f32_16x16x32_bf16 v[152:155],a[216:219],a[144:147],v[152:155]
ds_read_b64_tr_b16 a[200:201],v23 offset:36960
v_mfma_f32_16x16x32_bf16 v[152:155],a[220:223],a[148:151],v[152:155]
ds_read_b64_tr_b16 a[202:203],v23 offset:41568
v_mfma_f32_16x16x32_bf16 v[188:191],a[216:219],a[160:163],v[188:191]
ds_read_b64_tr_b16 a[204:205],v23 offset:46176
v_mfma_f32_16x16x32_bf16 v[188:191],a[220:223],a[164:167],v[188:191]
ds_read_b64_tr_b16 a[206:207],v23 offset:50784
v_mfma_f32_16x16x32_bf16 v[224:227],a[216:219],a[176:179],v[224:227]
buffer_load_dwordx4 a[104:107],v3,s[28:31],s68 offen offset:2048 sc1
v_mfma_f32_16x16x32_bf16 v[224:227],a[220:223],a[180:183],v[224:227]
buffer_load_dwordx4 v29,s[20:23],s41 offen offset:3072 lds
s_waitcnt lgkmcnt(4)
v_mfma_f32_16x16x32_bf16 v[156:159],a[192:195],a[144:147],v[156:159]
ds_read_b64_tr_b16 a[208:209],v23 offset:36992
v_mfma_f32_16x16x32_bf16 v[156:159],a[196:199],a[148:151],v[156:159]
ds_read_b64_tr_b16 a[210:211],v23 offset:41600
v_mfma_f32_16x16x32_bf16 v[192:195],a[192:195],a[160:163],v[192:195]
ds_read_b64_tr_b16 a[212:213],v23 offset:46208
v_mfma_f32_16x16x32_bf16 v[192:195],a[196:199],a[164:167],v[192:195]
ds_read_b64_tr_b16 a[214:215],v23 offset:50816
v_mfma_f32_16x16x32_bf16 v[228:231],a[192:195],a[176:179],v[228:231]
v_mfma_f32_16x16x32_bf16 v[228:231],a[196:199],a[180:183],v[228:231]
s_waitcnt lgkmcnt(5)
v_mfma_f32_16x16x32_bf16 v[160:163],a[200:203],a[144:147],v[160:163]
ds_read_b64_tr_b16 a[216:217],v23 offset:37024
s_waitcnt lgkmcnt(5)
v_mfma_f32_16x16x32_bf16 v[160:163],a[204:207],a[148:151],v[160:163]
ds_read_b64_tr_b16 a[218:219],v23 offset:41632
v_mfma_f32_16x16x32_bf16 v[196:199],a[200:203],a[160:163],v[196:199]
ds_read_b64_tr_b16 a[220:221],v23 offset:46240
v_mfma_f32_16x16x32_bf16 v[196:199],a[204:207],a[164:167],v[196:199]
ds_read_b64_tr_b16 a[222:223],v23 offset:50848
v_mfma_f32_16x16x32_bf16 v[232:235],a[200:203],a[176:179],v[232:235]
buffer_load_dwordx4 a[120:123],v3,s[28:31],s68 offen offset:3072 sc1
v_mfma_f32_16x16x32_bf16 v[232:235],a[204:207],a[180:183],v[232:235]
s_add_u32 m0,s65,22528
s_waitcnt lgkmcnt(5)
v_mfma_f32_16x16x32_bf16 v[164:167],a[208:211],a[144:147],v[164:167]
ds_read_b64_tr_b16 a[192:193],v23 offset:37056
s_add_u32 s41,s77,147456
s_waitcnt lgkmcnt(5)
v_mfma_f32_16x16x32_bf16 v[164:167],a[212:215],a[148:151],v[164:167]
ds_read_b64_tr_b16 a[194:195],v23 offset:41664
v_mfma_f32_16x16x32_bf16 v[200:203],a[208:211],a[160:163],v[200:203]
ds_read_b64_tr_b16 a[196:197],v23 offset:46272
v_mfma_f32_16x16x32_bf16 v[200:203],a[212:215],a[164:167],v[200:203]
ds_read_b64_tr_b16 a[198:199],v23 offset:50880
v_mfma_f32_16x16x32_bf16 v[236:239],a[208:211],a[176:179],v[236:239]
buffer_load_dwordx4 v42,s[20:23],s41 offen lds
v_mfma_f32_16x16x32_bf16 v[236:239],a[212:215],a[180:183],v[236:239]
s_add_u32 s68,s80,28672
s_waitcnt lgkmcnt(4)
v_mfma_f32_16x16x32_bf16 v[168:171],a[216:219],a[144:147],v[168:171]
ds_read_b64_tr_b16 a[200:201],v23 offset:37088
v_mfma_f32_16x16x32_bf16 v[168:171],a[220:223],a[148:151],v[168:171]
ds_read_b64_tr_b16 a[202:203],v23 offset:41696
v_mfma_f32_16x16x32_bf16 v[204:207],a[216:219],a[160:163],v[204:207]
ds_read_b64_tr_b16 a[204:205],v23 offset:46304
v_mfma_f32_16x16x32_bf16 v[204:207],a[220:223],a[164:167],v[204:207]
ds_read_b64_tr_b16 a[206:207],v23 offset:50912
v_mfma_f32_16x16x32_bf16 v[240:243],a[216:219],a[176:179],v[240:243]
buffer_load_dwordx4 a[76:79],v3,s[28:31],s68 offen sc1
v_mfma_f32_16x16x32_bf16 v[240:243],a[220:223],a[180:183],v[240:243]
buffer_load_dwordx4 v37,s[20:23],s41 offen offset:1024 lds
s_waitcnt lgkmcnt(4)
v_mfma_f32_16x16x32_bf16 v[172:175],a[192:195],a[144:147],v[172:175]
ds_read_b64_tr_b16 a[208:209],v23 offset:37120
v_mfma_f32_16x16x32_bf16 v[172:175],a[196:199],a[148:151],v[172:175]
ds_read_b64_tr_b16 a[210:211],v23 offset:41728
v_mfma_f32_16x16x32_bf16 v[208:211],a[192:195],a[160:163],v[208:211]
ds_read_b64_tr_b16 a[212:213],v23 offset:46336
v_mfma_f32_16x16x32_bf16 v[208:211],a[196:199],a[164:167],v[208:211]
ds_read_b64_tr_b16 a[214:215],v23 offset:50944
v_mfma_f32_16x16x32_bf16 v[244:247],a[192:195],a[176:179],v[244:247]
buffer_load_dwordx4 a[92:95],v3,s[28:31],s68 offen offset:1024 sc1
v_mfma_f32_16x16x32_bf16 v[244:247],a[196:199],a[180:183],v[244:247]
buffer_load_dwordx4 v38,s[20:23],s41 offen offset:2048 lds
s_waitcnt lgkmcnt(4)
v_mfma_f32_16x16x32_bf16 v[176:179],a[200:203],a[144:147],v[176:179]
ds_read_b64_tr_b16 a[216:217],v28 offset:36864
v_mfma_f32_16x16x32_bf16 v[176:179],a[204:207],a[148:151],v[176:179]
ds_read_b64_tr_b16 a[218:219],v28 offset:41472
v_mfma_f32_16x16x32_bf16 v[212:215],a[200:203],a[160:163],v[212:215]
ds_read_b64_tr_b16 a[220:221],v28 offset:46080
v_mfma_f32_16x16x32_bf16 v[212:215],a[204:207],a[164:167],v[212:215]
ds_read_b64_tr_b16 a[222:223],v28 offset:50688
v_mfma_f32_16x16x32_bf16 v[248:251],a[200:203],a[176:179],v[248:251]
buffer_load_dwordx4 a[108:111],v3,s[28:31],s68 offen offset:2048 sc1
v_mfma_f32_16x16x32_bf16 v[248:251],a[204:207],a[180:183],v[248:251]
buffer_load_dwordx4 v39,s[20:23],s41 offen offset:3072 lds
s_waitcnt lgkmcnt(4)
v_mfma_f32_16x16x32_bf16 v[180:183],a[208:211],a[144:147],v[180:183]
ds_read_b64_tr_b16 a[192:193],v28 offset:36896
v_mfma_f32_16x16x32_bf16 v[180:183],a[212:215],a[148:151],v[180:183]
ds_read_b64_tr_b16 a[194:195],v28 offset:41504
v_mfma_f32_16x16x32_bf16 v[216:219],a[208:211],a[160:163],v[216:219]
ds_read_b64_tr_b16 a[196:197],v28 offset:46112
v_mfma_f32_16x16x32_bf16 v[216:219],a[212:215],a[164:167],v[216:219]
ds_read_b64_tr_b16 a[198:199],v28 offset:50720
v_mfma_f32_16x16x32_bf16 v[252:255],a[208:211],a[176:179],v[252:255]
buffer_load_dwordx4 a[124:127],v3,s[28:31],s68 offen offset:3072 sc1
v_mfma_f32_16x16x32_bf16 v[252:255],a[212:215],a[180:183],v[252:255]
s_waitcnt vmcnt(27)
s_waitcnt lgkmcnt(4)
v_mfma_f32_16x16x32_bf16 v[148:151],a[216:219],a[152:155],v[148:151]
ds_read_b64_tr_b16 a[200:201],v28 offset:36928
v_mfma_f32_16x16x32_bf16 v[148:151],a[220:223],a[156:159],v[148:151]
ds_read_b64_tr_b16 a[202:203],v28 offset:41536
v_mfma_f32_16x16x32_bf16 v[184:187],a[216:219],a[168:171],v[184:187]
ds_read_b64_tr_b16 a[204:205],v28 offset:46144
s_add_u32 m0,s65,26624
v_mfma_f32_16x16x32_bf16 v[184:187],a[220:223],a[172:175],v[184:187]
ds_read_b64_tr_b16 a[206:207],v28 offset:50752
s_add_u32 s41,s77,147456
v_mfma_f32_16x16x32_bf16 v[220:223],a[216:219],a[184:187],v[220:223]
buffer_load_dwordx4 v40,s[20:23],s41 offen lds
v_mfma_f32_16x16x32_bf16 v[220:223],a[220:223],a[188:191],v[220:223]
s_add_u32 s68,s81,16384
v_lshlrev_b32 v34,2,v31
s_waitcnt lgkmcnt(4)
v_mfma_f32_16x16x32_bf16 v[152:155],a[192:195],a[152:155],v[152:155]
ds_read_b64_tr_b16 a[208:209],v28 offset:36960
v_sub_u32 v34,v30,v34
v_mfma_f32_16x16x32_bf16 v[152:155],a[196:199],a[156:159],v[152:155]
ds_read_b64_tr_b16 a[210:211],v28 offset:41568
v_mov_b32 v35,0x3f80
v_mfma_f32_16x16x32_bf16 v[188:191],a[192:195],a[168:171],v[188:191]
ds_read_b64_tr_b16 a[212:213],v28 offset:46176
v_mov_b32 v36,0x3f800000
v_mfma_f32_16x16x32_bf16 v[188:191],a[196:199],a[172:175],v[188:191]
ds_read_b64_tr_b16 a[214:215],v28 offset:50784
v_cmp_eq_u32 vcc,0,v34
v_mfma_f32_16x16x32_bf16 v[224:227],a[192:195],a[184:187],v[224:227]
buffer_load_dwordx4 a[0:3],v3,s[28:31],s68 offen sc1
v_mov_b32 v98,0
v_mfma_f32_16x16x32_bf16 v[224:227],a[196:199],a[188:191],v[224:227]
v_mov_b32 v100,0
v_cndmask_b32 v96,0,v35,vcc
s_waitcnt lgkmcnt(3)
v_mfma_f32_16x16x32_bf16 v[156:159],a[200:203],a[152:155],v[156:159]
ds_read_b64_tr_b16 a[216:217],v28 offset:36992
v_cmp_eq_u32 vcc,1,v34
v_mfma_f32_16x16x32_bf16 v[156:159],a[204:207],a[156:159],v[156:159]
ds_read_b64_tr_b16 a[218:219],v28 offset:41600
v_mov_b32 v37,0
v_mfma_f32_16x16x32_bf16 v[192:195],a[200:203],a[168:171],v[192:195]
ds_read_b64_tr_b16 a[220:221],v28 offset:46208
v_mov_b32 v37,0
v_mfma_f32_16x16x32_bf16 v[192:195],a[204:207],a[172:175],v[192:195]
ds_read_b64_tr_b16 a[222:223],v28 offset:50816
v_cndmask_b32 v96,v96,v36,vcc
v_mfma_f32_16x16x32_bf16 v[228:231],a[200:203],a[184:187],v[228:231]
buffer_load_dwordx4 a[16:19],v3,s[28:31],s68 offen offset:1024 sc1
v_mov_b32 v102,v96
v_mfma_f32_16x16x32_bf16 v[228:231],a[204:207],a[188:191],v[228:231]
v_cmp_eq_u32 vcc,2,v34
v_mov_b32 v99,0
s_waitcnt lgkmcnt(3)
v_mfma_f32_16x16x32_bf16 v[160:163],a[208:211],a[152:155],v[160:163]
ds_read_b64_tr_b16 a[192:193],v28 offset:37024
v_mov_b32 v101,0
v_mfma_f32_16x16x32_bf16 v[160:163],a[212:215],a[156:159],v[160:163]
ds_read_b64_tr_b16 a[194:195],v28 offset:41632
v_cndmask_b32 v97,0,v35,vcc
v_mfma_f32_16x16x32_bf16 v[196:199],a[208:211],a[168:171],v[196:199]
ds_read_b64_tr_b16 a[196:197],v28 offset:46240
v_cmp_eq_u32 vcc,3,v34
v_mfma_f32_16x16x32_bf16 v[196:199],a[212:215],a[172:175],v[196:199]
ds_read_b64_tr_b16 a[198:199],v28 offset:50848
v_mov_b32 v37,0
v_mfma_f32_16x16x32_bf16 v[232:235],a[208:211],a[184:187],v[232:235]
buffer_load_dwordx4 a[32:35],v3,s[28:31],s68 offen offset:2048 sc1
v_mov_b32 v37,0
v_mfma_f32_16x16x32_bf16 v[232:235],a[212:215],a[188:191],v[232:235]
v_cndmask_b32 v97,v97,v36,vcc
v_mov_b32 v103,v97
s_waitcnt lgkmcnt(3)
v_mfma_f32_16x16x32_bf16 v[164:167],a[216:219],a[152:155],v[164:167]
ds_read_b64_tr_b16 a[200:201],v28 offset:37056
v_mul_u32_u24 v9,304,v30
v_mfma_f32_16x16x32_bf16 v[164:167],a[220:223],a[156:159],v[164:167]
ds_read_b64_tr_b16 a[202:203],v28 offset:41664
v_lshl_add_u32 v9,v31,3,v9
v_mfma_f32_16x16x32_bf16 v[200:203],a[216:219],a[168:171],v[200:203]
ds_read_b64_tr_b16 a[204:205],v28 offset:46272
v_add_u32 v9,s40,v9
v_mfma_f32_16x16x32_bf16 v[200:203],a[220:223],a[172:175],v[200:203]
ds_read_b64_tr_b16 a[206:207],v28 offset:50880
v_add_u32 v9,131072,v9
v_mfma_f32_16x16x32_bf16 v[236:239],a[216:219],a[184:187],v[236:239]
buffer_load_dwordx4 a[48:51],v3,s[28:31],s68 offen offset:3072 sc1
v_add_u32 v34,0,v0
v_mfma_f32_16x16x32_bf16 v[236:239],a[220:223],a[188:191],v[236:239]
v_mul_u32_u24 v35,3641,v34
v_lshrrev_b32 v35,16,v35
s_waitcnt lgkmcnt(3)
v_mfma_f32_16x16x32_bf16 v[168:171],a[192:195],a[152:155],v[168:171]
ds_read_b64_tr_b16 a[208:209],v28 offset:37088
v_mul_u32_u24 v36,18,v35
v_mfma_f32_16x16x32_bf16 v[168:171],a[196:199],a[156:159],v[168:171]
ds_read_b64_tr_b16 a[210:211],v28 offset:41696
v_sub_u32 v36,v34,v36
v_mfma_f32_16x16x32_bf16 v[204:207],a[192:195],a[168:171],v[204:207]
ds_read_b64_tr_b16 a[212:213],v28 offset:46304
v_lshlrev_b32 v36,4,v36
v_mfma_f32_16x16x32_bf16 v[204:207],a[196:199],a[172:175],v[204:207]
ds_read_b64_tr_b16 a[214:215],v28 offset:50912
v_mul_u32_u24 v34,304,v35
v_mfma_f32_16x16x32_bf16 v[240:243],a[192:195],a[184:187],v[240:243]
v_add3_u32 v10,v34,v36,s40
v_add_u32 v10,131072,v10
v_mfma_f32_16x16x32_bf16 v[240:243],a[196:199],a[188:191],v[240:243]
v_mul_u32_u24 v34,2304,v35
v_add_u32 v15,v34,v36
s_waitcnt lgkmcnt(3)
v_mfma_f32_16x16x32_bf16 v[172:175],a[200:203],a[152:155],v[172:175]
ds_read_b64_tr_b16 a[216:217],v28 offset:37120
ds_read_b64_tr_b16 a[218:219],v28 offset:41728
v_mfma_f32_16x16x32_bf16 v[172:175],a[204:207],a[156:159],v[172:175]
ds_read_b64_tr_b16 a[220:221],v28 offset:46336
ds_read_b64_tr_b16 a[222:223],v28 offset:50944
v_mfma_f32_16x16x32_bf16 v[208:211],a[200:203],a[168:171],v[208:211]
s_add_u32 s68,s81,20480
v_add_u32 v34,64,v0
v_mfma_f32_16x16x32_bf16 v[208:211],a[204:207],a[172:175],v[208:211]
buffer_load_dwordx4 a[4:7],v3,s[28:31],s68 offen sc1
v_mul_u32_u24 v35,3641,v34
v_mfma_f32_16x16x32_bf16 v[244:247],a[200:203],a[184:187],v[244:247]
s_waitcnt vmcnt(27)
v_lshrrev_b32 v35,16,v35
v_mfma_f32_16x16x32_bf16 v[244:247],a[204:207],a[188:191],v[244:247]
s_waitcnt lgkmcnt(0)
s_barrier
v_mfma_f32_16x16x32_bf16 v[176:179],a[208:211],a[152:155],v[176:179]
ds_read_b64_tr_b16 a[192:193],v23 offset:0
v_mul_u32_u24 v36,18,v35
v_mfma_f32_16x16x32_bf16 v[176:179],a[212:215],a[156:159],v[176:179]
ds_read_b64_tr_b16 a[194:195],v23 offset:4608
v_sub_u32 v36,v34,v36
v_mfma_f32_16x16x32_bf16 v[212:215],a[208:211],a[168:171],v[212:215]
ds_read_b64_tr_b16 a[196:197],v23 offset:9216
v_lshlrev_b32 v36,4,v36
v_mfma_f32_16x16x32_bf16 v[212:215],a[212:215],a[172:175],v[212:215]
ds_read_b64_tr_b16 a[198:199],v23 offset:13824
v_mul_u32_u24 v34,304,v35
v_mfma_f32_16x16x32_bf16 v[248:251],a[208:211],a[184:187],v[248:251]
buffer_load_dwordx4 a[20:23],v3,s[28:31],s68 offen offset:1024 sc1
v_add3_u32 v11,v34,v36,s40
v_mfma_f32_16x16x32_bf16 v[248:251],a[212:215],a[188:191],v[248:251]
v_add_u32 v11,131072,v11
v_mul_u32_u24 v34,2304,v35
v_mfma_f32_16x16x32_bf16 v[180:183],a[216:219],a[152:155],v[180:183]
ds_read_b64_tr_b16 a[200:201],v23 offset:32
v_add_u32 v16,v34,v36
v_mfma_f32_16x16x32_bf16 v[180:183],a[220:223],a[156:159],v[180:183]
ds_read_b64_tr_b16 a[202:203],v23 offset:4640
v_add_u32 v34,128,v0
v_mfma_f32_16x16x32_bf16 v[216:219],a[216:219],a[168:171],v[216:219]
ds_read_b64_tr_b16 a[204:205],v23 offset:9248
v_mul_u32_u24 v35,3641,v34
v_mfma_f32_16x16x32_bf16 v[216:219],a[220:223],a[172:175],v[216:219]
ds_read_b64_tr_b16 a[206:207],v23 offset:13856
v_lshrrev_b32 v35,16,v35
v_mfma_f32_16x16x32_bf16 v[252:255],a[216:219],a[184:187],v[252:255]
buffer_load_dwordx4 a[36:39],v3,s[28:31],s68 offen offset:2048 sc1
v_mul_u32_u24 v36,18,v35
v_mfma_f32_16x16x32_bf16 v[252:255],a[220:223],a[188:191],v[252:255]
s_waitcnt vmcnt(23)
v_sub_u32 v36,v34,v36
s_waitcnt lgkmcnt(3)
v_mfma_f32_16x16x32_bf16 v[148:151],a[192:195],a[80:83],v[148:151]
ds_read_b64_tr_b16 a[208:209],v23 offset:64
v_lshlrev_b32 v36,4,v36
v_mfma_f32_16x16x32_bf16 v[148:151],a[196:199],a[84:87],v[148:151]
ds_read_b64_tr_b16 a[210:211],v23 offset:4672
v_mul_u32_u24 v34,304,v35
v_mfma_f32_16x16x32_bf16 v[184:187],a[192:195],a[96:99],v[184:187]
ds_read_b64_tr_b16 a[212:213],v23 offset:9280
v_add3_u32 v12,v34,v36,s40
v_mfma_f32_16x16x32_bf16 v[184:187],a[196:199],a[100:103],v[184:187]
ds_read_b64_tr_b16 a[214:215],v23 offset:13888
v_add_u32 v12,131072,v12
v_mfma_f32_16x16x32_bf16 v[220:223],a[192:195],a[112:115],v[220:223]
v_mul_u32_u24 v34,2304,v35
v_add_u32 v17,v34,v36
v_mfma_f32_16x16x32_bf16 v[220:223],a[196:199],a[116:119],v[220:223]
v_add_u32 v34,192,v0
v_mul_u32_u24 v35,3641,v34
s_waitcnt lgkmcnt(3)
v_mfma_f32_16x16x32_bf16 v[152:155],a[200:203],a[80:83],v[152:155]
ds_read_b64_tr_b16 a[216:217],v23 offset:96
v_lshrrev_b32 v35,16,v35
v_mfma_f32_16x16x32_bf16 v[152:155],a[204:207],a[84:87],v[152:155]
ds_read_b64_tr_b16 a[218:219],v23 offset:4704
v_mul_u32_u24 v36,18,v35
v_mfma_f32_16x16x32_bf16 v[188:191],a[200:203],a[96:99],v[188:191]
ds_read_b64_tr_b16 a[220:221],v23 offset:9312
v_sub_u32 v36,v34,v36
v_mfma_f32_16x16x32_bf16 v[188:191],a[204:207],a[100:103],v[188:191]
ds_read_b64_tr_b16 a[222:223],v23 offset:13920
v_lshlrev_b32 v36,4,v36
v_mfma_f32_16x16x32_bf16 v[224:227],a[200:203],a[112:115],v[224:227]
buffer_load_dwordx4 a[52:55],v3,s[28:31],s68 offen offset:3072 sc1
v_mul_u32_u24 v34,304,v35
v_mfma_f32_16x16x32_bf16 v[224:227],a[204:207],a[116:119],v[224:227]
v_add3_u32 v13,v34,v36,s40
v_add_u32 v13,131072,v13
s_waitcnt lgkmcnt(3)
v_mfma_f32_16x16x32_bf16 v[156:159],a[208:211],a[80:83],v[156:159]
ds_read_b64_tr_b16 a[192:193],v23 offset:128
v_mul_u32_u24 v34,2304,v35
v_mfma_f32_16x16x32_bf16 v[156:159],a[212:215],a[84:87],v[156:159]
ds_read_b64_tr_b16 a[194:195],v23 offset:4736
v_add_u32 v18,v34,v36
v_mfma_f32_16x16x32_bf16 v[192:195],a[208:211],a[96:99],v[192:195]
ds_read_b64_tr_b16 a[196:197],v23 offset:9344
s_add_u32 s68,s81,24576
v_mfma_f32_16x16x32_bf16 v[192:195],a[212:215],a[100:103],v[192:195]
ds_read_b64_tr_b16 a[198:199],v23 offset:13952
v_add_u32 v34,256,v0
v_mfma_f32_16x16x32_bf16 v[228:231],a[208:211],a[112:115],v[228:231]
buffer_load_dwordx4 a[8:11],v3,s[28:31],s68 offen sc1
v_mul_u32_u24 v35,3641,v34
v_mfma_f32_16x16x32_bf16 v[228:231],a[212:215],a[116:119],v[228:231]
v_lshrrev_b32 v35,16,v35
v_mul_u32_u24 v36,18,v35
s_waitcnt lgkmcnt(3)
v_mfma_f32_16x16x32_bf16 v[160:163],a[216:219],a[80:83],v[160:163]
ds_read_b64_tr_b16 a[200:201],v23 offset:160
v_sub_u32 v36,v34,v36
v_mfma_f32_16x16x32_bf16 v[160:163],a[220:223],a[84:87],v[160:163]
ds_read_b64_tr_b16 a[202:203],v23 offset:4768
v_lshlrev_b32 v36,4,v36
v_mfma_f32_16x16x32_bf16 v[196:199],a[216:219],a[96:99],v[196:199]
ds_read_b64_tr_b16 a[204:205],v23 offset:9376
v_mul_u32_u24 v34,304,v35
v_mfma_f32_16x16x32_bf16 v[196:199],a[220:223],a[100:103],v[196:199]
ds_read_b64_tr_b16 a[206:207],v23 offset:13984
v_add3_u32 v14,v34,v36,s40
v_mfma_f32_16x16x32_bf16 v[232:235],a[216:219],a[112:115],v[232:235]
buffer_load_dwordx4 a[24:27],v3,s[28:31],s68 offen offset:1024 sc1
v_add_u32 v14,131072,v14
v_mfma_f32_16x16x32_bf16 v[232:235],a[220:223],a[116:119],v[232:235]
v_mul_u32_u24 v34,2304,v35
v_add_u32 v19,v34,v36
s_waitcnt lgkmcnt(3)
v_mfma_f32_16x16x32_bf16 v[164:167],a[192:195],a[80:83],v[164:167]
ds_read_b64_tr_b16 a[208:209],v23 offset:192
v_cmp_gt_u32 vcc,32,v0
v_mfma_f32_16x16x32_bf16 v[164:167],a[196:199],a[84:87],v[164:167]
ds_read_b64_tr_b16 a[210:211],v23 offset:4800
v_mov_b32 v34,0x7fff0000
v_mfma_f32_16x16x32_bf16 v[200:203],a[192:195],a[96:99],v[200:203]
ds_read_b64_tr_b16 a[212:213],v23 offset:9408
v_lshlrev_b32 v8,3,v0
v_mfma_f32_16x16x32_bf16 v[200:203],a[196:199],a[100:103],v[200:203]
ds_read_b64_tr_b16 a[214:215],v23 offset:14016
v_cndmask_b32 v19,v34,v19,vcc
v_mfma_f32_16x16x32_bf16 v[236:239],a[192:195],a[112:115],v[236:239]
v_mfma_f32_16x16x32_bf16 v[236:239],a[196:199],a[116:119],v[236:239]
s_waitcnt lgkmcnt(4)
v_mfma_f32_16x16x32_bf16 v[168:171],a[200:203],a[80:83],v[168:171]
ds_read_b64_tr_b16 a[216:217],v23 offset:224
v_mfma_f32_16x16x32_bf16 v[168:171],a[204:207],a[84:87],v[168:171]
ds_read_b64_tr_b16 a[218:219],v23 offset:4832
v_mfma_f32_16x16x32_bf16 v[204:207],a[200:203],a[96:99],v[204:207]
ds_read_b64_tr_b16 a[220:221],v23 offset:9440
v_mfma_f32_16x16x32_bf16 v[204:207],a[204:207],a[100:103],v[204:207]
ds_read_b64_tr_b16 a[222:223],v23 offset:14048
v_mfma_f32_16x16x32_bf16 v[240:243],a[200:203],a[112:115],v[240:243]
buffer_load_dwordx4 a[40:43],v3,s[28:31],s68 offen offset:2048 sc1
v_mfma_f32_16x16x32_bf16 v[240:243],a[204:207],a[116:119],v[240:243]
s_waitcnt lgkmcnt(5)
v_mfma_f32_16x16x32_bf16 v[172:175],a[208:211],a[80:83],v[172:175]
ds_read_b64_tr_b16 a[192:193],v23 offset:256
s_waitcnt lgkmcnt(5)
v_mfma_f32_16x16x32_bf16 v[172:175],a[212:215],a[84:87],v[172:175]
ds_read_b64_tr_b16 a[194:195],v23 offset:4864
v_mfma_f32_16x16x32_bf16 v[208:211],a[208:211],a[96:99],v[208:211]
ds_read_b64_tr_b16 a[196:197],v23 offset:9472
v_mfma_f32_16x16x32_bf16 v[208:211],a[212:215],a[100:103],v[208:211]
ds_read_b64_tr_b16 a[198:199],v23 offset:14080
v_mfma_f32_16x16x32_bf16 v[244:247],a[208:211],a[112:115],v[244:247]
buffer_load_dwordx4 a[56:59],v3,s[28:31],s68 offen offset:3072 sc1
v_mfma_f32_16x16x32_bf16 v[244:247],a[212:215],a[116:119],v[244:247]
s_waitcnt lgkmcnt(5)
v_mfma_f32_16x16x32_bf16 v[176:179],a[216:219],a[80:83],v[176:179]
ds_read_b64_tr_b16 a[200:201],v28 offset:0
s_waitcnt lgkmcnt(5)
v_mfma_f32_16x16x32_bf16 v[176:179],a[220:223],a[84:87],v[176:179]
ds_read_b64_tr_b16 a[202:203],v28 offset:4608
v_mfma_f32_16x16x32_bf16 v[212:215],a[216:219],a[96:99],v[212:215]
ds_read_b64_tr_b16 a[204:205],v28 offset:9216
v_mfma_f32_16x16x32_bf16 v[212:215],a[220:223],a[100:103],v[212:215]
ds_read_b64_tr_b16 a[206:207],v28 offset:13824
v_mfma_f32_16x16x32_bf16 v[248:251],a[216:219],a[112:115],v[248:251]
s_add_u32 s68,s81,28672
v_mfma_f32_16x16x32_bf16 v[248:251],a[220:223],a[116:119],v[248:251]
buffer_load_dwordx4 a[12:15],v3,s[28:31],s68 offen sc1
s_waitcnt lgkmcnt(4)
v_mfma_f32_16x16x32_bf16 v[180:183],a[192:195],a[80:83],v[180:183]
ds_read_b64_tr_b16 a[208:209],v28 offset:32
v_mfma_f32_16x16x32_bf16 v[180:183],a[196:199],a[84:87],v[180:183]
ds_read_b64_tr_b16 a[210:211],v28 offset:4640
v_mfma_f32_16x16x32_bf16 v[216:219],a[192:195],a[96:99],v[216:219]
ds_read_b64_tr_b16 a[212:213],v28 offset:9248
v_mfma_f32_16x16x32_bf16 v[216:219],a[196:199],a[100:103],v[216:219]
ds_read_b64_tr_b16 a[214:215],v28 offset:13856
v_mfma_f32_16x16x32_bf16 v[252:255],a[192:195],a[112:115],v[252:255]
v_mfma_f32_16x16x32_bf16 v[252:255],a[196:199],a[116:119],v[252:255]
s_waitcnt vmcnt(14)
s_waitcnt lgkmcnt(4)
v_mfma_f32_16x16x32_bf16 v[148:151],a[200:203],a[88:91],v[148:151]
ds_read_b64_tr_b16 a[216:217],v28 offset:64
v_mfma_f32_16x16x32_bf16 v[148:151],a[204:207],a[92:95],v[148:151]
ds_read_b64_tr_b16 a[218:219],v28 offset:4672
v_mfma_f32_16x16x32_bf16 v[184:187],a[200:203],a[104:107],v[184:187]
ds_read_b64_tr_b16 a[220:221],v28 offset:9280
v_mfma_f32_16x16x32_bf16 v[184:187],a[204:207],a[108:111],v[184:187]
ds_read_b64_tr_b16 a[222:223],v28 offset:13888
v_mfma_f32_16x16x32_bf16 v[220:223],a[200:203],a[120:123],v[220:223]
buffer_load_dwordx4 a[28:31],v3,s[28:31],s68 offen offset:1024 sc1
v_mfma_f32_16x16x32_bf16 v[220:223],a[204:207],a[124:127],v[220:223]
s_waitcnt lgkmcnt(5)
v_mfma_f32_16x16x32_bf16 v[152:155],a[208:211],a[88:91],v[152:155]
ds_read_b64_tr_b16 a[192:193],v28 offset:96
s_waitcnt lgkmcnt(5)
v_mfma_f32_16x16x32_bf16 v[152:155],a[212:215],a[92:95],v[152:155]
ds_read_b64_tr_b16 a[194:195],v28 offset:4704
v_mfma_f32_16x16x32_bf16 v[188:191],a[208:211],a[104:107],v[188:191]
ds_read_b64_tr_b16 a[196:197],v28 offset:9312
v_mfma_f32_16x16x32_bf16 v[188:191],a[212:215],a[108:111],v[188:191]
ds_read_b64_tr_b16 a[198:199],v28 offset:13920
v_mfma_f32_16x16x32_bf16 v[224:227],a[208:211],a[120:123],v[224:227]
buffer_load_dwordx4 a[44:47],v3,s[28:31],s68 offen offset:2048 sc1
v_mfma_f32_16x16x32_bf16 v[224:227],a[212:215],a[124:127],v[224:227]
s_waitcnt lgkmcnt(5)
v_mfma_f32_16x16x32_bf16 v[156:159],a[216:219],a[88:91],v[156:159]
ds_read_b64_tr_b16 a[200:201],v28 offset:128
s_waitcnt lgkmcnt(5)
v_mfma_f32_16x16x32_bf16 v[156:159],a[220:223],a[92:95],v[156:159]
ds_read_b64_tr_b16 a[202:203],v28 offset:4736
v_mfma_f32_16x16x32_bf16 v[192:195],a[216:219],a[104:107],v[192:195]
ds_read_b64_tr_b16 a[204:205],v28 offset:9344
v_mfma_f32_16x16x32_bf16 v[192:195],a[220:223],a[108:111],v[192:195]
ds_read_b64_tr_b16 a[206:207],v28 offset:13952
v_mfma_f32_16x16x32_bf16 v[228:231],a[216:219],a[120:123],v[228:231]
buffer_load_dwordx4 a[60:63],v3,s[28:31],s68 offen offset:3072 sc1
v_mfma_f32_16x16x32_bf16 v[228:231],a[220:223],a[124:127],v[228:231]
s_waitcnt lgkmcnt(5)
v_mfma_f32_16x16x32_bf16 v[160:163],a[192:195],a[88:91],v[160:163]
ds_read_b64_tr_b16 a[208:209],v28 offset:160
s_waitcnt lgkmcnt(5)
v_mfma_f32_16x16x32_bf16 v[160:163],a[196:199],a[92:95],v[160:163]
ds_read_b64_tr_b16 a[210:211],v28 offset:4768
v_mfma_f32_16x16x32_bf16 v[196:199],a[192:195],a[104:107],v[196:199]
ds_read_b64_tr_b16 a[212:213],v28 offset:9376
v_mfma_f32_16x16x32_bf16 v[196:199],a[196:199],a[108:111],v[196:199]
ds_read_b64_tr_b16 a[214:215],v28 offset:13984
v_mfma_f32_16x16x32_bf16 v[232:235],a[192:195],a[120:123],v[232:235]
v_mfma_f32_16x16x32_bf16 v[232:235],a[196:199],a[124:127],v[232:235]
s_waitcnt lgkmcnt(5)
v_mfma_f32_16x16x32_bf16 v[164:167],a[200:203],a[88:91],v[164:167]
ds_read_b64_tr_b16 a[216:217],v28 offset:192
s_waitcnt lgkmcnt(5)
v_mfma_f32_16x16x32_bf16 v[164:167],a[204:207],a[92:95],v[164:167]
ds_read_b64_tr_b16 a[218:219],v28 offset:4800
v_mfma_f32_16x16x32_bf16 v[200:203],a[200:203],a[104:107],v[200:203]
ds_read_b64_tr_b16 a[220:221],v28 offset:9408
v_mfma_f32_16x16x32_bf16 v[200:203],a[204:207],a[108:111],v[200:203]
ds_read_b64_tr_b16 a[222:223],v28 offset:14016
v_mfma_f32_16x16x32_bf16 v[236:239],a[200:203],a[120:123],v[236:239]
v_mfma_f32_16x16x32_bf16 v[236:239],a[204:207],a[124:127],v[236:239]
s_waitcnt lgkmcnt(6)
v_mfma_f32_16x16x32_bf16 v[168:171],a[208:211],a[88:91],v[168:171]
ds_read_b64_tr_b16 a[192:193],v28 offset:224
s_waitcnt lgkmcnt(5)
v_mfma_f32_16x16x32_bf16 v[168:171],a[212:215],a[92:95],v[168:171]
ds_read_b64_tr_b16 a[194:195],v28 offset:4832
v_mfma_f32_16x16x32_bf16 v[204:207],a[208:211],a[104:107],v[204:207]
ds_read_b64_tr_b16 a[196:197],v28 offset:9440
v_mfma_f32_16x16x32_bf16 v[204:207],a[212:215],a[108:111],v[204:207]
ds_read_b64_tr_b16 a[198:199],v28 offset:14048
v_mfma_f32_16x16x32_bf16 v[240:243],a[208:211],a[120:123],v[240:243]
v_mfma_f32_16x16x32_bf16 v[240:243],a[212:215],a[124:127],v[240:243]
s_waitcnt lgkmcnt(6)
v_mfma_f32_16x16x32_bf16 v[172:175],a[216:219],a[88:91],v[172:175]
ds_read_b64_tr_b16 a[200:201],v28 offset:256
ds_read_b64_tr_b16 a[202:203],v28 offset:4864
s_waitcnt lgkmcnt(6)
v_mfma_f32_16x16x32_bf16 v[172:175],a[220:223],a[92:95],v[172:175]
ds_read_b64_tr_b16 a[204:205],v28 offset:9472
ds_read_b64_tr_b16 a[206:207],v28 offset:14080
v_mfma_f32_16x16x32_bf16 v[208:211],a[216:219],a[104:107],v[208:211]
v_mfma_f32_16x16x32_bf16 v[208:211],a[220:223],a[108:111],v[208:211]
v_mfma_f32_16x16x32_bf16 v[244:247],a[216:219],a[120:123],v[244:247]
s_waitcnt vmcnt(16)
v_mfma_f32_16x16x32_bf16 v[244:247],a[220:223],a[124:127],v[244:247]
s_waitcnt lgkmcnt(0)
s_barrier
v_mfma_f32_16x16x32_bf16 v[176:179],a[192:195],a[88:91],v[176:179]
ds_read_b64_tr_b16 a[144:145],v23 offset:18432
ds_read_b64_tr_b16 a[146:147],v23 offset:23040
v_mfma_f32_16x16x32_bf16 v[176:179],a[196:199],a[92:95],v[176:179]
ds_read_b64_tr_b16 a[148:149],v23 offset:27648
ds_read_b64_tr_b16 a[150:151],v23 offset:32256
v_mfma_f32_16x16x32_bf16 v[212:215],a[192:195],a[104:107],v[212:215]
ds_read_b64_tr_b16 a[152:153],v28 offset:18432
ds_read_b64_tr_b16 a[154:155],v28 offset:23040
v_mfma_f32_16x16x32_bf16 v[212:215],a[196:199],a[108:111],v[212:215]
ds_read_b64_tr_b16 a[156:157],v28 offset:27648
ds_read_b64_tr_b16 a[158:159],v28 offset:32256
v_mfma_f32_16x16x32_bf16 v[248:251],a[192:195],a[120:123],v[248:251]
ds_read_b64_tr_b16 a[160:161],v23 offset:18464
ds_read_b64_tr_b16 a[162:163],v23 offset:23072
v_mfma_f32_16x16x32_bf16 v[248:251],a[196:199],a[124:127],v[248:251]
ds_read_b64_tr_b16 a[164:165],v23 offset:27680
ds_read_b64_tr_b16 a[166:167],v23 offset:32288
v_mfma_f32_16x16x32_bf16 v[180:183],a[200:203],a[88:91],v[180:183]
ds_read_b64_tr_b16 a[168:169],v28 offset:18464
ds_read_b64_tr_b16 a[170:171],v28 offset:23072
v_mfma_f32_16x16x32_bf16 v[180:183],a[204:207],a[92:95],v[180:183]
ds_read_b64_tr_b16 a[172:173],v28 offset:27680
ds_read_b64_tr_b16 a[174:175],v28 offset:32288
v_mfma_f32_16x16x32_bf16 v[216:219],a[200:203],a[104:107],v[216:219]
ds_read_b64_tr_b16 a[176:177],v23 offset:18496
ds_read_b64_tr_b16 a[178:179],v23 offset:23104
v_mfma_f32_16x16x32_bf16 v[216:219],a[204:207],a[108:111],v[216:219]
ds_read_b64_tr_b16 a[180:181],v23 offset:27712
ds_read_b64_tr_b16 a[182:183],v23 offset:32320
v_mfma_f32_16x16x32_bf16 v[252:255],a[200:203],a[120:123],v[252:255]
ds_read_b64_tr_b16 a[184:185],v28 offset:18496
ds_read_b64_tr_b16 a[186:187],v28 offset:23104
v_mfma_f32_16x16x32_bf16 v[252:255],a[204:207],a[124:127],v[252:255]
s_waitcnt vmcnt(0)
ds_read_b64_tr_b16 a[188:189],v28 offset:27712
s_waitcnt lgkmcnt(9)
v_mfma_f32_16x16x32_bf16 v[148:151],a[144:147],a[16:19],v[148:151]
ds_read_b64_tr_b16 a[190:191],v28 offset:32320
ds_read_b64_tr_b16 a[224:225],v23 offset:18528
v_mfma_f32_16x16x32_bf16 v[148:151],a[148:151],a[20:23],v[148:151]
ds_read_b64_tr_b16 a[226:227],v23 offset:23136
ds_read_b64_tr_b16 a[228:229],v23 offset:27744
v_mfma_f32_16x16x32_bf16 v[148:151],a[152:155],a[24:27],v[148:151]
ds_read_b64_tr_b16 a[230:231],v23 offset:32352
ds_read_b64_tr_b16 a[232:233],v28 offset:18528
v_mfma_f32_16x16x32_bf16 v[148:151],a[156:159],a[28:31],v[148:151]
ds_read_b64_tr_b16 a[234:235],v28 offset:23136
ds_read_b64_tr_b16 a[236:237],v28 offset:27744
v_mfma_f32_16x16x32_bf16 v[152:155],a[160:163],a[16:19],v[152:155]
ds_read_b64_tr_b16 a[238:239],v28 offset:32352
ds_read_b64_tr_b16 a[240:241],v23 offset:18560
v_mfma_f32_16x16x32_bf16 v[152:155],a[164:167],a[20:23],v[152:155]
ds_read_b64_tr_b16 a[242:243],v23 offset:23168
ds_read_b64_tr_b16 a[244:245],v23 offset:27776
v_mfma_f32_16x16x32_bf16 v[152:155],a[168:171],a[24:27],v[152:155]
ds_read_b64_tr_b16 a[246:247],v23 offset:32384
ds_read_b64_tr_b16 a[248:249],v28 offset:18560
s_waitcnt lgkmcnt(10)
v_mfma_f32_16x16x32_bf16 v[152:155],a[172:175],a[28:31],v[152:155]
ds_read_b64_tr_b16 a[250:251],v28 offset:23168
ds_read_b64_tr_b16 a[252:253],v28 offset:27776
v_mfma_f32_16x16x32_bf16 v[156:159],a[176:179],a[16:19],v[156:159]
ds_read_b64_tr_b16 a[254:255],v28 offset:32384
ds_read_b64_tr_b16 a[192:193],v23 offset:18592
v_mfma_f32_16x16x32_bf16 v[156:159],a[180:183],a[20:23],v[156:159]
ds_read_b64_tr_b16 a[194:195],v23 offset:23200
ds_read_b64_tr_b16 a[196:197],v23 offset:27808
v_mfma_f32_16x16x32_bf16 v[156:159],a[184:187],a[24:27],v[156:159]
ds_read_b64_tr_b16 a[198:199],v23 offset:32416
ds_read_b64_tr_b16 a[200:201],v28 offset:18592
v_mfma_f32_16x16x32_bf16 v[156:159],a[188:191],a[28:31],v[156:159]
ds_read_b64_tr_b16 a[202:203],v28 offset:23200
ds_read_b64_tr_b16 a[204:205],v28 offset:27808
v_mfma_f32_16x16x32_bf16 v[160:163],a[224:227],a[16:19],v[160:163]
ds_read_b64_tr_b16 a[206:207],v28 offset:32416
ds_read_b64_tr_b16 a[208:209],v23 offset:18624
s_waitcnt lgkmcnt(10)
v_mfma_f32_16x16x32_bf16 v[160:163],a[228:231],a[20:23],v[160:163]
ds_read_b64_tr_b16 a[210:211],v23 offset:23232
ds_read_b64_tr_b16 a[212:213],v23 offset:27840
v_mfma_f32_16x16x32_bf16 v[160:163],a[232:235],a[24:27],v[160:163]
ds_read_b64_tr_b16 a[214:215],v23 offset:32448
ds_read_b64_tr_b16 a[216:217],v28 offset:18624
v_mfma_f32_16x16x32_bf16 v[160:163],a[236:239],a[28:31],v[160:163]
ds_read_b64_tr_b16 a[218:219],v28 offset:23232
ds_read_b64_tr_b16 a[220:221],v28 offset:27840
v_mfma_f32_16x16x32_bf16 v[164:167],a[240:243],a[16:19],v[164:167]
ds_read_b64_tr_b16 a[222:223],v28 offset:32448
ds_read_b64_tr_b16 a[80:81],v23 offset:18656
v_mfma_f32_16x16x32_bf16 v[164:167],a[244:247],a[20:23],v[164:167]
ds_read_b64_tr_b16 a[82:83],v23 offset:23264
ds_read_b64_tr_b16 a[84:85],v23 offset:27872
v_mfma_f32_16x16x32_bf16 v[164:167],a[248:251],a[24:27],v[164:167]
ds_read_b64_tr_b16 a[86:87],v23 offset:32480
ds_read_b64_tr_b16 a[88:89],v28 offset:18656
s_waitcnt lgkmcnt(10)
v_mfma_f32_16x16x32_bf16 v[164:167],a[252:255],a[28:31],v[164:167]
ds_read_b64_tr_b16 a[90:91],v28 offset:23264
ds_read_b64_tr_b16 a[92:93],v28 offset:27872
v_mfma_f32_16x16x32_bf16 v[168:171],a[192:195],a[16:19],v[168:171]
ds_read_b64_tr_b16 a[94:95],v28 offset:32480
ds_read_b64_tr_b16 a[96:97],v23 offset:18688
v_mfma_f32_16x16x32_bf16 v[168:171],a[196:199],a[20:23],v[168:171]
ds_read_b64_tr_b16 a[98:99],v23 offset:23296
ds_read_b64_tr_b16 a[100:101],v23 offset:27904
v_mfma_f32_16x16x32_bf16 v[168:171],a[200:203],a[24:27],v[168:171]
ds_read_b64_tr_b16 a[102:103],v23 offset:32512
ds_read_b64_tr_b16 a[104:105],v28 offset:18688
v_mfma_f32_16x16x32_bf16 v[168:171],a[204:207],a[28:31],v[168:171]
ds_read_b64_tr_b16 a[106:107],v28 offset:23296
ds_read_b64_tr_b16 a[108:109],v28 offset:27904
v_mfma_f32_16x16x32_bf16 v[172:175],a[208:211],a[16:19],v[172:175]
ds_read_b64_tr_b16 a[110:111],v28 offset:32512
v_cvt_pk_bf16_f32 v148,v148,v149
s_waitcnt lgkmcnt(9)
v_mfma_f32_16x16x32_bf16 v[172:175],a[212:215],a[20:23],v[172:175]
v_cvt_pk_bf16_f32 v149,v150,v151
v_cvt_pk_bf16_f32 v150,v152,v153
v_mfma_f32_16x16x32_bf16 v[172:175],a[216:219],a[24:27],v[172:175]
v_cvt_pk_bf16_f32 v151,v154,v155
v_mfma_f32_16x16x32_bf16 v[172:175],a[220:223],a[28:31],v[172:175]
s_xor_b32 s71,s70,16
s_mul_i32 s71,s71,15360
v_mfma_f32_16x16x32_bf16 v[176:179],a[80:83],a[16:19],v[176:179]
s_add_u32 s71,s71,0
v_mfma_f32_16x16x32_bf16 v[176:179],a[84:87],a[20:23],v[176:179]
buffer_store_dwordx4 v[148:151],v3,s[56:59],s71 offen sc1
v_mfma_f32_16x16x32_bf16 v[176:179],a[88:91],a[24:27],v[176:179]
v_cvt_pk_bf16_f32 v156,v156,v157
v_cvt_pk_bf16_f32 v157,v158,v159
s_waitcnt lgkmcnt(0)
v_mfma_f32_16x16x32_bf16 v[176:179],a[92:95],a[28:31],v[176:179]
v_cvt_pk_bf16_f32 v158,v160,v161
v_cvt_pk_bf16_f32 v159,v162,v163
v_mfma_f32_16x16x32_bf16 v[180:183],a[96:99],a[16:19],v[180:183]
buffer_store_dwordx4 v[156:159],v3,s[56:59],s71 offen offset:1024 sc1
v_mfma_f32_16x16x32_bf16 v[180:183],a[100:103],a[20:23],v[180:183]
v_cvt_pk_bf16_f32 v164,v164,v165
v_cvt_pk_bf16_f32 v165,v166,v167
v_mfma_f32_16x16x32_bf16 v[180:183],a[104:107],a[24:27],v[180:183]
v_cvt_pk_bf16_f32 v166,v168,v169
v_cvt_pk_bf16_f32 v167,v170,v171
v_mfma_f32_16x16x32_bf16 v[180:183],a[108:111],a[28:31],v[180:183]
buffer_store_dwordx4 v[164:167],v3,s[56:59],s71 offen offset:2048 sc1
v_mfma_f32_16x16x32_bf16 v[184:187],a[144:147],a[32:35],v[184:187]
v_cvt_pk_bf16_f32 v172,v172,v173
v_cvt_pk_bf16_f32 v173,v174,v175
v_mfma_f32_16x16x32_bf16 v[184:187],a[148:151],a[36:39],v[184:187]
v_cvt_pk_bf16_f32 v174,v176,v177
v_cvt_pk_bf16_f32 v175,v178,v179
v_mfma_f32_16x16x32_bf16 v[184:187],a[152:155],a[40:43],v[184:187]
buffer_store_dwordx4 v[172:175],v3,s[56:59],s71 offen offset:3072 sc1
v_mfma_f32_16x16x32_bf16 v[184:187],a[156:159],a[44:47],v[184:187]
v_mfma_f32_16x16x32_bf16 v[188:191],a[160:163],a[32:35],v[188:191]
v_cvt_pk_bf16_f32 v180,v180,v181
v_cvt_pk_bf16_f32 v181,v182,v183
v_mfma_f32_16x16x32_bf16 v[188:191],a[164:167],a[36:39],v[188:191]
s_add_u32 s71,s71,4096
v_mfma_f32_16x16x32_bf16 v[188:191],a[168:171],a[40:43],v[188:191]
buffer_store_dwordx2 v[180:181],v8,s[56:59],s71 offen sc1
v_mfma_f32_16x16x32_bf16 v[188:191],a[172:175],a[44:47],v[188:191]
v_mfma_f32_16x16x32_bf16 v[192:195],a[176:179],a[32:35],v[192:195]
v_mfma_f32_16x16x32_bf16 v[192:195],a[180:183],a[36:39],v[192:195]
v_mfma_f32_16x16x32_bf16 v[192:195],a[184:187],a[40:43],v[192:195]
v_mfma_f32_16x16x32_bf16 v[192:195],a[188:191],a[44:47],v[192:195]
v_mfma_f32_16x16x32_bf16 v[196:199],a[224:227],a[32:35],v[196:199]
v_cvt_pk_bf16_f32 v184,v184,v185
v_cvt_pk_bf16_f32 v185,v186,v187
v_mfma_f32_16x16x32_bf16 v[196:199],a[228:231],a[36:39],v[196:199]
v_cvt_pk_bf16_f32 v186,v188,v189
v_cvt_pk_bf16_f32 v187,v190,v191
v_mfma_f32_16x16x32_bf16 v[196:199],a[232:235],a[40:43],v[196:199]
s_xor_b32 s71,s70,32
s_mul_i32 s71,s71,15360
v_mfma_f32_16x16x32_bf16 v[196:199],a[236:239],a[44:47],v[196:199]
s_add_u32 s71,s71,5120
v_mfma_f32_16x16x32_bf16 v[200:203],a[240:243],a[32:35],v[200:203]
buffer_store_dwordx4 v[184:187],v3,s[56:59],s71 offen sc1
v_mfma_f32_16x16x32_bf16 v[200:203],a[244:247],a[36:39],v[200:203]
v_mfma_f32_16x16x32_bf16 v[200:203],a[248:251],a[40:43],v[200:203]
v_mfma_f32_16x16x32_bf16 v[200:203],a[252:255],a[44:47],v[200:203]
v_mfma_f32_16x16x32_bf16 v[204:207],a[192:195],a[32:35],v[204:207]
v_cvt_pk_bf16_f32 v192,v192,v193
v_cvt_pk_bf16_f32 v193,v194,v195
v_mfma_f32_16x16x32_bf16 v[204:207],a[196:199],a[36:39],v[204:207]
v_cvt_pk_bf16_f32 v194,v196,v197
v_cvt_pk_bf16_f32 v195,v198,v199
v_mfma_f32_16x16x32_bf16 v[204:207],a[200:203],a[40:43],v[204:207]
buffer_store_dwordx4 v[192:195],v3,s[56:59],s71 offen offset:1024 sc1
v_mfma_f32_16x16x32_bf16 v[204:207],a[204:207],a[44:47],v[204:207]
v_mfma_f32_16x16x32_bf16 v[208:211],a[208:211],a[32:35],v[208:211]
v_mfma_f32_16x16x32_bf16 v[208:211],a[212:215],a[36:39],v[208:211]
v_mfma_f32_16x16x32_bf16 v[208:211],a[216:219],a[40:43],v[208:211]
v_mfma_f32_16x16x32_bf16 v[208:211],a[220:223],a[44:47],v[208:211]
v_mfma_f32_16x16x32_bf16 v[212:215],a[80:83],a[32:35],v[212:215]
v_cvt_pk_bf16_f32 v200,v200,v201
v_cvt_pk_bf16_f32 v201,v202,v203
v_mfma_f32_16x16x32_bf16 v[212:215],a[84:87],a[36:39],v[212:215]
v_cvt_pk_bf16_f32 v202,v204,v205
v_cvt_pk_bf16_f32 v203,v206,v207
v_mfma_f32_16x16x32_bf16 v[212:215],a[88:91],a[40:43],v[212:215]
buffer_store_dwordx4 v[200:203],v3,s[56:59],s71 offen offset:2048 sc1
v_mfma_f32_16x16x32_bf16 v[212:215],a[92:95],a[44:47],v[212:215]
v_mfma_f32_16x16x32_bf16 v[216:219],a[96:99],a[32:35],v[216:219]
v_mfma_f32_16x16x32_bf16 v[216:219],a[100:103],a[36:39],v[216:219]
v_mfma_f32_16x16x32_bf16 v[216:219],a[104:107],a[40:43],v[216:219]
v_mfma_f32_16x16x32_bf16 v[216:219],a[108:111],a[44:47],v[216:219]
v_mfma_f32_16x16x32_bf16 v[220:223],a[144:147],a[48:51],v[220:223]
v_cvt_pk_bf16_f32 v208,v208,v209
v_cvt_pk_bf16_f32 v209,v210,v211
v_mfma_f32_16x16x32_bf16 v[220:223],a[148:151],a[52:55],v[220:223]
v_cvt_pk_bf16_f32 v210,v212,v213
v_cvt_pk_bf16_f32 v211,v214,v215
v_mfma_f32_16x16x32_bf16 v[220:223],a[152:155],a[56:59],v[220:223]
buffer_store_dwordx4 v[208:211],v3,s[56:59],s71 offen offset:3072 sc1
v_mfma_f32_16x16x32_bf16 v[220:223],a[156:159],a[60:63],v[220:223]
v_mfma_f32_16x16x32_bf16 v[224:227],a[160:163],a[48:51],v[224:227]
v_cvt_pk_bf16_f32 v216,v216,v217
v_cvt_pk_bf16_f32 v217,v218,v219
v_mfma_f32_16x16x32_bf16 v[224:227],a[164:167],a[52:55],v[224:227]
s_add_u32 s71,s71,4096
v_mfma_f32_16x16x32_bf16 v[224:227],a[168:171],a[56:59],v[224:227]
buffer_store_dwordx2 v[216:217],v8,s[56:59],s71 offen sc1
v_mfma_f32_16x16x32_bf16 v[224:227],a[172:175],a[60:63],v[224:227]
v_mfma_f32_16x16x32_bf16 v[228:231],a[176:179],a[48:51],v[228:231]
v_mfma_f32_16x16x32_bf16 v[228:231],a[180:183],a[52:55],v[228:231]
v_mfma_f32_16x16x32_bf16 v[228:231],a[184:187],a[56:59],v[228:231]
v_mfma_f32_16x16x32_bf16 v[228:231],a[188:191],a[60:63],v[228:231]
v_mfma_f32_16x16x32_bf16 v[232:235],a[224:227],a[48:51],v[232:235]
v_cvt_pk_bf16_f32 v220,v220,v221
v_cvt_pk_bf16_f32 v221,v222,v223
v_mfma_f32_16x16x32_bf16 v[232:235],a[228:231],a[52:55],v[232:235]
v_cvt_pk_bf16_f32 v222,v224,v225
v_cvt_pk_bf16_f32 v223,v226,v227
v_mfma_f32_16x16x32_bf16 v[232:235],a[232:235],a[56:59],v[232:235]
s_xor_b32 s71,s70,48
s_mul_i32 s71,s71,15360
v_mfma_f32_16x16x32_bf16 v[232:235],a[236:239],a[60:63],v[232:235]
s_add_u32 s71,s71,10240
v_mfma_f32_16x16x32_bf16 v[236:239],a[240:243],a[48:51],v[236:239]
buffer_store_dwordx4 v[220:223],v3,s[56:59],s71 offen sc1
v_mfma_f32_16x16x32_bf16 v[236:239],a[244:247],a[52:55],v[236:239]
v_mfma_f32_16x16x32_bf16 v[236:239],a[248:251],a[56:59],v[236:239]
v_mfma_f32_16x16x32_bf16 v[236:239],a[252:255],a[60:63],v[236:239]
v_mfma_f32_16x16x32_bf16 v[240:243],a[192:195],a[48:51],v[240:243]
v_cvt_pk_bf16_f32 v228,v228,v229
v_cvt_pk_bf16_f32 v229,v230,v231
v_mfma_f32_16x16x32_bf16 v[240:243],a[196:199],a[52:55],v[240:243]
v_cvt_pk_bf16_f32 v230,v232,v233
v_cvt_pk_bf16_f32 v231,v234,v235
v_mfma_f32_16x16x32_bf16 v[240:243],a[200:203],a[56:59],v[240:243]
buffer_store_dwordx4 v[228:231],v3,s[56:59],s71 offen offset:1024 sc1
v_mfma_f32_16x16x32_bf16 v[240:243],a[204:207],a[60:63],v[240:243]
v_mfma_f32_16x16x32_bf16 v[244:247],a[208:211],a[48:51],v[244:247]
v_mfma_f32_16x16x32_bf16 v[244:247],a[212:215],a[52:55],v[244:247]
v_mfma_f32_16x16x32_bf16 v[244:247],a[216:219],a[56:59],v[244:247]
v_mfma_f32_16x16x32_bf16 v[244:247],a[220:223],a[60:63],v[244:247]
v_mfma_f32_16x16x32_bf16 v[248:251],a[80:83],a[48:51],v[248:251]
v_cvt_pk_bf16_f32 v236,v236,v237
v_cvt_pk_bf16_f32 v237,v238,v239
v_mfma_f32_16x16x32_bf16 v[248:251],a[84:87],a[52:55],v[248:251]
v_cvt_pk_bf16_f32 v238,v240,v241
v_cvt_pk_bf16_f32 v239,v242,v243
v_mfma_f32_16x16x32_bf16 v[248:251],a[88:91],a[56:59],v[248:251]
buffer_store_dwordx4 v[236:239],v3,s[56:59],s71 offen offset:2048 sc1
v_mfma_f32_16x16x32_bf16 v[248:251],a[92:95],a[60:63],v[248:251]
v_mfma_f32_16x16x32_bf16 v[252:255],a[96:99],a[48:51],v[252:255]
v_mfma_f32_16x16x32_bf16 v[252:255],a[100:103],a[52:55],v[252:255]
v_mfma_f32_16x16x32_bf16 v[252:255],a[104:107],a[56:59],v[252:255]
v_mfma_f32_16x16x32_bf16 v[252:255],a[108:111],a[60:63],v[252:255]
v_mfma_f32_16x16x32_bf16 v[112:115],a[144:147],a[0:3],v[112:115]
v_cvt_pk_bf16_f32 v244,v244,v245
v_cvt_pk_bf16_f32 v245,v246,v247
v_mfma_f32_16x16x32_bf16 v[112:115],a[148:151],a[4:7],v[112:115]
v_cvt_pk_bf16_f32 v246,v248,v249
v_cvt_pk_bf16_f32 v247,v250,v251
v_mfma_f32_16x16x32_bf16 v[112:115],a[152:155],a[8:11],v[112:115]
buffer_store_dwordx4 v[244:247],v3,s[56:59],s71 offen offset:3072 sc1
v_mfma_f32_16x16x32_bf16 v[112:115],a[156:159],a[12:15],v[112:115]
v_mfma_f32_16x16x32_bf16 v[116:119],a[160:163],a[0:3],v[116:119]
ds_read_b64_tr_b16 a[144:145],v23 offset:36864
ds_read_b64_tr_b16 a[146:147],v23 offset:41472
v_cvt_pk_bf16_f32 v252,v252,v253
v_mfma_f32_16x16x32_bf16 v[116:119],a[164:167],a[4:7],v[116:119]
ds_read_b64_tr_b16 a[148:149],v23 offset:46080
ds_read_b64_tr_b16 a[150:151],v23 offset:50688
v_cvt_pk_bf16_f32 v253,v254,v255
v_mfma_f32_16x16x32_bf16 v[116:119],a[168:171],a[8:11],v[116:119]
ds_read_b64_tr_b16 a[152:153],v28 offset:36864
ds_read_b64_tr_b16 a[154:155],v28 offset:41472
s_add_u32 s71,s71,4096
v_mfma_f32_16x16x32_bf16 v[116:119],a[172:175],a[12:15],v[116:119]
ds_read_b64_tr_b16 a[156:157],v28 offset:46080
ds_read_b64_tr_b16 a[158:159],v28 offset:50688
buffer_store_dwordx2 v[252:253],v8,s[56:59],s71 offen sc1
v_mfma_f32_16x16x32_bf16 v[120:123],a[176:179],a[0:3],v[120:123]
ds_read_b64_tr_b16 a[160:161],v23 offset:36896
ds_read_b64_tr_b16 a[162:163],v23 offset:41504
v_mfma_f32_16x16x32_bf16 v[120:123],a[180:183],a[4:7],v[120:123]
ds_read_b64_tr_b16 a[164:165],v23 offset:46112
ds_read_b64_tr_b16 a[166:167],v23 offset:50720
v_mfma_f32_16x16x32_bf16 v[120:123],a[184:187],a[8:11],v[120:123]
ds_read_b64_tr_b16 a[168:169],v28 offset:36896
ds_read_b64_tr_b16 a[170:171],v28 offset:41504
v_mfma_f32_16x16x32_bf16 v[120:123],a[188:191],a[12:15],v[120:123]
ds_read_b64_tr_b16 a[172:173],v28 offset:46112
ds_read_b64_tr_b16 a[174:175],v28 offset:50720
v_mfma_f32_16x16x32_bf16 v[124:127],a[224:227],a[0:3],v[124:127]
ds_read_b64_tr_b16 a[176:177],v23 offset:36928
ds_read_b64_tr_b16 a[178:179],v23 offset:41536
v_mfma_f32_16x16x32_bf16 v[124:127],a[228:231],a[4:7],v[124:127]
ds_read_b64_tr_b16 a[180:181],v23 offset:46144
ds_read_b64_tr_b16 a[182:183],v23 offset:50752
v_mfma_f32_16x16x32_bf16 v[124:127],a[232:235],a[8:11],v[124:127]
ds_read_b64_tr_b16 a[184:185],v28 offset:36928
ds_read_b64_tr_b16 a[186:187],v28 offset:41536
v_mfma_f32_16x16x32_bf16 v[124:127],a[236:239],a[12:15],v[124:127]
ds_read_b64_tr_b16 a[188:189],v28 offset:46144
ds_read_b64_tr_b16 a[190:191],v28 offset:50752
v_mfma_f32_16x16x32_bf16 v[128:131],a[240:243],a[0:3],v[128:131]
ds_read_b64_tr_b16 a[224:225],v23 offset:36960
ds_read_b64_tr_b16 a[226:227],v23 offset:41568
v_mfma_f32_16x16x32_bf16 v[128:131],a[244:247],a[4:7],v[128:131]
ds_read_b64_tr_b16 a[228:229],v23 offset:46176
ds_read_b64_tr_b16 a[230:231],v23 offset:50784
v_mfma_f32_16x16x32_bf16 v[128:131],a[248:251],a[8:11],v[128:131]
ds_read_b64_tr_b16 a[232:233],v28 offset:36960
ds_read_b64_tr_b16 a[234:235],v28 offset:41568
v_mfma_f32_16x16x32_bf16 v[128:131],a[252:255],a[12:15],v[128:131]
ds_read_b64_tr_b16 a[236:237],v28 offset:46176
ds_read_b64_tr_b16 a[238:239],v28 offset:50784
v_mfma_f32_16x16x32_bf16 v[132:135],a[192:195],a[0:3],v[132:135]
ds_read_b64_tr_b16 a[240:241],v23 offset:36992
ds_read_b64_tr_b16 a[242:243],v23 offset:41600
v_mfma_f32_16x16x32_bf16 v[132:135],a[196:199],a[4:7],v[132:135]
ds_read_b64_tr_b16 a[244:245],v23 offset:46208
ds_read_b64_tr_b16 a[246:247],v23 offset:50816
v_mfma_f32_16x16x32_bf16 v[132:135],a[200:203],a[8:11],v[132:135]
ds_read_b64_tr_b16 a[248:249],v28 offset:36992
ds_read_b64_tr_b16 a[250:251],v28 offset:41600
s_xor_b32 s4,s70,16
s_lshl_b32 s4,s4,8
s_add_u32 s4,s4,0x40000
s_waitcnt vmcnt(10)
buffer_atomic_add v26,v25,s[32:35],s4 offen sc1
v_mfma_f32_16x16x32_bf16 v[132:135],a[204:207],a[12:15],v[132:135]
ds_read_b64_tr_b16 a[252:253],v28 offset:46208
ds_read_b64_tr_b16 a[254:255],v28 offset:50816
v_mfma_f32_16x16x32_bf16 v[136:139],a[208:211],a[0:3],v[136:139]
ds_read_b64_tr_b16 a[192:193],v23 offset:37024
ds_read_b64_tr_b16 a[194:195],v23 offset:41632
v_mfma_f32_16x16x32_bf16 v[136:139],a[212:215],a[4:7],v[136:139]
ds_read_b64_tr_b16 a[196:197],v23 offset:46240
ds_read_b64_tr_b16 a[198:199],v23 offset:50848
v_mfma_f32_16x16x32_bf16 v[136:139],a[216:219],a[8:11],v[136:139]
ds_read_b64_tr_b16 a[200:201],v28 offset:37024
ds_read_b64_tr_b16 a[202:203],v28 offset:41632
v_mfma_f32_16x16x32_bf16 v[136:139],a[220:223],a[12:15],v[136:139]
ds_read_b64_tr_b16 a[204:205],v28 offset:46240
ds_read_b64_tr_b16 a[206:207],v28 offset:50848
v_mfma_f32_16x16x32_bf16 v[140:143],a[80:83],a[0:3],v[140:143]
ds_read_b64_tr_b16 a[208:209],v23 offset:37056
ds_read_b64_tr_b16 a[210:211],v23 offset:41664
v_mfma_f32_16x16x32_bf16 v[140:143],a[84:87],a[4:7],v[140:143]
ds_read_b64_tr_b16 a[212:213],v23 offset:46272
ds_read_b64_tr_b16 a[214:215],v23 offset:50880
v_mfma_f32_16x16x32_bf16 v[140:143],a[88:91],a[8:11],v[140:143]
ds_read_b64_tr_b16 a[216:217],v28 offset:37056
ds_read_b64_tr_b16 a[218:219],v28 offset:41664
v_mfma_f32_16x16x32_bf16 v[140:143],a[92:95],a[12:15],v[140:143]
ds_read_b64_tr_b16 a[220:221],v28 offset:46272
ds_read_b64_tr_b16 a[222:223],v28 offset:50880
v_mfma_f32_16x16x32_bf16 v[144:147],a[96:99],a[0:3],v[144:147]
ds_read_b64_tr_b16 a[80:81],v23 offset:37088
ds_read_b64_tr_b16 a[82:83],v23 offset:41696
v_mfma_f32_16x16x32_bf16 v[144:147],a[100:103],a[4:7],v[144:147]
ds_read_b64_tr_b16 a[84:85],v23 offset:46304
ds_read_b64_tr_b16 a[86:87],v23 offset:50912
v_mfma_f32_16x16x32_bf16 v[144:147],a[104:107],a[8:11],v[144:147]
ds_read_b64_tr_b16 a[88:89],v28 offset:37088
ds_read_b64_tr_b16 a[90:91],v28 offset:41696
v_mfma_f32_16x16x32_bf16 v[144:147],a[108:111],a[12:15],v[144:147]
ds_read_b64_tr_b16 a[92:93],v28 offset:46304
ds_read_b64_tr_b16 a[94:95],v28 offset:50912
s_waitcnt lgkmcnt(10)
v_mfma_f32_16x16x32_bf16 v[112:115],a[144:147],a[128:131],v[112:115]
ds_read_b64_tr_b16 a[96:97],v23 offset:37120
ds_read_b64_tr_b16 a[98:99],v23 offset:41728
v_mfma_f32_16x16x32_bf16 v[112:115],a[148:151],a[132:135],v[112:115]
ds_read_b64_tr_b16 a[100:101],v23 offset:46336
ds_read_b64_tr_b16 a[102:103],v23 offset:50944
v_mfma_f32_16x16x32_bf16 v[112:115],a[152:155],a[136:139],v[112:115]
ds_read_b64_tr_b16 a[104:105],v28 offset:37120
ds_read_b64_tr_b16 a[106:107],v28 offset:41728
v_mfma_f32_16x16x32_bf16 v[112:115],a[156:159],a[140:143],v[112:115]
ds_read_b64_tr_b16 a[108:109],v28 offset:46336
ds_read_b64_tr_b16 a[110:111],v28 offset:50944
v_mfma_f32_16x16x32_bf16 v[116:119],a[160:163],a[128:131],v[116:119]
ds_read_b64_tr_b16 a[144:145],v23 offset:0
ds_read_b64_tr_b16 a[146:147],v23 offset:4608
v_mfma_f32_16x16x32_bf16 v[116:119],a[164:167],a[132:135],v[116:119]
ds_read_b64_tr_b16 a[148:149],v23 offset:9216
ds_read_b64_tr_b16 a[150:151],v23 offset:13824
v_mfma_f32_16x16x32_bf16 v[116:119],a[168:171],a[136:139],v[116:119]
ds_read_b64_tr_b16 a[152:153],v28 offset:0
ds_read_b64_tr_b16 a[154:155],v28 offset:4608
v_mfma_f32_16x16x32_bf16 v[116:119],a[172:175],a[140:143],v[116:119]
ds_read_b64_tr_b16 a[156:157],v28 offset:9216
ds_read_b64_tr_b16 a[158:159],v28 offset:13824
v_mfma_f32_16x16x32_bf16 v[120:123],a[176:179],a[128:131],v[120:123]
ds_read_b64_tr_b16 a[160:161],v23 offset:32
ds_read_b64_tr_b16 a[162:163],v23 offset:4640
v_mfma_f32_16x16x32_bf16 v[120:123],a[180:183],a[132:135],v[120:123]
ds_read_b64_tr_b16 a[164:165],v23 offset:9248
ds_read_b64_tr_b16 a[166:167],v23 offset:13856
v_mfma_f32_16x16x32_bf16 v[120:123],a[184:187],a[136:139],v[120:123]
ds_read_b64_tr_b16 a[168:169],v28 offset:32
ds_read_b64_tr_b16 a[170:171],v28 offset:4640
v_mfma_f32_16x16x32_bf16 v[120:123],a[188:191],a[140:143],v[120:123]
ds_read_b64_tr_b16 a[172:173],v28 offset:9248
ds_read_b64_tr_b16 a[174:175],v28 offset:13856
v_mfma_f32_16x16x32_bf16 v[124:127],a[224:227],a[128:131],v[124:127]
ds_read_b64_tr_b16 a[176:177],v23 offset:64
ds_read_b64_tr_b16 a[178:179],v23 offset:4672
v_mfma_f32_16x16x32_bf16 v[124:127],a[228:231],a[132:135],v[124:127]
ds_read_b64_tr_b16 a[180:181],v23 offset:9280
ds_read_b64_tr_b16 a[182:183],v23 offset:13888
v_mfma_f32_16x16x32_bf16 v[124:127],a[232:235],a[136:139],v[124:127]
ds_read_b64_tr_b16 a[184:185],v28 offset:64
ds_read_b64_tr_b16 a[186:187],v28 offset:4672
v_mfma_f32_16x16x32_bf16 v[124:127],a[236:239],a[140:143],v[124:127]
ds_read_b64_tr_b16 a[188:189],v28 offset:9280
ds_read_b64_tr_b16 a[190:191],v28 offset:13888
v_mfma_f32_16x16x32_bf16 v[128:131],a[240:243],a[128:131],v[128:131]
ds_read_b64_tr_b16 a[224:225],v23 offset:96
ds_read_b64_tr_b16 a[226:227],v23 offset:4704
s_xor_b32 s4,s70,32
s_lshl_b32 s4,s4,8
s_add_u32 s4,s4,0x40000
s_waitcnt vmcnt(6)
buffer_atomic_add v26,v25,s[32:35],s4 offen sc1
v_mfma_f32_16x16x32_bf16 v[128:131],a[244:247],a[132:135],v[128:131]
ds_read_b64_tr_b16 a[228:229],v23 offset:9312
ds_read_b64_tr_b16 a[230:231],v23 offset:13920
v_mfma_f32_16x16x32_bf16 v[128:131],a[248:251],a[136:139],v[128:131]
ds_read_b64_tr_b16 a[232:233],v28 offset:96
ds_read_b64_tr_b16 a[234:235],v28 offset:4704
v_mfma_f32_16x16x32_bf16 v[128:131],a[252:255],a[140:143],v[128:131]
ds_read_b64_tr_b16 a[236:237],v28 offset:9312
ds_read_b64_tr_b16 a[238:239],v28 offset:13920
v_mfma_f32_16x16x32_bf16 v[132:135],a[192:195],a[128:131],v[132:135]
ds_read_b64_tr_b16 a[240:241],v23 offset:128
ds_read_b64_tr_b16 a[242:243],v23 offset:4736
v_mfma_f32_16x16x32_bf16 v[132:135],a[196:199],a[132:135],v[132:135]
ds_read_b64_tr_b16 a[244:245],v23 offset:9344
ds_read_b64_tr_b16 a[246:247],v23 offset:13952
v_mfma_f32_16x16x32_bf16 v[132:135],a[200:203],a[136:139],v[132:135]
ds_read_b64_tr_b16 a[248:249],v28 offset:128
ds_read_b64_tr_b16 a[250:251],v28 offset:4736
v_mfma_f32_16x16x32_bf16 v[132:135],a[204:207],a[140:143],v[132:135]
ds_read_b64_tr_b16 a[252:253],v28 offset:9344
ds_read_b64_tr_b16 a[254:255],v28 offset:13952
v_mfma_f32_16x16x32_bf16 v[136:139],a[208:211],a[128:131],v[136:139]
ds_read_b64_tr_b16 a[192:193],v23 offset:160
ds_read_b64_tr_b16 a[194:195],v23 offset:4768
v_mfma_f32_16x16x32_bf16 v[136:139],a[212:215],a[132:135],v[136:139]
ds_read_b64_tr_b16 a[196:197],v23 offset:9376
ds_read_b64_tr_b16 a[198:199],v23 offset:13984
v_mfma_f32_16x16x32_bf16 v[136:139],a[216:219],a[136:139],v[136:139]
ds_read_b64_tr_b16 a[200:201],v28 offset:160
ds_read_b64_tr_b16 a[202:203],v28 offset:4768
s_waitcnt lgkmcnt(10)
v_mfma_f32_16x16x32_bf16 v[136:139],a[220:223],a[140:143],v[136:139]
ds_read_b64_tr_b16 a[204:205],v28 offset:9376
ds_read_b64_tr_b16 a[206:207],v28 offset:13984
v_mfma_f32_16x16x32_bf16 v[140:143],a[80:83],a[128:131],v[140:143]
ds_read_b64_tr_b16 a[208:209],v23 offset:192
ds_read_b64_tr_b16 a[210:211],v23 offset:4800
v_mfma_f32_16x16x32_bf16 v[140:143],a[84:87],a[132:135],v[140:143]
ds_read_b64_tr_b16 a[212:213],v23 offset:9408
ds_read_b64_tr_b16 a[214:215],v23 offset:14016
v_mfma_f32_16x16x32_bf16 v[140:143],a[88:91],a[136:139],v[140:143]
ds_read_b64_tr_b16 a[216:217],v28 offset:192
ds_read_b64_tr_b16 a[218:219],v28 offset:4800
v_mfma_f32_16x16x32_bf16 v[140:143],a[92:95],a[140:143],v[140:143]
ds_read_b64_tr_b16 a[220:221],v28 offset:9408
ds_read_b64_tr_b16 a[222:223],v28 offset:14016
v_mfma_f32_16x16x32_bf16 v[144:147],a[96:99],a[128:131],v[144:147]
ds_read_b64_tr_b16 a[80:81],v23 offset:224
ds_read_b64_tr_b16 a[82:83],v23 offset:4832
v_mfma_f32_16x16x32_bf16 v[144:147],a[100:103],a[132:135],v[144:147]
ds_read_b64_tr_b16 a[84:85],v23 offset:9440
ds_read_b64_tr_b16 a[86:87],v23 offset:14048
v_mfma_f32_16x16x32_bf16 v[144:147],a[104:107],a[136:139],v[144:147]
ds_read_b64_tr_b16 a[88:89],v28 offset:224
ds_read_b64_tr_b16 a[90:91],v28 offset:4832
v_mfma_f32_16x16x32_bf16 v[144:147],a[108:111],a[140:143],v[144:147]
ds_read_b64_tr_b16 a[92:93],v28 offset:9440
ds_read_b64_tr_b16 a[94:95],v28 offset:14048
v_mfma_f32_16x16x32_bf16 v[112:115],a[144:147],a[64:67],v[112:115]
ds_read_b64_tr_b16 a[96:97],v23 offset:256
ds_read_b64_tr_b16 a[98:99],v23 offset:4864
v_mfma_f32_16x16x32_bf16 v[112:115],a[148:151],a[68:71],v[112:115]
ds_read_b64_tr_b16 a[100:101],v23 offset:9472
ds_read_b64_tr_b16 a[102:103],v23 offset:14080
v_mfma_f32_16x16x32_bf16 v[112:115],a[152:155],a[72:75],v[112:115]
ds_read_b64_tr_b16 a[104:105],v28 offset:256
ds_read_b64_tr_b16 a[106:107],v28 offset:4864
v_mfma_f32_16x16x32_bf16 v[112:115],a[156:159],a[76:79],v[112:115]
ds_read_b64_tr_b16 a[108:109],v28 offset:9472
ds_read_b64_tr_b16 a[110:111],v28 offset:14080
v_mfma_f32_16x16x32_bf16 v[116:119],a[160:163],a[64:67],v[116:119]
v_mfma_f32_16x16x32_bf16 v[116:119],a[164:167],a[68:71],v[116:119]
v_mfma_f32_16x16x32_bf16 v[116:119],a[168:171],a[72:75],v[116:119]
v_mfma_f32_16x16x32_bf16 v[116:119],a[172:175],a[76:79],v[116:119]
v_mfma_f32_16x16x32_bf16 v[120:123],a[176:179],a[64:67],v[120:123]
v_mfma_f32_16x16x32_bf16 v[120:123],a[180:183],a[68:71],v[120:123]
v_mfma_f32_16x16x32_bf16 v[120:123],a[184:187],a[72:75],v[120:123]
s_xor_b32 s4,s70,48
s_lshl_b32 s4,s4,8
s_add_u32 s4,s4,0x40000
s_waitcnt vmcnt(2)
buffer_atomic_add v26,v25,s[32:35],s4 offen sc1
v_mfma_f32_16x16x32_bf16 v[120:123],a[188:191],a[76:79],v[120:123]
v_mfma_f32_16x16x32_bf16 v[124:127],a[224:227],a[64:67],v[124:127]
v_mfma_f32_16x16x32_bf16 v[124:127],a[228:231],a[68:71],v[124:127]
v_mfma_f32_16x16x32_bf16 v[124:127],a[232:235],a[72:75],v[124:127]
v_mfma_f32_16x16x32_bf16 v[124:127],a[236:239],a[76:79],v[124:127]
v_mfma_f32_16x16x32_bf16 v[128:131],a[240:243],a[64:67],v[128:131]
v_mfma_f32_16x16x32_bf16 v[128:131],a[244:247],a[68:71],v[128:131]
s_waitcnt lgkmcnt(0)
v_mfma_f32_16x16x32_bf16 v[128:131],a[248:251],a[72:75],v[128:131]
v_mfma_f32_16x16x32_bf16 v[128:131],a[252:255],a[76:79],v[128:131]
v_mfma_f32_16x16x32_bf16 v[132:135],a[192:195],a[64:67],v[132:135]
v_mfma_f32_16x16x32_bf16 v[132:135],a[196:199],a[68:71],v[132:135]
v_mfma_f32_16x16x32_bf16 v[132:135],a[200:203],a[72:75],v[132:135]
v_mfma_f32_16x16x32_bf16 v[132:135],a[204:207],a[76:79],v[132:135]
v_mfma_f32_16x16x32_bf16 v[136:139],a[208:211],a[64:67],v[136:139]
v_mfma_f32_16x16x32_bf16 v[136:139],a[212:215],a[68:71],v[136:139]
v_mfma_f32_16x16x32_bf16 v[136:139],a[216:219],a[72:75],v[136:139]
v_mfma_f32_16x16x32_bf16 v[136:139],a[220:223],a[76:79],v[136:139]
v_mfma_f32_16x16x32_bf16 v[140:143],a[80:83],a[64:67],v[140:143]
v_mfma_f32_16x16x32_bf16 v[140:143],a[84:87],a[68:71],v[140:143]
v_mfma_f32_16x16x32_bf16 v[140:143],a[88:91],a[72:75],v[140:143]
v_mfma_f32_16x16x32_bf16 v[140:143],a[92:95],a[76:79],v[140:143]
v_mfma_f32_16x16x32_bf16 v[144:147],a[96:99],a[64:67],v[144:147]
v_mfma_f32_16x16x32_bf16 v[144:147],a[100:103],a[68:71],v[144:147]
v_mfma_f32_16x16x32_bf16 v[144:147],a[104:107],a[72:75],v[144:147]
v_mfma_f32_16x16x32_bf16 v[144:147],a[108:111],a[76:79],v[144:147]
buffer_load_dword v24,v27,s[32:35],s67 offen sc1
s_lshl_b32 s4,s37,4
s_lshl_b32 s6,s3,2
s_add_u32 s4,s4,s6
s_add_u32 s4,s4,s64
s_mul_i32 s4,s4,36864
s_mul_i32 s6,s36,1152
s_add_u32 s4,s4,s6
s_mul_i32 s6,s91,288
s_add_u32 s4,s4,s6
s_mul_i32 s71,s70,15360
s_waitcnt vmcnt(0)
s_mov_b32 s55,0x20000
FC4_RE:
v_readfirstlane_b32 s53,v24
s_nop 0
s_bfe_u32 s53,s53,524288
s_cmp_ge_u32 s53,3
s_cbranch_scc0 FC4_SPIN
FC4_OK:
s_add_u32 s41,s71,0
buffer_load_dwordx4 a[0:3],v3,s[56:59],s41 offen sc1
s_add_u32 s41,s71,5120
buffer_load_dwordx4 a[20:23],v3,s[56:59],s41 offen sc1
s_add_u32 s41,s71,10240
buffer_load_dwordx4 a[40:43],v3,s[56:59],s41 offen sc1
s_add_u32 s41,s71,1024
buffer_load_dwordx4 a[4:7],v3,s[56:59],s41 offen sc1
s_add_u32 s41,s71,6144
buffer_load_dwordx4 a[24:27],v3,s[56:59],s41 offen sc1
s_add_u32 s41,s71,11264
buffer_load_dwordx4 a[44:47],v3,s[56:59],s41 offen sc1
s_add_u32 s41,s71,2048
buffer_load_dwordx4 a[8:11],v3,s[56:59],s41 offen sc1
s_add_u32 s41,s71,7168
buffer_load_dwordx4 a[28:31],v3,s[56:59],s41 offen sc1
s_add_u32 s41,s71,12288
buffer_load_dwordx4 a[48:51],v3,s[56:59],s41 offen sc1
s_add_u32 s41,s71,3072
buffer_load_dwordx4 a[12:15],v3,s[56:59],s41 offen sc1
s_add_u32 s41,s71,8192
buffer_load_dwordx4 a[32:35],v3,s[56:59],s41 offen sc1
s_add_u32 s41,s71,13312
buffer_load_dwordx4 a[52:55],v3,s[56:59],s41 offen sc1
s_add_u32 s41,s71,4096
buffer_load_dwordx2 a[16:17],v8,s[56:59],s41 offen sc1
s_add_u32 s41,s71,9216
buffer_load_dwordx2 a[36:37],v8,s[56:59],s41 offen sc1
s_add_u32 s41,s71,14336
buffer_load_dwordx2 a[56:57],v8,s[56:59],s41 offen sc1
v_accvgpr_write_b32 a18,0
v_accvgpr_write_b32 a19,0
v_accvgpr_write_b32 a38,0
v_accvgpr_write_b32 a39,0
v_accvgpr_write_b32 a58,0
v_accvgpr_write_b32 a59,0
s_waitcnt vmcnt(12)
v_mfma_f32_16x16x32_bf16 v[112:115],v[96:99],a[0:3],v[112:115]
v_mfma_f32_16x16x32_bf16 v[112:115],v[96:99],a[20:23],v[112:115]
v_mfma_f32_16x16x32_bf16 v[112:115],v[96:99],a[40:43],v[112:115]
v_mfma_f32_16x16x32_bf16 v[116:119],v[100:103],a[0:3],v[116:119]
v_mfma_f32_16x16x32_bf16 v[116:119],v[100:103],a[20:23],v[116:119]
v_mfma_f32_16x16x32_bf16 v[116:119],v[100:103],a[40:43],v[116:119]
s_waitcnt vmcnt(9)
v_mfma_f32_16x16x32_bf16 v[120:123],v[96:99],a[4:7],v[120:123]
v_mfma_f32_16x16x32_bf16 v[120:123],v[96:99],a[24:27],v[120:123]
v_mfma_f32_16x16x32_bf16 v[120:123],v[96:99],a[44:47],v[120:123]
v_mfma_f32_16x16x32_bf16 v[124:127],v[100:103],a[4:7],v[124:127]
v_mfma_f32_16x16x32_bf16 v[124:127],v[100:103],a[24:27],v[124:127]
v_mfma_f32_16x16x32_bf16 v[124:127],v[100:103],a[44:47],v[124:127]
s_nop 1
v_cvt_pk_bf16_f32 v112,v112,v113
v_cvt_pk_bf16_f32 v113,v114,v115
ds_write_b64 v9,v[112:113] offset:0
v_cvt_pk_bf16_f32 v116,v116,v117
v_cvt_pk_bf16_f32 v117,v118,v119
ds_write_b64 v9,v[116:117] offset:32
s_waitcnt vmcnt(6)
v_mfma_f32_16x16x32_bf16 v[128:131],v[96:99],a[8:11],v[128:131]
v_mfma_f32_16x16x32_bf16 v[128:131],v[96:99],a[28:31],v[128:131]
v_mfma_f32_16x16x32_bf16 v[128:131],v[96:99],a[48:51],v[128:131]
v_mfma_f32_16x16x32_bf16 v[132:135],v[100:103],a[8:11],v[132:135]
v_mfma_f32_16x16x32_bf16 v[132:135],v[100:103],a[28:31],v[132:135]
v_mfma_f32_16x16x32_bf16 v[132:135],v[100:103],a[48:51],v[132:135]
s_nop 1
v_cvt_pk_bf16_f32 v120,v120,v121
v_cvt_pk_bf16_f32 v121,v122,v123
ds_write_b64 v9,v[120:121] offset:64
v_cvt_pk_bf16_f32 v124,v124,v125
v_cvt_pk_bf16_f32 v125,v126,v127
ds_write_b64 v9,v[124:125] offset:96
s_waitcnt vmcnt(3)
v_mfma_f32_16x16x32_bf16 v[136:139],v[96:99],a[12:15],v[136:139]
v_mfma_f32_16x16x32_bf16 v[136:139],v[96:99],a[32:35],v[136:139]
v_mfma_f32_16x16x32_bf16 v[136:139],v[96:99],a[52:55],v[136:139]
v_mfma_f32_16x16x32_bf16 v[140:143],v[100:103],a[12:15],v[140:143]
v_mfma_f32_16x16x32_bf16 v[140:143],v[100:103],a[32:35],v[140:143]
v_mfma_f32_16x16x32_bf16 v[140:143],v[100:103],a[52:55],v[140:143]
s_nop 1
v_cvt_pk_bf16_f32 v128,v128,v129
v_cvt_pk_bf16_f32 v129,v130,v131
ds_write_b64 v9,v[128:129] offset:128
v_cvt_pk_bf16_f32 v132,v132,v133
v_cvt_pk_bf16_f32 v133,v134,v135
ds_write_b64 v9,v[132:133] offset:160
s_waitcnt vmcnt(0)
v_mfma_f32_16x16x32_bf16 v[144:147],v[96:99],a[16:19],v[144:147]
v_mfma_f32_16x16x32_bf16 v[144:147],v[96:99],a[36:39],v[144:147]
v_mfma_f32_16x16x32_bf16 v[144:147],v[96:99],a[56:59],v[144:147]
s_nop 1
v_cvt_pk_bf16_f32 v136,v136,v137
v_cvt_pk_bf16_f32 v137,v138,v139
ds_write_b64 v9,v[136:137] offset:192
v_cvt_pk_bf16_f32 v140,v140,v141
v_cvt_pk_bf16_f32 v141,v142,v143
ds_write_b64 v9,v[140:141] offset:224
s_nop 1
v_cvt_pk_bf16_f32 v144,v144,v145
v_cvt_pk_bf16_f32 v145,v146,v147
ds_write_b64 v9,v[144:145] offset:256
s_waitcnt lgkmcnt(0)
ds_read_b128 v[48:51],v10
ds_read_b128 v[52:55],v11
ds_read_b128 v[56:59],v12
ds_read_b128 v[60:63],v13
ds_read_b128 v[64:67],v14
s_waitcnt lgkmcnt(4)
buffer_store_dwordx4 v[48:51],v15,s[24:27],s4 offen
s_waitcnt lgkmcnt(3)
buffer_store_dwordx4 v[52:55],v16,s[24:27],s4 offen
s_waitcnt lgkmcnt(2)
buffer_store_dwordx4 v[56:59],v17,s[24:27],s4 offen
s_waitcnt lgkmcnt(1)
buffer_store_dwordx4 v[60:63],v18,s[24:27],s4 offen
s_waitcnt lgkmcnt(0)
buffer_store_dwordx4 v[64:67],v19,s[24:27],s4 offen
s_endpgm
K1_COLD:
FC1_SPIN:
s_sub_u32 s55,s55,1
s_cbranch_scc1 FC1_OK
s_sleep 8
buffer_load_dword v24,v27,s[60:63],s83 offen sc1
s_waitcnt vmcnt(0)
s_branch FC1_RE
FC4_SPIN:
s_sub_u32 s55,s55,1
s_cbranch_scc1 FC4_OK
s_sleep 1
buffer_load_dword v24,v27,s[32:35],s67 offen sc1
s_waitcnt vmcnt(0)
s_branch FC4_RE
FO0_SPIN:
s_sub_u32 s55,s55,1
s_cbranch_scc1 FO0_OK
s_sleep 8
buffer_load_dword v24,v27,s[32:35],s82 offen sc1
s_waitcnt vmcnt(0)
s_branch FO0_RE
FO1_SPIN:
s_sub_u32 s55,s55,1
s_cbranch_scc1 FO1_OK
s_sleep 8
buffer_load_dword v24,v27,s[32:35],s82 offen sc1
s_waitcnt vmcnt(0)
s_branch FO1_RE
FB0:
s_waitcnt vmcnt(0) lgkmcnt(0)
s_mov_b32 s7,m0
v_and_b32 v38,1,v31
v_lshrrev_b32 v39,1,v31
v_lshl_add_u32 v38,v38,1,v39
v_lshlrev_b32 v38,4,v38
v_lshl_add_u32 v38,v30,8,v38
v_lshl_add_u32 v39,v31,2,v32
v_lshlrev_b32 v39,8,v39
v_lshl_add_u32 v39,v33,3,v39
v_add_u32 v39,s40,v39
v_add_u32 v39,131072,v39
v_mov_b32 v34,0xff800000
v_mov_b32 v35,0xff800000
v_mov_b32 v36,0xff800000
v_mov_b32 v37,0xff800000
s_mov_b32 s4,0
FB0_L1:
s_add_u32 s5,s4,4096
buffer_load_dwordx4 a[192:195],v38,s[8:11],s4 offen offset:0
buffer_load_dwordx4 a[196:199],v38,s[8:11],s4 offen offset:64
buffer_load_dwordx4 a[200:203],v38,s[8:11],s4 offen offset:128
buffer_load_dwordx4 a[204:207],v38,s[8:11],s4 offen offset:192
buffer_load_dwordx4 a[208:211],v38,s[8:11],s5 offen offset:0
buffer_load_dwordx4 a[212:215],v38,s[8:11],s5 offen offset:64
buffer_load_dwordx4 a[216:219],v38,s[8:11],s5 offen offset:128
buffer_load_dwordx4 a[220:223],v38,s[8:11],s5 offen offset:192
s_waitcnt vmcnt(0)
v_mfma_f32_16x16x32_bf16 v[96:99],a[192:195],a[0:3],0
v_mfma_f32_16x16x32_bf16 v[96:99],a[196:199],a[4:7],v[96:99]
v_mfma_f32_16x16x32_bf16 v[96:99],a[200:203],a[8:11],v[96:99]
v_mfma_f32_16x16x32_bf16 v[96:99],a[204:207],a[12:15],v[96:99]
v_mfma_f32_16x16x32_bf16 v[100:103],a[208:211],a[0:3],0
v_mfma_f32_16x16x32_bf16 v[100:103],a[212:215],a[4:7],v[100:103]
v_mfma_f32_16x16x32_bf16 v[100:103],a[216:219],a[8:11],v[100:103]
v_mfma_f32_16x16x32_bf16 v[100:103],a[220:223],a[12:15],v[100:103]
v_mfma_f32_16x16x32_bf16 v[104:107],a[192:195],a[16:19],0
v_mfma_f32_16x16x32_bf16 v[104:107],a[196:199],a[20:23],v[104:107]
v_mfma_f32_16x16x32_bf16 v[104:107],a[200:203],a[24:27],v[104:107]
v_mfma_f32_16x16x32_bf16 v[104:107],a[204:207],a[28:31],v[104:107]
v_mfma_f32_16x16x32_bf16 v[108:111],a[208:211],a[16:19],0
v_mfma_f32_16x16x32_bf16 v[108:111],a[212:215],a[20:23],v[108:111]
v_mfma_f32_16x16x32_bf16 v[108:111],a[216:219],a[24:27],v[108:111]
v_mfma_f32_16x16x32_bf16 v[108:111],a[220:223],a[28:31],v[108:111]
v_mfma_f32_16x16x32_bf16 v[112:115],a[192:195],a[32:35],0
v_mfma_f32_16x16x32_bf16 v[112:115],a[196:199],a[36:39],v[112:115]
v_mfma_f32_16x16x32_bf16 v[112:115],a[200:203],a[40:43],v[112:115]
v_mfma_f32_16x16x32_bf16 v[112:115],a[204:207],a[44:47],v[112:115]
v_mfma_f32_16x16x32_bf16 v[116:119],a[208:211],a[32:35],0
v_mfma_f32_16x16x32_bf16 v[116:119],a[212:215],a[36:39],v[116:119]
v_mfma_f32_16x16x32_bf16 v[116:119],a[216:219],a[40:43],v[116:119]
v_mfma_f32_16x16x32_bf16 v[116:119],a[220:223],a[44:47],v[116:119]
v_mfma_f32_16x16x32_bf16 v[120:123],a[192:195],a[48:51],0
v_mfma_f32_16x16x32_bf16 v[120:123],a[196:199],a[52:55],v[120:123]
v_mfma_f32_16x16x32_bf16 v[120:123],a[200:203],a[56:59],v[120:123]
v_mfma_f32_16x16x32_bf16 v[120:123],a[204:207],a[60:63],v[120:123]
v_mfma_f32_16x16x32_bf16 v[124:127],a[208:211],a[48:51],0
v_mfma_f32_16x16x32_bf16 v[124:127],a[212:215],a[52:55],v[124:127]
v_mfma_f32_16x16x32_bf16 v[124:127],a[216:219],a[56:59],v[124:127]
v_mfma_f32_16x16x32_bf16 v[124:127],a[220:223],a[60:63],v[124:127]
s_nop 7
v_max3_f32 v34,v34,v96,v97
v_max3_f32 v35,v35,v104,v105
v_max3_f32 v36,v36,v112,v113
v_max3_f32 v37,v37,v120,v121
v_max3_f32 v34,v34,v98,v99
v_max3_f32 v35,v35,v106,v107
v_max3_f32 v36,v36,v114,v115
v_max3_f32 v37,v37,v122,v123
v_max3_f32 v34,v34,v100,v101
v_max3_f32 v35,v35,v108,v109
v_max3_f32 v36,v36,v116,v117
v_max3_f32 v37,v37,v124,v125
v_max3_f32 v34,v34,v102,v103
v_max3_f32 v35,v35,v110,v111
v_max3_f32 v36,v36,v118,v119
v_max3_f32 v37,v37,v126,v127
s_add_u32 s4,s4,8192
s_cmp_lt_u32 s4,262144
s_cbranch_scc1 FB0_L1
v_mov_b32 v96,v34
v_mov_b32 v97,v35
v_mov_b32 v98,v36
v_mov_b32 v99,v37
s_nop 1
v_permlane16_swap_b32 v34,v96
v_permlane16_swap_b32 v35,v97
v_permlane16_swap_b32 v36,v98
v_permlane16_swap_b32 v37,v99
v_max_f32 v34,v34,v96
v_max_f32 v35,v35,v97
v_max_f32 v36,v36,v98
v_max_f32 v37,v37,v99
v_mov_b32 v96,v34
v_mov_b32 v97,v35
v_mov_b32 v98,v36
v_mov_b32 v99,v37
s_nop 1
v_permlane32_swap_b32 v34,v96
v_permlane32_swap_b32 v35,v97
v_permlane32_swap_b32 v36,v98
v_permlane32_swap_b32 v37,v99
v_max_f32 v34,v34,v96
v_max_f32 v35,v35,v97
v_max_f32 v36,v36,v98
v_max_f32 v37,v37,v99
v_sub_f32 v64,0,v34
v_sub_f32 v65,0,v34
v_sub_f32 v66,0,v34
v_sub_f32 v67,0,v34
v_sub_f32 v68,0,v35
v_sub_f32 v69,0,v35
v_sub_f32 v70,0,v35
v_sub_f32 v71,0,v35
v_sub_f32 v72,0,v36
v_sub_f32 v73,0,v36
v_sub_f32 v74,0,v36
v_sub_f32 v75,0,v36
v_sub_f32 v76,0,v37
v_sub_f32 v77,0,v37
v_sub_f32 v78,0,v37
v_sub_f32 v79,0,v37
v_mov_b32 v128,0
v_mov_b32 v129,0
v_mov_b32 v130,0
v_mov_b32 v131,0
v_mov_b32 v132,0
v_mov_b32 v133,0
v_mov_b32 v134,0
v_mov_b32 v135,0
v_mov_b32 v136,0
v_mov_b32 v137,0
v_mov_b32 v138,0
v_mov_b32 v139,0
v_mov_b32 v140,0
v_mov_b32 v141,0
v_mov_b32 v142,0
v_mov_b32 v143,0
v_mov_b32 v144,0
v_mov_b32 v145,0
v_mov_b32 v146,0
v_mov_b32 v147,0
v_mov_b32 v148,0
v_mov_b32 v149,0
v_mov_b32 v150,0
v_mov_b32 v151,0
v_mov_b32 v152,0
v_mov_b32 v153,0
v_mov_b32 v154,0
v_mov_b32 v155,0
v_mov_b32 v156,0
v_mov_b32 v157,0
v_mov_b32 v158,0
v_mov_b32 v159,0
v_mov_b32 v160,0
v_mov_b32 v161,0
v_mov_b32 v162,0
v_mov_b32 v163,0
v_mov_b32 v164,0
v_mov_b32 v165,0
v_mov_b32 v166,0
v_mov_b32 v167,0
v_mov_b32 v168,0
v_mov_b32 v169,0
v_mov_b32 v170,0
v_mov_b32 v171,0
v_mov_b32 v172,0
v_mov_b32 v173,0
v_mov_b32 v174,0
v_mov_b32 v175,0
v_mov_b32 v176,0
v_mov_b32 v177,0
v_mov_b32 v178,0
v_mov_b32 v179,0
v_mov_b32 v180,0
v_mov_b32 v181,0
v_mov_b32 v182,0
v_mov_b32 v183,0
v_mov_b32 v184,0
v_mov_b32 v185,0
v_mov_b32 v186,0
v_mov_b32 v187,0
v_mov_b32 v188,0
v_mov_b32 v189,0
v_mov_b32 v190,0
v_mov_b32 v191,0
v_mov_b32 v192,0
v_mov_b32 v193,0
v_mov_b32 v194,0
v_mov_b32 v195,0
v_mov_b32 v196,0
v_mov_b32 v197,0
v_mov_b32 v198,0
v_mov_b32 v199,0
v_mov_b32 v200,0
v_mov_b32 v201,0
v_mov_b32 v202,0
v_mov_b32 v203,0
v_mov_b32 v204,0
v_mov_b32 v205,0
v_mov_b32 v206,0
v_mov_b32 v207,0
v_mov_b32 v208,0
v_mov_b32 v209,0
v_mov_b32 v210,0
v_mov_b32 v211,0
v_mov_b32 v212,0
v_mov_b32 v213,0
v_mov_b32 v214,0
v_mov_b32 v215,0
v_mov_b32 v216,0
v_mov_b32 v217,0
v_mov_b32 v218,0
v_mov_b32 v219,0
v_mov_b32 v220,0
v_mov_b32 v221,0
v_mov_b32 v222,0
v_mov_b32 v223,0
v_mov_b32 v224,0
v_mov_b32 v225,0
v_mov_b32 v226,0
v_mov_b32 v227,0
v_mov_b32 v228,0
v_mov_b32 v229,0
v_mov_b32 v230,0
v_mov_b32 v231,0
v_mov_b32 v232,0
v_mov_b32 v233,0
v_mov_b32 v234,0
v_mov_b32 v235,0
v_mov_b32 v236,0
v_mov_b32 v237,0
v_mov_b32 v238,0
v_mov_b32 v239,0
v_mov_b32 v240,0
v_mov_b32 v241,0
v_mov_b32 v242,0
v_mov_b32 v243,0
v_mov_b32 v244,0
v_mov_b32 v245,0
v_mov_b32 v246,0
v_mov_b32 v247,0
v_mov_b32 v248,0
v_mov_b32 v249,0
v_mov_b32 v250,0
v_mov_b32 v251,0
v_mov_b32 v252,0
v_mov_b32 v253,0
v_mov_b32 v254,0
v_mov_b32 v255,0
v_mov_b32 v48,0
v_mov_b32 v49,0
v_mov_b32 v50,0
v_mov_b32 v51,0
v_mov_b32 v52,0
v_mov_b32 v53,0
v_mov_b32 v54,0
v_mov_b32 v55,0
v_mov_b32 v56,0
v_mov_b32 v57,0
v_mov_b32 v58,0
v_mov_b32 v59,0
v_mov_b32 v60,0
v_mov_b32 v61,0
v_mov_b32 v62,0
v_mov_b32 v63,0
s_mov_b32 s4,0
FB0_L2:
s_add_u32 s5,s4,4096
buffer_load_dwordx4 a[192:195],v38,s[8:11],s4 offen offset:0
buffer_load_dwordx4 a[196:199],v38,s[8:11],s4 offen offset:64
buffer_load_dwordx4 a[200:203],v38,s[8:11],s4 offen offset:128
buffer_load_dwordx4 a[204:207],v38,s[8:11],s4 offen offset:192
buffer_load_dwordx4 a[208:211],v38,s[8:11],s5 offen offset:0
buffer_load_dwordx4 a[212:215],v38,s[8:11],s5 offen offset:64
buffer_load_dwordx4 a[216:219],v38,s[8:11],s5 offen offset:128
buffer_load_dwordx4 a[220:223],v38,s[8:11],s5 offen offset:192
s_add_u32 m0,s40,131072
s_nop 0
buffer_load_dwordx4 v3,s[12:15],s4 offen lds
buffer_load_dwordx4 v3,s[12:15],s4 offen offset:1024 lds
buffer_load_dwordx4 v3,s[12:15],s4 offen offset:2048 lds
buffer_load_dwordx4 v3,s[12:15],s4 offen offset:3072 lds
s_add_u32 m0,s40,135168
s_nop 0
buffer_load_dwordx4 v3,s[12:15],s5 offen lds
buffer_load_dwordx4 v3,s[12:15],s5 offen offset:1024 lds
buffer_load_dwordx4 v3,s[12:15],s5 offen offset:2048 lds
buffer_load_dwordx4 v3,s[12:15],s5 offen offset:3072 lds
s_waitcnt vmcnt(0)
ds_read_b64_tr_b16 a[224:225],v39 offset:0
ds_read_b64_tr_b16 a[226:227],v39 offset:4096
ds_read_b64_tr_b16 a[228:229],v39 offset:32
ds_read_b64_tr_b16 a[230:231],v39 offset:4128
ds_read_b64_tr_b16 a[232:233],v39 offset:64
ds_read_b64_tr_b16 a[234:235],v39 offset:4160
ds_read_b64_tr_b16 a[236:237],v39 offset:96
ds_read_b64_tr_b16 a[238:239],v39 offset:4192
ds_read_b64_tr_b16 a[240:241],v39 offset:128
ds_read_b64_tr_b16 a[242:243],v39 offset:4224
ds_read_b64_tr_b16 a[244:245],v39 offset:160
ds_read_b64_tr_b16 a[246:247],v39 offset:4256
ds_read_b64_tr_b16 a[248:249],v39 offset:192
ds_read_b64_tr_b16 a[250:251],v39 offset:4288
ds_read_b64_tr_b16 a[252:253],v39 offset:224
ds_read_b64_tr_b16 a[254:255],v39 offset:4320
v_mfma_f32_16x16x32_bf16 v[96:99],a[192:195],a[0:3],v[64:67]
v_mfma_f32_16x16x32_bf16 v[96:99],a[196:199],a[4:7],v[96:99]
v_mfma_f32_16x16x32_bf16 v[96:99],a[200:203],a[8:11],v[96:99]
v_mfma_f32_16x16x32_bf16 v[96:99],a[204:207],a[12:15],v[96:99]
v_mfma_f32_16x16x32_bf16 v[100:103],a[208:211],a[0:3],v[64:67]
v_mfma_f32_16x16x32_bf16 v[100:103],a[212:215],a[4:7],v[100:103]
v_mfma_f32_16x16x32_bf16 v[100:103],a[216:219],a[8:11],v[100:103]
v_mfma_f32_16x16x32_bf16 v[100:103],a[220:223],a[12:15],v[100:103]
v_mfma_f32_16x16x32_bf16 v[104:107],a[192:195],a[16:19],v[68:71]
v_mfma_f32_16x16x32_bf16 v[104:107],a[196:199],a[20:23],v[104:107]
v_mfma_f32_16x16x32_bf16 v[104:107],a[200:203],a[24:27],v[104:107]
v_mfma_f32_16x16x32_bf16 v[104:107],a[204:207],a[28:31],v[104:107]
v_mfma_f32_16x16x32_bf16 v[108:111],a[208:211],a[16:19],v[68:71]
v_mfma_f32_16x16x32_bf16 v[108:111],a[212:215],a[20:23],v[108:111]
v_mfma_f32_16x16x32_bf16 v[108:111],a[216:219],a[24:27],v[108:111]
v_mfma_f32_16x16x32_bf16 v[108:111],a[220:223],a[28:31],v[108:111]
v_mfma_f32_16x16x32_bf16 v[112:115],a[192:195],a[32:35],v[72:75]
v_mfma_f32_16x16x32_bf16 v[112:115],a[196:199],a[36:39],v[112:115]
v_mfma_f32_16x16x32_bf16 v[112:115],a[200:203],a[40:43],v[112:115]
v_mfma_f32_16x16x32_bf16 v[112:115],a[204:207],a[44:47],v[112:115]
v_mfma_f32_16x16x32_bf16 v[116:119],a[208:211],a[32:35],v[72:75]
v_mfma_f32_16x16x32_bf16 v[116:119],a[212:215],a[36:39],v[116:119]
v_mfma_f32_16x16x32_bf16 v[116:119],a[216:219],a[40:43],v[116:119]
v_mfma_f32_16x16x32_bf16 v[116:119],a[220:223],a[44:47],v[116:119]
v_mfma_f32_16x16x32_bf16 v[120:123],a[192:195],a[48:51],v[76:79]
v_mfma_f32_16x16x32_bf16 v[120:123],a[196:199],a[52:55],v[120:123]
v_mfma_f32_16x16x32_bf16 v[120:123],a[200:203],a[56:59],v[120:123]
v_mfma_f32_16x16x32_bf16 v[120:123],a[204:207],a[60:63],v[120:123]
v_mfma_f32_16x16x32_bf16 v[124:127],a[208:211],a[48:51],v[76:79]
v_mfma_f32_16x16x32_bf16 v[124:127],a[212:215],a[52:55],v[124:127]
v_mfma_f32_16x16x32_bf16 v[124:127],a[216:219],a[56:59],v[124:127]
v_mfma_f32_16x16x32_bf16 v[124:127],a[220:223],a[60:63],v[124:127]
s_nop 7
v_exp_f32 v96,v96
v_exp_f32 v97,v97
v_exp_f32 v98,v98
v_exp_f32 v99,v99
v_exp_f32 v100,v100
v_exp_f32 v101,v101
v_exp_f32 v102,v102
v_exp_f32 v103,v103
v_exp_f32 v104,v104
v_exp_f32 v105,v105
v_exp_f32 v106,v106
v_exp_f32 v107,v107
v_exp_f32 v108,v108
v_exp_f32 v109,v109
v_exp_f32 v110,v110
v_exp_f32 v111,v111
v_exp_f32 v112,v112
v_exp_f32 v113,v113
v_exp_f32 v114,v114
v_exp_f32 v115,v115
v_exp_f32 v116,v116
v_exp_f32 v117,v117
v_exp_f32 v118,v118
v_exp_f32 v119,v119
v_exp_f32 v120,v120
v_exp_f32 v121,v121
v_exp_f32 v122,v122
v_exp_f32 v123,v123
v_exp_f32 v124,v124
v_exp_f32 v125,v125
v_exp_f32 v126,v126
v_exp_f32 v127,v127
s_nop 0
v_cvt_pk_bf16_f32 v80,v96,v97
v_cvt_pk_bf16_f32 v81,v98,v99
v_cvt_pk_bf16_f32 v82,v100,v101
v_cvt_pk_bf16_f32 v83,v102,v103
v_cvt_pk_bf16_f32 v84,v104,v105
v_cvt_pk_bf16_f32 v85,v106,v107
v_cvt_pk_bf16_f32 v86,v108,v109
v_cvt_pk_bf16_f32 v87,v110,v111
v_cvt_pk_bf16_f32 v88,v112,v113
v_cvt_pk_bf16_f32 v89,v114,v115
v_cvt_pk_bf16_f32 v90,v116,v117
v_cvt_pk_bf16_f32 v91,v118,v119
v_cvt_pk_bf16_f32 v92,v120,v121
v_cvt_pk_bf16_f32 v93,v122,v123
v_cvt_pk_bf16_f32 v94,v124,v125
v_cvt_pk_bf16_f32 v95,v126,v127
s_waitcnt lgkmcnt(0)
s_nop 0
v_mfma_f32_16x16x32_bf16 v[128:131],a[224:227],v[80:83],v[128:131]
v_mfma_f32_16x16x32_bf16 v[132:135],a[228:231],v[80:83],v[132:135]
v_mfma_f32_16x16x32_bf16 v[136:139],a[232:235],v[80:83],v[136:139]
v_mfma_f32_16x16x32_bf16 v[140:143],a[236:239],v[80:83],v[140:143]
v_mfma_f32_16x16x32_bf16 v[144:147],a[240:243],v[80:83],v[144:147]
v_mfma_f32_16x16x32_bf16 v[148:151],a[244:247],v[80:83],v[148:151]
v_mfma_f32_16x16x32_bf16 v[152:155],a[248:251],v[80:83],v[152:155]
v_mfma_f32_16x16x32_bf16 v[156:159],a[252:255],v[80:83],v[156:159]
v_mfma_f32_16x16x32_bf16 v[48:51],v[44:47],v[80:83],v[48:51]
v_mfma_f32_16x16x32_bf16 v[160:163],a[224:227],v[84:87],v[160:163]
v_mfma_f32_16x16x32_bf16 v[164:167],a[228:231],v[84:87],v[164:167]
v_mfma_f32_16x16x32_bf16 v[168:171],a[232:235],v[84:87],v[168:171]
v_mfma_f32_16x16x32_bf16 v[172:175],a[236:239],v[84:87],v[172:175]
v_mfma_f32_16x16x32_bf16 v[176:179],a[240:243],v[84:87],v[176:179]
v_mfma_f32_16x16x32_bf16 v[180:183],a[244:247],v[84:87],v[180:183]
v_mfma_f32_16x16x32_bf16 v[184:187],a[248:251],v[84:87],v[184:187]
v_mfma_f32_16x16x32_bf16 v[188:191],a[252:255],v[84:87],v[188:191]
v_mfma_f32_16x16x32_bf16 v[52:55],v[44:47],v[84:87],v[52:55]
v_mfma_f32_16x16x32_bf16 v[192:195],a[224:227],v[88:91],v[192:195]
v_mfma_f32_16x16x32_bf16 v[196:199],a[228:231],v[88:91],v[196:199]
v_mfma_f32_16x16x32_bf16 v[200:203],a[232:235],v[88:91],v[200:203]
v_mfma_f32_16x16x32_bf16 v[204:207],a[236:239],v[88:91],v[204:207]
v_mfma_f32_16x16x32_bf16 v[208:211],a[240:243],v[88:91],v[208:211]
v_mfma_f32_16x16x32_bf16 v[212:215],a[244:247],v[88:91],v[212:215]
v_mfma_f32_16x16x32_bf16 v[216:219],a[248:251],v[88:91],v[216:219]
v_mfma_f32_16x16x32_bf16 v[220:223],a[252:255],v[88:91],v[220:223]
v_mfma_f32_16x16x32_bf16 v[56:59],v[44:47],v[88:91],v[56:59]
v_mfma_f32_16x16x32_bf16 v[224:227],a[224:227],v[92:95],v[224:227]
v_mfma_f32_16x16x32_bf16 v[228:231],a[228:231],v[92:95],v[228:231]
v_mfma_f32_16x16x32_bf16 v[232:235],a[232:235],v[92:95],v[232:235]
v_mfma_f32_16x16x32_bf16 v[236:239],a[236:239],v[92:95],v[236:239]
v_mfma_f32_16x16x32_bf16 v[240:243],a[240:243],v[92:95],v[240:243]
v_mfma_f32_16x16x32_bf16 v[244:247],a[244:247],v[92:95],v[244:247]
v_mfma_f32_16x16x32_bf16 v[248:251],a[248:251],v[92:95],v[248:251]
v_mfma_f32_16x16x32_bf16 v[252:255],a[252:255],v[92:95],v[252:255]
v_mfma_f32_16x16x32_bf16 v[60:63],v[44:47],v[92:95],v[60:63]
s_add_u32 s4,s4,8192
s_cmp_lt_u32 s4,262144
s_cbranch_scc1 FB0_L2
v_mfma_f32_16x16x32_bf16 v[96:99],a[128:131],a[64:67],0
v_mfma_f32_16x16x32_bf16 v[96:99],a[132:135],a[68:71],v[96:99]
v_mfma_f32_16x16x32_bf16 v[96:99],a[136:139],a[72:75],v[96:99]
v_mfma_f32_16x16x32_bf16 v[96:99],a[140:143],a[76:79],v[96:99]
v_mfma_f32_16x16x32_bf16 v[100:103],a[128:131],a[80:83],0
v_mfma_f32_16x16x32_bf16 v[100:103],a[132:135],a[84:87],v[100:103]
v_mfma_f32_16x16x32_bf16 v[100:103],a[136:139],a[88:91],v[100:103]
v_mfma_f32_16x16x32_bf16 v[100:103],a[140:143],a[92:95],v[100:103]
v_mfma_f32_16x16x32_bf16 v[104:107],a[128:131],a[96:99],0
v_mfma_f32_16x16x32_bf16 v[104:107],a[132:135],a[100:103],v[104:107]
v_mfma_f32_16x16x32_bf16 v[104:107],a[136:139],a[104:107],v[104:107]
v_mfma_f32_16x16x32_bf16 v[104:107],a[140:143],a[108:111],v[104:107]
v_mfma_f32_16x16x32_bf16 v[108:111],a[128:131],a[112:115],0
v_mfma_f32_16x16x32_bf16 v[108:111],a[132:135],a[116:119],v[108:111]
v_mfma_f32_16x16x32_bf16 v[108:111],a[136:139],a[120:123],v[108:111]
v_mfma_f32_16x16x32_bf16 v[108:111],a[140:143],a[124:127],v[108:111]
s_nop 7
v_max3_f32 v34,v96,v97,v98
v_max3_f32 v35,v100,v101,v102
v_max3_f32 v36,v104,v105,v106
v_max3_f32 v37,v108,v109,v110
v_max_f32 v34,v34,v99
v_max_f32 v35,v35,v103
v_max_f32 v36,v36,v107
v_max_f32 v37,v37,v111
v_mov_b32 v96,v34
v_mov_b32 v100,v35
v_mov_b32 v104,v36
v_mov_b32 v108,v37
v_permlane16_swap_b32 v34,v96
v_permlane16_swap_b32 v35,v100
v_permlane16_swap_b32 v36,v104
v_permlane16_swap_b32 v37,v108
v_max_f32 v34,v34,v96
v_max_f32 v35,v35,v100
v_max_f32 v36,v36,v104
v_max_f32 v37,v37,v108
v_mov_b32 v96,v34
v_mov_b32 v100,v35
v_mov_b32 v104,v36
v_mov_b32 v108,v37
v_permlane32_swap_b32 v34,v96
v_permlane32_swap_b32 v35,v100
v_permlane32_swap_b32 v36,v104
v_permlane32_swap_b32 v37,v108
v_max_f32 v34,v34,v96
v_max_f32 v35,v35,v100
v_max_f32 v36,v36,v104
v_max_f32 v37,v37,v108
v_sub_f32 v64,0,v34
v_sub_f32 v65,0,v34
v_sub_f32 v66,0,v34
v_sub_f32 v67,0,v34
v_sub_f32 v68,0,v35
v_sub_f32 v69,0,v35
v_sub_f32 v70,0,v35
v_sub_f32 v71,0,v35
v_sub_f32 v72,0,v36
v_sub_f32 v73,0,v36
v_sub_f32 v74,0,v36
v_sub_f32 v75,0,v36
v_sub_f32 v76,0,v37
v_sub_f32 v77,0,v37
v_sub_f32 v78,0,v37
v_sub_f32 v79,0,v37
s_mov_b32 m0,s7
s_nop 7
s_branch FB0_RET
FB1:
s_waitcnt vmcnt(0) lgkmcnt(0)
s_mov_b32 s7,m0
v_and_b32 v14,1,v31
v_lshrrev_b32 v15,1,v31
v_lshl_add_u32 v14,v14,1,v15
v_lshlrev_b32 v14,4,v14
v_lshl_add_u32 v14,v30,8,v14
v_lshl_add_u32 v15,v31,2,v32
v_lshlrev_b32 v15,8,v15
v_lshl_add_u32 v15,v33,3,v15
v_add_u32 v15,s40,v15
v_add_u32 v15,131072,v15
v_mov_b32 v10,0xff800000
v_mov_b32 v11,0xff800000
v_mov_b32 v12,0xff800000
v_mov_b32 v13,0xff800000
s_mov_b32 s4,262144
FB1_L1:
s_add_u32 s5,s4,4096
buffer_load_dwordx4 a[192:195],v14,s[8:11],s4 offen offset:0
buffer_load_dwordx4 a[196:199],v14,s[8:11],s4 offen offset:64
buffer_load_dwordx4 a[200:203],v14,s[8:11],s4 offen offset:128
buffer_load_dwordx4 a[204:207],v14,s[8:11],s4 offen offset:192
buffer_load_dwordx4 a[208:211],v14,s[8:11],s5 offen offset:0
buffer_load_dwordx4 a[212:215],v14,s[8:11],s5 offen offset:64
buffer_load_dwordx4 a[216:219],v14,s[8:11],s5 offen offset:128
buffer_load_dwordx4 a[220:223],v14,s[8:11],s5 offen offset:192
s_waitcnt vmcnt(0)
v_mfma_f32_16x16x32_bf16 v[96:99],a[192:195],a[64:67],0
v_mfma_f32_16x16x32_bf16 v[96:99],a[196:199],a[68:71],v[96:99]
v_mfma_f32_16x16x32_bf16 v[96:99],a[200:203],a[72:75],v[96:99]
v_mfma_f32_16x16x32_bf16 v[96:99],a[204:207],a[76:79],v[96:99]
v_mfma_f32_16x16x32_bf16 v[100:103],a[208:211],a[64:67],0
v_mfma_f32_16x16x32_bf16 v[100:103],a[212:215],a[68:71],v[100:103]
v_mfma_f32_16x16x32_bf16 v[100:103],a[216:219],a[72:75],v[100:103]
v_mfma_f32_16x16x32_bf16 v[100:103],a[220:223],a[76:79],v[100:103]
v_mfma_f32_16x16x32_bf16 v[104:107],a[192:195],a[80:83],0
v_mfma_f32_16x16x32_bf16 v[104:107],a[196:199],a[84:87],v[104:107]
v_mfma_f32_16x16x32_bf16 v[104:107],a[200:203],a[88:91],v[104:107]
v_mfma_f32_16x16x32_bf16 v[104:107],a[204:207],a[92:95],v[104:107]
v_mfma_f32_16x16x32_bf16 v[108:111],a[208:211],a[80:83],0
v_mfma_f32_16x16x32_bf16 v[108:111],a[212:215],a[84:87],v[108:111]
v_mfma_f32_16x16x32_bf16 v[108:111],a[216:219],a[88:91],v[108:111]
v_mfma_f32_16x16x32_bf16 v[108:111],a[220:223],a[92:95],v[108:111]
v_mfma_f32_16x16x32_bf16 v[112:115],a[192:195],a[96:99],0
v_mfma_f32_16x16x32_bf16 v[112:115],a[196:199],a[100:103],v[112:115]
v_mfma_f32_16x16x32_bf16 v[112:115],a[200:203],a[104:107],v[112:115]
v_mfma_f32_16x16x32_bf16 v[112:115],a[204:207],a[108:111],v[112:115]
v_mfma_f32_16x16x32_bf16 v[116:119],a[208:211],a[96:99],0
v_mfma_f32_16x16x32_bf16 v[116:119],a[212:215],a[100:103],v[116:119]
v_mfma_f32_16x16x32_bf16 v[116:119],a[216:219],a[104:107],v[116:119]
v_mfma_f32_16x16x32_bf16 v[116:119],a[220:223],a[108:111],v[116:119]
v_mfma_f32_16x16x32_bf16 v[120:123],a[192:195],a[112:115],0
v_mfma_f32_16x16x32_bf16 v[120:123],a[196:199],a[116:119],v[120:123]
v_mfma_f32_16x16x32_bf16 v[120:123],a[200:203],a[120:123],v[120:123]
v_mfma_f32_16x16x32_bf16 v[120:123],a[204:207],a[124:127],v[120:123]
v_mfma_f32_16x16x32_bf16 v[124:127],a[208:211],a[112:115],0
v_mfma_f32_16x16x32_bf16 v[124:127],a[212:215],a[116:119],v[124:127]
v_mfma_f32_16x16x32_bf16 v[124:127],a[216:219],a[120:123],v[124:127]
v_mfma_f32_16x16x32_bf16 v[124:127],a[220:223],a[124:127],v[124:127]
s_nop 7
v_max3_f32 v10,v10,v96,v97
v_max3_f32 v11,v11,v104,v105
v_max3_f32 v12,v12,v112,v113
v_max3_f32 v13,v13,v120,v121
v_max3_f32 v10,v10,v98,v99
v_max3_f32 v11,v11,v106,v107
v_max3_f32 v12,v12,v114,v115
v_max3_f32 v13,v13,v122,v123
v_max3_f32 v10,v10,v100,v101
v_max3_f32 v11,v11,v108,v109
v_max3_f32 v12,v12,v116,v117
v_max3_f32 v13,v13,v124,v125
v_max3_f32 v10,v10,v102,v103
v_max3_f32 v11,v11,v110,v111
v_max3_f32 v12,v12,v118,v119
v_max3_f32 v13,v13,v126,v127
s_add_u32 s4,s4,8192
s_cmp_lt_u32 s4,524288
s_cbranch_scc1 FB1_L1
v_mov_b32 v96,v10
v_mov_b32 v97,v11
v_mov_b32 v98,v12
v_mov_b32 v99,v13
s_nop 1
v_permlane16_swap_b32 v10,v96
v_permlane16_swap_b32 v11,v97
v_permlane16_swap_b32 v12,v98
v_permlane16_swap_b32 v13,v99
v_max_f32 v10,v10,v96
v_max_f32 v11,v11,v97
v_max_f32 v12,v12,v98
v_max_f32 v13,v13,v99
v_mov_b32 v96,v10
v_mov_b32 v97,v11
v_mov_b32 v98,v12
v_mov_b32 v99,v13
s_nop 1
v_permlane32_swap_b32 v10,v96
v_permlane32_swap_b32 v11,v97
v_permlane32_swap_b32 v12,v98
v_permlane32_swap_b32 v13,v99
v_max_f32 v10,v10,v96
v_max_f32 v11,v11,v97
v_max_f32 v12,v12,v98
v_max_f32 v13,v13,v99
v_sub_f32 v64,0,v10
v_sub_f32 v65,0,v10
v_sub_f32 v66,0,v10
v_sub_f32 v67,0,v10
v_sub_f32 v68,0,v11
v_sub_f32 v69,0,v11
v_sub_f32 v70,0,v11
v_sub_f32 v71,0,v11
v_sub_f32 v72,0,v12
v_sub_f32 v73,0,v12
v_sub_f32 v74,0,v12
v_sub_f32 v75,0,v12
v_sub_f32 v76,0,v13
v_sub_f32 v77,0,v13
v_sub_f32 v78,0,v13
v_sub_f32 v79,0,v13
v_mov_b32 v128,0
v_mov_b32 v129,0
v_mov_b32 v130,0
v_mov_b32 v131,0
v_mov_b32 v132,0
v_mov_b32 v133,0
v_mov_b32 v134,0
v_mov_b32 v135,0
v_mov_b32 v136,0
v_mov_b32 v137,0
v_mov_b32 v138,0
v_mov_b32 v139,0
v_mov_b32 v140,0
v_mov_b32 v141,0
v_mov_b32 v142,0
v_mov_b32 v143,0
v_mov_b32 v144,0
v_mov_b32 v145,0
v_mov_b32 v146,0
v_mov_b32 v147,0
v_mov_b32 v148,0
v_mov_b32 v149,0
v_mov_b32 v150,0
v_mov_b32 v151,0
v_mov_b32 v152,0
v_mov_b32 v153,0
v_mov_b32 v154,0
v_mov_b32 v155,0
v_mov_b32 v156,0
v_mov_b32 v157,0
v_mov_b32 v158,0
v_mov_b32 v159,0
v_mov_b32 v160,0
v_mov_b32 v161,0
v_mov_b32 v162,0
v_mov_b32 v163,0
v_mov_b32 v164,0
v_mov_b32 v165,0
v_mov_b32 v166,0
v_mov_b32 v167,0
v_mov_b32 v168,0
v_mov_b32 v169,0
v_mov_b32 v170,0
v_mov_b32 v171,0
v_mov_b32 v172,0
v_mov_b32 v173,0
v_mov_b32 v174,0
v_mov_b32 v175,0
v_mov_b32 v176,0
v_mov_b32 v177,0
v_mov_b32 v178,0
v_mov_b32 v179,0
v_mov_b32 v180,0
v_mov_b32 v181,0
v_mov_b32 v182,0
v_mov_b32 v183,0
v_mov_b32 v184,0
v_mov_b32 v185,0
v_mov_b32 v186,0
v_mov_b32 v187,0
v_mov_b32 v188,0
v_mov_b32 v189,0
v_mov_b32 v190,0
v_mov_b32 v191,0
v_mov_b32 v192,0
v_mov_b32 v193,0
v_mov_b32 v194,0
v_mov_b32 v195,0
v_mov_b32 v196,0
v_mov_b32 v197,0
v_mov_b32 v198,0
v_mov_b32 v199,0
v_mov_b32 v200,0
v_mov_b32 v201,0
v_mov_b32 v202,0
v_mov_b32 v203,0
v_mov_b32 v204,0
v_mov_b32 v205,0
v_mov_b32 v206,0
v_mov_b32 v207,0
v_mov_b32 v208,0
v_mov_b32 v209,0
v_mov_b32 v210,0
v_mov_b32 v211,0
v_mov_b32 v212,0
v_mov_b32 v213,0
v_mov_b32 v214,0
v_mov_b32 v215,0
v_mov_b32 v216,0
v_mov_b32 v217,0
v_mov_b32 v218,0
v_mov_b32 v219,0
v_mov_b32 v220,0
v_mov_b32 v221,0
v_mov_b32 v222,0
v_mov_b32 v223,0
v_mov_b32 v224,0
v_mov_b32 v225,0
v_mov_b32 v226,0
v_mov_b32 v227,0
v_mov_b32 v228,0
v_mov_b32 v229,0
v_mov_b32 v230,0
v_mov_b32 v231,0
v_mov_b32 v232,0
v_mov_b32 v233,0
v_mov_b32 v234,0
v_mov_b32 v235,0
v_mov_b32 v236,0
v_mov_b32 v237,0
v_mov_b32 v238,0
v_mov_b32 v239,0
v_mov_b32 v240,0
v_mov_b32 v241,0
v_mov_b32 v242,0
v_mov_b32 v243,0
v_mov_b32 v244,0
v_mov_b32 v245,0
v_mov_b32 v246,0
v_mov_b32 v247,0
v_mov_b32 v248,0
v_mov_b32 v249,0
v_mov_b32 v250,0
v_mov_b32 v251,0
v_mov_b32 v252,0
v_mov_b32 v253,0
v_mov_b32 v254,0
v_mov_b32 v255,0
v_mov_b32 v48,0
v_mov_b32 v49,0
v_mov_b32 v50,0
v_mov_b32 v51,0
v_mov_b32 v52,0
v_mov_b32 v53,0
v_mov_b32 v54,0
v_mov_b32 v55,0
v_mov_b32 v56,0
v_mov_b32 v57,0
v_mov_b32 v58,0
v_mov_b32 v59,0
v_mov_b32 v60,0
v_mov_b32 v61,0
v_mov_b32 v62,0
v_mov_b32 v63,0
s_mov_b32 s4,262144
FB1_L2:
s_add_u32 s5,s4,4096
buffer_load_dwordx4 a[192:195],v14,s[8:11],s4 offen offset:0
buffer_load_dwordx4 a[196:199],v14,s[8:11],s4 offen offset:64
buffer_load_dwordx4 a[200:203],v14,s[8:11],s4 offen offset:128
buffer_load_dwordx4 a[204:207],v14,s[8:11],s4 offen offset:192
buffer_load_dwordx4 a[208:211],v14,s[8:11],s5 offen offset:0
buffer_load_dwordx4 a[212:215],v14,s[8:11],s5 offen offset:64
buffer_load_dwordx4 a[216:219],v14,s[8:11],s5 offen offset:128
buffer_load_dwordx4 a[220:223],v14,s[8:11],s5 offen offset:192
s_add_u32 m0,s40,131072
s_nop 0
buffer_load_dwordx4 v3,s[12:15],s4 offen lds
buffer_load_dwordx4 v3,s[12:15],s4 offen offset:1024 lds
buffer_load_dwordx4 v3,s[12:15],s4 offen offset:2048 lds
buffer_load_dwordx4 v3,s[12:15],s4 offen offset:3072 lds
s_add_u32 m0,s40,135168
s_nop 0
buffer_load_dwordx4 v3,s[12:15],s5 offen lds
buffer_load_dwordx4 v3,s[12:15],s5 offen offset:1024 lds
buffer_load_dwordx4 v3,s[12:15],s5 offen offset:2048 lds
buffer_load_dwordx4 v3,s[12:15],s5 offen offset:3072 lds
s_waitcnt vmcnt(0)
ds_read_b64_tr_b16 a[224:225],v15 offset:0
ds_read_b64_tr_b16 a[226:227],v15 offset:4096
ds_read_b64_tr_b16 a[228:229],v15 offset:32
ds_read_b64_tr_b16 a[230:231],v15 offset:4128
ds_read_b64_tr_b16 a[232:233],v15 offset:64
ds_read_b64_tr_b16 a[234:235],v15 offset:4160
ds_read_b64_tr_b16 a[236:237],v15 offset:96
ds_read_b64_tr_b16 a[238:239],v15 offset:4192
ds_read_b64_tr_b16 a[240:241],v15 offset:128
ds_read_b64_tr_b16 a[242:243],v15 offset:4224
ds_read_b64_tr_b16 a[244:245],v15 offset:160
ds_read_b64_tr_b16 a[246:247],v15 offset:4256
ds_read_b64_tr_b16 a[248:249],v15 offset:192
ds_read_b64_tr_b16 a[250:251],v15 offset:4288
ds_read_b64_tr_b16 a[252:253],v15 offset:224
ds_read_b64_tr_b16 a[254:255],v15 offset:4320
v_mfma_f32_16x16x32_bf16 v[96:99],a[192:195],a[64:67],v[64:67]
v_mfma_f32_16x16x32_bf16 v[96:99],a[196:199],a[68:71],v[96:99]
v_mfma_f32_16x16x32_bf16 v[96:99],a[200:203],a[72:75],v[96:99]
v_mfma_f32_16x16x32_bf16 v[96:99],a[204:207],a[76:79],v[96:99]
v_mfma_f32_16x16x32_bf16 v[100:103],a[208:211],a[64:67],v[64:67]
v_mfma_f32_16x16x32_bf16 v[100:103],a[212:215],a[68:71],v[100:103]
v_mfma_f32_16x16x32_bf16 v[100:103],a[216:219],a[72:75],v[100:103]
v_mfma_f32_16x16x32_bf16 v[100:103],a[220:223],a[76:79],v[100:103]
v_mfma_f32_16x16x32_bf16 v[104:107],a[192:195],a[80:83],v[68:71]
v_mfma_f32_16x16x32_bf16 v[104:107],a[196:199],a[84:87],v[104:107]
v_mfma_f32_16x16x32_bf16 v[104:107],a[200:203],a[88:91],v[104:107]
v_mfma_f32_16x16x32_bf16 v[104:107],a[204:207],a[92:95],v[104:107]
v_mfma_f32_16x16x32_bf16 v[108:111],a[208:211],a[80:83],v[68:71]
v_mfma_f32_16x16x32_bf16 v[108:111],a[212:215],a[84:87],v[108:111]
v_mfma_f32_16x16x32_bf16 v[108:111],a[216:219],a[88:91],v[108:111]
v_mfma_f32_16x16x32_bf16 v[108:111],a[220:223],a[92:95],v[108:111]
v_mfma_f32_16x16x32_bf16 v[112:115],a[192:195],a[96:99],v[72:75]
v_mfma_f32_16x16x32_bf16 v[112:115],a[196:199],a[100:103],v[112:115]
v_mfma_f32_16x16x32_bf16 v[112:115],a[200:203],a[104:107],v[112:115]
v_mfma_f32_16x16x32_bf16 v[112:115],a[204:207],a[108:111],v[112:115]
v_mfma_f32_16x16x32_bf16 v[116:119],a[208:211],a[96:99],v[72:75]
v_mfma_f32_16x16x32_bf16 v[116:119],a[212:215],a[100:103],v[116:119]
v_mfma_f32_16x16x32_bf16 v[116:119],a[216:219],a[104:107],v[116:119]
v_mfma_f32_16x16x32_bf16 v[116:119],a[220:223],a[108:111],v[116:119]
v_mfma_f32_16x16x32_bf16 v[120:123],a[192:195],a[112:115],v[76:79]
v_mfma_f32_16x16x32_bf16 v[120:123],a[196:199],a[116:119],v[120:123]
v_mfma_f32_16x16x32_bf16 v[120:123],a[200:203],a[120:123],v[120:123]
v_mfma_f32_16x16x32_bf16 v[120:123],a[204:207],a[124:127],v[120:123]
v_mfma_f32_16x16x32_bf16 v[124:127],a[208:211],a[112:115],v[76:79]
v_mfma_f32_16x16x32_bf16 v[124:127],a[212:215],a[116:119],v[124:127]
v_mfma_f32_16x16x32_bf16 v[124:127],a[216:219],a[120:123],v[124:127]
v_mfma_f32_16x16x32_bf16 v[124:127],a[220:223],a[124:127],v[124:127]
s_nop 7
v_exp_f32 v96,v96
v_exp_f32 v97,v97
v_exp_f32 v98,v98
v_exp_f32 v99,v99
v_exp_f32 v100,v100
v_exp_f32 v101,v101
v_exp_f32 v102,v102
v_exp_f32 v103,v103
v_exp_f32 v104,v104
v_exp_f32 v105,v105
v_exp_f32 v106,v106
v_exp_f32 v107,v107
v_exp_f32 v108,v108
v_exp_f32 v109,v109
v_exp_f32 v110,v110
v_exp_f32 v111,v111
v_exp_f32 v112,v112
v_exp_f32 v113,v113
v_exp_f32 v114,v114
v_exp_f32 v115,v115
v_exp_f32 v116,v116
v_exp_f32 v117,v117
v_exp_f32 v118,v118
v_exp_f32 v119,v119
v_exp_f32 v120,v120
v_exp_f32 v121,v121
v_exp_f32 v122,v122
v_exp_f32 v123,v123
v_exp_f32 v124,v124
v_exp_f32 v125,v125
v_exp_f32 v126,v126
v_exp_f32 v127,v127
s_nop 0
v_cvt_pk_bf16_f32 v80,v96,v97
v_cvt_pk_bf16_f32 v81,v98,v99
v_cvt_pk_bf16_f32 v82,v100,v101
v_cvt_pk_bf16_f32 v83,v102,v103
v_cvt_pk_bf16_f32 v84,v104,v105
v_cvt_pk_bf16_f32 v85,v106,v107
v_cvt_pk_bf16_f32 v86,v108,v109
v_cvt_pk_bf16_f32 v87,v110,v111
v_cvt_pk_bf16_f32 v88,v112,v113
v_cvt_pk_bf16_f32 v89,v114,v115
v_cvt_pk_bf16_f32 v90,v116,v117
v_cvt_pk_bf16_f32 v91,v118,v119
v_cvt_pk_bf16_f32 v92,v120,v121
v_cvt_pk_bf16_f32 v93,v122,v123
v_cvt_pk_bf16_f32 v94,v124,v125
v_cvt_pk_bf16_f32 v95,v126,v127
s_waitcnt lgkmcnt(0)
s_nop 0
v_mfma_f32_16x16x32_bf16 v[128:131],a[224:227],v[80:83],v[128:131]
v_mfma_f32_16x16x32_bf16 v[132:135],a[228:231],v[80:83],v[132:135]
v_mfma_f32_16x16x32_bf16 v[136:139],a[232:235],v[80:83],v[136:139]
v_mfma_f32_16x16x32_bf16 v[140:143],a[236:239],v[80:83],v[140:143]
v_mfma_f32_16x16x32_bf16 v[144:147],a[240:243],v[80:83],v[144:147]
v_mfma_f32_16x16x32_bf16 v[148:151],a[244:247],v[80:83],v[148:151]
v_mfma_f32_16x16x32_bf16 v[152:155],a[248:251],v[80:83],v[152:155]
v_mfma_f32_16x16x32_bf16 v[156:159],a[252:255],v[80:83],v[156:159]
v_mfma_f32_16x16x32_bf16 v[48:51],v[44:47],v[80:83],v[48:51]
v_mfma_f32_16x16x32_bf16 v[160:163],a[224:227],v[84:87],v[160:163]
v_mfma_f32_16x16x32_bf16 v[164:167],a[228:231],v[84:87],v[164:167]
v_mfma_f32_16x16x32_bf16 v[168:171],a[232:235],v[84:87],v[168:171]
v_mfma_f32_16x16x32_bf16 v[172:175],a[236:239],v[84:87],v[172:175]
v_mfma_f32_16x16x32_bf16 v[176:179],a[240:243],v[84:87],v[176:179]
v_mfma_f32_16x16x32_bf16 v[180:183],a[244:247],v[84:87],v[180:183]
v_mfma_f32_16x16x32_bf16 v[184:187],a[248:251],v[84:87],v[184:187]
v_mfma_f32_16x16x32_bf16 v[188:191],a[252:255],v[84:87],v[188:191]
v_mfma_f32_16x16x32_bf16 v[52:55],v[44:47],v[84:87],v[52:55]
v_mfma_f32_16x16x32_bf16 v[192:195],a[224:227],v[88:91],v[192:195]
v_mfma_f32_16x16x32_bf16 v[196:199],a[228:231],v[88:91],v[196:199]
v_mfma_f32_16x16x32_bf16 v[200:203],a[232:235],v[88:91],v[200:203]
v_mfma_f32_16x16x32_bf16 v[204:207],a[236:239],v[88:91],v[204:207]
v_mfma_f32_16x16x32_bf16 v[208:211],a[240:243],v[88:91],v[208:211]
v_mfma_f32_16x16x32_bf16 v[212:215],a[244:247],v[88:91],v[212:215]
v_mfma_f32_16x16x32_bf16 v[216:219],a[248:251],v[88:91],v[216:219]
v_mfma_f32_16x16x32_bf16 v[220:223],a[252:255],v[88:91],v[220:223]
v_mfma_f32_16x16x32_bf16 v[56:59],v[44:47],v[88:91],v[56:59]
v_mfma_f32_16x16x32_bf16 v[224:227],a[224:227],v[92:95],v[224:227]
v_mfma_f32_16x16x32_bf16 v[228:231],a[228:231],v[92:95],v[228:231]
v_mfma_f32_16x16x32_bf16 v[232:235],a[232:235],v[92:95],v[232:235]
v_mfma_f32_16x16x32_bf16 v[236:239],a[236:239],v[92:95],v[236:239]
v_mfma_f32_16x16x32_bf16 v[240:243],a[240:243],v[92:95],v[240:243]
v_mfma_f32_16x16x32_bf16 v[244:247],a[244:247],v[92:95],v[244:247]
v_mfma_f32_16x16x32_bf16 v[248:251],a[248:251],v[92:95],v[248:251]
v_mfma_f32_16x16x32_bf16 v[252:255],a[252:255],v[92:95],v[252:255]
v_mfma_f32_16x16x32_bf16 v[60:63],v[44:47],v[92:95],v[60:63]
s_add_u32 s4,s4,8192
s_cmp_lt_u32 s4,524288
s_cbranch_scc1 FB1_L2
s_mov_b32 m0,s7
s_nop 7
s_branch FB1_RET
K1_END:
s_endpgm
.section .rodata,"a"
.p2align 6
.amdhsa_kernel concat_heads__mha_block_cached__mha_block_cached__near_ridge_kernel
.amdhsa_next_free_vgpr 512
.amdhsa_next_free_sgpr 102
.amdhsa_accum_offset 256
.amdhsa_group_segment_fixed_size 0
.amdhsa_kernarg_size 104
.amdhsa_user_sgpr_count 2
.amdhsa_user_sgpr_kernarg_segment_ptr 1
.amdhsa_system_sgpr_workgroup_id_x 1
.end_amdhsa_kernel
```
